```python
import torch

def _softmax(x, axis=-1):
    return torch.softmax(x, dim=axis)
def _gelu(x):
    return torch.nn.functional.gelu(x, approximate="tanh")
def _silu(x):
    return torch.nn.functional.silu(x)
def _sigmoid(x):
    return torch.sigmoid(x)
def _layernorm(x, axis=-1, eps=1e-5):
    m = x.mean(dim=axis, keepdim=True)
    v = x.var(dim=axis, keepdim=True, unbiased=False)
    return (x - m) / torch.sqrt(v + eps)
def _scatter_add(tgt, idx, src, axis=0):
    return tgt.clone().index_add_(axis, idx, src)
def _segment_sum(src, seg, n):
    out = torch.zeros((n,) + src.shape[1:], dtype=src.dtype)
    return out.index_add_(0, seg, src)
def _pad(x, pw):
    flat = tuple(v for pair in reversed(pw) for v in pair)
    return torch.nn.functional.pad(x, flat)

kernel_name = 'parallel_sum__linear_kernel_hedgehog__geglu_ffn__prompt'

def setup_inputs():

    _w = (lambda a: (lambda t: t.to(torch.bfloat16) if t.is_floating_point() else t)(torch.as_tensor(a)))
    def _A_setup():
        B, S, D, H = 1, 2048, 1024, 32
        Dh = D // H
        return {
            "x": _w((lambda *s: torch.randn(*s, dtype=torch.bfloat16) * 0.05)(B, S, D)),
            "wqkv": _w((lambda *s: torch.randn(*s, dtype=torch.bfloat16) * 0.8)(D, 3 * D)),
            "w_phi": _w((lambda *s: torch.randn(*s, dtype=torch.bfloat16) * 0.8)(H, Dh, Dh) * (Dh ** -0.5)),
            "wo": _w((lambda *s: torch.randn(*s, dtype=torch.bfloat16) * 0.2)(D, D)),
        }
    _A_in = _A_setup()

    def _B_setup():
        B, S, D, F = 1, 2048, 1024, 3584
        return {
            "x": _w((lambda *s: torch.randn(*s, dtype=torch.bfloat16) * 0.05)(B, S, D)),
            "w_gate": _w((lambda *s: torch.randn(*s, dtype=torch.bfloat16) * 0.05)(D, F)),
            "w_up": _w((lambda *s: torch.randn(*s, dtype=torch.bfloat16) * 0.05)(D, F)),
            "w_down": _w((lambda *s: torch.randn(*s, dtype=torch.bfloat16) * 0.05)(F, D)),
        }
    _B_in = _B_setup()

    return {
        "A_x": _A_in["x"],
        "A_wqkv": _A_in["wqkv"],
        "A_w_phi": _A_in["w_phi"],
        "A_wo": _A_in["wo"],
        "B_x": _B_in["x"],
        "B_w_gate": _B_in["w_gate"],
        "B_w_up": _B_in["w_up"],
        "B_w_down": _B_in["w_down"],
    }

def reference(A_x, A_wqkv, A_w_phi, A_wo, B_x, B_w_gate, B_w_up, B_w_down):
    def _A_ref(x, wqkv, w_phi, wo):
        B, S, D = x.shape
        H = 32; Dh = D // H
        qkv = (lambda x, *d: x.permute(*d))((x @ wqkv).reshape(B, S, 3, H, Dh), 2, 0, 3, 1, 4)
        q, k, v = qkv[0], qkv[1], qkv[2]
        pq = torch.einsum("bhsd,hdf->bhsf", q, w_phi)
        pk = torch.einsum("bhsd,hdf->bhsf", k, w_phi)
        phi_q = torch.concatenate([_softmax(pq, axis=-1), _softmax(-pq, axis=-1)], axis=-1)
        phi_k = torch.concatenate([_softmax(pk, axis=-1), _softmax(-pk, axis=-1)], axis=-1)
        kv = torch.einsum("bhsf,bhsd->bhfd", phi_k, v)
        z  = torch.einsum("bhsf->bhf", phi_k)
        num = torch.einsum("bhqf,bhfd->bhqd", phi_q, kv)
        den = torch.einsum("bhqf,bhf->bhq", phi_q, z)[..., None] + 1e-6
        o = num / den
        return (lambda x, *d: x.permute(*d))(o, 0, 2, 1, 3).reshape(B, S, D) @ wo

    def _B_ref(x, w_gate, w_up, w_down):
        return (_gelu(x @ w_gate) * (x @ w_up)) @ w_down

    x = A_x
    xn = _layernorm(x, axis=-1)
    return x + _A_ref(xn, A_wqkv, A_w_phi, A_wo) + _B_ref(xn, B_w_gate, B_w_up, B_w_down)
```

```asm
; @launch grid=(256,1,1) block=(512,1,1) lds=163840
.amdgcn_target "amdgcn-amd-amdhsa--gfx950"
.text
.globl parallel_sum__linear_kernel_hedgehog__geglu_ffn__prompt_kernel
.p2align 8
.type parallel_sum__linear_kernel_hedgehog__geglu_ffn__prompt_kernel,@function
parallel_sum__linear_kernel_hedgehog__geglu_ffn__prompt_kernel:
    s_cmp_ge_u32 s2, 256
    s_cbranch_scc1 L_done
    s_xor_b32 s2, s2, 1
    s_load_dwordx8 s[40:47], s[0:1], 0
    s_load_dwordx8 s[48:55], s[0:1], 40
    s_load_dwordx2 s[56:57], s[0:1], 80
    v_lshrrev_b32 v16, 6, v0
    v_and_b32 v1, 63, v0
    v_readfirstlane_b32 s59, v16
    v_lshlrev_b32 v2, 4, v1
    v_mov_b32 v22, s0
    v_mov_b32 v23, s1
    s_cmp_lt_u32 s59, 5
    s_cbranch_scc1 L_main
    s_cmp_eq_u32 s59, 7
    s_cbranch_scc1 L_t7
    s_cmp_eq_u32 s59, 6
    s_cbranch_scc1 L_t6
    s_bfe_u32 s5, s2, 0x30003
    s_lshl_b32 s5, s5, 19
    s_lshr_b32 s6, s2, 6
    s_lshl_b32 s6, s6, 17
    s_add_u32 s5, s5, s6
    v_lshl_add_u32 v17, v1, 11, s5
    v_lshrrev_b32 v18, 3, v1
    v_and_b32 v19, 7, v1
    v_min_u32 v19, -1, v19
    v_lshlrev_b32 v19, 7, v19
    v_lshl_add_u32 v18, v18, 11, v19
    s_lshl_b32 s5, s2, 14
    s_add_u32 s5, s5, 256
    v_add_u32 v18, s5, v18
    s_waitcnt lgkmcnt(0)
    global_load_dword v227, v17, s[40:41] offset:0
    global_load_dword v227, v17, s[40:41] offset:128
    s_branch L_main
L_t6:
    s_getpc_b64 s[6:7]
L_pc:
    s_lshr_b32 s5, s2, 3
    s_mul_i32 s5, s5, (L_end-L_pc+4095)/4096
    v_min_u32 v18, (L_end-L_pc+4095)/4096-1, v1
    v_add_u32 v18, s5, v18
    v_min_u32 v18, (L_end-L_pc)/128-1, v18
    v_lshlrev_b32 v18, 7, v18
    v_mov_b32 v19, s7
    v_add_co_u32 v18, vcc, s6, v18
    s_nop 1
    v_addc_co_u32 v19, vcc, 0, v19, vcc
    global_load_dword v227, v[18:19], off
    s_branch L_main
L_t7:
    v_min_u32 v20, 55, v1
    v_cmp_lt_u32 vcc, 27, v20
    v_subrev_u32 v17, 28, v20
    v_min_u32 v20, v20, v17
    v_mul_u32_u24 v17, 9363, v20
    v_lshrrev_b32 v17, 16, v17
    v_mul_u32_u24 v17, 228480, v17
    v_lshl_add_u32 v20, v20, 7, v17
    s_lshr_b32 s5, s2, 3
    s_mul_i32 s5, s5, 7168
    s_and_b32 s6, s2, 7
    s_mul_i32 s6, s6, 896
    s_add_u32 s5, s5, s6
    v_add_u32 v20, s5, v20
    s_waitcnt lgkmcnt(0)
    v_mov_b32 v17, s48
    v_mov_b32 v18, s50
    v_cndmask_b32 v17, v17, v18, vcc
    v_mov_b32 v18, s49
    v_mov_b32 v19, s51
    v_cndmask_b32 v18, v18, v19, vcc
    v_add_co_u32 v22, vcc, v20, v17
    s_nop 1
    v_addc_co_u32 v23, vcc, 0, v18, vcc
    global_load_dword v20, v[22:23], off
    v_add_co_u32 v22, vcc, 917504, v22
    s_nop 1
    v_addc_co_u32 v23, vcc, 0, v23, vcc
L_main:
    v_lshrrev_b32 v17, 3, v1
    v_and_b32 v18, 7, v1
    v_lshrrev_b32 v19, 4, v1
    v_xor_b32 v18, v18, v19
    v_lshlrev_b32 v18, 4, v18
    v_lshl_add_u32 v17, v16, 5, v17
    v_lshl_add_u32 v4, v17, 11, v18
    v_xor_b32 v5, 64, v4
    v_add_u32 v5, 15360, v5
    s_and_b32 s3, s2, 7
    s_lshr_b32 s4, s2, 3
    s_and_b32 s62, s4, 7
    s_lshr_b32 s4, s4, 3
    s_lshl_b32 s3, s3, 2
    s_add_u32 s63, s3, s4
    s_lshl_b32 s64, s62, 19
    s_add_u32 s66, s64, 30720
    s_lshl_b32 s28, s59, 12
    s_lshl_b32 s3, s2, 14
    s_lshl_b32 s4, s59, 11
    s_add_u32 s3, s3, s4
    s_waitcnt lgkmcnt(0)
    s_mov_b32 s8, s40
    s_mov_b32 s9, s41
    s_and_b32 s9, s9, 0xffff
    s_mov_b32 s10, 0x400000
    s_mov_b32 s11, 0x20000
    buffer_load_dwordx4 v[104:107], v2, s[8:11], s3 offen offset:0
    buffer_load_dwordx4 v[108:111], v2, s[8:11], s3 offen offset:1024
    v_mul_u32_u24 v16, 4682, v0
    v_lshrrev_b32 v16, 16, v16
    v_mul_u32_u24 v17, 14, v16
    v_sub_u32 v17, v0, v17
    s_and_b32 s5, s63, 1
    s_lshl_b32 s5, s5, 1
    v_add_u32 v17, s5, v17
    v_subrev_u32 v18, 14, v17
    v_min_u32 v17, v17, v18
    v_and_b32 v18, 3, v16
    v_bfe_u32 v19, v16, 2, 2
    v_lshl_add_u32 v18, v19, 3, v18
    v_lshrrev_b32 v19, 4, v16
    v_lshl_add_u32 v16, v19, 2, v18
    v_mul_u32_u24 v16, 7168, v16
    v_lshl_add_u32 v16, v17, 4, v16
    s_mul_i32 s5, s63, 224
    v_add_u32 v6, s5, v16
    s_waitcnt lgkmcnt(0)
    s_mov_b32 s12, s48
    s_mov_b32 s13, s49
    s_and_b32 s13, s13, 0xffff
    s_mov_b32 s14, 0x700000
    s_mov_b32 s15, 0x20000
    s_mov_b32 s16, s50
    s_mov_b32 s17, s51
    s_and_b32 s17, s17, 0xffff
    s_mov_b32 s18, 0x700000
    s_mov_b32 s19, 0x20000
    s_lshl_b32 s5, s59, 10
    s_add_u32 s29, s5, 65536
    s_mov_b32 s65, 0
    s_add_u32 s24, s56, 0x1a00000
    s_addc_u32 s25, s57, 0
    s_and_b32 s25, s25, 0xffff
    s_mov_b32 s26, 0x2600000
    s_mov_b32 s27, 0x20000
    s_mov_b32 s5, 2162688
    buffer_load_dword v33, off, s[24:27], s5 sc1
    s_and_b32 s60, s59, 3
    s_lshr_b32 s61, s59, 2
    s_and_b32 s57, s57, 0xffff
    s_lshl_b32 s95, s59, 11
    s_mov_b32 s76, s42
    s_mov_b32 s77, s43
    s_and_b32 s77, s77, 0xffff
    s_mov_b32 s78, 0x600000
    s_mov_b32 s79, 0x20000
    v_lshrrev_b32 v16, 4, v1
    v_bfe_u32 v17, v1, 2, 2
    v_lshl_add_u32 v16, v16, 3, v17
    v_mul_u32_u24 v16, 6144, v16
    v_lshrrev_b32 v17, 3, v1
    v_and_b32 v17, 2, v17
    v_and_b32 v18, 3, v1
    v_xor_b32 v17, v17, v18
    v_lshl_add_u32 v16, v17, 4, v16
    s_lshl_b32 s5, s63, 6
    v_add_u32 v35, s5, v16
    v_and_b32 v26, 15, v1
    s_lshl_b32 s5, s60, 9
    s_add_u32 s5, s5, 156672
    v_lshl_add_u32 v26, v26, 3, s5
    s_lshl_b32 s5, s60, 6
    s_lshl_b32 s6, s61, 9
    s_add_u32 s5, s5, s6
    s_add_u32 s5, s5, 160768
    v_and_b32 v27, 15, v1
    v_lshl_add_u32 v27, v27, 2, s5
    v_mov_b32 v28, 0x3f803f80
    v_mov_b32 v29, 0x3f803f80
    v_mov_b32 v30, 0x3f803f80
    v_mov_b32 v31, 0x3f803f80
    s_mov_b32 s32, s44
    s_mov_b32 s33, s45
    s_and_b32 s33, s33, 0xffff
    s_mov_b32 s34, 0x10000
    s_mov_b32 s35, 0x20000
    s_mov_b32 s20, s56
    s_mov_b32 s21, s57
    s_and_b32 s21, s21, 0xffff
    s_mov_b32 s22, 0x400000
    s_mov_b32 s23, 0x20000
    v_bfe_u32 v16, v1, 3, 1
    v_and_b32 v17, 7, v1
    v_lshlrev_b32 v17, 7, v17
    v_lshl_add_u32 v16, v16, 10, v17
    v_bfe_u32 v17, v1, 1, 3
    v_lshrrev_b32 v18, 4, v1
    v_xor_b32 v17, v17, v18
    v_lshl_add_u32 v16, v17, 4, v16
    s_lshl_b32 s5, s60, 13
    v_add_u32 v8, s5, v16
    v_xor_b32 v9, 64, v8
    v_add_u32 v94, 123904, v8
    v_add_u32 v95, 123904, v9
    v_lshrrev_b32 v16, 2, v1
    v_and_b32 v17, 3, v1
    v_lshlrev_b32 v17, 3, v17
    v_mul_u32_u24 v10, 224, v16
    v_add_u32 v10, v10, v17
    v_add_u32 v10, 65536, v10
    v_lshl_add_u32 v16, v16, 6, v17
    v_bfe_u32 v17, v1, 4, 1
    v_lshl_add_u32 v16, v17, 5, v16
    v_add_u32 v16, 98304, v16
    v_xor_b32 v32, 32, v16
    v_xor_b32 v92, 32, v32
    s_mov_b32 s36, 0
    s_mov_b32 s87, 0x3f803f80
    s_bfe_u32 s70, s2, 0x20001
    s_and_b32 s5, s2, 1
    s_lshl_b32 s5, s5, 2
    s_lshr_b32 s6, s2, 6
    s_add_u32 s71, s5, s6
    s_bfe_u32 s72, s2, 0x30003
    s_mul_i32 s74, s70, 1835008
    s_lshl_b32 s5, s71, 1
    s_add_u32 s5, s5, s61
    s_mul_i32 s5, s5, 1179648
    s_lshl_b32 s6, s60, 11
    s_add_u32 s5, s5, s6
    s_mul_i32 s6, s70, 229376
    s_add_u32 s75, s5, s6
    s_lshl_b32 s6, s70, 16
    s_add_u32 s5, s5, s6
    s_add_u32 s73, s5, 917504
    s_lshl_b32 s5, s71, 19
    s_lshl_b32 s6, s59, 16
    s_add_u32 s5, s5, s6
    s_lshl_b32 s6, s72, 8
    s_add_u32 s5, s5, s6
    s_and_b32 s6, s59, 3
    s_xor_b32 s6, s6, s70
    s_lshl_b32 s6, s6, 6
    s_add_u32 s93, s5, s6
    s_lshl_b32 s5, s71, 3
    s_add_u32 s5, s5, s72
    s_lshl_b32 s5, s5, 2
    s_add_u32 s5, s5, s70
    s_lshl_b32 s6, s5, 16
    s_add_u32 s94, s6, s95
    s_add_u32 s94, s94, 0x600000
    s_lshl_b32 s5, s5, 3
    s_add_u32 s5, s5, s59
    s_lshl_b32 s5, s5, 7
    s_add_u32 s92, s5, 2883584
    s_lshl_b32 s5, s62, 1
    s_lshr_b32 s6, s60, 1
    s_add_u32 s5, s5, s6
    s_mul_i32 s88, s5, 1179648
    s_and_b32 s7, s60, 1
    s_lshl_b32 s6, s7, 12
    s_add_u32 s88, s88, s6
    s_lshl_b32 s5, s62, 12
    s_lshl_b32 s6, s63, 7
    s_add_u32 s5, s5, s6
    s_lshl_b32 s6, s59, 2
    s_add_u32 s5, s5, s6
    s_add_u32 s89, s5, 2228224
    s_lshl_b32 s5, s71, 12
    s_lshl_b32 s6, s70, 10
    s_add_u32 s5, s5, s6
    s_add_u32 s90, s5, 2228224
    s_mul_i32 s91, s63, 67584
    s_mul_i32 s5, s63, 7
    s_add_u32 s5, s5, 1
    s_lshr_b32 s5, s5, 1
    s_lshl_b32 s6, s61, 1
    s_add_u32 s5, s5, s6
    s_lshl_b32 s5, s5, 13
    s_add_u32 s88, s5, s88
    s_mov_b32 s84, 0x3fb8aa3b
    s_mov_b32 s85, 0x3fb8aa3b
    s_mov_b32 s86, 0xbdd2d3e8
    s_mov_b32 s69, 0xc0135761
    s_cmp_eq_u32 s59, 1
    s_cbranch_scc1 L_w1
    s_cmp_eq_u32 s59, 2
    s_cbranch_scc1 L_w2
    s_cmp_eq_u32 s59, 3
    s_cbranch_scc1 L_w3
    s_cmp_eq_u32 s59, 4
    s_cbranch_scc1 L_w4
    s_cmp_eq_u32 s59, 5
    s_cbranch_scc1 L_w5
    s_cmp_eq_u32 s59, 6
    s_cbranch_scc1 L_w6
    s_cmp_eq_u32 s59, 7
    s_cbranch_scc1 L_w7
L_w0:
    s_barrier
    s_add_u32 m0, s28, 0
    s_nop 0
    buffer_load_dwordx4 v4, s[8:11], s64 offen offset:0 sc1 lds
    buffer_load_dwordx4 v5, s[8:11], s64 offen offset:1024 sc1 lds
    buffer_load_dwordx4 v4, s[8:11], s66 offen offset:2048 sc1 lds
    buffer_load_dwordx4 v5, s[8:11], s66 offen offset:3072 sc1 lds
    s_add_u32 s64, s64, 128
    s_bitset0_b32 s64, 11
    s_add_u32 s66, s64, 30720
    s_add_u32 m0, s29, 0
    s_nop 0
    buffer_load_dwordx4 v6, s[12:15], s65 offen lds
    s_add_u32 s65, s65, 229376
    s_add_u32 m0, s29, 7296
    s_nop 0
    buffer_load_dwordx4 v6, s[12:15], s65 offen lds
    s_sub_u32 s65, s65, 229376
    s_add_u32 m0, s29, 14592
    s_nop 0
    buffer_load_dwordx4 v6, s[16:19], s65 offen lds
    s_add_u32 s65, s65, 229376
    s_add_u32 m0, s29, 21888
    s_nop 0
    buffer_load_dwordx4 v6, s[16:19], s65 offen lds
    s_add_u32 s65, s65, 229376
    s_waitcnt vmcnt(9)
    v_lshlrev_b32 v112, 16, v104
    v_and_b32 v113, 0xffff0000, v104
    v_lshlrev_b32 v114, 16, v105
    v_and_b32 v115, 0xffff0000, v105
    v_lshlrev_b32 v116, 16, v106
    v_and_b32 v117, 0xffff0000, v106
    v_lshlrev_b32 v118, 16, v107
    v_and_b32 v119, 0xffff0000, v107
    v_lshlrev_b32 v120, 16, v108
    v_and_b32 v121, 0xffff0000, v108
    v_lshlrev_b32 v122, 16, v109
    v_and_b32 v123, 0xffff0000, v109
    v_lshlrev_b32 v124, 16, v110
    v_and_b32 v125, 0xffff0000, v110
    v_lshlrev_b32 v126, 16, v111
    v_and_b32 v127, 0xffff0000, v111
    v_add_f32 v36, v112, v116
    v_add_f32 v37, v113, v117
    v_add_f32 v38, v114, v118
    v_add_f32 v39, v115, v119
    v_add_f32 v36, v36, v120
    v_add_f32 v37, v37, v121
    v_add_f32 v38, v38, v122
    v_add_f32 v39, v39, v123
    v_add_f32 v36, v36, v124
    v_add_f32 v37, v37, v125
    v_add_f32 v38, v38, v126
    v_add_f32 v39, v39, v127
    v_add_f32 v36, v36, v37
    v_add_f32 v38, v38, v39
    v_add_f32 v34, v36, v38
    s_nop 1
    v_add_f32_dpp v34, v34, v34 row_ror:8 row_mask:0xf bank_mask:0xf
    s_nop 1
    v_add_f32_dpp v34, v34, v34 row_ror:4 row_mask:0xf bank_mask:0xf
    s_nop 1
    v_add_f32_dpp v34, v34, v34 row_ror:2 row_mask:0xf bank_mask:0xf
    s_nop 1
    v_add_f32_dpp v34, v34, v34 row_ror:1 row_mask:0xf bank_mask:0xf
    v_mov_b32 v36, v34
    s_nop 1
    v_permlane16_swap_b32 v34, v36
    v_add_f32 v34, v34, v36
    v_mov_b32 v36, v34
    s_nop 1
    v_permlane32_swap_b32 v34, v36
    v_add_f32 v34, v34, v36
    v_mul_f32 v34, 0x3a800000, v34
    v_cvt_pk_bf16_f32 v14, v34, v34
    v_and_b32 v14, 0xffff0000, v14
    v_sub_f32 v112, v112, v14
    v_sub_f32 v113, v113, v14
    v_sub_f32 v114, v114, v14
    v_sub_f32 v115, v115, v14
    v_sub_f32 v116, v116, v14
    v_sub_f32 v117, v117, v14
    v_sub_f32 v118, v118, v14
    v_sub_f32 v119, v119, v14
    v_sub_f32 v120, v120, v14
    v_sub_f32 v121, v121, v14
    v_sub_f32 v122, v122, v14
    v_sub_f32 v123, v123, v14
    v_sub_f32 v124, v124, v14
    v_sub_f32 v125, v125, v14
    v_sub_f32 v126, v126, v14
    v_sub_f32 v127, v127, v14
    v_mul_f32 v36, v112, v112
    v_mul_f32 v37, v113, v113
    v_mul_f32 v38, v114, v114
    v_mul_f32 v39, v115, v115
    v_fmac_f32 v36, v116, v116
    v_fmac_f32 v37, v117, v117
    v_fmac_f32 v38, v118, v118
    v_fmac_f32 v39, v119, v119
    v_fmac_f32 v36, v120, v120
    v_fmac_f32 v37, v121, v121
    v_fmac_f32 v38, v122, v122
    v_fmac_f32 v39, v123, v123
    v_fmac_f32 v36, v124, v124
    v_fmac_f32 v37, v125, v125
    v_fmac_f32 v38, v126, v126
    v_fmac_f32 v39, v127, v127
    v_add_f32 v36, v36, v37
    v_add_f32 v38, v38, v39
    v_sub_f32 v34, v34, v14
    v_add_f32 v12, v36, v38
    s_nop 1
    v_add_f32_dpp v12, v12, v12 row_ror:8 row_mask:0xf bank_mask:0xf
    v_cvt_pk_bf16_f32 v104, v112, v113
    s_nop 0
    v_add_f32_dpp v12, v12, v12 row_ror:4 row_mask:0xf bank_mask:0xf
    v_cvt_pk_bf16_f32 v105, v114, v115
    s_nop 0
    v_add_f32_dpp v12, v12, v12 row_ror:2 row_mask:0xf bank_mask:0xf
    v_cvt_pk_bf16_f32 v106, v116, v117
    s_nop 0
    v_add_f32_dpp v12, v12, v12 row_ror:1 row_mask:0xf bank_mask:0xf
    v_cvt_pk_bf16_f32 v107, v118, v119
    v_mov_b32 v36, v12
    v_cvt_pk_bf16_f32 v108, v120, v121
    s_nop 0
    v_permlane16_swap_b32 v12, v36
    v_cvt_pk_bf16_f32 v109, v122, v123
    v_add_f32 v12, v12, v36
    v_cvt_pk_bf16_f32 v110, v124, v125
    v_mov_b32 v36, v12
    v_cvt_pk_bf16_f32 v111, v126, v127
    s_nop 0
    v_permlane32_swap_b32 v12, v36
    v_lshlrev_b32 v112, 16, v104
    v_add_f32 v12, v12, v36
    v_and_b32 v113, 0xffff0000, v104
    v_mul_f32 v12, 0x3a800000, v12
    v_lshlrev_b32 v114, 16, v105
    v_fma_f32 v12, -v34, v34, v12
    v_and_b32 v115, 0xffff0000, v105
    v_max_f32 v12, 0, v12
    v_lshlrev_b32 v116, 16, v106
    v_cvt_pk_bf16_f32 v12, v12, v12
    v_and_b32 v117, 0xffff0000, v106
    v_and_b32 v12, 0xffff0000, v12
    v_lshlrev_b32 v118, 16, v107
    v_add_f32 v12, 0x3727c5ac, v12
    v_and_b32 v119, 0xffff0000, v107
    v_cvt_pk_bf16_f32 v12, v12, v12
    v_lshlrev_b32 v120, 16, v108
    v_and_b32 v12, 0xffff0000, v12
    v_and_b32 v121, 0xffff0000, v108
    v_sqrt_f32 v15, v12
    v_lshlrev_b32 v122, 16, v109
    v_cvt_pk_bf16_f32 v15, v15, v15
    v_and_b32 v123, 0xffff0000, v109
    v_and_b32 v15, 0xffff0000, v15
    v_lshlrev_b32 v124, 16, v110
    v_rcp_f32 v12, v15
    v_and_b32 v125, 0xffff0000, v110
    v_sub_f32 v14, 0, v14
    v_lshlrev_b32 v126, 16, v111
    v_and_b32 v127, 0xffff0000, v111
    v_mul_f32 v112, v112, v12
    v_mul_f32 v113, v113, v12
    v_mul_f32 v114, v114, v12
    v_mul_f32 v115, v115, v12
    v_mul_f32 v116, v116, v12
    v_mul_f32 v117, v117, v12
    v_mul_f32 v118, v118, v12
    v_mul_f32 v119, v119, v12
    v_mul_f32 v120, v120, v12
    v_mul_f32 v121, v121, v12
    v_mul_f32 v122, v122, v12
    v_mul_f32 v123, v123, v12
    v_mul_f32 v124, v124, v12
    v_mul_f32 v125, v125, v12
    v_mul_f32 v126, v126, v12
    v_mul_f32 v127, v127, v12
    v_cvt_pk_bf16_f32 v104, v112, v113
    v_cvt_pk_bf16_f32 v105, v114, v115
    v_cvt_pk_bf16_f32 v106, v116, v117
    v_cvt_pk_bf16_f32 v107, v118, v119
    v_cvt_pk_bf16_f32 v108, v120, v121
    v_cvt_pk_bf16_f32 v109, v122, v123
    v_cvt_pk_bf16_f32 v110, v124, v125
    v_cvt_pk_bf16_f32 v111, v126, v127
    buffer_store_dwordx4 v[104:107], v2, s[20:23], s3 offen offset:0 sc1
    buffer_store_dwordx4 v[108:111], v2, s[20:23], s3 offen offset:1024 sc1
    v_lshrrev_b32 v14, 16, v14
    v_or_b32 v14, v14, v15
    s_waitcnt vmcnt(10)
    s_mov_b32 s5, 0x9E3779B1
    v_mul_lo_u32 v33, v33, s5
    v_add_u32 v33, 0x7F4A7C15, v33
    s_nop 0
    v_readfirstlane_b32 s58, v33
    v_mov_b32 v15, v33
    s_waitcnt vmcnt(4)
    s_barrier
    ds_read_b128 v[40:43], v8 offset:0
    ds_read_b64_tr_b16 v[84:85], v10 offset:0
    ds_read_b64_tr_b16 v[86:87], v10 offset:3584
    ds_read_b128 v[56:59], v9 offset:0
    ds_read_b64_tr_b16 v[88:89], v10 offset:7296
    ds_read_b64_tr_b16 v[90:91], v10 offset:10880
    ds_read_b128 v[60:63], v9 offset:2048
    ds_read_b128 v[44:47], v8 offset:2048
    ds_read_b128 v[48:51], v8 offset:4096
    ds_read_b128 v[64:67], v9 offset:4096
    ds_read_b128 v[68:71], v9 offset:6144
    ds_read_b128 v[52:55], v8 offset:6144
    ds_read_b64_tr_b16 v[72:73], v10 offset:32
    ds_read_b64_tr_b16 v[74:75], v10 offset:3616
    ds_read_b64_tr_b16 v[76:77], v10 offset:7328
    ds_read_b64_tr_b16 v[78:79], v10 offset:10912
    s_mov_b32 s37, 1572864
    s_add_u32 m0, s28, 32768
    s_waitcnt lgkmcnt(10)
    v_mfma_f32_16x16x32_bf16 v[128:131], v[84:87], v[40:43], 0
    s_setprio 1
    ds_read_b64_tr_b16 v[80:81], v10 offset:64
    v_mfma_f32_16x16x32_bf16 v[128:131], v[88:91], v[56:59], v[128:131]
    s_setprio 0
    buffer_load_dwordx4 v4, s[8:11], s64 offen offset:0 sc1 lds
    ds_read_b64_tr_b16 v[82:83], v10 offset:3648
    s_waitcnt lgkmcnt(10)
    v_mfma_f32_16x16x32_bf16 v[132:135], v[88:91], v[60:63], 0
    s_setprio 1
    s_add_u32 m0, s28, 32768
    v_mfma_f32_16x16x32_bf16 v[132:135], v[84:87], v[44:47], v[132:135]
    s_setprio 0
    v_mfma_f32_16x16x32_bf16 v[16:19], v[28:31], v[84:87], 0
    v_mfma_f32_16x16x32_bf16 v[16:19], v[28:31], v[88:91], v[16:19]
    buffer_load_dwordx4 v5, s[8:11], s64 offen offset:1024 sc1 lds
    s_waitcnt lgkmcnt(8)
    v_mfma_f32_16x16x32_bf16 v[136:139], v[84:87], v[48:51], 0
    s_setprio 1
    v_mfma_f32_16x16x32_bf16 v[136:139], v[88:91], v[64:67], v[136:139]
    s_setprio 0
    s_add_u32 m0, s28, 32768
    s_waitcnt lgkmcnt(6)
    v_mfma_f32_16x16x32_bf16 v[140:143], v[88:91], v[68:71], 0
    s_setprio 1
    v_mfma_f32_16x16x32_bf16 v[140:143], v[84:87], v[52:55], v[140:143]
    s_setprio 0
    buffer_load_dwordx4 v4, s[8:11], s66 offen offset:2048 sc1 lds
    ds_read_b64_tr_b16 v[84:85], v10 offset:7360
    s_waitcnt lgkmcnt(3)
    v_mfma_f32_16x16x32_bf16 v[172:175], v[72:75], v[52:55], 0
    s_setprio 1
    ds_read_b64_tr_b16 v[86:87], v10 offset:10944
    s_add_u32 m0, s28, 32768
    v_mfma_f32_16x16x32_bf16 v[172:175], v[76:79], v[68:71], v[172:175]
    s_setprio 0
    ds_read_b64_tr_b16 v[88:89], v10 offset:96
    buffer_load_dwordx4 v5, s[8:11], s66 offen offset:3072 sc1 lds
    v_mfma_f32_16x16x32_bf16 v[168:171], v[76:79], v[64:67], 0
    s_setprio 1
    ds_read_b64_tr_b16 v[90:91], v10 offset:3680
    s_add_u32 s64, s64, 128
    s_bitset0_b32 s64, 11
    v_mfma_f32_16x16x32_bf16 v[168:171], v[72:75], v[48:51], v[168:171]
    s_setprio 0
    s_add_u32 s66, s64, 30720
    s_add_u32 m0, s29, 29184
    v_mfma_f32_16x16x32_bf16 v[164:167], v[72:75], v[44:47], 0
    s_setprio 1
    v_mfma_f32_16x16x32_bf16 v[164:167], v[76:79], v[60:63], v[164:167]
    s_setprio 0
    buffer_load_dwordx4 v6, s[12:15], s65 offen lds
    s_add_u32 s65, s65, 229376
    v_mfma_f32_16x16x32_bf16 v[160:163], v[76:79], v[56:59], 0
    s_setprio 1
    s_add_u32 m0, s29, 36480
    v_mfma_f32_16x16x32_bf16 v[160:163], v[72:75], v[40:43], v[160:163]
    s_setprio 0
    ds_read_b64_tr_b16 v[72:73], v10 offset:7392
    buffer_load_dwordx4 v6, s[12:15], s65 offen lds
    s_waitcnt lgkmcnt(3)
    v_mfma_f32_16x16x32_bf16 v[192:195], v[80:83], v[40:43], 0
    s_setprio 1
    ds_read_b64_tr_b16 v[74:75], v10 offset:10976
    s_sub_u32 s65, s65, 229376
    v_mfma_f32_16x16x32_bf16 v[192:195], v[84:87], v[56:59], v[192:195]
    s_setprio 0
    s_waitcnt vmcnt(8) lgkmcnt(0)
    s_barrier
    s_add_u32 m0, s29, 43776
    v_mfma_f32_16x16x32_bf16 v[196:199], v[84:87], v[60:63], 0
    s_setprio 1
    ds_read_b64_tr_b16 v[76:77], v10 offset:14592
    v_mfma_f32_16x16x32_bf16 v[196:199], v[80:83], v[44:47], v[196:199]
    s_setprio 0
    buffer_load_dwordx4 v6, s[16:19], s65 offen lds
    s_add_u32 s65, s65, 229376
    ds_read_b64_tr_b16 v[78:79], v10 offset:18176
    v_mfma_f32_16x16x32_bf16 v[200:203], v[80:83], v[48:51], 0
    s_setprio 1
    s_add_u32 m0, s29, 51072
    v_mfma_f32_16x16x32_bf16 v[200:203], v[84:87], v[64:67], v[200:203]
    s_setprio 0
    buffer_load_dwordx4 v6, s[16:19], s65 offen lds
    v_mfma_f32_16x16x32_bf16 v[204:207], v[84:87], v[68:71], 0
    s_setprio 1
    s_add_u32 s65, s65, 229376
    v_mfma_f32_16x16x32_bf16 v[204:207], v[80:83], v[52:55], v[204:207]
    s_setprio 0
    ds_read_b64_tr_b16 v[80:81], v10 offset:21888
    s_add_u32 m0, s29, 0
    v_mfma_f32_16x16x32_bf16 v[236:239], v[88:91], v[52:55], 0
    s_setprio 1
    ds_read_b64_tr_b16 v[82:83], v10 offset:25472
    v_mfma_f32_16x16x32_bf16 v[236:239], v[72:75], v[68:71], v[236:239]
    s_setprio 0
    buffer_load_dwordx4 v6, s[12:15], s65 offen lds
    s_add_u32 s65, s65, 229376
    ds_read_b64_tr_b16 v[84:85], v10 offset:14624
    v_mfma_f32_16x16x32_bf16 v[232:235], v[72:75], v[64:67], 0
    s_setprio 1
    ds_read_b64_tr_b16 v[86:87], v10 offset:18208
    s_add_u32 m0, s29, 7296
    v_mfma_f32_16x16x32_bf16 v[232:235], v[88:91], v[48:51], v[232:235]
    s_setprio 0
    buffer_load_dwordx4 v6, s[12:15], s65 offen lds
    v_mfma_f32_16x16x32_bf16 v[228:231], v[88:91], v[44:47], 0
    s_setprio 1
    s_sub_u32 s65, s65, 229376
    v_mfma_f32_16x16x32_bf16 v[228:231], v[72:75], v[60:63], v[228:231]
    s_setprio 0
    s_add_u32 m0, s28, 123904
    v_mfma_f32_16x16x32_bf16 v[224:227], v[72:75], v[56:59], 0
    s_setprio 1
    v_mfma_f32_16x16x32_bf16 v[224:227], v[88:91], v[40:43], v[224:227]
    s_setprio 0
    buffer_load_dwordx4 v4, s[8:11], s64 offen offset:0 sc1 lds
    ds_read_b64_tr_b16 v[88:89], v10 offset:21920
    s_waitcnt lgkmcnt(3)
    v_mfma_f32_16x16x32_bf16 v[144:147], v[76:79], v[40:43], 0
    s_setprio 1
    ds_read_b64_tr_b16 v[90:91], v10 offset:25504
    s_add_u32 m0, s28, 123904
    v_mfma_f32_16x16x32_bf16 v[144:147], v[80:83], v[56:59], v[144:147]
    s_setprio 0
    ds_read_b64_tr_b16 v[72:73], v10 offset:14656
    buffer_load_dwordx4 v5, s[8:11], s64 offen offset:1024 sc1 lds
    v_mfma_f32_16x16x32_bf16 v[148:151], v[80:83], v[60:63], 0
    s_setprio 1
    ds_read_b64_tr_b16 v[74:75], v10 offset:18240
    v_mfma_f32_16x16x32_bf16 v[148:151], v[76:79], v[44:47], v[148:151]
    s_setprio 0
    v_mfma_f32_16x16x32_bf16 v[20:23], v[28:31], v[76:79], 0
    v_mfma_f32_16x16x32_bf16 v[20:23], v[28:31], v[80:83], v[20:23]
    s_add_u32 m0, s28, 123904
    v_mfma_f32_16x16x32_bf16 v[152:155], v[76:79], v[48:51], 0
    s_setprio 1
    v_mfma_f32_16x16x32_bf16 v[152:155], v[80:83], v[64:67], v[152:155]
    s_setprio 0
    buffer_load_dwordx4 v4, s[8:11], s66 offen offset:2048 sc1 lds
    v_mfma_f32_16x16x32_bf16 v[156:159], v[80:83], v[68:71], 0
    s_setprio 1
    s_add_u32 m0, s28, 123904
    v_mfma_f32_16x16x32_bf16 v[156:159], v[76:79], v[52:55], v[156:159]
    s_setprio 0
    ds_read_b64_tr_b16 v[76:77], v10 offset:21952
    buffer_load_dwordx4 v5, s[8:11], s66 offen offset:3072 sc1 lds
    s_waitcnt lgkmcnt(3)
    v_mfma_f32_16x16x32_bf16 v[188:191], v[84:87], v[52:55], 0
    s_setprio 1
    ds_read_b64_tr_b16 v[78:79], v10 offset:25536
    s_add_u32 s64, s64, 128
    s_bitset0_b32 s64, 11
    v_mfma_f32_16x16x32_bf16 v[188:191], v[88:91], v[68:71], v[188:191]
    s_setprio 0
    s_add_u32 s66, s64, 30720
    s_waitcnt vmcnt(14)
    s_lshr_b32 s3, s3, 8
    s_add_u32 s3, s3, 3211264
    s_mov_b64 exec, 1
    buffer_store_dwordx2 v[14:15], off, s[24:27], s3 sc1
    s_mov_b64 exec, -1
    ds_read_b64_tr_b16 v[80:81], v10 offset:14688
    v_mfma_f32_16x16x32_bf16 v[184:187], v[88:91], v[64:67], 0
    s_setprio 1
    ds_read_b64_tr_b16 v[82:83], v10 offset:18272
    v_mfma_f32_16x16x32_bf16 v[184:187], v[84:87], v[48:51], v[184:187]
    s_setprio 0
    v_mfma_f32_16x16x32_bf16 v[180:183], v[84:87], v[44:47], 0
    s_setprio 1
    v_mfma_f32_16x16x32_bf16 v[180:183], v[88:91], v[60:63], v[180:183]
    s_setprio 0
    v_mfma_f32_16x16x32_bf16 v[176:179], v[88:91], v[56:59], 0
    s_setprio 1
    v_mfma_f32_16x16x32_bf16 v[176:179], v[84:87], v[40:43], v[176:179]
    s_setprio 0
    ds_read_b64_tr_b16 v[84:85], v10 offset:21984
    s_waitcnt lgkmcnt(3)
    v_mfma_f32_16x16x32_bf16 v[208:211], v[72:75], v[40:43], 0
    s_setprio 1
    ds_read_b64_tr_b16 v[86:87], v10 offset:25568
    v_mfma_f32_16x16x32_bf16 v[208:211], v[76:79], v[56:59], v[208:211]
    s_setprio 0
    s_waitcnt vmcnt(9) lgkmcnt(0)
    s_barrier
    s_add_u32 m0, s29, 14592
    v_mfma_f32_16x16x32_bf16 v[212:215], v[76:79], v[60:63], 0
    s_setprio 1
    ds_read_b64_tr_b16 v[88:89], v10 offset:29184
    v_mfma_f32_16x16x32_bf16 v[212:215], v[72:75], v[44:47], v[212:215]
    s_setprio 0
    buffer_load_dwordx4 v6, s[16:19], s65 offen lds
    s_add_u32 s65, s65, 229376
    ds_read_b64_tr_b16 v[90:91], v10 offset:32768
    v_mfma_f32_16x16x32_bf16 v[216:219], v[72:75], v[48:51], 0
    s_setprio 1
    s_add_u32 m0, s29, 21888
    v_mfma_f32_16x16x32_bf16 v[216:219], v[76:79], v[64:67], v[216:219]
    s_setprio 0
    buffer_load_dwordx4 v6, s[16:19], s65 offen lds
    v_mfma_f32_16x16x32_bf16 v[220:223], v[76:79], v[68:71], 0
    s_setprio 1
    s_add_u32 s65, s65, 229376
    v_mfma_f32_16x16x32_bf16 v[220:223], v[72:75], v[52:55], v[220:223]
    s_setprio 0
    ds_read_b64_tr_b16 v[72:73], v10 offset:36480
    s_add_u32 m0, s28, 0
    v_mfma_f32_16x16x32_bf16 v[252:255], v[80:83], v[52:55], 0
    s_setprio 1
    ds_read_b128 v[52:55], v8 offset:38912
    ds_read_b64_tr_b16 v[74:75], v10 offset:40064
    v_mfma_f32_16x16x32_bf16 v[252:255], v[84:87], v[68:71], v[252:255]
    s_setprio 0
    buffer_load_dwordx4 v4, s[8:11], s64 offen offset:0 sc1 lds
    ds_read_b128 v[68:71], v9 offset:38912
    ds_read_b64_tr_b16 v[76:77], v10 offset:29216
    v_mfma_f32_16x16x32_bf16 v[248:251], v[84:87], v[64:67], 0
    s_setprio 1
    ds_read_b128 v[64:67], v9 offset:36864
    ds_read_b64_tr_b16 v[78:79], v10 offset:32800
    s_add_u32 m0, s28, 0
    v_mfma_f32_16x16x32_bf16 v[248:251], v[80:83], v[48:51], v[248:251]
    s_setprio 0
    ds_read_b128 v[48:51], v8 offset:36864
    buffer_load_dwordx4 v5, s[8:11], s64 offen offset:1024 sc1 lds
    v_mfma_f32_16x16x32_bf16 v[244:247], v[80:83], v[44:47], 0
    s_setprio 1
    ds_read_b128 v[44:47], v8 offset:34816
    v_mfma_f32_16x16x32_bf16 v[244:247], v[84:87], v[60:63], v[244:247]
    s_setprio 0
    ds_read_b128 v[60:63], v9 offset:34816
    s_add_u32 m0, s28, 0
    v_mfma_f32_16x16x32_bf16 v[240:243], v[84:87], v[56:59], 0
    s_setprio 1
    ds_read_b128 v[56:59], v9 offset:32768
    v_mfma_f32_16x16x32_bf16 v[240:243], v[80:83], v[40:43], v[240:243]
    s_setprio 0
    buffer_load_dwordx4 v4, s[8:11], s66 offen offset:2048 sc1 lds
    ds_read_b128 v[40:43], v8 offset:32768
    ds_read_b64_tr_b16 v[80:81], v10 offset:36512
    s_waitcnt lgkmcnt(9)
    v_mfma_f32_16x16x32_bf16 v[140:143], v[88:91], v[52:55], v[140:143]
    s_setprio 1
    ds_read_b64_tr_b16 v[82:83], v10 offset:40096
    s_add_u32 m0, s28, 0
    v_mfma_f32_16x16x32_bf16 v[140:143], v[72:75], v[68:71], v[140:143]
    s_setprio 0
    ds_read_b64_tr_b16 v[84:85], v10 offset:29248
    buffer_load_dwordx4 v5, s[8:11], s66 offen offset:3072 sc1 lds
    s_waitcnt lgkmcnt(7)
    v_mfma_f32_16x16x32_bf16 v[136:139], v[72:75], v[64:67], v[136:139]
    s_setprio 1
    ds_read_b64_tr_b16 v[86:87], v10 offset:32832
    s_add_u32 s64, s64, 128
    s_bitset0_b32 s64, 11
    v_mfma_f32_16x16x32_bf16 v[136:139], v[88:91], v[48:51], v[136:139]
    s_setprio 0
    v_mfma_f32_16x16x32_bf16 v[16:19], v[28:31], v[88:91], v[16:19]
    v_mfma_f32_16x16x32_bf16 v[16:19], v[28:31], v[72:75], v[16:19]
    s_add_u32 s66, s64, 30720
    s_waitcnt lgkmcnt(6)
    v_mfma_f32_16x16x32_bf16 v[132:135], v[88:91], v[44:47], v[132:135]
    s_setprio 1
    v_mfma_f32_16x16x32_bf16 v[132:135], v[72:75], v[60:63], v[132:135]
    s_setprio 0
    s_waitcnt lgkmcnt(4)
    v_mfma_f32_16x16x32_bf16 v[128:131], v[72:75], v[56:59], v[128:131]
    s_setprio 1
    v_mfma_f32_16x16x32_bf16 v[128:131], v[88:91], v[40:43], v[128:131]
    s_setprio 0
    ds_read_b64_tr_b16 v[88:89], v10 offset:36544
    s_waitcnt lgkmcnt(3)
    v_mfma_f32_16x16x32_bf16 v[160:163], v[76:79], v[40:43], v[160:163]
    s_setprio 1
    ds_read_b64_tr_b16 v[90:91], v10 offset:40128
    v_mfma_f32_16x16x32_bf16 v[160:163], v[80:83], v[56:59], v[160:163]
    s_setprio 0
    ds_read_b64_tr_b16 v[72:73], v10 offset:29280
    v_mfma_f32_16x16x32_bf16 v[164:167], v[80:83], v[60:63], v[164:167]
    s_setprio 1
    ds_read_b64_tr_b16 v[74:75], v10 offset:32864
    v_mfma_f32_16x16x32_bf16 v[164:167], v[76:79], v[44:47], v[164:167]
    s_setprio 0
    v_mfma_f32_16x16x32_bf16 v[168:171], v[76:79], v[48:51], v[168:171]
    s_setprio 1
    v_mfma_f32_16x16x32_bf16 v[168:171], v[80:83], v[64:67], v[168:171]
    s_setprio 0
    v_mfma_f32_16x16x32_bf16 v[172:175], v[80:83], v[68:71], v[172:175]
    s_setprio 1
    v_mfma_f32_16x16x32_bf16 v[172:175], v[76:79], v[52:55], v[172:175]
    s_setprio 0
    ds_read_b64_tr_b16 v[76:77], v10 offset:36576
    s_waitcnt lgkmcnt(3)
    v_mfma_f32_16x16x32_bf16 v[204:207], v[84:87], v[52:55], v[204:207]
    s_setprio 1
    ds_read_b64_tr_b16 v[78:79], v10 offset:40160
    v_mfma_f32_16x16x32_bf16 v[204:207], v[88:91], v[68:71], v[204:207]
    s_setprio 0
    s_waitcnt vmcnt(13) lgkmcnt(0)
    s_barrier
    v_mfma_f32_16x16x32_bf16 v[200:203], v[88:91], v[64:67], v[200:203]
    s_setprio 1
    ds_read_b64_tr_b16 v[80:81], v10 offset:43776
    s_add_u32 m0, s29, 29184
    v_mfma_f32_16x16x32_bf16 v[200:203], v[84:87], v[48:51], v[200:203]
    s_setprio 0
    ds_read_b64_tr_b16 v[82:83], v10 offset:47360
    buffer_load_dwordx4 v6, s[12:15], s65 offen lds
    v_mfma_f32_16x16x32_bf16 v[196:199], v[84:87], v[44:47], v[196:199]
    s_setprio 1
    s_add_u32 s65, s65, 229376
    v_mfma_f32_16x16x32_bf16 v[196:199], v[88:91], v[60:63], v[196:199]
    s_setprio 0
    v_mfma_f32_16x16x32_bf16 v[192:195], v[88:91], v[56:59], v[192:195]
    s_setprio 1
    s_add_u32 m0, s29, 36480
    v_mfma_f32_16x16x32_bf16 v[192:195], v[84:87], v[40:43], v[192:195]
    s_setprio 0
    ds_read_b64_tr_b16 v[84:85], v10 offset:51072
    buffer_load_dwordx4 v6, s[12:15], s65 offen lds
    v_mfma_f32_16x16x32_bf16 v[224:227], v[72:75], v[40:43], v[224:227]
    s_setprio 1
    ds_read_b64_tr_b16 v[86:87], v10 offset:54656
    s_sub_u32 s65, s65, 229376
    v_mfma_f32_16x16x32_bf16 v[224:227], v[76:79], v[56:59], v[224:227]
    s_setprio 0
    ds_read_b64_tr_b16 v[88:89], v10 offset:43808
    v_mfma_f32_16x16x32_bf16 v[228:231], v[76:79], v[60:63], v[228:231]
    s_setprio 1
    ds_read_b64_tr_b16 v[90:91], v10 offset:47392
    v_mfma_f32_16x16x32_bf16 v[228:231], v[72:75], v[44:47], v[228:231]
    s_setprio 0
    v_mfma_f32_16x16x32_bf16 v[232:235], v[72:75], v[48:51], v[232:235]
    s_setprio 1
    v_mfma_f32_16x16x32_bf16 v[232:235], v[76:79], v[64:67], v[232:235]
    s_setprio 0
    v_mfma_f32_16x16x32_bf16 v[236:239], v[76:79], v[68:71], v[236:239]
    s_setprio 1
    v_mfma_f32_16x16x32_bf16 v[236:239], v[72:75], v[52:55], v[236:239]
    s_setprio 0
    ds_read_b64_tr_b16 v[72:73], v10 offset:51104
    s_waitcnt lgkmcnt(3)
    v_mfma_f32_16x16x32_bf16 v[156:159], v[80:83], v[52:55], v[156:159]
    s_setprio 1
    ds_read_b64_tr_b16 v[74:75], v10 offset:54688
    v_mfma_f32_16x16x32_bf16 v[156:159], v[84:87], v[68:71], v[156:159]
    s_setprio 0
    ds_read_b64_tr_b16 v[76:77], v10 offset:43840
    v_mfma_f32_16x16x32_bf16 v[152:155], v[84:87], v[64:67], v[152:155]
    s_setprio 1
    ds_read_b64_tr_b16 v[78:79], v10 offset:47424
    v_mfma_f32_16x16x32_bf16 v[152:155], v[80:83], v[48:51], v[152:155]
    s_setprio 0
    v_mfma_f32_16x16x32_bf16 v[20:23], v[28:31], v[80:83], v[20:23]
    v_mfma_f32_16x16x32_bf16 v[20:23], v[28:31], v[84:87], v[20:23]
    v_mfma_f32_16x16x32_bf16 v[148:151], v[80:83], v[44:47], v[148:151]
    s_setprio 1
    v_mfma_f32_16x16x32_bf16 v[148:151], v[84:87], v[60:63], v[148:151]
    s_setprio 0
    v_mfma_f32_16x16x32_bf16 v[144:147], v[84:87], v[56:59], v[144:147]
    s_setprio 1
    v_mfma_f32_16x16x32_bf16 v[144:147], v[80:83], v[40:43], v[144:147]
    s_setprio 0
    ds_read_b64_tr_b16 v[80:81], v10 offset:51136
    s_waitcnt lgkmcnt(3)
    v_mfma_f32_16x16x32_bf16 v[176:179], v[88:91], v[40:43], v[176:179]
    s_setprio 1
    ds_read_b64_tr_b16 v[82:83], v10 offset:54720
    v_mfma_f32_16x16x32_bf16 v[176:179], v[72:75], v[56:59], v[176:179]
    s_setprio 0
    ds_read_b64_tr_b16 v[84:85], v10 offset:43872
    v_mfma_f32_16x16x32_bf16 v[180:183], v[72:75], v[60:63], v[180:183]
    s_setprio 1
    ds_read_b64_tr_b16 v[86:87], v10 offset:47456
    v_mfma_f32_16x16x32_bf16 v[180:183], v[88:91], v[44:47], v[180:183]
    s_setprio 0
    v_mfma_f32_16x16x32_bf16 v[184:187], v[88:91], v[48:51], v[184:187]
    s_setprio 1
    v_mfma_f32_16x16x32_bf16 v[184:187], v[72:75], v[64:67], v[184:187]
    s_setprio 0
    v_mfma_f32_16x16x32_bf16 v[188:191], v[72:75], v[68:71], v[188:191]
    s_setprio 1
    v_mfma_f32_16x16x32_bf16 v[188:191], v[88:91], v[52:55], v[188:191]
    s_setprio 0
    ds_read_b64_tr_b16 v[88:89], v10 offset:51168
    s_waitcnt lgkmcnt(3)
    v_mfma_f32_16x16x32_bf16 v[220:223], v[76:79], v[52:55], v[220:223]
    s_setprio 1
    ds_read_b64_tr_b16 v[90:91], v10 offset:54752
    v_mfma_f32_16x16x32_bf16 v[220:223], v[80:83], v[68:71], v[220:223]
    s_setprio 0
    s_waitcnt vmcnt(9) lgkmcnt(0)
    s_barrier
    v_mfma_f32_16x16x32_bf16 v[216:219], v[80:83], v[64:67], v[216:219]
    s_setprio 1
    ds_read_b64_tr_b16 v[72:73], v10 offset:0
    s_add_u32 m0, s29, 43776
    v_mfma_f32_16x16x32_bf16 v[216:219], v[76:79], v[48:51], v[216:219]
    s_setprio 0
    ds_read_b64_tr_b16 v[74:75], v10 offset:3584
    buffer_load_dwordx4 v6, s[16:19], s65 offen lds
    v_mfma_f32_16x16x32_bf16 v[212:215], v[76:79], v[44:47], v[212:215]
    s_setprio 1
    s_add_u32 s65, s65, 229376
    v_mfma_f32_16x16x32_bf16 v[212:215], v[80:83], v[60:63], v[212:215]
    s_setprio 0
    v_mfma_f32_16x16x32_bf16 v[208:211], v[80:83], v[56:59], v[208:211]
    s_setprio 1
    s_add_u32 m0, s29, 51072
    v_mfma_f32_16x16x32_bf16 v[208:211], v[76:79], v[40:43], v[208:211]
    s_setprio 0
    ds_read_b64_tr_b16 v[76:77], v10 offset:7296
    buffer_load_dwordx4 v6, s[16:19], s65 offen lds
    v_mfma_f32_16x16x32_bf16 v[240:243], v[84:87], v[40:43], v[240:243]
    s_setprio 1
    ds_read_b128 v[40:43], v94 offset:0
    ds_read_b64_tr_b16 v[78:79], v10 offset:10880
    s_add_u32 s65, s65, 229376
    v_mfma_f32_16x16x32_bf16 v[240:243], v[88:91], v[56:59], v[240:243]
    s_setprio 0
    ds_read_b128 v[56:59], v95 offset:0
    ds_read_b64_tr_b16 v[80:81], v10 offset:32
    v_mfma_f32_16x16x32_bf16 v[244:247], v[88:91], v[60:63], v[244:247]
    s_setprio 1
    ds_read_b128 v[60:63], v95 offset:2048
    ds_read_b64_tr_b16 v[82:83], v10 offset:3616
    v_mfma_f32_16x16x32_bf16 v[244:247], v[84:87], v[44:47], v[244:247]
    s_setprio 0
    ds_read_b128 v[44:47], v94 offset:2048
    v_mfma_f32_16x16x32_bf16 v[248:251], v[84:87], v[48:51], v[248:251]
    s_setprio 1
    ds_read_b128 v[48:51], v94 offset:4096
    v_mfma_f32_16x16x32_bf16 v[248:251], v[88:91], v[64:67], v[248:251]
    s_setprio 0
    ds_read_b128 v[64:67], v95 offset:4096
    v_mfma_f32_16x16x32_bf16 v[252:255], v[88:91], v[68:71], v[252:255]
    s_setprio 1
    ds_read_b128 v[68:71], v95 offset:6144
    v_mfma_f32_16x16x32_bf16 v[252:255], v[84:87], v[52:55], v[252:255]
    s_setprio 0
    ds_read_b128 v[52:55], v94 offset:6144
    ds_read_b64_tr_b16 v[84:85], v10 offset:7328
    s_waitcnt lgkmcnt(9)
    v_mfma_f32_16x16x32_bf16 v[128:131], v[72:75], v[40:43], v[128:131]
    s_setprio 1
    ds_read_b64_tr_b16 v[86:87], v10 offset:10912
    v_mfma_f32_16x16x32_bf16 v[128:131], v[76:79], v[56:59], v[128:131]
    s_setprio 0
    ds_read_b64_tr_b16 v[88:89], v10 offset:64
    s_waitcnt lgkmcnt(7)
    v_mfma_f32_16x16x32_bf16 v[132:135], v[76:79], v[60:63], v[132:135]
    s_setprio 1
    ds_read_b64_tr_b16 v[90:91], v10 offset:3648
    v_mfma_f32_16x16x32_bf16 v[132:135], v[72:75], v[44:47], v[132:135]
    s_setprio 0
    v_mfma_f32_16x16x32_bf16 v[16:19], v[28:31], v[72:75], v[16:19]
    v_mfma_f32_16x16x32_bf16 v[16:19], v[28:31], v[76:79], v[16:19]
    s_waitcnt lgkmcnt(6)
    v_mfma_f32_16x16x32_bf16 v[136:139], v[72:75], v[48:51], v[136:139]
    s_setprio 1
    v_mfma_f32_16x16x32_bf16 v[136:139], v[76:79], v[64:67], v[136:139]
    s_setprio 0
    s_waitcnt lgkmcnt(4)
    v_mfma_f32_16x16x32_bf16 v[140:143], v[76:79], v[68:71], v[140:143]
    s_setprio 1
    v_mfma_f32_16x16x32_bf16 v[140:143], v[72:75], v[52:55], v[140:143]
    s_setprio 0
    ds_read_b64_tr_b16 v[72:73], v10 offset:7360
    s_waitcnt lgkmcnt(3)
    v_mfma_f32_16x16x32_bf16 v[172:175], v[80:83], v[52:55], v[172:175]
    s_setprio 1
    ds_read_b64_tr_b16 v[74:75], v10 offset:10944
    v_mfma_f32_16x16x32_bf16 v[172:175], v[84:87], v[68:71], v[172:175]
    s_setprio 0
    ds_read_b64_tr_b16 v[76:77], v10 offset:96
    v_mfma_f32_16x16x32_bf16 v[168:171], v[84:87], v[64:67], v[168:171]
    s_setprio 1
    ds_read_b64_tr_b16 v[78:79], v10 offset:3680
    v_mfma_f32_16x16x32_bf16 v[168:171], v[80:83], v[48:51], v[168:171]
    s_setprio 0
    v_mfma_f32_16x16x32_bf16 v[164:167], v[80:83], v[44:47], v[164:167]
    s_setprio 1
    v_mfma_f32_16x16x32_bf16 v[164:167], v[84:87], v[60:63], v[164:167]
    s_setprio 0
    v_mfma_f32_16x16x32_bf16 v[160:163], v[84:87], v[56:59], v[160:163]
    s_setprio 1
    v_mfma_f32_16x16x32_bf16 v[160:163], v[80:83], v[40:43], v[160:163]
    s_setprio 0
    ds_read_b64_tr_b16 v[80:81], v10 offset:7392
    s_waitcnt lgkmcnt(3)
    v_mfma_f32_16x16x32_bf16 v[192:195], v[88:91], v[40:43], v[192:195]
    s_setprio 1
    ds_read_b64_tr_b16 v[82:83], v10 offset:10976
    v_mfma_f32_16x16x32_bf16 v[192:195], v[72:75], v[56:59], v[192:195]
    s_setprio 0
    s_waitcnt vmcnt(8) lgkmcnt(0)
    s_barrier
    v_mfma_f32_16x16x32_bf16 v[196:199], v[72:75], v[60:63], v[196:199]
    s_setprio 1
    ds_read_b64_tr_b16 v[84:85], v10 offset:14592
    s_add_u32 m0, s29, 0
    v_mfma_f32_16x16x32_bf16 v[196:199], v[88:91], v[44:47], v[196:199]
    s_setprio 0
    s_mov_b64 s[8:9], s[56:57]
    v_mov_b32 v124, 0
    ds_read_b64_tr_b16 v[86:87], v10 offset:18176
    buffer_load_dwordx4 v6, s[12:15], s65 offen lds
    v_mfma_f32_16x16x32_bf16 v[200:203], v[88:91], v[48:51], v[200:203]
    s_setprio 1
    s_add_u32 s65, s65, 229376
    v_mfma_f32_16x16x32_bf16 v[200:203], v[72:75], v[64:67], v[200:203]
    s_setprio 0
    v_mfma_f32_16x16x32_bf16 v[204:207], v[72:75], v[68:71], v[204:207]
    s_setprio 1
    s_add_u32 m0, s29, 7296
    v_mfma_f32_16x16x32_bf16 v[204:207], v[88:91], v[52:55], v[204:207]
    s_setprio 0
    v_mov_b32 v125, 0
    ds_read_b64_tr_b16 v[88:89], v10 offset:21888
    buffer_load_dwordx4 v6, s[12:15], s65 offen lds
    v_mfma_f32_16x16x32_bf16 v[236:239], v[76:79], v[52:55], v[236:239]
    s_setprio 1
    ds_read_b64_tr_b16 v[90:91], v10 offset:25472
    s_sub_u32 s65, s65, 229376
    v_mfma_f32_16x16x32_bf16 v[236:239], v[80:83], v[68:71], v[236:239]
    s_setprio 0
    ds_read_b64_tr_b16 v[72:73], v10 offset:14624
    v_mfma_f32_16x16x32_bf16 v[232:235], v[80:83], v[64:67], v[232:235]
    s_setprio 1
    ds_read_b64_tr_b16 v[74:75], v10 offset:18208
    v_mfma_f32_16x16x32_bf16 v[232:235], v[76:79], v[48:51], v[232:235]
    s_setprio 0
    v_mov_b32 v126, 0
    v_mfma_f32_16x16x32_bf16 v[228:231], v[76:79], v[44:47], v[228:231]
    s_setprio 1
    v_mfma_f32_16x16x32_bf16 v[228:231], v[80:83], v[60:63], v[228:231]
    s_setprio 0
    v_mfma_f32_16x16x32_bf16 v[224:227], v[80:83], v[56:59], v[224:227]
    s_setprio 1
    s_add_u32 m0, s28, 32768
    v_mfma_f32_16x16x32_bf16 v[224:227], v[76:79], v[40:43], v[224:227]
    s_setprio 0
    ds_read_b64_tr_b16 v[76:77], v10 offset:21920
    buffer_load_dwordx4 v4, s[8:11], s64 offen offset:0 sc1 lds
    s_waitcnt lgkmcnt(3)
    v_mfma_f32_16x16x32_bf16 v[144:147], v[84:87], v[40:43], v[144:147]
    s_setprio 1
    ds_read_b64_tr_b16 v[78:79], v10 offset:25504
    v_mfma_f32_16x16x32_bf16 v[144:147], v[88:91], v[56:59], v[144:147]
    s_setprio 0
    v_mov_b32 v127, 0
    ds_read_b64_tr_b16 v[80:81], v10 offset:14656
    v_mfma_f32_16x16x32_bf16 v[148:151], v[88:91], v[60:63], v[148:151]
    s_setprio 1
    ds_read_b64_tr_b16 v[82:83], v10 offset:18240
    s_add_u32 m0, s28, 32768
    v_mfma_f32_16x16x32_bf16 v[148:151], v[84:87], v[44:47], v[148:151]
    s_setprio 0
    v_mfma_f32_16x16x32_bf16 v[20:23], v[28:31], v[84:87], v[20:23]
    v_mfma_f32_16x16x32_bf16 v[20:23], v[28:31], v[88:91], v[20:23]
    buffer_load_dwordx4 v5, s[8:11], s64 offen offset:1024 sc1 lds
    v_mfma_f32_16x16x32_bf16 v[152:155], v[84:87], v[48:51], v[152:155]
    s_setprio 1
    v_mfma_f32_16x16x32_bf16 v[152:155], v[88:91], v[64:67], v[152:155]
    s_setprio 0
    v_mov_b32 v120, 0
    v_mfma_f32_16x16x32_bf16 v[156:159], v[88:91], v[68:71], v[156:159]
    s_setprio 1
    s_add_u32 m0, s28, 32768
    v_mfma_f32_16x16x32_bf16 v[156:159], v[84:87], v[52:55], v[156:159]
    s_setprio 0
    ds_read_b64_tr_b16 v[84:85], v10 offset:21952
    buffer_load_dwordx4 v4, s[8:11], s66 offen offset:2048 sc1 lds
    s_waitcnt lgkmcnt(3)
    v_mfma_f32_16x16x32_bf16 v[188:191], v[72:75], v[52:55], v[188:191]
    s_setprio 1
    ds_read_b64_tr_b16 v[86:87], v10 offset:25536
    v_mfma_f32_16x16x32_bf16 v[188:191], v[76:79], v[68:71], v[188:191]
    s_setprio 0
    ds_read_b64_tr_b16 v[88:89], v10 offset:14688
    v_mfma_f32_16x16x32_bf16 v[184:187], v[76:79], v[64:67], v[184:187]
    s_setprio 1
    ds_read_b64_tr_b16 v[90:91], v10 offset:18272
    s_add_u32 m0, s28, 32768
    v_mfma_f32_16x16x32_bf16 v[184:187], v[72:75], v[48:51], v[184:187]
    s_setprio 0
    v_mov_b32 v121, 0
    buffer_load_dwordx4 v5, s[8:11], s66 offen offset:3072 sc1 lds
    v_mfma_f32_16x16x32_bf16 v[180:183], v[72:75], v[44:47], v[180:183]
    s_setprio 1
    s_add_u32 s64, s64, 128
    s_bitset0_b32 s64, 11
    v_mfma_f32_16x16x32_bf16 v[180:183], v[76:79], v[60:63], v[180:183]
    s_setprio 0
    s_add_u32 s66, s64, 30720
    v_mfma_f32_16x16x32_bf16 v[176:179], v[76:79], v[56:59], v[176:179]
    s_setprio 1
    v_mfma_f32_16x16x32_bf16 v[176:179], v[72:75], v[40:43], v[176:179]
    s_setprio 0
    ds_read_b64_tr_b16 v[72:73], v10 offset:21984
    v_mov_b32 v122, 0
    s_waitcnt lgkmcnt(3)
    v_mfma_f32_16x16x32_bf16 v[208:211], v[80:83], v[40:43], v[208:211]
    s_setprio 1
    ds_read_b64_tr_b16 v[74:75], v10 offset:25568
    v_mfma_f32_16x16x32_bf16 v[208:211], v[84:87], v[56:59], v[208:211]
    s_setprio 0
    s_waitcnt vmcnt(8) lgkmcnt(0)
    s_barrier
    v_mfma_f32_16x16x32_bf16 v[212:215], v[84:87], v[60:63], v[212:215]
    s_setprio 1
    ds_read_b64_tr_b16 v[76:77], v10 offset:29184
    s_add_u32 m0, s29, 14592
    v_mfma_f32_16x16x32_bf16 v[212:215], v[80:83], v[44:47], v[212:215]
    s_setprio 0
    ds_read_b64_tr_b16 v[78:79], v10 offset:32768
    buffer_load_dwordx4 v6, s[16:19], s65 offen lds
    v_mfma_f32_16x16x32_bf16 v[216:219], v[80:83], v[48:51], v[216:219]
    s_setprio 1
    s_add_u32 s65, s65, 229376
    v_mfma_f32_16x16x32_bf16 v[216:219], v[84:87], v[64:67], v[216:219]
    s_setprio 0
    v_mov_b32 v123, 0
    v_mfma_f32_16x16x32_bf16 v[220:223], v[84:87], v[68:71], v[220:223]
    s_setprio 1
    s_add_u32 m0, s29, 21888
    v_mfma_f32_16x16x32_bf16 v[220:223], v[80:83], v[52:55], v[220:223]
    s_setprio 0
    ds_read_b64_tr_b16 v[80:81], v10 offset:36480
    buffer_load_dwordx4 v6, s[16:19], s65 offen lds
    v_mfma_f32_16x16x32_bf16 v[252:255], v[88:91], v[52:55], v[252:255]
    s_setprio 1
    ds_read_b128 v[52:55], v8 offset:6144
    ds_read_b64_tr_b16 v[82:83], v10 offset:40064
    s_add_u32 s65, s65, 229376
    v_mfma_f32_16x16x32_bf16 v[252:255], v[72:75], v[68:71], v[252:255]
    s_setprio 0
    ds_read_b128 v[68:71], v9 offset:6144
    ds_read_b64_tr_b16 v[84:85], v10 offset:29216
    v_mov_b32 v116, 0
    v_mfma_f32_16x16x32_bf16 v[248:251], v[72:75], v[64:67], v[248:251]
    s_setprio 1
    ds_read_b128 v[64:67], v9 offset:4096
    ds_read_b64_tr_b16 v[86:87], v10 offset:32800
    s_mov_b32 m0, 131072
    v_mfma_f32_16x16x32_bf16 v[248:251], v[88:91], v[48:51], v[248:251]
    s_setprio 0
    ds_read_b128 v[48:51], v8 offset:4096
    buffer_load_dwordx4 v35, s[76:79], s37 offen  lds
    v_mfma_f32_16x16x32_bf16 v[244:247], v[88:91], v[44:47], v[244:247]
    s_setprio 1
    ds_read_b128 v[44:47], v8 offset:2048
    s_add_u32 s37, s37, 196608
    v_mfma_f32_16x16x32_bf16 v[244:247], v[72:75], v[60:63], v[244:247]
    s_setprio 0
    ds_read_b128 v[60:63], v9 offset:2048
    v_mov_b32 v117, 0
    v_mfma_f32_16x16x32_bf16 v[240:243], v[72:75], v[56:59], v[240:243]
    s_setprio 1
    ds_read_b128 v[56:59], v9 offset:0
    v_mfma_f32_16x16x32_bf16 v[240:243], v[88:91], v[40:43], v[240:243]
    s_setprio 0
    ds_read_b128 v[40:43], v8 offset:0
    ds_read_b64_tr_b16 v[88:89], v10 offset:36512
    s_waitcnt lgkmcnt(9)
    v_mfma_f32_16x16x32_bf16 v[140:143], v[76:79], v[52:55], v[140:143]
    s_setprio 1
    ds_read_b64_tr_b16 v[90:91], v10 offset:40096
    v_mfma_f32_16x16x32_bf16 v[140:143], v[80:83], v[68:71], v[140:143]
    s_setprio 0
    ds_read_b64_tr_b16 v[72:73], v10 offset:29248
    s_waitcnt lgkmcnt(7)
    v_mfma_f32_16x16x32_bf16 v[136:139], v[80:83], v[64:67], v[136:139]
    s_setprio 1
    ds_read_b64_tr_b16 v[74:75], v10 offset:32832
    s_mov_b32 m0, 137216
    v_mfma_f32_16x16x32_bf16 v[136:139], v[76:79], v[48:51], v[136:139]
    s_setprio 0
    v_mfma_f32_16x16x32_bf16 v[16:19], v[28:31], v[76:79], v[16:19]
    v_mfma_f32_16x16x32_bf16 v[16:19], v[28:31], v[80:83], v[16:19]
    v_mov_b32 v118, 0
    buffer_load_dwordx4 v35, s[76:79], s37 offen  lds
    s_waitcnt lgkmcnt(6)
    v_mfma_f32_16x16x32_bf16 v[132:135], v[76:79], v[44:47], v[132:135]
    s_setprio 1
    s_add_u32 s37, s37, 196608
    v_mfma_f32_16x16x32_bf16 v[132:135], v[80:83], v[60:63], v[132:135]
    s_setprio 0
    s_waitcnt lgkmcnt(4)
    v_mfma_f32_16x16x32_bf16 v[128:131], v[80:83], v[56:59], v[128:131]
    s_setprio 1
    v_mfma_f32_16x16x32_bf16 v[128:131], v[76:79], v[40:43], v[128:131]
    s_setprio 0
    ds_read_b64_tr_b16 v[76:77], v10 offset:36544
    v_mov_b32 v119, 0
    s_waitcnt lgkmcnt(3)
    v_mfma_f32_16x16x32_bf16 v[160:163], v[84:87], v[40:43], v[160:163]
    s_setprio 1
    ds_read_b64_tr_b16 v[78:79], v10 offset:40128
    v_mfma_f32_16x16x32_bf16 v[160:163], v[88:91], v[56:59], v[160:163]
    s_setprio 0
    ds_read_b64_tr_b16 v[80:81], v10 offset:29280
    v_mfma_f32_16x16x32_bf16 v[164:167], v[88:91], v[60:63], v[164:167]
    s_setprio 1
    ds_read_b64_tr_b16 v[82:83], v10 offset:32864
    v_mfma_f32_16x16x32_bf16 v[164:167], v[84:87], v[44:47], v[164:167]
    s_setprio 0
    v_mfma_f32_16x16x32_bf16 v[168:171], v[84:87], v[48:51], v[168:171]
    s_setprio 1
    v_mfma_f32_16x16x32_bf16 v[168:171], v[88:91], v[64:67], v[168:171]
    s_setprio 0
    v_mov_b32 v112, 0
    v_mfma_f32_16x16x32_bf16 v[172:175], v[88:91], v[68:71], v[172:175]
    s_setprio 1
    v_mfma_f32_16x16x32_bf16 v[172:175], v[84:87], v[52:55], v[172:175]
    s_setprio 0
    ds_read_b64_tr_b16 v[84:85], v10 offset:36576
    s_waitcnt lgkmcnt(3)
    v_mfma_f32_16x16x32_bf16 v[204:207], v[72:75], v[52:55], v[204:207]
    s_setprio 1
    ds_read_b64_tr_b16 v[86:87], v10 offset:40160
    v_mfma_f32_16x16x32_bf16 v[204:207], v[76:79], v[68:71], v[204:207]
    s_setprio 0
    v_mov_b32 v113, 0
    s_waitcnt vmcnt(10) lgkmcnt(0)
    s_barrier
    v_mfma_f32_16x16x32_bf16 v[200:203], v[76:79], v[64:67], v[200:203]
    s_setprio 1
    ds_read_b64_tr_b16 v[88:89], v10 offset:43776
    s_add_u32 m0, s29, 29184
    v_mfma_f32_16x16x32_bf16 v[200:203], v[72:75], v[48:51], v[200:203]
    s_setprio 0
    ds_read_b64_tr_b16 v[90:91], v10 offset:47360
    buffer_load_dwordx4 v6, s[12:15], s65 offen lds
    ds_read_b64 v[36:37], v26 offset:0
    v_mfma_f32_16x16x32_bf16 v[196:199], v[72:75], v[44:47], v[196:199]
    s_setprio 1
    ds_read_b64 v[38:39], v26 offset:128
    s_add_u32 s65, s65, 229376
    v_mfma_f32_16x16x32_bf16 v[196:199], v[76:79], v[60:63], v[196:199]
    s_setprio 0
    ds_read_b64 v[12:13], v26 offset:256
    v_mfma_f32_16x16x32_bf16 v[192:195], v[76:79], v[56:59], v[192:195]
    s_setprio 1
    ds_read_b64 v[14:15], v26 offset:384
    s_add_u32 m0, s29, 36480
    v_mfma_f32_16x16x32_bf16 v[192:195], v[72:75], v[40:43], v[192:195]
    s_setprio 0
    v_mov_b32 v114, 0
    ds_read_b64_tr_b16 v[72:73], v10 offset:51072
    buffer_load_dwordx4 v6, s[12:15], s65 offen lds
    v_mfma_f32_16x16x32_bf16 v[224:227], v[80:83], v[40:43], v[224:227]
    s_setprio 1
    ds_read_b64_tr_b16 v[74:75], v10 offset:54656
    s_sub_u32 s65, s65, 229376
    v_mfma_f32_16x16x32_bf16 v[224:227], v[84:87], v[56:59], v[224:227]
    s_setprio 0
    ds_read_b64_tr_b16 v[76:77], v10 offset:43808
    v_mfma_f32_16x16x32_bf16 v[228:231], v[84:87], v[60:63], v[228:231]
    s_setprio 1
    ds_read_b64_tr_b16 v[78:79], v10 offset:47392
    v_mfma_f32_16x16x32_bf16 v[228:231], v[80:83], v[44:47], v[228:231]
    s_setprio 0
    v_mov_b32 v115, 0
    v_mfma_f32_16x16x32_bf16 v[232:235], v[80:83], v[48:51], v[232:235]
    s_setprio 1
    v_mfma_f32_16x16x32_bf16 v[232:235], v[84:87], v[64:67], v[232:235]
    s_setprio 0
    v_mfma_f32_16x16x32_bf16 v[236:239], v[84:87], v[68:71], v[236:239]
    s_setprio 1
    s_add_u32 m0, s28, 0
    v_mfma_f32_16x16x32_bf16 v[236:239], v[80:83], v[52:55], v[236:239]
    s_setprio 0
    ds_read_b64_tr_b16 v[80:81], v10 offset:51104
    buffer_load_dwordx4 v4, s[8:11], s64 offen offset:0 sc1 lds
    s_waitcnt lgkmcnt(3)
    v_mfma_f32_16x16x32_bf16 v[156:159], v[88:91], v[52:55], v[156:159]
    s_setprio 1
    ds_read_b64_tr_b16 v[82:83], v10 offset:54688
    v_mfma_f32_16x16x32_bf16 v[156:159], v[72:75], v[68:71], v[156:159]
    s_setprio 0
    ds_read_b64_tr_b16 v[84:85], v10 offset:43840
    v_mfma_f32_16x16x32_bf16 v[152:155], v[72:75], v[64:67], v[152:155]
    s_setprio 1
    ds_read_b64_tr_b16 v[86:87], v10 offset:47424
    s_add_u32 m0, s28, 0
    v_mfma_f32_16x16x32_bf16 v[152:155], v[88:91], v[48:51], v[152:155]
    s_setprio 0
    v_mfma_f32_16x16x32_bf16 v[20:23], v[28:31], v[88:91], v[20:23]
    v_mfma_f32_16x16x32_bf16 v[20:23], v[28:31], v[72:75], v[20:23]
    buffer_load_dwordx4 v5, s[8:11], s64 offen offset:1024 sc1 lds
    v_mul_f32 v140, v140, v15
    v_mul_f32 v141, v141, v15
    v_mul_f32 v142, v142, v15
    v_mfma_f32_16x16x32_bf16 v[148:151], v[88:91], v[44:47], v[148:151]
    s_setprio 1
    v_mfma_f32_16x16x32_bf16 v[148:151], v[72:75], v[60:63], v[148:151]
    s_setprio 0
    v_mul_f32 v143, v143, v15
    v_mul_f32 v136, v136, v13
    v_mul_f32 v137, v137, v13
    v_mul_f32 v138, v138, v13
    v_mfma_f32_16x16x32_bf16 v[144:147], v[72:75], v[56:59], v[144:147]
    s_setprio 1
    s_add_u32 m0, s28, 0
    v_mfma_f32_16x16x32_bf16 v[144:147], v[88:91], v[40:43], v[144:147]
    s_setprio 0
    v_mul_f32 v139, v139, v13
    v_mul_f32 v132, v132, v39
    v_mul_f32 v133, v133, v39
    ds_read_b64_tr_b16 v[88:89], v10 offset:51136
    buffer_load_dwordx4 v4, s[8:11], s66 offen offset:2048 sc1 lds
    v_mul_f32 v134, v134, v39
    v_mul_f32 v135, v135, v39
    s_waitcnt lgkmcnt(3)
    v_mfma_f32_16x16x32_bf16 v[176:179], v[76:79], v[40:43], v[176:179]
    s_setprio 1
    ds_read_b64_tr_b16 v[90:91], v10 offset:54720
    v_mfma_f32_16x16x32_bf16 v[176:179], v[80:83], v[56:59], v[176:179]
    s_setprio 0
    v_mul_f32 v128, v128, v37
    v_mul_f32 v129, v129, v37
    ds_read_b64_tr_b16 v[72:73], v10 offset:43872
    v_mul_f32 v130, v130, v37
    v_mul_f32 v131, v131, v37
    v_mfma_f32_16x16x32_bf16 v[180:183], v[80:83], v[60:63], v[180:183]
    s_setprio 1
    ds_read_b64_tr_b16 v[74:75], v10 offset:47456
    s_add_u32 m0, s28, 0
    v_mfma_f32_16x16x32_bf16 v[180:183], v[76:79], v[44:47], v[180:183]
    s_setprio 0
    v_mul_f32 v160, v160, v37
    v_mul_f32 v161, v161, v37
    v_mul_f32 v162, v162, v37
    buffer_load_dwordx4 v5, s[8:11], s66 offen offset:3072 sc1 lds
    v_mul_f32 v163, v163, v37
    v_mul_f32 v164, v164, v39
    v_mfma_f32_16x16x32_bf16 v[184:187], v[76:79], v[48:51], v[184:187]
    s_setprio 1
    s_add_u32 s64, s64, 128
    s_bitset0_b32 s64, 11
    v_mfma_f32_16x16x32_bf16 v[184:187], v[80:83], v[64:67], v[184:187]
    s_setprio 0
    s_add_u32 s66, s64, 30720
    v_mul_f32 v165, v165, v39
    v_mul_f32 v166, v166, v39
    v_mul_f32 v167, v167, v39
    v_mul_f32 v168, v168, v13
    v_mul_f32 v169, v169, v13
    v_mfma_f32_16x16x32_bf16 v[188:191], v[80:83], v[68:71], v[188:191]
    s_setprio 1
    v_mfma_f32_16x16x32_bf16 v[188:191], v[76:79], v[52:55], v[188:191]
    s_setprio 0
    v_mul_f32 v170, v170, v13
    v_mul_f32 v171, v171, v13
    ds_read_b64_tr_b16 v[76:77], v10 offset:51168
    v_mul_f32 v172, v172, v15
    v_mul_f32 v173, v173, v15
    s_waitcnt lgkmcnt(3)
    v_mfma_f32_16x16x32_bf16 v[220:223], v[84:87], v[52:55], v[220:223]
    s_setprio 1
    ds_read_b64_tr_b16 v[78:79], v10 offset:54752
    v_mfma_f32_16x16x32_bf16 v[220:223], v[88:91], v[68:71], v[220:223]
    s_setprio 0
    v_mul_f32 v174, v174, v15
    v_mul_f32 v175, v175, v15
    v_mul_f32 v204, v204, v15
    v_mul_f32 v205, v205, v15
    v_mul_f32 v206, v206, v15
    s_waitcnt vmcnt(10) lgkmcnt(0)
    s_barrier
    v_mfma_f32_16x16x32_bf16 v[216:219], v[88:91], v[64:67], v[216:219]
    s_setprio 1
    ds_read_b64_tr_b16 v[80:81], v10 offset:0
    s_add_u32 m0, s29, 43776
    v_mfma_f32_16x16x32_bf16 v[216:219], v[84:87], v[48:51], v[216:219]
    s_setprio 0
    v_mul_f32 v207, v207, v15
    v_mul_f32 v200, v200, v13
    ds_read_b64_tr_b16 v[82:83], v10 offset:3584
    buffer_load_dwordx4 v6, s[16:19], s65 offen lds
    v_mul_f32 v201, v201, v13
    v_mul_f32 v202, v202, v13
    v_mfma_f32_16x16x32_bf16 v[212:215], v[84:87], v[44:47], v[212:215]
    s_setprio 1
    s_add_u32 s65, s65, 229376
    v_mfma_f32_16x16x32_bf16 v[212:215], v[88:91], v[60:63], v[212:215]
    s_setprio 0
    v_mul_f32 v203, v203, v13
    v_mul_f32 v196, v196, v39
    v_mul_f32 v197, v197, v39
    v_mul_f32 v198, v198, v39
    v_mul_f32 v199, v199, v39
    v_mfma_f32_16x16x32_bf16 v[208:211], v[88:91], v[56:59], v[208:211]
    s_setprio 1
    s_add_u32 m0, s29, 51072
    v_mfma_f32_16x16x32_bf16 v[208:211], v[84:87], v[40:43], v[208:211]
    s_setprio 0
    v_mul_f32 v192, v192, v37
    v_mul_f32 v193, v193, v37
    ds_read_b64_tr_b16 v[84:85], v10 offset:7296
    buffer_load_dwordx4 v6, s[16:19], s65 offen lds
    v_mul_f32 v194, v194, v37
    v_mul_f32 v195, v195, v37
    v_mfma_f32_16x16x32_bf16 v[240:243], v[72:75], v[40:43], v[240:243]
    s_setprio 1
    ds_read_b128 v[40:43], v8 offset:32768
    ds_read_b64_tr_b16 v[86:87], v10 offset:10880
    s_add_u32 s65, s65, 229376
    v_mfma_f32_16x16x32_bf16 v[240:243], v[76:79], v[56:59], v[240:243]
    s_setprio 0
    v_mul_f32 v224, v224, v37
    v_mul_f32 v225, v225, v37
    v_mul_f32 v226, v226, v37
    ds_read_b128 v[56:59], v9 offset:32768
    ds_read_b64_tr_b16 v[88:89], v10 offset:32
    v_mul_f32 v227, v227, v37
    v_mul_f32 v228, v228, v39
    v_mfma_f32_16x16x32_bf16 v[244:247], v[76:79], v[60:63], v[244:247]
    s_setprio 1
    ds_read_b128 v[60:63], v9 offset:34816
    ds_read_b64_tr_b16 v[90:91], v10 offset:3616
    s_mov_b32 m0, 143360
    v_mfma_f32_16x16x32_bf16 v[244:247], v[72:75], v[44:47], v[244:247]
    s_setprio 0
    v_mul_f32 v229, v229, v39
    v_mul_f32 v230, v230, v39
    ds_read_b128 v[44:47], v8 offset:34816
    buffer_load_dwordx4 v35, s[76:79], s37 offen  lds
    v_mul_f32 v231, v231, v39
    v_mul_f32 v232, v232, v13
    v_mul_f32 v233, v233, v13
    v_mfma_f32_16x16x32_bf16 v[248:251], v[72:75], v[48:51], v[248:251]
    s_setprio 1
    ds_read_b128 v[48:51], v8 offset:36864
    s_add_u32 s37, s37, 196608
    v_mfma_f32_16x16x32_bf16 v[248:251], v[76:79], v[64:67], v[248:251]
    s_setprio 0
    v_mul_f32 v234, v234, v13
    v_mul_f32 v235, v235, v13
    ds_read_b128 v[64:67], v9 offset:36864
    v_mul_f32 v236, v236, v15
    v_mul_f32 v237, v237, v15
    v_mfma_f32_16x16x32_bf16 v[252:255], v[76:79], v[68:71], v[252:255]
    s_setprio 1
    ds_read_b128 v[68:71], v9 offset:38912
    v_mfma_f32_16x16x32_bf16 v[252:255], v[72:75], v[52:55], v[252:255]
    s_setprio 0
    v_mul_f32 v238, v238, v15
    v_mul_f32 v239, v239, v15
    ds_read_b128 v[52:55], v8 offset:38912
    ds_read_b64_tr_b16 v[72:73], v10 offset:7328
    s_waitcnt lgkmcnt(9)
    v_mfma_f32_16x16x32_bf16 v[128:131], v[80:83], v[40:43], v[128:131]
    s_setprio 1
    ds_read_b64_tr_b16 v[74:75], v10 offset:10912
    v_mfma_f32_16x16x32_bf16 v[128:131], v[84:87], v[56:59], v[128:131]
    s_setprio 0
    v_mul_f32 v156, v156, v15
    v_mul_f32 v157, v157, v15
    ds_read_b64_tr_b16 v[76:77], v10 offset:64
    v_mul_f32 v158, v158, v15
    v_mul_f32 v159, v159, v15
    s_waitcnt lgkmcnt(7)
    v_mfma_f32_16x16x32_bf16 v[132:135], v[84:87], v[60:63], v[132:135]
    s_setprio 1
    ds_read_b64_tr_b16 v[78:79], v10 offset:3648
    s_mov_b32 m0, 149504
    v_mfma_f32_16x16x32_bf16 v[132:135], v[80:83], v[44:47], v[132:135]
    s_setprio 0
    v_mul_f32 v152, v152, v13
    ds_write2_b32 v27, v16, v20 offset1:64
    buffer_load_dwordx4 v35, s[76:79], s37 offen  lds
    v_mul_f32 v153, v153, v13
    v_mul_f32 v154, v154, v13
    s_waitcnt lgkmcnt(7)
    v_mfma_f32_16x16x32_bf16 v[136:139], v[80:83], v[48:51], v[136:139]
    s_setprio 1
    s_add_u32 s37, s37, 196608
    v_mfma_f32_16x16x32_bf16 v[136:139], v[84:87], v[64:67], v[136:139]
    s_setprio 0
    v_mul_f32 v155, v155, v13
    v_mul_f32 v148, v148, v39
    v_mul_f32 v149, v149, v39
    s_waitcnt lgkmcnt(5)
    v_mfma_f32_16x16x32_bf16 v[140:143], v[84:87], v[68:71], v[140:143]
    s_setprio 1
    v_mfma_f32_16x16x32_bf16 v[140:143], v[80:83], v[52:55], v[140:143]
    s_setprio 0
    v_mul_f32 v150, v150, v39
    v_mul_f32 v151, v151, v39
    ds_read_b64_tr_b16 v[80:81], v10 offset:7360
    v_mul_f32 v144, v144, v37
    v_mul_f32 v145, v145, v37
    s_waitcnt lgkmcnt(4)
    v_mfma_f32_16x16x32_bf16 v[172:175], v[88:91], v[52:55], v[172:175]
    s_setprio 1
    ds_read_b64_tr_b16 v[82:83], v10 offset:10944
    v_mfma_f32_16x16x32_bf16 v[172:175], v[72:75], v[68:71], v[172:175]
    s_setprio 0
    v_mul_f32 v146, v146, v37
    ds_read_b64_tr_b16 v[84:85], v10 offset:96
    v_mul_f32 v147, v147, v37
    v_mul_f32 v176, v176, v37
    v_mfma_f32_16x16x32_bf16 v[168:171], v[72:75], v[64:67], v[168:171]
    s_setprio 1
    ds_read_b64_tr_b16 v[86:87], v10 offset:3680
    v_mfma_f32_16x16x32_bf16 v[168:171], v[88:91], v[48:51], v[168:171]
    s_setprio 0
    v_mul_f32 v177, v177, v37
    v_mul_f32 v178, v178, v37
    v_mul_f32 v179, v179, v37
    v_mfma_f32_16x16x32_bf16 v[164:167], v[88:91], v[44:47], v[164:167]
    s_setprio 1
    v_mfma_f32_16x16x32_bf16 v[164:167], v[72:75], v[60:63], v[164:167]
    s_setprio 0
    v_mul_f32 v180, v180, v39
    v_mul_f32 v181, v181, v39
    v_mul_f32 v182, v182, v39
    v_mfma_f32_16x16x32_bf16 v[160:163], v[72:75], v[56:59], v[160:163]
    s_setprio 1
    v_mfma_f32_16x16x32_bf16 v[160:163], v[88:91], v[40:43], v[160:163]
    s_setprio 0
    v_mul_f32 v183, v183, v39
    v_mul_f32 v184, v184, v13
    ds_read_b64_tr_b16 v[88:89], v10 offset:7392
    v_mul_f32 v185, v185, v13
    v_mul_f32 v186, v186, v13
    s_waitcnt lgkmcnt(3)
    v_mfma_f32_16x16x32_bf16 v[192:195], v[76:79], v[40:43], v[192:195]
    s_setprio 1
    ds_read_b64_tr_b16 v[90:91], v10 offset:10976
    v_mfma_f32_16x16x32_bf16 v[192:195], v[80:83], v[56:59], v[192:195]
    s_setprio 0
    v_mul_f32 v187, v187, v13
    v_mul_f32 v188, v188, v15
    v_mul_f32 v189, v189, v15
    s_waitcnt vmcnt(10) lgkmcnt(0)
    s_barrier
    v_mfma_f32_16x16x32_bf16 v[196:199], v[80:83], v[60:63], v[196:199]
    s_setprio 1
    ds_read_b64_tr_b16 v[28:29], v92 offset:32768
    s_add_u32 m0, s29, 0
    v_mfma_f32_16x16x32_bf16 v[196:199], v[76:79], v[44:47], v[196:199]
    s_setprio 0
    v_mul_f32 v190, v190, v15
    v_mul_f32 v191, v191, v15
    ds_read_b64_tr_b16 v[30:31], v92 offset:33792
    buffer_load_dwordx4 v6, s[12:15], s65 offen lds
    v_mul_f32 v220, v220, v15
    v_mfma_f32_16x16x32_bf16 v[200:203], v[76:79], v[48:51], v[200:203]
    s_setprio 1
    ds_read_b64_tr_b16 v[16:17], v92 offset:38912
    s_add_u32 s65, s65, 229376
    v_mfma_f32_16x16x32_bf16 v[200:203], v[80:83], v[64:67], v[200:203]
    s_setprio 0
    v_mul_f32 v221, v221, v15
    v_mul_f32 v222, v222, v15
    ds_read_b64_tr_b16 v[18:19], v92 offset:39936
    v_mul_f32 v223, v223, v15
    v_mul_f32 v216, v216, v13
    v_mfma_f32_16x16x32_bf16 v[204:207], v[80:83], v[68:71], v[204:207]
    s_setprio 1
    ds_read_b64_tr_b16 v[72:73], v32 offset:32768
    s_add_u32 m0, s29, 7296
    v_mfma_f32_16x16x32_bf16 v[204:207], v[76:79], v[52:55], v[204:207]
    s_setprio 0
    v_mul_f32 v217, v217, v13
    ds_read_b64_tr_b16 v[74:75], v32 offset:33792
    buffer_load_dwordx4 v6, s[12:15], s65 offen lds
    v_mul_f32 v218, v218, v13
    v_mul_f32 v219, v219, v13
    v_mfma_f32_16x16x32_bf16 v[236:239], v[84:87], v[52:55], v[236:239]
    s_setprio 1
    ds_read_b64_tr_b16 v[76:77], v32 offset:38912
    s_sub_u32 s65, s65, 229376
    v_mfma_f32_16x16x32_bf16 v[236:239], v[88:91], v[68:71], v[236:239]
    s_setprio 0
    v_mul_f32 v212, v212, v39
    v_mul_f32 v213, v213, v39
    ds_read_b64_tr_b16 v[78:79], v32 offset:39936
    v_mul_f32 v214, v214, v39
    v_mfma_f32_16x16x32_bf16 v[232:235], v[88:91], v[64:67], v[232:235]
    s_setprio 1
    v_mfma_f32_16x16x32_bf16 v[232:235], v[84:87], v[48:51], v[232:235]
    s_setprio 0
    v_mul_f32 v215, v215, v39
    v_mul_f32 v208, v208, v37
    v_mul_f32 v209, v209, v37
    v_mfma_f32_16x16x32_bf16 v[228:231], v[84:87], v[44:47], v[228:231]
    s_setprio 1
    ds_read_b64_tr_b16 v[80:81], v10 offset:14592
    v_mfma_f32_16x16x32_bf16 v[228:231], v[88:91], v[60:63], v[228:231]
    s_setprio 0
    v_mul_f32 v210, v210, v37
    v_mul_f32 v211, v211, v37
    ds_read_b64_tr_b16 v[82:83], v10 offset:18176
    v_mul_f32 v240, v240, v37
    v_mul_f32 v241, v241, v37
    v_mfma_f32_16x16x32_bf16 v[224:227], v[88:91], v[56:59], v[224:227]
    s_setprio 1
    v_mfma_f32_16x16x32_bf16 v[224:227], v[84:87], v[40:43], v[224:227]
    s_setprio 0
    v_mul_f32 v242, v242, v37
    v_mul_f32 v243, v243, v37
    v_mul_f32 v244, v244, v39
    s_waitcnt lgkmcnt(6)
    v_mfma_f32_16x16x32_bf16 v[96:99], v[28:31], v[40:43], 0
    s_setprio 1
    ds_read_b64_tr_b16 v[84:85], v10 offset:21888
    v_mfma_f32_16x16x32_bf16 v[96:99], v[16:19], v[56:59], v[96:99]
    s_setprio 0
    v_mul_f32 v245, v245, v39
    v_mul_f32 v246, v246, v39
    ds_read_b64_tr_b16 v[86:87], v10 offset:25472
    v_mul_f32 v247, v247, v39
    v_mfma_f32_16x16x32_bf16 v[100:103], v[16:19], v[60:63], 0
    s_setprio 1
    s_add_u32 m0, s28, 32768
    v_mfma_f32_16x16x32_bf16 v[100:103], v[28:31], v[44:47], v[100:103]
    s_setprio 0
    v_mul_f32 v248, v248, v13
    v_mul_f32 v249, v249, v13
    buffer_load_dwordx4 v4, s[8:11], s64 offen offset:0 sc1 lds
    v_mul_f32 v250, v250, v13
    v_mul_f32 v251, v251, v13
    v_mfma_f32_16x16x32_bf16 v[104:107], v[28:31], v[48:51], 0
    s_setprio 1
    ds_read_b64_tr_b16 v[88:89], v10 offset:14624
    v_mfma_f32_16x16x32_bf16 v[104:107], v[16:19], v[64:67], v[104:107]
    s_setprio 0
    v_mul_f32 v252, v252, v15
    ds_read_b64_tr_b16 v[90:91], v10 offset:18208
    v_mul_f32 v253, v253, v15
    v_mul_f32 v254, v254, v15
    v_mfma_f32_16x16x32_bf16 v[108:111], v[16:19], v[68:71], 0
    s_setprio 1
    v_mfma_f32_16x16x32_bf16 v[108:111], v[28:31], v[52:55], v[108:111]
    s_setprio 0
    v_mul_f32 v255, v255, v15
    s_nop 1
L_loop0:
    s_waitcnt lgkmcnt(6)
    v_mfma_f32_16x16x32_bf16 v[124:127], v[72:75], v[52:55], v[124:127]
    s_setprio 1
    ds_read_b64_tr_b16 v[28:29], v10 offset:21920
    v_mfma_f32_16x16x32_bf16 v[124:127], v[76:79], v[68:71], v[124:127]
    s_setprio 0
    ds_read_b64_tr_b16 v[30:31], v10 offset:25504
    v_mfma_f32_16x16x32_bf16 v[120:123], v[76:79], v[64:67], v[120:123]
    s_setprio 1
    s_add_u32 m0, s28, 32768
    v_mfma_f32_16x16x32_bf16 v[120:123], v[72:75], v[48:51], v[120:123]
    s_setprio 0
    buffer_load_dwordx4 v5, s[8:11], s64 offen offset:1024 sc1 lds
    v_mfma_f32_16x16x32_bf16 v[116:119], v[72:75], v[44:47], v[116:119]
    s_setprio 1
    v_mfma_f32_16x16x32_bf16 v[116:119], v[76:79], v[60:63], v[116:119]
    s_setprio 0
    v_mfma_f32_16x16x32_bf16 v[112:115], v[76:79], v[56:59], v[112:115]
    s_setprio 1
    v_mfma_f32_16x16x32_bf16 v[112:115], v[72:75], v[40:43], v[112:115]
    s_setprio 0
    ds_read_b64_tr_b16 v[72:73], v10 offset:14656
    s_waitcnt lgkmcnt(5)
    v_mfma_f32_16x16x32_bf16 v[144:147], v[80:83], v[40:43], v[144:147]
    s_setprio 1
    ds_read_b64_tr_b16 v[74:75], v10 offset:18240
    v_mfma_f32_16x16x32_bf16 v[144:147], v[84:87], v[56:59], v[144:147]
    s_setprio 0
    ds_read_b64_tr_b16 v[76:77], v10 offset:21952
    v_mfma_f32_16x16x32_bf16 v[148:151], v[84:87], v[60:63], v[148:151]
    s_setprio 1
    ds_read_b64_tr_b16 v[78:79], v10 offset:25536
    s_add_u32 m0, s28, 32768
    v_mfma_f32_16x16x32_bf16 v[148:151], v[80:83], v[44:47], v[148:151]
    s_setprio 0
    buffer_load_dwordx4 v4, s[8:11], s66 offen offset:2048 sc1 lds
    v_mfma_f32_16x16x32_bf16 v[152:155], v[80:83], v[48:51], v[152:155]
    s_setprio 1
    v_mfma_f32_16x16x32_bf16 v[152:155], v[84:87], v[64:67], v[152:155]
    s_setprio 0
    v_mfma_f32_16x16x32_bf16 v[156:159], v[84:87], v[68:71], v[156:159]
    s_setprio 1
    v_mfma_f32_16x16x32_bf16 v[156:159], v[80:83], v[52:55], v[156:159]
    s_setprio 0
    ds_read_b64_tr_b16 v[80:81], v10 offset:14688
    s_waitcnt lgkmcnt(5)
    v_mfma_f32_16x16x32_bf16 v[188:191], v[88:91], v[52:55], v[188:191]
    s_setprio 1
    ds_read_b64_tr_b16 v[82:83], v10 offset:18272
    v_mfma_f32_16x16x32_bf16 v[188:191], v[28:31], v[68:71], v[188:191]
    s_setprio 0
    ds_read_b64_tr_b16 v[84:85], v10 offset:21984
    v_mfma_f32_16x16x32_bf16 v[184:187], v[28:31], v[64:67], v[184:187]
    s_setprio 1
    ds_read_b64_tr_b16 v[86:87], v10 offset:25568
    s_add_u32 m0, s28, 32768
    v_mfma_f32_16x16x32_bf16 v[184:187], v[88:91], v[48:51], v[184:187]
    s_setprio 0
    buffer_load_dwordx4 v5, s[8:11], s66 offen offset:3072 sc1 lds
    v_mfma_f32_16x16x32_bf16 v[180:183], v[88:91], v[44:47], v[180:183]
    s_setprio 1
    s_add_u32 s64, s64, 128
    s_bitset0_b32 s64, 11
    v_mfma_f32_16x16x32_bf16 v[180:183], v[28:31], v[60:63], v[180:183]
    s_setprio 0
    s_add_u32 s66, s64, 30720
    s_waitcnt vmcnt(10) lgkmcnt(0)
    s_barrier
    v_mfma_f32_16x16x32_bf16 v[176:179], v[28:31], v[56:59], v[176:179]
    s_setprio 1
    ds_read_b128 v[12:15], v8 offset:6144
    s_add_u32 m0, s29, 14592
    v_mfma_f32_16x16x32_bf16 v[176:179], v[88:91], v[40:43], v[176:179]
    s_setprio 0
    ds_read_b64_tr_b16 v[88:89], v10 offset:29184
    buffer_load_dwordx4 v6, s[16:19], s65 offen lds
    v_mfma_f32_16x16x32_bf16 v[208:211], v[72:75], v[40:43], v[208:211]
    s_setprio 1
    ds_read_b64_tr_b16 v[90:91], v10 offset:32768
    s_add_u32 s65, s65, 229376
    v_mfma_f32_16x16x32_bf16 v[208:211], v[76:79], v[56:59], v[208:211]
    s_setprio 0
    ds_read_b64_tr_b16 v[28:29], v10 offset:36480
    v_mfma_f32_16x16x32_bf16 v[212:215], v[76:79], v[60:63], v[212:215]
    s_setprio 1
    ds_read_b64_tr_b16 v[30:31], v10 offset:40064
    v_mfma_f32_16x16x32_bf16 v[212:215], v[72:75], v[44:47], v[212:215]
    s_setprio 0
    ds_read_b128 v[36:39], v9 offset:6144
    v_mfma_f32_16x16x32_bf16 v[216:219], v[72:75], v[48:51], v[216:219]
    s_setprio 1
    ds_read_b64_tr_b16 v[16:17], v10 offset:29216
    v_mfma_f32_16x16x32_bf16 v[216:219], v[76:79], v[64:67], v[216:219]
    s_setprio 0
    ds_read_b64_tr_b16 v[18:19], v10 offset:32800
    v_mfma_f32_16x16x32_bf16 v[220:223], v[76:79], v[68:71], v[220:223]
    s_setprio 1
    s_add_u32 m0, s29, 21888
    v_mfma_f32_16x16x32_bf16 v[220:223], v[72:75], v[52:55], v[220:223]
    s_setprio 0
    buffer_load_dwordx4 v6, s[16:19], s65 offen lds
    v_mfma_f32_16x16x32_bf16 v[252:255], v[80:83], v[52:55], v[252:255]
    s_setprio 1
    ds_read_b128 v[52:55], v9 offset:4096
    ds_read_b64_tr_b16 v[72:73], v10 offset:36512
    s_add_u32 s65, s65, 229376
    v_mfma_f32_16x16x32_bf16 v[252:255], v[84:87], v[68:71], v[252:255]
    s_setprio 0
    ds_read_b128 v[68:71], v8 offset:4096
    ds_read_b64_tr_b16 v[74:75], v10 offset:40096
    v_mfma_f32_16x16x32_bf16 v[248:251], v[84:87], v[64:67], v[248:251]
    s_setprio 1
    ds_read_b128 v[64:67], v8 offset:2048
    v_mfma_f32_16x16x32_bf16 v[248:251], v[80:83], v[48:51], v[248:251]
    s_setprio 0
    ds_read_b128 v[48:51], v9 offset:2048
    v_mfma_f32_16x16x32_bf16 v[244:247], v[80:83], v[44:47], v[244:247]
    s_setprio 1
    ds_read_b128 v[44:47], v9 offset:0
    ds_read_b64_tr_b16 v[76:77], v10 offset:29248
    v_mfma_f32_16x16x32_bf16 v[244:247], v[84:87], v[60:63], v[244:247]
    s_setprio 0
    ds_read_b128 v[60:63], v8 offset:0
    ds_read_b64_tr_b16 v[78:79], v10 offset:32832
    v_mfma_f32_16x16x32_bf16 v[240:243], v[84:87], v[56:59], v[240:243]
    s_setprio 1
    s_mov_b32 m0, 131072
    v_mfma_f32_16x16x32_bf16 v[240:243], v[80:83], v[40:43], v[240:243]
    s_setprio 0
    buffer_load_dwordx4 v35, s[76:79], s37 offen  lds
    s_add_u32 s37, s37, 196608
    s_waitcnt lgkmcnt(12)
    v_mfma_f32_16x16x32_bf16 v[140:143], v[88:91], v[12:15], v[140:143]
    s_setprio 1
    ds_read_b64_tr_b16 v[80:81], v10 offset:36544
    v_mfma_f32_16x16x32_bf16 v[140:143], v[28:31], v[36:39], v[140:143]
    s_setprio 0
    ds_read_b64_tr_b16 v[82:83], v10 offset:40128
    s_waitcnt lgkmcnt(9)
    v_mfma_f32_16x16x32_bf16 v[136:139], v[28:31], v[52:55], v[136:139]
    s_setprio 1
    v_mfma_f32_16x16x32_bf16 v[136:139], v[88:91], v[68:71], v[136:139]
    s_setprio 0
    s_waitcnt lgkmcnt(6)
    v_mfma_f32_16x16x32_bf16 v[132:135], v[88:91], v[64:67], v[132:135]
    s_setprio 1
    ds_read_b64_tr_b16 v[84:85], v10 offset:29280
    v_mfma_f32_16x16x32_bf16 v[132:135], v[28:31], v[48:51], v[132:135]
    s_setprio 0
    ds_read_b64_tr_b16 v[86:87], v10 offset:32864
    s_waitcnt lgkmcnt(5)
    v_mfma_f32_16x16x32_bf16 v[128:131], v[28:31], v[44:47], v[128:131]
    s_setprio 1
    s_mov_b32 m0, 137216
    v_mfma_f32_16x16x32_bf16 v[128:131], v[88:91], v[60:63], v[128:131]
    s_setprio 0
    buffer_load_dwordx4 v35, s[76:79], s37 offen  lds
    v_mfma_f32_16x16x32_bf16 v[160:163], v[16:19], v[60:63], v[160:163]
    s_setprio 1
    ds_read_b64_tr_b16 v[88:89], v10 offset:36576
    s_add_u32 s37, s37, 196608
    v_mfma_f32_16x16x32_bf16 v[160:163], v[72:75], v[44:47], v[160:163]
    s_setprio 0
    ds_read_b64_tr_b16 v[90:91], v10 offset:40160
    v_mfma_f32_16x16x32_bf16 v[164:167], v[72:75], v[48:51], v[164:167]
    s_setprio 1
    v_mfma_f32_16x16x32_bf16 v[164:167], v[16:19], v[64:67], v[164:167]
    s_setprio 0
    v_mfma_f32_16x16x32_bf16 v[168:171], v[16:19], v[68:71], v[168:171]
    s_setprio 1
    v_mfma_f32_16x16x32_bf16 v[168:171], v[72:75], v[52:55], v[168:171]
    s_setprio 0
    s_waitcnt vmcnt(10) lgkmcnt(0)
    s_barrier
    v_mfma_f32_16x16x32_bf16 v[172:175], v[72:75], v[36:39], v[172:175]
    s_setprio 1
    ds_read_b64_tr_b16 v[28:29], v92 offset:45056
    s_add_u32 m0, s29, 29184
    v_mfma_f32_16x16x32_bf16 v[172:175], v[16:19], v[12:15], v[172:175]
    s_setprio 0
    ds_read_b64_tr_b16 v[30:31], v92 offset:46080
    buffer_load_dwordx4 v6, s[12:15], s65 offen lds
    v_mfma_f32_16x16x32_bf16 v[204:207], v[76:79], v[12:15], v[204:207]
    s_setprio 1
    ds_read_b64_tr_b16 v[16:17], v92 offset:51200
    s_add_u32 s65, s65, 229376
    v_mfma_f32_16x16x32_bf16 v[204:207], v[80:83], v[36:39], v[204:207]
    s_setprio 0
    ds_read_b64_tr_b16 v[18:19], v92 offset:52224
    v_mfma_f32_16x16x32_bf16 v[200:203], v[80:83], v[52:55], v[200:203]
    s_setprio 1
    v_mfma_f32_16x16x32_bf16 v[200:203], v[76:79], v[68:71], v[200:203]
    s_setprio 0
    v_mfma_f32_16x16x32_bf16 v[196:199], v[76:79], v[64:67], v[196:199]
    s_setprio 1
    ds_read_b64_tr_b16 v[72:73], v32 offset:45056
    v_mfma_f32_16x16x32_bf16 v[196:199], v[80:83], v[48:51], v[196:199]
    s_setprio 0
    ds_read_b64_tr_b16 v[74:75], v32 offset:46080
    v_mfma_f32_16x16x32_bf16 v[192:195], v[80:83], v[44:47], v[192:195]
    s_setprio 1
    s_add_u32 m0, s29, 36480
    v_mfma_f32_16x16x32_bf16 v[192:195], v[76:79], v[60:63], v[192:195]
    s_setprio 0
    buffer_load_dwordx4 v6, s[12:15], s65 offen lds
    v_mfma_f32_16x16x32_bf16 v[224:227], v[84:87], v[60:63], v[224:227]
    s_setprio 1
    ds_read_b64_tr_b16 v[76:77], v32 offset:51200
    s_sub_u32 s65, s65, 229376
    v_mfma_f32_16x16x32_bf16 v[224:227], v[88:91], v[44:47], v[224:227]
    s_setprio 0
    ds_read_b64_tr_b16 v[78:79], v32 offset:52224
    v_mfma_f32_16x16x32_bf16 v[228:231], v[88:91], v[48:51], v[228:231]
    s_setprio 1
    v_mfma_f32_16x16x32_bf16 v[228:231], v[84:87], v[64:67], v[228:231]
    s_setprio 0
    v_mfma_f32_16x16x32_bf16 v[232:235], v[84:87], v[68:71], v[232:235]
    s_setprio 1
    ds_read_b64_tr_b16 v[80:81], v10 offset:43776
    v_mfma_f32_16x16x32_bf16 v[232:235], v[88:91], v[52:55], v[232:235]
    s_setprio 0
    ds_read_b64_tr_b16 v[82:83], v10 offset:47360
    v_mfma_f32_16x16x32_bf16 v[236:239], v[88:91], v[36:39], v[236:239]
    s_setprio 1
    v_mfma_f32_16x16x32_bf16 v[236:239], v[84:87], v[12:15], v[236:239]
    s_setprio 0
    s_waitcnt lgkmcnt(6)
    v_mfma_f32_16x16x32_bf16 v[108:111], v[28:31], v[12:15], v[108:111]
    s_setprio 1
    ds_read_b64_tr_b16 v[84:85], v10 offset:51072
    v_mfma_f32_16x16x32_bf16 v[108:111], v[16:19], v[36:39], v[108:111]
    s_setprio 0
    ds_read_b64_tr_b16 v[86:87], v10 offset:54656
    v_mfma_f32_16x16x32_bf16 v[104:107], v[16:19], v[52:55], v[104:107]
    s_setprio 1
    s_add_u32 m0, s28, 0
    v_mfma_f32_16x16x32_bf16 v[104:107], v[28:31], v[68:71], v[104:107]
    s_setprio 0
    buffer_load_dwordx4 v4, s[8:11], s64 offen offset:0 sc1 lds
    v_mfma_f32_16x16x32_bf16 v[100:103], v[28:31], v[64:67], v[100:103]
    s_setprio 1
    ds_read_b64_tr_b16 v[88:89], v10 offset:43808
    v_mfma_f32_16x16x32_bf16 v[100:103], v[16:19], v[48:51], v[100:103]
    s_setprio 0
    ds_read_b64_tr_b16 v[90:91], v10 offset:47392
    v_mfma_f32_16x16x32_bf16 v[96:99], v[16:19], v[44:47], v[96:99]
    s_setprio 1
    v_mfma_f32_16x16x32_bf16 v[96:99], v[28:31], v[60:63], v[96:99]
    s_setprio 0
    s_waitcnt lgkmcnt(6)
    v_mfma_f32_16x16x32_bf16 v[112:115], v[72:75], v[60:63], v[112:115]
    s_setprio 1
    ds_read_b64_tr_b16 v[28:29], v10 offset:51104
    v_mfma_f32_16x16x32_bf16 v[112:115], v[76:79], v[44:47], v[112:115]
    s_setprio 0
    ds_read_b64_tr_b16 v[30:31], v10 offset:54688
    v_mfma_f32_16x16x32_bf16 v[116:119], v[76:79], v[48:51], v[116:119]
    s_setprio 1
    s_add_u32 m0, s28, 0
    v_mfma_f32_16x16x32_bf16 v[116:119], v[72:75], v[64:67], v[116:119]
    s_setprio 0
    buffer_load_dwordx4 v5, s[8:11], s64 offen offset:1024 sc1 lds
    v_mfma_f32_16x16x32_bf16 v[120:123], v[72:75], v[68:71], v[120:123]
    s_setprio 1
    v_mfma_f32_16x16x32_bf16 v[120:123], v[76:79], v[52:55], v[120:123]
    s_setprio 0
    v_mfma_f32_16x16x32_bf16 v[124:127], v[76:79], v[36:39], v[124:127]
    s_setprio 1
    v_mfma_f32_16x16x32_bf16 v[124:127], v[72:75], v[12:15], v[124:127]
    s_setprio 0
    ds_read_b64_tr_b16 v[72:73], v10 offset:43840
    s_waitcnt lgkmcnt(5)
    v_mfma_f32_16x16x32_bf16 v[156:159], v[80:83], v[12:15], v[156:159]
    s_setprio 1
    ds_read_b64_tr_b16 v[74:75], v10 offset:47424
    v_mfma_f32_16x16x32_bf16 v[156:159], v[84:87], v[36:39], v[156:159]
    s_setprio 0
    ds_read_b64_tr_b16 v[76:77], v10 offset:51136
    v_mfma_f32_16x16x32_bf16 v[152:155], v[84:87], v[52:55], v[152:155]
    s_setprio 1
    ds_read_b64_tr_b16 v[78:79], v10 offset:54720
    s_add_u32 m0, s28, 0
    v_mfma_f32_16x16x32_bf16 v[152:155], v[80:83], v[68:71], v[152:155]
    s_setprio 0
    buffer_load_dwordx4 v4, s[8:11], s66 offen offset:2048 sc1 lds
    v_mfma_f32_16x16x32_bf16 v[148:151], v[80:83], v[64:67], v[148:151]
    s_setprio 1
    v_mfma_f32_16x16x32_bf16 v[148:151], v[84:87], v[48:51], v[148:151]
    s_setprio 0
    v_mfma_f32_16x16x32_bf16 v[144:147], v[84:87], v[44:47], v[144:147]
    s_setprio 1
    v_mfma_f32_16x16x32_bf16 v[144:147], v[80:83], v[60:63], v[144:147]
    s_setprio 0
    ds_read_b64_tr_b16 v[80:81], v10 offset:43872
    s_waitcnt lgkmcnt(5)
    v_mfma_f32_16x16x32_bf16 v[176:179], v[88:91], v[60:63], v[176:179]
    s_setprio 1
    ds_read_b64_tr_b16 v[82:83], v10 offset:47456
    v_mfma_f32_16x16x32_bf16 v[176:179], v[28:31], v[44:47], v[176:179]
    s_setprio 0
    ds_read_b64_tr_b16 v[84:85], v10 offset:51168
    v_mfma_f32_16x16x32_bf16 v[180:183], v[28:31], v[48:51], v[180:183]
    s_setprio 1
    ds_read_b64_tr_b16 v[86:87], v10 offset:54752
    s_add_u32 m0, s28, 0
    v_mfma_f32_16x16x32_bf16 v[180:183], v[88:91], v[64:67], v[180:183]
    s_setprio 0
    buffer_load_dwordx4 v5, s[8:11], s66 offen offset:3072 sc1 lds
    v_mfma_f32_16x16x32_bf16 v[184:187], v[88:91], v[68:71], v[184:187]
    s_setprio 1
    s_add_u32 s64, s64, 128
    s_bitset0_b32 s64, 11
    v_mfma_f32_16x16x32_bf16 v[184:187], v[28:31], v[52:55], v[184:187]
    s_setprio 0
    s_add_u32 s66, s64, 30720
    s_waitcnt vmcnt(10) lgkmcnt(0)
    s_barrier
    v_mfma_f32_16x16x32_bf16 v[188:191], v[28:31], v[36:39], v[188:191]
    s_setprio 1
    ds_read_b128 v[40:43], v8 offset:32768
    s_add_u32 m0, s29, 43776
    v_mfma_f32_16x16x32_bf16 v[188:191], v[88:91], v[12:15], v[188:191]
    s_setprio 0
    ds_read_b64_tr_b16 v[88:89], v10 offset:0
    buffer_load_dwordx4 v6, s[16:19], s65 offen lds
    v_mfma_f32_16x16x32_bf16 v[220:223], v[72:75], v[12:15], v[220:223]
    s_setprio 1
    ds_read_b64_tr_b16 v[90:91], v10 offset:3584
    s_add_u32 s65, s65, 229376
    v_mfma_f32_16x16x32_bf16 v[220:223], v[76:79], v[36:39], v[220:223]
    s_setprio 0
    ds_read_b64_tr_b16 v[28:29], v10 offset:7296
    v_mfma_f32_16x16x32_bf16 v[216:219], v[76:79], v[52:55], v[216:219]
    s_setprio 1
    ds_read_b64_tr_b16 v[30:31], v10 offset:10880
    v_mfma_f32_16x16x32_bf16 v[216:219], v[72:75], v[68:71], v[216:219]
    s_setprio 0
    ds_read_b128 v[56:59], v9 offset:32768
    v_mfma_f32_16x16x32_bf16 v[212:215], v[72:75], v[64:67], v[212:215]
    s_setprio 1
    ds_read_b64_tr_b16 v[16:17], v10 offset:32
    v_mfma_f32_16x16x32_bf16 v[212:215], v[76:79], v[48:51], v[212:215]
    s_setprio 0
    ds_read_b64_tr_b16 v[18:19], v10 offset:3616
    v_mfma_f32_16x16x32_bf16 v[208:211], v[76:79], v[44:47], v[208:211]
    s_setprio 1
    s_add_u32 m0, s29, 51072
    v_mfma_f32_16x16x32_bf16 v[208:211], v[72:75], v[60:63], v[208:211]
    s_setprio 0
    buffer_load_dwordx4 v6, s[16:19], s65 offen lds
    v_mfma_f32_16x16x32_bf16 v[240:243], v[80:83], v[60:63], v[240:243]
    s_setprio 1
    ds_read_b128 v[60:63], v9 offset:34816
    ds_read_b64_tr_b16 v[72:73], v10 offset:7328
    s_add_u32 s65, s65, 229376
    v_mfma_f32_16x16x32_bf16 v[240:243], v[84:87], v[44:47], v[240:243]
    s_setprio 0
    ds_read_b128 v[44:47], v8 offset:34816
    ds_read_b64_tr_b16 v[74:75], v10 offset:10912
    v_mfma_f32_16x16x32_bf16 v[244:247], v[84:87], v[48:51], v[244:247]
    s_setprio 1
    ds_read_b128 v[48:51], v8 offset:36864
    v_mfma_f32_16x16x32_bf16 v[244:247], v[80:83], v[64:67], v[244:247]
    s_setprio 0
    ds_read_b128 v[64:67], v9 offset:36864
    v_mfma_f32_16x16x32_bf16 v[248:251], v[80:83], v[68:71], v[248:251]
    s_setprio 1
    ds_read_b128 v[68:71], v9 offset:38912
    ds_read_b64_tr_b16 v[76:77], v10 offset:64
    v_mfma_f32_16x16x32_bf16 v[248:251], v[84:87], v[52:55], v[248:251]
    s_setprio 0
    ds_read_b128 v[52:55], v8 offset:38912
    ds_read_b64_tr_b16 v[78:79], v10 offset:3648
    v_mfma_f32_16x16x32_bf16 v[252:255], v[84:87], v[36:39], v[252:255]
    s_setprio 1
    s_mov_b32 m0, 143360
    v_mfma_f32_16x16x32_bf16 v[252:255], v[80:83], v[12:15], v[252:255]
    s_setprio 0
    buffer_load_dwordx4 v35, s[76:79], s37 offen  lds
    s_add_u32 s37, s37, 196608
    s_waitcnt lgkmcnt(12)
    v_mfma_f32_16x16x32_bf16 v[128:131], v[88:91], v[40:43], v[128:131]
    s_setprio 1
    ds_read_b64_tr_b16 v[80:81], v10 offset:7360
    v_mfma_f32_16x16x32_bf16 v[128:131], v[28:31], v[56:59], v[128:131]
    s_setprio 0
    ds_read_b64_tr_b16 v[82:83], v10 offset:10944
    s_waitcnt lgkmcnt(9)
    v_mfma_f32_16x16x32_bf16 v[132:135], v[28:31], v[60:63], v[132:135]
    s_setprio 1
    v_mfma_f32_16x16x32_bf16 v[132:135], v[88:91], v[44:47], v[132:135]
    s_setprio 0
    s_bitcmp1_b32 0x10, s36
    s_cbranch_scc1 L_h0p3_2
L_r0p3_2:
    s_waitcnt lgkmcnt(6)
    v_mfma_f32_16x16x32_bf16 v[136:139], v[88:91], v[48:51], v[136:139]
    s_setprio 1
    ds_read_b64_tr_b16 v[84:85], v10 offset:96
    v_mfma_f32_16x16x32_bf16 v[136:139], v[28:31], v[64:67], v[136:139]
    s_setprio 0
    ds_read_b64_tr_b16 v[86:87], v10 offset:3680
    s_waitcnt lgkmcnt(5)
    v_mfma_f32_16x16x32_bf16 v[140:143], v[28:31], v[68:71], v[140:143]
    s_setprio 1
    s_mov_b32 m0, 149504
    v_mfma_f32_16x16x32_bf16 v[140:143], v[88:91], v[52:55], v[140:143]
    s_setprio 0
    buffer_load_dwordx4 v35, s[76:79], s37 offen  lds
    v_mfma_f32_16x16x32_bf16 v[172:175], v[16:19], v[52:55], v[172:175]
    s_setprio 1
    ds_read_b64_tr_b16 v[88:89], v10 offset:7392
    s_add_u32 s37, s37, 196608
    v_mfma_f32_16x16x32_bf16 v[172:175], v[72:75], v[68:71], v[172:175]
    s_setprio 0
    ds_read_b64_tr_b16 v[90:91], v10 offset:10976
    v_mfma_f32_16x16x32_bf16 v[168:171], v[72:75], v[64:67], v[168:171]
    s_setprio 1
    v_mfma_f32_16x16x32_bf16 v[168:171], v[16:19], v[48:51], v[168:171]
    s_setprio 0
    v_mfma_f32_16x16x32_bf16 v[164:167], v[16:19], v[44:47], v[164:167]
    s_setprio 1
    v_mfma_f32_16x16x32_bf16 v[164:167], v[72:75], v[60:63], v[164:167]
    s_setprio 0
    s_waitcnt vmcnt(10) lgkmcnt(0)
    s_barrier
    v_mfma_f32_16x16x32_bf16 v[160:163], v[72:75], v[56:59], v[160:163]
    s_setprio 1
    ds_read_b64_tr_b16 v[28:29], v92 offset:32768
    s_add_u32 m0, s29, 0
    v_mfma_f32_16x16x32_bf16 v[160:163], v[16:19], v[40:43], v[160:163]
    s_setprio 0
    ds_read_b64_tr_b16 v[30:31], v92 offset:33792
    buffer_load_dwordx4 v6, s[12:15], s65 offen lds
    v_mfma_f32_16x16x32_bf16 v[192:195], v[76:79], v[40:43], v[192:195]
    s_setprio 1
    ds_read_b64_tr_b16 v[16:17], v92 offset:38912
    s_add_u32 s65, s65, 229376
    v_mfma_f32_16x16x32_bf16 v[192:195], v[80:83], v[56:59], v[192:195]
    s_setprio 0
    ds_read_b64_tr_b16 v[18:19], v92 offset:39936
    v_mfma_f32_16x16x32_bf16 v[196:199], v[80:83], v[60:63], v[196:199]
    s_setprio 1
    v_mfma_f32_16x16x32_bf16 v[196:199], v[76:79], v[44:47], v[196:199]
    s_setprio 0
    v_mfma_f32_16x16x32_bf16 v[200:203], v[76:79], v[48:51], v[200:203]
    s_setprio 1
    ds_read_b64_tr_b16 v[72:73], v32 offset:32768
    v_mfma_f32_16x16x32_bf16 v[200:203], v[80:83], v[64:67], v[200:203]
    s_setprio 0
    ds_read_b64_tr_b16 v[74:75], v32 offset:33792
    v_mfma_f32_16x16x32_bf16 v[204:207], v[80:83], v[68:71], v[204:207]
    s_setprio 1
    s_add_u32 m0, s29, 7296
    v_mfma_f32_16x16x32_bf16 v[204:207], v[76:79], v[52:55], v[204:207]
    s_setprio 0
    buffer_load_dwordx4 v6, s[12:15], s65 offen lds
    v_mfma_f32_16x16x32_bf16 v[236:239], v[84:87], v[52:55], v[236:239]
    s_setprio 1
    ds_read_b64_tr_b16 v[76:77], v32 offset:38912
    s_sub_u32 s65, s65, 229376
    v_mfma_f32_16x16x32_bf16 v[236:239], v[88:91], v[68:71], v[236:239]
    s_setprio 0
    ds_read_b64_tr_b16 v[78:79], v32 offset:39936
    v_mfma_f32_16x16x32_bf16 v[232:235], v[88:91], v[64:67], v[232:235]
    s_setprio 1
    v_mfma_f32_16x16x32_bf16 v[232:235], v[84:87], v[48:51], v[232:235]
    s_setprio 0
    v_mfma_f32_16x16x32_bf16 v[228:231], v[84:87], v[44:47], v[228:231]
    s_setprio 1
    ds_read_b64_tr_b16 v[80:81], v10 offset:14592
    v_mfma_f32_16x16x32_bf16 v[228:231], v[88:91], v[60:63], v[228:231]
    s_setprio 0
    ds_read_b64_tr_b16 v[82:83], v10 offset:18176
    v_mfma_f32_16x16x32_bf16 v[224:227], v[88:91], v[56:59], v[224:227]
    s_setprio 1
    v_mfma_f32_16x16x32_bf16 v[224:227], v[84:87], v[40:43], v[224:227]
    s_setprio 0
    s_waitcnt lgkmcnt(6)
    v_mfma_f32_16x16x32_bf16 v[96:99], v[28:31], v[40:43], v[96:99]
    s_setprio 1
    ds_read_b64_tr_b16 v[84:85], v10 offset:21888
    v_mfma_f32_16x16x32_bf16 v[96:99], v[16:19], v[56:59], v[96:99]
    s_setprio 0
    ds_read_b64_tr_b16 v[86:87], v10 offset:25472
    v_mfma_f32_16x16x32_bf16 v[100:103], v[16:19], v[60:63], v[100:103]
    s_setprio 1
    s_add_u32 m0, s28, 32768
    v_mfma_f32_16x16x32_bf16 v[100:103], v[28:31], v[44:47], v[100:103]
    s_setprio 0
    buffer_load_dwordx4 v4, s[8:11], s64 offen offset:0 sc1 lds
    v_mfma_f32_16x16x32_bf16 v[104:107], v[28:31], v[48:51], v[104:107]
    s_setprio 1
    ds_read_b64_tr_b16 v[88:89], v10 offset:14624
    v_mfma_f32_16x16x32_bf16 v[104:107], v[16:19], v[64:67], v[104:107]
    s_setprio 0
    ds_read_b64_tr_b16 v[90:91], v10 offset:18208
    v_mfma_f32_16x16x32_bf16 v[108:111], v[16:19], v[68:71], v[108:111]
    s_setprio 1
    v_mfma_f32_16x16x32_bf16 v[108:111], v[28:31], v[52:55], v[108:111]
    s_setprio 0
    s_add_u32 s36, s36, 1
    s_cmp_lt_u32 s36, 5
    s_cbranch_scc1 L_loop0
    s_mov_b32 s80, 786432
    s_mov_b32 s81, 811008
    s_mov_b32 s82, 788480
    s_mov_b32 s29, 98304
    s_mov_b32 s37, 0
    s_mov_b32 s83, 131072
    s_branch L_pb0
L_w1:
    s_barrier
    s_add_u32 m0, s28, 0
    s_nop 0
    buffer_load_dwordx4 v4, s[8:11], s64 offen offset:0 sc1 lds
    buffer_load_dwordx4 v5, s[8:11], s64 offen offset:1024 sc1 lds
    buffer_load_dwordx4 v4, s[8:11], s66 offen offset:2048 sc1 lds
    buffer_load_dwordx4 v5, s[8:11], s66 offen offset:3072 sc1 lds
    s_add_u32 s64, s64, 128
    s_bitset0_b32 s64, 11
    s_add_u32 s66, s64, 30720
    s_add_u32 m0, s29, 0
    s_nop 0
    buffer_load_dwordx4 v6, s[12:15], s65 offen lds
    s_add_u32 s65, s65, 229376
    s_add_u32 m0, s29, 7296
    s_nop 0
    buffer_load_dwordx4 v6, s[12:15], s65 offen lds
    s_sub_u32 s65, s65, 229376
    s_add_u32 m0, s29, 14592
    s_nop 0
    buffer_load_dwordx4 v6, s[16:19], s65 offen lds
    s_add_u32 s65, s65, 229376
    s_add_u32 m0, s29, 21888
    s_nop 0
    buffer_load_dwordx4 v6, s[16:19], s65 offen lds
    s_add_u32 s65, s65, 229376
    s_waitcnt vmcnt(9)
    v_lshlrev_b32 v112, 16, v104
    v_and_b32 v113, 0xffff0000, v104
    v_lshlrev_b32 v114, 16, v105
    v_and_b32 v115, 0xffff0000, v105
    v_lshlrev_b32 v116, 16, v106
    v_and_b32 v117, 0xffff0000, v106
    v_lshlrev_b32 v118, 16, v107
    v_and_b32 v119, 0xffff0000, v107
    v_lshlrev_b32 v120, 16, v108
    v_and_b32 v121, 0xffff0000, v108
    v_lshlrev_b32 v122, 16, v109
    v_and_b32 v123, 0xffff0000, v109
    v_lshlrev_b32 v124, 16, v110
    v_and_b32 v125, 0xffff0000, v110
    v_lshlrev_b32 v126, 16, v111
    v_and_b32 v127, 0xffff0000, v111
    v_add_f32 v36, v112, v116
    v_add_f32 v37, v113, v117
    v_add_f32 v38, v114, v118
    v_add_f32 v39, v115, v119
    v_add_f32 v36, v36, v120
    v_add_f32 v37, v37, v121
    v_add_f32 v38, v38, v122
    v_add_f32 v39, v39, v123
    v_add_f32 v36, v36, v124
    v_add_f32 v37, v37, v125
    v_add_f32 v38, v38, v126
    v_add_f32 v39, v39, v127
    v_add_f32 v36, v36, v37
    v_add_f32 v38, v38, v39
    v_add_f32 v34, v36, v38
    s_nop 1
    v_add_f32_dpp v34, v34, v34 row_ror:8 row_mask:0xf bank_mask:0xf
    s_nop 1
    v_add_f32_dpp v34, v34, v34 row_ror:4 row_mask:0xf bank_mask:0xf
    s_nop 1
    v_add_f32_dpp v34, v34, v34 row_ror:2 row_mask:0xf bank_mask:0xf
    s_nop 1
    v_add_f32_dpp v34, v34, v34 row_ror:1 row_mask:0xf bank_mask:0xf
    v_mov_b32 v36, v34
    s_nop 1
    v_permlane16_swap_b32 v34, v36
    v_add_f32 v34, v34, v36
    v_mov_b32 v36, v34
    s_nop 1
    v_permlane32_swap_b32 v34, v36
    v_add_f32 v34, v34, v36
    v_mul_f32 v34, 0x3a800000, v34
    v_cvt_pk_bf16_f32 v14, v34, v34
    v_and_b32 v14, 0xffff0000, v14
    v_sub_f32 v112, v112, v14
    v_sub_f32 v113, v113, v14
    v_sub_f32 v114, v114, v14
    v_sub_f32 v115, v115, v14
    v_sub_f32 v116, v116, v14
    v_sub_f32 v117, v117, v14
    v_sub_f32 v118, v118, v14
    v_sub_f32 v119, v119, v14
    v_sub_f32 v120, v120, v14
    v_sub_f32 v121, v121, v14
    v_sub_f32 v122, v122, v14
    v_sub_f32 v123, v123, v14
    v_sub_f32 v124, v124, v14
    v_sub_f32 v125, v125, v14
    v_sub_f32 v126, v126, v14
    v_sub_f32 v127, v127, v14
    v_mul_f32 v36, v112, v112
    v_mul_f32 v37, v113, v113
    v_mul_f32 v38, v114, v114
    v_mul_f32 v39, v115, v115
    v_fmac_f32 v36, v116, v116
    v_fmac_f32 v37, v117, v117
    v_fmac_f32 v38, v118, v118
    v_fmac_f32 v39, v119, v119
    v_fmac_f32 v36, v120, v120
    v_fmac_f32 v37, v121, v121
    v_fmac_f32 v38, v122, v122
    v_fmac_f32 v39, v123, v123
    v_fmac_f32 v36, v124, v124
    v_fmac_f32 v37, v125, v125
    v_fmac_f32 v38, v126, v126
    v_fmac_f32 v39, v127, v127
    v_add_f32 v36, v36, v37
    v_add_f32 v38, v38, v39
    v_sub_f32 v34, v34, v14
    v_add_f32 v12, v36, v38
    s_nop 1
    v_add_f32_dpp v12, v12, v12 row_ror:8 row_mask:0xf bank_mask:0xf
    v_cvt_pk_bf16_f32 v104, v112, v113
    s_nop 0
    v_add_f32_dpp v12, v12, v12 row_ror:4 row_mask:0xf bank_mask:0xf
    v_cvt_pk_bf16_f32 v105, v114, v115
    s_nop 0
    v_add_f32_dpp v12, v12, v12 row_ror:2 row_mask:0xf bank_mask:0xf
    v_cvt_pk_bf16_f32 v106, v116, v117
    s_nop 0
    v_add_f32_dpp v12, v12, v12 row_ror:1 row_mask:0xf bank_mask:0xf
    v_cvt_pk_bf16_f32 v107, v118, v119
    v_mov_b32 v36, v12
    v_cvt_pk_bf16_f32 v108, v120, v121
    s_nop 0
    v_permlane16_swap_b32 v12, v36
    v_cvt_pk_bf16_f32 v109, v122, v123
    v_add_f32 v12, v12, v36
    v_cvt_pk_bf16_f32 v110, v124, v125
    v_mov_b32 v36, v12
    v_cvt_pk_bf16_f32 v111, v126, v127
    s_nop 0
    v_permlane32_swap_b32 v12, v36
    v_lshlrev_b32 v112, 16, v104
    v_add_f32 v12, v12, v36
    v_and_b32 v113, 0xffff0000, v104
    v_mul_f32 v12, 0x3a800000, v12
    v_lshlrev_b32 v114, 16, v105
    v_fma_f32 v12, -v34, v34, v12
    v_and_b32 v115, 0xffff0000, v105
    v_max_f32 v12, 0, v12
    v_lshlrev_b32 v116, 16, v106
    v_cvt_pk_bf16_f32 v12, v12, v12
    v_and_b32 v117, 0xffff0000, v106
    v_and_b32 v12, 0xffff0000, v12
    v_lshlrev_b32 v118, 16, v107
    v_add_f32 v12, 0x3727c5ac, v12
    v_and_b32 v119, 0xffff0000, v107
    v_cvt_pk_bf16_f32 v12, v12, v12
    v_lshlrev_b32 v120, 16, v108
    v_and_b32 v12, 0xffff0000, v12
    v_and_b32 v121, 0xffff0000, v108
    v_sqrt_f32 v15, v12
    v_lshlrev_b32 v122, 16, v109
    v_cvt_pk_bf16_f32 v15, v15, v15
    v_and_b32 v123, 0xffff0000, v109
    v_and_b32 v15, 0xffff0000, v15
    v_lshlrev_b32 v124, 16, v110
    v_rcp_f32 v12, v15
    v_and_b32 v125, 0xffff0000, v110
    v_sub_f32 v14, 0, v14
    v_lshlrev_b32 v126, 16, v111
    v_and_b32 v127, 0xffff0000, v111
    v_mul_f32 v112, v112, v12
    v_mul_f32 v113, v113, v12
    v_mul_f32 v114, v114, v12
    v_mul_f32 v115, v115, v12
    v_mul_f32 v116, v116, v12
    v_mul_f32 v117, v117, v12
    v_mul_f32 v118, v118, v12
    v_mul_f32 v119, v119, v12
    v_mul_f32 v120, v120, v12
    v_mul_f32 v121, v121, v12
    v_mul_f32 v122, v122, v12
    v_mul_f32 v123, v123, v12
    v_mul_f32 v124, v124, v12
    v_mul_f32 v125, v125, v12
    v_mul_f32 v126, v126, v12
    v_mul_f32 v127, v127, v12
    v_cvt_pk_bf16_f32 v104, v112, v113
    v_cvt_pk_bf16_f32 v105, v114, v115
    v_cvt_pk_bf16_f32 v106, v116, v117
    v_cvt_pk_bf16_f32 v107, v118, v119
    v_cvt_pk_bf16_f32 v108, v120, v121
    v_cvt_pk_bf16_f32 v109, v122, v123
    v_cvt_pk_bf16_f32 v110, v124, v125
    v_cvt_pk_bf16_f32 v111, v126, v127
    buffer_store_dwordx4 v[104:107], v2, s[20:23], s3 offen offset:0 sc1
    buffer_store_dwordx4 v[108:111], v2, s[20:23], s3 offen offset:1024 sc1
    v_lshrrev_b32 v14, 16, v14
    v_or_b32 v14, v14, v15
    s_waitcnt vmcnt(10)
    s_mov_b32 s5, 0x9E3779B1
    v_mul_lo_u32 v33, v33, s5
    v_add_u32 v33, 0x7F4A7C15, v33
    s_nop 0
    v_readfirstlane_b32 s58, v33
    v_mov_b32 v15, v33
    s_waitcnt vmcnt(4)
    s_barrier
    ds_read_b128 v[40:43], v8 offset:0
    ds_read_b64_tr_b16 v[84:85], v10 offset:0
    ds_read_b64_tr_b16 v[86:87], v10 offset:3584
    ds_read_b128 v[56:59], v9 offset:0
    ds_read_b64_tr_b16 v[88:89], v10 offset:7296
    ds_read_b64_tr_b16 v[90:91], v10 offset:10880
    ds_read_b128 v[60:63], v9 offset:2048
    ds_read_b128 v[44:47], v8 offset:2048
    ds_read_b128 v[48:51], v8 offset:4096
    ds_read_b128 v[64:67], v9 offset:4096
    ds_read_b128 v[68:71], v9 offset:6144
    ds_read_b128 v[52:55], v8 offset:6144
    ds_read_b64_tr_b16 v[72:73], v10 offset:32
    ds_read_b64_tr_b16 v[74:75], v10 offset:3616
    ds_read_b64_tr_b16 v[76:77], v10 offset:7328
    ds_read_b64_tr_b16 v[78:79], v10 offset:10912
    s_mov_b32 s37, 1597440
    s_add_u32 m0, s28, 32768
    s_waitcnt lgkmcnt(10)
    v_mfma_f32_16x16x32_bf16 v[128:131], v[84:87], v[40:43], 0
    s_setprio 1
    ds_read_b64_tr_b16 v[80:81], v10 offset:64
    v_mfma_f32_16x16x32_bf16 v[128:131], v[88:91], v[56:59], v[128:131]
    s_setprio 0
    buffer_load_dwordx4 v4, s[8:11], s64 offen offset:0 sc1 lds
    ds_read_b64_tr_b16 v[82:83], v10 offset:3648
    s_waitcnt lgkmcnt(10)
    v_mfma_f32_16x16x32_bf16 v[132:135], v[88:91], v[60:63], 0
    s_setprio 1
    s_add_u32 m0, s28, 32768
    v_mfma_f32_16x16x32_bf16 v[132:135], v[84:87], v[44:47], v[132:135]
    s_setprio 0
    buffer_load_dwordx4 v5, s[8:11], s64 offen offset:1024 sc1 lds
    s_waitcnt lgkmcnt(8)
    v_mfma_f32_16x16x32_bf16 v[136:139], v[84:87], v[48:51], 0
    s_setprio 1
    v_mfma_f32_16x16x32_bf16 v[136:139], v[88:91], v[64:67], v[136:139]
    s_setprio 0
    s_add_u32 m0, s28, 32768
    s_waitcnt lgkmcnt(6)
    v_mfma_f32_16x16x32_bf16 v[140:143], v[88:91], v[68:71], 0
    s_setprio 1
    v_mfma_f32_16x16x32_bf16 v[140:143], v[84:87], v[52:55], v[140:143]
    s_setprio 0
    buffer_load_dwordx4 v4, s[8:11], s66 offen offset:2048 sc1 lds
    ds_read_b64_tr_b16 v[84:85], v10 offset:7360
    s_waitcnt lgkmcnt(3)
    v_mfma_f32_16x16x32_bf16 v[172:175], v[72:75], v[52:55], 0
    s_setprio 1
    ds_read_b64_tr_b16 v[86:87], v10 offset:10944
    s_add_u32 m0, s28, 32768
    v_mfma_f32_16x16x32_bf16 v[172:175], v[76:79], v[68:71], v[172:175]
    s_setprio 0
    ds_read_b64_tr_b16 v[88:89], v10 offset:96
    buffer_load_dwordx4 v5, s[8:11], s66 offen offset:3072 sc1 lds
    v_mfma_f32_16x16x32_bf16 v[168:171], v[76:79], v[64:67], 0
    s_setprio 1
    ds_read_b64_tr_b16 v[90:91], v10 offset:3680
    s_add_u32 s64, s64, 128
    s_bitset0_b32 s64, 11
    v_mfma_f32_16x16x32_bf16 v[168:171], v[72:75], v[48:51], v[168:171]
    s_setprio 0
    v_mfma_f32_16x16x32_bf16 v[16:19], v[28:31], v[72:75], 0
    v_mfma_f32_16x16x32_bf16 v[16:19], v[28:31], v[76:79], v[16:19]
    s_add_u32 s66, s64, 30720
    s_add_u32 m0, s29, 29184
    v_mfma_f32_16x16x32_bf16 v[164:167], v[72:75], v[44:47], 0
    s_setprio 1
    v_mfma_f32_16x16x32_bf16 v[164:167], v[76:79], v[60:63], v[164:167]
    s_setprio 0
    buffer_load_dwordx4 v6, s[12:15], s65 offen lds
    s_add_u32 s65, s65, 229376
    v_mfma_f32_16x16x32_bf16 v[160:163], v[76:79], v[56:59], 0
    s_setprio 1
    s_add_u32 m0, s29, 36480
    v_mfma_f32_16x16x32_bf16 v[160:163], v[72:75], v[40:43], v[160:163]
    s_setprio 0
    ds_read_b64_tr_b16 v[72:73], v10 offset:7392
    buffer_load_dwordx4 v6, s[12:15], s65 offen lds
    s_waitcnt lgkmcnt(3)
    v_mfma_f32_16x16x32_bf16 v[192:195], v[80:83], v[40:43], 0
    s_setprio 1
    ds_read_b64_tr_b16 v[74:75], v10 offset:10976
    s_sub_u32 s65, s65, 229376
    v_mfma_f32_16x16x32_bf16 v[192:195], v[84:87], v[56:59], v[192:195]
    s_setprio 0
    s_waitcnt vmcnt(8) lgkmcnt(0)
    s_barrier
    s_add_u32 m0, s29, 43776
    v_mfma_f32_16x16x32_bf16 v[196:199], v[84:87], v[60:63], 0
    s_setprio 1
    ds_read_b64_tr_b16 v[76:77], v10 offset:14592
    v_mfma_f32_16x16x32_bf16 v[196:199], v[80:83], v[44:47], v[196:199]
    s_setprio 0
    buffer_load_dwordx4 v6, s[16:19], s65 offen lds
    s_add_u32 s65, s65, 229376
    ds_read_b64_tr_b16 v[78:79], v10 offset:18176
    v_mfma_f32_16x16x32_bf16 v[200:203], v[80:83], v[48:51], 0
    s_setprio 1
    s_add_u32 m0, s29, 51072
    v_mfma_f32_16x16x32_bf16 v[200:203], v[84:87], v[64:67], v[200:203]
    s_setprio 0
    buffer_load_dwordx4 v6, s[16:19], s65 offen lds
    v_mfma_f32_16x16x32_bf16 v[204:207], v[84:87], v[68:71], 0
    s_setprio 1
    s_add_u32 s65, s65, 229376
    v_mfma_f32_16x16x32_bf16 v[204:207], v[80:83], v[52:55], v[204:207]
    s_setprio 0
    ds_read_b64_tr_b16 v[80:81], v10 offset:21888
    s_add_u32 m0, s29, 0
    v_mfma_f32_16x16x32_bf16 v[236:239], v[88:91], v[52:55], 0
    s_setprio 1
    ds_read_b64_tr_b16 v[82:83], v10 offset:25472
    v_mfma_f32_16x16x32_bf16 v[236:239], v[72:75], v[68:71], v[236:239]
    s_setprio 0
    buffer_load_dwordx4 v6, s[12:15], s65 offen lds
    s_add_u32 s65, s65, 229376
    ds_read_b64_tr_b16 v[84:85], v10 offset:14624
    v_mfma_f32_16x16x32_bf16 v[232:235], v[72:75], v[64:67], 0
    s_setprio 1
    ds_read_b64_tr_b16 v[86:87], v10 offset:18208
    s_add_u32 m0, s29, 7296
    v_mfma_f32_16x16x32_bf16 v[232:235], v[88:91], v[48:51], v[232:235]
    s_setprio 0
    buffer_load_dwordx4 v6, s[12:15], s65 offen lds
    v_mfma_f32_16x16x32_bf16 v[228:231], v[88:91], v[44:47], 0
    s_setprio 1
    s_sub_u32 s65, s65, 229376
    v_mfma_f32_16x16x32_bf16 v[228:231], v[72:75], v[60:63], v[228:231]
    s_setprio 0
    s_add_u32 m0, s28, 123904
    v_mfma_f32_16x16x32_bf16 v[224:227], v[72:75], v[56:59], 0
    s_setprio 1
    v_mfma_f32_16x16x32_bf16 v[224:227], v[88:91], v[40:43], v[224:227]
    s_setprio 0
    buffer_load_dwordx4 v4, s[8:11], s64 offen offset:0 sc1 lds
    ds_read_b64_tr_b16 v[88:89], v10 offset:21920
    s_waitcnt lgkmcnt(3)
    v_mfma_f32_16x16x32_bf16 v[144:147], v[76:79], v[40:43], 0
    s_setprio 1
    ds_read_b64_tr_b16 v[90:91], v10 offset:25504
    s_add_u32 m0, s28, 123904
    v_mfma_f32_16x16x32_bf16 v[144:147], v[80:83], v[56:59], v[144:147]
    s_setprio 0
    ds_read_b64_tr_b16 v[72:73], v10 offset:14656
    buffer_load_dwordx4 v5, s[8:11], s64 offen offset:1024 sc1 lds
    v_mfma_f32_16x16x32_bf16 v[148:151], v[80:83], v[60:63], 0
    s_setprio 1
    ds_read_b64_tr_b16 v[74:75], v10 offset:18240
    v_mfma_f32_16x16x32_bf16 v[148:151], v[76:79], v[44:47], v[148:151]
    s_setprio 0
    s_add_u32 m0, s28, 123904
    v_mfma_f32_16x16x32_bf16 v[152:155], v[76:79], v[48:51], 0
    s_setprio 1
    v_mfma_f32_16x16x32_bf16 v[152:155], v[80:83], v[64:67], v[152:155]
    s_setprio 0
    buffer_load_dwordx4 v4, s[8:11], s66 offen offset:2048 sc1 lds
    v_mfma_f32_16x16x32_bf16 v[156:159], v[80:83], v[68:71], 0
    s_setprio 1
    s_add_u32 m0, s28, 123904
    v_mfma_f32_16x16x32_bf16 v[156:159], v[76:79], v[52:55], v[156:159]
    s_setprio 0
    ds_read_b64_tr_b16 v[76:77], v10 offset:21952
    buffer_load_dwordx4 v5, s[8:11], s66 offen offset:3072 sc1 lds
    s_waitcnt lgkmcnt(3)
    v_mfma_f32_16x16x32_bf16 v[188:191], v[84:87], v[52:55], 0
    s_setprio 1
    ds_read_b64_tr_b16 v[78:79], v10 offset:25536
    s_add_u32 s64, s64, 128
    s_bitset0_b32 s64, 11
    v_mfma_f32_16x16x32_bf16 v[188:191], v[88:91], v[68:71], v[188:191]
    s_setprio 0
    s_add_u32 s66, s64, 30720
    s_waitcnt vmcnt(14)
    s_lshr_b32 s3, s3, 8
    s_add_u32 s3, s3, 3211264
    s_mov_b64 exec, 1
    buffer_store_dwordx2 v[14:15], off, s[24:27], s3 sc1
    s_mov_b64 exec, -1
    ds_read_b64_tr_b16 v[80:81], v10 offset:14688
    v_mfma_f32_16x16x32_bf16 v[184:187], v[88:91], v[64:67], 0
    s_setprio 1
    ds_read_b64_tr_b16 v[82:83], v10 offset:18272
    v_mfma_f32_16x16x32_bf16 v[184:187], v[84:87], v[48:51], v[184:187]
    s_setprio 0
    v_mfma_f32_16x16x32_bf16 v[20:23], v[28:31], v[84:87], 0
    v_mfma_f32_16x16x32_bf16 v[20:23], v[28:31], v[88:91], v[20:23]
    v_mfma_f32_16x16x32_bf16 v[180:183], v[84:87], v[44:47], 0
    s_setprio 1
    v_mfma_f32_16x16x32_bf16 v[180:183], v[88:91], v[60:63], v[180:183]
    s_setprio 0
    v_mfma_f32_16x16x32_bf16 v[176:179], v[88:91], v[56:59], 0
    s_setprio 1
    v_mfma_f32_16x16x32_bf16 v[176:179], v[84:87], v[40:43], v[176:179]
    s_setprio 0
    ds_read_b64_tr_b16 v[84:85], v10 offset:21984
    s_waitcnt lgkmcnt(3)
    v_mfma_f32_16x16x32_bf16 v[208:211], v[72:75], v[40:43], 0
    s_setprio 1
    ds_read_b64_tr_b16 v[86:87], v10 offset:25568
    v_mfma_f32_16x16x32_bf16 v[208:211], v[76:79], v[56:59], v[208:211]
    s_setprio 0
    s_waitcnt vmcnt(9) lgkmcnt(0)
    s_barrier
    s_add_u32 m0, s29, 14592
    v_mfma_f32_16x16x32_bf16 v[212:215], v[76:79], v[60:63], 0
    s_setprio 1
    ds_read_b64_tr_b16 v[88:89], v10 offset:29184
    v_mfma_f32_16x16x32_bf16 v[212:215], v[72:75], v[44:47], v[212:215]
    s_setprio 0
    buffer_load_dwordx4 v6, s[16:19], s65 offen lds
    s_add_u32 s65, s65, 229376
    ds_read_b64_tr_b16 v[90:91], v10 offset:32768
    v_mfma_f32_16x16x32_bf16 v[216:219], v[72:75], v[48:51], 0
    s_setprio 1
    s_add_u32 m0, s29, 21888
    v_mfma_f32_16x16x32_bf16 v[216:219], v[76:79], v[64:67], v[216:219]
    s_setprio 0
    buffer_load_dwordx4 v6, s[16:19], s65 offen lds
    v_mfma_f32_16x16x32_bf16 v[220:223], v[76:79], v[68:71], 0
    s_setprio 1
    s_add_u32 s65, s65, 229376
    v_mfma_f32_16x16x32_bf16 v[220:223], v[72:75], v[52:55], v[220:223]
    s_setprio 0
    ds_read_b64_tr_b16 v[72:73], v10 offset:36480
    s_add_u32 m0, s28, 0
    v_mfma_f32_16x16x32_bf16 v[252:255], v[80:83], v[52:55], 0
    s_setprio 1
    ds_read_b128 v[52:55], v8 offset:38912
    ds_read_b64_tr_b16 v[74:75], v10 offset:40064
    v_mfma_f32_16x16x32_bf16 v[252:255], v[84:87], v[68:71], v[252:255]
    s_setprio 0
    buffer_load_dwordx4 v4, s[8:11], s64 offen offset:0 sc1 lds
    ds_read_b128 v[68:71], v9 offset:38912
    ds_read_b64_tr_b16 v[76:77], v10 offset:29216
    v_mfma_f32_16x16x32_bf16 v[248:251], v[84:87], v[64:67], 0
    s_setprio 1
    ds_read_b128 v[64:67], v9 offset:36864
    ds_read_b64_tr_b16 v[78:79], v10 offset:32800
    s_add_u32 m0, s28, 0
    v_mfma_f32_16x16x32_bf16 v[248:251], v[80:83], v[48:51], v[248:251]
    s_setprio 0
    ds_read_b128 v[48:51], v8 offset:36864
    buffer_load_dwordx4 v5, s[8:11], s64 offen offset:1024 sc1 lds
    v_mfma_f32_16x16x32_bf16 v[244:247], v[80:83], v[44:47], 0
    s_setprio 1
    ds_read_b128 v[44:47], v8 offset:34816
    v_mfma_f32_16x16x32_bf16 v[244:247], v[84:87], v[60:63], v[244:247]
    s_setprio 0
    ds_read_b128 v[60:63], v9 offset:34816
    s_add_u32 m0, s28, 0
    v_mfma_f32_16x16x32_bf16 v[240:243], v[84:87], v[56:59], 0
    s_setprio 1
    ds_read_b128 v[56:59], v9 offset:32768
    v_mfma_f32_16x16x32_bf16 v[240:243], v[80:83], v[40:43], v[240:243]
    s_setprio 0
    buffer_load_dwordx4 v4, s[8:11], s66 offen offset:2048 sc1 lds
    ds_read_b128 v[40:43], v8 offset:32768
    ds_read_b64_tr_b16 v[80:81], v10 offset:36512
    s_waitcnt lgkmcnt(9)
    v_mfma_f32_16x16x32_bf16 v[140:143], v[88:91], v[52:55], v[140:143]
    s_setprio 1
    ds_read_b64_tr_b16 v[82:83], v10 offset:40096
    s_add_u32 m0, s28, 0
    v_mfma_f32_16x16x32_bf16 v[140:143], v[72:75], v[68:71], v[140:143]
    s_setprio 0
    ds_read_b64_tr_b16 v[84:85], v10 offset:29248
    buffer_load_dwordx4 v5, s[8:11], s66 offen offset:3072 sc1 lds
    s_waitcnt lgkmcnt(7)
    v_mfma_f32_16x16x32_bf16 v[136:139], v[72:75], v[64:67], v[136:139]
    s_setprio 1
    ds_read_b64_tr_b16 v[86:87], v10 offset:32832
    s_add_u32 s64, s64, 128
    s_bitset0_b32 s64, 11
    v_mfma_f32_16x16x32_bf16 v[136:139], v[88:91], v[48:51], v[136:139]
    s_setprio 0
    s_add_u32 s66, s64, 30720
    s_waitcnt lgkmcnt(6)
    v_mfma_f32_16x16x32_bf16 v[132:135], v[88:91], v[44:47], v[132:135]
    s_setprio 1
    v_mfma_f32_16x16x32_bf16 v[132:135], v[72:75], v[60:63], v[132:135]
    s_setprio 0
    s_waitcnt lgkmcnt(4)
    v_mfma_f32_16x16x32_bf16 v[128:131], v[72:75], v[56:59], v[128:131]
    s_setprio 1
    v_mfma_f32_16x16x32_bf16 v[128:131], v[88:91], v[40:43], v[128:131]
    s_setprio 0
    ds_read_b64_tr_b16 v[88:89], v10 offset:36544
    s_waitcnt lgkmcnt(3)
    v_mfma_f32_16x16x32_bf16 v[160:163], v[76:79], v[40:43], v[160:163]
    s_setprio 1
    ds_read_b64_tr_b16 v[90:91], v10 offset:40128
    v_mfma_f32_16x16x32_bf16 v[160:163], v[80:83], v[56:59], v[160:163]
    s_setprio 0
    ds_read_b64_tr_b16 v[72:73], v10 offset:29280
    v_mfma_f32_16x16x32_bf16 v[164:167], v[80:83], v[60:63], v[164:167]
    s_setprio 1
    ds_read_b64_tr_b16 v[74:75], v10 offset:32864
    v_mfma_f32_16x16x32_bf16 v[164:167], v[76:79], v[44:47], v[164:167]
    s_setprio 0
    v_mfma_f32_16x16x32_bf16 v[16:19], v[28:31], v[76:79], v[16:19]
    v_mfma_f32_16x16x32_bf16 v[16:19], v[28:31], v[80:83], v[16:19]
    v_mfma_f32_16x16x32_bf16 v[168:171], v[76:79], v[48:51], v[168:171]
    s_setprio 1
    v_mfma_f32_16x16x32_bf16 v[168:171], v[80:83], v[64:67], v[168:171]
    s_setprio 0
    v_mfma_f32_16x16x32_bf16 v[172:175], v[80:83], v[68:71], v[172:175]
    s_setprio 1
    v_mfma_f32_16x16x32_bf16 v[172:175], v[76:79], v[52:55], v[172:175]
    s_setprio 0
    ds_read_b64_tr_b16 v[76:77], v10 offset:36576
    s_waitcnt lgkmcnt(3)
    v_mfma_f32_16x16x32_bf16 v[204:207], v[84:87], v[52:55], v[204:207]
    s_setprio 1
    ds_read_b64_tr_b16 v[78:79], v10 offset:40160
    v_mfma_f32_16x16x32_bf16 v[204:207], v[88:91], v[68:71], v[204:207]
    s_setprio 0
    s_waitcnt vmcnt(13) lgkmcnt(0)
    s_barrier
    v_mfma_f32_16x16x32_bf16 v[200:203], v[88:91], v[64:67], v[200:203]
    s_setprio 1
    ds_read_b64_tr_b16 v[80:81], v10 offset:43776
    s_add_u32 m0, s29, 29184
    v_mfma_f32_16x16x32_bf16 v[200:203], v[84:87], v[48:51], v[200:203]
    s_setprio 0
    ds_read_b64_tr_b16 v[82:83], v10 offset:47360
    buffer_load_dwordx4 v6, s[12:15], s65 offen lds
    v_mfma_f32_16x16x32_bf16 v[196:199], v[84:87], v[44:47], v[196:199]
    s_setprio 1
    s_add_u32 s65, s65, 229376
    v_mfma_f32_16x16x32_bf16 v[196:199], v[88:91], v[60:63], v[196:199]
    s_setprio 0
    v_mfma_f32_16x16x32_bf16 v[192:195], v[88:91], v[56:59], v[192:195]
    s_setprio 1
    s_add_u32 m0, s29, 36480
    v_mfma_f32_16x16x32_bf16 v[192:195], v[84:87], v[40:43], v[192:195]
    s_setprio 0
    ds_read_b64_tr_b16 v[84:85], v10 offset:51072
    buffer_load_dwordx4 v6, s[12:15], s65 offen lds
    v_mfma_f32_16x16x32_bf16 v[224:227], v[72:75], v[40:43], v[224:227]
    s_setprio 1
    ds_read_b64_tr_b16 v[86:87], v10 offset:54656
    s_sub_u32 s65, s65, 229376
    v_mfma_f32_16x16x32_bf16 v[224:227], v[76:79], v[56:59], v[224:227]
    s_setprio 0
    ds_read_b64_tr_b16 v[88:89], v10 offset:43808
    v_mfma_f32_16x16x32_bf16 v[228:231], v[76:79], v[60:63], v[228:231]
    s_setprio 1
    ds_read_b64_tr_b16 v[90:91], v10 offset:47392
    v_mfma_f32_16x16x32_bf16 v[228:231], v[72:75], v[44:47], v[228:231]
    s_setprio 0
    v_mfma_f32_16x16x32_bf16 v[232:235], v[72:75], v[48:51], v[232:235]
    s_setprio 1
    v_mfma_f32_16x16x32_bf16 v[232:235], v[76:79], v[64:67], v[232:235]
    s_setprio 0
    v_mfma_f32_16x16x32_bf16 v[236:239], v[76:79], v[68:71], v[236:239]
    s_setprio 1
    v_mfma_f32_16x16x32_bf16 v[236:239], v[72:75], v[52:55], v[236:239]
    s_setprio 0
    ds_read_b64_tr_b16 v[72:73], v10 offset:51104
    s_waitcnt lgkmcnt(3)
    v_mfma_f32_16x16x32_bf16 v[156:159], v[80:83], v[52:55], v[156:159]
    s_setprio 1
    ds_read_b64_tr_b16 v[74:75], v10 offset:54688
    v_mfma_f32_16x16x32_bf16 v[156:159], v[84:87], v[68:71], v[156:159]
    s_setprio 0
    ds_read_b64_tr_b16 v[76:77], v10 offset:43840
    v_mfma_f32_16x16x32_bf16 v[152:155], v[84:87], v[64:67], v[152:155]
    s_setprio 1
    ds_read_b64_tr_b16 v[78:79], v10 offset:47424
    v_mfma_f32_16x16x32_bf16 v[152:155], v[80:83], v[48:51], v[152:155]
    s_setprio 0
    v_mfma_f32_16x16x32_bf16 v[148:151], v[80:83], v[44:47], v[148:151]
    s_setprio 1
    v_mfma_f32_16x16x32_bf16 v[148:151], v[84:87], v[60:63], v[148:151]
    s_setprio 0
    v_mfma_f32_16x16x32_bf16 v[144:147], v[84:87], v[56:59], v[144:147]
    s_setprio 1
    v_mfma_f32_16x16x32_bf16 v[144:147], v[80:83], v[40:43], v[144:147]
    s_setprio 0
    ds_read_b64_tr_b16 v[80:81], v10 offset:51136
    s_waitcnt lgkmcnt(3)
    v_mfma_f32_16x16x32_bf16 v[176:179], v[88:91], v[40:43], v[176:179]
    s_setprio 1
    ds_read_b64_tr_b16 v[82:83], v10 offset:54720
    v_mfma_f32_16x16x32_bf16 v[176:179], v[72:75], v[56:59], v[176:179]
    s_setprio 0
    ds_read_b64_tr_b16 v[84:85], v10 offset:43872
    v_mfma_f32_16x16x32_bf16 v[180:183], v[72:75], v[60:63], v[180:183]
    s_setprio 1
    ds_read_b64_tr_b16 v[86:87], v10 offset:47456
    v_mfma_f32_16x16x32_bf16 v[180:183], v[88:91], v[44:47], v[180:183]
    s_setprio 0
    v_mfma_f32_16x16x32_bf16 v[20:23], v[28:31], v[88:91], v[20:23]
    v_mfma_f32_16x16x32_bf16 v[20:23], v[28:31], v[72:75], v[20:23]
    v_mfma_f32_16x16x32_bf16 v[184:187], v[88:91], v[48:51], v[184:187]
    s_setprio 1
    v_mfma_f32_16x16x32_bf16 v[184:187], v[72:75], v[64:67], v[184:187]
    s_setprio 0
    v_mfma_f32_16x16x32_bf16 v[188:191], v[72:75], v[68:71], v[188:191]
    s_setprio 1
    v_mfma_f32_16x16x32_bf16 v[188:191], v[88:91], v[52:55], v[188:191]
    s_setprio 0
    ds_read_b64_tr_b16 v[88:89], v10 offset:51168
    s_waitcnt lgkmcnt(3)
    v_mfma_f32_16x16x32_bf16 v[220:223], v[76:79], v[52:55], v[220:223]
    s_setprio 1
    ds_read_b64_tr_b16 v[90:91], v10 offset:54752
    v_mfma_f32_16x16x32_bf16 v[220:223], v[80:83], v[68:71], v[220:223]
    s_setprio 0
    s_waitcnt vmcnt(9) lgkmcnt(0)
    s_barrier
    v_mfma_f32_16x16x32_bf16 v[216:219], v[80:83], v[64:67], v[216:219]
    s_setprio 1
    ds_read_b64_tr_b16 v[72:73], v10 offset:0
    s_add_u32 m0, s29, 43776
    v_mfma_f32_16x16x32_bf16 v[216:219], v[76:79], v[48:51], v[216:219]
    s_setprio 0
    ds_read_b64_tr_b16 v[74:75], v10 offset:3584
    buffer_load_dwordx4 v6, s[16:19], s65 offen lds
    v_mfma_f32_16x16x32_bf16 v[212:215], v[76:79], v[44:47], v[212:215]
    s_setprio 1
    s_add_u32 s65, s65, 229376
    v_mfma_f32_16x16x32_bf16 v[212:215], v[80:83], v[60:63], v[212:215]
    s_setprio 0
    v_mfma_f32_16x16x32_bf16 v[208:211], v[80:83], v[56:59], v[208:211]
    s_setprio 1
    s_add_u32 m0, s29, 51072
    v_mfma_f32_16x16x32_bf16 v[208:211], v[76:79], v[40:43], v[208:211]
    s_setprio 0
    ds_read_b64_tr_b16 v[76:77], v10 offset:7296
    buffer_load_dwordx4 v6, s[16:19], s65 offen lds
    v_mfma_f32_16x16x32_bf16 v[240:243], v[84:87], v[40:43], v[240:243]
    s_setprio 1
    ds_read_b128 v[40:43], v94 offset:0
    ds_read_b64_tr_b16 v[78:79], v10 offset:10880
    s_add_u32 s65, s65, 229376
    v_mfma_f32_16x16x32_bf16 v[240:243], v[88:91], v[56:59], v[240:243]
    s_setprio 0
    ds_read_b128 v[56:59], v95 offset:0
    ds_read_b64_tr_b16 v[80:81], v10 offset:32
    v_mfma_f32_16x16x32_bf16 v[244:247], v[88:91], v[60:63], v[244:247]
    s_setprio 1
    ds_read_b128 v[60:63], v95 offset:2048
    ds_read_b64_tr_b16 v[82:83], v10 offset:3616
    v_mfma_f32_16x16x32_bf16 v[244:247], v[84:87], v[44:47], v[244:247]
    s_setprio 0
    ds_read_b128 v[44:47], v94 offset:2048
    v_mfma_f32_16x16x32_bf16 v[248:251], v[84:87], v[48:51], v[248:251]
    s_setprio 1
    ds_read_b128 v[48:51], v94 offset:4096
    v_mfma_f32_16x16x32_bf16 v[248:251], v[88:91], v[64:67], v[248:251]
    s_setprio 0
    ds_read_b128 v[64:67], v95 offset:4096
    v_mfma_f32_16x16x32_bf16 v[252:255], v[88:91], v[68:71], v[252:255]
    s_setprio 1
    ds_read_b128 v[68:71], v95 offset:6144
    v_mfma_f32_16x16x32_bf16 v[252:255], v[84:87], v[52:55], v[252:255]
    s_setprio 0
    ds_read_b128 v[52:55], v94 offset:6144
    ds_read_b64_tr_b16 v[84:85], v10 offset:7328
    s_waitcnt lgkmcnt(9)
    v_mfma_f32_16x16x32_bf16 v[128:131], v[72:75], v[40:43], v[128:131]
    s_setprio 1
    ds_read_b64_tr_b16 v[86:87], v10 offset:10912
    v_mfma_f32_16x16x32_bf16 v[128:131], v[76:79], v[56:59], v[128:131]
    s_setprio 0
    ds_read_b64_tr_b16 v[88:89], v10 offset:64
    s_waitcnt lgkmcnt(7)
    v_mfma_f32_16x16x32_bf16 v[132:135], v[76:79], v[60:63], v[132:135]
    s_setprio 1
    ds_read_b64_tr_b16 v[90:91], v10 offset:3648
    v_mfma_f32_16x16x32_bf16 v[132:135], v[72:75], v[44:47], v[132:135]
    s_setprio 0
    s_waitcnt lgkmcnt(6)
    v_mfma_f32_16x16x32_bf16 v[136:139], v[72:75], v[48:51], v[136:139]
    s_setprio 1
    v_mfma_f32_16x16x32_bf16 v[136:139], v[76:79], v[64:67], v[136:139]
    s_setprio 0
    s_waitcnt lgkmcnt(4)
    v_mfma_f32_16x16x32_bf16 v[140:143], v[76:79], v[68:71], v[140:143]
    s_setprio 1
    v_mfma_f32_16x16x32_bf16 v[140:143], v[72:75], v[52:55], v[140:143]
    s_setprio 0
    ds_read_b64_tr_b16 v[72:73], v10 offset:7360
    s_waitcnt lgkmcnt(3)
    v_mfma_f32_16x16x32_bf16 v[172:175], v[80:83], v[52:55], v[172:175]
    s_setprio 1
    ds_read_b64_tr_b16 v[74:75], v10 offset:10944
    v_mfma_f32_16x16x32_bf16 v[172:175], v[84:87], v[68:71], v[172:175]
    s_setprio 0
    ds_read_b64_tr_b16 v[76:77], v10 offset:96
    v_mfma_f32_16x16x32_bf16 v[168:171], v[84:87], v[64:67], v[168:171]
    s_setprio 1
    ds_read_b64_tr_b16 v[78:79], v10 offset:3680
    v_mfma_f32_16x16x32_bf16 v[168:171], v[80:83], v[48:51], v[168:171]
    s_setprio 0
    v_mfma_f32_16x16x32_bf16 v[16:19], v[28:31], v[80:83], v[16:19]
    v_mfma_f32_16x16x32_bf16 v[16:19], v[28:31], v[84:87], v[16:19]
    v_mfma_f32_16x16x32_bf16 v[164:167], v[80:83], v[44:47], v[164:167]
    s_setprio 1
    v_mfma_f32_16x16x32_bf16 v[164:167], v[84:87], v[60:63], v[164:167]
    s_setprio 0
    v_mfma_f32_16x16x32_bf16 v[160:163], v[84:87], v[56:59], v[160:163]
    s_setprio 1
    v_mfma_f32_16x16x32_bf16 v[160:163], v[80:83], v[40:43], v[160:163]
    s_setprio 0
    ds_read_b64_tr_b16 v[80:81], v10 offset:7392
    s_waitcnt lgkmcnt(3)
    v_mfma_f32_16x16x32_bf16 v[192:195], v[88:91], v[40:43], v[192:195]
    s_setprio 1
    ds_read_b64_tr_b16 v[82:83], v10 offset:10976
    v_mfma_f32_16x16x32_bf16 v[192:195], v[72:75], v[56:59], v[192:195]
    s_setprio 0
    s_waitcnt vmcnt(8) lgkmcnt(0)
    s_barrier
    v_mfma_f32_16x16x32_bf16 v[196:199], v[72:75], v[60:63], v[196:199]
    s_setprio 1
    ds_read_b64_tr_b16 v[84:85], v10 offset:14592
    s_add_u32 m0, s29, 0
    v_mfma_f32_16x16x32_bf16 v[196:199], v[88:91], v[44:47], v[196:199]
    s_setprio 0
    s_mov_b64 s[8:9], s[56:57]
    v_mov_b32 v124, 0
    ds_read_b64_tr_b16 v[86:87], v10 offset:18176
    buffer_load_dwordx4 v6, s[12:15], s65 offen lds
    v_mfma_f32_16x16x32_bf16 v[200:203], v[88:91], v[48:51], v[200:203]
    s_setprio 1
    s_add_u32 s65, s65, 229376
    v_mfma_f32_16x16x32_bf16 v[200:203], v[72:75], v[64:67], v[200:203]
    s_setprio 0
    v_mfma_f32_16x16x32_bf16 v[204:207], v[72:75], v[68:71], v[204:207]
    s_setprio 1
    s_add_u32 m0, s29, 7296
    v_mfma_f32_16x16x32_bf16 v[204:207], v[88:91], v[52:55], v[204:207]
    s_setprio 0
    v_mov_b32 v125, 0
    ds_read_b64_tr_b16 v[88:89], v10 offset:21888
    buffer_load_dwordx4 v6, s[12:15], s65 offen lds
    v_mfma_f32_16x16x32_bf16 v[236:239], v[76:79], v[52:55], v[236:239]
    s_setprio 1
    ds_read_b64_tr_b16 v[90:91], v10 offset:25472
    s_sub_u32 s65, s65, 229376
    v_mfma_f32_16x16x32_bf16 v[236:239], v[80:83], v[68:71], v[236:239]
    s_setprio 0
    ds_read_b64_tr_b16 v[72:73], v10 offset:14624
    v_mfma_f32_16x16x32_bf16 v[232:235], v[80:83], v[64:67], v[232:235]
    s_setprio 1
    ds_read_b64_tr_b16 v[74:75], v10 offset:18208
    v_mfma_f32_16x16x32_bf16 v[232:235], v[76:79], v[48:51], v[232:235]
    s_setprio 0
    v_mov_b32 v126, 0
    v_mfma_f32_16x16x32_bf16 v[228:231], v[76:79], v[44:47], v[228:231]
    s_setprio 1
    v_mfma_f32_16x16x32_bf16 v[228:231], v[80:83], v[60:63], v[228:231]
    s_setprio 0
    v_mfma_f32_16x16x32_bf16 v[224:227], v[80:83], v[56:59], v[224:227]
    s_setprio 1
    s_add_u32 m0, s28, 32768
    v_mfma_f32_16x16x32_bf16 v[224:227], v[76:79], v[40:43], v[224:227]
    s_setprio 0
    ds_read_b64_tr_b16 v[76:77], v10 offset:21920
    buffer_load_dwordx4 v4, s[8:11], s64 offen offset:0 sc1 lds
    s_waitcnt lgkmcnt(3)
    v_mfma_f32_16x16x32_bf16 v[144:147], v[84:87], v[40:43], v[144:147]
    s_setprio 1
    ds_read_b64_tr_b16 v[78:79], v10 offset:25504
    v_mfma_f32_16x16x32_bf16 v[144:147], v[88:91], v[56:59], v[144:147]
    s_setprio 0
    v_mov_b32 v127, 0
    ds_read_b64_tr_b16 v[80:81], v10 offset:14656
    v_mfma_f32_16x16x32_bf16 v[148:151], v[88:91], v[60:63], v[148:151]
    s_setprio 1
    ds_read_b64_tr_b16 v[82:83], v10 offset:18240
    s_add_u32 m0, s28, 32768
    v_mfma_f32_16x16x32_bf16 v[148:151], v[84:87], v[44:47], v[148:151]
    s_setprio 0
    buffer_load_dwordx4 v5, s[8:11], s64 offen offset:1024 sc1 lds
    v_mfma_f32_16x16x32_bf16 v[152:155], v[84:87], v[48:51], v[152:155]
    s_setprio 1
    v_mfma_f32_16x16x32_bf16 v[152:155], v[88:91], v[64:67], v[152:155]
    s_setprio 0
    v_mov_b32 v120, 0
    v_mfma_f32_16x16x32_bf16 v[156:159], v[88:91], v[68:71], v[156:159]
    s_setprio 1
    s_add_u32 m0, s28, 32768
    v_mfma_f32_16x16x32_bf16 v[156:159], v[84:87], v[52:55], v[156:159]
    s_setprio 0
    ds_read_b64_tr_b16 v[84:85], v10 offset:21952
    buffer_load_dwordx4 v4, s[8:11], s66 offen offset:2048 sc1 lds
    s_waitcnt lgkmcnt(3)
    v_mfma_f32_16x16x32_bf16 v[188:191], v[72:75], v[52:55], v[188:191]
    s_setprio 1
    ds_read_b64_tr_b16 v[86:87], v10 offset:25536
    v_mfma_f32_16x16x32_bf16 v[188:191], v[76:79], v[68:71], v[188:191]
    s_setprio 0
    ds_read_b64_tr_b16 v[88:89], v10 offset:14688
    v_mfma_f32_16x16x32_bf16 v[184:187], v[76:79], v[64:67], v[184:187]
    s_setprio 1
    ds_read_b64_tr_b16 v[90:91], v10 offset:18272
    s_add_u32 m0, s28, 32768
    v_mfma_f32_16x16x32_bf16 v[184:187], v[72:75], v[48:51], v[184:187]
    s_setprio 0
    v_mfma_f32_16x16x32_bf16 v[20:23], v[28:31], v[72:75], v[20:23]
    v_mfma_f32_16x16x32_bf16 v[20:23], v[28:31], v[76:79], v[20:23]
    v_mov_b32 v121, 0
    buffer_load_dwordx4 v5, s[8:11], s66 offen offset:3072 sc1 lds
    v_mfma_f32_16x16x32_bf16 v[180:183], v[72:75], v[44:47], v[180:183]
    s_setprio 1
    s_add_u32 s64, s64, 128
    s_bitset0_b32 s64, 11
    v_mfma_f32_16x16x32_bf16 v[180:183], v[76:79], v[60:63], v[180:183]
    s_setprio 0
    s_add_u32 s66, s64, 30720
    v_mfma_f32_16x16x32_bf16 v[176:179], v[76:79], v[56:59], v[176:179]
    s_setprio 1
    v_mfma_f32_16x16x32_bf16 v[176:179], v[72:75], v[40:43], v[176:179]
    s_setprio 0
    ds_read_b64_tr_b16 v[72:73], v10 offset:21984
    v_mov_b32 v122, 0
    s_waitcnt lgkmcnt(3)
    v_mfma_f32_16x16x32_bf16 v[208:211], v[80:83], v[40:43], v[208:211]
    s_setprio 1
    ds_read_b64_tr_b16 v[74:75], v10 offset:25568
    v_mfma_f32_16x16x32_bf16 v[208:211], v[84:87], v[56:59], v[208:211]
    s_setprio 0
    s_waitcnt vmcnt(8) lgkmcnt(0)
    s_barrier
    v_mfma_f32_16x16x32_bf16 v[212:215], v[84:87], v[60:63], v[212:215]
    s_setprio 1
    ds_read_b64_tr_b16 v[76:77], v10 offset:29184
    s_add_u32 m0, s29, 14592
    v_mfma_f32_16x16x32_bf16 v[212:215], v[80:83], v[44:47], v[212:215]
    s_setprio 0
    ds_read_b64_tr_b16 v[78:79], v10 offset:32768
    buffer_load_dwordx4 v6, s[16:19], s65 offen lds
    v_mfma_f32_16x16x32_bf16 v[216:219], v[80:83], v[48:51], v[216:219]
    s_setprio 1
    s_add_u32 s65, s65, 229376
    v_mfma_f32_16x16x32_bf16 v[216:219], v[84:87], v[64:67], v[216:219]
    s_setprio 0
    v_mov_b32 v123, 0
    v_mfma_f32_16x16x32_bf16 v[220:223], v[84:87], v[68:71], v[220:223]
    s_setprio 1
    s_add_u32 m0, s29, 21888
    v_mfma_f32_16x16x32_bf16 v[220:223], v[80:83], v[52:55], v[220:223]
    s_setprio 0
    ds_read_b64_tr_b16 v[80:81], v10 offset:36480
    buffer_load_dwordx4 v6, s[16:19], s65 offen lds
    v_mfma_f32_16x16x32_bf16 v[252:255], v[88:91], v[52:55], v[252:255]
    s_setprio 1
    ds_read_b128 v[52:55], v8 offset:6144
    ds_read_b64_tr_b16 v[82:83], v10 offset:40064
    s_add_u32 s65, s65, 229376
    v_mfma_f32_16x16x32_bf16 v[252:255], v[72:75], v[68:71], v[252:255]
    s_setprio 0
    ds_read_b128 v[68:71], v9 offset:6144
    ds_read_b64_tr_b16 v[84:85], v10 offset:29216
    v_mov_b32 v116, 0
    v_mfma_f32_16x16x32_bf16 v[248:251], v[72:75], v[64:67], v[248:251]
    s_setprio 1
    ds_read_b128 v[64:67], v9 offset:4096
    ds_read_b64_tr_b16 v[86:87], v10 offset:32800
    s_mov_b32 m0, 132096
    v_mfma_f32_16x16x32_bf16 v[248:251], v[88:91], v[48:51], v[248:251]
    s_setprio 0
    ds_read_b128 v[48:51], v8 offset:4096
    buffer_load_dwordx4 v35, s[76:79], s37 offen  lds
    v_mfma_f32_16x16x32_bf16 v[244:247], v[88:91], v[44:47], v[244:247]
    s_setprio 1
    ds_read_b128 v[44:47], v8 offset:2048
    s_add_u32 s37, s37, 196608
    v_mfma_f32_16x16x32_bf16 v[244:247], v[72:75], v[60:63], v[244:247]
    s_setprio 0
    ds_read_b128 v[60:63], v9 offset:2048
    v_mov_b32 v117, 0
    v_mfma_f32_16x16x32_bf16 v[240:243], v[72:75], v[56:59], v[240:243]
    s_setprio 1
    ds_read_b128 v[56:59], v9 offset:0
    v_mfma_f32_16x16x32_bf16 v[240:243], v[88:91], v[40:43], v[240:243]
    s_setprio 0
    ds_read_b128 v[40:43], v8 offset:0
    ds_read_b64_tr_b16 v[88:89], v10 offset:36512
    s_waitcnt lgkmcnt(9)
    v_mfma_f32_16x16x32_bf16 v[140:143], v[76:79], v[52:55], v[140:143]
    s_setprio 1
    ds_read_b64_tr_b16 v[90:91], v10 offset:40096
    v_mfma_f32_16x16x32_bf16 v[140:143], v[80:83], v[68:71], v[140:143]
    s_setprio 0
    ds_read_b64_tr_b16 v[72:73], v10 offset:29248
    s_waitcnt lgkmcnt(7)
    v_mfma_f32_16x16x32_bf16 v[136:139], v[80:83], v[64:67], v[136:139]
    s_setprio 1
    ds_read_b64_tr_b16 v[74:75], v10 offset:32832
    s_mov_b32 m0, 138240
    v_mfma_f32_16x16x32_bf16 v[136:139], v[76:79], v[48:51], v[136:139]
    s_setprio 0
    v_mov_b32 v118, 0
    buffer_load_dwordx4 v35, s[76:79], s37 offen  lds
    s_waitcnt lgkmcnt(6)
    v_mfma_f32_16x16x32_bf16 v[132:135], v[76:79], v[44:47], v[132:135]
    s_setprio 1
    s_add_u32 s37, s37, 196608
    v_mfma_f32_16x16x32_bf16 v[132:135], v[80:83], v[60:63], v[132:135]
    s_setprio 0
    s_waitcnt lgkmcnt(4)
    v_mfma_f32_16x16x32_bf16 v[128:131], v[80:83], v[56:59], v[128:131]
    s_setprio 1
    v_mfma_f32_16x16x32_bf16 v[128:131], v[76:79], v[40:43], v[128:131]
    s_setprio 0
    ds_read_b64_tr_b16 v[76:77], v10 offset:36544
    v_mov_b32 v119, 0
    s_waitcnt lgkmcnt(3)
    v_mfma_f32_16x16x32_bf16 v[160:163], v[84:87], v[40:43], v[160:163]
    s_setprio 1
    ds_read_b64_tr_b16 v[78:79], v10 offset:40128
    v_mfma_f32_16x16x32_bf16 v[160:163], v[88:91], v[56:59], v[160:163]
    s_setprio 0
    ds_read_b64_tr_b16 v[80:81], v10 offset:29280
    v_mfma_f32_16x16x32_bf16 v[164:167], v[88:91], v[60:63], v[164:167]
    s_setprio 1
    ds_read_b64_tr_b16 v[82:83], v10 offset:32864
    v_mfma_f32_16x16x32_bf16 v[164:167], v[84:87], v[44:47], v[164:167]
    s_setprio 0
    v_mfma_f32_16x16x32_bf16 v[16:19], v[28:31], v[84:87], v[16:19]
    v_mfma_f32_16x16x32_bf16 v[16:19], v[28:31], v[88:91], v[16:19]
    v_mfma_f32_16x16x32_bf16 v[168:171], v[84:87], v[48:51], v[168:171]
    s_setprio 1
    v_mfma_f32_16x16x32_bf16 v[168:171], v[88:91], v[64:67], v[168:171]
    s_setprio 0
    v_mov_b32 v112, 0
    v_mfma_f32_16x16x32_bf16 v[172:175], v[88:91], v[68:71], v[172:175]
    s_setprio 1
    v_mfma_f32_16x16x32_bf16 v[172:175], v[84:87], v[52:55], v[172:175]
    s_setprio 0
    ds_read_b64_tr_b16 v[84:85], v10 offset:36576
    s_waitcnt lgkmcnt(3)
    v_mfma_f32_16x16x32_bf16 v[204:207], v[72:75], v[52:55], v[204:207]
    s_setprio 1
    ds_read_b64_tr_b16 v[86:87], v10 offset:40160
    v_mfma_f32_16x16x32_bf16 v[204:207], v[76:79], v[68:71], v[204:207]
    s_setprio 0
    v_mov_b32 v113, 0
    s_waitcnt vmcnt(10) lgkmcnt(0)
    s_barrier
    v_mfma_f32_16x16x32_bf16 v[200:203], v[76:79], v[64:67], v[200:203]
    s_setprio 1
    ds_read_b64_tr_b16 v[88:89], v10 offset:43776
    s_add_u32 m0, s29, 29184
    v_mfma_f32_16x16x32_bf16 v[200:203], v[72:75], v[48:51], v[200:203]
    s_setprio 0
    ds_read_b64_tr_b16 v[90:91], v10 offset:47360
    buffer_load_dwordx4 v6, s[12:15], s65 offen lds
    ds_read_b64 v[36:37], v26 offset:0
    v_mfma_f32_16x16x32_bf16 v[196:199], v[72:75], v[44:47], v[196:199]
    s_setprio 1
    ds_read_b64 v[38:39], v26 offset:128
    s_add_u32 s65, s65, 229376
    v_mfma_f32_16x16x32_bf16 v[196:199], v[76:79], v[60:63], v[196:199]
    s_setprio 0
    ds_read_b64 v[12:13], v26 offset:256
    v_mfma_f32_16x16x32_bf16 v[192:195], v[76:79], v[56:59], v[192:195]
    s_setprio 1
    ds_read_b64 v[14:15], v26 offset:384
    s_add_u32 m0, s29, 36480
    v_mfma_f32_16x16x32_bf16 v[192:195], v[72:75], v[40:43], v[192:195]
    s_setprio 0
    v_mov_b32 v114, 0
    ds_read_b64_tr_b16 v[72:73], v10 offset:51072
    buffer_load_dwordx4 v6, s[12:15], s65 offen lds
    v_mfma_f32_16x16x32_bf16 v[224:227], v[80:83], v[40:43], v[224:227]
    s_setprio 1
    ds_read_b64_tr_b16 v[74:75], v10 offset:54656
    s_sub_u32 s65, s65, 229376
    v_mfma_f32_16x16x32_bf16 v[224:227], v[84:87], v[56:59], v[224:227]
    s_setprio 0
    ds_read_b64_tr_b16 v[76:77], v10 offset:43808
    v_mfma_f32_16x16x32_bf16 v[228:231], v[84:87], v[60:63], v[228:231]
    s_setprio 1
    ds_read_b64_tr_b16 v[78:79], v10 offset:47392
    v_mfma_f32_16x16x32_bf16 v[228:231], v[80:83], v[44:47], v[228:231]
    s_setprio 0
    v_mov_b32 v115, 0
    v_mfma_f32_16x16x32_bf16 v[232:235], v[80:83], v[48:51], v[232:235]
    s_setprio 1
    v_mfma_f32_16x16x32_bf16 v[232:235], v[84:87], v[64:67], v[232:235]
    s_setprio 0
    v_mfma_f32_16x16x32_bf16 v[236:239], v[84:87], v[68:71], v[236:239]
    s_setprio 1
    s_add_u32 m0, s28, 0
    v_mfma_f32_16x16x32_bf16 v[236:239], v[80:83], v[52:55], v[236:239]
    s_setprio 0
    ds_read_b64_tr_b16 v[80:81], v10 offset:51104
    buffer_load_dwordx4 v4, s[8:11], s64 offen offset:0 sc1 lds
    s_waitcnt lgkmcnt(3)
    v_mfma_f32_16x16x32_bf16 v[156:159], v[88:91], v[52:55], v[156:159]
    s_setprio 1
    ds_read_b64_tr_b16 v[82:83], v10 offset:54688
    v_mfma_f32_16x16x32_bf16 v[156:159], v[72:75], v[68:71], v[156:159]
    s_setprio 0
    ds_read_b64_tr_b16 v[84:85], v10 offset:43840
    v_mfma_f32_16x16x32_bf16 v[152:155], v[72:75], v[64:67], v[152:155]
    s_setprio 1
    ds_read_b64_tr_b16 v[86:87], v10 offset:47424
    s_add_u32 m0, s28, 0
    v_mfma_f32_16x16x32_bf16 v[152:155], v[88:91], v[48:51], v[152:155]
    s_setprio 0
    buffer_load_dwordx4 v5, s[8:11], s64 offen offset:1024 sc1 lds
    v_mul_f32 v140, v140, v15
    v_mul_f32 v141, v141, v15
    v_mul_f32 v142, v142, v15
    v_mfma_f32_16x16x32_bf16 v[148:151], v[88:91], v[44:47], v[148:151]
    s_setprio 1
    v_mfma_f32_16x16x32_bf16 v[148:151], v[72:75], v[60:63], v[148:151]
    s_setprio 0
    v_mul_f32 v143, v143, v15
    v_mul_f32 v136, v136, v13
    v_mul_f32 v137, v137, v13
    v_mul_f32 v138, v138, v13
    v_mfma_f32_16x16x32_bf16 v[144:147], v[72:75], v[56:59], v[144:147]
    s_setprio 1
    s_add_u32 m0, s28, 0
    v_mfma_f32_16x16x32_bf16 v[144:147], v[88:91], v[40:43], v[144:147]
    s_setprio 0
    v_mul_f32 v139, v139, v13
    v_mul_f32 v132, v132, v39
    v_mul_f32 v133, v133, v39
    ds_read_b64_tr_b16 v[88:89], v10 offset:51136
    buffer_load_dwordx4 v4, s[8:11], s66 offen offset:2048 sc1 lds
    v_mul_f32 v134, v134, v39
    v_mul_f32 v135, v135, v39
    s_waitcnt lgkmcnt(3)
    v_mfma_f32_16x16x32_bf16 v[176:179], v[76:79], v[40:43], v[176:179]
    s_setprio 1
    ds_read_b64_tr_b16 v[90:91], v10 offset:54720
    v_mfma_f32_16x16x32_bf16 v[176:179], v[80:83], v[56:59], v[176:179]
    s_setprio 0
    v_mul_f32 v128, v128, v37
    v_mul_f32 v129, v129, v37
    ds_read_b64_tr_b16 v[72:73], v10 offset:43872
    v_mul_f32 v130, v130, v37
    v_mul_f32 v131, v131, v37
    v_mfma_f32_16x16x32_bf16 v[180:183], v[80:83], v[60:63], v[180:183]
    s_setprio 1
    ds_read_b64_tr_b16 v[74:75], v10 offset:47456
    s_add_u32 m0, s28, 0
    v_mfma_f32_16x16x32_bf16 v[180:183], v[76:79], v[44:47], v[180:183]
    s_setprio 0
    v_mfma_f32_16x16x32_bf16 v[20:23], v[28:31], v[76:79], v[20:23]
    v_mfma_f32_16x16x32_bf16 v[20:23], v[28:31], v[80:83], v[20:23]
    v_mul_f32 v160, v160, v37
    v_mul_f32 v161, v161, v37
    v_mul_f32 v162, v162, v37
    buffer_load_dwordx4 v5, s[8:11], s66 offen offset:3072 sc1 lds
    v_mul_f32 v163, v163, v37
    v_mul_f32 v164, v164, v39
    v_mfma_f32_16x16x32_bf16 v[184:187], v[76:79], v[48:51], v[184:187]
    s_setprio 1
    s_add_u32 s64, s64, 128
    s_bitset0_b32 s64, 11
    v_mfma_f32_16x16x32_bf16 v[184:187], v[80:83], v[64:67], v[184:187]
    s_setprio 0
    s_add_u32 s66, s64, 30720
    v_mul_f32 v165, v165, v39
    v_mul_f32 v166, v166, v39
    v_mul_f32 v167, v167, v39
    v_mul_f32 v168, v168, v13
    v_mul_f32 v169, v169, v13
    v_mfma_f32_16x16x32_bf16 v[188:191], v[80:83], v[68:71], v[188:191]
    s_setprio 1
    v_mfma_f32_16x16x32_bf16 v[188:191], v[76:79], v[52:55], v[188:191]
    s_setprio 0
    v_mul_f32 v170, v170, v13
    v_mul_f32 v171, v171, v13
    ds_read_b64_tr_b16 v[76:77], v10 offset:51168
    v_mul_f32 v172, v172, v15
    v_mul_f32 v173, v173, v15
    s_waitcnt lgkmcnt(3)
    v_mfma_f32_16x16x32_bf16 v[220:223], v[84:87], v[52:55], v[220:223]
    s_setprio 1
    ds_read_b64_tr_b16 v[78:79], v10 offset:54752
    v_mfma_f32_16x16x32_bf16 v[220:223], v[88:91], v[68:71], v[220:223]
    s_setprio 0
    v_mul_f32 v174, v174, v15
    v_mul_f32 v175, v175, v15
    v_mul_f32 v204, v204, v15
    v_mul_f32 v205, v205, v15
    v_mul_f32 v206, v206, v15
    s_waitcnt vmcnt(10) lgkmcnt(0)
    s_barrier
    v_mfma_f32_16x16x32_bf16 v[216:219], v[88:91], v[64:67], v[216:219]
    s_setprio 1
    ds_read_b64_tr_b16 v[80:81], v10 offset:0
    s_add_u32 m0, s29, 43776
    v_mfma_f32_16x16x32_bf16 v[216:219], v[84:87], v[48:51], v[216:219]
    s_setprio 0
    v_mul_f32 v207, v207, v15
    v_mul_f32 v200, v200, v13
    ds_read_b64_tr_b16 v[82:83], v10 offset:3584
    buffer_load_dwordx4 v6, s[16:19], s65 offen lds
    v_mul_f32 v201, v201, v13
    v_mul_f32 v202, v202, v13
    v_mfma_f32_16x16x32_bf16 v[212:215], v[84:87], v[44:47], v[212:215]
    s_setprio 1
    s_add_u32 s65, s65, 229376
    v_mfma_f32_16x16x32_bf16 v[212:215], v[88:91], v[60:63], v[212:215]
    s_setprio 0
    v_mul_f32 v203, v203, v13
    v_mul_f32 v196, v196, v39
    v_mul_f32 v197, v197, v39
    v_mul_f32 v198, v198, v39
    v_mul_f32 v199, v199, v39
    v_mfma_f32_16x16x32_bf16 v[208:211], v[88:91], v[56:59], v[208:211]
    s_setprio 1
    s_add_u32 m0, s29, 51072
    v_mfma_f32_16x16x32_bf16 v[208:211], v[84:87], v[40:43], v[208:211]
    s_setprio 0
    v_mul_f32 v192, v192, v37
    v_mul_f32 v193, v193, v37
    ds_read_b64_tr_b16 v[84:85], v10 offset:7296
    buffer_load_dwordx4 v6, s[16:19], s65 offen lds
    v_mul_f32 v194, v194, v37
    v_mul_f32 v195, v195, v37
    v_mfma_f32_16x16x32_bf16 v[240:243], v[72:75], v[40:43], v[240:243]
    s_setprio 1
    ds_read_b128 v[40:43], v8 offset:32768
    ds_read_b64_tr_b16 v[86:87], v10 offset:10880
    s_add_u32 s65, s65, 229376
    v_mfma_f32_16x16x32_bf16 v[240:243], v[76:79], v[56:59], v[240:243]
    s_setprio 0
    v_mul_f32 v224, v224, v37
    v_mul_f32 v225, v225, v37
    v_mul_f32 v226, v226, v37
    ds_read_b128 v[56:59], v9 offset:32768
    ds_read_b64_tr_b16 v[88:89], v10 offset:32
    v_mul_f32 v227, v227, v37
    v_mul_f32 v228, v228, v39
    v_mfma_f32_16x16x32_bf16 v[244:247], v[76:79], v[60:63], v[244:247]
    s_setprio 1
    ds_read_b128 v[60:63], v9 offset:34816
    ds_read_b64_tr_b16 v[90:91], v10 offset:3616
    s_mov_b32 m0, 144384
    v_mfma_f32_16x16x32_bf16 v[244:247], v[72:75], v[44:47], v[244:247]
    s_setprio 0
    v_mul_f32 v229, v229, v39
    v_mul_f32 v230, v230, v39
    ds_read_b128 v[44:47], v8 offset:34816
    buffer_load_dwordx4 v35, s[76:79], s37 offen  lds
    v_mul_f32 v231, v231, v39
    v_mul_f32 v232, v232, v13
    v_mul_f32 v233, v233, v13
    v_mfma_f32_16x16x32_bf16 v[248:251], v[72:75], v[48:51], v[248:251]
    s_setprio 1
    ds_read_b128 v[48:51], v8 offset:36864
    s_add_u32 s37, s37, 196608
    v_mfma_f32_16x16x32_bf16 v[248:251], v[76:79], v[64:67], v[248:251]
    s_setprio 0
    v_mul_f32 v234, v234, v13
    v_mul_f32 v235, v235, v13
    ds_read_b128 v[64:67], v9 offset:36864
    v_mul_f32 v236, v236, v15
    v_mul_f32 v237, v237, v15
    v_mfma_f32_16x16x32_bf16 v[252:255], v[76:79], v[68:71], v[252:255]
    s_setprio 1
    ds_read_b128 v[68:71], v9 offset:38912
    v_mfma_f32_16x16x32_bf16 v[252:255], v[72:75], v[52:55], v[252:255]
    s_setprio 0
    v_mul_f32 v238, v238, v15
    v_mul_f32 v239, v239, v15
    ds_read_b128 v[52:55], v8 offset:38912
    ds_read_b64_tr_b16 v[72:73], v10 offset:7328
    s_waitcnt lgkmcnt(9)
    v_mfma_f32_16x16x32_bf16 v[128:131], v[80:83], v[40:43], v[128:131]
    s_setprio 1
    ds_read_b64_tr_b16 v[74:75], v10 offset:10912
    v_mfma_f32_16x16x32_bf16 v[128:131], v[84:87], v[56:59], v[128:131]
    s_setprio 0
    v_mul_f32 v156, v156, v15
    v_mul_f32 v157, v157, v15
    ds_read_b64_tr_b16 v[76:77], v10 offset:64
    v_mul_f32 v158, v158, v15
    v_mul_f32 v159, v159, v15
    s_waitcnt lgkmcnt(7)
    v_mfma_f32_16x16x32_bf16 v[132:135], v[84:87], v[60:63], v[132:135]
    s_setprio 1
    ds_read_b64_tr_b16 v[78:79], v10 offset:3648
    s_mov_b32 m0, 150528
    v_mfma_f32_16x16x32_bf16 v[132:135], v[80:83], v[44:47], v[132:135]
    s_setprio 0
    v_mul_f32 v152, v152, v13
    ds_write2_b32 v27, v16, v20 offset1:64
    buffer_load_dwordx4 v35, s[76:79], s37 offen  lds
    v_mul_f32 v153, v153, v13
    v_mul_f32 v154, v154, v13
    s_waitcnt lgkmcnt(7)
    v_mfma_f32_16x16x32_bf16 v[136:139], v[80:83], v[48:51], v[136:139]
    s_setprio 1
    s_add_u32 s37, s37, 196608
    v_mfma_f32_16x16x32_bf16 v[136:139], v[84:87], v[64:67], v[136:139]
    s_setprio 0
    v_mul_f32 v155, v155, v13
    v_mul_f32 v148, v148, v39
    v_mul_f32 v149, v149, v39
    s_waitcnt lgkmcnt(5)
    v_mfma_f32_16x16x32_bf16 v[140:143], v[84:87], v[68:71], v[140:143]
    s_setprio 1
    v_mfma_f32_16x16x32_bf16 v[140:143], v[80:83], v[52:55], v[140:143]
    s_setprio 0
    v_mul_f32 v150, v150, v39
    v_mul_f32 v151, v151, v39
    ds_read_b64_tr_b16 v[80:81], v10 offset:7360
    v_mul_f32 v144, v144, v37
    v_mul_f32 v145, v145, v37
    s_waitcnt lgkmcnt(4)
    v_mfma_f32_16x16x32_bf16 v[172:175], v[88:91], v[52:55], v[172:175]
    s_setprio 1
    ds_read_b64_tr_b16 v[82:83], v10 offset:10944
    v_mfma_f32_16x16x32_bf16 v[172:175], v[72:75], v[68:71], v[172:175]
    s_setprio 0
    v_mul_f32 v146, v146, v37
    ds_read_b64_tr_b16 v[84:85], v10 offset:96
    v_mul_f32 v147, v147, v37
    v_mul_f32 v176, v176, v37
    v_mfma_f32_16x16x32_bf16 v[168:171], v[72:75], v[64:67], v[168:171]
    s_setprio 1
    ds_read_b64_tr_b16 v[86:87], v10 offset:3680
    v_mfma_f32_16x16x32_bf16 v[168:171], v[88:91], v[48:51], v[168:171]
    s_setprio 0
    v_mul_f32 v177, v177, v37
    v_mul_f32 v178, v178, v37
    v_mul_f32 v179, v179, v37
    v_mfma_f32_16x16x32_bf16 v[164:167], v[88:91], v[44:47], v[164:167]
    s_setprio 1
    v_mfma_f32_16x16x32_bf16 v[164:167], v[72:75], v[60:63], v[164:167]
    s_setprio 0
    v_mul_f32 v180, v180, v39
    v_mul_f32 v181, v181, v39
    v_mul_f32 v182, v182, v39
    v_mfma_f32_16x16x32_bf16 v[160:163], v[72:75], v[56:59], v[160:163]
    s_setprio 1
    v_mfma_f32_16x16x32_bf16 v[160:163], v[88:91], v[40:43], v[160:163]
    s_setprio 0
    v_mul_f32 v183, v183, v39
    v_mul_f32 v184, v184, v13
    ds_read_b64_tr_b16 v[88:89], v10 offset:7392
    v_mul_f32 v185, v185, v13
    v_mul_f32 v186, v186, v13
    s_waitcnt lgkmcnt(3)
    v_mfma_f32_16x16x32_bf16 v[192:195], v[76:79], v[40:43], v[192:195]
    s_setprio 1
    ds_read_b64_tr_b16 v[90:91], v10 offset:10976
    v_mfma_f32_16x16x32_bf16 v[192:195], v[80:83], v[56:59], v[192:195]
    s_setprio 0
    v_mul_f32 v187, v187, v13
    v_mul_f32 v188, v188, v15
    v_mul_f32 v189, v189, v15
    s_waitcnt vmcnt(10) lgkmcnt(0)
    s_barrier
    v_mfma_f32_16x16x32_bf16 v[196:199], v[80:83], v[60:63], v[196:199]
    s_setprio 1
    ds_read_b64_tr_b16 v[28:29], v92 offset:32768
    s_add_u32 m0, s29, 0
    v_mfma_f32_16x16x32_bf16 v[196:199], v[76:79], v[44:47], v[196:199]
    s_setprio 0
    v_mul_f32 v190, v190, v15
    v_mul_f32 v191, v191, v15
    ds_read_b64_tr_b16 v[30:31], v92 offset:33792
    buffer_load_dwordx4 v6, s[12:15], s65 offen lds
    v_mul_f32 v220, v220, v15
    v_mfma_f32_16x16x32_bf16 v[200:203], v[76:79], v[48:51], v[200:203]
    s_setprio 1
    ds_read_b64_tr_b16 v[16:17], v92 offset:38912
    s_add_u32 s65, s65, 229376
    v_mfma_f32_16x16x32_bf16 v[200:203], v[80:83], v[64:67], v[200:203]
    s_setprio 0
    v_mul_f32 v221, v221, v15
    v_mul_f32 v222, v222, v15
    ds_read_b64_tr_b16 v[18:19], v92 offset:39936
    v_mul_f32 v223, v223, v15
    v_mul_f32 v216, v216, v13
    v_mfma_f32_16x16x32_bf16 v[204:207], v[80:83], v[68:71], v[204:207]
    s_setprio 1
    ds_read_b64_tr_b16 v[72:73], v32 offset:32768
    s_add_u32 m0, s29, 7296
    v_mfma_f32_16x16x32_bf16 v[204:207], v[76:79], v[52:55], v[204:207]
    s_setprio 0
    v_mul_f32 v217, v217, v13
    ds_read_b64_tr_b16 v[74:75], v32 offset:33792
    buffer_load_dwordx4 v6, s[12:15], s65 offen lds
    v_mul_f32 v218, v218, v13
    v_mul_f32 v219, v219, v13
    v_mfma_f32_16x16x32_bf16 v[236:239], v[84:87], v[52:55], v[236:239]
    s_setprio 1
    ds_read_b64_tr_b16 v[76:77], v32 offset:38912
    s_sub_u32 s65, s65, 229376
    v_mfma_f32_16x16x32_bf16 v[236:239], v[88:91], v[68:71], v[236:239]
    s_setprio 0
    v_mul_f32 v212, v212, v39
    v_mul_f32 v213, v213, v39
    ds_read_b64_tr_b16 v[78:79], v32 offset:39936
    v_mul_f32 v214, v214, v39
    v_mfma_f32_16x16x32_bf16 v[232:235], v[88:91], v[64:67], v[232:235]
    s_setprio 1
    v_mfma_f32_16x16x32_bf16 v[232:235], v[84:87], v[48:51], v[232:235]
    s_setprio 0
    v_mul_f32 v215, v215, v39
    v_mul_f32 v208, v208, v37
    v_mul_f32 v209, v209, v37
    v_mfma_f32_16x16x32_bf16 v[228:231], v[84:87], v[44:47], v[228:231]
    s_setprio 1
    ds_read_b64_tr_b16 v[80:81], v10 offset:14592
    v_mfma_f32_16x16x32_bf16 v[228:231], v[88:91], v[60:63], v[228:231]
    s_setprio 0
    v_mul_f32 v210, v210, v37
    v_mul_f32 v211, v211, v37
    ds_read_b64_tr_b16 v[82:83], v10 offset:18176
    v_mul_f32 v240, v240, v37
    v_mul_f32 v241, v241, v37
    v_mfma_f32_16x16x32_bf16 v[224:227], v[88:91], v[56:59], v[224:227]
    s_setprio 1
    v_mfma_f32_16x16x32_bf16 v[224:227], v[84:87], v[40:43], v[224:227]
    s_setprio 0
    v_mul_f32 v242, v242, v37
    v_mul_f32 v243, v243, v37
    v_mul_f32 v244, v244, v39
    s_waitcnt lgkmcnt(6)
    v_mfma_f32_16x16x32_bf16 v[96:99], v[28:31], v[40:43], 0
    s_setprio 1
    ds_read_b64_tr_b16 v[84:85], v10 offset:21888
    v_mfma_f32_16x16x32_bf16 v[96:99], v[16:19], v[56:59], v[96:99]
    s_setprio 0
    v_mul_f32 v245, v245, v39
    v_mul_f32 v246, v246, v39
    ds_read_b64_tr_b16 v[86:87], v10 offset:25472
    v_mul_f32 v247, v247, v39
    v_mfma_f32_16x16x32_bf16 v[100:103], v[16:19], v[60:63], 0
    s_setprio 1
    s_add_u32 m0, s28, 32768
    v_mfma_f32_16x16x32_bf16 v[100:103], v[28:31], v[44:47], v[100:103]
    s_setprio 0
    v_mul_f32 v248, v248, v13
    v_mul_f32 v249, v249, v13
    buffer_load_dwordx4 v4, s[8:11], s64 offen offset:0 sc1 lds
    v_mul_f32 v250, v250, v13
    v_mul_f32 v251, v251, v13
    v_mfma_f32_16x16x32_bf16 v[104:107], v[28:31], v[48:51], 0
    s_setprio 1
    ds_read_b64_tr_b16 v[88:89], v10 offset:14624
    v_mfma_f32_16x16x32_bf16 v[104:107], v[16:19], v[64:67], v[104:107]
    s_setprio 0
    v_mul_f32 v252, v252, v15
    ds_read_b64_tr_b16 v[90:91], v10 offset:18208
    v_mul_f32 v253, v253, v15
    v_mul_f32 v254, v254, v15
    v_mfma_f32_16x16x32_bf16 v[108:111], v[16:19], v[68:71], 0
    s_setprio 1
    v_mfma_f32_16x16x32_bf16 v[108:111], v[28:31], v[52:55], v[108:111]
    s_setprio 0
    v_mul_f32 v255, v255, v15
    s_nop 1
L_loop1:
    s_waitcnt lgkmcnt(6)
    v_mfma_f32_16x16x32_bf16 v[124:127], v[72:75], v[52:55], v[124:127]
    s_setprio 1
    ds_read_b64_tr_b16 v[28:29], v10 offset:21920
    v_mfma_f32_16x16x32_bf16 v[124:127], v[76:79], v[68:71], v[124:127]
    s_setprio 0
    ds_read_b64_tr_b16 v[30:31], v10 offset:25504
    v_mfma_f32_16x16x32_bf16 v[120:123], v[76:79], v[64:67], v[120:123]
    s_setprio 1
    s_add_u32 m0, s28, 32768
    v_mfma_f32_16x16x32_bf16 v[120:123], v[72:75], v[48:51], v[120:123]
    s_setprio 0
    buffer_load_dwordx4 v5, s[8:11], s64 offen offset:1024 sc1 lds
    v_mfma_f32_16x16x32_bf16 v[116:119], v[72:75], v[44:47], v[116:119]
    s_setprio 1
    v_mfma_f32_16x16x32_bf16 v[116:119], v[76:79], v[60:63], v[116:119]
    s_setprio 0
    v_mfma_f32_16x16x32_bf16 v[112:115], v[76:79], v[56:59], v[112:115]
    s_setprio 1
    v_mfma_f32_16x16x32_bf16 v[112:115], v[72:75], v[40:43], v[112:115]
    s_setprio 0
    ds_read_b64_tr_b16 v[72:73], v10 offset:14656
    s_waitcnt lgkmcnt(5)
    v_mfma_f32_16x16x32_bf16 v[144:147], v[80:83], v[40:43], v[144:147]
    s_setprio 1
    ds_read_b64_tr_b16 v[74:75], v10 offset:18240
    v_mfma_f32_16x16x32_bf16 v[144:147], v[84:87], v[56:59], v[144:147]
    s_setprio 0
    ds_read_b64_tr_b16 v[76:77], v10 offset:21952
    v_mfma_f32_16x16x32_bf16 v[148:151], v[84:87], v[60:63], v[148:151]
    s_setprio 1
    ds_read_b64_tr_b16 v[78:79], v10 offset:25536
    s_add_u32 m0, s28, 32768
    v_mfma_f32_16x16x32_bf16 v[148:151], v[80:83], v[44:47], v[148:151]
    s_setprio 0
    buffer_load_dwordx4 v4, s[8:11], s66 offen offset:2048 sc1 lds
    v_mfma_f32_16x16x32_bf16 v[152:155], v[80:83], v[48:51], v[152:155]
    s_setprio 1
    v_mfma_f32_16x16x32_bf16 v[152:155], v[84:87], v[64:67], v[152:155]
    s_setprio 0
    v_mfma_f32_16x16x32_bf16 v[156:159], v[84:87], v[68:71], v[156:159]
    s_setprio 1
    v_mfma_f32_16x16x32_bf16 v[156:159], v[80:83], v[52:55], v[156:159]
    s_setprio 0
    ds_read_b64_tr_b16 v[80:81], v10 offset:14688
    s_waitcnt lgkmcnt(5)
    v_mfma_f32_16x16x32_bf16 v[188:191], v[88:91], v[52:55], v[188:191]
    s_setprio 1
    ds_read_b64_tr_b16 v[82:83], v10 offset:18272
    v_mfma_f32_16x16x32_bf16 v[188:191], v[28:31], v[68:71], v[188:191]
    s_setprio 0
    ds_read_b64_tr_b16 v[84:85], v10 offset:21984
    v_mfma_f32_16x16x32_bf16 v[184:187], v[28:31], v[64:67], v[184:187]
    s_setprio 1
    ds_read_b64_tr_b16 v[86:87], v10 offset:25568
    s_add_u32 m0, s28, 32768
    v_mfma_f32_16x16x32_bf16 v[184:187], v[88:91], v[48:51], v[184:187]
    s_setprio 0
    buffer_load_dwordx4 v5, s[8:11], s66 offen offset:3072 sc1 lds
    v_mfma_f32_16x16x32_bf16 v[180:183], v[88:91], v[44:47], v[180:183]
    s_setprio 1
    s_add_u32 s64, s64, 128
    s_bitset0_b32 s64, 11
    v_mfma_f32_16x16x32_bf16 v[180:183], v[28:31], v[60:63], v[180:183]
    s_setprio 0
    s_add_u32 s66, s64, 30720
    s_waitcnt vmcnt(10) lgkmcnt(0)
    s_barrier
    v_mfma_f32_16x16x32_bf16 v[176:179], v[28:31], v[56:59], v[176:179]
    s_setprio 1
    ds_read_b128 v[12:15], v8 offset:6144
    s_add_u32 m0, s29, 14592
    v_mfma_f32_16x16x32_bf16 v[176:179], v[88:91], v[40:43], v[176:179]
    s_setprio 0
    ds_read_b64_tr_b16 v[88:89], v10 offset:29184
    buffer_load_dwordx4 v6, s[16:19], s65 offen lds
    v_mfma_f32_16x16x32_bf16 v[208:211], v[72:75], v[40:43], v[208:211]
    s_setprio 1
    ds_read_b64_tr_b16 v[90:91], v10 offset:32768
    s_add_u32 s65, s65, 229376
    v_mfma_f32_16x16x32_bf16 v[208:211], v[76:79], v[56:59], v[208:211]
    s_setprio 0
    ds_read_b64_tr_b16 v[28:29], v10 offset:36480
    v_mfma_f32_16x16x32_bf16 v[212:215], v[76:79], v[60:63], v[212:215]
    s_setprio 1
    ds_read_b64_tr_b16 v[30:31], v10 offset:40064
    v_mfma_f32_16x16x32_bf16 v[212:215], v[72:75], v[44:47], v[212:215]
    s_setprio 0
    ds_read_b128 v[36:39], v9 offset:6144
    v_mfma_f32_16x16x32_bf16 v[216:219], v[72:75], v[48:51], v[216:219]
    s_setprio 1
    ds_read_b64_tr_b16 v[16:17], v10 offset:29216
    v_mfma_f32_16x16x32_bf16 v[216:219], v[76:79], v[64:67], v[216:219]
    s_setprio 0
    ds_read_b64_tr_b16 v[18:19], v10 offset:32800
    v_mfma_f32_16x16x32_bf16 v[220:223], v[76:79], v[68:71], v[220:223]
    s_setprio 1
    s_add_u32 m0, s29, 21888
    v_mfma_f32_16x16x32_bf16 v[220:223], v[72:75], v[52:55], v[220:223]
    s_setprio 0
    buffer_load_dwordx4 v6, s[16:19], s65 offen lds
    v_mfma_f32_16x16x32_bf16 v[252:255], v[80:83], v[52:55], v[252:255]
    s_setprio 1
    ds_read_b128 v[52:55], v9 offset:4096
    ds_read_b64_tr_b16 v[72:73], v10 offset:36512
    s_add_u32 s65, s65, 229376
    v_mfma_f32_16x16x32_bf16 v[252:255], v[84:87], v[68:71], v[252:255]
    s_setprio 0
    ds_read_b128 v[68:71], v8 offset:4096
    ds_read_b64_tr_b16 v[74:75], v10 offset:40096
    v_mfma_f32_16x16x32_bf16 v[248:251], v[84:87], v[64:67], v[248:251]
    s_setprio 1
    ds_read_b128 v[64:67], v8 offset:2048
    v_mfma_f32_16x16x32_bf16 v[248:251], v[80:83], v[48:51], v[248:251]
    s_setprio 0
    ds_read_b128 v[48:51], v9 offset:2048
    v_mfma_f32_16x16x32_bf16 v[244:247], v[80:83], v[44:47], v[244:247]
    s_setprio 1
    ds_read_b128 v[44:47], v9 offset:0
    ds_read_b64_tr_b16 v[76:77], v10 offset:29248
    v_mfma_f32_16x16x32_bf16 v[244:247], v[84:87], v[60:63], v[244:247]
    s_setprio 0
    ds_read_b128 v[60:63], v8 offset:0
    ds_read_b64_tr_b16 v[78:79], v10 offset:32832
    v_mfma_f32_16x16x32_bf16 v[240:243], v[84:87], v[56:59], v[240:243]
    s_setprio 1
    s_mov_b32 m0, 132096
    v_mfma_f32_16x16x32_bf16 v[240:243], v[80:83], v[40:43], v[240:243]
    s_setprio 0
    buffer_load_dwordx4 v35, s[76:79], s37 offen  lds
    s_add_u32 s37, s37, 196608
    s_waitcnt lgkmcnt(12)
    v_mfma_f32_16x16x32_bf16 v[140:143], v[88:91], v[12:15], v[140:143]
    s_setprio 1
    ds_read_b64_tr_b16 v[80:81], v10 offset:36544
    v_mfma_f32_16x16x32_bf16 v[140:143], v[28:31], v[36:39], v[140:143]
    s_setprio 0
    ds_read_b64_tr_b16 v[82:83], v10 offset:40128
    s_waitcnt lgkmcnt(9)
    v_mfma_f32_16x16x32_bf16 v[136:139], v[28:31], v[52:55], v[136:139]
    s_setprio 1
    v_mfma_f32_16x16x32_bf16 v[136:139], v[88:91], v[68:71], v[136:139]
    s_setprio 0
    s_waitcnt lgkmcnt(6)
    v_mfma_f32_16x16x32_bf16 v[132:135], v[88:91], v[64:67], v[132:135]
    s_setprio 1
    ds_read_b64_tr_b16 v[84:85], v10 offset:29280
    v_mfma_f32_16x16x32_bf16 v[132:135], v[28:31], v[48:51], v[132:135]
    s_setprio 0
    ds_read_b64_tr_b16 v[86:87], v10 offset:32864
    s_waitcnt lgkmcnt(5)
    v_mfma_f32_16x16x32_bf16 v[128:131], v[28:31], v[44:47], v[128:131]
    s_setprio 1
    s_mov_b32 m0, 138240
    v_mfma_f32_16x16x32_bf16 v[128:131], v[88:91], v[60:63], v[128:131]
    s_setprio 0
    buffer_load_dwordx4 v35, s[76:79], s37 offen  lds
    v_mfma_f32_16x16x32_bf16 v[160:163], v[16:19], v[60:63], v[160:163]
    s_setprio 1
    ds_read_b64_tr_b16 v[88:89], v10 offset:36576
    s_add_u32 s37, s37, 196608
    v_mfma_f32_16x16x32_bf16 v[160:163], v[72:75], v[44:47], v[160:163]
    s_setprio 0
    ds_read_b64_tr_b16 v[90:91], v10 offset:40160
    v_mfma_f32_16x16x32_bf16 v[164:167], v[72:75], v[48:51], v[164:167]
    s_setprio 1
    v_mfma_f32_16x16x32_bf16 v[164:167], v[16:19], v[64:67], v[164:167]
    s_setprio 0
    v_mfma_f32_16x16x32_bf16 v[168:171], v[16:19], v[68:71], v[168:171]
    s_setprio 1
    v_mfma_f32_16x16x32_bf16 v[168:171], v[72:75], v[52:55], v[168:171]
    s_setprio 0
    s_waitcnt vmcnt(10) lgkmcnt(0)
    s_barrier
    v_mfma_f32_16x16x32_bf16 v[172:175], v[72:75], v[36:39], v[172:175]
    s_setprio 1
    ds_read_b64_tr_b16 v[28:29], v92 offset:45056
    s_add_u32 m0, s29, 29184
    v_mfma_f32_16x16x32_bf16 v[172:175], v[16:19], v[12:15], v[172:175]
    s_setprio 0
    ds_read_b64_tr_b16 v[30:31], v92 offset:46080
    buffer_load_dwordx4 v6, s[12:15], s65 offen lds
    v_mfma_f32_16x16x32_bf16 v[204:207], v[76:79], v[12:15], v[204:207]
    s_setprio 1
    ds_read_b64_tr_b16 v[16:17], v92 offset:51200
    s_add_u32 s65, s65, 229376
    v_mfma_f32_16x16x32_bf16 v[204:207], v[80:83], v[36:39], v[204:207]
    s_setprio 0
    ds_read_b64_tr_b16 v[18:19], v92 offset:52224
    v_mfma_f32_16x16x32_bf16 v[200:203], v[80:83], v[52:55], v[200:203]
    s_setprio 1
    v_mfma_f32_16x16x32_bf16 v[200:203], v[76:79], v[68:71], v[200:203]
    s_setprio 0
    v_mfma_f32_16x16x32_bf16 v[196:199], v[76:79], v[64:67], v[196:199]
    s_setprio 1
    ds_read_b64_tr_b16 v[72:73], v32 offset:45056
    v_mfma_f32_16x16x32_bf16 v[196:199], v[80:83], v[48:51], v[196:199]
    s_setprio 0
    ds_read_b64_tr_b16 v[74:75], v32 offset:46080
    v_mfma_f32_16x16x32_bf16 v[192:195], v[80:83], v[44:47], v[192:195]
    s_setprio 1
    s_add_u32 m0, s29, 36480
    v_mfma_f32_16x16x32_bf16 v[192:195], v[76:79], v[60:63], v[192:195]
    s_setprio 0
    buffer_load_dwordx4 v6, s[12:15], s65 offen lds
    v_mfma_f32_16x16x32_bf16 v[224:227], v[84:87], v[60:63], v[224:227]
    s_setprio 1
    ds_read_b64_tr_b16 v[76:77], v32 offset:51200
    s_sub_u32 s65, s65, 229376
    v_mfma_f32_16x16x32_bf16 v[224:227], v[88:91], v[44:47], v[224:227]
    s_setprio 0
    ds_read_b64_tr_b16 v[78:79], v32 offset:52224
    v_mfma_f32_16x16x32_bf16 v[228:231], v[88:91], v[48:51], v[228:231]
    s_setprio 1
    v_mfma_f32_16x16x32_bf16 v[228:231], v[84:87], v[64:67], v[228:231]
    s_setprio 0
    v_mfma_f32_16x16x32_bf16 v[232:235], v[84:87], v[68:71], v[232:235]
    s_setprio 1
    ds_read_b64_tr_b16 v[80:81], v10 offset:43776
    v_mfma_f32_16x16x32_bf16 v[232:235], v[88:91], v[52:55], v[232:235]
    s_setprio 0
    ds_read_b64_tr_b16 v[82:83], v10 offset:47360
    v_mfma_f32_16x16x32_bf16 v[236:239], v[88:91], v[36:39], v[236:239]
    s_setprio 1
    v_mfma_f32_16x16x32_bf16 v[236:239], v[84:87], v[12:15], v[236:239]
    s_setprio 0
    s_waitcnt lgkmcnt(6)
    v_mfma_f32_16x16x32_bf16 v[108:111], v[28:31], v[12:15], v[108:111]
    s_setprio 1
    ds_read_b64_tr_b16 v[84:85], v10 offset:51072
    v_mfma_f32_16x16x32_bf16 v[108:111], v[16:19], v[36:39], v[108:111]
    s_setprio 0
    ds_read_b64_tr_b16 v[86:87], v10 offset:54656
    v_mfma_f32_16x16x32_bf16 v[104:107], v[16:19], v[52:55], v[104:107]
    s_setprio 1
    s_add_u32 m0, s28, 0
    v_mfma_f32_16x16x32_bf16 v[104:107], v[28:31], v[68:71], v[104:107]
    s_setprio 0
    buffer_load_dwordx4 v4, s[8:11], s64 offen offset:0 sc1 lds
    v_mfma_f32_16x16x32_bf16 v[100:103], v[28:31], v[64:67], v[100:103]
    s_setprio 1
    ds_read_b64_tr_b16 v[88:89], v10 offset:43808
    v_mfma_f32_16x16x32_bf16 v[100:103], v[16:19], v[48:51], v[100:103]
    s_setprio 0
    ds_read_b64_tr_b16 v[90:91], v10 offset:47392
    v_mfma_f32_16x16x32_bf16 v[96:99], v[16:19], v[44:47], v[96:99]
    s_setprio 1
    v_mfma_f32_16x16x32_bf16 v[96:99], v[28:31], v[60:63], v[96:99]
    s_setprio 0
    s_waitcnt lgkmcnt(6)
    v_mfma_f32_16x16x32_bf16 v[112:115], v[72:75], v[60:63], v[112:115]
    s_setprio 1
    ds_read_b64_tr_b16 v[28:29], v10 offset:51104
    v_mfma_f32_16x16x32_bf16 v[112:115], v[76:79], v[44:47], v[112:115]
    s_setprio 0
    ds_read_b64_tr_b16 v[30:31], v10 offset:54688
    v_mfma_f32_16x16x32_bf16 v[116:119], v[76:79], v[48:51], v[116:119]
    s_setprio 1
    s_add_u32 m0, s28, 0
    v_mfma_f32_16x16x32_bf16 v[116:119], v[72:75], v[64:67], v[116:119]
    s_setprio 0
    buffer_load_dwordx4 v5, s[8:11], s64 offen offset:1024 sc1 lds
    v_mfma_f32_16x16x32_bf16 v[120:123], v[72:75], v[68:71], v[120:123]
    s_setprio 1
    v_mfma_f32_16x16x32_bf16 v[120:123], v[76:79], v[52:55], v[120:123]
    s_setprio 0
    v_mfma_f32_16x16x32_bf16 v[124:127], v[76:79], v[36:39], v[124:127]
    s_setprio 1
    v_mfma_f32_16x16x32_bf16 v[124:127], v[72:75], v[12:15], v[124:127]
    s_setprio 0
    ds_read_b64_tr_b16 v[72:73], v10 offset:43840
    s_waitcnt lgkmcnt(5)
    v_mfma_f32_16x16x32_bf16 v[156:159], v[80:83], v[12:15], v[156:159]
    s_setprio 1
    ds_read_b64_tr_b16 v[74:75], v10 offset:47424
    v_mfma_f32_16x16x32_bf16 v[156:159], v[84:87], v[36:39], v[156:159]
    s_setprio 0
    ds_read_b64_tr_b16 v[76:77], v10 offset:51136
    v_mfma_f32_16x16x32_bf16 v[152:155], v[84:87], v[52:55], v[152:155]
    s_setprio 1
    ds_read_b64_tr_b16 v[78:79], v10 offset:54720
    s_add_u32 m0, s28, 0
    v_mfma_f32_16x16x32_bf16 v[152:155], v[80:83], v[68:71], v[152:155]
    s_setprio 0
    buffer_load_dwordx4 v4, s[8:11], s66 offen offset:2048 sc1 lds
    v_mfma_f32_16x16x32_bf16 v[148:151], v[80:83], v[64:67], v[148:151]
    s_setprio 1
    v_mfma_f32_16x16x32_bf16 v[148:151], v[84:87], v[48:51], v[148:151]
    s_setprio 0
    v_mfma_f32_16x16x32_bf16 v[144:147], v[84:87], v[44:47], v[144:147]
    s_setprio 1
    v_mfma_f32_16x16x32_bf16 v[144:147], v[80:83], v[60:63], v[144:147]
    s_setprio 0
    ds_read_b64_tr_b16 v[80:81], v10 offset:43872
    s_waitcnt lgkmcnt(5)
    v_mfma_f32_16x16x32_bf16 v[176:179], v[88:91], v[60:63], v[176:179]
    s_setprio 1
    ds_read_b64_tr_b16 v[82:83], v10 offset:47456
    v_mfma_f32_16x16x32_bf16 v[176:179], v[28:31], v[44:47], v[176:179]
    s_setprio 0
    ds_read_b64_tr_b16 v[84:85], v10 offset:51168
    v_mfma_f32_16x16x32_bf16 v[180:183], v[28:31], v[48:51], v[180:183]
    s_setprio 1
    ds_read_b64_tr_b16 v[86:87], v10 offset:54752
    s_add_u32 m0, s28, 0
    v_mfma_f32_16x16x32_bf16 v[180:183], v[88:91], v[64:67], v[180:183]
    s_setprio 0
    buffer_load_dwordx4 v5, s[8:11], s66 offen offset:3072 sc1 lds
    v_mfma_f32_16x16x32_bf16 v[184:187], v[88:91], v[68:71], v[184:187]
    s_setprio 1
    s_add_u32 s64, s64, 128
    s_bitset0_b32 s64, 11
    v_mfma_f32_16x16x32_bf16 v[184:187], v[28:31], v[52:55], v[184:187]
    s_setprio 0
    s_add_u32 s66, s64, 30720
    s_waitcnt vmcnt(10) lgkmcnt(0)
    s_barrier
    v_mfma_f32_16x16x32_bf16 v[188:191], v[28:31], v[36:39], v[188:191]
    s_setprio 1
    ds_read_b128 v[40:43], v8 offset:32768
    s_add_u32 m0, s29, 43776
    v_mfma_f32_16x16x32_bf16 v[188:191], v[88:91], v[12:15], v[188:191]
    s_setprio 0
    ds_read_b64_tr_b16 v[88:89], v10 offset:0
    buffer_load_dwordx4 v6, s[16:19], s65 offen lds
    v_mfma_f32_16x16x32_bf16 v[220:223], v[72:75], v[12:15], v[220:223]
    s_setprio 1
    ds_read_b64_tr_b16 v[90:91], v10 offset:3584
    s_add_u32 s65, s65, 229376
    v_mfma_f32_16x16x32_bf16 v[220:223], v[76:79], v[36:39], v[220:223]
    s_setprio 0
    ds_read_b64_tr_b16 v[28:29], v10 offset:7296
    v_mfma_f32_16x16x32_bf16 v[216:219], v[76:79], v[52:55], v[216:219]
    s_setprio 1
    ds_read_b64_tr_b16 v[30:31], v10 offset:10880
    v_mfma_f32_16x16x32_bf16 v[216:219], v[72:75], v[68:71], v[216:219]
    s_setprio 0
    ds_read_b128 v[56:59], v9 offset:32768
    v_mfma_f32_16x16x32_bf16 v[212:215], v[72:75], v[64:67], v[212:215]
    s_setprio 1
    ds_read_b64_tr_b16 v[16:17], v10 offset:32
    v_mfma_f32_16x16x32_bf16 v[212:215], v[76:79], v[48:51], v[212:215]
    s_setprio 0
    ds_read_b64_tr_b16 v[18:19], v10 offset:3616
    v_mfma_f32_16x16x32_bf16 v[208:211], v[76:79], v[44:47], v[208:211]
    s_setprio 1
    s_add_u32 m0, s29, 51072
    v_mfma_f32_16x16x32_bf16 v[208:211], v[72:75], v[60:63], v[208:211]
    s_setprio 0
    buffer_load_dwordx4 v6, s[16:19], s65 offen lds
    v_mfma_f32_16x16x32_bf16 v[240:243], v[80:83], v[60:63], v[240:243]
    s_setprio 1
    ds_read_b128 v[60:63], v9 offset:34816
    ds_read_b64_tr_b16 v[72:73], v10 offset:7328
    s_add_u32 s65, s65, 229376
    v_mfma_f32_16x16x32_bf16 v[240:243], v[84:87], v[44:47], v[240:243]
    s_setprio 0
    ds_read_b128 v[44:47], v8 offset:34816
    ds_read_b64_tr_b16 v[74:75], v10 offset:10912
    v_mfma_f32_16x16x32_bf16 v[244:247], v[84:87], v[48:51], v[244:247]
    s_setprio 1
    ds_read_b128 v[48:51], v8 offset:36864
    v_mfma_f32_16x16x32_bf16 v[244:247], v[80:83], v[64:67], v[244:247]
    s_setprio 0
    ds_read_b128 v[64:67], v9 offset:36864
    v_mfma_f32_16x16x32_bf16 v[248:251], v[80:83], v[68:71], v[248:251]
    s_setprio 1
    ds_read_b128 v[68:71], v9 offset:38912
    ds_read_b64_tr_b16 v[76:77], v10 offset:64
    v_mfma_f32_16x16x32_bf16 v[248:251], v[84:87], v[52:55], v[248:251]
    s_setprio 0
    ds_read_b128 v[52:55], v8 offset:38912
    ds_read_b64_tr_b16 v[78:79], v10 offset:3648
    v_mfma_f32_16x16x32_bf16 v[252:255], v[84:87], v[36:39], v[252:255]
    s_setprio 1
    s_mov_b32 m0, 144384
    v_mfma_f32_16x16x32_bf16 v[252:255], v[80:83], v[12:15], v[252:255]
    s_setprio 0
    buffer_load_dwordx4 v35, s[76:79], s37 offen  lds
    s_add_u32 s37, s37, 196608
    s_waitcnt lgkmcnt(12)
    v_mfma_f32_16x16x32_bf16 v[128:131], v[88:91], v[40:43], v[128:131]
    s_setprio 1
    ds_read_b64_tr_b16 v[80:81], v10 offset:7360
    v_mfma_f32_16x16x32_bf16 v[128:131], v[28:31], v[56:59], v[128:131]
    s_setprio 0
    ds_read_b64_tr_b16 v[82:83], v10 offset:10944
    s_waitcnt lgkmcnt(9)
    v_mfma_f32_16x16x32_bf16 v[132:135], v[28:31], v[60:63], v[132:135]
    s_setprio 1
    v_mfma_f32_16x16x32_bf16 v[132:135], v[88:91], v[44:47], v[132:135]
    s_setprio 0
    s_bitcmp1_b32 0x10, s36
    s_cbranch_scc1 L_h1p3_2
L_r1p3_2:
    s_waitcnt lgkmcnt(6)
    v_mfma_f32_16x16x32_bf16 v[136:139], v[88:91], v[48:51], v[136:139]
    s_setprio 1
    ds_read_b64_tr_b16 v[84:85], v10 offset:96
    v_mfma_f32_16x16x32_bf16 v[136:139], v[28:31], v[64:67], v[136:139]
    s_setprio 0
    ds_read_b64_tr_b16 v[86:87], v10 offset:3680
    s_waitcnt lgkmcnt(5)
    v_mfma_f32_16x16x32_bf16 v[140:143], v[28:31], v[68:71], v[140:143]
    s_setprio 1
    s_mov_b32 m0, 150528
    v_mfma_f32_16x16x32_bf16 v[140:143], v[88:91], v[52:55], v[140:143]
    s_setprio 0
    buffer_load_dwordx4 v35, s[76:79], s37 offen  lds
    v_mfma_f32_16x16x32_bf16 v[172:175], v[16:19], v[52:55], v[172:175]
    s_setprio 1
    ds_read_b64_tr_b16 v[88:89], v10 offset:7392
    s_add_u32 s37, s37, 196608
    v_mfma_f32_16x16x32_bf16 v[172:175], v[72:75], v[68:71], v[172:175]
    s_setprio 0
    ds_read_b64_tr_b16 v[90:91], v10 offset:10976
    v_mfma_f32_16x16x32_bf16 v[168:171], v[72:75], v[64:67], v[168:171]
    s_setprio 1
    v_mfma_f32_16x16x32_bf16 v[168:171], v[16:19], v[48:51], v[168:171]
    s_setprio 0
    v_mfma_f32_16x16x32_bf16 v[164:167], v[16:19], v[44:47], v[164:167]
    s_setprio 1
    v_mfma_f32_16x16x32_bf16 v[164:167], v[72:75], v[60:63], v[164:167]
    s_setprio 0
    s_waitcnt vmcnt(10) lgkmcnt(0)
    s_barrier
    v_mfma_f32_16x16x32_bf16 v[160:163], v[72:75], v[56:59], v[160:163]
    s_setprio 1
    ds_read_b64_tr_b16 v[28:29], v92 offset:32768
    s_add_u32 m0, s29, 0
    v_mfma_f32_16x16x32_bf16 v[160:163], v[16:19], v[40:43], v[160:163]
    s_setprio 0
    ds_read_b64_tr_b16 v[30:31], v92 offset:33792
    buffer_load_dwordx4 v6, s[12:15], s65 offen lds
    v_mfma_f32_16x16x32_bf16 v[192:195], v[76:79], v[40:43], v[192:195]
    s_setprio 1
    ds_read_b64_tr_b16 v[16:17], v92 offset:38912
    s_add_u32 s65, s65, 229376
    v_mfma_f32_16x16x32_bf16 v[192:195], v[80:83], v[56:59], v[192:195]
    s_setprio 0
    ds_read_b64_tr_b16 v[18:19], v92 offset:39936
    v_mfma_f32_16x16x32_bf16 v[196:199], v[80:83], v[60:63], v[196:199]
    s_setprio 1
    v_mfma_f32_16x16x32_bf16 v[196:199], v[76:79], v[44:47], v[196:199]
    s_setprio 0
    v_mfma_f32_16x16x32_bf16 v[200:203], v[76:79], v[48:51], v[200:203]
    s_setprio 1
    ds_read_b64_tr_b16 v[72:73], v32 offset:32768
    v_mfma_f32_16x16x32_bf16 v[200:203], v[80:83], v[64:67], v[200:203]
    s_setprio 0
    ds_read_b64_tr_b16 v[74:75], v32 offset:33792
    v_mfma_f32_16x16x32_bf16 v[204:207], v[80:83], v[68:71], v[204:207]
    s_setprio 1
    s_add_u32 m0, s29, 7296
    v_mfma_f32_16x16x32_bf16 v[204:207], v[76:79], v[52:55], v[204:207]
    s_setprio 0
    buffer_load_dwordx4 v6, s[12:15], s65 offen lds
    v_mfma_f32_16x16x32_bf16 v[236:239], v[84:87], v[52:55], v[236:239]
    s_setprio 1
    ds_read_b64_tr_b16 v[76:77], v32 offset:38912
    s_sub_u32 s65, s65, 229376
    v_mfma_f32_16x16x32_bf16 v[236:239], v[88:91], v[68:71], v[236:239]
    s_setprio 0
    ds_read_b64_tr_b16 v[78:79], v32 offset:39936
    v_mfma_f32_16x16x32_bf16 v[232:235], v[88:91], v[64:67], v[232:235]
    s_setprio 1
    v_mfma_f32_16x16x32_bf16 v[232:235], v[84:87], v[48:51], v[232:235]
    s_setprio 0
    v_mfma_f32_16x16x32_bf16 v[228:231], v[84:87], v[44:47], v[228:231]
    s_setprio 1
    ds_read_b64_tr_b16 v[80:81], v10 offset:14592
    v_mfma_f32_16x16x32_bf16 v[228:231], v[88:91], v[60:63], v[228:231]
    s_setprio 0
    ds_read_b64_tr_b16 v[82:83], v10 offset:18176
    v_mfma_f32_16x16x32_bf16 v[224:227], v[88:91], v[56:59], v[224:227]
    s_setprio 1
    v_mfma_f32_16x16x32_bf16 v[224:227], v[84:87], v[40:43], v[224:227]
    s_setprio 0
    s_waitcnt lgkmcnt(6)
    v_mfma_f32_16x16x32_bf16 v[96:99], v[28:31], v[40:43], v[96:99]
    s_setprio 1
    ds_read_b64_tr_b16 v[84:85], v10 offset:21888
    v_mfma_f32_16x16x32_bf16 v[96:99], v[16:19], v[56:59], v[96:99]
    s_setprio 0
    ds_read_b64_tr_b16 v[86:87], v10 offset:25472
    v_mfma_f32_16x16x32_bf16 v[100:103], v[16:19], v[60:63], v[100:103]
    s_setprio 1
    s_add_u32 m0, s28, 32768
    v_mfma_f32_16x16x32_bf16 v[100:103], v[28:31], v[44:47], v[100:103]
    s_setprio 0
    buffer_load_dwordx4 v4, s[8:11], s64 offen offset:0 sc1 lds
    v_mfma_f32_16x16x32_bf16 v[104:107], v[28:31], v[48:51], v[104:107]
    s_setprio 1
    ds_read_b64_tr_b16 v[88:89], v10 offset:14624
    v_mfma_f32_16x16x32_bf16 v[104:107], v[16:19], v[64:67], v[104:107]
    s_setprio 0
    ds_read_b64_tr_b16 v[90:91], v10 offset:18208
    v_mfma_f32_16x16x32_bf16 v[108:111], v[16:19], v[68:71], v[108:111]
    s_setprio 1
    v_mfma_f32_16x16x32_bf16 v[108:111], v[28:31], v[52:55], v[108:111]
    s_setprio 0
    s_add_u32 s36, s36, 1
    s_cmp_lt_u32 s36, 5
    s_cbranch_scc1 L_loop1
    s_mov_b32 s80, 813056
    s_mov_b32 s81, 790528
    s_mov_b32 s82, 815104
    s_mov_b32 s29, 101376
    s_mov_b32 s37, 24576
    s_mov_b32 s83, 132096
    s_branch L_pb0
L_w2:
    s_barrier
    s_add_u32 m0, s28, 0
    s_nop 0
    buffer_load_dwordx4 v4, s[8:11], s64 offen offset:0 sc1 lds
    buffer_load_dwordx4 v5, s[8:11], s64 offen offset:1024 sc1 lds
    buffer_load_dwordx4 v4, s[8:11], s66 offen offset:2048 sc1 lds
    buffer_load_dwordx4 v5, s[8:11], s66 offen offset:3072 sc1 lds
    s_add_u32 s64, s64, 128
    s_bitset0_b32 s64, 11
    s_add_u32 s66, s64, 30720
    s_add_u32 m0, s29, 0
    s_nop 0
    buffer_load_dwordx4 v6, s[12:15], s65 offen lds
    s_add_u32 s65, s65, 229376
    s_add_u32 m0, s29, 7296
    s_nop 0
    buffer_load_dwordx4 v6, s[12:15], s65 offen lds
    s_sub_u32 s65, s65, 229376
    s_add_u32 m0, s29, 14592
    s_nop 0
    buffer_load_dwordx4 v6, s[16:19], s65 offen lds
    s_add_u32 s65, s65, 229376
    s_add_u32 m0, s29, 21888
    s_nop 0
    buffer_load_dwordx4 v6, s[16:19], s65 offen lds
    s_add_u32 s65, s65, 229376
    s_waitcnt vmcnt(9)
    v_lshlrev_b32 v112, 16, v104
    v_and_b32 v113, 0xffff0000, v104
    v_lshlrev_b32 v114, 16, v105
    v_and_b32 v115, 0xffff0000, v105
    v_lshlrev_b32 v116, 16, v106
    v_and_b32 v117, 0xffff0000, v106
    v_lshlrev_b32 v118, 16, v107
    v_and_b32 v119, 0xffff0000, v107
    v_lshlrev_b32 v120, 16, v108
    v_and_b32 v121, 0xffff0000, v108
    v_lshlrev_b32 v122, 16, v109
    v_and_b32 v123, 0xffff0000, v109
    v_lshlrev_b32 v124, 16, v110
    v_and_b32 v125, 0xffff0000, v110
    v_lshlrev_b32 v126, 16, v111
    v_and_b32 v127, 0xffff0000, v111
    v_add_f32 v36, v112, v116
    v_add_f32 v37, v113, v117
    v_add_f32 v38, v114, v118
    v_add_f32 v39, v115, v119
    v_add_f32 v36, v36, v120
    v_add_f32 v37, v37, v121
    v_add_f32 v38, v38, v122
    v_add_f32 v39, v39, v123
    v_add_f32 v36, v36, v124
    v_add_f32 v37, v37, v125
    v_add_f32 v38, v38, v126
    v_add_f32 v39, v39, v127
    v_add_f32 v36, v36, v37
    v_add_f32 v38, v38, v39
    v_add_f32 v34, v36, v38
    s_nop 1
    v_add_f32_dpp v34, v34, v34 row_ror:8 row_mask:0xf bank_mask:0xf
    s_nop 1
    v_add_f32_dpp v34, v34, v34 row_ror:4 row_mask:0xf bank_mask:0xf
    s_nop 1
    v_add_f32_dpp v34, v34, v34 row_ror:2 row_mask:0xf bank_mask:0xf
    s_nop 1
    v_add_f32_dpp v34, v34, v34 row_ror:1 row_mask:0xf bank_mask:0xf
    v_mov_b32 v36, v34
    s_nop 1
    v_permlane16_swap_b32 v34, v36
    v_add_f32 v34, v34, v36
    v_mov_b32 v36, v34
    s_nop 1
    v_permlane32_swap_b32 v34, v36
    v_add_f32 v34, v34, v36
    v_mul_f32 v34, 0x3a800000, v34
    v_cvt_pk_bf16_f32 v14, v34, v34
    v_and_b32 v14, 0xffff0000, v14
    v_sub_f32 v112, v112, v14
    v_sub_f32 v113, v113, v14
    v_sub_f32 v114, v114, v14
    v_sub_f32 v115, v115, v14
    v_sub_f32 v116, v116, v14
    v_sub_f32 v117, v117, v14
    v_sub_f32 v118, v118, v14
    v_sub_f32 v119, v119, v14
    v_sub_f32 v120, v120, v14
    v_sub_f32 v121, v121, v14
    v_sub_f32 v122, v122, v14
    v_sub_f32 v123, v123, v14
    v_sub_f32 v124, v124, v14
    v_sub_f32 v125, v125, v14
    v_sub_f32 v126, v126, v14
    v_sub_f32 v127, v127, v14
    v_mul_f32 v36, v112, v112
    v_mul_f32 v37, v113, v113
    v_mul_f32 v38, v114, v114
    v_mul_f32 v39, v115, v115
    v_fmac_f32 v36, v116, v116
    v_fmac_f32 v37, v117, v117
    v_fmac_f32 v38, v118, v118
    v_fmac_f32 v39, v119, v119
    v_fmac_f32 v36, v120, v120
    v_fmac_f32 v37, v121, v121
    v_fmac_f32 v38, v122, v122
    v_fmac_f32 v39, v123, v123
    v_fmac_f32 v36, v124, v124
    v_fmac_f32 v37, v125, v125
    v_fmac_f32 v38, v126, v126
    v_fmac_f32 v39, v127, v127
    v_add_f32 v36, v36, v37
    v_add_f32 v38, v38, v39
    v_sub_f32 v34, v34, v14
    v_add_f32 v12, v36, v38
    s_nop 1
    v_add_f32_dpp v12, v12, v12 row_ror:8 row_mask:0xf bank_mask:0xf
    v_cvt_pk_bf16_f32 v104, v112, v113
    s_nop 0
    v_add_f32_dpp v12, v12, v12 row_ror:4 row_mask:0xf bank_mask:0xf
    v_cvt_pk_bf16_f32 v105, v114, v115
    s_nop 0
    v_add_f32_dpp v12, v12, v12 row_ror:2 row_mask:0xf bank_mask:0xf
    v_cvt_pk_bf16_f32 v106, v116, v117
    s_nop 0
    v_add_f32_dpp v12, v12, v12 row_ror:1 row_mask:0xf bank_mask:0xf
    v_cvt_pk_bf16_f32 v107, v118, v119
    v_mov_b32 v36, v12
    v_cvt_pk_bf16_f32 v108, v120, v121
    s_nop 0
    v_permlane16_swap_b32 v12, v36
    v_cvt_pk_bf16_f32 v109, v122, v123
    v_add_f32 v12, v12, v36
    v_cvt_pk_bf16_f32 v110, v124, v125
    v_mov_b32 v36, v12
    v_cvt_pk_bf16_f32 v111, v126, v127
    s_nop 0
    v_permlane32_swap_b32 v12, v36
    v_lshlrev_b32 v112, 16, v104
    v_add_f32 v12, v12, v36
    v_and_b32 v113, 0xffff0000, v104
    v_mul_f32 v12, 0x3a800000, v12
    v_lshlrev_b32 v114, 16, v105
    v_fma_f32 v12, -v34, v34, v12
    v_and_b32 v115, 0xffff0000, v105
    v_max_f32 v12, 0, v12
    v_lshlrev_b32 v116, 16, v106
    v_cvt_pk_bf16_f32 v12, v12, v12
    v_and_b32 v117, 0xffff0000, v106
    v_and_b32 v12, 0xffff0000, v12
    v_lshlrev_b32 v118, 16, v107
    v_add_f32 v12, 0x3727c5ac, v12
    v_and_b32 v119, 0xffff0000, v107
    v_cvt_pk_bf16_f32 v12, v12, v12
    v_lshlrev_b32 v120, 16, v108
    v_and_b32 v12, 0xffff0000, v12
    v_and_b32 v121, 0xffff0000, v108
    v_sqrt_f32 v15, v12
    v_lshlrev_b32 v122, 16, v109
    v_cvt_pk_bf16_f32 v15, v15, v15
    v_and_b32 v123, 0xffff0000, v109
    v_and_b32 v15, 0xffff0000, v15
    v_lshlrev_b32 v124, 16, v110
    v_rcp_f32 v12, v15
    v_and_b32 v125, 0xffff0000, v110
    v_sub_f32 v14, 0, v14
    v_lshlrev_b32 v126, 16, v111
    v_and_b32 v127, 0xffff0000, v111
    v_mul_f32 v112, v112, v12
    v_mul_f32 v113, v113, v12
    v_mul_f32 v114, v114, v12
    v_mul_f32 v115, v115, v12
    v_mul_f32 v116, v116, v12
    v_mul_f32 v117, v117, v12
    v_mul_f32 v118, v118, v12
    v_mul_f32 v119, v119, v12
    v_mul_f32 v120, v120, v12
    v_mul_f32 v121, v121, v12
    v_mul_f32 v122, v122, v12
    v_mul_f32 v123, v123, v12
    v_mul_f32 v124, v124, v12
    v_mul_f32 v125, v125, v12
    v_mul_f32 v126, v126, v12
    v_mul_f32 v127, v127, v12
    v_cvt_pk_bf16_f32 v104, v112, v113
    v_cvt_pk_bf16_f32 v105, v114, v115
    v_cvt_pk_bf16_f32 v106, v116, v117
    v_cvt_pk_bf16_f32 v107, v118, v119
    v_cvt_pk_bf16_f32 v108, v120, v121
    v_cvt_pk_bf16_f32 v109, v122, v123
    v_cvt_pk_bf16_f32 v110, v124, v125
    v_cvt_pk_bf16_f32 v111, v126, v127
    buffer_store_dwordx4 v[104:107], v2, s[20:23], s3 offen offset:0 sc1
    buffer_store_dwordx4 v[108:111], v2, s[20:23], s3 offen offset:1024 sc1
    v_lshrrev_b32 v14, 16, v14
    v_or_b32 v14, v14, v15
    s_waitcnt vmcnt(10)
    s_mov_b32 s5, 0x9E3779B1
    v_mul_lo_u32 v33, v33, s5
    v_add_u32 v33, 0x7F4A7C15, v33
    s_nop 0
    v_readfirstlane_b32 s58, v33
    v_mov_b32 v15, v33
    s_waitcnt vmcnt(4)
    s_barrier
    ds_read_b128 v[40:43], v8 offset:0
    ds_read_b64_tr_b16 v[84:85], v10 offset:0
    ds_read_b64_tr_b16 v[86:87], v10 offset:3584
    ds_read_b128 v[56:59], v9 offset:0
    ds_read_b64_tr_b16 v[88:89], v10 offset:7296
    ds_read_b64_tr_b16 v[90:91], v10 offset:10880
    ds_read_b128 v[60:63], v9 offset:2048
    ds_read_b128 v[44:47], v8 offset:2048
    ds_read_b128 v[48:51], v8 offset:4096
    ds_read_b128 v[64:67], v9 offset:4096
    ds_read_b128 v[68:71], v9 offset:6144
    ds_read_b128 v[52:55], v8 offset:6144
    ds_read_b64_tr_b16 v[72:73], v10 offset:32
    ds_read_b64_tr_b16 v[74:75], v10 offset:3616
    ds_read_b64_tr_b16 v[76:77], v10 offset:7328
    ds_read_b64_tr_b16 v[78:79], v10 offset:10912
    s_mov_b32 s37, 1574912
    s_waitcnt lgkmcnt(10)
    v_mfma_f32_16x16x32_bf16 v[128:131], v[84:87], v[40:43], 0
    s_setprio 1
    ds_read_b64_tr_b16 v[80:81], v10 offset:64
    s_add_u32 m0, s28, 32768
    v_mfma_f32_16x16x32_bf16 v[128:131], v[88:91], v[56:59], v[128:131]
    s_setprio 0
    ds_read_b64_tr_b16 v[82:83], v10 offset:3648
    buffer_load_dwordx4 v4, s[8:11], s64 offen offset:0 sc1 lds
    s_waitcnt lgkmcnt(10)
    v_mfma_f32_16x16x32_bf16 v[132:135], v[88:91], v[60:63], 0
    s_setprio 1
    v_mfma_f32_16x16x32_bf16 v[132:135], v[84:87], v[44:47], v[132:135]
    s_setprio 0
    s_add_u32 m0, s28, 32768
    s_waitcnt lgkmcnt(8)
    v_mfma_f32_16x16x32_bf16 v[136:139], v[84:87], v[48:51], 0
    s_setprio 1
    v_mfma_f32_16x16x32_bf16 v[136:139], v[88:91], v[64:67], v[136:139]
    s_setprio 0
    buffer_load_dwordx4 v5, s[8:11], s64 offen offset:1024 sc1 lds
    s_waitcnt lgkmcnt(6)
    v_mfma_f32_16x16x32_bf16 v[140:143], v[88:91], v[68:71], 0
    s_setprio 1
    s_add_u32 m0, s28, 32768
    v_mfma_f32_16x16x32_bf16 v[140:143], v[84:87], v[52:55], v[140:143]
    s_setprio 0
    ds_read_b64_tr_b16 v[84:85], v10 offset:7360
    buffer_load_dwordx4 v4, s[8:11], s66 offen offset:2048 sc1 lds
    s_waitcnt lgkmcnt(3)
    v_mfma_f32_16x16x32_bf16 v[172:175], v[72:75], v[52:55], 0
    s_setprio 1
    ds_read_b64_tr_b16 v[86:87], v10 offset:10944
    v_mfma_f32_16x16x32_bf16 v[172:175], v[76:79], v[68:71], v[172:175]
    s_setprio 0
    ds_read_b64_tr_b16 v[88:89], v10 offset:96
    s_add_u32 m0, s28, 32768
    v_mfma_f32_16x16x32_bf16 v[168:171], v[76:79], v[64:67], 0
    s_setprio 1
    ds_read_b64_tr_b16 v[90:91], v10 offset:3680
    v_mfma_f32_16x16x32_bf16 v[168:171], v[72:75], v[48:51], v[168:171]
    s_setprio 0
    buffer_load_dwordx4 v5, s[8:11], s66 offen offset:3072 sc1 lds
    s_add_u32 s64, s64, 128
    s_bitset0_b32 s64, 11
    s_add_u32 s66, s64, 30720
    v_mfma_f32_16x16x32_bf16 v[164:167], v[72:75], v[44:47], 0
    s_setprio 1
    s_add_u32 m0, s29, 29184
    v_mfma_f32_16x16x32_bf16 v[164:167], v[76:79], v[60:63], v[164:167]
    s_setprio 0
    buffer_load_dwordx4 v6, s[12:15], s65 offen lds
    v_mfma_f32_16x16x32_bf16 v[160:163], v[76:79], v[56:59], 0
    s_setprio 1
    s_add_u32 s65, s65, 229376
    v_mfma_f32_16x16x32_bf16 v[160:163], v[72:75], v[40:43], v[160:163]
    s_setprio 0
    ds_read_b64_tr_b16 v[72:73], v10 offset:7392
    s_add_u32 m0, s29, 36480
    s_waitcnt lgkmcnt(3)
    v_mfma_f32_16x16x32_bf16 v[192:195], v[80:83], v[40:43], 0
    s_setprio 1
    ds_read_b64_tr_b16 v[74:75], v10 offset:10976
    v_mfma_f32_16x16x32_bf16 v[192:195], v[84:87], v[56:59], v[192:195]
    s_setprio 0
    buffer_load_dwordx4 v6, s[12:15], s65 offen lds
    s_sub_u32 s65, s65, 229376
    s_waitcnt vmcnt(8) lgkmcnt(0)
    s_barrier
    v_mfma_f32_16x16x32_bf16 v[196:199], v[84:87], v[60:63], 0
    s_setprio 1
    ds_read_b64_tr_b16 v[76:77], v10 offset:14592
    s_add_u32 m0, s29, 43776
    v_mfma_f32_16x16x32_bf16 v[196:199], v[80:83], v[44:47], v[196:199]
    s_setprio 0
    ds_read_b64_tr_b16 v[78:79], v10 offset:18176
    v_mfma_f32_16x16x32_bf16 v[16:19], v[28:31], v[80:83], 0
    v_mfma_f32_16x16x32_bf16 v[16:19], v[28:31], v[84:87], v[16:19]
    buffer_load_dwordx4 v6, s[16:19], s65 offen lds
    v_mfma_f32_16x16x32_bf16 v[200:203], v[80:83], v[48:51], 0
    s_setprio 1
    s_add_u32 s65, s65, 229376
    v_mfma_f32_16x16x32_bf16 v[200:203], v[84:87], v[64:67], v[200:203]
    s_setprio 0
    s_add_u32 m0, s29, 51072
    v_mfma_f32_16x16x32_bf16 v[204:207], v[84:87], v[68:71], 0
    s_setprio 1
    v_mfma_f32_16x16x32_bf16 v[204:207], v[80:83], v[52:55], v[204:207]
    s_setprio 0
    buffer_load_dwordx4 v6, s[16:19], s65 offen lds
    s_add_u32 s65, s65, 229376
    ds_read_b64_tr_b16 v[80:81], v10 offset:21888
    v_mfma_f32_16x16x32_bf16 v[236:239], v[88:91], v[52:55], 0
    s_setprio 1
    ds_read_b64_tr_b16 v[82:83], v10 offset:25472
    s_add_u32 m0, s29, 0
    v_mfma_f32_16x16x32_bf16 v[236:239], v[72:75], v[68:71], v[236:239]
    s_setprio 0
    ds_read_b64_tr_b16 v[84:85], v10 offset:14624
    buffer_load_dwordx4 v6, s[12:15], s65 offen lds
    v_mfma_f32_16x16x32_bf16 v[232:235], v[72:75], v[64:67], 0
    s_setprio 1
    ds_read_b64_tr_b16 v[86:87], v10 offset:18208
    s_add_u32 s65, s65, 229376
    v_mfma_f32_16x16x32_bf16 v[232:235], v[88:91], v[48:51], v[232:235]
    s_setprio 0
    s_add_u32 m0, s29, 7296
    v_mfma_f32_16x16x32_bf16 v[228:231], v[88:91], v[44:47], 0
    s_setprio 1
    v_mfma_f32_16x16x32_bf16 v[228:231], v[72:75], v[60:63], v[228:231]
    s_setprio 0
    buffer_load_dwordx4 v6, s[12:15], s65 offen lds
    s_sub_u32 s65, s65, 229376
    v_mfma_f32_16x16x32_bf16 v[224:227], v[72:75], v[56:59], 0
    s_setprio 1
    s_add_u32 m0, s28, 123904
    v_mfma_f32_16x16x32_bf16 v[224:227], v[88:91], v[40:43], v[224:227]
    s_setprio 0
    ds_read_b64_tr_b16 v[88:89], v10 offset:21920
    buffer_load_dwordx4 v4, s[8:11], s64 offen offset:0 sc1 lds
    s_waitcnt lgkmcnt(3)
    v_mfma_f32_16x16x32_bf16 v[144:147], v[76:79], v[40:43], 0
    s_setprio 1
    ds_read_b64_tr_b16 v[90:91], v10 offset:25504
    v_mfma_f32_16x16x32_bf16 v[144:147], v[80:83], v[56:59], v[144:147]
    s_setprio 0
    ds_read_b64_tr_b16 v[72:73], v10 offset:14656
    s_add_u32 m0, s28, 123904
    v_mfma_f32_16x16x32_bf16 v[148:151], v[80:83], v[60:63], 0
    s_setprio 1
    ds_read_b64_tr_b16 v[74:75], v10 offset:18240
    v_mfma_f32_16x16x32_bf16 v[148:151], v[76:79], v[44:47], v[148:151]
    s_setprio 0
    buffer_load_dwordx4 v5, s[8:11], s64 offen offset:1024 sc1 lds
    v_mfma_f32_16x16x32_bf16 v[152:155], v[76:79], v[48:51], 0
    s_setprio 1
    s_add_u32 m0, s28, 123904
    v_mfma_f32_16x16x32_bf16 v[152:155], v[80:83], v[64:67], v[152:155]
    s_setprio 0
    buffer_load_dwordx4 v4, s[8:11], s66 offen offset:2048 sc1 lds
    v_mfma_f32_16x16x32_bf16 v[156:159], v[80:83], v[68:71], 0
    s_setprio 1
    v_mfma_f32_16x16x32_bf16 v[156:159], v[76:79], v[52:55], v[156:159]
    s_setprio 0
    ds_read_b64_tr_b16 v[76:77], v10 offset:21952
    s_add_u32 m0, s28, 123904
    s_waitcnt lgkmcnt(3)
    v_mfma_f32_16x16x32_bf16 v[188:191], v[84:87], v[52:55], 0
    s_setprio 1
    ds_read_b64_tr_b16 v[78:79], v10 offset:25536
    v_mfma_f32_16x16x32_bf16 v[188:191], v[88:91], v[68:71], v[188:191]
    s_setprio 0
    buffer_load_dwordx4 v5, s[8:11], s66 offen offset:3072 sc1 lds
    s_add_u32 s64, s64, 128
    s_bitset0_b32 s64, 11
    s_add_u32 s66, s64, 30720
    s_waitcnt vmcnt(14)
    s_lshr_b32 s3, s3, 8
    s_add_u32 s3, s3, 3211264
    s_mov_b64 exec, 1
    buffer_store_dwordx2 v[14:15], off, s[24:27], s3 sc1
    s_mov_b64 exec, -1
    ds_read_b64_tr_b16 v[80:81], v10 offset:14688
    v_mfma_f32_16x16x32_bf16 v[184:187], v[88:91], v[64:67], 0
    s_setprio 1
    ds_read_b64_tr_b16 v[82:83], v10 offset:18272
    v_mfma_f32_16x16x32_bf16 v[184:187], v[84:87], v[48:51], v[184:187]
    s_setprio 0
    v_mfma_f32_16x16x32_bf16 v[180:183], v[84:87], v[44:47], 0
    s_setprio 1
    v_mfma_f32_16x16x32_bf16 v[180:183], v[88:91], v[60:63], v[180:183]
    s_setprio 0
    v_mfma_f32_16x16x32_bf16 v[176:179], v[88:91], v[56:59], 0
    s_setprio 1
    v_mfma_f32_16x16x32_bf16 v[176:179], v[84:87], v[40:43], v[176:179]
    s_setprio 0
    ds_read_b64_tr_b16 v[84:85], v10 offset:21984
    s_waitcnt lgkmcnt(3)
    v_mfma_f32_16x16x32_bf16 v[208:211], v[72:75], v[40:43], 0
    s_setprio 1
    ds_read_b64_tr_b16 v[86:87], v10 offset:25568
    v_mfma_f32_16x16x32_bf16 v[208:211], v[76:79], v[56:59], v[208:211]
    s_setprio 0
    s_waitcnt vmcnt(9) lgkmcnt(0)
    s_barrier
    s_add_u32 m0, s29, 14592
    v_mfma_f32_16x16x32_bf16 v[212:215], v[76:79], v[60:63], 0
    s_setprio 1
    ds_read_b64_tr_b16 v[88:89], v10 offset:29184
    v_mfma_f32_16x16x32_bf16 v[212:215], v[72:75], v[44:47], v[212:215]
    s_setprio 0
    v_mfma_f32_16x16x32_bf16 v[20:23], v[28:31], v[72:75], 0
    v_mfma_f32_16x16x32_bf16 v[20:23], v[28:31], v[76:79], v[20:23]
    buffer_load_dwordx4 v6, s[16:19], s65 offen lds
    s_add_u32 s65, s65, 229376
    ds_read_b64_tr_b16 v[90:91], v10 offset:32768
    v_mfma_f32_16x16x32_bf16 v[216:219], v[72:75], v[48:51], 0
    s_setprio 1
    s_add_u32 m0, s29, 21888
    v_mfma_f32_16x16x32_bf16 v[216:219], v[76:79], v[64:67], v[216:219]
    s_setprio 0
    buffer_load_dwordx4 v6, s[16:19], s65 offen lds
    v_mfma_f32_16x16x32_bf16 v[220:223], v[76:79], v[68:71], 0
    s_setprio 1
    s_add_u32 s65, s65, 229376
    v_mfma_f32_16x16x32_bf16 v[220:223], v[72:75], v[52:55], v[220:223]
    s_setprio 0
    ds_read_b64_tr_b16 v[72:73], v10 offset:36480
    s_add_u32 m0, s28, 0
    v_mfma_f32_16x16x32_bf16 v[252:255], v[80:83], v[52:55], 0
    s_setprio 1
    ds_read_b128 v[52:55], v8 offset:38912
    ds_read_b64_tr_b16 v[74:75], v10 offset:40064
    v_mfma_f32_16x16x32_bf16 v[252:255], v[84:87], v[68:71], v[252:255]
    s_setprio 0
    buffer_load_dwordx4 v4, s[8:11], s64 offen offset:0 sc1 lds
    ds_read_b128 v[68:71], v9 offset:38912
    ds_read_b64_tr_b16 v[76:77], v10 offset:29216
    v_mfma_f32_16x16x32_bf16 v[248:251], v[84:87], v[64:67], 0
    s_setprio 1
    ds_read_b128 v[64:67], v9 offset:36864
    ds_read_b64_tr_b16 v[78:79], v10 offset:32800
    s_add_u32 m0, s28, 0
    v_mfma_f32_16x16x32_bf16 v[248:251], v[80:83], v[48:51], v[248:251]
    s_setprio 0
    ds_read_b128 v[48:51], v8 offset:36864
    buffer_load_dwordx4 v5, s[8:11], s64 offen offset:1024 sc1 lds
    v_mfma_f32_16x16x32_bf16 v[244:247], v[80:83], v[44:47], 0
    s_setprio 1
    ds_read_b128 v[44:47], v8 offset:34816
    v_mfma_f32_16x16x32_bf16 v[244:247], v[84:87], v[60:63], v[244:247]
    s_setprio 0
    ds_read_b128 v[60:63], v9 offset:34816
    s_add_u32 m0, s28, 0
    v_mfma_f32_16x16x32_bf16 v[240:243], v[84:87], v[56:59], 0
    s_setprio 1
    ds_read_b128 v[56:59], v9 offset:32768
    v_mfma_f32_16x16x32_bf16 v[240:243], v[80:83], v[40:43], v[240:243]
    s_setprio 0
    buffer_load_dwordx4 v4, s[8:11], s66 offen offset:2048 sc1 lds
    ds_read_b128 v[40:43], v8 offset:32768
    ds_read_b64_tr_b16 v[80:81], v10 offset:36512
    s_waitcnt lgkmcnt(9)
    v_mfma_f32_16x16x32_bf16 v[140:143], v[88:91], v[52:55], v[140:143]
    s_setprio 1
    ds_read_b64_tr_b16 v[82:83], v10 offset:40096
    s_add_u32 m0, s28, 0
    v_mfma_f32_16x16x32_bf16 v[140:143], v[72:75], v[68:71], v[140:143]
    s_setprio 0
    ds_read_b64_tr_b16 v[84:85], v10 offset:29248
    buffer_load_dwordx4 v5, s[8:11], s66 offen offset:3072 sc1 lds
    s_waitcnt lgkmcnt(7)
    v_mfma_f32_16x16x32_bf16 v[136:139], v[72:75], v[64:67], v[136:139]
    s_setprio 1
    ds_read_b64_tr_b16 v[86:87], v10 offset:32832
    s_add_u32 s64, s64, 128
    s_bitset0_b32 s64, 11
    v_mfma_f32_16x16x32_bf16 v[136:139], v[88:91], v[48:51], v[136:139]
    s_setprio 0
    s_add_u32 s66, s64, 30720
    s_waitcnt lgkmcnt(6)
    v_mfma_f32_16x16x32_bf16 v[132:135], v[88:91], v[44:47], v[132:135]
    s_setprio 1
    v_mfma_f32_16x16x32_bf16 v[132:135], v[72:75], v[60:63], v[132:135]
    s_setprio 0
    s_waitcnt lgkmcnt(4)
    v_mfma_f32_16x16x32_bf16 v[128:131], v[72:75], v[56:59], v[128:131]
    s_setprio 1
    v_mfma_f32_16x16x32_bf16 v[128:131], v[88:91], v[40:43], v[128:131]
    s_setprio 0
    ds_read_b64_tr_b16 v[88:89], v10 offset:36544
    s_waitcnt lgkmcnt(3)
    v_mfma_f32_16x16x32_bf16 v[160:163], v[76:79], v[40:43], v[160:163]
    s_setprio 1
    ds_read_b64_tr_b16 v[90:91], v10 offset:40128
    v_mfma_f32_16x16x32_bf16 v[160:163], v[80:83], v[56:59], v[160:163]
    s_setprio 0
    ds_read_b64_tr_b16 v[72:73], v10 offset:29280
    v_mfma_f32_16x16x32_bf16 v[164:167], v[80:83], v[60:63], v[164:167]
    s_setprio 1
    ds_read_b64_tr_b16 v[74:75], v10 offset:32864
    v_mfma_f32_16x16x32_bf16 v[164:167], v[76:79], v[44:47], v[164:167]
    s_setprio 0
    v_mfma_f32_16x16x32_bf16 v[168:171], v[76:79], v[48:51], v[168:171]
    s_setprio 1
    v_mfma_f32_16x16x32_bf16 v[168:171], v[80:83], v[64:67], v[168:171]
    s_setprio 0
    v_mfma_f32_16x16x32_bf16 v[172:175], v[80:83], v[68:71], v[172:175]
    s_setprio 1
    v_mfma_f32_16x16x32_bf16 v[172:175], v[76:79], v[52:55], v[172:175]
    s_setprio 0
    ds_read_b64_tr_b16 v[76:77], v10 offset:36576
    s_waitcnt lgkmcnt(3)
    v_mfma_f32_16x16x32_bf16 v[204:207], v[84:87], v[52:55], v[204:207]
    s_setprio 1
    ds_read_b64_tr_b16 v[78:79], v10 offset:40160
    v_mfma_f32_16x16x32_bf16 v[204:207], v[88:91], v[68:71], v[204:207]
    s_setprio 0
    s_waitcnt vmcnt(13) lgkmcnt(0)
    s_barrier
    v_mfma_f32_16x16x32_bf16 v[200:203], v[88:91], v[64:67], v[200:203]
    s_setprio 1
    ds_read_b64_tr_b16 v[80:81], v10 offset:43776
    s_add_u32 m0, s29, 29184
    v_mfma_f32_16x16x32_bf16 v[200:203], v[84:87], v[48:51], v[200:203]
    s_setprio 0
    ds_read_b64_tr_b16 v[82:83], v10 offset:47360
    v_mfma_f32_16x16x32_bf16 v[16:19], v[28:31], v[84:87], v[16:19]
    v_mfma_f32_16x16x32_bf16 v[16:19], v[28:31], v[88:91], v[16:19]
    buffer_load_dwordx4 v6, s[12:15], s65 offen lds
    v_mfma_f32_16x16x32_bf16 v[196:199], v[84:87], v[44:47], v[196:199]
    s_setprio 1
    s_add_u32 s65, s65, 229376
    v_mfma_f32_16x16x32_bf16 v[196:199], v[88:91], v[60:63], v[196:199]
    s_setprio 0
    v_mfma_f32_16x16x32_bf16 v[192:195], v[88:91], v[56:59], v[192:195]
    s_setprio 1
    s_add_u32 m0, s29, 36480
    v_mfma_f32_16x16x32_bf16 v[192:195], v[84:87], v[40:43], v[192:195]
    s_setprio 0
    ds_read_b64_tr_b16 v[84:85], v10 offset:51072
    buffer_load_dwordx4 v6, s[12:15], s65 offen lds
    v_mfma_f32_16x16x32_bf16 v[224:227], v[72:75], v[40:43], v[224:227]
    s_setprio 1
    ds_read_b64_tr_b16 v[86:87], v10 offset:54656
    s_sub_u32 s65, s65, 229376
    v_mfma_f32_16x16x32_bf16 v[224:227], v[76:79], v[56:59], v[224:227]
    s_setprio 0
    ds_read_b64_tr_b16 v[88:89], v10 offset:43808
    v_mfma_f32_16x16x32_bf16 v[228:231], v[76:79], v[60:63], v[228:231]
    s_setprio 1
    ds_read_b64_tr_b16 v[90:91], v10 offset:47392
    v_mfma_f32_16x16x32_bf16 v[228:231], v[72:75], v[44:47], v[228:231]
    s_setprio 0
    v_mfma_f32_16x16x32_bf16 v[232:235], v[72:75], v[48:51], v[232:235]
    s_setprio 1
    v_mfma_f32_16x16x32_bf16 v[232:235], v[76:79], v[64:67], v[232:235]
    s_setprio 0
    v_mfma_f32_16x16x32_bf16 v[236:239], v[76:79], v[68:71], v[236:239]
    s_setprio 1
    v_mfma_f32_16x16x32_bf16 v[236:239], v[72:75], v[52:55], v[236:239]
    s_setprio 0
    ds_read_b64_tr_b16 v[72:73], v10 offset:51104
    s_waitcnt lgkmcnt(3)
    v_mfma_f32_16x16x32_bf16 v[156:159], v[80:83], v[52:55], v[156:159]
    s_setprio 1
    ds_read_b64_tr_b16 v[74:75], v10 offset:54688
    v_mfma_f32_16x16x32_bf16 v[156:159], v[84:87], v[68:71], v[156:159]
    s_setprio 0
    ds_read_b64_tr_b16 v[76:77], v10 offset:43840
    v_mfma_f32_16x16x32_bf16 v[152:155], v[84:87], v[64:67], v[152:155]
    s_setprio 1
    ds_read_b64_tr_b16 v[78:79], v10 offset:47424
    v_mfma_f32_16x16x32_bf16 v[152:155], v[80:83], v[48:51], v[152:155]
    s_setprio 0
    v_mfma_f32_16x16x32_bf16 v[148:151], v[80:83], v[44:47], v[148:151]
    s_setprio 1
    v_mfma_f32_16x16x32_bf16 v[148:151], v[84:87], v[60:63], v[148:151]
    s_setprio 0
    v_mfma_f32_16x16x32_bf16 v[144:147], v[84:87], v[56:59], v[144:147]
    s_setprio 1
    v_mfma_f32_16x16x32_bf16 v[144:147], v[80:83], v[40:43], v[144:147]
    s_setprio 0
    ds_read_b64_tr_b16 v[80:81], v10 offset:51136
    s_waitcnt lgkmcnt(3)
    v_mfma_f32_16x16x32_bf16 v[176:179], v[88:91], v[40:43], v[176:179]
    s_setprio 1
    ds_read_b64_tr_b16 v[82:83], v10 offset:54720
    v_mfma_f32_16x16x32_bf16 v[176:179], v[72:75], v[56:59], v[176:179]
    s_setprio 0
    ds_read_b64_tr_b16 v[84:85], v10 offset:43872
    v_mfma_f32_16x16x32_bf16 v[180:183], v[72:75], v[60:63], v[180:183]
    s_setprio 1
    ds_read_b64_tr_b16 v[86:87], v10 offset:47456
    v_mfma_f32_16x16x32_bf16 v[180:183], v[88:91], v[44:47], v[180:183]
    s_setprio 0
    v_mfma_f32_16x16x32_bf16 v[184:187], v[88:91], v[48:51], v[184:187]
    s_setprio 1
    v_mfma_f32_16x16x32_bf16 v[184:187], v[72:75], v[64:67], v[184:187]
    s_setprio 0
    v_mfma_f32_16x16x32_bf16 v[188:191], v[72:75], v[68:71], v[188:191]
    s_setprio 1
    v_mfma_f32_16x16x32_bf16 v[188:191], v[88:91], v[52:55], v[188:191]
    s_setprio 0
    ds_read_b64_tr_b16 v[88:89], v10 offset:51168
    s_waitcnt lgkmcnt(3)
    v_mfma_f32_16x16x32_bf16 v[220:223], v[76:79], v[52:55], v[220:223]
    s_setprio 1
    ds_read_b64_tr_b16 v[90:91], v10 offset:54752
    v_mfma_f32_16x16x32_bf16 v[220:223], v[80:83], v[68:71], v[220:223]
    s_setprio 0
    s_waitcnt vmcnt(9) lgkmcnt(0)
    s_barrier
    v_mfma_f32_16x16x32_bf16 v[216:219], v[80:83], v[64:67], v[216:219]
    s_setprio 1
    ds_read_b64_tr_b16 v[72:73], v10 offset:0
    s_add_u32 m0, s29, 43776
    v_mfma_f32_16x16x32_bf16 v[216:219], v[76:79], v[48:51], v[216:219]
    s_setprio 0
    ds_read_b64_tr_b16 v[74:75], v10 offset:3584
    v_mfma_f32_16x16x32_bf16 v[20:23], v[28:31], v[76:79], v[20:23]
    v_mfma_f32_16x16x32_bf16 v[20:23], v[28:31], v[80:83], v[20:23]
    buffer_load_dwordx4 v6, s[16:19], s65 offen lds
    v_mfma_f32_16x16x32_bf16 v[212:215], v[76:79], v[44:47], v[212:215]
    s_setprio 1
    s_add_u32 s65, s65, 229376
    v_mfma_f32_16x16x32_bf16 v[212:215], v[80:83], v[60:63], v[212:215]
    s_setprio 0
    v_mfma_f32_16x16x32_bf16 v[208:211], v[80:83], v[56:59], v[208:211]
    s_setprio 1
    s_add_u32 m0, s29, 51072
    v_mfma_f32_16x16x32_bf16 v[208:211], v[76:79], v[40:43], v[208:211]
    s_setprio 0
    ds_read_b64_tr_b16 v[76:77], v10 offset:7296
    buffer_load_dwordx4 v6, s[16:19], s65 offen lds
    v_mfma_f32_16x16x32_bf16 v[240:243], v[84:87], v[40:43], v[240:243]
    s_setprio 1
    ds_read_b128 v[40:43], v94 offset:0
    ds_read_b64_tr_b16 v[78:79], v10 offset:10880
    s_add_u32 s65, s65, 229376
    v_mfma_f32_16x16x32_bf16 v[240:243], v[88:91], v[56:59], v[240:243]
    s_setprio 0
    ds_read_b128 v[56:59], v95 offset:0
    ds_read_b64_tr_b16 v[80:81], v10 offset:32
    v_mfma_f32_16x16x32_bf16 v[244:247], v[88:91], v[60:63], v[244:247]
    s_setprio 1
    ds_read_b128 v[60:63], v95 offset:2048
    ds_read_b64_tr_b16 v[82:83], v10 offset:3616
    v_mfma_f32_16x16x32_bf16 v[244:247], v[84:87], v[44:47], v[244:247]
    s_setprio 0
    ds_read_b128 v[44:47], v94 offset:2048
    v_mfma_f32_16x16x32_bf16 v[248:251], v[84:87], v[48:51], v[248:251]
    s_setprio 1
    ds_read_b128 v[48:51], v94 offset:4096
    v_mfma_f32_16x16x32_bf16 v[248:251], v[88:91], v[64:67], v[248:251]
    s_setprio 0
    ds_read_b128 v[64:67], v95 offset:4096
    v_mfma_f32_16x16x32_bf16 v[252:255], v[88:91], v[68:71], v[252:255]
    s_setprio 1
    ds_read_b128 v[68:71], v95 offset:6144
    v_mfma_f32_16x16x32_bf16 v[252:255], v[84:87], v[52:55], v[252:255]
    s_setprio 0
    ds_read_b128 v[52:55], v94 offset:6144
    ds_read_b64_tr_b16 v[84:85], v10 offset:7328
    s_waitcnt lgkmcnt(9)
    v_mfma_f32_16x16x32_bf16 v[128:131], v[72:75], v[40:43], v[128:131]
    s_setprio 1
    ds_read_b64_tr_b16 v[86:87], v10 offset:10912
    v_mfma_f32_16x16x32_bf16 v[128:131], v[76:79], v[56:59], v[128:131]
    s_setprio 0
    ds_read_b64_tr_b16 v[88:89], v10 offset:64
    s_waitcnt lgkmcnt(7)
    v_mfma_f32_16x16x32_bf16 v[132:135], v[76:79], v[60:63], v[132:135]
    s_setprio 1
    ds_read_b64_tr_b16 v[90:91], v10 offset:3648
    v_mfma_f32_16x16x32_bf16 v[132:135], v[72:75], v[44:47], v[132:135]
    s_setprio 0
    s_waitcnt lgkmcnt(6)
    v_mfma_f32_16x16x32_bf16 v[136:139], v[72:75], v[48:51], v[136:139]
    s_setprio 1
    v_mfma_f32_16x16x32_bf16 v[136:139], v[76:79], v[64:67], v[136:139]
    s_setprio 0
    s_waitcnt lgkmcnt(4)
    v_mfma_f32_16x16x32_bf16 v[140:143], v[76:79], v[68:71], v[140:143]
    s_setprio 1
    v_mfma_f32_16x16x32_bf16 v[140:143], v[72:75], v[52:55], v[140:143]
    s_setprio 0
    ds_read_b64_tr_b16 v[72:73], v10 offset:7360
    s_waitcnt lgkmcnt(3)
    v_mfma_f32_16x16x32_bf16 v[172:175], v[80:83], v[52:55], v[172:175]
    s_setprio 1
    ds_read_b64_tr_b16 v[74:75], v10 offset:10944
    v_mfma_f32_16x16x32_bf16 v[172:175], v[84:87], v[68:71], v[172:175]
    s_setprio 0
    ds_read_b64_tr_b16 v[76:77], v10 offset:96
    v_mfma_f32_16x16x32_bf16 v[168:171], v[84:87], v[64:67], v[168:171]
    s_setprio 1
    ds_read_b64_tr_b16 v[78:79], v10 offset:3680
    v_mfma_f32_16x16x32_bf16 v[168:171], v[80:83], v[48:51], v[168:171]
    s_setprio 0
    v_mfma_f32_16x16x32_bf16 v[164:167], v[80:83], v[44:47], v[164:167]
    s_setprio 1
    v_mfma_f32_16x16x32_bf16 v[164:167], v[84:87], v[60:63], v[164:167]
    s_setprio 0
    v_mfma_f32_16x16x32_bf16 v[160:163], v[84:87], v[56:59], v[160:163]
    s_setprio 1
    v_mfma_f32_16x16x32_bf16 v[160:163], v[80:83], v[40:43], v[160:163]
    s_setprio 0
    ds_read_b64_tr_b16 v[80:81], v10 offset:7392
    s_waitcnt lgkmcnt(3)
    v_mfma_f32_16x16x32_bf16 v[192:195], v[88:91], v[40:43], v[192:195]
    s_setprio 1
    ds_read_b64_tr_b16 v[82:83], v10 offset:10976
    v_mfma_f32_16x16x32_bf16 v[192:195], v[72:75], v[56:59], v[192:195]
    s_setprio 0
    s_waitcnt vmcnt(8) lgkmcnt(0)
    s_barrier
    v_mfma_f32_16x16x32_bf16 v[196:199], v[72:75], v[60:63], v[196:199]
    s_setprio 1
    ds_read_b64_tr_b16 v[84:85], v10 offset:14592
    s_add_u32 m0, s29, 0
    v_mfma_f32_16x16x32_bf16 v[196:199], v[88:91], v[44:47], v[196:199]
    s_setprio 0
    v_mfma_f32_16x16x32_bf16 v[16:19], v[28:31], v[88:91], v[16:19]
    v_mfma_f32_16x16x32_bf16 v[16:19], v[28:31], v[72:75], v[16:19]
    s_mov_b64 s[8:9], s[56:57]
    v_mov_b32 v124, 0
    ds_read_b64_tr_b16 v[86:87], v10 offset:18176
    buffer_load_dwordx4 v6, s[12:15], s65 offen lds
    v_mfma_f32_16x16x32_bf16 v[200:203], v[88:91], v[48:51], v[200:203]
    s_setprio 1
    s_add_u32 s65, s65, 229376
    v_mfma_f32_16x16x32_bf16 v[200:203], v[72:75], v[64:67], v[200:203]
    s_setprio 0
    v_mfma_f32_16x16x32_bf16 v[204:207], v[72:75], v[68:71], v[204:207]
    s_setprio 1
    s_add_u32 m0, s29, 7296
    v_mfma_f32_16x16x32_bf16 v[204:207], v[88:91], v[52:55], v[204:207]
    s_setprio 0
    v_mov_b32 v125, 0
    ds_read_b64_tr_b16 v[88:89], v10 offset:21888
    buffer_load_dwordx4 v6, s[12:15], s65 offen lds
    v_mfma_f32_16x16x32_bf16 v[236:239], v[76:79], v[52:55], v[236:239]
    s_setprio 1
    ds_read_b64_tr_b16 v[90:91], v10 offset:25472
    s_sub_u32 s65, s65, 229376
    v_mfma_f32_16x16x32_bf16 v[236:239], v[80:83], v[68:71], v[236:239]
    s_setprio 0
    ds_read_b64_tr_b16 v[72:73], v10 offset:14624
    v_mfma_f32_16x16x32_bf16 v[232:235], v[80:83], v[64:67], v[232:235]
    s_setprio 1
    ds_read_b64_tr_b16 v[74:75], v10 offset:18208
    v_mfma_f32_16x16x32_bf16 v[232:235], v[76:79], v[48:51], v[232:235]
    s_setprio 0
    v_mov_b32 v126, 0
    v_mfma_f32_16x16x32_bf16 v[228:231], v[76:79], v[44:47], v[228:231]
    s_setprio 1
    v_mfma_f32_16x16x32_bf16 v[228:231], v[80:83], v[60:63], v[228:231]
    s_setprio 0
    v_mfma_f32_16x16x32_bf16 v[224:227], v[80:83], v[56:59], v[224:227]
    s_setprio 1
    s_add_u32 m0, s28, 32768
    v_mfma_f32_16x16x32_bf16 v[224:227], v[76:79], v[40:43], v[224:227]
    s_setprio 0
    ds_read_b64_tr_b16 v[76:77], v10 offset:21920
    buffer_load_dwordx4 v4, s[8:11], s64 offen offset:0 sc1 lds
    s_waitcnt lgkmcnt(3)
    v_mfma_f32_16x16x32_bf16 v[144:147], v[84:87], v[40:43], v[144:147]
    s_setprio 1
    ds_read_b64_tr_b16 v[78:79], v10 offset:25504
    v_mfma_f32_16x16x32_bf16 v[144:147], v[88:91], v[56:59], v[144:147]
    s_setprio 0
    v_mov_b32 v127, 0
    ds_read_b64_tr_b16 v[80:81], v10 offset:14656
    v_mfma_f32_16x16x32_bf16 v[148:151], v[88:91], v[60:63], v[148:151]
    s_setprio 1
    ds_read_b64_tr_b16 v[82:83], v10 offset:18240
    s_add_u32 m0, s28, 32768
    v_mfma_f32_16x16x32_bf16 v[148:151], v[84:87], v[44:47], v[148:151]
    s_setprio 0
    buffer_load_dwordx4 v5, s[8:11], s64 offen offset:1024 sc1 lds
    v_mfma_f32_16x16x32_bf16 v[152:155], v[84:87], v[48:51], v[152:155]
    s_setprio 1
    v_mfma_f32_16x16x32_bf16 v[152:155], v[88:91], v[64:67], v[152:155]
    s_setprio 0
    v_mov_b32 v120, 0
    v_mfma_f32_16x16x32_bf16 v[156:159], v[88:91], v[68:71], v[156:159]
    s_setprio 1
    s_add_u32 m0, s28, 32768
    v_mfma_f32_16x16x32_bf16 v[156:159], v[84:87], v[52:55], v[156:159]
    s_setprio 0
    ds_read_b64_tr_b16 v[84:85], v10 offset:21952
    buffer_load_dwordx4 v4, s[8:11], s66 offen offset:2048 sc1 lds
    s_waitcnt lgkmcnt(3)
    v_mfma_f32_16x16x32_bf16 v[188:191], v[72:75], v[52:55], v[188:191]
    s_setprio 1
    ds_read_b64_tr_b16 v[86:87], v10 offset:25536
    v_mfma_f32_16x16x32_bf16 v[188:191], v[76:79], v[68:71], v[188:191]
    s_setprio 0
    ds_read_b64_tr_b16 v[88:89], v10 offset:14688
    v_mfma_f32_16x16x32_bf16 v[184:187], v[76:79], v[64:67], v[184:187]
    s_setprio 1
    ds_read_b64_tr_b16 v[90:91], v10 offset:18272
    s_add_u32 m0, s28, 32768
    v_mfma_f32_16x16x32_bf16 v[184:187], v[72:75], v[48:51], v[184:187]
    s_setprio 0
    v_mov_b32 v121, 0
    buffer_load_dwordx4 v5, s[8:11], s66 offen offset:3072 sc1 lds
    v_mfma_f32_16x16x32_bf16 v[180:183], v[72:75], v[44:47], v[180:183]
    s_setprio 1
    s_add_u32 s64, s64, 128
    s_bitset0_b32 s64, 11
    v_mfma_f32_16x16x32_bf16 v[180:183], v[76:79], v[60:63], v[180:183]
    s_setprio 0
    s_add_u32 s66, s64, 30720
    v_mfma_f32_16x16x32_bf16 v[176:179], v[76:79], v[56:59], v[176:179]
    s_setprio 1
    v_mfma_f32_16x16x32_bf16 v[176:179], v[72:75], v[40:43], v[176:179]
    s_setprio 0
    ds_read_b64_tr_b16 v[72:73], v10 offset:21984
    v_mov_b32 v122, 0
    s_waitcnt lgkmcnt(3)
    v_mfma_f32_16x16x32_bf16 v[208:211], v[80:83], v[40:43], v[208:211]
    s_setprio 1
    ds_read_b64_tr_b16 v[74:75], v10 offset:25568
    v_mfma_f32_16x16x32_bf16 v[208:211], v[84:87], v[56:59], v[208:211]
    s_setprio 0
    s_waitcnt vmcnt(8) lgkmcnt(0)
    s_barrier
    v_mfma_f32_16x16x32_bf16 v[212:215], v[84:87], v[60:63], v[212:215]
    s_setprio 1
    ds_read_b64_tr_b16 v[76:77], v10 offset:29184
    s_add_u32 m0, s29, 14592
    v_mfma_f32_16x16x32_bf16 v[212:215], v[80:83], v[44:47], v[212:215]
    s_setprio 0
    ds_read_b64_tr_b16 v[78:79], v10 offset:32768
    v_mfma_f32_16x16x32_bf16 v[20:23], v[28:31], v[80:83], v[20:23]
    v_mfma_f32_16x16x32_bf16 v[20:23], v[28:31], v[84:87], v[20:23]
    buffer_load_dwordx4 v6, s[16:19], s65 offen lds
    v_mfma_f32_16x16x32_bf16 v[216:219], v[80:83], v[48:51], v[216:219]
    s_setprio 1
    s_add_u32 s65, s65, 229376
    v_mfma_f32_16x16x32_bf16 v[216:219], v[84:87], v[64:67], v[216:219]
    s_setprio 0
    v_mov_b32 v123, 0
    v_mfma_f32_16x16x32_bf16 v[220:223], v[84:87], v[68:71], v[220:223]
    s_setprio 1
    s_add_u32 m0, s29, 21888
    v_mfma_f32_16x16x32_bf16 v[220:223], v[80:83], v[52:55], v[220:223]
    s_setprio 0
    ds_read_b64_tr_b16 v[80:81], v10 offset:36480
    buffer_load_dwordx4 v6, s[16:19], s65 offen lds
    v_mfma_f32_16x16x32_bf16 v[252:255], v[88:91], v[52:55], v[252:255]
    s_setprio 1
    ds_read_b128 v[52:55], v8 offset:6144
    ds_read_b64_tr_b16 v[82:83], v10 offset:40064
    s_add_u32 s65, s65, 229376
    v_mfma_f32_16x16x32_bf16 v[252:255], v[72:75], v[68:71], v[252:255]
    s_setprio 0
    ds_read_b128 v[68:71], v9 offset:6144
    ds_read_b64_tr_b16 v[84:85], v10 offset:29216
    v_mov_b32 v116, 0
    v_mfma_f32_16x16x32_bf16 v[248:251], v[72:75], v[64:67], v[248:251]
    s_setprio 1
    ds_read_b128 v[64:67], v9 offset:4096
    ds_read_b64_tr_b16 v[86:87], v10 offset:32800
    s_mov_b32 m0, 133120
    v_mfma_f32_16x16x32_bf16 v[248:251], v[88:91], v[48:51], v[248:251]
    s_setprio 0
    ds_read_b128 v[48:51], v8 offset:4096
    buffer_load_dwordx4 v35, s[76:79], s37 offen  lds
    v_mfma_f32_16x16x32_bf16 v[244:247], v[88:91], v[44:47], v[244:247]
    s_setprio 1
    ds_read_b128 v[44:47], v8 offset:2048
    s_add_u32 s37, s37, 196608
    v_mfma_f32_16x16x32_bf16 v[244:247], v[72:75], v[60:63], v[244:247]
    s_setprio 0
    ds_read_b128 v[60:63], v9 offset:2048
    v_mov_b32 v117, 0
    v_mfma_f32_16x16x32_bf16 v[240:243], v[72:75], v[56:59], v[240:243]
    s_setprio 1
    ds_read_b128 v[56:59], v9 offset:0
    v_mfma_f32_16x16x32_bf16 v[240:243], v[88:91], v[40:43], v[240:243]
    s_setprio 0
    ds_read_b128 v[40:43], v8 offset:0
    ds_read_b64_tr_b16 v[88:89], v10 offset:36512
    s_waitcnt lgkmcnt(9)
    v_mfma_f32_16x16x32_bf16 v[140:143], v[76:79], v[52:55], v[140:143]
    s_setprio 1
    ds_read_b64_tr_b16 v[90:91], v10 offset:40096
    v_mfma_f32_16x16x32_bf16 v[140:143], v[80:83], v[68:71], v[140:143]
    s_setprio 0
    ds_read_b64_tr_b16 v[72:73], v10 offset:29248
    s_waitcnt lgkmcnt(7)
    v_mfma_f32_16x16x32_bf16 v[136:139], v[80:83], v[64:67], v[136:139]
    s_setprio 1
    ds_read_b64_tr_b16 v[74:75], v10 offset:32832
    s_mov_b32 m0, 139264
    v_mfma_f32_16x16x32_bf16 v[136:139], v[76:79], v[48:51], v[136:139]
    s_setprio 0
    v_mov_b32 v118, 0
    buffer_load_dwordx4 v35, s[76:79], s37 offen  lds
    s_waitcnt lgkmcnt(6)
    v_mfma_f32_16x16x32_bf16 v[132:135], v[76:79], v[44:47], v[132:135]
    s_setprio 1
    s_add_u32 s37, s37, 196608
    v_mfma_f32_16x16x32_bf16 v[132:135], v[80:83], v[60:63], v[132:135]
    s_setprio 0
    s_waitcnt lgkmcnt(4)
    v_mfma_f32_16x16x32_bf16 v[128:131], v[80:83], v[56:59], v[128:131]
    s_setprio 1
    v_mfma_f32_16x16x32_bf16 v[128:131], v[76:79], v[40:43], v[128:131]
    s_setprio 0
    ds_read_b64_tr_b16 v[76:77], v10 offset:36544
    v_mov_b32 v119, 0
    s_waitcnt lgkmcnt(3)
    v_mfma_f32_16x16x32_bf16 v[160:163], v[84:87], v[40:43], v[160:163]
    s_setprio 1
    ds_read_b64_tr_b16 v[78:79], v10 offset:40128
    v_mfma_f32_16x16x32_bf16 v[160:163], v[88:91], v[56:59], v[160:163]
    s_setprio 0
    ds_read_b64_tr_b16 v[80:81], v10 offset:29280
    v_mfma_f32_16x16x32_bf16 v[164:167], v[88:91], v[60:63], v[164:167]
    s_setprio 1
    ds_read_b64_tr_b16 v[82:83], v10 offset:32864
    v_mfma_f32_16x16x32_bf16 v[164:167], v[84:87], v[44:47], v[164:167]
    s_setprio 0
    v_mfma_f32_16x16x32_bf16 v[168:171], v[84:87], v[48:51], v[168:171]
    s_setprio 1
    v_mfma_f32_16x16x32_bf16 v[168:171], v[88:91], v[64:67], v[168:171]
    s_setprio 0
    v_mov_b32 v112, 0
    v_mfma_f32_16x16x32_bf16 v[172:175], v[88:91], v[68:71], v[172:175]
    s_setprio 1
    v_mfma_f32_16x16x32_bf16 v[172:175], v[84:87], v[52:55], v[172:175]
    s_setprio 0
    ds_read_b64_tr_b16 v[84:85], v10 offset:36576
    s_waitcnt lgkmcnt(3)
    v_mfma_f32_16x16x32_bf16 v[204:207], v[72:75], v[52:55], v[204:207]
    s_setprio 1
    ds_read_b64_tr_b16 v[86:87], v10 offset:40160
    v_mfma_f32_16x16x32_bf16 v[204:207], v[76:79], v[68:71], v[204:207]
    s_setprio 0
    v_mov_b32 v113, 0
    s_waitcnt vmcnt(10) lgkmcnt(0)
    s_barrier
    v_mfma_f32_16x16x32_bf16 v[200:203], v[76:79], v[64:67], v[200:203]
    s_setprio 1
    ds_read_b64_tr_b16 v[88:89], v10 offset:43776
    s_add_u32 m0, s29, 29184
    v_mfma_f32_16x16x32_bf16 v[200:203], v[72:75], v[48:51], v[200:203]
    s_setprio 0
    ds_read_b64_tr_b16 v[90:91], v10 offset:47360
    v_mfma_f32_16x16x32_bf16 v[16:19], v[28:31], v[72:75], v[16:19]
    v_mfma_f32_16x16x32_bf16 v[16:19], v[28:31], v[76:79], v[16:19]
    buffer_load_dwordx4 v6, s[12:15], s65 offen lds
    ds_read_b64 v[36:37], v26 offset:0
    v_mfma_f32_16x16x32_bf16 v[196:199], v[72:75], v[44:47], v[196:199]
    s_setprio 1
    ds_read_b64 v[38:39], v26 offset:128
    s_add_u32 s65, s65, 229376
    v_mfma_f32_16x16x32_bf16 v[196:199], v[76:79], v[60:63], v[196:199]
    s_setprio 0
    ds_read_b64 v[12:13], v26 offset:256
    v_mfma_f32_16x16x32_bf16 v[192:195], v[76:79], v[56:59], v[192:195]
    s_setprio 1
    ds_read_b64 v[14:15], v26 offset:384
    s_add_u32 m0, s29, 36480
    v_mfma_f32_16x16x32_bf16 v[192:195], v[72:75], v[40:43], v[192:195]
    s_setprio 0
    v_mov_b32 v114, 0
    ds_read_b64_tr_b16 v[72:73], v10 offset:51072
    buffer_load_dwordx4 v6, s[12:15], s65 offen lds
    v_mfma_f32_16x16x32_bf16 v[224:227], v[80:83], v[40:43], v[224:227]
    s_setprio 1
    ds_read_b64_tr_b16 v[74:75], v10 offset:54656
    s_sub_u32 s65, s65, 229376
    v_mfma_f32_16x16x32_bf16 v[224:227], v[84:87], v[56:59], v[224:227]
    s_setprio 0
    ds_read_b64_tr_b16 v[76:77], v10 offset:43808
    v_mfma_f32_16x16x32_bf16 v[228:231], v[84:87], v[60:63], v[228:231]
    s_setprio 1
    ds_read_b64_tr_b16 v[78:79], v10 offset:47392
    v_mfma_f32_16x16x32_bf16 v[228:231], v[80:83], v[44:47], v[228:231]
    s_setprio 0
    v_mov_b32 v115, 0
    v_mfma_f32_16x16x32_bf16 v[232:235], v[80:83], v[48:51], v[232:235]
    s_setprio 1
    v_mfma_f32_16x16x32_bf16 v[232:235], v[84:87], v[64:67], v[232:235]
    s_setprio 0
    v_mfma_f32_16x16x32_bf16 v[236:239], v[84:87], v[68:71], v[236:239]
    s_setprio 1
    s_add_u32 m0, s28, 0
    v_mfma_f32_16x16x32_bf16 v[236:239], v[80:83], v[52:55], v[236:239]
    s_setprio 0
    ds_read_b64_tr_b16 v[80:81], v10 offset:51104
    buffer_load_dwordx4 v4, s[8:11], s64 offen offset:0 sc1 lds
    s_waitcnt lgkmcnt(3)
    v_mfma_f32_16x16x32_bf16 v[156:159], v[88:91], v[52:55], v[156:159]
    s_setprio 1
    ds_read_b64_tr_b16 v[82:83], v10 offset:54688
    v_mfma_f32_16x16x32_bf16 v[156:159], v[72:75], v[68:71], v[156:159]
    s_setprio 0
    ds_read_b64_tr_b16 v[84:85], v10 offset:43840
    v_mfma_f32_16x16x32_bf16 v[152:155], v[72:75], v[64:67], v[152:155]
    s_setprio 1
    ds_read_b64_tr_b16 v[86:87], v10 offset:47424
    s_add_u32 m0, s28, 0
    v_mfma_f32_16x16x32_bf16 v[152:155], v[88:91], v[48:51], v[152:155]
    s_setprio 0
    buffer_load_dwordx4 v5, s[8:11], s64 offen offset:1024 sc1 lds
    v_mul_f32 v140, v140, v15
    v_mul_f32 v141, v141, v15
    v_mul_f32 v142, v142, v15
    v_mfma_f32_16x16x32_bf16 v[148:151], v[88:91], v[44:47], v[148:151]
    s_setprio 1
    v_mfma_f32_16x16x32_bf16 v[148:151], v[72:75], v[60:63], v[148:151]
    s_setprio 0
    v_mul_f32 v143, v143, v15
    v_mul_f32 v136, v136, v13
    v_mul_f32 v137, v137, v13
    v_mul_f32 v138, v138, v13
    v_mfma_f32_16x16x32_bf16 v[144:147], v[72:75], v[56:59], v[144:147]
    s_setprio 1
    s_add_u32 m0, s28, 0
    v_mfma_f32_16x16x32_bf16 v[144:147], v[88:91], v[40:43], v[144:147]
    s_setprio 0
    v_mul_f32 v139, v139, v13
    v_mul_f32 v132, v132, v39
    v_mul_f32 v133, v133, v39
    ds_read_b64_tr_b16 v[88:89], v10 offset:51136
    buffer_load_dwordx4 v4, s[8:11], s66 offen offset:2048 sc1 lds
    v_mul_f32 v134, v134, v39
    v_mul_f32 v135, v135, v39
    s_waitcnt lgkmcnt(3)
    v_mfma_f32_16x16x32_bf16 v[176:179], v[76:79], v[40:43], v[176:179]
    s_setprio 1
    ds_read_b64_tr_b16 v[90:91], v10 offset:54720
    v_mfma_f32_16x16x32_bf16 v[176:179], v[80:83], v[56:59], v[176:179]
    s_setprio 0
    v_mul_f32 v128, v128, v37
    v_mul_f32 v129, v129, v37
    ds_read_b64_tr_b16 v[72:73], v10 offset:43872
    v_mul_f32 v130, v130, v37
    v_mul_f32 v131, v131, v37
    v_mfma_f32_16x16x32_bf16 v[180:183], v[80:83], v[60:63], v[180:183]
    s_setprio 1
    ds_read_b64_tr_b16 v[74:75], v10 offset:47456
    s_add_u32 m0, s28, 0
    v_mfma_f32_16x16x32_bf16 v[180:183], v[76:79], v[44:47], v[180:183]
    s_setprio 0
    v_mul_f32 v160, v160, v37
    v_mul_f32 v161, v161, v37
    v_mul_f32 v162, v162, v37
    buffer_load_dwordx4 v5, s[8:11], s66 offen offset:3072 sc1 lds
    v_mul_f32 v163, v163, v37
    v_mul_f32 v164, v164, v39
    v_mfma_f32_16x16x32_bf16 v[184:187], v[76:79], v[48:51], v[184:187]
    s_setprio 1
    s_add_u32 s64, s64, 128
    s_bitset0_b32 s64, 11
    v_mfma_f32_16x16x32_bf16 v[184:187], v[80:83], v[64:67], v[184:187]
    s_setprio 0
    s_add_u32 s66, s64, 30720
    v_mul_f32 v165, v165, v39
    v_mul_f32 v166, v166, v39
    v_mul_f32 v167, v167, v39
    v_mul_f32 v168, v168, v13
    v_mul_f32 v169, v169, v13
    v_mfma_f32_16x16x32_bf16 v[188:191], v[80:83], v[68:71], v[188:191]
    s_setprio 1
    v_mfma_f32_16x16x32_bf16 v[188:191], v[76:79], v[52:55], v[188:191]
    s_setprio 0
    v_mul_f32 v170, v170, v13
    v_mul_f32 v171, v171, v13
    ds_read_b64_tr_b16 v[76:77], v10 offset:51168
    v_mul_f32 v172, v172, v15
    v_mul_f32 v173, v173, v15
    s_waitcnt lgkmcnt(3)
    v_mfma_f32_16x16x32_bf16 v[220:223], v[84:87], v[52:55], v[220:223]
    s_setprio 1
    ds_read_b64_tr_b16 v[78:79], v10 offset:54752
    v_mfma_f32_16x16x32_bf16 v[220:223], v[88:91], v[68:71], v[220:223]
    s_setprio 0
    v_mul_f32 v174, v174, v15
    v_mul_f32 v175, v175, v15
    v_mul_f32 v204, v204, v15
    v_mul_f32 v205, v205, v15
    v_mul_f32 v206, v206, v15
    s_waitcnt vmcnt(10) lgkmcnt(0)
    s_barrier
    v_mfma_f32_16x16x32_bf16 v[216:219], v[88:91], v[64:67], v[216:219]
    s_setprio 1
    ds_read_b64_tr_b16 v[80:81], v10 offset:0
    s_add_u32 m0, s29, 43776
    v_mfma_f32_16x16x32_bf16 v[216:219], v[84:87], v[48:51], v[216:219]
    s_setprio 0
    v_mfma_f32_16x16x32_bf16 v[20:23], v[28:31], v[84:87], v[20:23]
    v_mfma_f32_16x16x32_bf16 v[20:23], v[28:31], v[88:91], v[20:23]
    v_mul_f32 v207, v207, v15
    v_mul_f32 v200, v200, v13
    ds_read_b64_tr_b16 v[82:83], v10 offset:3584
    buffer_load_dwordx4 v6, s[16:19], s65 offen lds
    v_mul_f32 v201, v201, v13
    v_mul_f32 v202, v202, v13
    v_mfma_f32_16x16x32_bf16 v[212:215], v[84:87], v[44:47], v[212:215]
    s_setprio 1
    s_add_u32 s65, s65, 229376
    v_mfma_f32_16x16x32_bf16 v[212:215], v[88:91], v[60:63], v[212:215]
    s_setprio 0
    v_mul_f32 v203, v203, v13
    v_mul_f32 v196, v196, v39
    v_mul_f32 v197, v197, v39
    v_mul_f32 v198, v198, v39
    v_mul_f32 v199, v199, v39
    v_mfma_f32_16x16x32_bf16 v[208:211], v[88:91], v[56:59], v[208:211]
    s_setprio 1
    s_add_u32 m0, s29, 51072
    v_mfma_f32_16x16x32_bf16 v[208:211], v[84:87], v[40:43], v[208:211]
    s_setprio 0
    v_mul_f32 v192, v192, v37
    v_mul_f32 v193, v193, v37
    ds_read_b64_tr_b16 v[84:85], v10 offset:7296
    buffer_load_dwordx4 v6, s[16:19], s65 offen lds
    v_mul_f32 v194, v194, v37
    v_mul_f32 v195, v195, v37
    v_mfma_f32_16x16x32_bf16 v[240:243], v[72:75], v[40:43], v[240:243]
    s_setprio 1
    ds_read_b128 v[40:43], v8 offset:32768
    ds_read_b64_tr_b16 v[86:87], v10 offset:10880
    s_add_u32 s65, s65, 229376
    v_mfma_f32_16x16x32_bf16 v[240:243], v[76:79], v[56:59], v[240:243]
    s_setprio 0
    v_mul_f32 v224, v224, v37
    v_mul_f32 v225, v225, v37
    v_mul_f32 v226, v226, v37
    ds_read_b128 v[56:59], v9 offset:32768
    ds_read_b64_tr_b16 v[88:89], v10 offset:32
    v_mul_f32 v227, v227, v37
    v_mul_f32 v228, v228, v39
    v_mfma_f32_16x16x32_bf16 v[244:247], v[76:79], v[60:63], v[244:247]
    s_setprio 1
    ds_read_b128 v[60:63], v9 offset:34816
    ds_read_b64_tr_b16 v[90:91], v10 offset:3616
    s_mov_b32 m0, 145408
    v_mfma_f32_16x16x32_bf16 v[244:247], v[72:75], v[44:47], v[244:247]
    s_setprio 0
    v_mul_f32 v229, v229, v39
    v_mul_f32 v230, v230, v39
    ds_read_b128 v[44:47], v8 offset:34816
    buffer_load_dwordx4 v35, s[76:79], s37 offen  lds
    v_mul_f32 v231, v231, v39
    v_mul_f32 v232, v232, v13
    v_mul_f32 v233, v233, v13
    v_mfma_f32_16x16x32_bf16 v[248:251], v[72:75], v[48:51], v[248:251]
    s_setprio 1
    ds_read_b128 v[48:51], v8 offset:36864
    s_add_u32 s37, s37, 196608
    v_mfma_f32_16x16x32_bf16 v[248:251], v[76:79], v[64:67], v[248:251]
    s_setprio 0
    v_mul_f32 v234, v234, v13
    v_mul_f32 v235, v235, v13
    ds_read_b128 v[64:67], v9 offset:36864
    v_mul_f32 v236, v236, v15
    v_mul_f32 v237, v237, v15
    v_mfma_f32_16x16x32_bf16 v[252:255], v[76:79], v[68:71], v[252:255]
    s_setprio 1
    ds_read_b128 v[68:71], v9 offset:38912
    v_mfma_f32_16x16x32_bf16 v[252:255], v[72:75], v[52:55], v[252:255]
    s_setprio 0
    v_mul_f32 v238, v238, v15
    v_mul_f32 v239, v239, v15
    ds_read_b128 v[52:55], v8 offset:38912
    ds_read_b64_tr_b16 v[72:73], v10 offset:7328
    s_waitcnt lgkmcnt(9)
    v_mfma_f32_16x16x32_bf16 v[128:131], v[80:83], v[40:43], v[128:131]
    s_setprio 1
    ds_read_b64_tr_b16 v[74:75], v10 offset:10912
    v_mfma_f32_16x16x32_bf16 v[128:131], v[84:87], v[56:59], v[128:131]
    s_setprio 0
    v_mul_f32 v156, v156, v15
    v_mul_f32 v157, v157, v15
    ds_read_b64_tr_b16 v[76:77], v10 offset:64
    v_mul_f32 v158, v158, v15
    v_mul_f32 v159, v159, v15
    s_waitcnt lgkmcnt(7)
    v_mfma_f32_16x16x32_bf16 v[132:135], v[84:87], v[60:63], v[132:135]
    s_setprio 1
    ds_read_b64_tr_b16 v[78:79], v10 offset:3648
    s_mov_b32 m0, 151552
    v_mfma_f32_16x16x32_bf16 v[132:135], v[80:83], v[44:47], v[132:135]
    s_setprio 0
    v_mul_f32 v152, v152, v13
    ds_write2_b32 v27, v16, v20 offset1:64
    buffer_load_dwordx4 v35, s[76:79], s37 offen  lds
    v_mul_f32 v153, v153, v13
    v_mul_f32 v154, v154, v13
    s_waitcnt lgkmcnt(7)
    v_mfma_f32_16x16x32_bf16 v[136:139], v[80:83], v[48:51], v[136:139]
    s_setprio 1
    s_add_u32 s37, s37, 196608
    v_mfma_f32_16x16x32_bf16 v[136:139], v[84:87], v[64:67], v[136:139]
    s_setprio 0
    v_mul_f32 v155, v155, v13
    v_mul_f32 v148, v148, v39
    v_mul_f32 v149, v149, v39
    s_waitcnt lgkmcnt(5)
    v_mfma_f32_16x16x32_bf16 v[140:143], v[84:87], v[68:71], v[140:143]
    s_setprio 1
    v_mfma_f32_16x16x32_bf16 v[140:143], v[80:83], v[52:55], v[140:143]
    s_setprio 0
    v_mul_f32 v150, v150, v39
    v_mul_f32 v151, v151, v39
    ds_read_b64_tr_b16 v[80:81], v10 offset:7360
    v_mul_f32 v144, v144, v37
    v_mul_f32 v145, v145, v37
    s_waitcnt lgkmcnt(4)
    v_mfma_f32_16x16x32_bf16 v[172:175], v[88:91], v[52:55], v[172:175]
    s_setprio 1
    ds_read_b64_tr_b16 v[82:83], v10 offset:10944
    v_mfma_f32_16x16x32_bf16 v[172:175], v[72:75], v[68:71], v[172:175]
    s_setprio 0
    v_mul_f32 v146, v146, v37
    ds_read_b64_tr_b16 v[84:85], v10 offset:96
    v_mul_f32 v147, v147, v37
    v_mul_f32 v176, v176, v37
    v_mfma_f32_16x16x32_bf16 v[168:171], v[72:75], v[64:67], v[168:171]
    s_setprio 1
    ds_read_b64_tr_b16 v[86:87], v10 offset:3680
    v_mfma_f32_16x16x32_bf16 v[168:171], v[88:91], v[48:51], v[168:171]
    s_setprio 0
    v_mul_f32 v177, v177, v37
    v_mul_f32 v178, v178, v37
    v_mul_f32 v179, v179, v37
    v_mfma_f32_16x16x32_bf16 v[164:167], v[88:91], v[44:47], v[164:167]
    s_setprio 1
    v_mfma_f32_16x16x32_bf16 v[164:167], v[72:75], v[60:63], v[164:167]
    s_setprio 0
    v_mul_f32 v180, v180, v39
    v_mul_f32 v181, v181, v39
    v_mul_f32 v182, v182, v39
    v_mfma_f32_16x16x32_bf16 v[160:163], v[72:75], v[56:59], v[160:163]
    s_setprio 1
    v_mfma_f32_16x16x32_bf16 v[160:163], v[88:91], v[40:43], v[160:163]
    s_setprio 0
    v_mul_f32 v183, v183, v39
    v_mul_f32 v184, v184, v13
    ds_read_b64_tr_b16 v[88:89], v10 offset:7392
    v_mul_f32 v185, v185, v13
    v_mul_f32 v186, v186, v13
    s_waitcnt lgkmcnt(3)
    v_mfma_f32_16x16x32_bf16 v[192:195], v[76:79], v[40:43], v[192:195]
    s_setprio 1
    ds_read_b64_tr_b16 v[90:91], v10 offset:10976
    v_mfma_f32_16x16x32_bf16 v[192:195], v[80:83], v[56:59], v[192:195]
    s_setprio 0
    v_mul_f32 v187, v187, v13
    v_mul_f32 v188, v188, v15
    v_mul_f32 v189, v189, v15
    s_waitcnt vmcnt(10) lgkmcnt(0)
    s_barrier
    v_mfma_f32_16x16x32_bf16 v[196:199], v[80:83], v[60:63], v[196:199]
    s_setprio 1
    ds_read_b64_tr_b16 v[28:29], v92 offset:32768
    s_add_u32 m0, s29, 0
    v_mfma_f32_16x16x32_bf16 v[196:199], v[76:79], v[44:47], v[196:199]
    s_setprio 0
    v_mul_f32 v190, v190, v15
    v_mul_f32 v191, v191, v15
    ds_read_b64_tr_b16 v[30:31], v92 offset:33792
    buffer_load_dwordx4 v6, s[12:15], s65 offen lds
    v_mul_f32 v220, v220, v15
    v_mfma_f32_16x16x32_bf16 v[200:203], v[76:79], v[48:51], v[200:203]
    s_setprio 1
    ds_read_b64_tr_b16 v[16:17], v92 offset:38912
    s_add_u32 s65, s65, 229376
    v_mfma_f32_16x16x32_bf16 v[200:203], v[80:83], v[64:67], v[200:203]
    s_setprio 0
    v_mul_f32 v221, v221, v15
    v_mul_f32 v222, v222, v15
    ds_read_b64_tr_b16 v[18:19], v92 offset:39936
    v_mul_f32 v223, v223, v15
    v_mul_f32 v216, v216, v13
    v_mfma_f32_16x16x32_bf16 v[204:207], v[80:83], v[68:71], v[204:207]
    s_setprio 1
    ds_read_b64_tr_b16 v[72:73], v32 offset:32768
    s_add_u32 m0, s29, 7296
    v_mfma_f32_16x16x32_bf16 v[204:207], v[76:79], v[52:55], v[204:207]
    s_setprio 0
    v_mul_f32 v217, v217, v13
    ds_read_b64_tr_b16 v[74:75], v32 offset:33792
    buffer_load_dwordx4 v6, s[12:15], s65 offen lds
    v_mul_f32 v218, v218, v13
    v_mul_f32 v219, v219, v13
    v_mfma_f32_16x16x32_bf16 v[236:239], v[84:87], v[52:55], v[236:239]
    s_setprio 1
    ds_read_b64_tr_b16 v[76:77], v32 offset:38912
    s_sub_u32 s65, s65, 229376
    v_mfma_f32_16x16x32_bf16 v[236:239], v[88:91], v[68:71], v[236:239]
    s_setprio 0
    v_mul_f32 v212, v212, v39
    v_mul_f32 v213, v213, v39
    ds_read_b64_tr_b16 v[78:79], v32 offset:39936
    v_mul_f32 v214, v214, v39
    v_mfma_f32_16x16x32_bf16 v[232:235], v[88:91], v[64:67], v[232:235]
    s_setprio 1
    v_mfma_f32_16x16x32_bf16 v[232:235], v[84:87], v[48:51], v[232:235]
    s_setprio 0
    v_mul_f32 v215, v215, v39
    v_mul_f32 v208, v208, v37
    v_mul_f32 v209, v209, v37
    v_mfma_f32_16x16x32_bf16 v[228:231], v[84:87], v[44:47], v[228:231]
    s_setprio 1
    ds_read_b64_tr_b16 v[80:81], v10 offset:14592
    v_mfma_f32_16x16x32_bf16 v[228:231], v[88:91], v[60:63], v[228:231]
    s_setprio 0
    v_mul_f32 v210, v210, v37
    v_mul_f32 v211, v211, v37
    ds_read_b64_tr_b16 v[82:83], v10 offset:18176
    v_mul_f32 v240, v240, v37
    v_mul_f32 v241, v241, v37
    v_mfma_f32_16x16x32_bf16 v[224:227], v[88:91], v[56:59], v[224:227]
    s_setprio 1
    v_mfma_f32_16x16x32_bf16 v[224:227], v[84:87], v[40:43], v[224:227]
    s_setprio 0
    v_mul_f32 v242, v242, v37
    v_mul_f32 v243, v243, v37
    v_mul_f32 v244, v244, v39
    s_waitcnt lgkmcnt(6)
    v_mfma_f32_16x16x32_bf16 v[96:99], v[28:31], v[40:43], 0
    s_setprio 1
    ds_read_b64_tr_b16 v[84:85], v10 offset:21888
    v_mfma_f32_16x16x32_bf16 v[96:99], v[16:19], v[56:59], v[96:99]
    s_setprio 0
    v_mul_f32 v245, v245, v39
    v_mul_f32 v246, v246, v39
    ds_read_b64_tr_b16 v[86:87], v10 offset:25472
    v_mul_f32 v247, v247, v39
    v_mfma_f32_16x16x32_bf16 v[100:103], v[16:19], v[60:63], 0
    s_setprio 1
    s_add_u32 m0, s28, 32768
    v_mfma_f32_16x16x32_bf16 v[100:103], v[28:31], v[44:47], v[100:103]
    s_setprio 0
    v_mul_f32 v248, v248, v13
    v_mul_f32 v249, v249, v13
    buffer_load_dwordx4 v4, s[8:11], s64 offen offset:0 sc1 lds
    v_mul_f32 v250, v250, v13
    v_mul_f32 v251, v251, v13
    v_mfma_f32_16x16x32_bf16 v[104:107], v[28:31], v[48:51], 0
    s_setprio 1
    ds_read_b64_tr_b16 v[88:89], v10 offset:14624
    v_mfma_f32_16x16x32_bf16 v[104:107], v[16:19], v[64:67], v[104:107]
    s_setprio 0
    v_mul_f32 v252, v252, v15
    ds_read_b64_tr_b16 v[90:91], v10 offset:18208
    v_mul_f32 v253, v253, v15
    v_mul_f32 v254, v254, v15
    v_mfma_f32_16x16x32_bf16 v[108:111], v[16:19], v[68:71], 0
    s_setprio 1
    v_mfma_f32_16x16x32_bf16 v[108:111], v[28:31], v[52:55], v[108:111]
    s_setprio 0
    v_mul_f32 v255, v255, v15
    s_nop 1
L_loop2:
    s_waitcnt lgkmcnt(6)
    v_mfma_f32_16x16x32_bf16 v[124:127], v[72:75], v[52:55], v[124:127]
    s_setprio 1
    ds_read_b64_tr_b16 v[28:29], v10 offset:21920
    v_mfma_f32_16x16x32_bf16 v[124:127], v[76:79], v[68:71], v[124:127]
    s_setprio 0
    ds_read_b64_tr_b16 v[30:31], v10 offset:25504
    v_mfma_f32_16x16x32_bf16 v[120:123], v[76:79], v[64:67], v[120:123]
    s_setprio 1
    s_add_u32 m0, s28, 32768
    v_mfma_f32_16x16x32_bf16 v[120:123], v[72:75], v[48:51], v[120:123]
    s_setprio 0
    buffer_load_dwordx4 v5, s[8:11], s64 offen offset:1024 sc1 lds
    v_mfma_f32_16x16x32_bf16 v[116:119], v[72:75], v[44:47], v[116:119]
    s_setprio 1
    v_mfma_f32_16x16x32_bf16 v[116:119], v[76:79], v[60:63], v[116:119]
    s_setprio 0
    v_mfma_f32_16x16x32_bf16 v[112:115], v[76:79], v[56:59], v[112:115]
    s_setprio 1
    v_mfma_f32_16x16x32_bf16 v[112:115], v[72:75], v[40:43], v[112:115]
    s_setprio 0
    ds_read_b64_tr_b16 v[72:73], v10 offset:14656
    s_waitcnt lgkmcnt(5)
    v_mfma_f32_16x16x32_bf16 v[144:147], v[80:83], v[40:43], v[144:147]
    s_setprio 1
    ds_read_b64_tr_b16 v[74:75], v10 offset:18240
    v_mfma_f32_16x16x32_bf16 v[144:147], v[84:87], v[56:59], v[144:147]
    s_setprio 0
    ds_read_b64_tr_b16 v[76:77], v10 offset:21952
    v_mfma_f32_16x16x32_bf16 v[148:151], v[84:87], v[60:63], v[148:151]
    s_setprio 1
    ds_read_b64_tr_b16 v[78:79], v10 offset:25536
    s_add_u32 m0, s28, 32768
    v_mfma_f32_16x16x32_bf16 v[148:151], v[80:83], v[44:47], v[148:151]
    s_setprio 0
    buffer_load_dwordx4 v4, s[8:11], s66 offen offset:2048 sc1 lds
    v_mfma_f32_16x16x32_bf16 v[152:155], v[80:83], v[48:51], v[152:155]
    s_setprio 1
    v_mfma_f32_16x16x32_bf16 v[152:155], v[84:87], v[64:67], v[152:155]
    s_setprio 0
    v_mfma_f32_16x16x32_bf16 v[156:159], v[84:87], v[68:71], v[156:159]
    s_setprio 1
    v_mfma_f32_16x16x32_bf16 v[156:159], v[80:83], v[52:55], v[156:159]
    s_setprio 0
    ds_read_b64_tr_b16 v[80:81], v10 offset:14688
    s_waitcnt lgkmcnt(5)
    v_mfma_f32_16x16x32_bf16 v[188:191], v[88:91], v[52:55], v[188:191]
    s_setprio 1
    ds_read_b64_tr_b16 v[82:83], v10 offset:18272
    v_mfma_f32_16x16x32_bf16 v[188:191], v[28:31], v[68:71], v[188:191]
    s_setprio 0
    ds_read_b64_tr_b16 v[84:85], v10 offset:21984
    v_mfma_f32_16x16x32_bf16 v[184:187], v[28:31], v[64:67], v[184:187]
    s_setprio 1
    ds_read_b64_tr_b16 v[86:87], v10 offset:25568
    s_add_u32 m0, s28, 32768
    v_mfma_f32_16x16x32_bf16 v[184:187], v[88:91], v[48:51], v[184:187]
    s_setprio 0
    buffer_load_dwordx4 v5, s[8:11], s66 offen offset:3072 sc1 lds
    v_mfma_f32_16x16x32_bf16 v[180:183], v[88:91], v[44:47], v[180:183]
    s_setprio 1
    s_add_u32 s64, s64, 128
    s_bitset0_b32 s64, 11
    v_mfma_f32_16x16x32_bf16 v[180:183], v[28:31], v[60:63], v[180:183]
    s_setprio 0
    s_add_u32 s66, s64, 30720
    s_waitcnt vmcnt(10) lgkmcnt(0)
    s_barrier
    v_mfma_f32_16x16x32_bf16 v[176:179], v[28:31], v[56:59], v[176:179]
    s_setprio 1
    ds_read_b128 v[12:15], v8 offset:6144
    s_add_u32 m0, s29, 14592
    v_mfma_f32_16x16x32_bf16 v[176:179], v[88:91], v[40:43], v[176:179]
    s_setprio 0
    ds_read_b64_tr_b16 v[88:89], v10 offset:29184
    buffer_load_dwordx4 v6, s[16:19], s65 offen lds
    v_mfma_f32_16x16x32_bf16 v[208:211], v[72:75], v[40:43], v[208:211]
    s_setprio 1
    ds_read_b64_tr_b16 v[90:91], v10 offset:32768
    s_add_u32 s65, s65, 229376
    v_mfma_f32_16x16x32_bf16 v[208:211], v[76:79], v[56:59], v[208:211]
    s_setprio 0
    ds_read_b64_tr_b16 v[28:29], v10 offset:36480
    v_mfma_f32_16x16x32_bf16 v[212:215], v[76:79], v[60:63], v[212:215]
    s_setprio 1
    ds_read_b64_tr_b16 v[30:31], v10 offset:40064
    v_mfma_f32_16x16x32_bf16 v[212:215], v[72:75], v[44:47], v[212:215]
    s_setprio 0
    ds_read_b128 v[36:39], v9 offset:6144
    v_mfma_f32_16x16x32_bf16 v[216:219], v[72:75], v[48:51], v[216:219]
    s_setprio 1
    ds_read_b64_tr_b16 v[16:17], v10 offset:29216
    v_mfma_f32_16x16x32_bf16 v[216:219], v[76:79], v[64:67], v[216:219]
    s_setprio 0
    ds_read_b64_tr_b16 v[18:19], v10 offset:32800
    v_mfma_f32_16x16x32_bf16 v[220:223], v[76:79], v[68:71], v[220:223]
    s_setprio 1
    s_add_u32 m0, s29, 21888
    v_mfma_f32_16x16x32_bf16 v[220:223], v[72:75], v[52:55], v[220:223]
    s_setprio 0
    buffer_load_dwordx4 v6, s[16:19], s65 offen lds
    v_mfma_f32_16x16x32_bf16 v[252:255], v[80:83], v[52:55], v[252:255]
    s_setprio 1
    ds_read_b128 v[52:55], v9 offset:4096
    ds_read_b64_tr_b16 v[72:73], v10 offset:36512
    s_add_u32 s65, s65, 229376
    v_mfma_f32_16x16x32_bf16 v[252:255], v[84:87], v[68:71], v[252:255]
    s_setprio 0
    ds_read_b128 v[68:71], v8 offset:4096
    ds_read_b64_tr_b16 v[74:75], v10 offset:40096
    v_mfma_f32_16x16x32_bf16 v[248:251], v[84:87], v[64:67], v[248:251]
    s_setprio 1
    ds_read_b128 v[64:67], v8 offset:2048
    v_mfma_f32_16x16x32_bf16 v[248:251], v[80:83], v[48:51], v[248:251]
    s_setprio 0
    ds_read_b128 v[48:51], v9 offset:2048
    v_mfma_f32_16x16x32_bf16 v[244:247], v[80:83], v[44:47], v[244:247]
    s_setprio 1
    ds_read_b128 v[44:47], v9 offset:0
    ds_read_b64_tr_b16 v[76:77], v10 offset:29248
    v_mfma_f32_16x16x32_bf16 v[244:247], v[84:87], v[60:63], v[244:247]
    s_setprio 0
    ds_read_b128 v[60:63], v8 offset:0
    ds_read_b64_tr_b16 v[78:79], v10 offset:32832
    v_mfma_f32_16x16x32_bf16 v[240:243], v[84:87], v[56:59], v[240:243]
    s_setprio 1
    s_mov_b32 m0, 133120
    v_mfma_f32_16x16x32_bf16 v[240:243], v[80:83], v[40:43], v[240:243]
    s_setprio 0
    buffer_load_dwordx4 v35, s[76:79], s37 offen  lds
    s_add_u32 s37, s37, 196608
    s_waitcnt lgkmcnt(12)
    v_mfma_f32_16x16x32_bf16 v[140:143], v[88:91], v[12:15], v[140:143]
    s_setprio 1
    ds_read_b64_tr_b16 v[80:81], v10 offset:36544
    v_mfma_f32_16x16x32_bf16 v[140:143], v[28:31], v[36:39], v[140:143]
    s_setprio 0
    ds_read_b64_tr_b16 v[82:83], v10 offset:40128
    s_waitcnt lgkmcnt(9)
    v_mfma_f32_16x16x32_bf16 v[136:139], v[28:31], v[52:55], v[136:139]
    s_setprio 1
    v_mfma_f32_16x16x32_bf16 v[136:139], v[88:91], v[68:71], v[136:139]
    s_setprio 0
    s_waitcnt lgkmcnt(6)
    v_mfma_f32_16x16x32_bf16 v[132:135], v[88:91], v[64:67], v[132:135]
    s_setprio 1
    ds_read_b64_tr_b16 v[84:85], v10 offset:29280
    v_mfma_f32_16x16x32_bf16 v[132:135], v[28:31], v[48:51], v[132:135]
    s_setprio 0
    ds_read_b64_tr_b16 v[86:87], v10 offset:32864
    s_waitcnt lgkmcnt(5)
    v_mfma_f32_16x16x32_bf16 v[128:131], v[28:31], v[44:47], v[128:131]
    s_setprio 1
    s_mov_b32 m0, 139264
    v_mfma_f32_16x16x32_bf16 v[128:131], v[88:91], v[60:63], v[128:131]
    s_setprio 0
    buffer_load_dwordx4 v35, s[76:79], s37 offen  lds
    v_mfma_f32_16x16x32_bf16 v[160:163], v[16:19], v[60:63], v[160:163]
    s_setprio 1
    ds_read_b64_tr_b16 v[88:89], v10 offset:36576
    s_add_u32 s37, s37, 196608
    v_mfma_f32_16x16x32_bf16 v[160:163], v[72:75], v[44:47], v[160:163]
    s_setprio 0
    ds_read_b64_tr_b16 v[90:91], v10 offset:40160
    v_mfma_f32_16x16x32_bf16 v[164:167], v[72:75], v[48:51], v[164:167]
    s_setprio 1
    v_mfma_f32_16x16x32_bf16 v[164:167], v[16:19], v[64:67], v[164:167]
    s_setprio 0
    v_mfma_f32_16x16x32_bf16 v[168:171], v[16:19], v[68:71], v[168:171]
    s_setprio 1
    v_mfma_f32_16x16x32_bf16 v[168:171], v[72:75], v[52:55], v[168:171]
    s_setprio 0
    s_waitcnt vmcnt(10) lgkmcnt(0)
    s_barrier
    v_mfma_f32_16x16x32_bf16 v[172:175], v[72:75], v[36:39], v[172:175]
    s_setprio 1
    ds_read_b64_tr_b16 v[28:29], v92 offset:45056
    s_add_u32 m0, s29, 29184
    v_mfma_f32_16x16x32_bf16 v[172:175], v[16:19], v[12:15], v[172:175]
    s_setprio 0
    ds_read_b64_tr_b16 v[30:31], v92 offset:46080
    buffer_load_dwordx4 v6, s[12:15], s65 offen lds
    v_mfma_f32_16x16x32_bf16 v[204:207], v[76:79], v[12:15], v[204:207]
    s_setprio 1
    ds_read_b64_tr_b16 v[16:17], v92 offset:51200
    s_add_u32 s65, s65, 229376
    v_mfma_f32_16x16x32_bf16 v[204:207], v[80:83], v[36:39], v[204:207]
    s_setprio 0
    ds_read_b64_tr_b16 v[18:19], v92 offset:52224
    v_mfma_f32_16x16x32_bf16 v[200:203], v[80:83], v[52:55], v[200:203]
    s_setprio 1
    v_mfma_f32_16x16x32_bf16 v[200:203], v[76:79], v[68:71], v[200:203]
    s_setprio 0
    v_mfma_f32_16x16x32_bf16 v[196:199], v[76:79], v[64:67], v[196:199]
    s_setprio 1
    ds_read_b64_tr_b16 v[72:73], v32 offset:45056
    v_mfma_f32_16x16x32_bf16 v[196:199], v[80:83], v[48:51], v[196:199]
    s_setprio 0
    ds_read_b64_tr_b16 v[74:75], v32 offset:46080
    v_mfma_f32_16x16x32_bf16 v[192:195], v[80:83], v[44:47], v[192:195]
    s_setprio 1
    s_add_u32 m0, s29, 36480
    v_mfma_f32_16x16x32_bf16 v[192:195], v[76:79], v[60:63], v[192:195]
    s_setprio 0
    buffer_load_dwordx4 v6, s[12:15], s65 offen lds
    v_mfma_f32_16x16x32_bf16 v[224:227], v[84:87], v[60:63], v[224:227]
    s_setprio 1
    ds_read_b64_tr_b16 v[76:77], v32 offset:51200
    s_sub_u32 s65, s65, 229376
    v_mfma_f32_16x16x32_bf16 v[224:227], v[88:91], v[44:47], v[224:227]
    s_setprio 0
    ds_read_b64_tr_b16 v[78:79], v32 offset:52224
    v_mfma_f32_16x16x32_bf16 v[228:231], v[88:91], v[48:51], v[228:231]
    s_setprio 1
    v_mfma_f32_16x16x32_bf16 v[228:231], v[84:87], v[64:67], v[228:231]
    s_setprio 0
    v_mfma_f32_16x16x32_bf16 v[232:235], v[84:87], v[68:71], v[232:235]
    s_setprio 1
    ds_read_b64_tr_b16 v[80:81], v10 offset:43776
    v_mfma_f32_16x16x32_bf16 v[232:235], v[88:91], v[52:55], v[232:235]
    s_setprio 0
    ds_read_b64_tr_b16 v[82:83], v10 offset:47360
    v_mfma_f32_16x16x32_bf16 v[236:239], v[88:91], v[36:39], v[236:239]
    s_setprio 1
    v_mfma_f32_16x16x32_bf16 v[236:239], v[84:87], v[12:15], v[236:239]
    s_setprio 0
    s_waitcnt lgkmcnt(6)
    v_mfma_f32_16x16x32_bf16 v[108:111], v[28:31], v[12:15], v[108:111]
    s_setprio 1
    ds_read_b64_tr_b16 v[84:85], v10 offset:51072
    v_mfma_f32_16x16x32_bf16 v[108:111], v[16:19], v[36:39], v[108:111]
    s_setprio 0
    ds_read_b64_tr_b16 v[86:87], v10 offset:54656
    v_mfma_f32_16x16x32_bf16 v[104:107], v[16:19], v[52:55], v[104:107]
    s_setprio 1
    s_add_u32 m0, s28, 0
    v_mfma_f32_16x16x32_bf16 v[104:107], v[28:31], v[68:71], v[104:107]
    s_setprio 0
    buffer_load_dwordx4 v4, s[8:11], s64 offen offset:0 sc1 lds
    v_mfma_f32_16x16x32_bf16 v[100:103], v[28:31], v[64:67], v[100:103]
    s_setprio 1
    ds_read_b64_tr_b16 v[88:89], v10 offset:43808
    v_mfma_f32_16x16x32_bf16 v[100:103], v[16:19], v[48:51], v[100:103]
    s_setprio 0
    ds_read_b64_tr_b16 v[90:91], v10 offset:47392
    v_mfma_f32_16x16x32_bf16 v[96:99], v[16:19], v[44:47], v[96:99]
    s_setprio 1
    v_mfma_f32_16x16x32_bf16 v[96:99], v[28:31], v[60:63], v[96:99]
    s_setprio 0
    s_waitcnt lgkmcnt(6)
    v_mfma_f32_16x16x32_bf16 v[112:115], v[72:75], v[60:63], v[112:115]
    s_setprio 1
    ds_read_b64_tr_b16 v[28:29], v10 offset:51104
    v_mfma_f32_16x16x32_bf16 v[112:115], v[76:79], v[44:47], v[112:115]
    s_setprio 0
    ds_read_b64_tr_b16 v[30:31], v10 offset:54688
    v_mfma_f32_16x16x32_bf16 v[116:119], v[76:79], v[48:51], v[116:119]
    s_setprio 1
    s_add_u32 m0, s28, 0
    v_mfma_f32_16x16x32_bf16 v[116:119], v[72:75], v[64:67], v[116:119]
    s_setprio 0
    buffer_load_dwordx4 v5, s[8:11], s64 offen offset:1024 sc1 lds
    v_mfma_f32_16x16x32_bf16 v[120:123], v[72:75], v[68:71], v[120:123]
    s_setprio 1
    v_mfma_f32_16x16x32_bf16 v[120:123], v[76:79], v[52:55], v[120:123]
    s_setprio 0
    v_mfma_f32_16x16x32_bf16 v[124:127], v[76:79], v[36:39], v[124:127]
    s_setprio 1
    v_mfma_f32_16x16x32_bf16 v[124:127], v[72:75], v[12:15], v[124:127]
    s_setprio 0
    ds_read_b64_tr_b16 v[72:73], v10 offset:43840
    s_waitcnt lgkmcnt(5)
    v_mfma_f32_16x16x32_bf16 v[156:159], v[80:83], v[12:15], v[156:159]
    s_setprio 1
    ds_read_b64_tr_b16 v[74:75], v10 offset:47424
    v_mfma_f32_16x16x32_bf16 v[156:159], v[84:87], v[36:39], v[156:159]
    s_setprio 0
    ds_read_b64_tr_b16 v[76:77], v10 offset:51136
    v_mfma_f32_16x16x32_bf16 v[152:155], v[84:87], v[52:55], v[152:155]
    s_setprio 1
    ds_read_b64_tr_b16 v[78:79], v10 offset:54720
    s_add_u32 m0, s28, 0
    v_mfma_f32_16x16x32_bf16 v[152:155], v[80:83], v[68:71], v[152:155]
    s_setprio 0
    buffer_load_dwordx4 v4, s[8:11], s66 offen offset:2048 sc1 lds
    v_mfma_f32_16x16x32_bf16 v[148:151], v[80:83], v[64:67], v[148:151]
    s_setprio 1
    v_mfma_f32_16x16x32_bf16 v[148:151], v[84:87], v[48:51], v[148:151]
    s_setprio 0
    v_mfma_f32_16x16x32_bf16 v[144:147], v[84:87], v[44:47], v[144:147]
    s_setprio 1
    v_mfma_f32_16x16x32_bf16 v[144:147], v[80:83], v[60:63], v[144:147]
    s_setprio 0
    ds_read_b64_tr_b16 v[80:81], v10 offset:43872
    s_waitcnt lgkmcnt(5)
    v_mfma_f32_16x16x32_bf16 v[176:179], v[88:91], v[60:63], v[176:179]
    s_setprio 1
    ds_read_b64_tr_b16 v[82:83], v10 offset:47456
    v_mfma_f32_16x16x32_bf16 v[176:179], v[28:31], v[44:47], v[176:179]
    s_setprio 0
    ds_read_b64_tr_b16 v[84:85], v10 offset:51168
    v_mfma_f32_16x16x32_bf16 v[180:183], v[28:31], v[48:51], v[180:183]
    s_setprio 1
    ds_read_b64_tr_b16 v[86:87], v10 offset:54752
    s_add_u32 m0, s28, 0
    v_mfma_f32_16x16x32_bf16 v[180:183], v[88:91], v[64:67], v[180:183]
    s_setprio 0
    buffer_load_dwordx4 v5, s[8:11], s66 offen offset:3072 sc1 lds
    v_mfma_f32_16x16x32_bf16 v[184:187], v[88:91], v[68:71], v[184:187]
    s_setprio 1
    s_add_u32 s64, s64, 128
    s_bitset0_b32 s64, 11
    v_mfma_f32_16x16x32_bf16 v[184:187], v[28:31], v[52:55], v[184:187]
    s_setprio 0
    s_add_u32 s66, s64, 30720
    s_waitcnt vmcnt(10) lgkmcnt(0)
    s_barrier
    v_mfma_f32_16x16x32_bf16 v[188:191], v[28:31], v[36:39], v[188:191]
    s_setprio 1
    ds_read_b128 v[40:43], v8 offset:32768
    s_add_u32 m0, s29, 43776
    v_mfma_f32_16x16x32_bf16 v[188:191], v[88:91], v[12:15], v[188:191]
    s_setprio 0
    ds_read_b64_tr_b16 v[88:89], v10 offset:0
    buffer_load_dwordx4 v6, s[16:19], s65 offen lds
    v_mfma_f32_16x16x32_bf16 v[220:223], v[72:75], v[12:15], v[220:223]
    s_setprio 1
    ds_read_b64_tr_b16 v[90:91], v10 offset:3584
    s_add_u32 s65, s65, 229376
    v_mfma_f32_16x16x32_bf16 v[220:223], v[76:79], v[36:39], v[220:223]
    s_setprio 0
    ds_read_b64_tr_b16 v[28:29], v10 offset:7296
    v_mfma_f32_16x16x32_bf16 v[216:219], v[76:79], v[52:55], v[216:219]
    s_setprio 1
    ds_read_b64_tr_b16 v[30:31], v10 offset:10880
    v_mfma_f32_16x16x32_bf16 v[216:219], v[72:75], v[68:71], v[216:219]
    s_setprio 0
    ds_read_b128 v[56:59], v9 offset:32768
    v_mfma_f32_16x16x32_bf16 v[212:215], v[72:75], v[64:67], v[212:215]
    s_setprio 1
    ds_read_b64_tr_b16 v[16:17], v10 offset:32
    v_mfma_f32_16x16x32_bf16 v[212:215], v[76:79], v[48:51], v[212:215]
    s_setprio 0
    ds_read_b64_tr_b16 v[18:19], v10 offset:3616
    v_mfma_f32_16x16x32_bf16 v[208:211], v[76:79], v[44:47], v[208:211]
    s_setprio 1
    s_add_u32 m0, s29, 51072
    v_mfma_f32_16x16x32_bf16 v[208:211], v[72:75], v[60:63], v[208:211]
    s_setprio 0
    buffer_load_dwordx4 v6, s[16:19], s65 offen lds
    v_mfma_f32_16x16x32_bf16 v[240:243], v[80:83], v[60:63], v[240:243]
    s_setprio 1
    ds_read_b128 v[60:63], v9 offset:34816
    ds_read_b64_tr_b16 v[72:73], v10 offset:7328
    s_add_u32 s65, s65, 229376
    v_mfma_f32_16x16x32_bf16 v[240:243], v[84:87], v[44:47], v[240:243]
    s_setprio 0
    ds_read_b128 v[44:47], v8 offset:34816
    ds_read_b64_tr_b16 v[74:75], v10 offset:10912
    v_mfma_f32_16x16x32_bf16 v[244:247], v[84:87], v[48:51], v[244:247]
    s_setprio 1
    ds_read_b128 v[48:51], v8 offset:36864
    v_mfma_f32_16x16x32_bf16 v[244:247], v[80:83], v[64:67], v[244:247]
    s_setprio 0
    ds_read_b128 v[64:67], v9 offset:36864
    v_mfma_f32_16x16x32_bf16 v[248:251], v[80:83], v[68:71], v[248:251]
    s_setprio 1
    ds_read_b128 v[68:71], v9 offset:38912
    ds_read_b64_tr_b16 v[76:77], v10 offset:64
    v_mfma_f32_16x16x32_bf16 v[248:251], v[84:87], v[52:55], v[248:251]
    s_setprio 0
    ds_read_b128 v[52:55], v8 offset:38912
    ds_read_b64_tr_b16 v[78:79], v10 offset:3648
    v_mfma_f32_16x16x32_bf16 v[252:255], v[84:87], v[36:39], v[252:255]
    s_setprio 1
    s_mov_b32 m0, 145408
    v_mfma_f32_16x16x32_bf16 v[252:255], v[80:83], v[12:15], v[252:255]
    s_setprio 0
    buffer_load_dwordx4 v35, s[76:79], s37 offen  lds
    s_add_u32 s37, s37, 196608
    s_waitcnt lgkmcnt(12)
    v_mfma_f32_16x16x32_bf16 v[128:131], v[88:91], v[40:43], v[128:131]
    s_setprio 1
    ds_read_b64_tr_b16 v[80:81], v10 offset:7360
    v_mfma_f32_16x16x32_bf16 v[128:131], v[28:31], v[56:59], v[128:131]
    s_setprio 0
    ds_read_b64_tr_b16 v[82:83], v10 offset:10944
    s_waitcnt lgkmcnt(9)
    v_mfma_f32_16x16x32_bf16 v[132:135], v[28:31], v[60:63], v[132:135]
    s_setprio 1
    v_mfma_f32_16x16x32_bf16 v[132:135], v[88:91], v[44:47], v[132:135]
    s_setprio 0
    s_bitcmp1_b32 0x10, s36
    s_cbranch_scc1 L_h2p3_2
L_r2p3_2:
    s_waitcnt lgkmcnt(6)
    v_mfma_f32_16x16x32_bf16 v[136:139], v[88:91], v[48:51], v[136:139]
    s_setprio 1
    ds_read_b64_tr_b16 v[84:85], v10 offset:96
    v_mfma_f32_16x16x32_bf16 v[136:139], v[28:31], v[64:67], v[136:139]
    s_setprio 0
    ds_read_b64_tr_b16 v[86:87], v10 offset:3680
    s_waitcnt lgkmcnt(5)
    v_mfma_f32_16x16x32_bf16 v[140:143], v[28:31], v[68:71], v[140:143]
    s_setprio 1
    s_mov_b32 m0, 151552
    v_mfma_f32_16x16x32_bf16 v[140:143], v[88:91], v[52:55], v[140:143]
    s_setprio 0
    buffer_load_dwordx4 v35, s[76:79], s37 offen  lds
    v_mfma_f32_16x16x32_bf16 v[172:175], v[16:19], v[52:55], v[172:175]
    s_setprio 1
    ds_read_b64_tr_b16 v[88:89], v10 offset:7392
    s_add_u32 s37, s37, 196608
    v_mfma_f32_16x16x32_bf16 v[172:175], v[72:75], v[68:71], v[172:175]
    s_setprio 0
    ds_read_b64_tr_b16 v[90:91], v10 offset:10976
    v_mfma_f32_16x16x32_bf16 v[168:171], v[72:75], v[64:67], v[168:171]
    s_setprio 1
    v_mfma_f32_16x16x32_bf16 v[168:171], v[16:19], v[48:51], v[168:171]
    s_setprio 0
    v_mfma_f32_16x16x32_bf16 v[164:167], v[16:19], v[44:47], v[164:167]
    s_setprio 1
    v_mfma_f32_16x16x32_bf16 v[164:167], v[72:75], v[60:63], v[164:167]
    s_setprio 0
    s_waitcnt vmcnt(10) lgkmcnt(0)
    s_barrier
    v_mfma_f32_16x16x32_bf16 v[160:163], v[72:75], v[56:59], v[160:163]
    s_setprio 1
    ds_read_b64_tr_b16 v[28:29], v92 offset:32768
    s_add_u32 m0, s29, 0
    v_mfma_f32_16x16x32_bf16 v[160:163], v[16:19], v[40:43], v[160:163]
    s_setprio 0
    ds_read_b64_tr_b16 v[30:31], v92 offset:33792
    buffer_load_dwordx4 v6, s[12:15], s65 offen lds
    v_mfma_f32_16x16x32_bf16 v[192:195], v[76:79], v[40:43], v[192:195]
    s_setprio 1
    ds_read_b64_tr_b16 v[16:17], v92 offset:38912
    s_add_u32 s65, s65, 229376
    v_mfma_f32_16x16x32_bf16 v[192:195], v[80:83], v[56:59], v[192:195]
    s_setprio 0
    ds_read_b64_tr_b16 v[18:19], v92 offset:39936
    v_mfma_f32_16x16x32_bf16 v[196:199], v[80:83], v[60:63], v[196:199]
    s_setprio 1
    v_mfma_f32_16x16x32_bf16 v[196:199], v[76:79], v[44:47], v[196:199]
    s_setprio 0
    v_mfma_f32_16x16x32_bf16 v[200:203], v[76:79], v[48:51], v[200:203]
    s_setprio 1
    ds_read_b64_tr_b16 v[72:73], v32 offset:32768
    v_mfma_f32_16x16x32_bf16 v[200:203], v[80:83], v[64:67], v[200:203]
    s_setprio 0
    ds_read_b64_tr_b16 v[74:75], v32 offset:33792
    v_mfma_f32_16x16x32_bf16 v[204:207], v[80:83], v[68:71], v[204:207]
    s_setprio 1
    s_add_u32 m0, s29, 7296
    v_mfma_f32_16x16x32_bf16 v[204:207], v[76:79], v[52:55], v[204:207]
    s_setprio 0
    buffer_load_dwordx4 v6, s[12:15], s65 offen lds
    v_mfma_f32_16x16x32_bf16 v[236:239], v[84:87], v[52:55], v[236:239]
    s_setprio 1
    ds_read_b64_tr_b16 v[76:77], v32 offset:38912
    s_sub_u32 s65, s65, 229376
    v_mfma_f32_16x16x32_bf16 v[236:239], v[88:91], v[68:71], v[236:239]
    s_setprio 0
    ds_read_b64_tr_b16 v[78:79], v32 offset:39936
    v_mfma_f32_16x16x32_bf16 v[232:235], v[88:91], v[64:67], v[232:235]
    s_setprio 1
    v_mfma_f32_16x16x32_bf16 v[232:235], v[84:87], v[48:51], v[232:235]
    s_setprio 0
    v_mfma_f32_16x16x32_bf16 v[228:231], v[84:87], v[44:47], v[228:231]
    s_setprio 1
    ds_read_b64_tr_b16 v[80:81], v10 offset:14592
    v_mfma_f32_16x16x32_bf16 v[228:231], v[88:91], v[60:63], v[228:231]
    s_setprio 0
    ds_read_b64_tr_b16 v[82:83], v10 offset:18176
    v_mfma_f32_16x16x32_bf16 v[224:227], v[88:91], v[56:59], v[224:227]
    s_setprio 1
    v_mfma_f32_16x16x32_bf16 v[224:227], v[84:87], v[40:43], v[224:227]
    s_setprio 0
    s_waitcnt lgkmcnt(6)
    v_mfma_f32_16x16x32_bf16 v[96:99], v[28:31], v[40:43], v[96:99]
    s_setprio 1
    ds_read_b64_tr_b16 v[84:85], v10 offset:21888
    v_mfma_f32_16x16x32_bf16 v[96:99], v[16:19], v[56:59], v[96:99]
    s_setprio 0
    ds_read_b64_tr_b16 v[86:87], v10 offset:25472
    v_mfma_f32_16x16x32_bf16 v[100:103], v[16:19], v[60:63], v[100:103]
    s_setprio 1
    s_add_u32 m0, s28, 32768
    v_mfma_f32_16x16x32_bf16 v[100:103], v[28:31], v[44:47], v[100:103]
    s_setprio 0
    buffer_load_dwordx4 v4, s[8:11], s64 offen offset:0 sc1 lds
    v_mfma_f32_16x16x32_bf16 v[104:107], v[28:31], v[48:51], v[104:107]
    s_setprio 1
    ds_read_b64_tr_b16 v[88:89], v10 offset:14624
    v_mfma_f32_16x16x32_bf16 v[104:107], v[16:19], v[64:67], v[104:107]
    s_setprio 0
    ds_read_b64_tr_b16 v[90:91], v10 offset:18208
    v_mfma_f32_16x16x32_bf16 v[108:111], v[16:19], v[68:71], v[108:111]
    s_setprio 1
    v_mfma_f32_16x16x32_bf16 v[108:111], v[28:31], v[52:55], v[108:111]
    s_setprio 0
    s_add_u32 s36, s36, 1
    s_cmp_lt_u32 s36, 5
    s_cbranch_scc1 L_loop2
    s_mov_b32 s80, 983040
    s_mov_b32 s81, 1007616
    s_mov_b32 s82, 985088
    s_mov_b32 s29, 104448
    s_mov_b32 s37, 2048
    s_mov_b32 s83, 133120
    s_branch L_pb0
L_w3:
    s_barrier
    s_add_u32 m0, s28, 0
    s_nop 0
    buffer_load_dwordx4 v4, s[8:11], s64 offen offset:0 sc1 lds
    buffer_load_dwordx4 v5, s[8:11], s64 offen offset:1024 sc1 lds
    buffer_load_dwordx4 v4, s[8:11], s66 offen offset:2048 sc1 lds
    buffer_load_dwordx4 v5, s[8:11], s66 offen offset:3072 sc1 lds
    s_add_u32 s64, s64, 128
    s_bitset0_b32 s64, 11
    s_add_u32 s66, s64, 30720
    s_add_u32 m0, s29, 0
    s_nop 0
    buffer_load_dwordx4 v6, s[12:15], s65 offen lds
    s_add_u32 s65, s65, 229376
    s_add_u32 m0, s29, 7296
    s_nop 0
    buffer_load_dwordx4 v6, s[12:15], s65 offen lds
    s_sub_u32 s65, s65, 229376
    s_add_u32 m0, s29, 14592
    s_nop 0
    buffer_load_dwordx4 v6, s[16:19], s65 offen lds
    s_add_u32 s65, s65, 229376
    s_add_u32 m0, s29, 21888
    s_nop 0
    buffer_load_dwordx4 v6, s[16:19], s65 offen lds
    s_add_u32 s65, s65, 229376
    s_waitcnt vmcnt(9)
    v_lshlrev_b32 v112, 16, v104
    v_and_b32 v113, 0xffff0000, v104
    v_lshlrev_b32 v114, 16, v105
    v_and_b32 v115, 0xffff0000, v105
    v_lshlrev_b32 v116, 16, v106
    v_and_b32 v117, 0xffff0000, v106
    v_lshlrev_b32 v118, 16, v107
    v_and_b32 v119, 0xffff0000, v107
    v_lshlrev_b32 v120, 16, v108
    v_and_b32 v121, 0xffff0000, v108
    v_lshlrev_b32 v122, 16, v109
    v_and_b32 v123, 0xffff0000, v109
    v_lshlrev_b32 v124, 16, v110
    v_and_b32 v125, 0xffff0000, v110
    v_lshlrev_b32 v126, 16, v111
    v_and_b32 v127, 0xffff0000, v111
    v_add_f32 v36, v112, v116
    v_add_f32 v37, v113, v117
    v_add_f32 v38, v114, v118
    v_add_f32 v39, v115, v119
    v_add_f32 v36, v36, v120
    v_add_f32 v37, v37, v121
    v_add_f32 v38, v38, v122
    v_add_f32 v39, v39, v123
    v_add_f32 v36, v36, v124
    v_add_f32 v37, v37, v125
    v_add_f32 v38, v38, v126
    v_add_f32 v39, v39, v127
    v_add_f32 v36, v36, v37
    v_add_f32 v38, v38, v39
    v_add_f32 v34, v36, v38
    s_nop 1
    v_add_f32_dpp v34, v34, v34 row_ror:8 row_mask:0xf bank_mask:0xf
    s_nop 1
    v_add_f32_dpp v34, v34, v34 row_ror:4 row_mask:0xf bank_mask:0xf
    s_nop 1
    v_add_f32_dpp v34, v34, v34 row_ror:2 row_mask:0xf bank_mask:0xf
    s_nop 1
    v_add_f32_dpp v34, v34, v34 row_ror:1 row_mask:0xf bank_mask:0xf
    v_mov_b32 v36, v34
    s_nop 1
    v_permlane16_swap_b32 v34, v36
    v_add_f32 v34, v34, v36
    v_mov_b32 v36, v34
    s_nop 1
    v_permlane32_swap_b32 v34, v36
    v_add_f32 v34, v34, v36
    v_mul_f32 v34, 0x3a800000, v34
    v_cvt_pk_bf16_f32 v14, v34, v34
    v_and_b32 v14, 0xffff0000, v14
    v_sub_f32 v112, v112, v14
    v_sub_f32 v113, v113, v14
    v_sub_f32 v114, v114, v14
    v_sub_f32 v115, v115, v14
    v_sub_f32 v116, v116, v14
    v_sub_f32 v117, v117, v14
    v_sub_f32 v118, v118, v14
    v_sub_f32 v119, v119, v14
    v_sub_f32 v120, v120, v14
    v_sub_f32 v121, v121, v14
    v_sub_f32 v122, v122, v14
    v_sub_f32 v123, v123, v14
    v_sub_f32 v124, v124, v14
    v_sub_f32 v125, v125, v14
    v_sub_f32 v126, v126, v14
    v_sub_f32 v127, v127, v14
    v_mul_f32 v36, v112, v112
    v_mul_f32 v37, v113, v113
    v_mul_f32 v38, v114, v114
    v_mul_f32 v39, v115, v115
    v_fmac_f32 v36, v116, v116
    v_fmac_f32 v37, v117, v117
    v_fmac_f32 v38, v118, v118
    v_fmac_f32 v39, v119, v119
    v_fmac_f32 v36, v120, v120
    v_fmac_f32 v37, v121, v121
    v_fmac_f32 v38, v122, v122
    v_fmac_f32 v39, v123, v123
    v_fmac_f32 v36, v124, v124
    v_fmac_f32 v37, v125, v125
    v_fmac_f32 v38, v126, v126
    v_fmac_f32 v39, v127, v127
    v_add_f32 v36, v36, v37
    v_add_f32 v38, v38, v39
    v_sub_f32 v34, v34, v14
    v_add_f32 v12, v36, v38
    s_nop 1
    v_add_f32_dpp v12, v12, v12 row_ror:8 row_mask:0xf bank_mask:0xf
    v_cvt_pk_bf16_f32 v104, v112, v113
    s_nop 0
    v_add_f32_dpp v12, v12, v12 row_ror:4 row_mask:0xf bank_mask:0xf
    v_cvt_pk_bf16_f32 v105, v114, v115
    s_nop 0
    v_add_f32_dpp v12, v12, v12 row_ror:2 row_mask:0xf bank_mask:0xf
    v_cvt_pk_bf16_f32 v106, v116, v117
    s_nop 0
    v_add_f32_dpp v12, v12, v12 row_ror:1 row_mask:0xf bank_mask:0xf
    v_cvt_pk_bf16_f32 v107, v118, v119
    v_mov_b32 v36, v12
    v_cvt_pk_bf16_f32 v108, v120, v121
    s_nop 0
    v_permlane16_swap_b32 v12, v36
    v_cvt_pk_bf16_f32 v109, v122, v123
    v_add_f32 v12, v12, v36
    v_cvt_pk_bf16_f32 v110, v124, v125
    v_mov_b32 v36, v12
    v_cvt_pk_bf16_f32 v111, v126, v127
    s_nop 0
    v_permlane32_swap_b32 v12, v36
    v_lshlrev_b32 v112, 16, v104
    v_add_f32 v12, v12, v36
    v_and_b32 v113, 0xffff0000, v104
    v_mul_f32 v12, 0x3a800000, v12
    v_lshlrev_b32 v114, 16, v105
    v_fma_f32 v12, -v34, v34, v12
    v_and_b32 v115, 0xffff0000, v105
    v_max_f32 v12, 0, v12
    v_lshlrev_b32 v116, 16, v106
    v_cvt_pk_bf16_f32 v12, v12, v12
    v_and_b32 v117, 0xffff0000, v106
    v_and_b32 v12, 0xffff0000, v12
    v_lshlrev_b32 v118, 16, v107
    v_add_f32 v12, 0x3727c5ac, v12
    v_and_b32 v119, 0xffff0000, v107
    v_cvt_pk_bf16_f32 v12, v12, v12
    v_lshlrev_b32 v120, 16, v108
    v_and_b32 v12, 0xffff0000, v12
    v_and_b32 v121, 0xffff0000, v108
    v_sqrt_f32 v15, v12
    v_lshlrev_b32 v122, 16, v109
    v_cvt_pk_bf16_f32 v15, v15, v15
    v_and_b32 v123, 0xffff0000, v109
    v_and_b32 v15, 0xffff0000, v15
    v_lshlrev_b32 v124, 16, v110
    v_rcp_f32 v12, v15
    v_and_b32 v125, 0xffff0000, v110
    v_sub_f32 v14, 0, v14
    v_lshlrev_b32 v126, 16, v111
    v_and_b32 v127, 0xffff0000, v111
    v_mul_f32 v112, v112, v12
    v_mul_f32 v113, v113, v12
    v_mul_f32 v114, v114, v12
    v_mul_f32 v115, v115, v12
    v_mul_f32 v116, v116, v12
    v_mul_f32 v117, v117, v12
    v_mul_f32 v118, v118, v12
    v_mul_f32 v119, v119, v12
    v_mul_f32 v120, v120, v12
    v_mul_f32 v121, v121, v12
    v_mul_f32 v122, v122, v12
    v_mul_f32 v123, v123, v12
    v_mul_f32 v124, v124, v12
    v_mul_f32 v125, v125, v12
    v_mul_f32 v126, v126, v12
    v_mul_f32 v127, v127, v12
    v_cvt_pk_bf16_f32 v104, v112, v113
    v_cvt_pk_bf16_f32 v105, v114, v115
    v_cvt_pk_bf16_f32 v106, v116, v117
    v_cvt_pk_bf16_f32 v107, v118, v119
    v_cvt_pk_bf16_f32 v108, v120, v121
    v_cvt_pk_bf16_f32 v109, v122, v123
    v_cvt_pk_bf16_f32 v110, v124, v125
    v_cvt_pk_bf16_f32 v111, v126, v127
    buffer_store_dwordx4 v[104:107], v2, s[20:23], s3 offen offset:0 sc1
    buffer_store_dwordx4 v[108:111], v2, s[20:23], s3 offen offset:1024 sc1
    v_lshrrev_b32 v14, 16, v14
    v_or_b32 v14, v14, v15
    s_waitcnt vmcnt(10)
    s_mov_b32 s5, 0x9E3779B1
    v_mul_lo_u32 v33, v33, s5
    v_add_u32 v33, 0x7F4A7C15, v33
    s_nop 0
    v_readfirstlane_b32 s58, v33
    v_mov_b32 v15, v33
    s_waitcnt vmcnt(4)
    s_barrier
    ds_read_b128 v[40:43], v8 offset:0
    ds_read_b64_tr_b16 v[84:85], v10 offset:0
    ds_read_b64_tr_b16 v[86:87], v10 offset:3584
    ds_read_b128 v[56:59], v9 offset:0
    ds_read_b64_tr_b16 v[88:89], v10 offset:7296
    ds_read_b64_tr_b16 v[90:91], v10 offset:10880
    ds_read_b128 v[60:63], v9 offset:2048
    ds_read_b128 v[44:47], v8 offset:2048
    ds_read_b128 v[48:51], v8 offset:4096
    ds_read_b128 v[64:67], v9 offset:4096
    ds_read_b128 v[68:71], v9 offset:6144
    ds_read_b128 v[52:55], v8 offset:6144
    ds_read_b64_tr_b16 v[72:73], v10 offset:32
    ds_read_b64_tr_b16 v[74:75], v10 offset:3616
    ds_read_b64_tr_b16 v[76:77], v10 offset:7328
    ds_read_b64_tr_b16 v[78:79], v10 offset:10912
    s_mov_b32 s37, 1599488
    s_waitcnt lgkmcnt(10)
    v_mfma_f32_16x16x32_bf16 v[128:131], v[84:87], v[40:43], 0
    s_setprio 1
    ds_read_b64_tr_b16 v[80:81], v10 offset:64
    s_add_u32 m0, s28, 32768
    v_mfma_f32_16x16x32_bf16 v[128:131], v[88:91], v[56:59], v[128:131]
    s_setprio 0
    ds_read_b64_tr_b16 v[82:83], v10 offset:3648
    buffer_load_dwordx4 v4, s[8:11], s64 offen offset:0 sc1 lds
    s_waitcnt lgkmcnt(10)
    v_mfma_f32_16x16x32_bf16 v[132:135], v[88:91], v[60:63], 0
    s_setprio 1
    v_mfma_f32_16x16x32_bf16 v[132:135], v[84:87], v[44:47], v[132:135]
    s_setprio 0
    s_add_u32 m0, s28, 32768
    s_waitcnt lgkmcnt(8)
    v_mfma_f32_16x16x32_bf16 v[136:139], v[84:87], v[48:51], 0
    s_setprio 1
    v_mfma_f32_16x16x32_bf16 v[136:139], v[88:91], v[64:67], v[136:139]
    s_setprio 0
    buffer_load_dwordx4 v5, s[8:11], s64 offen offset:1024 sc1 lds
    s_waitcnt lgkmcnt(6)
    v_mfma_f32_16x16x32_bf16 v[140:143], v[88:91], v[68:71], 0
    s_setprio 1
    s_add_u32 m0, s28, 32768
    v_mfma_f32_16x16x32_bf16 v[140:143], v[84:87], v[52:55], v[140:143]
    s_setprio 0
    ds_read_b64_tr_b16 v[84:85], v10 offset:7360
    buffer_load_dwordx4 v4, s[8:11], s66 offen offset:2048 sc1 lds
    s_waitcnt lgkmcnt(3)
    v_mfma_f32_16x16x32_bf16 v[172:175], v[72:75], v[52:55], 0
    s_setprio 1
    ds_read_b64_tr_b16 v[86:87], v10 offset:10944
    v_mfma_f32_16x16x32_bf16 v[172:175], v[76:79], v[68:71], v[172:175]
    s_setprio 0
    ds_read_b64_tr_b16 v[88:89], v10 offset:96
    s_add_u32 m0, s28, 32768
    v_mfma_f32_16x16x32_bf16 v[168:171], v[76:79], v[64:67], 0
    s_setprio 1
    ds_read_b64_tr_b16 v[90:91], v10 offset:3680
    v_mfma_f32_16x16x32_bf16 v[168:171], v[72:75], v[48:51], v[168:171]
    s_setprio 0
    buffer_load_dwordx4 v5, s[8:11], s66 offen offset:3072 sc1 lds
    s_add_u32 s64, s64, 128
    s_bitset0_b32 s64, 11
    s_add_u32 s66, s64, 30720
    v_mfma_f32_16x16x32_bf16 v[164:167], v[72:75], v[44:47], 0
    s_setprio 1
    s_add_u32 m0, s29, 29184
    v_mfma_f32_16x16x32_bf16 v[164:167], v[76:79], v[60:63], v[164:167]
    s_setprio 0
    buffer_load_dwordx4 v6, s[12:15], s65 offen lds
    v_mfma_f32_16x16x32_bf16 v[160:163], v[76:79], v[56:59], 0
    s_setprio 1
    s_add_u32 s65, s65, 229376
    v_mfma_f32_16x16x32_bf16 v[160:163], v[72:75], v[40:43], v[160:163]
    s_setprio 0
    ds_read_b64_tr_b16 v[72:73], v10 offset:7392
    s_add_u32 m0, s29, 36480
    s_waitcnt lgkmcnt(3)
    v_mfma_f32_16x16x32_bf16 v[192:195], v[80:83], v[40:43], 0
    s_setprio 1
    ds_read_b64_tr_b16 v[74:75], v10 offset:10976
    v_mfma_f32_16x16x32_bf16 v[192:195], v[84:87], v[56:59], v[192:195]
    s_setprio 0
    buffer_load_dwordx4 v6, s[12:15], s65 offen lds
    s_sub_u32 s65, s65, 229376
    s_waitcnt vmcnt(8) lgkmcnt(0)
    s_barrier
    v_mfma_f32_16x16x32_bf16 v[196:199], v[84:87], v[60:63], 0
    s_setprio 1
    ds_read_b64_tr_b16 v[76:77], v10 offset:14592
    s_add_u32 m0, s29, 43776
    v_mfma_f32_16x16x32_bf16 v[196:199], v[80:83], v[44:47], v[196:199]
    s_setprio 0
    ds_read_b64_tr_b16 v[78:79], v10 offset:18176
    buffer_load_dwordx4 v6, s[16:19], s65 offen lds
    v_mfma_f32_16x16x32_bf16 v[200:203], v[80:83], v[48:51], 0
    s_setprio 1
    s_add_u32 s65, s65, 229376
    v_mfma_f32_16x16x32_bf16 v[200:203], v[84:87], v[64:67], v[200:203]
    s_setprio 0
    s_add_u32 m0, s29, 51072
    v_mfma_f32_16x16x32_bf16 v[204:207], v[84:87], v[68:71], 0
    s_setprio 1
    v_mfma_f32_16x16x32_bf16 v[204:207], v[80:83], v[52:55], v[204:207]
    s_setprio 0
    buffer_load_dwordx4 v6, s[16:19], s65 offen lds
    s_add_u32 s65, s65, 229376
    ds_read_b64_tr_b16 v[80:81], v10 offset:21888
    v_mfma_f32_16x16x32_bf16 v[236:239], v[88:91], v[52:55], 0
    s_setprio 1
    ds_read_b64_tr_b16 v[82:83], v10 offset:25472
    s_add_u32 m0, s29, 0
    v_mfma_f32_16x16x32_bf16 v[236:239], v[72:75], v[68:71], v[236:239]
    s_setprio 0
    ds_read_b64_tr_b16 v[84:85], v10 offset:14624
    buffer_load_dwordx4 v6, s[12:15], s65 offen lds
    v_mfma_f32_16x16x32_bf16 v[232:235], v[72:75], v[64:67], 0
    s_setprio 1
    ds_read_b64_tr_b16 v[86:87], v10 offset:18208
    s_add_u32 s65, s65, 229376
    v_mfma_f32_16x16x32_bf16 v[232:235], v[88:91], v[48:51], v[232:235]
    s_setprio 0
    v_mfma_f32_16x16x32_bf16 v[16:19], v[28:31], v[88:91], 0
    v_mfma_f32_16x16x32_bf16 v[16:19], v[28:31], v[72:75], v[16:19]
    s_add_u32 m0, s29, 7296
    v_mfma_f32_16x16x32_bf16 v[228:231], v[88:91], v[44:47], 0
    s_setprio 1
    v_mfma_f32_16x16x32_bf16 v[228:231], v[72:75], v[60:63], v[228:231]
    s_setprio 0
    buffer_load_dwordx4 v6, s[12:15], s65 offen lds
    s_sub_u32 s65, s65, 229376
    v_mfma_f32_16x16x32_bf16 v[224:227], v[72:75], v[56:59], 0
    s_setprio 1
    s_add_u32 m0, s28, 123904
    v_mfma_f32_16x16x32_bf16 v[224:227], v[88:91], v[40:43], v[224:227]
    s_setprio 0
    ds_read_b64_tr_b16 v[88:89], v10 offset:21920
    buffer_load_dwordx4 v4, s[8:11], s64 offen offset:0 sc1 lds
    s_waitcnt lgkmcnt(3)
    v_mfma_f32_16x16x32_bf16 v[144:147], v[76:79], v[40:43], 0
    s_setprio 1
    ds_read_b64_tr_b16 v[90:91], v10 offset:25504
    v_mfma_f32_16x16x32_bf16 v[144:147], v[80:83], v[56:59], v[144:147]
    s_setprio 0
    ds_read_b64_tr_b16 v[72:73], v10 offset:14656
    s_add_u32 m0, s28, 123904
    v_mfma_f32_16x16x32_bf16 v[148:151], v[80:83], v[60:63], 0
    s_setprio 1
    ds_read_b64_tr_b16 v[74:75], v10 offset:18240
    v_mfma_f32_16x16x32_bf16 v[148:151], v[76:79], v[44:47], v[148:151]
    s_setprio 0
    buffer_load_dwordx4 v5, s[8:11], s64 offen offset:1024 sc1 lds
    v_mfma_f32_16x16x32_bf16 v[152:155], v[76:79], v[48:51], 0
    s_setprio 1
    s_add_u32 m0, s28, 123904
    v_mfma_f32_16x16x32_bf16 v[152:155], v[80:83], v[64:67], v[152:155]
    s_setprio 0
    buffer_load_dwordx4 v4, s[8:11], s66 offen offset:2048 sc1 lds
    v_mfma_f32_16x16x32_bf16 v[156:159], v[80:83], v[68:71], 0
    s_setprio 1
    v_mfma_f32_16x16x32_bf16 v[156:159], v[76:79], v[52:55], v[156:159]
    s_setprio 0
    ds_read_b64_tr_b16 v[76:77], v10 offset:21952
    s_add_u32 m0, s28, 123904
    s_waitcnt lgkmcnt(3)
    v_mfma_f32_16x16x32_bf16 v[188:191], v[84:87], v[52:55], 0
    s_setprio 1
    ds_read_b64_tr_b16 v[78:79], v10 offset:25536
    v_mfma_f32_16x16x32_bf16 v[188:191], v[88:91], v[68:71], v[188:191]
    s_setprio 0
    buffer_load_dwordx4 v5, s[8:11], s66 offen offset:3072 sc1 lds
    s_add_u32 s64, s64, 128
    s_bitset0_b32 s64, 11
    s_add_u32 s66, s64, 30720
    s_waitcnt vmcnt(14)
    s_lshr_b32 s3, s3, 8
    s_add_u32 s3, s3, 3211264
    s_mov_b64 exec, 1
    buffer_store_dwordx2 v[14:15], off, s[24:27], s3 sc1
    s_mov_b64 exec, -1
    ds_read_b64_tr_b16 v[80:81], v10 offset:14688
    v_mfma_f32_16x16x32_bf16 v[184:187], v[88:91], v[64:67], 0
    s_setprio 1
    ds_read_b64_tr_b16 v[82:83], v10 offset:18272
    v_mfma_f32_16x16x32_bf16 v[184:187], v[84:87], v[48:51], v[184:187]
    s_setprio 0
    v_mfma_f32_16x16x32_bf16 v[180:183], v[84:87], v[44:47], 0
    s_setprio 1
    v_mfma_f32_16x16x32_bf16 v[180:183], v[88:91], v[60:63], v[180:183]
    s_setprio 0
    v_mfma_f32_16x16x32_bf16 v[176:179], v[88:91], v[56:59], 0
    s_setprio 1
    v_mfma_f32_16x16x32_bf16 v[176:179], v[84:87], v[40:43], v[176:179]
    s_setprio 0
    ds_read_b64_tr_b16 v[84:85], v10 offset:21984
    s_waitcnt lgkmcnt(3)
    v_mfma_f32_16x16x32_bf16 v[208:211], v[72:75], v[40:43], 0
    s_setprio 1
    ds_read_b64_tr_b16 v[86:87], v10 offset:25568
    v_mfma_f32_16x16x32_bf16 v[208:211], v[76:79], v[56:59], v[208:211]
    s_setprio 0
    s_waitcnt vmcnt(9) lgkmcnt(0)
    s_barrier
    s_add_u32 m0, s29, 14592
    v_mfma_f32_16x16x32_bf16 v[212:215], v[76:79], v[60:63], 0
    s_setprio 1
    ds_read_b64_tr_b16 v[88:89], v10 offset:29184
    v_mfma_f32_16x16x32_bf16 v[212:215], v[72:75], v[44:47], v[212:215]
    s_setprio 0
    buffer_load_dwordx4 v6, s[16:19], s65 offen lds
    s_add_u32 s65, s65, 229376
    ds_read_b64_tr_b16 v[90:91], v10 offset:32768
    v_mfma_f32_16x16x32_bf16 v[216:219], v[72:75], v[48:51], 0
    s_setprio 1
    s_add_u32 m0, s29, 21888
    v_mfma_f32_16x16x32_bf16 v[216:219], v[76:79], v[64:67], v[216:219]
    s_setprio 0
    buffer_load_dwordx4 v6, s[16:19], s65 offen lds
    v_mfma_f32_16x16x32_bf16 v[220:223], v[76:79], v[68:71], 0
    s_setprio 1
    s_add_u32 s65, s65, 229376
    v_mfma_f32_16x16x32_bf16 v[220:223], v[72:75], v[52:55], v[220:223]
    s_setprio 0
    ds_read_b64_tr_b16 v[72:73], v10 offset:36480
    s_mov_b32 m0, 28672
    v_mfma_f32_16x16x32_bf16 v[252:255], v[80:83], v[52:55], 0
    s_setprio 1
    ds_read_b128 v[52:55], v8 offset:38912
    ds_read_b64_tr_b16 v[74:75], v10 offset:40064
    v_mfma_f32_16x16x32_bf16 v[252:255], v[84:87], v[68:71], v[252:255]
    s_setprio 0
    s_add_u32 s5, s64, 262144
    buffer_load_dwordx4 v4, s[8:11], s5 offen offset:0 sc1 lds
    ds_read_b128 v[68:71], v9 offset:38912
    ds_read_b64_tr_b16 v[76:77], v10 offset:29216
    v_mfma_f32_16x16x32_bf16 v[248:251], v[84:87], v[64:67], 0
    s_setprio 1
    ds_read_b128 v[64:67], v9 offset:36864
    ds_read_b64_tr_b16 v[78:79], v10 offset:32800
    s_add_u32 m0, s28, 0
    v_mfma_f32_16x16x32_bf16 v[248:251], v[80:83], v[48:51], v[248:251]
    s_setprio 0
    ds_read_b128 v[48:51], v8 offset:36864
    v_mfma_f32_16x16x32_bf16 v[20:23], v[28:31], v[80:83], 0
    v_mfma_f32_16x16x32_bf16 v[20:23], v[28:31], v[84:87], v[20:23]
    buffer_load_dwordx4 v4, s[8:11], s64 offen offset:0 sc1 lds
    v_mfma_f32_16x16x32_bf16 v[244:247], v[80:83], v[44:47], 0
    s_setprio 1
    ds_read_b128 v[44:47], v8 offset:34816
    v_mfma_f32_16x16x32_bf16 v[244:247], v[84:87], v[60:63], v[244:247]
    s_setprio 0
    ds_read_b128 v[60:63], v9 offset:34816
    s_add_u32 m0, s28, 0
    v_mfma_f32_16x16x32_bf16 v[240:243], v[84:87], v[56:59], 0
    s_setprio 1
    ds_read_b128 v[56:59], v9 offset:32768
    v_mfma_f32_16x16x32_bf16 v[240:243], v[80:83], v[40:43], v[240:243]
    s_setprio 0
    buffer_load_dwordx4 v5, s[8:11], s64 offen offset:1024 sc1 lds
    ds_read_b128 v[40:43], v8 offset:32768
    ds_read_b64_tr_b16 v[80:81], v10 offset:36512
    s_waitcnt lgkmcnt(9)
    v_mfma_f32_16x16x32_bf16 v[140:143], v[88:91], v[52:55], v[140:143]
    s_setprio 1
    ds_read_b64_tr_b16 v[82:83], v10 offset:40096
    s_add_u32 m0, s28, 0
    v_mfma_f32_16x16x32_bf16 v[140:143], v[72:75], v[68:71], v[140:143]
    s_setprio 0
    ds_read_b64_tr_b16 v[84:85], v10 offset:29248
    buffer_load_dwordx4 v4, s[8:11], s66 offen offset:2048 sc1 lds
    s_waitcnt lgkmcnt(7)
    v_mfma_f32_16x16x32_bf16 v[136:139], v[72:75], v[64:67], v[136:139]
    s_setprio 1
    ds_read_b64_tr_b16 v[86:87], v10 offset:32832
    v_mfma_f32_16x16x32_bf16 v[136:139], v[88:91], v[48:51], v[136:139]
    s_setprio 0
    s_add_u32 m0, s28, 0
    s_waitcnt lgkmcnt(6)
    v_mfma_f32_16x16x32_bf16 v[132:135], v[88:91], v[44:47], v[132:135]
    s_setprio 1
    v_mfma_f32_16x16x32_bf16 v[132:135], v[72:75], v[60:63], v[132:135]
    s_setprio 0
    buffer_load_dwordx4 v5, s[8:11], s66 offen offset:3072 sc1 lds
    s_add_u32 s64, s64, 128
    s_bitset0_b32 s64, 11
    s_add_u32 s66, s64, 30720
    s_waitcnt lgkmcnt(4)
    v_mfma_f32_16x16x32_bf16 v[128:131], v[72:75], v[56:59], v[128:131]
    s_setprio 1
    v_mfma_f32_16x16x32_bf16 v[128:131], v[88:91], v[40:43], v[128:131]
    s_setprio 0
    ds_read_b64_tr_b16 v[88:89], v10 offset:36544
    s_waitcnt lgkmcnt(3)
    v_mfma_f32_16x16x32_bf16 v[160:163], v[76:79], v[40:43], v[160:163]
    s_setprio 1
    ds_read_b64_tr_b16 v[90:91], v10 offset:40128
    v_mfma_f32_16x16x32_bf16 v[160:163], v[80:83], v[56:59], v[160:163]
    s_setprio 0
    ds_read_b64_tr_b16 v[72:73], v10 offset:29280
    v_mfma_f32_16x16x32_bf16 v[164:167], v[80:83], v[60:63], v[164:167]
    s_setprio 1
    ds_read_b64_tr_b16 v[74:75], v10 offset:32864
    v_mfma_f32_16x16x32_bf16 v[164:167], v[76:79], v[44:47], v[164:167]
    s_setprio 0
    v_mfma_f32_16x16x32_bf16 v[168:171], v[76:79], v[48:51], v[168:171]
    s_setprio 1
    v_mfma_f32_16x16x32_bf16 v[168:171], v[80:83], v[64:67], v[168:171]
    s_setprio 0
    v_mfma_f32_16x16x32_bf16 v[172:175], v[80:83], v[68:71], v[172:175]
    s_setprio 1
    v_mfma_f32_16x16x32_bf16 v[172:175], v[76:79], v[52:55], v[172:175]
    s_setprio 0
    ds_read_b64_tr_b16 v[76:77], v10 offset:36576
    s_waitcnt lgkmcnt(3)
    v_mfma_f32_16x16x32_bf16 v[204:207], v[84:87], v[52:55], v[204:207]
    s_setprio 1
    ds_read_b64_tr_b16 v[78:79], v10 offset:40160
    v_mfma_f32_16x16x32_bf16 v[204:207], v[88:91], v[68:71], v[204:207]
    s_setprio 0
    s_waitcnt vmcnt(14) lgkmcnt(0)
    s_barrier
    v_mfma_f32_16x16x32_bf16 v[200:203], v[88:91], v[64:67], v[200:203]
    s_setprio 1
    ds_read_b64_tr_b16 v[80:81], v10 offset:43776
    s_add_u32 m0, s29, 29184
    v_mfma_f32_16x16x32_bf16 v[200:203], v[84:87], v[48:51], v[200:203]
    s_setprio 0
    ds_read_b64_tr_b16 v[82:83], v10 offset:47360
    buffer_load_dwordx4 v6, s[12:15], s65 offen lds
    v_mfma_f32_16x16x32_bf16 v[196:199], v[84:87], v[44:47], v[196:199]
    s_setprio 1
    s_add_u32 s65, s65, 229376
    v_mfma_f32_16x16x32_bf16 v[196:199], v[88:91], v[60:63], v[196:199]
    s_setprio 0
    v_mfma_f32_16x16x32_bf16 v[192:195], v[88:91], v[56:59], v[192:195]
    s_setprio 1
    s_add_u32 m0, s29, 36480
    v_mfma_f32_16x16x32_bf16 v[192:195], v[84:87], v[40:43], v[192:195]
    s_setprio 0
    ds_read_b64_tr_b16 v[84:85], v10 offset:51072
    buffer_load_dwordx4 v6, s[12:15], s65 offen lds
    v_mfma_f32_16x16x32_bf16 v[224:227], v[72:75], v[40:43], v[224:227]
    s_setprio 1
    ds_read_b64_tr_b16 v[86:87], v10 offset:54656
    s_sub_u32 s65, s65, 229376
    v_mfma_f32_16x16x32_bf16 v[224:227], v[76:79], v[56:59], v[224:227]
    s_setprio 0
    ds_read_b64_tr_b16 v[88:89], v10 offset:43808
    v_mfma_f32_16x16x32_bf16 v[228:231], v[76:79], v[60:63], v[228:231]
    s_setprio 1
    ds_read_b64_tr_b16 v[90:91], v10 offset:47392
    v_mfma_f32_16x16x32_bf16 v[228:231], v[72:75], v[44:47], v[228:231]
    s_setprio 0
    v_mfma_f32_16x16x32_bf16 v[16:19], v[28:31], v[72:75], v[16:19]
    v_mfma_f32_16x16x32_bf16 v[16:19], v[28:31], v[76:79], v[16:19]
    v_mfma_f32_16x16x32_bf16 v[232:235], v[72:75], v[48:51], v[232:235]
    s_setprio 1
    v_mfma_f32_16x16x32_bf16 v[232:235], v[76:79], v[64:67], v[232:235]
    s_setprio 0
    v_mfma_f32_16x16x32_bf16 v[236:239], v[76:79], v[68:71], v[236:239]
    s_setprio 1
    v_mfma_f32_16x16x32_bf16 v[236:239], v[72:75], v[52:55], v[236:239]
    s_setprio 0
    ds_read_b64_tr_b16 v[72:73], v10 offset:51104
    s_waitcnt lgkmcnt(3)
    v_mfma_f32_16x16x32_bf16 v[156:159], v[80:83], v[52:55], v[156:159]
    s_setprio 1
    ds_read_b64_tr_b16 v[74:75], v10 offset:54688
    v_mfma_f32_16x16x32_bf16 v[156:159], v[84:87], v[68:71], v[156:159]
    s_setprio 0
    ds_read_b64_tr_b16 v[76:77], v10 offset:43840
    v_mfma_f32_16x16x32_bf16 v[152:155], v[84:87], v[64:67], v[152:155]
    s_setprio 1
    ds_read_b64_tr_b16 v[78:79], v10 offset:47424
    v_mfma_f32_16x16x32_bf16 v[152:155], v[80:83], v[48:51], v[152:155]
    s_setprio 0
    v_mfma_f32_16x16x32_bf16 v[148:151], v[80:83], v[44:47], v[148:151]
    s_setprio 1
    v_mfma_f32_16x16x32_bf16 v[148:151], v[84:87], v[60:63], v[148:151]
    s_setprio 0
    v_mfma_f32_16x16x32_bf16 v[144:147], v[84:87], v[56:59], v[144:147]
    s_setprio 1
    v_mfma_f32_16x16x32_bf16 v[144:147], v[80:83], v[40:43], v[144:147]
    s_setprio 0
    ds_read_b64_tr_b16 v[80:81], v10 offset:51136
    s_waitcnt lgkmcnt(3)
    v_mfma_f32_16x16x32_bf16 v[176:179], v[88:91], v[40:43], v[176:179]
    s_setprio 1
    ds_read_b64_tr_b16 v[82:83], v10 offset:54720
    v_mfma_f32_16x16x32_bf16 v[176:179], v[72:75], v[56:59], v[176:179]
    s_setprio 0
    ds_read_b64_tr_b16 v[84:85], v10 offset:43872
    v_mfma_f32_16x16x32_bf16 v[180:183], v[72:75], v[60:63], v[180:183]
    s_setprio 1
    ds_read_b64_tr_b16 v[86:87], v10 offset:47456
    v_mfma_f32_16x16x32_bf16 v[180:183], v[88:91], v[44:47], v[180:183]
    s_setprio 0
    v_mfma_f32_16x16x32_bf16 v[184:187], v[88:91], v[48:51], v[184:187]
    s_setprio 1
    v_mfma_f32_16x16x32_bf16 v[184:187], v[72:75], v[64:67], v[184:187]
    s_setprio 0
    v_mfma_f32_16x16x32_bf16 v[188:191], v[72:75], v[68:71], v[188:191]
    s_setprio 1
    v_mfma_f32_16x16x32_bf16 v[188:191], v[88:91], v[52:55], v[188:191]
    s_setprio 0
    ds_read_b64_tr_b16 v[88:89], v10 offset:51168
    s_waitcnt lgkmcnt(3)
    v_mfma_f32_16x16x32_bf16 v[220:223], v[76:79], v[52:55], v[220:223]
    s_setprio 1
    ds_read_b64_tr_b16 v[90:91], v10 offset:54752
    v_mfma_f32_16x16x32_bf16 v[220:223], v[80:83], v[68:71], v[220:223]
    s_setprio 0
    s_waitcnt vmcnt(10) lgkmcnt(0)
    s_barrier
    v_mfma_f32_16x16x32_bf16 v[216:219], v[80:83], v[64:67], v[216:219]
    s_setprio 1
    ds_read_b64_tr_b16 v[72:73], v10 offset:0
    s_add_u32 m0, s29, 43776
    v_mfma_f32_16x16x32_bf16 v[216:219], v[76:79], v[48:51], v[216:219]
    s_setprio 0
    ds_read_b64_tr_b16 v[74:75], v10 offset:3584
    buffer_load_dwordx4 v6, s[16:19], s65 offen lds
    v_mfma_f32_16x16x32_bf16 v[212:215], v[76:79], v[44:47], v[212:215]
    s_setprio 1
    s_add_u32 s65, s65, 229376
    v_mfma_f32_16x16x32_bf16 v[212:215], v[80:83], v[60:63], v[212:215]
    s_setprio 0
    v_mfma_f32_16x16x32_bf16 v[208:211], v[80:83], v[56:59], v[208:211]
    s_setprio 1
    s_add_u32 m0, s29, 51072
    v_mfma_f32_16x16x32_bf16 v[208:211], v[76:79], v[40:43], v[208:211]
    s_setprio 0
    ds_read_b64_tr_b16 v[76:77], v10 offset:7296
    buffer_load_dwordx4 v6, s[16:19], s65 offen lds
    v_mfma_f32_16x16x32_bf16 v[240:243], v[84:87], v[40:43], v[240:243]
    s_setprio 1
    ds_read_b128 v[40:43], v94 offset:0
    ds_read_b64_tr_b16 v[78:79], v10 offset:10880
    s_add_u32 s65, s65, 229376
    v_mfma_f32_16x16x32_bf16 v[240:243], v[88:91], v[56:59], v[240:243]
    s_setprio 0
    ds_read_b128 v[56:59], v95 offset:0
    ds_read_b64_tr_b16 v[80:81], v10 offset:32
    v_mfma_f32_16x16x32_bf16 v[244:247], v[88:91], v[60:63], v[244:247]
    s_setprio 1
    ds_read_b128 v[60:63], v95 offset:2048
    ds_read_b64_tr_b16 v[82:83], v10 offset:3616
    v_mfma_f32_16x16x32_bf16 v[244:247], v[84:87], v[44:47], v[244:247]
    s_setprio 0
    ds_read_b128 v[44:47], v94 offset:2048
    v_mfma_f32_16x16x32_bf16 v[20:23], v[28:31], v[84:87], v[20:23]
    v_mfma_f32_16x16x32_bf16 v[20:23], v[28:31], v[88:91], v[20:23]
    v_mfma_f32_16x16x32_bf16 v[248:251], v[84:87], v[48:51], v[248:251]
    s_setprio 1
    ds_read_b128 v[48:51], v94 offset:4096
    v_mfma_f32_16x16x32_bf16 v[248:251], v[88:91], v[64:67], v[248:251]
    s_setprio 0
    ds_read_b128 v[64:67], v95 offset:4096
    v_mfma_f32_16x16x32_bf16 v[252:255], v[88:91], v[68:71], v[252:255]
    s_setprio 1
    ds_read_b128 v[68:71], v95 offset:6144
    v_mfma_f32_16x16x32_bf16 v[252:255], v[84:87], v[52:55], v[252:255]
    s_setprio 0
    ds_read_b128 v[52:55], v94 offset:6144
    ds_read_b64_tr_b16 v[84:85], v10 offset:7328
    s_waitcnt lgkmcnt(9)
    v_mfma_f32_16x16x32_bf16 v[128:131], v[72:75], v[40:43], v[128:131]
    s_setprio 1
    ds_read_b64_tr_b16 v[86:87], v10 offset:10912
    v_mfma_f32_16x16x32_bf16 v[128:131], v[76:79], v[56:59], v[128:131]
    s_setprio 0
    ds_read_b64_tr_b16 v[88:89], v10 offset:64
    s_waitcnt lgkmcnt(7)
    v_mfma_f32_16x16x32_bf16 v[132:135], v[76:79], v[60:63], v[132:135]
    s_setprio 1
    ds_read_b64_tr_b16 v[90:91], v10 offset:3648
    v_mfma_f32_16x16x32_bf16 v[132:135], v[72:75], v[44:47], v[132:135]
    s_setprio 0
    s_waitcnt lgkmcnt(6)
    v_mfma_f32_16x16x32_bf16 v[136:139], v[72:75], v[48:51], v[136:139]
    s_setprio 1
    v_mfma_f32_16x16x32_bf16 v[136:139], v[76:79], v[64:67], v[136:139]
    s_setprio 0
    s_waitcnt lgkmcnt(4)
    v_mfma_f32_16x16x32_bf16 v[140:143], v[76:79], v[68:71], v[140:143]
    s_setprio 1
    v_mfma_f32_16x16x32_bf16 v[140:143], v[72:75], v[52:55], v[140:143]
    s_setprio 0
    ds_read_b64_tr_b16 v[72:73], v10 offset:7360
    s_waitcnt lgkmcnt(3)
    v_mfma_f32_16x16x32_bf16 v[172:175], v[80:83], v[52:55], v[172:175]
    s_setprio 1
    ds_read_b64_tr_b16 v[74:75], v10 offset:10944
    v_mfma_f32_16x16x32_bf16 v[172:175], v[84:87], v[68:71], v[172:175]
    s_setprio 0
    ds_read_b64_tr_b16 v[76:77], v10 offset:96
    v_mfma_f32_16x16x32_bf16 v[168:171], v[84:87], v[64:67], v[168:171]
    s_setprio 1
    ds_read_b64_tr_b16 v[78:79], v10 offset:3680
    v_mfma_f32_16x16x32_bf16 v[168:171], v[80:83], v[48:51], v[168:171]
    s_setprio 0
    v_mfma_f32_16x16x32_bf16 v[164:167], v[80:83], v[44:47], v[164:167]
    s_setprio 1
    v_mfma_f32_16x16x32_bf16 v[164:167], v[84:87], v[60:63], v[164:167]
    s_setprio 0
    v_mfma_f32_16x16x32_bf16 v[160:163], v[84:87], v[56:59], v[160:163]
    s_setprio 1
    v_mfma_f32_16x16x32_bf16 v[160:163], v[80:83], v[40:43], v[160:163]
    s_setprio 0
    ds_read_b64_tr_b16 v[80:81], v10 offset:7392
    s_waitcnt lgkmcnt(3)
    v_mfma_f32_16x16x32_bf16 v[192:195], v[88:91], v[40:43], v[192:195]
    s_setprio 1
    ds_read_b64_tr_b16 v[82:83], v10 offset:10976
    v_mfma_f32_16x16x32_bf16 v[192:195], v[72:75], v[56:59], v[192:195]
    s_setprio 0
    s_waitcnt vmcnt(9) lgkmcnt(0)
    s_barrier
    v_mfma_f32_16x16x32_bf16 v[196:199], v[72:75], v[60:63], v[196:199]
    s_setprio 1
    ds_read_b64_tr_b16 v[84:85], v10 offset:14592
    s_add_u32 m0, s29, 0
    v_mfma_f32_16x16x32_bf16 v[196:199], v[88:91], v[44:47], v[196:199]
    s_setprio 0
    s_mov_b64 s[8:9], s[56:57]
    v_mov_b32 v124, 0
    ds_read_b64_tr_b16 v[86:87], v10 offset:18176
    buffer_load_dwordx4 v6, s[12:15], s65 offen lds
    v_mfma_f32_16x16x32_bf16 v[200:203], v[88:91], v[48:51], v[200:203]
    s_setprio 1
    s_add_u32 s65, s65, 229376
    v_mfma_f32_16x16x32_bf16 v[200:203], v[72:75], v[64:67], v[200:203]
    s_setprio 0
    v_mfma_f32_16x16x32_bf16 v[204:207], v[72:75], v[68:71], v[204:207]
    s_setprio 1
    s_add_u32 m0, s29, 7296
    v_mfma_f32_16x16x32_bf16 v[204:207], v[88:91], v[52:55], v[204:207]
    s_setprio 0
    v_mov_b32 v125, 0
    ds_read_b64_tr_b16 v[88:89], v10 offset:21888
    buffer_load_dwordx4 v6, s[12:15], s65 offen lds
    v_mfma_f32_16x16x32_bf16 v[236:239], v[76:79], v[52:55], v[236:239]
    s_setprio 1
    ds_read_b64_tr_b16 v[90:91], v10 offset:25472
    s_sub_u32 s65, s65, 229376
    v_mfma_f32_16x16x32_bf16 v[236:239], v[80:83], v[68:71], v[236:239]
    s_setprio 0
    ds_read_b64_tr_b16 v[72:73], v10 offset:14624
    v_mfma_f32_16x16x32_bf16 v[232:235], v[80:83], v[64:67], v[232:235]
    s_setprio 1
    ds_read_b64_tr_b16 v[74:75], v10 offset:18208
    s_mov_b32 m0, 61440
    v_mfma_f32_16x16x32_bf16 v[232:235], v[76:79], v[48:51], v[232:235]
    s_setprio 0
    v_mfma_f32_16x16x32_bf16 v[16:19], v[28:31], v[76:79], v[16:19]
    v_mfma_f32_16x16x32_bf16 v[16:19], v[28:31], v[80:83], v[16:19]
    s_add_u32 s5, s64, 262144
    buffer_load_dwordx4 v4, s[8:11], s5 offen offset:0 sc1 lds
    v_mov_b32 v126, 0
    v_mfma_f32_16x16x32_bf16 v[228:231], v[76:79], v[44:47], v[228:231]
    s_setprio 1
    v_mfma_f32_16x16x32_bf16 v[228:231], v[80:83], v[60:63], v[228:231]
    s_setprio 0
    v_mfma_f32_16x16x32_bf16 v[224:227], v[80:83], v[56:59], v[224:227]
    s_setprio 1
    s_add_u32 m0, s28, 32768
    v_mfma_f32_16x16x32_bf16 v[224:227], v[76:79], v[40:43], v[224:227]
    s_setprio 0
    ds_read_b64_tr_b16 v[76:77], v10 offset:21920
    buffer_load_dwordx4 v4, s[8:11], s64 offen offset:0 sc1 lds
    s_waitcnt lgkmcnt(3)
    v_mfma_f32_16x16x32_bf16 v[144:147], v[84:87], v[40:43], v[144:147]
    s_setprio 1
    ds_read_b64_tr_b16 v[78:79], v10 offset:25504
    v_mfma_f32_16x16x32_bf16 v[144:147], v[88:91], v[56:59], v[144:147]
    s_setprio 0
    v_mov_b32 v127, 0
    ds_read_b64_tr_b16 v[80:81], v10 offset:14656
    v_mfma_f32_16x16x32_bf16 v[148:151], v[88:91], v[60:63], v[148:151]
    s_setprio 1
    ds_read_b64_tr_b16 v[82:83], v10 offset:18240
    s_add_u32 m0, s28, 32768
    v_mfma_f32_16x16x32_bf16 v[148:151], v[84:87], v[44:47], v[148:151]
    s_setprio 0
    buffer_load_dwordx4 v5, s[8:11], s64 offen offset:1024 sc1 lds
    v_mfma_f32_16x16x32_bf16 v[152:155], v[84:87], v[48:51], v[152:155]
    s_setprio 1
    v_mfma_f32_16x16x32_bf16 v[152:155], v[88:91], v[64:67], v[152:155]
    s_setprio 0
    v_mov_b32 v120, 0
    v_mfma_f32_16x16x32_bf16 v[156:159], v[88:91], v[68:71], v[156:159]
    s_setprio 1
    s_add_u32 m0, s28, 32768
    v_mfma_f32_16x16x32_bf16 v[156:159], v[84:87], v[52:55], v[156:159]
    s_setprio 0
    ds_read_b64_tr_b16 v[84:85], v10 offset:21952
    buffer_load_dwordx4 v4, s[8:11], s66 offen offset:2048 sc1 lds
    s_waitcnt lgkmcnt(3)
    v_mfma_f32_16x16x32_bf16 v[188:191], v[72:75], v[52:55], v[188:191]
    s_setprio 1
    ds_read_b64_tr_b16 v[86:87], v10 offset:25536
    v_mfma_f32_16x16x32_bf16 v[188:191], v[76:79], v[68:71], v[188:191]
    s_setprio 0
    ds_read_b64_tr_b16 v[88:89], v10 offset:14688
    v_mfma_f32_16x16x32_bf16 v[184:187], v[76:79], v[64:67], v[184:187]
    s_setprio 1
    ds_read_b64_tr_b16 v[90:91], v10 offset:18272
    s_add_u32 m0, s28, 32768
    v_mfma_f32_16x16x32_bf16 v[184:187], v[72:75], v[48:51], v[184:187]
    s_setprio 0
    v_mov_b32 v121, 0
    buffer_load_dwordx4 v5, s[8:11], s66 offen offset:3072 sc1 lds
    v_mfma_f32_16x16x32_bf16 v[180:183], v[72:75], v[44:47], v[180:183]
    s_setprio 1
    s_add_u32 s64, s64, 128
    s_bitset0_b32 s64, 11
    v_mfma_f32_16x16x32_bf16 v[180:183], v[76:79], v[60:63], v[180:183]
    s_setprio 0
    s_add_u32 s66, s64, 30720
    v_mfma_f32_16x16x32_bf16 v[176:179], v[76:79], v[56:59], v[176:179]
    s_setprio 1
    v_mfma_f32_16x16x32_bf16 v[176:179], v[72:75], v[40:43], v[176:179]
    s_setprio 0
    ds_read_b64_tr_b16 v[72:73], v10 offset:21984
    v_mov_b32 v122, 0
    s_waitcnt lgkmcnt(3)
    v_mfma_f32_16x16x32_bf16 v[208:211], v[80:83], v[40:43], v[208:211]
    s_setprio 1
    ds_read_b64_tr_b16 v[74:75], v10 offset:25568
    v_mfma_f32_16x16x32_bf16 v[208:211], v[84:87], v[56:59], v[208:211]
    s_setprio 0
    s_waitcnt vmcnt(9) lgkmcnt(0)
    s_barrier
    v_mfma_f32_16x16x32_bf16 v[212:215], v[84:87], v[60:63], v[212:215]
    s_setprio 1
    ds_read_b64_tr_b16 v[76:77], v10 offset:29184
    s_add_u32 m0, s29, 14592
    v_mfma_f32_16x16x32_bf16 v[212:215], v[80:83], v[44:47], v[212:215]
    s_setprio 0
    ds_read_b64_tr_b16 v[78:79], v10 offset:32768
    buffer_load_dwordx4 v6, s[16:19], s65 offen lds
    v_mfma_f32_16x16x32_bf16 v[216:219], v[80:83], v[48:51], v[216:219]
    s_setprio 1
    s_add_u32 s65, s65, 229376
    v_mfma_f32_16x16x32_bf16 v[216:219], v[84:87], v[64:67], v[216:219]
    s_setprio 0
    v_mov_b32 v123, 0
    v_mfma_f32_16x16x32_bf16 v[220:223], v[84:87], v[68:71], v[220:223]
    s_setprio 1
    s_add_u32 m0, s29, 21888
    v_mfma_f32_16x16x32_bf16 v[220:223], v[80:83], v[52:55], v[220:223]
    s_setprio 0
    ds_read_b64_tr_b16 v[80:81], v10 offset:36480
    buffer_load_dwordx4 v6, s[16:19], s65 offen lds
    v_mfma_f32_16x16x32_bf16 v[252:255], v[88:91], v[52:55], v[252:255]
    s_setprio 1
    ds_read_b128 v[52:55], v8 offset:6144
    ds_read_b64_tr_b16 v[82:83], v10 offset:40064
    s_add_u32 s65, s65, 229376
    v_mfma_f32_16x16x32_bf16 v[252:255], v[72:75], v[68:71], v[252:255]
    s_setprio 0
    ds_read_b128 v[68:71], v9 offset:6144
    ds_read_b64_tr_b16 v[84:85], v10 offset:29216
    v_mov_b32 v116, 0
    v_mfma_f32_16x16x32_bf16 v[248:251], v[72:75], v[64:67], v[248:251]
    s_setprio 1
    ds_read_b128 v[64:67], v9 offset:4096
    ds_read_b64_tr_b16 v[86:87], v10 offset:32800
    s_mov_b32 m0, 134144
    v_mfma_f32_16x16x32_bf16 v[248:251], v[88:91], v[48:51], v[248:251]
    s_setprio 0
    ds_read_b128 v[48:51], v8 offset:4096
    v_mfma_f32_16x16x32_bf16 v[20:23], v[28:31], v[88:91], v[20:23]
    v_mfma_f32_16x16x32_bf16 v[20:23], v[28:31], v[72:75], v[20:23]
    buffer_load_dwordx4 v35, s[76:79], s37 offen  lds
    v_mfma_f32_16x16x32_bf16 v[244:247], v[88:91], v[44:47], v[244:247]
    s_setprio 1
    ds_read_b128 v[44:47], v8 offset:2048
    s_add_u32 s37, s37, 196608
    v_mfma_f32_16x16x32_bf16 v[244:247], v[72:75], v[60:63], v[244:247]
    s_setprio 0
    ds_read_b128 v[60:63], v9 offset:2048
    v_mov_b32 v117, 0
    v_mfma_f32_16x16x32_bf16 v[240:243], v[72:75], v[56:59], v[240:243]
    s_setprio 1
    ds_read_b128 v[56:59], v9 offset:0
    v_mfma_f32_16x16x32_bf16 v[240:243], v[88:91], v[40:43], v[240:243]
    s_setprio 0
    ds_read_b128 v[40:43], v8 offset:0
    ds_read_b64_tr_b16 v[88:89], v10 offset:36512
    s_waitcnt lgkmcnt(9)
    v_mfma_f32_16x16x32_bf16 v[140:143], v[76:79], v[52:55], v[140:143]
    s_setprio 1
    ds_read_b64_tr_b16 v[90:91], v10 offset:40096
    v_mfma_f32_16x16x32_bf16 v[140:143], v[80:83], v[68:71], v[140:143]
    s_setprio 0
    ds_read_b64_tr_b16 v[72:73], v10 offset:29248
    s_waitcnt lgkmcnt(7)
    v_mfma_f32_16x16x32_bf16 v[136:139], v[80:83], v[64:67], v[136:139]
    s_setprio 1
    ds_read_b64_tr_b16 v[74:75], v10 offset:32832
    s_mov_b32 m0, 140288
    v_mfma_f32_16x16x32_bf16 v[136:139], v[76:79], v[48:51], v[136:139]
    s_setprio 0
    v_mov_b32 v118, 0
    buffer_load_dwordx4 v35, s[76:79], s37 offen  lds
    s_waitcnt lgkmcnt(6)
    v_mfma_f32_16x16x32_bf16 v[132:135], v[76:79], v[44:47], v[132:135]
    s_setprio 1
    s_add_u32 s37, s37, 196608
    v_mfma_f32_16x16x32_bf16 v[132:135], v[80:83], v[60:63], v[132:135]
    s_setprio 0
    s_waitcnt lgkmcnt(4)
    v_mfma_f32_16x16x32_bf16 v[128:131], v[80:83], v[56:59], v[128:131]
    s_setprio 1
    v_mfma_f32_16x16x32_bf16 v[128:131], v[76:79], v[40:43], v[128:131]
    s_setprio 0
    ds_read_b64_tr_b16 v[76:77], v10 offset:36544
    v_mov_b32 v119, 0
    s_waitcnt lgkmcnt(3)
    v_mfma_f32_16x16x32_bf16 v[160:163], v[84:87], v[40:43], v[160:163]
    s_setprio 1
    ds_read_b64_tr_b16 v[78:79], v10 offset:40128
    v_mfma_f32_16x16x32_bf16 v[160:163], v[88:91], v[56:59], v[160:163]
    s_setprio 0
    ds_read_b64_tr_b16 v[80:81], v10 offset:29280
    v_mfma_f32_16x16x32_bf16 v[164:167], v[88:91], v[60:63], v[164:167]
    s_setprio 1
    ds_read_b64_tr_b16 v[82:83], v10 offset:32864
    v_mfma_f32_16x16x32_bf16 v[164:167], v[84:87], v[44:47], v[164:167]
    s_setprio 0
    v_mfma_f32_16x16x32_bf16 v[168:171], v[84:87], v[48:51], v[168:171]
    s_setprio 1
    v_mfma_f32_16x16x32_bf16 v[168:171], v[88:91], v[64:67], v[168:171]
    s_setprio 0
    v_mov_b32 v112, 0
    v_mfma_f32_16x16x32_bf16 v[172:175], v[88:91], v[68:71], v[172:175]
    s_setprio 1
    v_mfma_f32_16x16x32_bf16 v[172:175], v[84:87], v[52:55], v[172:175]
    s_setprio 0
    ds_read_b64_tr_b16 v[84:85], v10 offset:36576
    s_waitcnt lgkmcnt(3)
    v_mfma_f32_16x16x32_bf16 v[204:207], v[72:75], v[52:55], v[204:207]
    s_setprio 1
    ds_read_b64_tr_b16 v[86:87], v10 offset:40160
    v_mfma_f32_16x16x32_bf16 v[204:207], v[76:79], v[68:71], v[204:207]
    s_setprio 0
    v_mov_b32 v113, 0
    s_waitcnt vmcnt(11) lgkmcnt(0)
    s_barrier
    v_mfma_f32_16x16x32_bf16 v[200:203], v[76:79], v[64:67], v[200:203]
    s_setprio 1
    ds_read_b64_tr_b16 v[88:89], v10 offset:43776
    s_add_u32 m0, s29, 29184
    v_mfma_f32_16x16x32_bf16 v[200:203], v[72:75], v[48:51], v[200:203]
    s_setprio 0
    ds_read_b64_tr_b16 v[90:91], v10 offset:47360
    buffer_load_dwordx4 v6, s[12:15], s65 offen lds
    ds_read_b64 v[36:37], v26 offset:0
    v_mfma_f32_16x16x32_bf16 v[196:199], v[72:75], v[44:47], v[196:199]
    s_setprio 1
    ds_read_b64 v[38:39], v26 offset:128
    s_add_u32 s65, s65, 229376
    v_mfma_f32_16x16x32_bf16 v[196:199], v[76:79], v[60:63], v[196:199]
    s_setprio 0
    ds_read_b64 v[12:13], v26 offset:256
    v_mfma_f32_16x16x32_bf16 v[192:195], v[76:79], v[56:59], v[192:195]
    s_setprio 1
    ds_read_b64 v[14:15], v26 offset:384
    s_add_u32 m0, s29, 36480
    v_mfma_f32_16x16x32_bf16 v[192:195], v[72:75], v[40:43], v[192:195]
    s_setprio 0
    v_mov_b32 v114, 0
    ds_read_b64_tr_b16 v[72:73], v10 offset:51072
    buffer_load_dwordx4 v6, s[12:15], s65 offen lds
    v_mfma_f32_16x16x32_bf16 v[224:227], v[80:83], v[40:43], v[224:227]
    s_setprio 1
    ds_read_b64_tr_b16 v[74:75], v10 offset:54656
    s_sub_u32 s65, s65, 229376
    v_mfma_f32_16x16x32_bf16 v[224:227], v[84:87], v[56:59], v[224:227]
    s_setprio 0
    ds_read_b64_tr_b16 v[76:77], v10 offset:43808
    v_mfma_f32_16x16x32_bf16 v[228:231], v[84:87], v[60:63], v[228:231]
    s_setprio 1
    ds_read_b64_tr_b16 v[78:79], v10 offset:47392
    s_mov_b32 m0, 28672
    v_mfma_f32_16x16x32_bf16 v[228:231], v[80:83], v[44:47], v[228:231]
    s_setprio 0
    v_mfma_f32_16x16x32_bf16 v[16:19], v[28:31], v[80:83], v[16:19]
    v_mfma_f32_16x16x32_bf16 v[16:19], v[28:31], v[84:87], v[16:19]
    s_add_u32 s5, s64, 262144
    buffer_load_dwordx4 v4, s[8:11], s5 offen offset:0 sc1 lds
    v_mov_b32 v115, 0
    v_mfma_f32_16x16x32_bf16 v[232:235], v[80:83], v[48:51], v[232:235]
    s_setprio 1
    v_mfma_f32_16x16x32_bf16 v[232:235], v[84:87], v[64:67], v[232:235]
    s_setprio 0
    v_mfma_f32_16x16x32_bf16 v[236:239], v[84:87], v[68:71], v[236:239]
    s_setprio 1
    s_add_u32 m0, s28, 0
    v_mfma_f32_16x16x32_bf16 v[236:239], v[80:83], v[52:55], v[236:239]
    s_setprio 0
    ds_read_b64_tr_b16 v[80:81], v10 offset:51104
    buffer_load_dwordx4 v4, s[8:11], s64 offen offset:0 sc1 lds
    s_waitcnt lgkmcnt(3)
    v_mfma_f32_16x16x32_bf16 v[156:159], v[88:91], v[52:55], v[156:159]
    s_setprio 1
    ds_read_b64_tr_b16 v[82:83], v10 offset:54688
    v_mfma_f32_16x16x32_bf16 v[156:159], v[72:75], v[68:71], v[156:159]
    s_setprio 0
    ds_read_b64_tr_b16 v[84:85], v10 offset:43840
    v_mfma_f32_16x16x32_bf16 v[152:155], v[72:75], v[64:67], v[152:155]
    s_setprio 1
    ds_read_b64_tr_b16 v[86:87], v10 offset:47424
    s_add_u32 m0, s28, 0
    v_mfma_f32_16x16x32_bf16 v[152:155], v[88:91], v[48:51], v[152:155]
    s_setprio 0
    buffer_load_dwordx4 v5, s[8:11], s64 offen offset:1024 sc1 lds
    v_mul_f32 v140, v140, v15
    v_mul_f32 v141, v141, v15
    v_mul_f32 v142, v142, v15
    v_mfma_f32_16x16x32_bf16 v[148:151], v[88:91], v[44:47], v[148:151]
    s_setprio 1
    v_mfma_f32_16x16x32_bf16 v[148:151], v[72:75], v[60:63], v[148:151]
    s_setprio 0
    v_mul_f32 v143, v143, v15
    v_mul_f32 v136, v136, v13
    v_mul_f32 v137, v137, v13
    v_mul_f32 v138, v138, v13
    v_mfma_f32_16x16x32_bf16 v[144:147], v[72:75], v[56:59], v[144:147]
    s_setprio 1
    s_add_u32 m0, s28, 0
    v_mfma_f32_16x16x32_bf16 v[144:147], v[88:91], v[40:43], v[144:147]
    s_setprio 0
    v_mul_f32 v139, v139, v13
    v_mul_f32 v132, v132, v39
    v_mul_f32 v133, v133, v39
    ds_read_b64_tr_b16 v[88:89], v10 offset:51136
    buffer_load_dwordx4 v4, s[8:11], s66 offen offset:2048 sc1 lds
    v_mul_f32 v134, v134, v39
    v_mul_f32 v135, v135, v39
    s_waitcnt lgkmcnt(3)
    v_mfma_f32_16x16x32_bf16 v[176:179], v[76:79], v[40:43], v[176:179]
    s_setprio 1
    ds_read_b64_tr_b16 v[90:91], v10 offset:54720
    v_mfma_f32_16x16x32_bf16 v[176:179], v[80:83], v[56:59], v[176:179]
    s_setprio 0
    v_mul_f32 v128, v128, v37
    v_mul_f32 v129, v129, v37
    ds_read_b64_tr_b16 v[72:73], v10 offset:43872
    v_mul_f32 v130, v130, v37
    v_mul_f32 v131, v131, v37
    v_mfma_f32_16x16x32_bf16 v[180:183], v[80:83], v[60:63], v[180:183]
    s_setprio 1
    ds_read_b64_tr_b16 v[74:75], v10 offset:47456
    s_add_u32 m0, s28, 0
    v_mfma_f32_16x16x32_bf16 v[180:183], v[76:79], v[44:47], v[180:183]
    s_setprio 0
    v_mul_f32 v160, v160, v37
    v_mul_f32 v161, v161, v37
    v_mul_f32 v162, v162, v37
    buffer_load_dwordx4 v5, s[8:11], s66 offen offset:3072 sc1 lds
    v_mul_f32 v163, v163, v37
    v_mul_f32 v164, v164, v39
    v_mfma_f32_16x16x32_bf16 v[184:187], v[76:79], v[48:51], v[184:187]
    s_setprio 1
    s_add_u32 s64, s64, 128
    s_bitset0_b32 s64, 11
    v_mfma_f32_16x16x32_bf16 v[184:187], v[80:83], v[64:67], v[184:187]
    s_setprio 0
    s_add_u32 s66, s64, 30720
    v_mul_f32 v165, v165, v39
    v_mul_f32 v166, v166, v39
    v_mul_f32 v167, v167, v39
    v_mul_f32 v168, v168, v13
    v_mul_f32 v169, v169, v13
    v_mfma_f32_16x16x32_bf16 v[188:191], v[80:83], v[68:71], v[188:191]
    s_setprio 1
    v_mfma_f32_16x16x32_bf16 v[188:191], v[76:79], v[52:55], v[188:191]
    s_setprio 0
    v_mul_f32 v170, v170, v13
    v_mul_f32 v171, v171, v13
    ds_read_b64_tr_b16 v[76:77], v10 offset:51168
    v_mul_f32 v172, v172, v15
    v_mul_f32 v173, v173, v15
    s_waitcnt lgkmcnt(3)
    v_mfma_f32_16x16x32_bf16 v[220:223], v[84:87], v[52:55], v[220:223]
    s_setprio 1
    ds_read_b64_tr_b16 v[78:79], v10 offset:54752
    v_mfma_f32_16x16x32_bf16 v[220:223], v[88:91], v[68:71], v[220:223]
    s_setprio 0
    v_mul_f32 v174, v174, v15
    v_mul_f32 v175, v175, v15
    v_mul_f32 v204, v204, v15
    v_mul_f32 v205, v205, v15
    v_mul_f32 v206, v206, v15
    s_waitcnt vmcnt(11) lgkmcnt(0)
    s_barrier
    v_mfma_f32_16x16x32_bf16 v[216:219], v[88:91], v[64:67], v[216:219]
    s_setprio 1
    ds_read_b64_tr_b16 v[80:81], v10 offset:0
    s_add_u32 m0, s29, 43776
    v_mfma_f32_16x16x32_bf16 v[216:219], v[84:87], v[48:51], v[216:219]
    s_setprio 0
    v_mul_f32 v207, v207, v15
    v_mul_f32 v200, v200, v13
    ds_read_b64_tr_b16 v[82:83], v10 offset:3584
    buffer_load_dwordx4 v6, s[16:19], s65 offen lds
    v_mul_f32 v201, v201, v13
    v_mul_f32 v202, v202, v13
    v_mfma_f32_16x16x32_bf16 v[212:215], v[84:87], v[44:47], v[212:215]
    s_setprio 1
    s_add_u32 s65, s65, 229376
    v_mfma_f32_16x16x32_bf16 v[212:215], v[88:91], v[60:63], v[212:215]
    s_setprio 0
    v_mul_f32 v203, v203, v13
    v_mul_f32 v196, v196, v39
    v_mul_f32 v197, v197, v39
    v_mul_f32 v198, v198, v39
    v_mul_f32 v199, v199, v39
    v_mfma_f32_16x16x32_bf16 v[208:211], v[88:91], v[56:59], v[208:211]
    s_setprio 1
    s_add_u32 m0, s29, 51072
    v_mfma_f32_16x16x32_bf16 v[208:211], v[84:87], v[40:43], v[208:211]
    s_setprio 0
    v_mul_f32 v192, v192, v37
    v_mul_f32 v193, v193, v37
    ds_read_b64_tr_b16 v[84:85], v10 offset:7296
    buffer_load_dwordx4 v6, s[16:19], s65 offen lds
    v_mul_f32 v194, v194, v37
    v_mul_f32 v195, v195, v37
    v_mfma_f32_16x16x32_bf16 v[240:243], v[72:75], v[40:43], v[240:243]
    s_setprio 1
    ds_read_b128 v[40:43], v8 offset:32768
    ds_read_b64_tr_b16 v[86:87], v10 offset:10880
    s_add_u32 s65, s65, 229376
    v_mfma_f32_16x16x32_bf16 v[240:243], v[76:79], v[56:59], v[240:243]
    s_setprio 0
    v_mul_f32 v224, v224, v37
    v_mul_f32 v225, v225, v37
    v_mul_f32 v226, v226, v37
    ds_read_b128 v[56:59], v9 offset:32768
    ds_read_b64_tr_b16 v[88:89], v10 offset:32
    v_mul_f32 v227, v227, v37
    v_mul_f32 v228, v228, v39
    v_mfma_f32_16x16x32_bf16 v[244:247], v[76:79], v[60:63], v[244:247]
    s_setprio 1
    ds_read_b128 v[60:63], v9 offset:34816
    ds_read_b64_tr_b16 v[90:91], v10 offset:3616
    s_mov_b32 m0, 146432
    v_mfma_f32_16x16x32_bf16 v[244:247], v[72:75], v[44:47], v[244:247]
    s_setprio 0
    v_mfma_f32_16x16x32_bf16 v[20:23], v[28:31], v[72:75], v[20:23]
    v_mfma_f32_16x16x32_bf16 v[20:23], v[28:31], v[76:79], v[20:23]
    v_mul_f32 v229, v229, v39
    v_mul_f32 v230, v230, v39
    ds_read_b128 v[44:47], v8 offset:34816
    buffer_load_dwordx4 v35, s[76:79], s37 offen  lds
    v_mul_f32 v231, v231, v39
    v_mul_f32 v232, v232, v13
    v_mul_f32 v233, v233, v13
    v_mfma_f32_16x16x32_bf16 v[248:251], v[72:75], v[48:51], v[248:251]
    s_setprio 1
    ds_read_b128 v[48:51], v8 offset:36864
    s_add_u32 s37, s37, 196608
    v_mfma_f32_16x16x32_bf16 v[248:251], v[76:79], v[64:67], v[248:251]
    s_setprio 0
    v_mul_f32 v234, v234, v13
    v_mul_f32 v235, v235, v13
    ds_read_b128 v[64:67], v9 offset:36864
    v_mul_f32 v236, v236, v15
    v_mul_f32 v237, v237, v15
    v_mfma_f32_16x16x32_bf16 v[252:255], v[76:79], v[68:71], v[252:255]
    s_setprio 1
    ds_read_b128 v[68:71], v9 offset:38912
    v_mfma_f32_16x16x32_bf16 v[252:255], v[72:75], v[52:55], v[252:255]
    s_setprio 0
    v_mul_f32 v238, v238, v15
    v_mul_f32 v239, v239, v15
    ds_read_b128 v[52:55], v8 offset:38912
    ds_read_b64_tr_b16 v[72:73], v10 offset:7328
    s_waitcnt lgkmcnt(9)
    v_mfma_f32_16x16x32_bf16 v[128:131], v[80:83], v[40:43], v[128:131]
    s_setprio 1
    ds_read_b64_tr_b16 v[74:75], v10 offset:10912
    v_mfma_f32_16x16x32_bf16 v[128:131], v[84:87], v[56:59], v[128:131]
    s_setprio 0
    v_mul_f32 v156, v156, v15
    v_mul_f32 v157, v157, v15
    ds_read_b64_tr_b16 v[76:77], v10 offset:64
    v_mul_f32 v158, v158, v15
    v_mul_f32 v159, v159, v15
    s_waitcnt lgkmcnt(7)
    v_mfma_f32_16x16x32_bf16 v[132:135], v[84:87], v[60:63], v[132:135]
    s_setprio 1
    ds_read_b64_tr_b16 v[78:79], v10 offset:3648
    s_mov_b32 m0, 152576
    v_mfma_f32_16x16x32_bf16 v[132:135], v[80:83], v[44:47], v[132:135]
    s_setprio 0
    v_mul_f32 v152, v152, v13
    ds_write2_b32 v27, v16, v20 offset1:64
    buffer_load_dwordx4 v35, s[76:79], s37 offen  lds
    v_mul_f32 v153, v153, v13
    v_mul_f32 v154, v154, v13
    s_waitcnt lgkmcnt(7)
    v_mfma_f32_16x16x32_bf16 v[136:139], v[80:83], v[48:51], v[136:139]
    s_setprio 1
    s_add_u32 s37, s37, 196608
    v_mfma_f32_16x16x32_bf16 v[136:139], v[84:87], v[64:67], v[136:139]
    s_setprio 0
    v_mul_f32 v155, v155, v13
    v_mul_f32 v148, v148, v39
    v_mul_f32 v149, v149, v39
    s_waitcnt lgkmcnt(5)
    v_mfma_f32_16x16x32_bf16 v[140:143], v[84:87], v[68:71], v[140:143]
    s_setprio 1
    v_mfma_f32_16x16x32_bf16 v[140:143], v[80:83], v[52:55], v[140:143]
    s_setprio 0
    v_mul_f32 v150, v150, v39
    v_mul_f32 v151, v151, v39
    ds_read_b64_tr_b16 v[80:81], v10 offset:7360
    v_mul_f32 v144, v144, v37
    v_mul_f32 v145, v145, v37
    s_waitcnt lgkmcnt(4)
    v_mfma_f32_16x16x32_bf16 v[172:175], v[88:91], v[52:55], v[172:175]
    s_setprio 1
    ds_read_b64_tr_b16 v[82:83], v10 offset:10944
    v_mfma_f32_16x16x32_bf16 v[172:175], v[72:75], v[68:71], v[172:175]
    s_setprio 0
    v_mul_f32 v146, v146, v37
    ds_read_b64_tr_b16 v[84:85], v10 offset:96
    v_mul_f32 v147, v147, v37
    v_mul_f32 v176, v176, v37
    v_mfma_f32_16x16x32_bf16 v[168:171], v[72:75], v[64:67], v[168:171]
    s_setprio 1
    ds_read_b64_tr_b16 v[86:87], v10 offset:3680
    v_mfma_f32_16x16x32_bf16 v[168:171], v[88:91], v[48:51], v[168:171]
    s_setprio 0
    v_mul_f32 v177, v177, v37
    v_mul_f32 v178, v178, v37
    v_mul_f32 v179, v179, v37
    v_mfma_f32_16x16x32_bf16 v[164:167], v[88:91], v[44:47], v[164:167]
    s_setprio 1
    v_mfma_f32_16x16x32_bf16 v[164:167], v[72:75], v[60:63], v[164:167]
    s_setprio 0
    v_mul_f32 v180, v180, v39
    v_mul_f32 v181, v181, v39
    v_mul_f32 v182, v182, v39
    v_mfma_f32_16x16x32_bf16 v[160:163], v[72:75], v[56:59], v[160:163]
    s_setprio 1
    v_mfma_f32_16x16x32_bf16 v[160:163], v[88:91], v[40:43], v[160:163]
    s_setprio 0
    v_mul_f32 v183, v183, v39
    v_mul_f32 v184, v184, v13
    ds_read_b64_tr_b16 v[88:89], v10 offset:7392
    v_mul_f32 v185, v185, v13
    v_mul_f32 v186, v186, v13
    s_waitcnt lgkmcnt(3)
    v_mfma_f32_16x16x32_bf16 v[192:195], v[76:79], v[40:43], v[192:195]
    s_setprio 1
    ds_read_b64_tr_b16 v[90:91], v10 offset:10976
    v_mfma_f32_16x16x32_bf16 v[192:195], v[80:83], v[56:59], v[192:195]
    s_setprio 0
    v_mul_f32 v187, v187, v13
    v_mul_f32 v188, v188, v15
    v_mul_f32 v189, v189, v15
    s_waitcnt vmcnt(11) lgkmcnt(0)
    s_barrier
    v_mfma_f32_16x16x32_bf16 v[196:199], v[80:83], v[60:63], v[196:199]
    s_setprio 1
    ds_read_b64_tr_b16 v[28:29], v92 offset:32768
    s_add_u32 m0, s29, 0
    v_mfma_f32_16x16x32_bf16 v[196:199], v[76:79], v[44:47], v[196:199]
    s_setprio 0
    v_mul_f32 v190, v190, v15
    v_mul_f32 v191, v191, v15
    ds_read_b64_tr_b16 v[30:31], v92 offset:33792
    buffer_load_dwordx4 v6, s[12:15], s65 offen lds
    v_mul_f32 v220, v220, v15
    v_mfma_f32_16x16x32_bf16 v[200:203], v[76:79], v[48:51], v[200:203]
    s_setprio 1
    ds_read_b64_tr_b16 v[16:17], v92 offset:38912
    s_add_u32 s65, s65, 229376
    v_mfma_f32_16x16x32_bf16 v[200:203], v[80:83], v[64:67], v[200:203]
    s_setprio 0
    v_mul_f32 v221, v221, v15
    v_mul_f32 v222, v222, v15
    ds_read_b64_tr_b16 v[18:19], v92 offset:39936
    v_mul_f32 v223, v223, v15
    v_mul_f32 v216, v216, v13
    v_mfma_f32_16x16x32_bf16 v[204:207], v[80:83], v[68:71], v[204:207]
    s_setprio 1
    ds_read_b64_tr_b16 v[72:73], v32 offset:32768
    s_add_u32 m0, s29, 7296
    v_mfma_f32_16x16x32_bf16 v[204:207], v[76:79], v[52:55], v[204:207]
    s_setprio 0
    v_mul_f32 v217, v217, v13
    ds_read_b64_tr_b16 v[74:75], v32 offset:33792
    buffer_load_dwordx4 v6, s[12:15], s65 offen lds
    v_mul_f32 v218, v218, v13
    v_mul_f32 v219, v219, v13
    v_mfma_f32_16x16x32_bf16 v[236:239], v[84:87], v[52:55], v[236:239]
    s_setprio 1
    ds_read_b64_tr_b16 v[76:77], v32 offset:38912
    s_sub_u32 s65, s65, 229376
    v_mfma_f32_16x16x32_bf16 v[236:239], v[88:91], v[68:71], v[236:239]
    s_setprio 0
    v_mul_f32 v212, v212, v39
    v_mul_f32 v213, v213, v39
    ds_read_b64_tr_b16 v[78:79], v32 offset:39936
    v_mul_f32 v214, v214, v39
    v_mfma_f32_16x16x32_bf16 v[232:235], v[88:91], v[64:67], v[232:235]
    s_setprio 1
    v_mfma_f32_16x16x32_bf16 v[232:235], v[84:87], v[48:51], v[232:235]
    s_setprio 0
    v_mul_f32 v215, v215, v39
    v_mul_f32 v208, v208, v37
    v_mul_f32 v209, v209, v37
    v_mfma_f32_16x16x32_bf16 v[228:231], v[84:87], v[44:47], v[228:231]
    s_setprio 1
    ds_read_b64_tr_b16 v[80:81], v10 offset:14592
    v_mfma_f32_16x16x32_bf16 v[228:231], v[88:91], v[60:63], v[228:231]
    s_setprio 0
    v_mul_f32 v210, v210, v37
    v_mul_f32 v211, v211, v37
    ds_read_b64_tr_b16 v[82:83], v10 offset:18176
    v_mul_f32 v240, v240, v37
    v_mul_f32 v241, v241, v37
    v_mfma_f32_16x16x32_bf16 v[224:227], v[88:91], v[56:59], v[224:227]
    s_setprio 1
    s_mov_b32 m0, 61440
    v_mfma_f32_16x16x32_bf16 v[224:227], v[84:87], v[40:43], v[224:227]
    s_setprio 0
    v_mul_f32 v242, v242, v37
    s_add_u32 s5, s64, 262144
    buffer_load_dwordx4 v4, s[8:11], s5 offen offset:0 sc1 lds
    v_mul_f32 v243, v243, v37
    v_mul_f32 v244, v244, v39
    s_waitcnt lgkmcnt(6)
    v_mfma_f32_16x16x32_bf16 v[96:99], v[28:31], v[40:43], 0
    s_setprio 1
    ds_read_b64_tr_b16 v[84:85], v10 offset:21888
    v_mfma_f32_16x16x32_bf16 v[96:99], v[16:19], v[56:59], v[96:99]
    s_setprio 0
    v_mul_f32 v245, v245, v39
    v_mul_f32 v246, v246, v39
    ds_read_b64_tr_b16 v[86:87], v10 offset:25472
    v_mul_f32 v247, v247, v39
    v_mfma_f32_16x16x32_bf16 v[100:103], v[16:19], v[60:63], 0
    s_setprio 1
    s_add_u32 m0, s28, 32768
    v_mfma_f32_16x16x32_bf16 v[100:103], v[28:31], v[44:47], v[100:103]
    s_setprio 0
    v_mul_f32 v248, v248, v13
    v_mul_f32 v249, v249, v13
    buffer_load_dwordx4 v4, s[8:11], s64 offen offset:0 sc1 lds
    v_mul_f32 v250, v250, v13
    v_mul_f32 v251, v251, v13
    v_mfma_f32_16x16x32_bf16 v[104:107], v[28:31], v[48:51], 0
    s_setprio 1
    ds_read_b64_tr_b16 v[88:89], v10 offset:14624
    v_mfma_f32_16x16x32_bf16 v[104:107], v[16:19], v[64:67], v[104:107]
    s_setprio 0
    v_mul_f32 v252, v252, v15
    ds_read_b64_tr_b16 v[90:91], v10 offset:18208
    v_mul_f32 v253, v253, v15
    v_mul_f32 v254, v254, v15
    v_mfma_f32_16x16x32_bf16 v[108:111], v[16:19], v[68:71], 0
    s_setprio 1
    v_mfma_f32_16x16x32_bf16 v[108:111], v[28:31], v[52:55], v[108:111]
    s_setprio 0
    v_mul_f32 v255, v255, v15
    s_nop 1
L_loop3:
    s_waitcnt lgkmcnt(6)
    v_mfma_f32_16x16x32_bf16 v[124:127], v[72:75], v[52:55], v[124:127]
    s_setprio 1
    ds_read_b64_tr_b16 v[28:29], v10 offset:21920
    v_mfma_f32_16x16x32_bf16 v[124:127], v[76:79], v[68:71], v[124:127]
    s_setprio 0
    ds_read_b64_tr_b16 v[30:31], v10 offset:25504
    v_mfma_f32_16x16x32_bf16 v[120:123], v[76:79], v[64:67], v[120:123]
    s_setprio 1
    s_add_u32 m0, s28, 32768
    v_mfma_f32_16x16x32_bf16 v[120:123], v[72:75], v[48:51], v[120:123]
    s_setprio 0
    buffer_load_dwordx4 v5, s[8:11], s64 offen offset:1024 sc1 lds
    v_mfma_f32_16x16x32_bf16 v[116:119], v[72:75], v[44:47], v[116:119]
    s_setprio 1
    v_mfma_f32_16x16x32_bf16 v[116:119], v[76:79], v[60:63], v[116:119]
    s_setprio 0
    v_mfma_f32_16x16x32_bf16 v[112:115], v[76:79], v[56:59], v[112:115]
    s_setprio 1
    v_mfma_f32_16x16x32_bf16 v[112:115], v[72:75], v[40:43], v[112:115]
    s_setprio 0
    ds_read_b64_tr_b16 v[72:73], v10 offset:14656
    s_waitcnt lgkmcnt(5)
    v_mfma_f32_16x16x32_bf16 v[144:147], v[80:83], v[40:43], v[144:147]
    s_setprio 1
    ds_read_b64_tr_b16 v[74:75], v10 offset:18240
    v_mfma_f32_16x16x32_bf16 v[144:147], v[84:87], v[56:59], v[144:147]
    s_setprio 0
    ds_read_b64_tr_b16 v[76:77], v10 offset:21952
    v_mfma_f32_16x16x32_bf16 v[148:151], v[84:87], v[60:63], v[148:151]
    s_setprio 1
    ds_read_b64_tr_b16 v[78:79], v10 offset:25536
    s_add_u32 m0, s28, 32768
    v_mfma_f32_16x16x32_bf16 v[148:151], v[80:83], v[44:47], v[148:151]
    s_setprio 0
    buffer_load_dwordx4 v4, s[8:11], s66 offen offset:2048 sc1 lds
    v_mfma_f32_16x16x32_bf16 v[152:155], v[80:83], v[48:51], v[152:155]
    s_setprio 1
    v_mfma_f32_16x16x32_bf16 v[152:155], v[84:87], v[64:67], v[152:155]
    s_setprio 0
    v_mfma_f32_16x16x32_bf16 v[156:159], v[84:87], v[68:71], v[156:159]
    s_setprio 1
    v_mfma_f32_16x16x32_bf16 v[156:159], v[80:83], v[52:55], v[156:159]
    s_setprio 0
    ds_read_b64_tr_b16 v[80:81], v10 offset:14688
    s_waitcnt lgkmcnt(5)
    v_mfma_f32_16x16x32_bf16 v[188:191], v[88:91], v[52:55], v[188:191]
    s_setprio 1
    ds_read_b64_tr_b16 v[82:83], v10 offset:18272
    v_mfma_f32_16x16x32_bf16 v[188:191], v[28:31], v[68:71], v[188:191]
    s_setprio 0
    ds_read_b64_tr_b16 v[84:85], v10 offset:21984
    v_mfma_f32_16x16x32_bf16 v[184:187], v[28:31], v[64:67], v[184:187]
    s_setprio 1
    ds_read_b64_tr_b16 v[86:87], v10 offset:25568
    s_add_u32 m0, s28, 32768
    v_mfma_f32_16x16x32_bf16 v[184:187], v[88:91], v[48:51], v[184:187]
    s_setprio 0
    buffer_load_dwordx4 v5, s[8:11], s66 offen offset:3072 sc1 lds
    v_mfma_f32_16x16x32_bf16 v[180:183], v[88:91], v[44:47], v[180:183]
    s_setprio 1
    s_add_u32 s64, s64, 128
    s_bitset0_b32 s64, 11
    v_mfma_f32_16x16x32_bf16 v[180:183], v[28:31], v[60:63], v[180:183]
    s_setprio 0
    s_add_u32 s66, s64, 30720
    s_waitcnt vmcnt(11) lgkmcnt(0)
    s_barrier
    v_mfma_f32_16x16x32_bf16 v[176:179], v[28:31], v[56:59], v[176:179]
    s_setprio 1
    ds_read_b128 v[12:15], v8 offset:6144
    s_add_u32 m0, s29, 14592
    v_mfma_f32_16x16x32_bf16 v[176:179], v[88:91], v[40:43], v[176:179]
    s_setprio 0
    ds_read_b64_tr_b16 v[88:89], v10 offset:29184
    buffer_load_dwordx4 v6, s[16:19], s65 offen lds
    v_mfma_f32_16x16x32_bf16 v[208:211], v[72:75], v[40:43], v[208:211]
    s_setprio 1
    ds_read_b64_tr_b16 v[90:91], v10 offset:32768
    s_add_u32 s65, s65, 229376
    v_mfma_f32_16x16x32_bf16 v[208:211], v[76:79], v[56:59], v[208:211]
    s_setprio 0
    ds_read_b64_tr_b16 v[28:29], v10 offset:36480
    v_mfma_f32_16x16x32_bf16 v[212:215], v[76:79], v[60:63], v[212:215]
    s_setprio 1
    ds_read_b64_tr_b16 v[30:31], v10 offset:40064
    v_mfma_f32_16x16x32_bf16 v[212:215], v[72:75], v[44:47], v[212:215]
    s_setprio 0
    ds_read_b128 v[36:39], v9 offset:6144
    v_mfma_f32_16x16x32_bf16 v[216:219], v[72:75], v[48:51], v[216:219]
    s_setprio 1
    ds_read_b64_tr_b16 v[16:17], v10 offset:29216
    v_mfma_f32_16x16x32_bf16 v[216:219], v[76:79], v[64:67], v[216:219]
    s_setprio 0
    ds_read_b64_tr_b16 v[18:19], v10 offset:32800
    v_mfma_f32_16x16x32_bf16 v[220:223], v[76:79], v[68:71], v[220:223]
    s_setprio 1
    s_add_u32 m0, s29, 21888
    v_mfma_f32_16x16x32_bf16 v[220:223], v[72:75], v[52:55], v[220:223]
    s_setprio 0
    buffer_load_dwordx4 v6, s[16:19], s65 offen lds
    v_mfma_f32_16x16x32_bf16 v[252:255], v[80:83], v[52:55], v[252:255]
    s_setprio 1
    ds_read_b128 v[52:55], v9 offset:4096
    ds_read_b64_tr_b16 v[72:73], v10 offset:36512
    s_add_u32 s65, s65, 229376
    v_mfma_f32_16x16x32_bf16 v[252:255], v[84:87], v[68:71], v[252:255]
    s_setprio 0
    ds_read_b128 v[68:71], v8 offset:4096
    ds_read_b64_tr_b16 v[74:75], v10 offset:40096
    v_mfma_f32_16x16x32_bf16 v[248:251], v[84:87], v[64:67], v[248:251]
    s_setprio 1
    ds_read_b128 v[64:67], v8 offset:2048
    v_mfma_f32_16x16x32_bf16 v[248:251], v[80:83], v[48:51], v[248:251]
    s_setprio 0
    ds_read_b128 v[48:51], v9 offset:2048
    v_mfma_f32_16x16x32_bf16 v[244:247], v[80:83], v[44:47], v[244:247]
    s_setprio 1
    ds_read_b128 v[44:47], v9 offset:0
    ds_read_b64_tr_b16 v[76:77], v10 offset:29248
    v_mfma_f32_16x16x32_bf16 v[244:247], v[84:87], v[60:63], v[244:247]
    s_setprio 0
    ds_read_b128 v[60:63], v8 offset:0
    ds_read_b64_tr_b16 v[78:79], v10 offset:32832
    v_mfma_f32_16x16x32_bf16 v[240:243], v[84:87], v[56:59], v[240:243]
    s_setprio 1
    s_mov_b32 m0, 134144
    v_mfma_f32_16x16x32_bf16 v[240:243], v[80:83], v[40:43], v[240:243]
    s_setprio 0
    buffer_load_dwordx4 v35, s[76:79], s37 offen  lds
    s_add_u32 s37, s37, 196608
    s_waitcnt lgkmcnt(12)
    v_mfma_f32_16x16x32_bf16 v[140:143], v[88:91], v[12:15], v[140:143]
    s_setprio 1
    ds_read_b64_tr_b16 v[80:81], v10 offset:36544
    v_mfma_f32_16x16x32_bf16 v[140:143], v[28:31], v[36:39], v[140:143]
    s_setprio 0
    ds_read_b64_tr_b16 v[82:83], v10 offset:40128
    s_waitcnt lgkmcnt(9)
    v_mfma_f32_16x16x32_bf16 v[136:139], v[28:31], v[52:55], v[136:139]
    s_setprio 1
    v_mfma_f32_16x16x32_bf16 v[136:139], v[88:91], v[68:71], v[136:139]
    s_setprio 0
    s_waitcnt lgkmcnt(6)
    v_mfma_f32_16x16x32_bf16 v[132:135], v[88:91], v[64:67], v[132:135]
    s_setprio 1
    ds_read_b64_tr_b16 v[84:85], v10 offset:29280
    v_mfma_f32_16x16x32_bf16 v[132:135], v[28:31], v[48:51], v[132:135]
    s_setprio 0
    ds_read_b64_tr_b16 v[86:87], v10 offset:32864
    s_waitcnt lgkmcnt(5)
    v_mfma_f32_16x16x32_bf16 v[128:131], v[28:31], v[44:47], v[128:131]
    s_setprio 1
    s_mov_b32 m0, 140288
    v_mfma_f32_16x16x32_bf16 v[128:131], v[88:91], v[60:63], v[128:131]
    s_setprio 0
    buffer_load_dwordx4 v35, s[76:79], s37 offen  lds
    v_mfma_f32_16x16x32_bf16 v[160:163], v[16:19], v[60:63], v[160:163]
    s_setprio 1
    ds_read_b64_tr_b16 v[88:89], v10 offset:36576
    s_add_u32 s37, s37, 196608
    v_mfma_f32_16x16x32_bf16 v[160:163], v[72:75], v[44:47], v[160:163]
    s_setprio 0
    ds_read_b64_tr_b16 v[90:91], v10 offset:40160
    v_mfma_f32_16x16x32_bf16 v[164:167], v[72:75], v[48:51], v[164:167]
    s_setprio 1
    v_mfma_f32_16x16x32_bf16 v[164:167], v[16:19], v[64:67], v[164:167]
    s_setprio 0
    v_mfma_f32_16x16x32_bf16 v[168:171], v[16:19], v[68:71], v[168:171]
    s_setprio 1
    v_mfma_f32_16x16x32_bf16 v[168:171], v[72:75], v[52:55], v[168:171]
    s_setprio 0
    s_waitcnt vmcnt(11) lgkmcnt(0)
    s_barrier
    v_mfma_f32_16x16x32_bf16 v[172:175], v[72:75], v[36:39], v[172:175]
    s_setprio 1
    ds_read_b64_tr_b16 v[28:29], v92 offset:45056
    s_add_u32 m0, s29, 29184
    v_mfma_f32_16x16x32_bf16 v[172:175], v[16:19], v[12:15], v[172:175]
    s_setprio 0
    ds_read_b64_tr_b16 v[30:31], v92 offset:46080
    buffer_load_dwordx4 v6, s[12:15], s65 offen lds
    v_mfma_f32_16x16x32_bf16 v[204:207], v[76:79], v[12:15], v[204:207]
    s_setprio 1
    ds_read_b64_tr_b16 v[16:17], v92 offset:51200
    s_add_u32 s65, s65, 229376
    v_mfma_f32_16x16x32_bf16 v[204:207], v[80:83], v[36:39], v[204:207]
    s_setprio 0
    ds_read_b64_tr_b16 v[18:19], v92 offset:52224
    v_mfma_f32_16x16x32_bf16 v[200:203], v[80:83], v[52:55], v[200:203]
    s_setprio 1
    v_mfma_f32_16x16x32_bf16 v[200:203], v[76:79], v[68:71], v[200:203]
    s_setprio 0
    v_mfma_f32_16x16x32_bf16 v[196:199], v[76:79], v[64:67], v[196:199]
    s_setprio 1
    ds_read_b64_tr_b16 v[72:73], v32 offset:45056
    v_mfma_f32_16x16x32_bf16 v[196:199], v[80:83], v[48:51], v[196:199]
    s_setprio 0
    ds_read_b64_tr_b16 v[74:75], v32 offset:46080
    v_mfma_f32_16x16x32_bf16 v[192:195], v[80:83], v[44:47], v[192:195]
    s_setprio 1
    s_add_u32 m0, s29, 36480
    v_mfma_f32_16x16x32_bf16 v[192:195], v[76:79], v[60:63], v[192:195]
    s_setprio 0
    buffer_load_dwordx4 v6, s[12:15], s65 offen lds
    v_mfma_f32_16x16x32_bf16 v[224:227], v[84:87], v[60:63], v[224:227]
    s_setprio 1
    ds_read_b64_tr_b16 v[76:77], v32 offset:51200
    s_sub_u32 s65, s65, 229376
    v_mfma_f32_16x16x32_bf16 v[224:227], v[88:91], v[44:47], v[224:227]
    s_setprio 0
    ds_read_b64_tr_b16 v[78:79], v32 offset:52224
    v_mfma_f32_16x16x32_bf16 v[228:231], v[88:91], v[48:51], v[228:231]
    s_setprio 1
    v_mfma_f32_16x16x32_bf16 v[228:231], v[84:87], v[64:67], v[228:231]
    s_setprio 0
    v_mfma_f32_16x16x32_bf16 v[232:235], v[84:87], v[68:71], v[232:235]
    s_setprio 1
    ds_read_b64_tr_b16 v[80:81], v10 offset:43776
    v_mfma_f32_16x16x32_bf16 v[232:235], v[88:91], v[52:55], v[232:235]
    s_setprio 0
    ds_read_b64_tr_b16 v[82:83], v10 offset:47360
    v_mfma_f32_16x16x32_bf16 v[236:239], v[88:91], v[36:39], v[236:239]
    s_setprio 1
    s_mov_b32 m0, 28672
    v_mfma_f32_16x16x32_bf16 v[236:239], v[84:87], v[12:15], v[236:239]
    s_setprio 0
    s_add_u32 s5, s64, 262144
    buffer_load_dwordx4 v4, s[8:11], s5 offen offset:0 sc1 lds
    s_waitcnt lgkmcnt(6)
    v_mfma_f32_16x16x32_bf16 v[108:111], v[28:31], v[12:15], v[108:111]
    s_setprio 1
    ds_read_b64_tr_b16 v[84:85], v10 offset:51072
    v_mfma_f32_16x16x32_bf16 v[108:111], v[16:19], v[36:39], v[108:111]
    s_setprio 0
    ds_read_b64_tr_b16 v[86:87], v10 offset:54656
    v_mfma_f32_16x16x32_bf16 v[104:107], v[16:19], v[52:55], v[104:107]
    s_setprio 1
    s_add_u32 m0, s28, 0
    v_mfma_f32_16x16x32_bf16 v[104:107], v[28:31], v[68:71], v[104:107]
    s_setprio 0
    buffer_load_dwordx4 v4, s[8:11], s64 offen offset:0 sc1 lds
    v_mfma_f32_16x16x32_bf16 v[100:103], v[28:31], v[64:67], v[100:103]
    s_setprio 1
    ds_read_b64_tr_b16 v[88:89], v10 offset:43808
    v_mfma_f32_16x16x32_bf16 v[100:103], v[16:19], v[48:51], v[100:103]
    s_setprio 0
    ds_read_b64_tr_b16 v[90:91], v10 offset:47392
    v_mfma_f32_16x16x32_bf16 v[96:99], v[16:19], v[44:47], v[96:99]
    s_setprio 1
    v_mfma_f32_16x16x32_bf16 v[96:99], v[28:31], v[60:63], v[96:99]
    s_setprio 0
    s_waitcnt lgkmcnt(6)
    v_mfma_f32_16x16x32_bf16 v[112:115], v[72:75], v[60:63], v[112:115]
    s_setprio 1
    ds_read_b64_tr_b16 v[28:29], v10 offset:51104
    v_mfma_f32_16x16x32_bf16 v[112:115], v[76:79], v[44:47], v[112:115]
    s_setprio 0
    ds_read_b64_tr_b16 v[30:31], v10 offset:54688
    v_mfma_f32_16x16x32_bf16 v[116:119], v[76:79], v[48:51], v[116:119]
    s_setprio 1
    s_add_u32 m0, s28, 0
    v_mfma_f32_16x16x32_bf16 v[116:119], v[72:75], v[64:67], v[116:119]
    s_setprio 0
    buffer_load_dwordx4 v5, s[8:11], s64 offen offset:1024 sc1 lds
    v_mfma_f32_16x16x32_bf16 v[120:123], v[72:75], v[68:71], v[120:123]
    s_setprio 1
    v_mfma_f32_16x16x32_bf16 v[120:123], v[76:79], v[52:55], v[120:123]
    s_setprio 0
    v_mfma_f32_16x16x32_bf16 v[124:127], v[76:79], v[36:39], v[124:127]
    s_setprio 1
    v_mfma_f32_16x16x32_bf16 v[124:127], v[72:75], v[12:15], v[124:127]
    s_setprio 0
    ds_read_b64_tr_b16 v[72:73], v10 offset:43840
    s_waitcnt lgkmcnt(5)
    v_mfma_f32_16x16x32_bf16 v[156:159], v[80:83], v[12:15], v[156:159]
    s_setprio 1
    ds_read_b64_tr_b16 v[74:75], v10 offset:47424
    v_mfma_f32_16x16x32_bf16 v[156:159], v[84:87], v[36:39], v[156:159]
    s_setprio 0
    ds_read_b64_tr_b16 v[76:77], v10 offset:51136
    v_mfma_f32_16x16x32_bf16 v[152:155], v[84:87], v[52:55], v[152:155]
    s_setprio 1
    ds_read_b64_tr_b16 v[78:79], v10 offset:54720
    s_add_u32 m0, s28, 0
    v_mfma_f32_16x16x32_bf16 v[152:155], v[80:83], v[68:71], v[152:155]
    s_setprio 0
    buffer_load_dwordx4 v4, s[8:11], s66 offen offset:2048 sc1 lds
    v_mfma_f32_16x16x32_bf16 v[148:151], v[80:83], v[64:67], v[148:151]
    s_setprio 1
    v_mfma_f32_16x16x32_bf16 v[148:151], v[84:87], v[48:51], v[148:151]
    s_setprio 0
    v_mfma_f32_16x16x32_bf16 v[144:147], v[84:87], v[44:47], v[144:147]
    s_setprio 1
    v_mfma_f32_16x16x32_bf16 v[144:147], v[80:83], v[60:63], v[144:147]
    s_setprio 0
    ds_read_b64_tr_b16 v[80:81], v10 offset:43872
    s_waitcnt lgkmcnt(5)
    v_mfma_f32_16x16x32_bf16 v[176:179], v[88:91], v[60:63], v[176:179]
    s_setprio 1
    ds_read_b64_tr_b16 v[82:83], v10 offset:47456
    v_mfma_f32_16x16x32_bf16 v[176:179], v[28:31], v[44:47], v[176:179]
    s_setprio 0
    ds_read_b64_tr_b16 v[84:85], v10 offset:51168
    v_mfma_f32_16x16x32_bf16 v[180:183], v[28:31], v[48:51], v[180:183]
    s_setprio 1
    ds_read_b64_tr_b16 v[86:87], v10 offset:54752
    s_add_u32 m0, s28, 0
    v_mfma_f32_16x16x32_bf16 v[180:183], v[88:91], v[64:67], v[180:183]
    s_setprio 0
    buffer_load_dwordx4 v5, s[8:11], s66 offen offset:3072 sc1 lds
    v_mfma_f32_16x16x32_bf16 v[184:187], v[88:91], v[68:71], v[184:187]
    s_setprio 1
    s_add_u32 s64, s64, 128
    s_bitset0_b32 s64, 11
    v_mfma_f32_16x16x32_bf16 v[184:187], v[28:31], v[52:55], v[184:187]
    s_setprio 0
    s_add_u32 s66, s64, 30720
    s_waitcnt vmcnt(11) lgkmcnt(0)
    s_barrier
    v_mfma_f32_16x16x32_bf16 v[188:191], v[28:31], v[36:39], v[188:191]
    s_setprio 1
    ds_read_b128 v[40:43], v8 offset:32768
    s_add_u32 m0, s29, 43776
    v_mfma_f32_16x16x32_bf16 v[188:191], v[88:91], v[12:15], v[188:191]
    s_setprio 0
    ds_read_b64_tr_b16 v[88:89], v10 offset:0
    buffer_load_dwordx4 v6, s[16:19], s65 offen lds
    v_mfma_f32_16x16x32_bf16 v[220:223], v[72:75], v[12:15], v[220:223]
    s_setprio 1
    ds_read_b64_tr_b16 v[90:91], v10 offset:3584
    s_add_u32 s65, s65, 229376
    v_mfma_f32_16x16x32_bf16 v[220:223], v[76:79], v[36:39], v[220:223]
    s_setprio 0
    ds_read_b64_tr_b16 v[28:29], v10 offset:7296
    v_mfma_f32_16x16x32_bf16 v[216:219], v[76:79], v[52:55], v[216:219]
    s_setprio 1
    ds_read_b64_tr_b16 v[30:31], v10 offset:10880
    v_mfma_f32_16x16x32_bf16 v[216:219], v[72:75], v[68:71], v[216:219]
    s_setprio 0
    ds_read_b128 v[56:59], v9 offset:32768
    v_mfma_f32_16x16x32_bf16 v[212:215], v[72:75], v[64:67], v[212:215]
    s_setprio 1
    ds_read_b64_tr_b16 v[16:17], v10 offset:32
    v_mfma_f32_16x16x32_bf16 v[212:215], v[76:79], v[48:51], v[212:215]
    s_setprio 0
    ds_read_b64_tr_b16 v[18:19], v10 offset:3616
    v_mfma_f32_16x16x32_bf16 v[208:211], v[76:79], v[44:47], v[208:211]
    s_setprio 1
    s_add_u32 m0, s29, 51072
    v_mfma_f32_16x16x32_bf16 v[208:211], v[72:75], v[60:63], v[208:211]
    s_setprio 0
    buffer_load_dwordx4 v6, s[16:19], s65 offen lds
    v_mfma_f32_16x16x32_bf16 v[240:243], v[80:83], v[60:63], v[240:243]
    s_setprio 1
    ds_read_b128 v[60:63], v9 offset:34816
    ds_read_b64_tr_b16 v[72:73], v10 offset:7328
    s_add_u32 s65, s65, 229376
    v_mfma_f32_16x16x32_bf16 v[240:243], v[84:87], v[44:47], v[240:243]
    s_setprio 0
    ds_read_b128 v[44:47], v8 offset:34816
    ds_read_b64_tr_b16 v[74:75], v10 offset:10912
    v_mfma_f32_16x16x32_bf16 v[244:247], v[84:87], v[48:51], v[244:247]
    s_setprio 1
    ds_read_b128 v[48:51], v8 offset:36864
    v_mfma_f32_16x16x32_bf16 v[244:247], v[80:83], v[64:67], v[244:247]
    s_setprio 0
    ds_read_b128 v[64:67], v9 offset:36864
    v_mfma_f32_16x16x32_bf16 v[248:251], v[80:83], v[68:71], v[248:251]
    s_setprio 1
    ds_read_b128 v[68:71], v9 offset:38912
    ds_read_b64_tr_b16 v[76:77], v10 offset:64
    v_mfma_f32_16x16x32_bf16 v[248:251], v[84:87], v[52:55], v[248:251]
    s_setprio 0
    ds_read_b128 v[52:55], v8 offset:38912
    ds_read_b64_tr_b16 v[78:79], v10 offset:3648
    v_mfma_f32_16x16x32_bf16 v[252:255], v[84:87], v[36:39], v[252:255]
    s_setprio 1
    s_mov_b32 m0, 146432
    v_mfma_f32_16x16x32_bf16 v[252:255], v[80:83], v[12:15], v[252:255]
    s_setprio 0
    buffer_load_dwordx4 v35, s[76:79], s37 offen  lds
    s_add_u32 s37, s37, 196608
    s_waitcnt lgkmcnt(12)
    v_mfma_f32_16x16x32_bf16 v[128:131], v[88:91], v[40:43], v[128:131]
    s_setprio 1
    ds_read_b64_tr_b16 v[80:81], v10 offset:7360
    v_mfma_f32_16x16x32_bf16 v[128:131], v[28:31], v[56:59], v[128:131]
    s_setprio 0
    ds_read_b64_tr_b16 v[82:83], v10 offset:10944
    s_waitcnt lgkmcnt(9)
    v_mfma_f32_16x16x32_bf16 v[132:135], v[28:31], v[60:63], v[132:135]
    s_setprio 1
    v_mfma_f32_16x16x32_bf16 v[132:135], v[88:91], v[44:47], v[132:135]
    s_setprio 0
    s_bitcmp1_b32 0x10, s36
    s_cbranch_scc1 L_h3p3_2
L_r3p3_2:
    s_waitcnt lgkmcnt(6)
    v_mfma_f32_16x16x32_bf16 v[136:139], v[88:91], v[48:51], v[136:139]
    s_setprio 1
    ds_read_b64_tr_b16 v[84:85], v10 offset:96
    v_mfma_f32_16x16x32_bf16 v[136:139], v[28:31], v[64:67], v[136:139]
    s_setprio 0
    ds_read_b64_tr_b16 v[86:87], v10 offset:3680
    s_waitcnt lgkmcnt(5)
    v_mfma_f32_16x16x32_bf16 v[140:143], v[28:31], v[68:71], v[140:143]
    s_setprio 1
    s_mov_b32 m0, 152576
    v_mfma_f32_16x16x32_bf16 v[140:143], v[88:91], v[52:55], v[140:143]
    s_setprio 0
    buffer_load_dwordx4 v35, s[76:79], s37 offen  lds
    v_mfma_f32_16x16x32_bf16 v[172:175], v[16:19], v[52:55], v[172:175]
    s_setprio 1
    ds_read_b64_tr_b16 v[88:89], v10 offset:7392
    s_add_u32 s37, s37, 196608
    v_mfma_f32_16x16x32_bf16 v[172:175], v[72:75], v[68:71], v[172:175]
    s_setprio 0
    ds_read_b64_tr_b16 v[90:91], v10 offset:10976
    v_mfma_f32_16x16x32_bf16 v[168:171], v[72:75], v[64:67], v[168:171]
    s_setprio 1
    v_mfma_f32_16x16x32_bf16 v[168:171], v[16:19], v[48:51], v[168:171]
    s_setprio 0
    v_mfma_f32_16x16x32_bf16 v[164:167], v[16:19], v[44:47], v[164:167]
    s_setprio 1
    v_mfma_f32_16x16x32_bf16 v[164:167], v[72:75], v[60:63], v[164:167]
    s_setprio 0
    s_waitcnt vmcnt(11) lgkmcnt(0)
    s_barrier
    v_mfma_f32_16x16x32_bf16 v[160:163], v[72:75], v[56:59], v[160:163]
    s_setprio 1
    ds_read_b64_tr_b16 v[28:29], v92 offset:32768
    s_add_u32 m0, s29, 0
    v_mfma_f32_16x16x32_bf16 v[160:163], v[16:19], v[40:43], v[160:163]
    s_setprio 0
    ds_read_b64_tr_b16 v[30:31], v92 offset:33792
    buffer_load_dwordx4 v6, s[12:15], s65 offen lds
    v_mfma_f32_16x16x32_bf16 v[192:195], v[76:79], v[40:43], v[192:195]
    s_setprio 1
    ds_read_b64_tr_b16 v[16:17], v92 offset:38912
    s_add_u32 s65, s65, 229376
    v_mfma_f32_16x16x32_bf16 v[192:195], v[80:83], v[56:59], v[192:195]
    s_setprio 0
    ds_read_b64_tr_b16 v[18:19], v92 offset:39936
    v_mfma_f32_16x16x32_bf16 v[196:199], v[80:83], v[60:63], v[196:199]
    s_setprio 1
    v_mfma_f32_16x16x32_bf16 v[196:199], v[76:79], v[44:47], v[196:199]
    s_setprio 0
    v_mfma_f32_16x16x32_bf16 v[200:203], v[76:79], v[48:51], v[200:203]
    s_setprio 1
    ds_read_b64_tr_b16 v[72:73], v32 offset:32768
    v_mfma_f32_16x16x32_bf16 v[200:203], v[80:83], v[64:67], v[200:203]
    s_setprio 0
    ds_read_b64_tr_b16 v[74:75], v32 offset:33792
    v_mfma_f32_16x16x32_bf16 v[204:207], v[80:83], v[68:71], v[204:207]
    s_setprio 1
    s_add_u32 m0, s29, 7296
    v_mfma_f32_16x16x32_bf16 v[204:207], v[76:79], v[52:55], v[204:207]
    s_setprio 0
    buffer_load_dwordx4 v6, s[12:15], s65 offen lds
    v_mfma_f32_16x16x32_bf16 v[236:239], v[84:87], v[52:55], v[236:239]
    s_setprio 1
    ds_read_b64_tr_b16 v[76:77], v32 offset:38912
    s_sub_u32 s65, s65, 229376
    v_mfma_f32_16x16x32_bf16 v[236:239], v[88:91], v[68:71], v[236:239]
    s_setprio 0
    ds_read_b64_tr_b16 v[78:79], v32 offset:39936
    v_mfma_f32_16x16x32_bf16 v[232:235], v[88:91], v[64:67], v[232:235]
    s_setprio 1
    v_mfma_f32_16x16x32_bf16 v[232:235], v[84:87], v[48:51], v[232:235]
    s_setprio 0
    v_mfma_f32_16x16x32_bf16 v[228:231], v[84:87], v[44:47], v[228:231]
    s_setprio 1
    ds_read_b64_tr_b16 v[80:81], v10 offset:14592
    v_mfma_f32_16x16x32_bf16 v[228:231], v[88:91], v[60:63], v[228:231]
    s_setprio 0
    ds_read_b64_tr_b16 v[82:83], v10 offset:18176
    v_mfma_f32_16x16x32_bf16 v[224:227], v[88:91], v[56:59], v[224:227]
    s_setprio 1
    s_mov_b32 m0, 61440
    v_mfma_f32_16x16x32_bf16 v[224:227], v[84:87], v[40:43], v[224:227]
    s_setprio 0
    s_add_u32 s5, s64, 262144
    buffer_load_dwordx4 v4, s[8:11], s5 offen offset:0 sc1 lds
    s_waitcnt lgkmcnt(6)
    v_mfma_f32_16x16x32_bf16 v[96:99], v[28:31], v[40:43], v[96:99]
    s_setprio 1
    ds_read_b64_tr_b16 v[84:85], v10 offset:21888
    v_mfma_f32_16x16x32_bf16 v[96:99], v[16:19], v[56:59], v[96:99]
    s_setprio 0
    ds_read_b64_tr_b16 v[86:87], v10 offset:25472
    v_mfma_f32_16x16x32_bf16 v[100:103], v[16:19], v[60:63], v[100:103]
    s_setprio 1
    s_add_u32 m0, s28, 32768
    v_mfma_f32_16x16x32_bf16 v[100:103], v[28:31], v[44:47], v[100:103]
    s_setprio 0
    buffer_load_dwordx4 v4, s[8:11], s64 offen offset:0 sc1 lds
    v_mfma_f32_16x16x32_bf16 v[104:107], v[28:31], v[48:51], v[104:107]
    s_setprio 1
    ds_read_b64_tr_b16 v[88:89], v10 offset:14624
    v_mfma_f32_16x16x32_bf16 v[104:107], v[16:19], v[64:67], v[104:107]
    s_setprio 0
    ds_read_b64_tr_b16 v[90:91], v10 offset:18208
    v_mfma_f32_16x16x32_bf16 v[108:111], v[16:19], v[68:71], v[108:111]
    s_setprio 1
    v_mfma_f32_16x16x32_bf16 v[108:111], v[28:31], v[52:55], v[108:111]
    s_setprio 0
    s_add_u32 s36, s36, 1
    s_cmp_lt_u32 s36, 5
    s_cbranch_scc1 L_loop3
    s_mov_b32 s80, 1009664
    s_mov_b32 s81, 987136
    s_mov_b32 s82, 1011712
    s_mov_b32 s29, 107520
    s_mov_b32 s37, 26624
    s_mov_b32 s83, 134144
L_pb0:
    s_waitcnt lgkmcnt(6)
    v_mfma_f32_16x16x32_bf16 v[124:127], v[72:75], v[52:55], v[124:127]
    s_setprio 1
    v_mfma_f32_16x16x32_bf16 v[124:127], v[76:79], v[68:71], v[124:127]
    s_setprio 0
    v_and_b32 v34, 48, v1
    v_add_u32 v34, 160768, v34
    ds_read2_b32 v[12:13], v26 offset0:0 offset1:32
    ds_read2_b32 v[14:15], v26 offset0:64 offset1:96
    v_mfma_f32_16x16x32_bf16 v[120:123], v[76:79], v[64:67], v[120:123]
    s_setprio 1
    s_add_u32 m0, s28, 32768
    v_mfma_f32_16x16x32_bf16 v[120:123], v[72:75], v[48:51], v[120:123]
    s_setprio 0
    buffer_load_dwordx4 v5, s[8:11], s64 offen offset:1024 sc1 lds
    ds_read_b128 v[16:19], v34 offset:0
    v_mov_b32 v94, s69
    v_mov_b32 v95, s69
    v_mfma_f32_16x16x32_bf16 v[116:119], v[72:75], v[44:47], v[116:119]
    s_setprio 1
    v_mfma_f32_16x16x32_bf16 v[116:119], v[76:79], v[60:63], v[116:119]
    s_setprio 0
    v_lshrrev_b32 v30, 4, v1
    v_and_b32 v29, 15, v1
    v_lshlrev_b32 v28, 1, v30
    v_mfma_f32_16x16x32_bf16 v[112:115], v[76:79], v[56:59], v[112:115]
    s_setprio 1
    v_mfma_f32_16x16x32_bf16 v[112:115], v[72:75], v[40:43], v[112:115]
    s_setprio 0
    ds_read_b64_tr_b16 v[72:73], v10 offset:21920
    ds_read_b128 v[20:23], v34 offset:256
    s_waitcnt lgkmcnt(2)
    v_fmac_f32 v128, v12, v16
    v_fmac_f32 v129, v12, v17
    v_mfma_f32_16x16x32_bf16 v[144:147], v[80:83], v[40:43], v[144:147]
    s_setprio 1
    ds_read_b64_tr_b16 v[74:75], v10 offset:25504
    v_mfma_f32_16x16x32_bf16 v[144:147], v[84:87], v[56:59], v[144:147]
    s_setprio 0
    ds_read_b64_tr_b16 v[76:77], v10 offset:14656
    v_fmac_f32 v130, v12, v18
    v_fmac_f32 v131, v12, v19
    v_fmac_f32 v132, v13, v16
    v_fmac_f32 v133, v13, v17
    v_mfma_f32_16x16x32_bf16 v[148:151], v[84:87], v[60:63], v[148:151]
    s_setprio 1
    ds_read_b64_tr_b16 v[78:79], v10 offset:18240
    s_add_u32 m0, s28, 32768
    v_mfma_f32_16x16x32_bf16 v[148:151], v[80:83], v[44:47], v[148:151]
    s_setprio 0
    buffer_load_dwordx4 v4, s[8:11], s66 offen offset:2048 sc1 lds
    v_fmac_f32 v134, v13, v18
    v_fmac_f32 v135, v13, v19
    v_fmac_f32 v136, v14, v16
    v_mfma_f32_16x16x32_bf16 v[152:155], v[80:83], v[48:51], v[152:155]
    s_setprio 1
    v_mfma_f32_16x16x32_bf16 v[152:155], v[84:87], v[64:67], v[152:155]
    s_setprio 0
    v_fmac_f32 v137, v14, v17
    v_fmac_f32 v138, v14, v18
    v_fmac_f32 v139, v14, v19
    v_mfma_f32_16x16x32_bf16 v[156:159], v[84:87], v[68:71], v[156:159]
    s_setprio 1
    v_mfma_f32_16x16x32_bf16 v[156:159], v[80:83], v[52:55], v[156:159]
    s_setprio 0
    ds_read_b64_tr_b16 v[80:81], v10 offset:21952
    v_fmac_f32 v140, v15, v16
    v_fmac_f32 v141, v15, v17
    v_fmac_f32 v142, v15, v18
    s_waitcnt lgkmcnt(3)
    v_mfma_f32_16x16x32_bf16 v[188:191], v[88:91], v[52:55], v[188:191]
    s_setprio 1
    ds_read_b64_tr_b16 v[82:83], v10 offset:25536
    v_mfma_f32_16x16x32_bf16 v[188:191], v[72:75], v[68:71], v[188:191]
    s_setprio 0
    ds_read_b64_tr_b16 v[84:85], v10 offset:14688
    v_fmac_f32 v143, v15, v19
    v_xor_b32 v29, v29, v28
    v_lshlrev_b32 v29, 4, v29
    v_lshl_add_u32 v29, v30, 11, v29
    v_mfma_f32_16x16x32_bf16 v[184:187], v[72:75], v[64:67], v[184:187]
    s_setprio 1
    ds_read_b64_tr_b16 v[86:87], v10 offset:18272
    s_add_u32 m0, s28, 32768
    v_mfma_f32_16x16x32_bf16 v[184:187], v[88:91], v[48:51], v[184:187]
    s_setprio 0
    buffer_load_dwordx4 v5, s[8:11], s66 offen offset:3072 sc1 lds
    s_lshl_b32 s5, s59, 14
    s_lshl_b32 s6, s72, 8
    s_add_u32 s5, s5, s6
    v_add_u32 v6, s5, v29
    v_xor_b32 v7, 0x80, v6
    ds_read_b128 v[16:19], v34 offset:64
    v_mfma_f32_16x16x32_bf16 v[180:183], v[88:91], v[44:47], v[180:183]
    s_setprio 1
    s_add_u32 s64, s64, 128
    s_bitset0_b32 s64, 11
    v_mfma_f32_16x16x32_bf16 v[180:183], v[72:75], v[60:63], v[180:183]
    s_setprio 0
    s_add_u32 s66, s64, 30720
    v_fmac_f32 v144, v12, v20
    v_fmac_f32 v145, v12, v21
    v_fmac_f32 v146, v12, v22
    v_mfma_f32_16x16x32_bf16 v[176:179], v[72:75], v[56:59], v[176:179]
    s_setprio 1
    v_mfma_f32_16x16x32_bf16 v[176:179], v[88:91], v[40:43], v[176:179]
    s_setprio 0
    ds_read_b64_tr_b16 v[88:89], v10 offset:21984
    v_fmac_f32 v147, v12, v23
    v_fmac_f32 v148, v13, v20
    v_fmac_f32 v149, v13, v21
    s_waitcnt lgkmcnt(4)
    v_mfma_f32_16x16x32_bf16 v[208:211], v[76:79], v[40:43], v[208:211]
    s_setprio 1
    ds_read_b64_tr_b16 v[90:91], v10 offset:25568
    v_mfma_f32_16x16x32_bf16 v[208:211], v[80:83], v[56:59], v[208:211]
    s_setprio 0
    v_fmac_f32 v150, v13, v22
    v_fmac_f32 v151, v13, v23
    v_fmac_f32 v152, v14, v20
    v_fmac_f32 v153, v14, v21
    s_waitcnt vmcnt(10) lgkmcnt(0)
    s_barrier
    v_mfma_f32_16x16x32_bf16 v[212:215], v[80:83], v[60:63], v[212:215]
    s_setprio 1
    ds_read_b64_tr_b16 v[72:73], v10 offset:29184
    s_add_u32 m0, s83, 0x0
    v_mfma_f32_16x16x32_bf16 v[212:215], v[76:79], v[44:47], v[212:215]
    s_setprio 0
    ds_read_b64_tr_b16 v[74:75], v10 offset:32768
    buffer_load_dwordx4 v35, s[76:79], s37 offen  lds
    v_fmac_f32 v154, v14, v22
    v_fmac_f32 v155, v14, v23
    v_fmac_f32 v156, v15, v20
    v_mfma_f32_16x16x32_bf16 v[216:219], v[76:79], v[48:51], v[216:219]
    s_setprio 1
    s_add_u32 s37, s37, 196608
    v_mfma_f32_16x16x32_bf16 v[216:219], v[80:83], v[64:67], v[216:219]
    s_setprio 0
    v_fmac_f32 v157, v15, v21
    v_fmac_f32 v158, v15, v22
    v_fmac_f32 v159, v15, v23
    v_mfma_f32_16x16x32_bf16 v[220:223], v[80:83], v[68:71], v[220:223]
    s_setprio 1
    s_add_u32 m0, s83, 0x1800
    v_mfma_f32_16x16x32_bf16 v[220:223], v[76:79], v[52:55], v[220:223]
    s_setprio 0
    ds_read_b64_tr_b16 v[76:77], v10 offset:36480
    buffer_load_dwordx4 v35, s[76:79], s37 offen  lds
    v_add_u32 v7, 7168, v7
    v_lshrrev_b32 v31, 4, v1
    v_lshrrev_b32 v28, 2, v1
    v_mfma_f32_16x16x32_bf16 v[252:255], v[84:87], v[52:55], v[252:255]
    s_setprio 1
    ds_read_b128 v[52:55], v8 offset:6144
    ds_read_b64_tr_b16 v[78:79], v10 offset:40064
    s_add_u32 s37, s37, 196608
    v_mfma_f32_16x16x32_bf16 v[252:255], v[88:91], v[68:71], v[252:255]
    s_setprio 0
    ds_read_b128 v[68:71], v9 offset:6144
    ds_read_b64_tr_b16 v[80:81], v10 offset:29216
    v_and_b32 v29, 3, v1
    v_lshlrev_b32 v29, 3, v29
    v_lshl_add_u32 v30, v28, 6, v29
    ds_read_b128 v[20:23], v34 offset:320
    v_mfma_f32_16x16x32_bf16 v[248:251], v[88:91], v[64:67], v[248:251]
    s_setprio 1
    ds_read_b128 v[64:67], v9 offset:4096
    ds_read_b64_tr_b16 v[82:83], v10 offset:32800
    v_mfma_f32_16x16x32_bf16 v[248:251], v[84:87], v[48:51], v[248:251]
    s_setprio 0
    ds_read_b128 v[48:51], v8 offset:4096
    v_fmac_f32 v160, v12, v16
    v_fmac_f32 v161, v12, v17
    v_fmac_f32 v162, v12, v18
    v_mfma_f32_16x16x32_bf16 v[244:247], v[84:87], v[44:47], v[244:247]
    s_setprio 1
    ds_read_b128 v[44:47], v8 offset:2048
    v_mfma_f32_16x16x32_bf16 v[244:247], v[88:91], v[60:63], v[244:247]
    s_setprio 0
    ds_read_b128 v[60:63], v9 offset:2048
    v_fmac_f32 v163, v12, v19
    v_fmac_f32 v164, v13, v16
    v_fmac_f32 v165, v13, v17
    v_mfma_f32_16x16x32_bf16 v[240:243], v[88:91], v[56:59], v[240:243]
    s_setprio 1
    ds_read_b128 v[56:59], v9 offset:0
    v_mfma_f32_16x16x32_bf16 v[240:243], v[84:87], v[40:43], v[240:243]
    s_setprio 0
    ds_read_b128 v[40:43], v8 offset:0
    ds_read_b64_tr_b16 v[84:85], v10 offset:36512
    v_fmac_f32 v166, v13, v18
    v_fmac_f32 v167, v13, v19
    v_fmac_f32 v168, v14, v16
    s_waitcnt lgkmcnt(10)
    v_mfma_f32_16x16x32_bf16 v[140:143], v[72:75], v[52:55], v[140:143]
    s_setprio 1
    ds_read_b64_tr_b16 v[86:87], v10 offset:40096
    v_mfma_f32_16x16x32_bf16 v[140:143], v[76:79], v[68:71], v[140:143]
    s_setprio 0
    ds_read_b64_tr_b16 v[88:89], v10 offset:29248
    v_fmac_f32 v169, v14, v17
    v_fmac_f32 v170, v14, v18
    v_fmac_f32 v171, v14, v19
    v_fmac_f32 v172, v15, v16
    s_waitcnt lgkmcnt(7)
    v_mfma_f32_16x16x32_bf16 v[136:139], v[76:79], v[64:67], v[136:139]
    s_setprio 1
    ds_read_b64_tr_b16 v[90:91], v10 offset:32832
    v_mfma_f32_16x16x32_bf16 v[136:139], v[72:75], v[48:51], v[136:139]
    s_setprio 0
    v_fmac_f32 v173, v15, v17
    v_fmac_f32 v174, v15, v18
    v_fmac_f32 v175, v15, v19
    s_waitcnt lgkmcnt(6)
    v_mfma_f32_16x16x32_bf16 v[132:135], v[72:75], v[44:47], v[132:135]
    s_setprio 1
    v_mfma_f32_16x16x32_bf16 v[132:135], v[76:79], v[60:63], v[132:135]
    s_setprio 0
    v_add_u32 v38, 161792, v30
    v_mul_u32_u24 v37, 144, v28
    s_lshl_b32 s5, s60, 5
    s_add_u32 s5, s5, 98304
    v_add3_u32 v37, v37, v29, s5
    s_waitcnt lgkmcnt(4)
    v_mfma_f32_16x16x32_bf16 v[128:131], v[76:79], v[56:59], v[128:131]
    s_setprio 1
    v_mfma_f32_16x16x32_bf16 v[128:131], v[72:75], v[40:43], v[128:131]
    s_setprio 0
    ds_read_b64_tr_b16 v[72:73], v10 offset:36544
    v_and_b32 v30, 15, v1
    v_mul_u32_u24 v30, 144, v30
    ds_read_b128 v[16:19], v34 offset:384
    s_waitcnt lgkmcnt(4)
    v_mfma_f32_16x16x32_bf16 v[160:163], v[80:83], v[40:43], v[160:163]
    s_setprio 1
    ds_read_b64_tr_b16 v[74:75], v10 offset:40128
    v_mfma_f32_16x16x32_bf16 v[160:163], v[84:87], v[56:59], v[160:163]
    s_setprio 0
    ds_read_b64_tr_b16 v[76:77], v10 offset:29280
    v_fmac_f32 v176, v12, v20
    v_fmac_f32 v177, v12, v21
    v_fmac_f32 v178, v12, v22
    v_fmac_f32 v179, v12, v23
    v_mfma_f32_16x16x32_bf16 v[164:167], v[84:87], v[60:63], v[164:167]
    s_setprio 1
    ds_read_b64_tr_b16 v[78:79], v10 offset:32864
    v_mfma_f32_16x16x32_bf16 v[164:167], v[80:83], v[44:47], v[164:167]
    s_setprio 0
    v_fmac_f32 v180, v13, v20
    v_fmac_f32 v181, v13, v21
    v_fmac_f32 v182, v13, v22
    v_mfma_f32_16x16x32_bf16 v[168:171], v[80:83], v[48:51], v[168:171]
    s_setprio 1
    v_mfma_f32_16x16x32_bf16 v[168:171], v[84:87], v[64:67], v[168:171]
    s_setprio 0
    v_fmac_f32 v183, v13, v23
    v_fmac_f32 v184, v14, v20
    v_fmac_f32 v185, v14, v21
    v_mfma_f32_16x16x32_bf16 v[172:175], v[84:87], v[68:71], v[172:175]
    s_setprio 1
    v_mfma_f32_16x16x32_bf16 v[172:175], v[80:83], v[52:55], v[172:175]
    s_setprio 0
    ds_read_b64_tr_b16 v[80:81], v10 offset:36576
    v_fmac_f32 v186, v14, v22
    v_fmac_f32 v187, v14, v23
    v_fmac_f32 v188, v15, v20
    s_waitcnt lgkmcnt(3)
    v_mfma_f32_16x16x32_bf16 v[204:207], v[88:91], v[52:55], v[204:207]
    s_setprio 1
    ds_read_b64_tr_b16 v[82:83], v10 offset:40160
    v_mfma_f32_16x16x32_bf16 v[204:207], v[72:75], v[68:71], v[204:207]
    s_setprio 0
    v_fmac_f32 v189, v15, v21
    v_fmac_f32 v190, v15, v22
    v_fmac_f32 v191, v15, v23
    v_lshl_add_u32 v30, v31, 3, v30
    s_waitcnt vmcnt(6) lgkmcnt(0)
    s_barrier
    v_mfma_f32_16x16x32_bf16 v[200:203], v[72:75], v[64:67], v[200:203]
    s_setprio 1
    ds_read_b64_tr_b16 v[84:85], v92 offset:45056
    s_add_u32 m0, s83, 0xffffe800
    v_mfma_f32_16x16x32_bf16 v[200:203], v[88:91], v[48:51], v[200:203]
    s_setprio 0
    ds_read_b64_tr_b16 v[86:87], v92 offset:46080
    buffer_load_dwordx4 v35, s[76:79], s37 offen  lds
    s_mul_i32 s5, s59, 4608
    s_add_u32 s5, s5, 98304
    v_add_u32 v36, s5, v30
    v_and_b32 v30, 7, v28
    s_and_b32 s5, s59, 3
    s_xor_b32 s5, s5, s70
    s_lshl_b32 s5, s5, 1
    v_xor_b32 v30, s5, v30
    v_mfma_f32_16x16x32_bf16 v[196:199], v[88:91], v[44:47], v[196:199]
    s_setprio 1
    s_add_u32 s37, s37, 196608
    v_mfma_f32_16x16x32_bf16 v[196:199], v[72:75], v[60:63], v[196:199]
    s_setprio 0
    v_lshl_add_u32 v30, v30, 5, v29
    ds_read_b128 v[20:23], v34 offset:128
    v_fmac_f32 v208, v12, v16
    v_mfma_f32_16x16x32_bf16 v[192:195], v[72:75], v[56:59], v[192:195]
    s_setprio 1
    s_add_u32 m0, s28, 0
    v_mfma_f32_16x16x32_bf16 v[192:195], v[88:91], v[40:43], v[192:195]
    s_setprio 0
    ds_read_b64_tr_b16 v[88:89], v92 offset:51200
    buffer_load_dwordx4 v4, s[8:11], s64 offen offset:0 sc1 lds
    v_fmac_f32 v209, v12, v17
    v_fmac_f32 v210, v12, v18
    v_fmac_f32 v211, v12, v19
    v_mfma_f32_16x16x32_bf16 v[224:227], v[76:79], v[40:43], v[224:227]
    s_setprio 1
    ds_read_b64_tr_b16 v[90:91], v92 offset:52224
    v_mfma_f32_16x16x32_bf16 v[224:227], v[80:83], v[56:59], v[224:227]
    s_setprio 0
    ds_read_b64_tr_b16 v[72:73], v32 offset:45056
    v_fmac_f32 v212, v13, v16
    v_fmac_f32 v213, v13, v17
    v_fmac_f32 v214, v13, v18
    v_fmac_f32 v215, v13, v19
    v_mfma_f32_16x16x32_bf16 v[228:231], v[80:83], v[60:63], v[228:231]
    s_setprio 1
    ds_read_b64_tr_b16 v[74:75], v32 offset:46080
    s_add_u32 m0, s28, 0
    v_mfma_f32_16x16x32_bf16 v[228:231], v[76:79], v[44:47], v[228:231]
    s_setprio 0
    buffer_load_dwordx4 v5, s[8:11], s64 offen offset:1024 sc1 lds
    v_fmac_f32 v216, v14, v16
    v_fmac_f32 v217, v14, v17
    v_fmac_f32 v218, v14, v18
    v_mfma_f32_16x16x32_bf16 v[232:235], v[76:79], v[48:51], v[232:235]
    s_setprio 1
    v_mfma_f32_16x16x32_bf16 v[232:235], v[80:83], v[64:67], v[232:235]
    s_setprio 0
    v_fmac_f32 v219, v14, v19
    v_fmac_f32 v220, v15, v16
    v_fmac_f32 v221, v15, v17
    v_mfma_f32_16x16x32_bf16 v[236:239], v[80:83], v[68:71], v[236:239]
    s_setprio 1
    s_add_u32 m0, s28, 0
    v_mfma_f32_16x16x32_bf16 v[236:239], v[76:79], v[52:55], v[236:239]
    s_setprio 0
    ds_read_b64_tr_b16 v[76:77], v32 offset:51200
    buffer_load_dwordx4 v4, s[8:11], s66 offen offset:2048 sc1 lds
    v_fmac_f32 v222, v15, v18
    v_fmac_f32 v223, v15, v19
    v_lshl_add_u32 v24, v28, 8, v30
    s_waitcnt lgkmcnt(3)
    v_mfma_f32_16x16x32_bf16 v[108:111], v[84:87], v[52:55], v[108:111]
    s_setprio 1
    ds_read_b64_tr_b16 v[78:79], v32 offset:52224
    v_mfma_f32_16x16x32_bf16 v[108:111], v[88:91], v[68:71], v[108:111]
    s_setprio 0
    ds_read_b64_tr_b16 v[80:81], v10 offset:43776
    v_xor_b32 v0, v2, v1
    v_and_b32 v0, 48, v0
    v_lshl_add_u32 v0, v28, 11, v0
    v_and_b32 v28, 7, v1
    v_mfma_f32_16x16x32_bf16 v[104:107], v[88:91], v[64:67], v[104:107]
    s_setprio 1
    ds_read_b64_tr_b16 v[82:83], v10 offset:47360
    s_add_u32 m0, s28, 0
    v_mfma_f32_16x16x32_bf16 v[104:107], v[84:87], v[48:51], v[104:107]
    s_setprio 0
    buffer_load_dwordx4 v5, s[8:11], s66 offen offset:3072 sc1 lds
    v_and_b32 v29, 8, v1
    ds_read_b128 v[16:19], v34 offset:192
    v_fmac_f32 v192, v12, v20
    v_mfma_f32_16x16x32_bf16 v[100:103], v[84:87], v[44:47], v[100:103]
    s_setprio 1
    s_add_u32 s64, s64, 128
    s_bitset0_b32 s64, 11
    v_mfma_f32_16x16x32_bf16 v[100:103], v[88:91], v[60:63], v[100:103]
    s_setprio 0
    s_add_u32 s66, s64, 30720
    v_fmac_f32 v193, v12, v21
    v_fmac_f32 v194, v12, v22
    v_fmac_f32 v195, v12, v23
    v_mfma_f32_16x16x32_bf16 v[96:99], v[88:91], v[56:59], v[96:99]
    s_setprio 1
    s_add_u32 m0, s28, 65536
    v_mfma_f32_16x16x32_bf16 v[96:99], v[84:87], v[40:43], v[96:99]
    s_setprio 0
    ds_read_b64_tr_b16 v[84:85], v10 offset:51072
    buffer_load_dwordx4 v4, s[8:11], s64 offen offset:0 sc1 lds
    v_fmac_f32 v196, v13, v20
    v_fmac_f32 v197, v13, v21
    v_fmac_f32 v198, v13, v22
    s_waitcnt lgkmcnt(4)
    v_mfma_f32_16x16x32_bf16 v[112:115], v[72:75], v[40:43], v[112:115]
    s_setprio 1
    ds_read_b64_tr_b16 v[86:87], v10 offset:54656
    v_mfma_f32_16x16x32_bf16 v[112:115], v[76:79], v[56:59], v[112:115]
    s_setprio 0
    ds_read_b64_tr_b16 v[88:89], v10 offset:43808
    v_fmac_f32 v199, v13, v23
    v_fmac_f32 v200, v14, v20
    v_fmac_f32 v201, v14, v21
    v_mfma_f32_16x16x32_bf16 v[116:119], v[76:79], v[60:63], v[116:119]
    s_setprio 1
    ds_read_b64_tr_b16 v[90:91], v10 offset:47392
    s_add_u32 m0, s28, 65536
    v_mfma_f32_16x16x32_bf16 v[116:119], v[72:75], v[44:47], v[116:119]
    s_setprio 0
    buffer_load_dwordx4 v5, s[8:11], s64 offen offset:1024 sc1 lds
    v_fmac_f32 v202, v14, v22
    v_fmac_f32 v203, v14, v23
    v_fmac_f32 v204, v15, v20
    v_fmac_f32 v205, v15, v21
    v_mfma_f32_16x16x32_bf16 v[120:123], v[72:75], v[48:51], v[120:123]
    s_setprio 1
    v_mfma_f32_16x16x32_bf16 v[120:123], v[76:79], v[64:67], v[120:123]
    s_setprio 0
    v_fmac_f32 v206, v15, v22
    v_fmac_f32 v207, v15, v23
    v_lshlrev_b32 v29, 1, v29
    v_mfma_f32_16x16x32_bf16 v[124:127], v[76:79], v[68:71], v[124:127]
    s_setprio 1
    s_add_u32 m0, s28, 65536
    v_mfma_f32_16x16x32_bf16 v[124:127], v[72:75], v[52:55], v[124:127]
    s_setprio 0
    ds_read_b64_tr_b16 v[72:73], v10 offset:51104
    buffer_load_dwordx4 v4, s[8:11], s66 offen offset:2048 sc1 lds
    v_lshl_add_u32 v28, v28, 7, v29
    s_lshr_b32 s5, s59, 1
    s_lshl_b32 s5, s5, 2
    v_add_u32 v39, s5, v28
    s_lshl_b32 s5, s61, 10
    s_add_u32 s5, s5, 135168
    v_add_u32 v11, s5, v2
    s_waitcnt lgkmcnt(3)
    v_mfma_f32_16x16x32_bf16 v[156:159], v[80:83], v[52:55], v[156:159]
    s_setprio 1
    ds_read_b64_tr_b16 v[74:75], v10 offset:54688
    v_mfma_f32_16x16x32_bf16 v[156:159], v[84:87], v[68:71], v[156:159]
    s_setprio 0
    ds_read_b64_tr_b16 v[76:77], v10 offset:43840
    v_xor_b32 v25, 32, v24
    ds_read_b128 v[20:23], v34 offset:448
    v_fmac_f32 v224, v12, v16
    v_mfma_f32_16x16x32_bf16 v[152:155], v[84:87], v[64:67], v[152:155]
    s_setprio 1
    ds_read_b64_tr_b16 v[78:79], v10 offset:47424
    s_add_u32 m0, s28, 65536
    v_mfma_f32_16x16x32_bf16 v[152:155], v[80:83], v[48:51], v[152:155]
    s_setprio 0
    s_add_u32 s20, s56, 0x400000
    s_addc_u32 s21, s57, 0
    s_and_b32 s21, s21, 0xffff
    s_mov_b32 s22, 0x1200000
    s_mov_b32 s23, 0x20000
    buffer_load_dwordx4 v5, s[8:11], s66 offen offset:3072 sc1 lds
    v_fmac_f32 v225, v12, v17
    v_fmac_f32 v226, v12, v18
    v_fmac_f32 v227, v12, v19
    v_fmac_f32 v228, v13, v16
    v_mfma_f32_16x16x32_bf16 v[148:151], v[80:83], v[44:47], v[148:151]
    s_setprio 1
    s_add_u32 s64, s64, 128
    s_bitset0_b32 s64, 11
    v_mfma_f32_16x16x32_bf16 v[148:151], v[84:87], v[60:63], v[148:151]
    s_setprio 0
    s_add_u32 s66, s64, 30720
    s_mov_b32 s12, s52
    s_mov_b32 s13, s53
    s_and_b32 s13, s13, 0xffff
    s_mov_b32 s14, 0x700000
    s_mov_b32 s15, 0x20000
    v_fmac_f32 v229, v13, v17
    v_fmac_f32 v230, v13, v18
    v_fmac_f32 v231, v13, v19
    v_mfma_f32_16x16x32_bf16 v[144:147], v[84:87], v[56:59], v[144:147]
    s_setprio 1
    v_mfma_f32_16x16x32_bf16 v[144:147], v[80:83], v[40:43], v[144:147]
    s_setprio 0
    s_add_u32 s3, s88, 8192
    ds_read_b64_tr_b16 v[80:81], v10 offset:51136
    v_fmac_f32 v232, v14, v16
    v_fmac_f32 v233, v14, v17
    v_fmac_f32 v234, v14, v18
    s_waitcnt lgkmcnt(4)
    v_mfma_f32_16x16x32_bf16 v[176:179], v[88:91], v[40:43], v[176:179]
    s_setprio 1
    ds_read_b64_tr_b16 v[82:83], v10 offset:54720
    v_mfma_f32_16x16x32_bf16 v[176:179], v[72:75], v[56:59], v[176:179]
    s_setprio 0
    ds_read_b64_tr_b16 v[84:85], v10 offset:43872
    v_fmac_f32 v235, v14, v19
    v_fmac_f32 v236, v15, v16
    v_fmac_f32 v237, v15, v17
    v_mfma_f32_16x16x32_bf16 v[180:183], v[72:75], v[60:63], v[180:183]
    s_setprio 1
    ds_read_b64_tr_b16 v[86:87], v10 offset:47456
    v_mfma_f32_16x16x32_bf16 v[180:183], v[88:91], v[44:47], v[180:183]
    s_setprio 0
    v_fmac_f32 v238, v15, v18
    v_fmac_f32 v239, v15, v19
    v_xor_b32 v26, 64, v24
    v_xor_b32 v27, 96, v24
    v_mfma_f32_16x16x32_bf16 v[184:187], v[88:91], v[48:51], v[184:187]
    s_setprio 1
    v_mfma_f32_16x16x32_bf16 v[184:187], v[72:75], v[64:67], v[184:187]
    s_setprio 0
    v_xor_b32 v28, 128, v24
    v_xor_b32 v29, 160, v24
    v_xor_b32 v30, 192, v24
    v_mfma_f32_16x16x32_bf16 v[188:191], v[72:75], v[68:71], v[188:191]
    s_setprio 1
    v_mfma_f32_16x16x32_bf16 v[188:191], v[88:91], v[52:55], v[188:191]
    s_setprio 0
    ds_read_b64_tr_b16 v[88:89], v10 offset:51168
    v_xor_b32 v31, 224, v24
    s_waitcnt lgkmcnt(6)
    v_fmac_f32 v240, v12, v20
    v_fmac_f32 v241, v12, v21
    s_waitcnt lgkmcnt(3)
    v_mfma_f32_16x16x32_bf16 v[220:223], v[76:79], v[52:55], v[220:223]
    s_setprio 1
    ds_read_b64_tr_b16 v[90:91], v10 offset:54752
    v_mfma_f32_16x16x32_bf16 v[220:223], v[80:83], v[68:71], v[220:223]
    s_setprio 0
    v_fmac_f32 v242, v12, v22
    v_fmac_f32 v243, v12, v23
    v_fmac_f32 v244, v13, v20
    s_waitcnt vmcnt(9) lgkmcnt(0)
    s_barrier
    v_mfma_f32_16x16x32_bf16 v[216:219], v[80:83], v[64:67], v[216:219]
    s_setprio 1
    ds_read_b64_tr_b16 v[72:73], v92 offset:32768
    s_add_u32 m0, s83, 0x4800
    v_mfma_f32_16x16x32_bf16 v[216:219], v[76:79], v[48:51], v[216:219]
    s_setprio 0
    ds_read_b64_tr_b16 v[74:75], v92 offset:33792
    buffer_load_dwordx4 v35, s[76:79], s37 offen  lds
    v_fmac_f32 v245, v13, v21
    v_fmac_f32 v246, v13, v22
    v_fmac_f32 v247, v13, v23
    v_fmac_f32 v248, v14, v20
    v_mfma_f32_16x16x32_bf16 v[212:215], v[76:79], v[44:47], v[212:215]
    s_setprio 1
    s_add_u32 s37, s37, 196608
    v_mfma_f32_16x16x32_bf16 v[212:215], v[80:83], v[60:63], v[212:215]
    s_setprio 0
    v_fmac_f32 v249, v14, v21
    v_fmac_f32 v250, v14, v22
    v_fmac_f32 v251, v14, v23
    v_mfma_f32_16x16x32_bf16 v[208:211], v[80:83], v[56:59], v[208:211]
    s_setprio 1
    s_add_u32 m0, s29, 0
    v_mfma_f32_16x16x32_bf16 v[208:211], v[76:79], v[40:43], v[208:211]
    s_setprio 0
    ds_read_b64_tr_b16 v[76:77], v32 offset:32768
    buffer_load_dwordx4 v35, s[76:79], s80 offen  lds
    v_fmac_f32 v252, v15, v20
    v_fmac_f32 v253, v15, v21
    v_fmac_f32 v254, v15, v22
    v_mfma_f32_16x16x32_bf16 v[240:243], v[84:87], v[40:43], v[240:243]
    s_setprio 1
    ds_read_b128 v[40:43], v8 offset:32768
    ds_read_b64_tr_b16 v[78:79], v32 offset:33792
    v_mfma_f32_16x16x32_bf16 v[240:243], v[88:91], v[56:59], v[240:243]
    s_setprio 0
    ds_read_b64_tr_b16 v[80:81], v92 offset:38912
    v_fmac_f32 v255, v15, v23
    v_and_b32 v14, 0xf0, v2
    v_bfe_u32 v15, v1, 4, 1
    v_mfma_f32_16x16x32_bf16 v[244:247], v[88:91], v[60:63], v[244:247]
    s_setprio 1
    ds_read_b64_tr_b16 v[82:83], v92 offset:39936
    s_add_u32 m0, s29, 1024
    v_mfma_f32_16x16x32_bf16 v[244:247], v[84:87], v[44:47], v[244:247]
    s_setprio 0
    ds_read_b128 v[44:47], v8 offset:34816
    buffer_load_dwordx4 v35, s[76:79], s81 offen  lds
    v_lshl_add_u32 v14, v15, 3, v14
    v_lshrrev_b32 v15, 5, v1
    v_lshl_add_u32 v14, v15, 8, v14
    s_lshl_b32 s5, s60, 11
    s_add_u32 s5, s5, 81920
    v_add_u32 v13, s5, v2
    v_mfma_f32_16x16x32_bf16 v[248:251], v[84:87], v[48:51], v[248:251]
    s_setprio 1
    ds_read_b128 v[48:51], v8 offset:36864
    v_mfma_f32_16x16x32_bf16 v[248:251], v[88:91], v[64:67], v[248:251]
    s_setprio 0
    v_mov_b32 v20, s87
    v_mov_b32 v21, s87
    v_mov_b32 v22, s87
    v_mfma_f32_16x16x32_bf16 v[252:255], v[88:91], v[68:71], v[252:255]
    s_setprio 1
    s_add_u32 m0, s29, 2048
    v_mfma_f32_16x16x32_bf16 v[252:255], v[84:87], v[52:55], v[252:255]
    s_setprio 0
    ds_read_b128 v[52:55], v8 offset:38912
    ds_read_b64_tr_b16 v[84:85], v32 offset:38912
    buffer_load_dwordx4 v35, s[76:79], s82 offen  lds
    v_mov_b32 v23, s87
    s_waitcnt lgkmcnt(7)
    v_mfma_f32_16x16x32_bf16 v[96:99], v[72:75], v[40:43], v[96:99]
    ds_read_b64_tr_b16 v[86:87], v32 offset:39936
    ds_read_b128 v[56:59], v9 offset:32768
    ds_read_b128 v[60:63], v9 offset:34816
    ds_read_b128 v[64:67], v9 offset:36864
    ds_read_b128 v[68:71], v9 offset:38912
    v_pk_mul_f32 v[16:17], v[128:129], v[128:129]
    v_pk_mul_f32 v[18:19], v[130:131], v[130:131]
    v_pk_mul_f32 v[144:145], v[128:129], v[144:145]
    v_pk_mul_f32 v[146:147], v[130:131], v[146:147]
    v_pk_fma_f32 v[16:17], v[16:17], s[86:87], v[94:95] op_sel_hi:[1,0,1]
    v_pk_fma_f32 v[18:19], v[18:19], s[86:87], v[94:95] op_sel_hi:[1,0,1]
    v_pk_mul_f32 v[16:17], v[16:17], v[128:129]
    v_pk_mul_f32 v[18:19], v[18:19], v[130:131]
    s_waitcnt lgkmcnt(8)
    v_mfma_f32_16x16x32_bf16 v[100:103], v[72:75], v[44:47], v[100:103]
    v_exp_f32 v16, v16
    s_waitcnt vmcnt(8) lgkmcnt(0)
    s_barrier
    v_mfma_f32_16x16x32_bf16 v[104:107], v[72:75], v[48:51], v[104:107]
    ds_read_b64_tr_b16 v[88:89], v92 offset:26624
    ds_read_b64_tr_b16 v[90:91], v92 offset:27648
    v_exp_f32 v17, v17
    v_exp_f32 v18, v18
    v_exp_f32 v19, v19
    v_pk_add_f32 v[16:17], v[16:17], 1.0 op_sel_hi:[1,0]
    v_pk_add_f32 v[18:19], v[18:19], 1.0 op_sel_hi:[1,0]
    s_add_u32 m0, s28, 32768
    v_mfma_f32_16x16x32_bf16 v[108:111], v[72:75], v[52:55], v[108:111]
    ds_read_b64_tr_b16 v[72:73], v32 offset:26624
    ds_read_b64_tr_b16 v[74:75], v32 offset:27648
    buffer_load_dwordx4 v4, s[8:11], s64 offen offset:0 sc1 lds
    v_rcp_f32 v16, v16
    s_add_u32 m0, s28, 32768
    v_mfma_f32_16x16x32_bf16 v[124:127], v[76:79], v[52:55], v[124:127]
    buffer_load_dwordx4 v5, s[8:11], s64 offen offset:1024 sc1 lds
    v_rcp_f32 v17, v17
    v_rcp_f32 v18, v18
    v_rcp_f32 v19, v19
    v_pk_mul_f32 v[144:145], v[144:145], v[16:17]
    v_pk_mul_f32 v[146:147], v[146:147], v[18:19]
    v_cvt_pk_bf16_f32 v128, v144, v145
    v_cvt_pk_bf16_f32 v129, v146, v147
    v_pk_mul_f32 v[16:17], v[160:161], v[160:161]
    v_pk_mul_f32 v[18:19], v[162:163], v[162:163]
    v_pk_mul_f32 v[176:177], v[160:161], v[176:177]
    v_pk_mul_f32 v[178:179], v[162:163], v[178:179]
    v_pk_fma_f32 v[16:17], v[16:17], s[86:87], v[94:95] op_sel_hi:[1,0,1]
    v_pk_fma_f32 v[18:19], v[18:19], s[86:87], v[94:95] op_sel_hi:[1,0,1]
    v_pk_mul_f32 v[16:17], v[16:17], v[160:161]
    v_pk_mul_f32 v[18:19], v[18:19], v[162:163]
    s_add_u32 m0, s28, 32768
    v_mfma_f32_16x16x32_bf16 v[120:123], v[76:79], v[48:51], v[120:123]
    buffer_load_dwordx4 v4, s[8:11], s66 offen offset:2048 sc1 lds
    v_exp_f32 v16, v16
    s_add_u32 m0, s28, 32768
    v_mfma_f32_16x16x32_bf16 v[116:119], v[76:79], v[44:47], v[116:119]
    buffer_load_dwordx4 v5, s[8:11], s66 offen offset:3072 sc1 lds
    s_add_u32 s64, s64, 128
    s_bitset0_b32 s64, 11
    s_add_u32 s66, s64, 30720
    v_exp_f32 v17, v17
    v_exp_f32 v18, v18
    v_exp_f32 v19, v19
    v_pk_add_f32 v[16:17], v[16:17], 1.0 op_sel_hi:[1,0]
    v_pk_add_f32 v[18:19], v[18:19], 1.0 op_sel_hi:[1,0]
    v_mfma_f32_16x16x32_bf16 v[112:115], v[76:79], v[40:43], v[112:115]
    v_rcp_f32 v16, v16
    v_mfma_f32_16x16x32_bf16 v[96:99], v[80:83], v[56:59], v[96:99]
    ds_read_b128 v[40:43], v8 offset:0
    ds_read_b128 v[44:47], v8 offset:2048
    v_rcp_f32 v17, v17
    v_rcp_f32 v18, v18
    v_rcp_f32 v19, v19
    v_pk_mul_f32 v[176:177], v[176:177], v[16:17]
    v_pk_mul_f32 v[178:179], v[178:179], v[18:19]
    v_cvt_pk_bf16_f32 v130, v176, v177
    v_cvt_pk_bf16_f32 v131, v178, v179
    buffer_store_dwordx4 v[128:131], v2, s[20:23], s88 offen offset:0 sc1
    v_pk_mul_f32 v[16:17], v[192:193], v[192:193]
    v_pk_mul_f32 v[18:19], v[194:195], v[194:195]
    v_pk_mul_f32 v[208:209], v[192:193], v[208:209]
    v_pk_mul_f32 v[210:211], v[194:195], v[210:211]
    v_pk_fma_f32 v[16:17], v[16:17], s[86:87], v[94:95] op_sel_hi:[1,0,1]
    v_pk_fma_f32 v[18:19], v[18:19], s[86:87], v[94:95] op_sel_hi:[1,0,1]
    v_pk_mul_f32 v[16:17], v[16:17], v[192:193]
    v_pk_mul_f32 v[18:19], v[18:19], v[194:195]
    v_mfma_f32_16x16x32_bf16 v[100:103], v[80:83], v[60:63], v[100:103]
    ds_read_b128 v[48:51], v8 offset:4096
    ds_read_b128 v[52:55], v8 offset:6144
    v_exp_f32 v16, v16
    v_mfma_f32_16x16x32_bf16 v[104:107], v[80:83], v[64:67], v[104:107]
    v_exp_f32 v17, v17
    v_exp_f32 v18, v18
    v_exp_f32 v19, v19
    v_pk_add_f32 v[16:17], v[16:17], 1.0 op_sel_hi:[1,0]
    v_pk_add_f32 v[18:19], v[18:19], 1.0 op_sel_hi:[1,0]
    v_mfma_f32_16x16x32_bf16 v[108:111], v[80:83], v[68:71], v[108:111]
    v_rcp_f32 v16, v16
    v_mfma_f32_16x16x32_bf16 v[124:127], v[84:87], v[68:71], v[124:127]
    v_rcp_f32 v17, v17
    v_rcp_f32 v18, v18
    v_rcp_f32 v19, v19
    v_pk_mul_f32 v[208:209], v[208:209], v[16:17]
    v_pk_mul_f32 v[210:211], v[210:211], v[18:19]
    v_cvt_pk_bf16_f32 v192, v208, v209
    v_cvt_pk_bf16_f32 v193, v210, v211
    v_pk_mul_f32 v[16:17], v[224:225], v[224:225]
    v_pk_mul_f32 v[18:19], v[226:227], v[226:227]
    v_pk_mul_f32 v[240:241], v[224:225], v[240:241]
    v_pk_mul_f32 v[242:243], v[226:227], v[242:243]
    v_pk_fma_f32 v[16:17], v[16:17], s[86:87], v[94:95] op_sel_hi:[1,0,1]
    v_pk_fma_f32 v[18:19], v[18:19], s[86:87], v[94:95] op_sel_hi:[1,0,1]
    v_pk_mul_f32 v[16:17], v[16:17], v[224:225]
    v_pk_mul_f32 v[18:19], v[18:19], v[226:227]
    v_mfma_f32_16x16x32_bf16 v[120:123], v[84:87], v[64:67], v[120:123]
    v_exp_f32 v16, v16
    v_mfma_f32_16x16x32_bf16 v[116:119], v[84:87], v[60:63], v[116:119]
    v_exp_f32 v17, v17
    v_exp_f32 v18, v18
    v_exp_f32 v19, v19
    v_pk_add_f32 v[16:17], v[16:17], 1.0 op_sel_hi:[1,0]
    v_pk_add_f32 v[18:19], v[18:19], 1.0 op_sel_hi:[1,0]
    v_mfma_f32_16x16x32_bf16 v[112:115], v[84:87], v[56:59], v[112:115]
    v_rcp_f32 v16, v16
    s_waitcnt lgkmcnt(3)
    v_mfma_f32_16x16x32_bf16 v[96:99], v[88:91], v[40:43], v[96:99]
    ds_read_b128 v[56:59], v9 offset:0
    ds_read_b128 v[60:63], v9 offset:2048
    ds_read_b128 v[64:67], v9 offset:4096
    ds_read_b128 v[68:71], v9 offset:6144
    v_rcp_f32 v17, v17
    v_rcp_f32 v18, v18
    v_rcp_f32 v19, v19
    v_pk_mul_f32 v[240:241], v[240:241], v[16:17]
    v_pk_mul_f32 v[242:243], v[242:243], v[18:19]
    v_cvt_pk_bf16_f32 v194, v240, v241
    v_cvt_pk_bf16_f32 v195, v242, v243
    buffer_store_dwordx4 v[192:195], v2, s[20:23], s3 offen offset:0 sc1
    v_pk_mul_f32 v[16:17], v[132:133], v[132:133]
    v_pk_mul_f32 v[18:19], v[134:135], v[134:135]
    v_pk_mul_f32 v[148:149], v[132:133], v[148:149]
    v_pk_mul_f32 v[150:151], v[134:135], v[150:151]
    v_pk_fma_f32 v[16:17], v[16:17], s[86:87], v[94:95] op_sel_hi:[1,0,1]
    v_pk_fma_f32 v[18:19], v[18:19], s[86:87], v[94:95] op_sel_hi:[1,0,1]
    v_pk_mul_f32 v[16:17], v[16:17], v[132:133]
    v_pk_mul_f32 v[18:19], v[18:19], v[134:135]
    s_waitcnt lgkmcnt(6)
    v_mfma_f32_16x16x32_bf16 v[100:103], v[88:91], v[44:47], v[100:103]
    v_exp_f32 v16, v16
    s_waitcnt vmcnt(6) lgkmcnt(0)
    s_barrier
    s_add_u32 m0, s95, 0
    v_mfma_f32_16x16x32_bf16 v[104:107], v[88:91], v[48:51], v[104:107]
    ds_read_b64_tr_b16 v[76:77], v92 offset:51200
    ds_read_b64_tr_b16 v[78:79], v92 offset:52224
    buffer_load_dwordx4 v6, s[12:15], s74 offen  lds
    v_exp_f32 v17, v17
    v_exp_f32 v18, v18
    v_exp_f32 v19, v19
    v_pk_add_f32 v[16:17], v[16:17], 1.0 op_sel_hi:[1,0]
    v_pk_add_f32 v[18:19], v[18:19], 1.0 op_sel_hi:[1,0]
    s_add_u32 m0, s95, 0
    v_mfma_f32_16x16x32_bf16 v[108:111], v[88:91], v[52:55], v[108:111]
    ds_read_b64_tr_b16 v[80:81], v32 offset:51200
    ds_read_b64_tr_b16 v[82:83], v32 offset:52224
    buffer_load_dwordx4 v7, s[12:15], s74 offen offset:1024  lds
    s_add_u32 s74, s74, 0x20000
    v_rcp_f32 v16, v16
    v_mfma_f32_16x16x32_bf16 v[124:127], v[72:75], v[52:55], v[124:127]
    ds_read_b64_tr_b16 v[84:85], v92 offset:0
    ds_read_b64_tr_b16 v[86:87], v92 offset:1024
    v_rcp_f32 v17, v17
    v_rcp_f32 v18, v18
    v_rcp_f32 v19, v19
    v_pk_mul_f32 v[148:149], v[148:149], v[16:17]
    v_pk_mul_f32 v[150:151], v[150:151], v[18:19]
    v_cvt_pk_bf16_f32 v132, v148, v149
    v_cvt_pk_bf16_f32 v133, v150, v151
    v_pk_mul_f32 v[16:17], v[164:165], v[164:165]
    v_pk_mul_f32 v[18:19], v[166:167], v[166:167]
    v_pk_mul_f32 v[180:181], v[164:165], v[180:181]
    v_pk_mul_f32 v[182:183], v[166:167], v[182:183]
    v_pk_fma_f32 v[16:17], v[16:17], s[86:87], v[94:95] op_sel_hi:[1,0,1]
    v_pk_fma_f32 v[18:19], v[18:19], s[86:87], v[94:95] op_sel_hi:[1,0,1]
    v_pk_mul_f32 v[16:17], v[16:17], v[164:165]
    v_pk_mul_f32 v[18:19], v[18:19], v[166:167]
    v_mfma_f32_16x16x32_bf16 v[120:123], v[72:75], v[48:51], v[120:123]
    ds_read_b64_tr_b16 v[88:89], v32 offset:0
    ds_read_b64_tr_b16 v[90:91], v32 offset:1024
    v_exp_f32 v16, v16
    v_mfma_f32_16x16x32_bf16 v[116:119], v[72:75], v[44:47], v[116:119]
    v_exp_f32 v17, v17
    v_exp_f32 v18, v18
    v_exp_f32 v19, v19
    v_pk_add_f32 v[16:17], v[16:17], 1.0 op_sel_hi:[1,0]
    v_pk_add_f32 v[18:19], v[18:19], 1.0 op_sel_hi:[1,0]
    v_mfma_f32_16x16x32_bf16 v[112:115], v[72:75], v[40:43], v[112:115]
    ds_read_b64_tr_b16 v[72:73], v92 offset:6144
    ds_read_b64_tr_b16 v[74:75], v92 offset:7168
    v_add_u32 v8, 32768, v8
    v_add_u32 v9, 32768, v9
    v_rcp_f32 v16, v16
    s_add_u32 m0, s95, 16384
    s_waitcnt lgkmcnt(8)
    v_mfma_f32_16x16x32_bf16 v[96:99], v[76:79], v[56:59], v[96:99]
    ds_read_b128 v[40:43], v8 offset:32768
    ds_read_b128 v[44:47], v8 offset:34816
    buffer_load_dwordx4 v6, s[12:15], s74 offen  lds
    v_rcp_f32 v17, v17
    v_rcp_f32 v18, v18
    v_rcp_f32 v19, v19
    v_pk_mul_f32 v[180:181], v[180:181], v[16:17]
    v_pk_mul_f32 v[182:183], v[182:183], v[18:19]
    v_cvt_pk_bf16_f32 v134, v180, v181
    v_cvt_pk_bf16_f32 v135, v182, v183
    buffer_store_dwordx4 v[132:135], v2, s[20:23], s88 offen offset:1024 sc1
    v_pk_mul_f32 v[16:17], v[196:197], v[196:197]
    v_pk_mul_f32 v[18:19], v[198:199], v[198:199]
    v_pk_mul_f32 v[212:213], v[196:197], v[212:213]
    v_pk_mul_f32 v[214:215], v[198:199], v[214:215]
    v_pk_fma_f32 v[16:17], v[16:17], s[86:87], v[94:95] op_sel_hi:[1,0,1]
    v_pk_fma_f32 v[18:19], v[18:19], s[86:87], v[94:95] op_sel_hi:[1,0,1]
    v_pk_mul_f32 v[16:17], v[16:17], v[196:197]
    v_pk_mul_f32 v[18:19], v[18:19], v[198:199]
    s_add_u32 m0, s95, 16384
    v_mfma_f32_16x16x32_bf16 v[100:103], v[76:79], v[60:63], v[100:103]
    ds_read_b128 v[48:51], v8 offset:36864
    ds_read_b128 v[52:55], v8 offset:38912
    buffer_load_dwordx4 v7, s[12:15], s74 offen offset:1024  lds
    s_add_u32 s74, s74, 0x20000
    v_exp_f32 v16, v16
    v_mfma_f32_16x16x32_bf16 v[104:107], v[76:79], v[64:67], v[104:107]
    v_exp_f32 v17, v17
    v_exp_f32 v18, v18
    v_exp_f32 v19, v19
    v_pk_add_f32 v[16:17], v[16:17], 1.0 op_sel_hi:[1,0]
    v_pk_add_f32 v[18:19], v[18:19], 1.0 op_sel_hi:[1,0]
    v_mfma_f32_16x16x32_bf16 v[108:111], v[76:79], v[68:71], v[108:111]
    ds_read_b64_tr_b16 v[76:77], v32 offset:6144
    ds_read_b64_tr_b16 v[78:79], v32 offset:7168
    v_rcp_f32 v16, v16
    s_waitcnt lgkmcnt(12)
    v_mfma_f32_16x16x32_bf16 v[124:127], v[80:83], v[68:71], v[124:127]
    v_rcp_f32 v17, v17
    v_rcp_f32 v18, v18
    v_rcp_f32 v19, v19
    v_pk_mul_f32 v[212:213], v[212:213], v[16:17]
    v_pk_mul_f32 v[214:215], v[214:215], v[18:19]
    v_cvt_pk_bf16_f32 v196, v212, v213
    v_cvt_pk_bf16_f32 v197, v214, v215
    v_pk_mul_f32 v[16:17], v[228:229], v[228:229]
    v_pk_mul_f32 v[18:19], v[230:231], v[230:231]
    v_pk_mul_f32 v[244:245], v[228:229], v[244:245]
    v_pk_mul_f32 v[246:247], v[230:231], v[246:247]
    v_pk_fma_f32 v[16:17], v[16:17], s[86:87], v[94:95] op_sel_hi:[1,0,1]
    v_pk_fma_f32 v[18:19], v[18:19], s[86:87], v[94:95] op_sel_hi:[1,0,1]
    v_pk_mul_f32 v[16:17], v[16:17], v[228:229]
    v_pk_mul_f32 v[18:19], v[18:19], v[230:231]
    v_mfma_f32_16x16x32_bf16 v[120:123], v[80:83], v[64:67], v[120:123]
    v_exp_f32 v16, v16
    v_mfma_f32_16x16x32_bf16 v[116:119], v[80:83], v[60:63], v[116:119]
    v_exp_f32 v17, v17
    v_exp_f32 v18, v18
    v_exp_f32 v19, v19
    v_pk_add_f32 v[16:17], v[16:17], 1.0 op_sel_hi:[1,0]
    v_pk_add_f32 v[18:19], v[18:19], 1.0 op_sel_hi:[1,0]
    v_mfma_f32_16x16x32_bf16 v[112:115], v[80:83], v[56:59], v[112:115]
    ds_read_b64_tr_b16 v[80:81], v92 offset:12288
    ds_read_b64_tr_b16 v[82:83], v92 offset:13312
    v_rcp_f32 v16, v16
    s_waitcnt lgkmcnt(7)
    v_mfma_f32_16x16x32_bf16 v[96:99], v[84:87], v[40:43], v[96:99]
    ds_read_b128 v[56:59], v9 offset:32768
    ds_read_b128 v[60:63], v9 offset:34816
    ds_read_b128 v[64:67], v9 offset:36864
    ds_read_b128 v[68:71], v9 offset:38912
    v_rcp_f32 v17, v17
    v_rcp_f32 v18, v18
    v_rcp_f32 v19, v19
    v_pk_mul_f32 v[244:245], v[244:245], v[16:17]
    v_pk_mul_f32 v[246:247], v[246:247], v[18:19]
    v_cvt_pk_bf16_f32 v198, v244, v245
    v_cvt_pk_bf16_f32 v199, v246, v247
    buffer_store_dwordx4 v[196:199], v2, s[20:23], s3 offen offset:1024 sc1
    v_pk_mul_f32 v[16:17], v[136:137], v[136:137]
    v_pk_mul_f32 v[18:19], v[138:139], v[138:139]
    v_pk_mul_f32 v[152:153], v[136:137], v[152:153]
    v_pk_mul_f32 v[154:155], v[138:139], v[154:155]
    v_pk_fma_f32 v[16:17], v[16:17], s[86:87], v[94:95] op_sel_hi:[1,0,1]
    v_pk_fma_f32 v[18:19], v[18:19], s[86:87], v[94:95] op_sel_hi:[1,0,1]
    v_pk_mul_f32 v[16:17], v[16:17], v[136:137]
    v_pk_mul_f32 v[18:19], v[18:19], v[138:139]
    s_waitcnt lgkmcnt(10)
    v_mfma_f32_16x16x32_bf16 v[100:103], v[84:87], v[44:47], v[100:103]
    v_exp_f32 v16, v16
    s_waitcnt vmcnt(8) lgkmcnt(0)
    s_barrier
    v_mfma_f32_16x16x32_bf16 v[104:107], v[84:87], v[48:51], v[104:107]
    v_exp_f32 v17, v17
    v_exp_f32 v18, v18
    v_exp_f32 v19, v19
    v_pk_add_f32 v[16:17], v[16:17], 1.0 op_sel_hi:[1,0]
    v_pk_add_f32 v[18:19], v[18:19], 1.0 op_sel_hi:[1,0]
    v_mfma_f32_16x16x32_bf16 v[108:111], v[84:87], v[52:55], v[108:111]
    ds_read_b64_tr_b16 v[84:85], v32 offset:12288
    ds_read_b64_tr_b16 v[86:87], v32 offset:13312
    v_rcp_f32 v16, v16
    v_mfma_f32_16x16x32_bf16 v[124:127], v[88:91], v[52:55], v[124:127]
    v_rcp_f32 v17, v17
    v_rcp_f32 v18, v18
    v_rcp_f32 v19, v19
    v_pk_mul_f32 v[152:153], v[152:153], v[16:17]
    v_pk_mul_f32 v[154:155], v[154:155], v[18:19]
    v_cvt_pk_bf16_f32 v136, v152, v153
    v_cvt_pk_bf16_f32 v137, v154, v155
    v_pk_mul_f32 v[16:17], v[168:169], v[168:169]
    v_pk_mul_f32 v[18:19], v[170:171], v[170:171]
    v_pk_mul_f32 v[184:185], v[168:169], v[184:185]
    v_pk_mul_f32 v[186:187], v[170:171], v[186:187]
    v_pk_fma_f32 v[16:17], v[16:17], s[86:87], v[94:95] op_sel_hi:[1,0,1]
    v_pk_fma_f32 v[18:19], v[18:19], s[86:87], v[94:95] op_sel_hi:[1,0,1]
    v_pk_mul_f32 v[16:17], v[16:17], v[168:169]
    v_pk_mul_f32 v[18:19], v[18:19], v[170:171]
    v_mfma_f32_16x16x32_bf16 v[120:123], v[88:91], v[48:51], v[120:123]
    v_exp_f32 v16, v16
    v_mfma_f32_16x16x32_bf16 v[116:119], v[88:91], v[44:47], v[116:119]
    v_exp_f32 v17, v17
    v_exp_f32 v18, v18
    v_exp_f32 v19, v19
    v_pk_add_f32 v[16:17], v[16:17], 1.0 op_sel_hi:[1,0]
    v_pk_add_f32 v[18:19], v[18:19], 1.0 op_sel_hi:[1,0]
    v_mfma_f32_16x16x32_bf16 v[112:115], v[88:91], v[40:43], v[112:115]
    ds_read_b64_tr_b16 v[88:89], v92 offset:18432
    ds_read_b64_tr_b16 v[90:91], v92 offset:19456
    v_rcp_f32 v16, v16
    v_mfma_f32_16x16x32_bf16 v[96:99], v[72:75], v[56:59], v[96:99]
    ds_read_b128 v[40:43], v8 offset:0
    ds_read_b128 v[44:47], v8 offset:2048
    v_rcp_f32 v17, v17
    v_rcp_f32 v18, v18
    v_rcp_f32 v19, v19
    v_pk_mul_f32 v[184:185], v[184:185], v[16:17]
    v_pk_mul_f32 v[186:187], v[186:187], v[18:19]
    v_cvt_pk_bf16_f32 v138, v184, v185
    v_cvt_pk_bf16_f32 v139, v186, v187
    buffer_store_dwordx4 v[136:139], v2, s[20:23], s88 offen offset:2048 sc1
    v_pk_mul_f32 v[16:17], v[200:201], v[200:201]
    v_pk_mul_f32 v[18:19], v[202:203], v[202:203]
    v_pk_mul_f32 v[216:217], v[200:201], v[216:217]
    v_pk_mul_f32 v[218:219], v[202:203], v[218:219]
    v_pk_fma_f32 v[16:17], v[16:17], s[86:87], v[94:95] op_sel_hi:[1,0,1]
    v_pk_fma_f32 v[18:19], v[18:19], s[86:87], v[94:95] op_sel_hi:[1,0,1]
    v_pk_mul_f32 v[16:17], v[16:17], v[200:201]
    v_pk_mul_f32 v[18:19], v[18:19], v[202:203]
    v_mfma_f32_16x16x32_bf16 v[100:103], v[72:75], v[60:63], v[100:103]
    ds_read_b128 v[48:51], v8 offset:4096
    ds_read_b128 v[52:55], v8 offset:6144
    v_exp_f32 v16, v16
    v_mfma_f32_16x16x32_bf16 v[104:107], v[72:75], v[64:67], v[104:107]
    v_exp_f32 v17, v17
    v_exp_f32 v18, v18
    v_exp_f32 v19, v19
    v_pk_add_f32 v[16:17], v[16:17], 1.0 op_sel_hi:[1,0]
    v_pk_add_f32 v[18:19], v[18:19], 1.0 op_sel_hi:[1,0]
    v_mfma_f32_16x16x32_bf16 v[108:111], v[72:75], v[68:71], v[108:111]
    ds_read_b64_tr_b16 v[72:73], v32 offset:18432
    ds_read_b64_tr_b16 v[74:75], v32 offset:19456
    v_rcp_f32 v16, v16
    v_mfma_f32_16x16x32_bf16 v[124:127], v[76:79], v[68:71], v[124:127]
    v_rcp_f32 v17, v17
    v_rcp_f32 v18, v18
    v_rcp_f32 v19, v19
    v_pk_mul_f32 v[216:217], v[216:217], v[16:17]
    v_pk_mul_f32 v[218:219], v[218:219], v[18:19]
    v_cvt_pk_bf16_f32 v200, v216, v217
    v_cvt_pk_bf16_f32 v201, v218, v219
    v_pk_mul_f32 v[16:17], v[232:233], v[232:233]
    v_pk_mul_f32 v[18:19], v[234:235], v[234:235]
    v_pk_mul_f32 v[248:249], v[232:233], v[248:249]
    v_pk_mul_f32 v[250:251], v[234:235], v[250:251]
    v_pk_fma_f32 v[16:17], v[16:17], s[86:87], v[94:95] op_sel_hi:[1,0,1]
    v_pk_fma_f32 v[18:19], v[18:19], s[86:87], v[94:95] op_sel_hi:[1,0,1]
    v_pk_mul_f32 v[16:17], v[16:17], v[232:233]
    v_pk_mul_f32 v[18:19], v[18:19], v[234:235]
    v_mfma_f32_16x16x32_bf16 v[120:123], v[76:79], v[64:67], v[120:123]
    v_exp_f32 v16, v16
    v_mfma_f32_16x16x32_bf16 v[116:119], v[76:79], v[60:63], v[116:119]
    v_exp_f32 v17, v17
    v_exp_f32 v18, v18
    v_exp_f32 v19, v19
    v_pk_add_f32 v[16:17], v[16:17], 1.0 op_sel_hi:[1,0]
    v_pk_add_f32 v[18:19], v[18:19], 1.0 op_sel_hi:[1,0]
    v_mfma_f32_16x16x32_bf16 v[112:115], v[76:79], v[56:59], v[112:115]
    v_rcp_f32 v16, v16
    s_waitcnt lgkmcnt(5)
    v_mfma_f32_16x16x32_bf16 v[96:99], v[80:83], v[40:43], v[96:99]
    ds_read_b128 v[56:59], v9 offset:0
    ds_read_b128 v[60:63], v9 offset:2048
    ds_read_b128 v[64:67], v9 offset:4096
    ds_read_b128 v[68:71], v9 offset:6144
    v_rcp_f32 v17, v17
    v_rcp_f32 v18, v18
    v_rcp_f32 v19, v19
    v_pk_mul_f32 v[248:249], v[248:249], v[16:17]
    v_pk_mul_f32 v[250:251], v[250:251], v[18:19]
    v_cvt_pk_bf16_f32 v202, v248, v249
    v_cvt_pk_bf16_f32 v203, v250, v251
    buffer_store_dwordx4 v[200:203], v2, s[20:23], s3 offen offset:2048 sc1
    v_pk_mul_f32 v[16:17], v[140:141], v[140:141]
    v_pk_mul_f32 v[18:19], v[142:143], v[142:143]
    v_pk_mul_f32 v[156:157], v[140:141], v[156:157]
    v_pk_mul_f32 v[158:159], v[142:143], v[158:159]
    v_pk_fma_f32 v[16:17], v[16:17], s[86:87], v[94:95] op_sel_hi:[1,0,1]
    v_pk_fma_f32 v[18:19], v[18:19], s[86:87], v[94:95] op_sel_hi:[1,0,1]
    v_pk_mul_f32 v[16:17], v[16:17], v[140:141]
    v_pk_mul_f32 v[18:19], v[18:19], v[142:143]
    s_waitcnt lgkmcnt(8)
    v_mfma_f32_16x16x32_bf16 v[100:103], v[80:83], v[44:47], v[100:103]
    v_exp_f32 v16, v16
    s_waitcnt lgkmcnt(7)
    v_mfma_f32_16x16x32_bf16 v[104:107], v[80:83], v[48:51], v[104:107]
    v_exp_f32 v17, v17
    v_exp_f32 v18, v18
    v_exp_f32 v19, v19
    v_pk_add_f32 v[16:17], v[16:17], 1.0 op_sel_hi:[1,0]
    v_pk_add_f32 v[18:19], v[18:19], 1.0 op_sel_hi:[1,0]
    s_waitcnt lgkmcnt(6)
    v_mfma_f32_16x16x32_bf16 v[108:111], v[80:83], v[52:55], v[108:111]
    v_rcp_f32 v16, v16
    v_mfma_f32_16x16x32_bf16 v[124:127], v[84:87], v[52:55], v[124:127]
    v_rcp_f32 v17, v17
    v_rcp_f32 v18, v18
    v_rcp_f32 v19, v19
    v_pk_mul_f32 v[156:157], v[156:157], v[16:17]
    v_pk_mul_f32 v[158:159], v[158:159], v[18:19]
    v_cvt_pk_bf16_f32 v140, v156, v157
    v_cvt_pk_bf16_f32 v141, v158, v159
    v_pk_mul_f32 v[16:17], v[172:173], v[172:173]
    v_pk_mul_f32 v[18:19], v[174:175], v[174:175]
    v_pk_mul_f32 v[188:189], v[172:173], v[188:189]
    v_pk_mul_f32 v[190:191], v[174:175], v[190:191]
    v_pk_fma_f32 v[16:17], v[16:17], s[86:87], v[94:95] op_sel_hi:[1,0,1]
    v_pk_fma_f32 v[18:19], v[18:19], s[86:87], v[94:95] op_sel_hi:[1,0,1]
    v_pk_mul_f32 v[16:17], v[16:17], v[172:173]
    v_pk_mul_f32 v[18:19], v[18:19], v[174:175]
    v_mfma_f32_16x16x32_bf16 v[120:123], v[84:87], v[48:51], v[120:123]
    v_exp_f32 v16, v16
    v_mfma_f32_16x16x32_bf16 v[116:119], v[84:87], v[44:47], v[116:119]
    v_exp_f32 v17, v17
    v_exp_f32 v18, v18
    v_exp_f32 v19, v19
    v_pk_add_f32 v[16:17], v[16:17], 1.0 op_sel_hi:[1,0]
    v_pk_add_f32 v[18:19], v[18:19], 1.0 op_sel_hi:[1,0]
    v_mfma_f32_16x16x32_bf16 v[112:115], v[84:87], v[40:43], v[112:115]
    v_rcp_f32 v16, v16
    s_waitcnt lgkmcnt(3)
    v_mfma_f32_16x16x32_bf16 v[96:99], v[88:91], v[56:59], v[96:99]
    v_rcp_f32 v17, v17
    v_rcp_f32 v18, v18
    v_rcp_f32 v19, v19
    v_pk_mul_f32 v[188:189], v[188:189], v[16:17]
    v_pk_mul_f32 v[190:191], v[190:191], v[18:19]
    v_cvt_pk_bf16_f32 v142, v188, v189
    v_cvt_pk_bf16_f32 v143, v190, v191
    buffer_store_dwordx4 v[140:143], v2, s[20:23], s88 offen offset:3072 sc1
    v_pk_mul_f32 v[16:17], v[204:205], v[204:205]
    v_pk_mul_f32 v[18:19], v[206:207], v[206:207]
    v_pk_mul_f32 v[220:221], v[204:205], v[220:221]
    v_pk_mul_f32 v[222:223], v[206:207], v[222:223]
    v_pk_fma_f32 v[16:17], v[16:17], s[86:87], v[94:95] op_sel_hi:[1,0,1]
    v_pk_fma_f32 v[18:19], v[18:19], s[86:87], v[94:95] op_sel_hi:[1,0,1]
    v_pk_mul_f32 v[16:17], v[16:17], v[204:205]
    v_pk_mul_f32 v[18:19], v[18:19], v[206:207]
    s_waitcnt lgkmcnt(2)
    v_mfma_f32_16x16x32_bf16 v[100:103], v[88:91], v[60:63], v[100:103]
    v_exp_f32 v16, v16
    s_waitcnt lgkmcnt(1)
    v_mfma_f32_16x16x32_bf16 v[104:107], v[88:91], v[64:67], v[104:107]
    v_exp_f32 v17, v17
    v_exp_f32 v18, v18
    v_exp_f32 v19, v19
    v_pk_add_f32 v[16:17], v[16:17], 1.0 op_sel_hi:[1,0]
    v_pk_add_f32 v[18:19], v[18:19], 1.0 op_sel_hi:[1,0]
    s_waitcnt lgkmcnt(0)
    v_mfma_f32_16x16x32_bf16 v[108:111], v[88:91], v[68:71], v[108:111]
    v_rcp_f32 v16, v16
    v_mfma_f32_16x16x32_bf16 v[124:127], v[72:75], v[68:71], v[124:127]
    v_rcp_f32 v17, v17
    v_rcp_f32 v18, v18
    v_rcp_f32 v19, v19
    v_pk_mul_f32 v[220:221], v[220:221], v[16:17]
    v_pk_mul_f32 v[222:223], v[222:223], v[18:19]
    v_cvt_pk_bf16_f32 v204, v220, v221
    v_cvt_pk_bf16_f32 v205, v222, v223
    v_pk_mul_f32 v[16:17], v[236:237], v[236:237]
    v_pk_mul_f32 v[18:19], v[238:239], v[238:239]
    v_pk_mul_f32 v[252:253], v[236:237], v[252:253]
    v_pk_mul_f32 v[254:255], v[238:239], v[254:255]
    v_pk_fma_f32 v[16:17], v[16:17], s[86:87], v[94:95] op_sel_hi:[1,0,1]
    v_pk_fma_f32 v[18:19], v[18:19], s[86:87], v[94:95] op_sel_hi:[1,0,1]
    v_pk_mul_f32 v[16:17], v[16:17], v[236:237]
    v_pk_mul_f32 v[18:19], v[18:19], v[238:239]
    v_mfma_f32_16x16x32_bf16 v[120:123], v[72:75], v[64:67], v[120:123]
    v_exp_f32 v16, v16
    v_mfma_f32_16x16x32_bf16 v[116:119], v[72:75], v[60:63], v[116:119]
    v_exp_f32 v17, v17
    v_exp_f32 v18, v18
    v_exp_f32 v19, v19
    v_pk_add_f32 v[16:17], v[16:17], 1.0 op_sel_hi:[1,0]
    v_pk_add_f32 v[18:19], v[18:19], 1.0 op_sel_hi:[1,0]
    v_mfma_f32_16x16x32_bf16 v[112:115], v[72:75], v[56:59], v[112:115]
    v_rcp_f32 v16, v16
    v_rcp_f32 v17, v17
    v_rcp_f32 v18, v18
    v_rcp_f32 v19, v19
    v_pk_mul_f32 v[252:253], v[252:253], v[16:17]
    v_pk_mul_f32 v[254:255], v[254:255], v[18:19]
    v_cvt_pk_bf16_f32 v206, v252, v253
    v_cvt_pk_bf16_f32 v207, v254, v255
    buffer_store_dwordx4 v[204:207], v2, s[20:23], s3 offen offset:3072 sc1
    v_cvt_pk_bf16_f32 v40, v104, v105
    v_cvt_pk_bf16_f32 v41, v106, v107
    v_cvt_pk_bf16_f32 v42, v120, v121
    v_cvt_pk_bf16_f32 v43, v122, v123
    ds_write_b128 v13, v[40:43] offset:8192
    v_cvt_pk_bf16_f32 v44, v108, v109
    v_cvt_pk_bf16_f32 v45, v110, v111
    v_cvt_pk_bf16_f32 v46, v124, v125
    v_cvt_pk_bf16_f32 v47, v126, v127
    ds_write_b128 v13, v[44:47] offset:9216
    v_cvt_pk_bf16_f32 v80, v96, v97
    v_cvt_pk_bf16_f32 v81, v98, v99
    v_cvt_pk_bf16_f32 v82, v112, v113
    v_cvt_pk_bf16_f32 v83, v114, v115
    v_cvt_pk_bf16_f32 v84, v100, v101
    v_cvt_pk_bf16_f32 v85, v102, v103
    v_cvt_pk_bf16_f32 v86, v116, v117
    v_cvt_pk_bf16_f32 v87, v118, v119
    ds_read_b64_tr_b16 v[88:89], v38 offset:0
    ds_read_b64_tr_b16 v[90:91], v38 offset:1024
    ds_read_b64_tr_b16 v[92:93], v38 offset:32
    ds_read_b64_tr_b16 v[94:95], v38 offset:1056
    s_waitcnt lgkmcnt(4)
    s_barrier
    ds_read_b128 v[72:75], v13 offset:0
    ds_read_b128 v[76:79], v13 offset:1024
    s_waitcnt lgkmcnt(0)
    s_branch L_k3
L_w5:
    s_barrier
    s_add_u32 m0, s28, 0
    s_nop 0
    buffer_load_dwordx4 v4, s[8:11], s64 offen offset:0 sc1 lds
    buffer_load_dwordx4 v5, s[8:11], s64 offen offset:1024 sc1 lds
    buffer_load_dwordx4 v4, s[8:11], s66 offen offset:2048 sc1 lds
    buffer_load_dwordx4 v5, s[8:11], s66 offen offset:3072 sc1 lds
    s_add_u32 s64, s64, 128
    s_bitset0_b32 s64, 11
    s_add_u32 s66, s64, 30720
    s_add_u32 m0, s29, 0
    s_nop 0
    buffer_load_dwordx4 v6, s[12:15], s65 offen lds
    s_add_u32 s65, s65, 229376
    s_add_u32 m0, s29, 7296
    s_nop 0
    buffer_load_dwordx4 v6, s[12:15], s65 offen lds
    s_sub_u32 s65, s65, 229376
    s_add_u32 m0, s29, 14592
    s_nop 0
    buffer_load_dwordx4 v6, s[16:19], s65 offen lds
    s_add_u32 s65, s65, 229376
    s_add_u32 m0, s29, 21888
    s_nop 0
    buffer_load_dwordx4 v6, s[16:19], s65 offen lds
    s_add_u32 s65, s65, 229376
    s_waitcnt vmcnt(9)
    v_lshlrev_b32 v112, 16, v104
    v_and_b32 v113, 0xffff0000, v104
    v_lshlrev_b32 v114, 16, v105
    v_and_b32 v115, 0xffff0000, v105
    v_lshlrev_b32 v116, 16, v106
    v_and_b32 v117, 0xffff0000, v106
    v_lshlrev_b32 v118, 16, v107
    v_and_b32 v119, 0xffff0000, v107
    v_lshlrev_b32 v120, 16, v108
    v_and_b32 v121, 0xffff0000, v108
    v_lshlrev_b32 v122, 16, v109
    v_and_b32 v123, 0xffff0000, v109
    v_lshlrev_b32 v124, 16, v110
    v_and_b32 v125, 0xffff0000, v110
    v_lshlrev_b32 v126, 16, v111
    v_and_b32 v127, 0xffff0000, v111
    v_add_f32 v36, v112, v116
    v_add_f32 v37, v113, v117
    v_add_f32 v38, v114, v118
    v_add_f32 v39, v115, v119
    v_add_f32 v36, v36, v120
    v_add_f32 v37, v37, v121
    v_add_f32 v38, v38, v122
    v_add_f32 v39, v39, v123
    v_add_f32 v36, v36, v124
    v_add_f32 v37, v37, v125
    v_add_f32 v38, v38, v126
    v_add_f32 v39, v39, v127
    v_add_f32 v36, v36, v37
    v_add_f32 v38, v38, v39
    v_add_f32 v34, v36, v38
    s_nop 1
    v_add_f32_dpp v34, v34, v34 row_ror:8 row_mask:0xf bank_mask:0xf
    s_nop 1
    v_add_f32_dpp v34, v34, v34 row_ror:4 row_mask:0xf bank_mask:0xf
    s_nop 1
    v_add_f32_dpp v34, v34, v34 row_ror:2 row_mask:0xf bank_mask:0xf
    s_nop 1
    v_add_f32_dpp v34, v34, v34 row_ror:1 row_mask:0xf bank_mask:0xf
    v_mov_b32 v36, v34
    s_nop 1
    v_permlane16_swap_b32 v34, v36
    v_add_f32 v34, v34, v36
    v_mov_b32 v36, v34
    s_nop 1
    v_permlane32_swap_b32 v34, v36
    v_add_f32 v34, v34, v36
    v_mul_f32 v34, 0x3a800000, v34
    v_cvt_pk_bf16_f32 v14, v34, v34
    v_and_b32 v14, 0xffff0000, v14
    v_sub_f32 v112, v112, v14
    v_sub_f32 v113, v113, v14
    v_sub_f32 v114, v114, v14
    v_sub_f32 v115, v115, v14
    v_sub_f32 v116, v116, v14
    v_sub_f32 v117, v117, v14
    v_sub_f32 v118, v118, v14
    v_sub_f32 v119, v119, v14
    v_sub_f32 v120, v120, v14
    v_sub_f32 v121, v121, v14
    v_sub_f32 v122, v122, v14
    v_sub_f32 v123, v123, v14
    v_sub_f32 v124, v124, v14
    v_sub_f32 v125, v125, v14
    v_sub_f32 v126, v126, v14
    v_sub_f32 v127, v127, v14
    v_mul_f32 v36, v112, v112
    v_mul_f32 v37, v113, v113
    v_mul_f32 v38, v114, v114
    v_mul_f32 v39, v115, v115
    v_fmac_f32 v36, v116, v116
    v_fmac_f32 v37, v117, v117
    v_fmac_f32 v38, v118, v118
    v_fmac_f32 v39, v119, v119
    v_fmac_f32 v36, v120, v120
    v_fmac_f32 v37, v121, v121
    v_fmac_f32 v38, v122, v122
    v_fmac_f32 v39, v123, v123
    v_fmac_f32 v36, v124, v124
    v_fmac_f32 v37, v125, v125
    v_fmac_f32 v38, v126, v126
    v_fmac_f32 v39, v127, v127
    v_add_f32 v36, v36, v37
    v_add_f32 v38, v38, v39
    v_sub_f32 v34, v34, v14
    v_add_f32 v12, v36, v38
    s_nop 1
    v_add_f32_dpp v12, v12, v12 row_ror:8 row_mask:0xf bank_mask:0xf
    v_cvt_pk_bf16_f32 v104, v112, v113
    s_nop 0
    v_add_f32_dpp v12, v12, v12 row_ror:4 row_mask:0xf bank_mask:0xf
    v_cvt_pk_bf16_f32 v105, v114, v115
    s_nop 0
    v_add_f32_dpp v12, v12, v12 row_ror:2 row_mask:0xf bank_mask:0xf
    v_cvt_pk_bf16_f32 v106, v116, v117
    s_nop 0
    v_add_f32_dpp v12, v12, v12 row_ror:1 row_mask:0xf bank_mask:0xf
    v_cvt_pk_bf16_f32 v107, v118, v119
    v_mov_b32 v36, v12
    v_cvt_pk_bf16_f32 v108, v120, v121
    s_nop 0
    v_permlane16_swap_b32 v12, v36
    v_cvt_pk_bf16_f32 v109, v122, v123
    v_add_f32 v12, v12, v36
    v_cvt_pk_bf16_f32 v110, v124, v125
    v_mov_b32 v36, v12
    v_cvt_pk_bf16_f32 v111, v126, v127
    s_nop 0
    v_permlane32_swap_b32 v12, v36
    v_lshlrev_b32 v112, 16, v104
    v_add_f32 v12, v12, v36
    v_and_b32 v113, 0xffff0000, v104
    v_mul_f32 v12, 0x3a800000, v12
    v_lshlrev_b32 v114, 16, v105
    v_fma_f32 v12, -v34, v34, v12
    v_and_b32 v115, 0xffff0000, v105
    v_max_f32 v12, 0, v12
    v_lshlrev_b32 v116, 16, v106
    v_cvt_pk_bf16_f32 v12, v12, v12
    v_and_b32 v117, 0xffff0000, v106
    v_and_b32 v12, 0xffff0000, v12
    v_lshlrev_b32 v118, 16, v107
    v_add_f32 v12, 0x3727c5ac, v12
    v_and_b32 v119, 0xffff0000, v107
    v_cvt_pk_bf16_f32 v12, v12, v12
    v_lshlrev_b32 v120, 16, v108
    v_and_b32 v12, 0xffff0000, v12
    v_and_b32 v121, 0xffff0000, v108
    v_sqrt_f32 v15, v12
    v_lshlrev_b32 v122, 16, v109
    v_cvt_pk_bf16_f32 v15, v15, v15
    v_and_b32 v123, 0xffff0000, v109
    v_and_b32 v15, 0xffff0000, v15
    v_lshlrev_b32 v124, 16, v110
    v_rcp_f32 v12, v15
    v_and_b32 v125, 0xffff0000, v110
    v_sub_f32 v14, 0, v14
    v_lshlrev_b32 v126, 16, v111
    v_and_b32 v127, 0xffff0000, v111
    v_mul_f32 v112, v112, v12
    v_mul_f32 v113, v113, v12
    v_mul_f32 v114, v114, v12
    v_mul_f32 v115, v115, v12
    v_mul_f32 v116, v116, v12
    v_mul_f32 v117, v117, v12
    v_mul_f32 v118, v118, v12
    v_mul_f32 v119, v119, v12
    v_mul_f32 v120, v120, v12
    v_mul_f32 v121, v121, v12
    v_mul_f32 v122, v122, v12
    v_mul_f32 v123, v123, v12
    v_mul_f32 v124, v124, v12
    v_mul_f32 v125, v125, v12
    v_mul_f32 v126, v126, v12
    v_mul_f32 v127, v127, v12
    v_cvt_pk_bf16_f32 v104, v112, v113
    v_cvt_pk_bf16_f32 v105, v114, v115
    v_cvt_pk_bf16_f32 v106, v116, v117
    v_cvt_pk_bf16_f32 v107, v118, v119
    v_cvt_pk_bf16_f32 v108, v120, v121
    v_cvt_pk_bf16_f32 v109, v122, v123
    v_cvt_pk_bf16_f32 v110, v124, v125
    v_cvt_pk_bf16_f32 v111, v126, v127
    buffer_store_dwordx4 v[104:107], v2, s[20:23], s3 offen offset:0 sc1
    buffer_store_dwordx4 v[108:111], v2, s[20:23], s3 offen offset:1024 sc1
    v_lshrrev_b32 v14, 16, v14
    v_or_b32 v14, v14, v15
    s_waitcnt vmcnt(10)
    s_mov_b32 s5, 0x9E3779B1
    v_mul_lo_u32 v33, v33, s5
    v_add_u32 v33, 0x7F4A7C15, v33
    s_nop 0
    v_readfirstlane_b32 s58, v33
    v_mov_b32 v15, v33
    s_waitcnt vmcnt(4)
    s_barrier
    ds_read_b128 v[40:43], v8 offset:0
    ds_read_b64_tr_b16 v[88:89], v10 offset:128
    ds_read_b64_tr_b16 v[90:91], v10 offset:3712
    ds_read_b128 v[56:59], v9 offset:0
    ds_read_b64_tr_b16 v[72:73], v10 offset:7424
    ds_read_b64_tr_b16 v[74:75], v10 offset:11008
    ds_read_b128 v[60:63], v9 offset:2048
    ds_read_b128 v[44:47], v8 offset:2048
    ds_read_b128 v[48:51], v8 offset:4096
    ds_read_b128 v[64:67], v9 offset:4096
    ds_read_b128 v[68:71], v9 offset:6144
    ds_read_b128 v[52:55], v8 offset:6144
    ds_read_b64_tr_b16 v[76:77], v10 offset:160
    ds_read_b64_tr_b16 v[78:79], v10 offset:3744
    ds_read_b64_tr_b16 v[80:81], v10 offset:7456
    ds_read_b64_tr_b16 v[82:83], v10 offset:11040
    s_mov_b32 s37, 1601536
    s_add_u32 m0, s28, 32768
    s_waitcnt lgkmcnt(10)
    v_mfma_f32_16x16x32_bf16 v[128:131], v[88:91], v[40:43], 0
    s_setprio 1
    ds_read_b64_tr_b16 v[84:85], v10 offset:192
    v_mfma_f32_16x16x32_bf16 v[128:131], v[72:75], v[56:59], v[128:131]
    s_setprio 0
    buffer_load_dwordx4 v4, s[8:11], s64 offen offset:0 sc1 lds
    ds_read_b64_tr_b16 v[86:87], v10 offset:3776
    s_add_u32 m0, s28, 32768
    s_waitcnt lgkmcnt(10)
    v_mfma_f32_16x16x32_bf16 v[132:135], v[72:75], v[60:63], 0
    s_setprio 1
    v_mfma_f32_16x16x32_bf16 v[132:135], v[88:91], v[44:47], v[132:135]
    s_setprio 0
    buffer_load_dwordx4 v5, s[8:11], s64 offen offset:1024 sc1 lds
    s_add_u32 m0, s28, 32768
    s_waitcnt lgkmcnt(8)
    v_mfma_f32_16x16x32_bf16 v[136:139], v[88:91], v[48:51], 0
    s_setprio 1
    v_mfma_f32_16x16x32_bf16 v[136:139], v[72:75], v[64:67], v[136:139]
    s_setprio 0
    buffer_load_dwordx4 v4, s[8:11], s66 offen offset:2048 sc1 lds
    s_add_u32 m0, s28, 32768
    s_waitcnt lgkmcnt(6)
    v_mfma_f32_16x16x32_bf16 v[140:143], v[72:75], v[68:71], 0
    s_setprio 1
    v_mfma_f32_16x16x32_bf16 v[140:143], v[88:91], v[52:55], v[140:143]
    s_setprio 0
    buffer_load_dwordx4 v5, s[8:11], s66 offen offset:3072 sc1 lds
    s_add_u32 s64, s64, 128
    s_bitset0_b32 s64, 11
    s_add_u32 s66, s64, 30720
    ds_read_b64_tr_b16 v[88:89], v10 offset:7488
    s_add_u32 m0, s29, 29184
    s_waitcnt lgkmcnt(3)
    v_mfma_f32_16x16x32_bf16 v[172:175], v[76:79], v[52:55], 0
    s_setprio 1
    ds_read_b64_tr_b16 v[90:91], v10 offset:11072
    v_mfma_f32_16x16x32_bf16 v[172:175], v[80:83], v[68:71], v[172:175]
    s_setprio 0
    buffer_load_dwordx4 v6, s[12:15], s65 offen lds
    s_add_u32 s65, s65, 229376
    s_waitcnt vmcnt(7) lgkmcnt(0)
    s_barrier
    s_add_u32 m0, s29, 36480
    v_mfma_f32_16x16x32_bf16 v[168:171], v[80:83], v[64:67], 0
    s_setprio 1
    ds_read_b64_tr_b16 v[72:73], v10 offset:14720
    v_mfma_f32_16x16x32_bf16 v[168:171], v[76:79], v[48:51], v[168:171]
    s_setprio 0
    v_mfma_f32_16x16x32_bf16 v[16:19], v[28:31], v[76:79], 0
    v_mfma_f32_16x16x32_bf16 v[16:19], v[28:31], v[80:83], v[16:19]
    buffer_load_dwordx4 v6, s[12:15], s65 offen lds
    s_sub_u32 s65, s65, 229376
    ds_read_b64_tr_b16 v[74:75], v10 offset:18304
    s_add_u32 m0, s29, 43776
    v_mfma_f32_16x16x32_bf16 v[164:167], v[76:79], v[44:47], 0
    s_setprio 1
    v_mfma_f32_16x16x32_bf16 v[164:167], v[80:83], v[60:63], v[164:167]
    s_setprio 0
    buffer_load_dwordx4 v6, s[16:19], s65 offen lds
    s_add_u32 s65, s65, 229376
    s_add_u32 m0, s29, 51072
    v_mfma_f32_16x16x32_bf16 v[160:163], v[80:83], v[56:59], 0
    s_setprio 1
    v_mfma_f32_16x16x32_bf16 v[160:163], v[76:79], v[40:43], v[160:163]
    s_setprio 0
    buffer_load_dwordx4 v6, s[16:19], s65 offen lds
    s_add_u32 s65, s65, 229376
    ds_read_b64_tr_b16 v[76:77], v10 offset:22016
    s_add_u32 m0, s29, 0
    v_mfma_f32_16x16x32_bf16 v[192:195], v[84:87], v[40:43], 0
    s_setprio 1
    ds_read_b64_tr_b16 v[78:79], v10 offset:25600
    v_mfma_f32_16x16x32_bf16 v[192:195], v[88:91], v[56:59], v[192:195]
    s_setprio 0
    buffer_load_dwordx4 v6, s[12:15], s65 offen lds
    s_add_u32 s65, s65, 229376
    ds_read_b64_tr_b16 v[80:81], v10 offset:14752
    s_add_u32 m0, s29, 7296
    v_mfma_f32_16x16x32_bf16 v[196:199], v[88:91], v[60:63], 0
    s_setprio 1
    ds_read_b64_tr_b16 v[82:83], v10 offset:18336
    v_mfma_f32_16x16x32_bf16 v[196:199], v[84:87], v[44:47], v[196:199]
    s_setprio 0
    buffer_load_dwordx4 v6, s[12:15], s65 offen lds
    s_sub_u32 s65, s65, 229376
    s_add_u32 m0, s28, 123904
    v_mfma_f32_16x16x32_bf16 v[200:203], v[84:87], v[48:51], 0
    s_setprio 1
    v_mfma_f32_16x16x32_bf16 v[200:203], v[88:91], v[64:67], v[200:203]
    s_setprio 0
    buffer_load_dwordx4 v4, s[8:11], s64 offen offset:0 sc1 lds
    s_add_u32 m0, s28, 123904
    v_mfma_f32_16x16x32_bf16 v[204:207], v[88:91], v[68:71], 0
    s_setprio 1
    v_mfma_f32_16x16x32_bf16 v[204:207], v[84:87], v[52:55], v[204:207]
    s_setprio 0
    buffer_load_dwordx4 v5, s[8:11], s64 offen offset:1024 sc1 lds
    ds_read_b64_tr_b16 v[84:85], v10 offset:22048
    s_add_u32 m0, s28, 123904
    s_waitcnt lgkmcnt(3)
    v_mfma_f32_16x16x32_bf16 v[156:159], v[72:75], v[52:55], 0
    s_setprio 1
    ds_read_b64_tr_b16 v[86:87], v10 offset:25632
    v_mfma_f32_16x16x32_bf16 v[156:159], v[76:79], v[68:71], v[156:159]
    s_setprio 0
    buffer_load_dwordx4 v4, s[8:11], s66 offen offset:2048 sc1 lds
    ds_read_b64_tr_b16 v[88:89], v10 offset:14784
    s_add_u32 m0, s28, 123904
    v_mfma_f32_16x16x32_bf16 v[152:155], v[76:79], v[64:67], 0
    s_setprio 1
    ds_read_b64_tr_b16 v[90:91], v10 offset:18368
    v_mfma_f32_16x16x32_bf16 v[152:155], v[72:75], v[48:51], v[152:155]
    s_setprio 0
    buffer_load_dwordx4 v5, s[8:11], s66 offen offset:3072 sc1 lds
    s_add_u32 s64, s64, 128
    s_bitset0_b32 s64, 11
    s_add_u32 s66, s64, 30720
    v_mfma_f32_16x16x32_bf16 v[148:151], v[72:75], v[44:47], 0
    s_setprio 1
    v_mfma_f32_16x16x32_bf16 v[148:151], v[76:79], v[60:63], v[148:151]
    s_setprio 0
    v_mfma_f32_16x16x32_bf16 v[144:147], v[76:79], v[56:59], 0
    s_setprio 1
    v_mfma_f32_16x16x32_bf16 v[144:147], v[72:75], v[40:43], v[144:147]
    s_setprio 0
    s_waitcnt vmcnt(14)
    s_lshr_b32 s3, s3, 8
    s_add_u32 s3, s3, 3211264
    s_mov_b64 exec, 1
    buffer_store_dwordx2 v[14:15], off, s[24:27], s3 sc1
    s_mov_b64 exec, -1
    ds_read_b64_tr_b16 v[72:73], v10 offset:22080
    s_waitcnt lgkmcnt(3)
    v_mfma_f32_16x16x32_bf16 v[176:179], v[80:83], v[40:43], 0
    s_setprio 1
    ds_read_b64_tr_b16 v[74:75], v10 offset:25664
    v_mfma_f32_16x16x32_bf16 v[176:179], v[84:87], v[56:59], v[176:179]
    s_setprio 0
    s_waitcnt vmcnt(9) lgkmcnt(0)
    s_barrier
    s_add_u32 m0, s29, 14592
    v_mfma_f32_16x16x32_bf16 v[180:183], v[84:87], v[60:63], 0
    s_setprio 1
    ds_read_b64_tr_b16 v[76:77], v10 offset:29312
    v_mfma_f32_16x16x32_bf16 v[180:183], v[80:83], v[44:47], v[180:183]
    s_setprio 0
    v_mfma_f32_16x16x32_bf16 v[20:23], v[28:31], v[80:83], 0
    v_mfma_f32_16x16x32_bf16 v[20:23], v[28:31], v[84:87], v[20:23]
    buffer_load_dwordx4 v6, s[16:19], s65 offen lds
    s_add_u32 s65, s65, 229376
    ds_read_b64_tr_b16 v[78:79], v10 offset:32896
    s_add_u32 m0, s29, 21888
    v_mfma_f32_16x16x32_bf16 v[184:187], v[80:83], v[48:51], 0
    s_setprio 1
    v_mfma_f32_16x16x32_bf16 v[184:187], v[84:87], v[64:67], v[184:187]
    s_setprio 0
    buffer_load_dwordx4 v6, s[16:19], s65 offen lds
    s_add_u32 s65, s65, 229376
    s_mov_b32 m0, 28672
    v_mfma_f32_16x16x32_bf16 v[188:191], v[84:87], v[68:71], 0
    s_setprio 1
    v_mfma_f32_16x16x32_bf16 v[188:191], v[80:83], v[52:55], v[188:191]
    s_setprio 0
    s_add_u32 s5, s66, 131072
    buffer_load_dwordx4 v4, s[8:11], s5 offen offset:2048 sc1 lds
    ds_read_b64_tr_b16 v[80:81], v10 offset:36608
    s_add_u32 m0, s28, 0
    v_mfma_f32_16x16x32_bf16 v[220:223], v[88:91], v[52:55], 0
    s_setprio 1
    ds_read_b128 v[52:55], v8 offset:38912
    ds_read_b64_tr_b16 v[82:83], v10 offset:40192
    v_mfma_f32_16x16x32_bf16 v[220:223], v[72:75], v[68:71], v[220:223]
    s_setprio 0
    buffer_load_dwordx4 v4, s[8:11], s64 offen offset:0 sc1 lds
    ds_read_b128 v[68:71], v9 offset:38912
    ds_read_b64_tr_b16 v[84:85], v10 offset:29344
    s_add_u32 m0, s28, 0
    v_mfma_f32_16x16x32_bf16 v[216:219], v[72:75], v[64:67], 0
    s_setprio 1
    ds_read_b128 v[64:67], v9 offset:36864
    ds_read_b64_tr_b16 v[86:87], v10 offset:32928
    v_mfma_f32_16x16x32_bf16 v[216:219], v[88:91], v[48:51], v[216:219]
    s_setprio 0
    buffer_load_dwordx4 v5, s[8:11], s64 offen offset:1024 sc1 lds
    ds_read_b128 v[48:51], v8 offset:36864
    s_add_u32 m0, s28, 0
    v_mfma_f32_16x16x32_bf16 v[212:215], v[88:91], v[44:47], 0
    s_setprio 1
    ds_read_b128 v[44:47], v8 offset:34816
    v_mfma_f32_16x16x32_bf16 v[212:215], v[72:75], v[60:63], v[212:215]
    s_setprio 0
    buffer_load_dwordx4 v4, s[8:11], s66 offen offset:2048 sc1 lds
    ds_read_b128 v[60:63], v9 offset:34816
    s_add_u32 m0, s28, 0
    v_mfma_f32_16x16x32_bf16 v[208:211], v[72:75], v[56:59], 0
    s_setprio 1
    ds_read_b128 v[56:59], v9 offset:32768
    v_mfma_f32_16x16x32_bf16 v[208:211], v[88:91], v[40:43], v[208:211]
    s_setprio 0
    buffer_load_dwordx4 v5, s[8:11], s66 offen offset:3072 sc1 lds
    s_add_u32 s64, s64, 128
    s_bitset0_b32 s64, 11
    s_add_u32 s66, s64, 30720
    ds_read_b128 v[40:43], v8 offset:32768
    ds_read_b64_tr_b16 v[88:89], v10 offset:36640
    s_waitcnt lgkmcnt(9)
    v_mfma_f32_16x16x32_bf16 v[140:143], v[76:79], v[52:55], v[140:143]
    s_setprio 1
    ds_read_b64_tr_b16 v[90:91], v10 offset:40224
    v_mfma_f32_16x16x32_bf16 v[140:143], v[80:83], v[68:71], v[140:143]
    s_setprio 0
    ds_read_b64_tr_b16 v[72:73], v10 offset:29376
    s_waitcnt lgkmcnt(7)
    v_mfma_f32_16x16x32_bf16 v[136:139], v[80:83], v[64:67], v[136:139]
    s_setprio 1
    ds_read_b64_tr_b16 v[74:75], v10 offset:32960
    v_mfma_f32_16x16x32_bf16 v[136:139], v[76:79], v[48:51], v[136:139]
    s_setprio 0
    s_waitcnt lgkmcnt(6)
    v_mfma_f32_16x16x32_bf16 v[132:135], v[76:79], v[44:47], v[132:135]
    s_setprio 1
    v_mfma_f32_16x16x32_bf16 v[132:135], v[80:83], v[60:63], v[132:135]
    s_setprio 0
    s_waitcnt lgkmcnt(4)
    v_mfma_f32_16x16x32_bf16 v[128:131], v[80:83], v[56:59], v[128:131]
    s_setprio 1
    v_mfma_f32_16x16x32_bf16 v[128:131], v[76:79], v[40:43], v[128:131]
    s_setprio 0
    ds_read_b64_tr_b16 v[76:77], v10 offset:36672
    s_waitcnt lgkmcnt(3)
    v_mfma_f32_16x16x32_bf16 v[160:163], v[84:87], v[40:43], v[160:163]
    s_setprio 1
    ds_read_b64_tr_b16 v[78:79], v10 offset:40256
    v_mfma_f32_16x16x32_bf16 v[160:163], v[88:91], v[56:59], v[160:163]
    s_setprio 0
    s_waitcnt vmcnt(14) lgkmcnt(0)
    s_barrier
    v_mfma_f32_16x16x32_bf16 v[164:167], v[88:91], v[60:63], v[164:167]
    s_setprio 1
    ds_read_b64_tr_b16 v[80:81], v10 offset:43904
    s_add_u32 m0, s29, 29184
    v_mfma_f32_16x16x32_bf16 v[164:167], v[84:87], v[44:47], v[164:167]
    s_setprio 0
    ds_read_b64_tr_b16 v[82:83], v10 offset:47488
    v_mfma_f32_16x16x32_bf16 v[16:19], v[28:31], v[84:87], v[16:19]
    v_mfma_f32_16x16x32_bf16 v[16:19], v[28:31], v[88:91], v[16:19]
    buffer_load_dwordx4 v6, s[12:15], s65 offen lds
    v_mfma_f32_16x16x32_bf16 v[168:171], v[84:87], v[48:51], v[168:171]
    s_setprio 1
    s_add_u32 s65, s65, 229376
    v_mfma_f32_16x16x32_bf16 v[168:171], v[88:91], v[64:67], v[168:171]
    s_setprio 0
    v_mfma_f32_16x16x32_bf16 v[172:175], v[88:91], v[68:71], v[172:175]
    s_setprio 1
    s_add_u32 m0, s29, 36480
    v_mfma_f32_16x16x32_bf16 v[172:175], v[84:87], v[52:55], v[172:175]
    s_setprio 0
    ds_read_b64_tr_b16 v[84:85], v10 offset:51200
    buffer_load_dwordx4 v6, s[12:15], s65 offen lds
    v_mfma_f32_16x16x32_bf16 v[204:207], v[72:75], v[52:55], v[204:207]
    s_setprio 1
    ds_read_b64_tr_b16 v[86:87], v10 offset:54784
    s_sub_u32 s65, s65, 229376
    v_mfma_f32_16x16x32_bf16 v[204:207], v[76:79], v[68:71], v[204:207]
    s_setprio 0
    ds_read_b64_tr_b16 v[88:89], v10 offset:43936
    v_mfma_f32_16x16x32_bf16 v[200:203], v[76:79], v[64:67], v[200:203]
    s_setprio 1
    ds_read_b64_tr_b16 v[90:91], v10 offset:47520
    v_mfma_f32_16x16x32_bf16 v[200:203], v[72:75], v[48:51], v[200:203]
    s_setprio 0
    v_mfma_f32_16x16x32_bf16 v[196:199], v[72:75], v[44:47], v[196:199]
    s_setprio 1
    v_mfma_f32_16x16x32_bf16 v[196:199], v[76:79], v[60:63], v[196:199]
    s_setprio 0
    v_mfma_f32_16x16x32_bf16 v[192:195], v[76:79], v[56:59], v[192:195]
    s_setprio 1
    v_mfma_f32_16x16x32_bf16 v[192:195], v[72:75], v[40:43], v[192:195]
    s_setprio 0
    ds_read_b64_tr_b16 v[72:73], v10 offset:51232
    s_waitcnt lgkmcnt(3)
    v_mfma_f32_16x16x32_bf16 v[144:147], v[80:83], v[40:43], v[144:147]
    s_setprio 1
    ds_read_b64_tr_b16 v[74:75], v10 offset:54816
    v_mfma_f32_16x16x32_bf16 v[144:147], v[84:87], v[56:59], v[144:147]
    s_setprio 0
    ds_read_b64_tr_b16 v[76:77], v10 offset:43968
    v_mfma_f32_16x16x32_bf16 v[148:151], v[84:87], v[60:63], v[148:151]
    s_setprio 1
    ds_read_b64_tr_b16 v[78:79], v10 offset:47552
    v_mfma_f32_16x16x32_bf16 v[148:151], v[80:83], v[44:47], v[148:151]
    s_setprio 0
    v_mfma_f32_16x16x32_bf16 v[152:155], v[80:83], v[48:51], v[152:155]
    s_setprio 1
    v_mfma_f32_16x16x32_bf16 v[152:155], v[84:87], v[64:67], v[152:155]
    s_setprio 0
    v_mfma_f32_16x16x32_bf16 v[156:159], v[84:87], v[68:71], v[156:159]
    s_setprio 1
    v_mfma_f32_16x16x32_bf16 v[156:159], v[80:83], v[52:55], v[156:159]
    s_setprio 0
    ds_read_b64_tr_b16 v[80:81], v10 offset:51264
    s_waitcnt lgkmcnt(3)
    v_mfma_f32_16x16x32_bf16 v[188:191], v[88:91], v[52:55], v[188:191]
    s_setprio 1
    ds_read_b64_tr_b16 v[82:83], v10 offset:54848
    v_mfma_f32_16x16x32_bf16 v[188:191], v[72:75], v[68:71], v[188:191]
    s_setprio 0
    s_waitcnt vmcnt(10) lgkmcnt(0)
    s_barrier
    v_mfma_f32_16x16x32_bf16 v[184:187], v[72:75], v[64:67], v[184:187]
    s_setprio 1
    ds_read_b64_tr_b16 v[84:85], v10 offset:128
    s_add_u32 m0, s29, 43776
    v_mfma_f32_16x16x32_bf16 v[184:187], v[88:91], v[48:51], v[184:187]
    s_setprio 0
    ds_read_b64_tr_b16 v[86:87], v10 offset:3712
    v_mfma_f32_16x16x32_bf16 v[20:23], v[28:31], v[88:91], v[20:23]
    v_mfma_f32_16x16x32_bf16 v[20:23], v[28:31], v[72:75], v[20:23]
    buffer_load_dwordx4 v6, s[16:19], s65 offen lds
    v_mfma_f32_16x16x32_bf16 v[180:183], v[88:91], v[44:47], v[180:183]
    s_setprio 1
    s_add_u32 s65, s65, 229376
    v_mfma_f32_16x16x32_bf16 v[180:183], v[72:75], v[60:63], v[180:183]
    s_setprio 0
    v_mfma_f32_16x16x32_bf16 v[176:179], v[72:75], v[56:59], v[176:179]
    s_setprio 1
    s_add_u32 m0, s29, 51072
    v_mfma_f32_16x16x32_bf16 v[176:179], v[88:91], v[40:43], v[176:179]
    s_setprio 0
    ds_read_b64_tr_b16 v[88:89], v10 offset:7424
    buffer_load_dwordx4 v6, s[16:19], s65 offen lds
    v_mfma_f32_16x16x32_bf16 v[208:211], v[76:79], v[40:43], v[208:211]
    s_setprio 1
    ds_read_b128 v[40:43], v94 offset:0
    ds_read_b64_tr_b16 v[90:91], v10 offset:11008
    s_add_u32 s65, s65, 229376
    v_mfma_f32_16x16x32_bf16 v[208:211], v[80:83], v[56:59], v[208:211]
    s_setprio 0
    ds_read_b128 v[56:59], v95 offset:0
    ds_read_b64_tr_b16 v[72:73], v10 offset:160
    v_mfma_f32_16x16x32_bf16 v[212:215], v[80:83], v[60:63], v[212:215]
    s_setprio 1
    ds_read_b128 v[60:63], v95 offset:2048
    ds_read_b64_tr_b16 v[74:75], v10 offset:3744
    v_mfma_f32_16x16x32_bf16 v[212:215], v[76:79], v[44:47], v[212:215]
    s_setprio 0
    ds_read_b128 v[44:47], v94 offset:2048
    v_mfma_f32_16x16x32_bf16 v[216:219], v[76:79], v[48:51], v[216:219]
    s_setprio 1
    ds_read_b128 v[48:51], v94 offset:4096
    v_mfma_f32_16x16x32_bf16 v[216:219], v[80:83], v[64:67], v[216:219]
    s_setprio 0
    ds_read_b128 v[64:67], v95 offset:4096
    v_mfma_f32_16x16x32_bf16 v[220:223], v[80:83], v[68:71], v[220:223]
    s_setprio 1
    ds_read_b128 v[68:71], v95 offset:6144
    v_mfma_f32_16x16x32_bf16 v[220:223], v[76:79], v[52:55], v[220:223]
    s_setprio 0
    ds_read_b128 v[52:55], v94 offset:6144
    ds_read_b64_tr_b16 v[76:77], v10 offset:7456
    s_waitcnt lgkmcnt(9)
    v_mfma_f32_16x16x32_bf16 v[128:131], v[84:87], v[40:43], v[128:131]
    s_setprio 1
    ds_read_b64_tr_b16 v[78:79], v10 offset:11040
    v_mfma_f32_16x16x32_bf16 v[128:131], v[88:91], v[56:59], v[128:131]
    s_setprio 0
    ds_read_b64_tr_b16 v[80:81], v10 offset:192
    s_waitcnt lgkmcnt(7)
    v_mfma_f32_16x16x32_bf16 v[132:135], v[88:91], v[60:63], v[132:135]
    s_setprio 1
    ds_read_b64_tr_b16 v[82:83], v10 offset:3776
    v_mfma_f32_16x16x32_bf16 v[132:135], v[84:87], v[44:47], v[132:135]
    s_setprio 0
    s_waitcnt lgkmcnt(6)
    v_mfma_f32_16x16x32_bf16 v[136:139], v[84:87], v[48:51], v[136:139]
    s_setprio 1
    v_mfma_f32_16x16x32_bf16 v[136:139], v[88:91], v[64:67], v[136:139]
    s_setprio 0
    s_waitcnt lgkmcnt(4)
    v_mfma_f32_16x16x32_bf16 v[140:143], v[88:91], v[68:71], v[140:143]
    s_setprio 1
    v_mfma_f32_16x16x32_bf16 v[140:143], v[84:87], v[52:55], v[140:143]
    s_setprio 0
    ds_read_b64_tr_b16 v[84:85], v10 offset:7488
    s_waitcnt lgkmcnt(3)
    v_mfma_f32_16x16x32_bf16 v[172:175], v[72:75], v[52:55], v[172:175]
    s_setprio 1
    ds_read_b64_tr_b16 v[86:87], v10 offset:11072
    v_mfma_f32_16x16x32_bf16 v[172:175], v[76:79], v[68:71], v[172:175]
    s_setprio 0
    s_waitcnt vmcnt(9) lgkmcnt(0)
    s_barrier
    v_mfma_f32_16x16x32_bf16 v[168:171], v[76:79], v[64:67], v[168:171]
    s_setprio 1
    ds_read_b64_tr_b16 v[88:89], v10 offset:14720
    s_add_u32 m0, s29, 0
    v_mfma_f32_16x16x32_bf16 v[168:171], v[72:75], v[48:51], v[168:171]
    s_setprio 0
    v_mfma_f32_16x16x32_bf16 v[16:19], v[28:31], v[72:75], v[16:19]
    v_mfma_f32_16x16x32_bf16 v[16:19], v[28:31], v[76:79], v[16:19]
    s_mov_b64 s[8:9], s[56:57]
    v_mov_b32 v236, 0
    ds_read_b64_tr_b16 v[90:91], v10 offset:18304
    buffer_load_dwordx4 v6, s[12:15], s65 offen lds
    v_mov_b32 v237, 0
    v_mfma_f32_16x16x32_bf16 v[164:167], v[72:75], v[44:47], v[164:167]
    s_setprio 1
    s_add_u32 s65, s65, 229376
    v_mfma_f32_16x16x32_bf16 v[164:167], v[76:79], v[60:63], v[164:167]
    s_setprio 0
    v_mov_b32 v238, 0
    v_mfma_f32_16x16x32_bf16 v[160:163], v[76:79], v[56:59], v[160:163]
    s_setprio 1
    s_add_u32 m0, s29, 7296
    v_mfma_f32_16x16x32_bf16 v[160:163], v[72:75], v[40:43], v[160:163]
    s_setprio 0
    ds_read_b64_tr_b16 v[72:73], v10 offset:22016
    buffer_load_dwordx4 v6, s[12:15], s65 offen lds
    v_mov_b32 v239, 0
    v_mfma_f32_16x16x32_bf16 v[192:195], v[80:83], v[40:43], v[192:195]
    s_setprio 1
    ds_read_b64_tr_b16 v[74:75], v10 offset:25600
    s_sub_u32 s65, s65, 229376
    v_mfma_f32_16x16x32_bf16 v[192:195], v[84:87], v[56:59], v[192:195]
    s_setprio 0
    ds_read_b64_tr_b16 v[76:77], v10 offset:14752
    v_mov_b32 v232, 0
    v_mfma_f32_16x16x32_bf16 v[196:199], v[84:87], v[60:63], v[196:199]
    s_setprio 1
    ds_read_b64_tr_b16 v[78:79], v10 offset:18336
    s_mov_b32 m0, 61440
    v_mfma_f32_16x16x32_bf16 v[196:199], v[80:83], v[44:47], v[196:199]
    s_setprio 0
    s_add_u32 s5, s66, 131072
    buffer_load_dwordx4 v4, s[8:11], s5 offen offset:2048 sc1 lds
    v_mov_b32 v233, 0
    v_mfma_f32_16x16x32_bf16 v[200:203], v[80:83], v[48:51], v[200:203]
    s_setprio 1
    v_mfma_f32_16x16x32_bf16 v[200:203], v[84:87], v[64:67], v[200:203]
    s_setprio 0
    v_mov_b32 v234, 0
    v_mfma_f32_16x16x32_bf16 v[204:207], v[84:87], v[68:71], v[204:207]
    s_setprio 1
    s_add_u32 m0, s28, 32768
    v_mfma_f32_16x16x32_bf16 v[204:207], v[80:83], v[52:55], v[204:207]
    s_setprio 0
    ds_read_b64_tr_b16 v[80:81], v10 offset:22048
    buffer_load_dwordx4 v4, s[8:11], s64 offen offset:0 sc1 lds
    v_mov_b32 v235, 0
    s_waitcnt lgkmcnt(3)
    v_mfma_f32_16x16x32_bf16 v[156:159], v[88:91], v[52:55], v[156:159]
    s_setprio 1
    ds_read_b64_tr_b16 v[82:83], v10 offset:25632
    v_mfma_f32_16x16x32_bf16 v[156:159], v[72:75], v[68:71], v[156:159]
    s_setprio 0
    ds_read_b64_tr_b16 v[84:85], v10 offset:14784
    v_mov_b32 v228, 0
    v_mfma_f32_16x16x32_bf16 v[152:155], v[72:75], v[64:67], v[152:155]
    s_setprio 1
    ds_read_b64_tr_b16 v[86:87], v10 offset:18368
    s_add_u32 m0, s28, 32768
    v_mfma_f32_16x16x32_bf16 v[152:155], v[88:91], v[48:51], v[152:155]
    s_setprio 0
    buffer_load_dwordx4 v5, s[8:11], s64 offen offset:1024 sc1 lds
    v_mov_b32 v229, 0
    v_mfma_f32_16x16x32_bf16 v[148:151], v[88:91], v[44:47], v[148:151]
    s_setprio 1
    v_mfma_f32_16x16x32_bf16 v[148:151], v[72:75], v[60:63], v[148:151]
    s_setprio 0
    v_mov_b32 v230, 0
    v_mfma_f32_16x16x32_bf16 v[144:147], v[72:75], v[56:59], v[144:147]
    s_setprio 1
    s_add_u32 m0, s28, 32768
    v_mfma_f32_16x16x32_bf16 v[144:147], v[88:91], v[40:43], v[144:147]
    s_setprio 0
    ds_read_b64_tr_b16 v[88:89], v10 offset:22080
    buffer_load_dwordx4 v4, s[8:11], s66 offen offset:2048 sc1 lds
    v_mov_b32 v231, 0
    s_waitcnt lgkmcnt(3)
    v_mfma_f32_16x16x32_bf16 v[176:179], v[76:79], v[40:43], v[176:179]
    s_setprio 1
    ds_read_b64_tr_b16 v[90:91], v10 offset:25664
    s_add_u32 m0, s28, 32768
    v_mfma_f32_16x16x32_bf16 v[176:179], v[80:83], v[56:59], v[176:179]
    s_setprio 0
    buffer_load_dwordx4 v5, s[8:11], s66 offen offset:3072 sc1 lds
    v_mov_b32 v224, 0
    s_waitcnt vmcnt(9) lgkmcnt(0)
    s_barrier
    v_mfma_f32_16x16x32_bf16 v[180:183], v[80:83], v[60:63], v[180:183]
    s_setprio 1
    ds_read_b64_tr_b16 v[72:73], v10 offset:29312
    s_add_u32 s64, s64, 128
    s_bitset0_b32 s64, 11
    s_add_u32 m0, s29, 14592
    v_mfma_f32_16x16x32_bf16 v[180:183], v[76:79], v[44:47], v[180:183]
    s_setprio 0
    v_mfma_f32_16x16x32_bf16 v[20:23], v[28:31], v[76:79], v[20:23]
    v_mfma_f32_16x16x32_bf16 v[20:23], v[28:31], v[80:83], v[20:23]
    s_add_u32 s66, s64, 30720
    ds_read_b64_tr_b16 v[74:75], v10 offset:32896
    buffer_load_dwordx4 v6, s[16:19], s65 offen lds
    v_mov_b32 v225, 0
    v_mfma_f32_16x16x32_bf16 v[184:187], v[76:79], v[48:51], v[184:187]
    s_setprio 1
    s_add_u32 s65, s65, 229376
    v_mfma_f32_16x16x32_bf16 v[184:187], v[80:83], v[64:67], v[184:187]
    s_setprio 0
    v_mov_b32 v226, 0
    v_mfma_f32_16x16x32_bf16 v[188:191], v[80:83], v[68:71], v[188:191]
    s_setprio 1
    s_add_u32 m0, s29, 21888
    v_mfma_f32_16x16x32_bf16 v[188:191], v[76:79], v[52:55], v[188:191]
    s_setprio 0
    ds_read_b64_tr_b16 v[76:77], v10 offset:36608
    buffer_load_dwordx4 v6, s[16:19], s65 offen lds
    v_mov_b32 v227, 0
    v_mfma_f32_16x16x32_bf16 v[220:223], v[84:87], v[52:55], v[220:223]
    s_setprio 1
    ds_read_b128 v[52:55], v8 offset:6144
    ds_read_b64_tr_b16 v[78:79], v10 offset:40192
    s_add_u32 s65, s65, 229376
    v_mfma_f32_16x16x32_bf16 v[220:223], v[88:91], v[68:71], v[220:223]
    s_setprio 0
    ds_read_b128 v[68:71], v9 offset:6144
    ds_read_b64_tr_b16 v[80:81], v10 offset:29344
    v_mov_b32 v240, 0
    v_mfma_f32_16x16x32_bf16 v[216:219], v[88:91], v[64:67], v[216:219]
    s_setprio 1
    ds_read_b128 v[64:67], v9 offset:4096
    ds_read_b64_tr_b16 v[82:83], v10 offset:32928
    s_mov_b32 m0, 136192
    v_mfma_f32_16x16x32_bf16 v[216:219], v[84:87], v[48:51], v[216:219]
    s_setprio 0
    v_mov_b32 v241, 0
    ds_read_b128 v[48:51], v8 offset:4096
    buffer_load_dwordx4 v35, s[76:79], s37 offen  lds
    v_mfma_f32_16x16x32_bf16 v[212:215], v[84:87], v[44:47], v[212:215]
    s_setprio 1
    ds_read_b128 v[44:47], v8 offset:2048
    s_add_u32 s37, s37, 196608
    v_mfma_f32_16x16x32_bf16 v[212:215], v[88:91], v[60:63], v[212:215]
    s_setprio 0
    v_mov_b32 v242, 0
    ds_read_b128 v[60:63], v9 offset:2048
    v_mfma_f32_16x16x32_bf16 v[208:211], v[88:91], v[56:59], v[208:211]
    s_setprio 1
    ds_read_b128 v[56:59], v9 offset:0
    v_mfma_f32_16x16x32_bf16 v[208:211], v[84:87], v[40:43], v[208:211]
    s_setprio 0
    v_mov_b32 v243, 0
    ds_read_b128 v[40:43], v8 offset:0
    ds_read_b64_tr_b16 v[84:85], v10 offset:36640
    s_waitcnt lgkmcnt(9)
    v_mfma_f32_16x16x32_bf16 v[140:143], v[72:75], v[52:55], v[140:143]
    s_setprio 1
    ds_read_b64_tr_b16 v[86:87], v10 offset:40224
    v_mfma_f32_16x16x32_bf16 v[140:143], v[76:79], v[68:71], v[140:143]
    s_setprio 0
    v_mov_b32 v244, 0
    ds_read_b64_tr_b16 v[88:89], v10 offset:29376
    s_waitcnt lgkmcnt(7)
    v_mfma_f32_16x16x32_bf16 v[136:139], v[76:79], v[64:67], v[136:139]
    s_setprio 1
    ds_read_b64_tr_b16 v[90:91], v10 offset:32960
    s_mov_b32 m0, 142336
    v_mfma_f32_16x16x32_bf16 v[136:139], v[72:75], v[48:51], v[136:139]
    s_setprio 0
    v_mov_b32 v245, 0
    buffer_load_dwordx4 v35, s[76:79], s37 offen  lds
    s_waitcnt lgkmcnt(6)
    v_mfma_f32_16x16x32_bf16 v[132:135], v[72:75], v[44:47], v[132:135]
    s_setprio 1
    s_add_u32 s37, s37, 196608
    v_mfma_f32_16x16x32_bf16 v[132:135], v[76:79], v[60:63], v[132:135]
    s_setprio 0
    v_mov_b32 v246, 0
    s_waitcnt lgkmcnt(4)
    v_mfma_f32_16x16x32_bf16 v[128:131], v[76:79], v[56:59], v[128:131]
    s_setprio 1
    v_mfma_f32_16x16x32_bf16 v[128:131], v[72:75], v[40:43], v[128:131]
    s_setprio 0
    v_mov_b32 v247, 0
    ds_read_b64_tr_b16 v[72:73], v10 offset:36672
    s_waitcnt lgkmcnt(3)
    v_mfma_f32_16x16x32_bf16 v[160:163], v[80:83], v[40:43], v[160:163]
    s_setprio 1
    ds_read_b64_tr_b16 v[74:75], v10 offset:40256
    v_mfma_f32_16x16x32_bf16 v[160:163], v[84:87], v[56:59], v[160:163]
    s_setprio 0
    v_mov_b32 v248, 0
    s_waitcnt vmcnt(11) lgkmcnt(0)
    s_barrier
    v_mfma_f32_16x16x32_bf16 v[164:167], v[84:87], v[60:63], v[164:167]
    s_setprio 1
    ds_read_b64_tr_b16 v[76:77], v10 offset:43904
    s_add_u32 m0, s29, 29184
    v_mfma_f32_16x16x32_bf16 v[164:167], v[80:83], v[44:47], v[164:167]
    s_setprio 0
    v_mfma_f32_16x16x32_bf16 v[16:19], v[28:31], v[80:83], v[16:19]
    v_mfma_f32_16x16x32_bf16 v[16:19], v[28:31], v[84:87], v[16:19]
    v_mov_b32 v249, 0
    ds_read_b64_tr_b16 v[78:79], v10 offset:47488
    buffer_load_dwordx4 v6, s[12:15], s65 offen lds
    ds_read_b64 v[36:37], v26 offset:0
    v_mfma_f32_16x16x32_bf16 v[168:171], v[80:83], v[48:51], v[168:171]
    s_setprio 1
    ds_read_b64 v[38:39], v26 offset:128
    s_add_u32 s65, s65, 229376
    v_mfma_f32_16x16x32_bf16 v[168:171], v[84:87], v[64:67], v[168:171]
    s_setprio 0
    v_mov_b32 v250, 0
    ds_read_b64 v[12:13], v26 offset:256
    v_mfma_f32_16x16x32_bf16 v[172:175], v[84:87], v[68:71], v[172:175]
    s_setprio 1
    ds_read_b64 v[14:15], v26 offset:384
    s_add_u32 m0, s29, 36480
    v_mfma_f32_16x16x32_bf16 v[172:175], v[80:83], v[52:55], v[172:175]
    s_setprio 0
    v_mov_b32 v251, 0
    ds_read_b64_tr_b16 v[80:81], v10 offset:51200
    buffer_load_dwordx4 v6, s[12:15], s65 offen lds
    v_mfma_f32_16x16x32_bf16 v[204:207], v[88:91], v[52:55], v[204:207]
    s_setprio 1
    ds_read_b64_tr_b16 v[82:83], v10 offset:54784
    s_sub_u32 s65, s65, 229376
    v_mfma_f32_16x16x32_bf16 v[204:207], v[72:75], v[68:71], v[204:207]
    s_setprio 0
    v_mov_b32 v252, 0
    ds_read_b64_tr_b16 v[84:85], v10 offset:43936
    v_mfma_f32_16x16x32_bf16 v[200:203], v[72:75], v[64:67], v[200:203]
    s_setprio 1
    ds_read_b64_tr_b16 v[86:87], v10 offset:47520
    s_mov_b32 m0, 28672
    v_mfma_f32_16x16x32_bf16 v[200:203], v[88:91], v[48:51], v[200:203]
    s_setprio 0
    v_mov_b32 v253, 0
    s_add_u32 s5, s66, 131072
    buffer_load_dwordx4 v4, s[8:11], s5 offen offset:2048 sc1 lds
    v_mfma_f32_16x16x32_bf16 v[196:199], v[88:91], v[44:47], v[196:199]
    s_setprio 1
    v_mfma_f32_16x16x32_bf16 v[196:199], v[72:75], v[60:63], v[196:199]
    s_setprio 0
    v_mov_b32 v254, 0
    v_mfma_f32_16x16x32_bf16 v[192:195], v[72:75], v[56:59], v[192:195]
    s_setprio 1
    s_add_u32 m0, s28, 0
    v_mfma_f32_16x16x32_bf16 v[192:195], v[88:91], v[40:43], v[192:195]
    s_setprio 0
    v_mov_b32 v255, 0
    ds_read_b64_tr_b16 v[88:89], v10 offset:51232
    buffer_load_dwordx4 v4, s[8:11], s64 offen offset:0 sc1 lds
    s_waitcnt lgkmcnt(3)
    v_mfma_f32_16x16x32_bf16 v[144:147], v[76:79], v[40:43], v[144:147]
    s_setprio 1
    ds_read_b64_tr_b16 v[90:91], v10 offset:54816
    v_mfma_f32_16x16x32_bf16 v[144:147], v[80:83], v[56:59], v[144:147]
    s_setprio 0
    ds_read_b64_tr_b16 v[72:73], v10 offset:43968
    v_mfma_f32_16x16x32_bf16 v[148:151], v[80:83], v[60:63], v[148:151]
    s_setprio 1
    ds_read_b64_tr_b16 v[74:75], v10 offset:47552
    s_add_u32 m0, s28, 0
    v_mfma_f32_16x16x32_bf16 v[148:151], v[76:79], v[44:47], v[148:151]
    s_setprio 0
    buffer_load_dwordx4 v5, s[8:11], s64 offen offset:1024 sc1 lds
    v_mul_f32 v140, v140, v15
    v_mul_f32 v141, v141, v15
    v_mul_f32 v142, v142, v15
    v_mfma_f32_16x16x32_bf16 v[152:155], v[76:79], v[48:51], v[152:155]
    s_setprio 1
    v_mfma_f32_16x16x32_bf16 v[152:155], v[80:83], v[64:67], v[152:155]
    s_setprio 0
    v_mul_f32 v143, v143, v15
    v_mul_f32 v136, v136, v13
    v_mul_f32 v137, v137, v13
    v_mul_f32 v138, v138, v13
    v_mul_f32 v139, v139, v13
    v_mfma_f32_16x16x32_bf16 v[156:159], v[80:83], v[68:71], v[156:159]
    s_setprio 1
    s_add_u32 m0, s28, 0
    v_mfma_f32_16x16x32_bf16 v[156:159], v[76:79], v[52:55], v[156:159]
    s_setprio 0
    v_mul_f32 v132, v132, v39
    v_mul_f32 v133, v133, v39
    ds_read_b64_tr_b16 v[76:77], v10 offset:51264
    buffer_load_dwordx4 v4, s[8:11], s66 offen offset:2048 sc1 lds
    v_mul_f32 v134, v134, v39
    v_mul_f32 v135, v135, v39
    s_waitcnt lgkmcnt(3)
    v_mfma_f32_16x16x32_bf16 v[188:191], v[84:87], v[52:55], v[188:191]
    s_setprio 1
    ds_read_b64_tr_b16 v[78:79], v10 offset:54848
    s_add_u32 m0, s28, 0
    v_mfma_f32_16x16x32_bf16 v[188:191], v[88:91], v[68:71], v[188:191]
    s_setprio 0
    v_mul_f32 v128, v128, v37
    v_mul_f32 v129, v129, v37
    v_mul_f32 v130, v130, v37
    buffer_load_dwordx4 v5, s[8:11], s66 offen offset:3072 sc1 lds
    v_mul_f32 v131, v131, v37
    v_mul_f32 v160, v160, v37
    s_waitcnt vmcnt(11) lgkmcnt(0)
    s_barrier
    v_mfma_f32_16x16x32_bf16 v[184:187], v[88:91], v[64:67], v[184:187]
    s_setprio 1
    ds_read_b64_tr_b16 v[80:81], v10 offset:128
    s_add_u32 s64, s64, 128
    s_bitset0_b32 s64, 11
    s_add_u32 m0, s29, 43776
    v_mfma_f32_16x16x32_bf16 v[184:187], v[84:87], v[48:51], v[184:187]
    s_setprio 0
    v_mfma_f32_16x16x32_bf16 v[20:23], v[28:31], v[84:87], v[20:23]
    v_mfma_f32_16x16x32_bf16 v[20:23], v[28:31], v[88:91], v[20:23]
    s_add_u32 s66, s64, 30720
    v_mul_f32 v161, v161, v37
    v_mul_f32 v162, v162, v37
    v_mul_f32 v163, v163, v37
    ds_read_b64_tr_b16 v[82:83], v10 offset:3712
    buffer_load_dwordx4 v6, s[16:19], s65 offen lds
    v_mul_f32 v164, v164, v39
    v_mul_f32 v165, v165, v39
    v_mfma_f32_16x16x32_bf16 v[180:183], v[84:87], v[44:47], v[180:183]
    s_setprio 1
    s_add_u32 s65, s65, 229376
    v_mfma_f32_16x16x32_bf16 v[180:183], v[88:91], v[60:63], v[180:183]
    s_setprio 0
    v_mul_f32 v166, v166, v39
    v_mul_f32 v167, v167, v39
    v_mul_f32 v168, v168, v13
    v_mul_f32 v169, v169, v13
    v_mul_f32 v170, v170, v13
    v_mfma_f32_16x16x32_bf16 v[176:179], v[88:91], v[56:59], v[176:179]
    s_setprio 1
    s_add_u32 m0, s29, 51072
    v_mfma_f32_16x16x32_bf16 v[176:179], v[84:87], v[40:43], v[176:179]
    s_setprio 0
    v_mul_f32 v171, v171, v13
    v_mul_f32 v172, v172, v15
    ds_read_b64_tr_b16 v[84:85], v10 offset:7424
    buffer_load_dwordx4 v6, s[16:19], s65 offen lds
    v_mul_f32 v173, v173, v15
    v_mul_f32 v174, v174, v15
    v_mul_f32 v175, v175, v15
    v_mfma_f32_16x16x32_bf16 v[208:211], v[72:75], v[40:43], v[208:211]
    s_setprio 1
    ds_read_b128 v[40:43], v8 offset:32768
    ds_read_b64_tr_b16 v[86:87], v10 offset:11008
    s_add_u32 s65, s65, 229376
    v_mfma_f32_16x16x32_bf16 v[208:211], v[76:79], v[56:59], v[208:211]
    s_setprio 0
    v_mul_f32 v204, v204, v15
    v_mul_f32 v205, v205, v15
    ds_read_b128 v[56:59], v9 offset:32768
    ds_read_b64_tr_b16 v[88:89], v10 offset:160
    v_mul_f32 v206, v206, v15
    v_mul_f32 v207, v207, v15
    v_mfma_f32_16x16x32_bf16 v[212:215], v[76:79], v[60:63], v[212:215]
    s_setprio 1
    ds_read_b128 v[60:63], v9 offset:34816
    ds_read_b64_tr_b16 v[90:91], v10 offset:3744
    s_mov_b32 m0, 148480
    v_mfma_f32_16x16x32_bf16 v[212:215], v[72:75], v[44:47], v[212:215]
    s_setprio 0
    v_mul_f32 v200, v200, v13
    v_mul_f32 v201, v201, v13
    v_mul_f32 v202, v202, v13
    ds_read_b128 v[44:47], v8 offset:34816
    buffer_load_dwordx4 v35, s[76:79], s37 offen  lds
    v_mul_f32 v203, v203, v13
    v_mul_f32 v196, v196, v39
    v_mfma_f32_16x16x32_bf16 v[216:219], v[72:75], v[48:51], v[216:219]
    s_setprio 1
    ds_read_b128 v[48:51], v8 offset:36864
    s_add_u32 s37, s37, 196608
    v_mfma_f32_16x16x32_bf16 v[216:219], v[76:79], v[64:67], v[216:219]
    s_setprio 0
    v_mul_f32 v197, v197, v39
    v_mul_f32 v198, v198, v39
    v_mul_f32 v199, v199, v39
    ds_read_b128 v[64:67], v9 offset:36864
    v_mul_f32 v192, v192, v37
    v_mul_f32 v193, v193, v37
    v_mfma_f32_16x16x32_bf16 v[220:223], v[76:79], v[68:71], v[220:223]
    s_setprio 1
    ds_read_b128 v[68:71], v9 offset:38912
    v_mfma_f32_16x16x32_bf16 v[220:223], v[72:75], v[52:55], v[220:223]
    s_setprio 0
    v_mul_f32 v194, v194, v37
    v_mul_f32 v195, v195, v37
    ds_read_b128 v[52:55], v8 offset:38912
    ds_read_b64_tr_b16 v[72:73], v10 offset:7456
    s_waitcnt lgkmcnt(9)
    v_mfma_f32_16x16x32_bf16 v[128:131], v[80:83], v[40:43], v[128:131]
    s_setprio 1
    ds_read_b64_tr_b16 v[74:75], v10 offset:11040
    v_mfma_f32_16x16x32_bf16 v[128:131], v[84:87], v[56:59], v[128:131]
    s_setprio 0
    v_mul_f32 v144, v144, v37
    v_mul_f32 v145, v145, v37
    ds_read_b64_tr_b16 v[76:77], v10 offset:192
    v_mul_f32 v146, v146, v37
    s_waitcnt lgkmcnt(7)
    v_mfma_f32_16x16x32_bf16 v[132:135], v[84:87], v[60:63], v[132:135]
    s_setprio 1
    ds_read_b64_tr_b16 v[78:79], v10 offset:3776
    s_mov_b32 m0, 154624
    v_mfma_f32_16x16x32_bf16 v[132:135], v[80:83], v[44:47], v[132:135]
    s_setprio 0
    v_mul_f32 v147, v147, v37
    ds_write2_b32 v27, v16, v20 offset1:64
    buffer_load_dwordx4 v35, s[76:79], s37 offen  lds
    v_mul_f32 v148, v148, v39
    s_waitcnt lgkmcnt(7)
    v_mfma_f32_16x16x32_bf16 v[136:139], v[80:83], v[48:51], v[136:139]
    s_setprio 1
    s_add_u32 s37, s37, 196608
    v_mfma_f32_16x16x32_bf16 v[136:139], v[84:87], v[64:67], v[136:139]
    s_setprio 0
    v_mul_f32 v149, v149, v39
    v_mul_f32 v150, v150, v39
    v_mul_f32 v151, v151, v39
    s_waitcnt lgkmcnt(5)
    v_mfma_f32_16x16x32_bf16 v[140:143], v[84:87], v[68:71], v[140:143]
    s_setprio 1
    v_mfma_f32_16x16x32_bf16 v[140:143], v[80:83], v[52:55], v[140:143]
    s_setprio 0
    v_mul_f32 v152, v152, v13
    ds_read_b64_tr_b16 v[80:81], v10 offset:7488
    v_mul_f32 v153, v153, v13
    s_waitcnt lgkmcnt(4)
    v_mfma_f32_16x16x32_bf16 v[172:175], v[88:91], v[52:55], v[172:175]
    s_setprio 1
    ds_read_b64_tr_b16 v[82:83], v10 offset:11072
    v_mfma_f32_16x16x32_bf16 v[172:175], v[72:75], v[68:71], v[172:175]
    s_setprio 0
    v_mul_f32 v154, v154, v13
    v_mul_f32 v155, v155, v13
    v_mul_f32 v156, v156, v15
    s_waitcnt vmcnt(11) lgkmcnt(0)
    s_barrier
    v_mfma_f32_16x16x32_bf16 v[168:171], v[72:75], v[64:67], v[168:171]
    s_setprio 1
    ds_read_b64_tr_b16 v[84:85], v92 offset:34816
    s_add_u32 m0, s29, 0
    v_mfma_f32_16x16x32_bf16 v[168:171], v[88:91], v[48:51], v[168:171]
    s_setprio 0
    v_mul_f32 v157, v157, v15
    ds_read_b64_tr_b16 v[86:87], v92 offset:35840
    buffer_load_dwordx4 v6, s[12:15], s65 offen lds
    v_mul_f32 v158, v158, v15
    v_mfma_f32_16x16x32_bf16 v[164:167], v[88:91], v[44:47], v[164:167]
    s_setprio 1
    s_add_u32 s65, s65, 229376
    v_mfma_f32_16x16x32_bf16 v[164:167], v[72:75], v[60:63], v[164:167]
    s_setprio 0
    v_mul_f32 v159, v159, v15
    v_mul_f32 v188, v188, v15
    v_mul_f32 v189, v189, v15
    v_mfma_f32_16x16x32_bf16 v[160:163], v[72:75], v[56:59], v[160:163]
    s_setprio 1
    s_add_u32 m0, s29, 7296
    v_mfma_f32_16x16x32_bf16 v[160:163], v[88:91], v[40:43], v[160:163]
    s_setprio 0
    v_mul_f32 v190, v190, v15
    ds_read_b64_tr_b16 v[88:89], v92 offset:40960
    buffer_load_dwordx4 v6, s[12:15], s65 offen lds
    v_mul_f32 v191, v191, v15
    v_mfma_f32_16x16x32_bf16 v[192:195], v[76:79], v[40:43], v[192:195]
    s_setprio 1
    ds_read_b64_tr_b16 v[90:91], v92 offset:41984
    s_sub_u32 s65, s65, 229376
    v_mfma_f32_16x16x32_bf16 v[192:195], v[80:83], v[56:59], v[192:195]
    s_setprio 0
    v_mul_f32 v184, v184, v13
    ds_read_b64_tr_b16 v[28:29], v32 offset:34816
    v_mul_f32 v185, v185, v13
    v_mul_f32 v186, v186, v13
    v_mfma_f32_16x16x32_bf16 v[196:199], v[80:83], v[60:63], v[196:199]
    s_setprio 1
    ds_read_b64_tr_b16 v[30:31], v32 offset:35840
    v_mfma_f32_16x16x32_bf16 v[196:199], v[76:79], v[44:47], v[196:199]
    s_setprio 0
    v_mul_f32 v187, v187, v13
    ds_read_b64_tr_b16 v[16:17], v32 offset:40960
    v_mul_f32 v180, v180, v39
    v_mfma_f32_16x16x32_bf16 v[200:203], v[76:79], v[48:51], v[200:203]
    s_setprio 1
    ds_read_b64_tr_b16 v[18:19], v32 offset:41984
    v_mfma_f32_16x16x32_bf16 v[200:203], v[80:83], v[64:67], v[200:203]
    s_setprio 0
    v_mul_f32 v181, v181, v39
    ds_read_b64_tr_b16 v[72:73], v92 offset:36864
    v_mul_f32 v182, v182, v39
    v_mul_f32 v183, v183, v39
    v_mfma_f32_16x16x32_bf16 v[204:207], v[80:83], v[68:71], v[204:207]
    s_setprio 1
    ds_read_b64_tr_b16 v[74:75], v92 offset:37888
    v_mfma_f32_16x16x32_bf16 v[204:207], v[76:79], v[52:55], v[204:207]
    s_setprio 0
    v_mul_f32 v176, v176, v37
    v_mul_f32 v177, v177, v37
    s_waitcnt lgkmcnt(6)
    v_mfma_f32_16x16x32_bf16 v[108:111], v[84:87], v[52:55], 0
    s_setprio 1
    ds_read_b64_tr_b16 v[76:77], v92 offset:43008
    v_mfma_f32_16x16x32_bf16 v[108:111], v[88:91], v[68:71], v[108:111]
    s_setprio 0
    v_mul_f32 v178, v178, v37
    ds_read_b64_tr_b16 v[78:79], v92 offset:44032
    v_mul_f32 v179, v179, v37
    v_mfma_f32_16x16x32_bf16 v[104:107], v[88:91], v[64:67], 0
    s_setprio 1
    v_mfma_f32_16x16x32_bf16 v[104:107], v[84:87], v[48:51], v[104:107]
    s_setprio 0
    v_mul_f32 v208, v208, v37
    v_mul_f32 v209, v209, v37
    v_mul_f32 v210, v210, v37
    v_mfma_f32_16x16x32_bf16 v[100:103], v[84:87], v[44:47], 0
    s_setprio 1
    ds_read_b64_tr_b16 v[80:81], v32 offset:36864
    v_mfma_f32_16x16x32_bf16 v[100:103], v[88:91], v[60:63], v[100:103]
    s_setprio 0
    v_mul_f32 v211, v211, v37
    ds_read_b64_tr_b16 v[82:83], v32 offset:37888
    v_mul_f32 v212, v212, v39
    v_mfma_f32_16x16x32_bf16 v[96:99], v[88:91], v[56:59], 0
    s_setprio 1
    s_mov_b32 m0, 61440
    v_mfma_f32_16x16x32_bf16 v[96:99], v[84:87], v[40:43], v[96:99]
    s_setprio 0
    v_mul_f32 v213, v213, v39
    v_mul_f32 v214, v214, v39
    s_add_u32 s5, s66, 131072
    buffer_load_dwordx4 v4, s[8:11], s5 offen offset:2048 sc1 lds
    v_mul_f32 v215, v215, v39
    s_waitcnt lgkmcnt(6)
    v_mfma_f32_16x16x32_bf16 v[112:115], v[28:31], v[40:43], 0
    s_setprio 1
    ds_read_b64_tr_b16 v[84:85], v32 offset:43008
    v_mfma_f32_16x16x32_bf16 v[112:115], v[16:19], v[56:59], v[112:115]
    s_setprio 0
    v_mul_f32 v216, v216, v13
    ds_read_b64_tr_b16 v[86:87], v32 offset:44032
    v_mul_f32 v217, v217, v13
    v_mfma_f32_16x16x32_bf16 v[116:119], v[16:19], v[60:63], 0
    s_setprio 1
    s_add_u32 m0, s28, 32768
    v_mfma_f32_16x16x32_bf16 v[116:119], v[28:31], v[44:47], v[116:119]
    s_setprio 0
    v_mul_f32 v218, v218, v13
    v_mul_f32 v219, v219, v13
    buffer_load_dwordx4 v4, s[8:11], s64 offen offset:0 sc1 lds
    v_mul_f32 v220, v220, v15
    v_mfma_f32_16x16x32_bf16 v[120:123], v[28:31], v[48:51], 0
    s_setprio 1
    ds_read_b64_tr_b16 v[88:89], v10 offset:14720
    v_mfma_f32_16x16x32_bf16 v[120:123], v[16:19], v[64:67], v[120:123]
    s_setprio 0
    v_mul_f32 v221, v221, v15
    ds_read_b64_tr_b16 v[90:91], v10 offset:18304
    v_mul_f32 v222, v222, v15
    v_mfma_f32_16x16x32_bf16 v[124:127], v[16:19], v[68:71], 0
    s_setprio 1
    v_mfma_f32_16x16x32_bf16 v[124:127], v[28:31], v[52:55], v[124:127]
    s_setprio 0
    v_mul_f32 v223, v223, v15
    s_nop 1
L_loop5:
    s_waitcnt lgkmcnt(6)
    v_mfma_f32_16x16x32_bf16 v[236:239], v[52:55], v[72:75], v[236:239]
    s_setprio 1
    ds_read_b64_tr_b16 v[28:29], v10 offset:22016
    v_mfma_f32_16x16x32_bf16 v[236:239], v[68:71], v[76:79], v[236:239]
    s_setprio 0
    ds_read_b64_tr_b16 v[30:31], v10 offset:25600
    v_mfma_f32_16x16x32_bf16 v[232:235], v[64:67], v[76:79], v[232:235]
    s_setprio 1
    s_add_u32 m0, s28, 32768
    v_mfma_f32_16x16x32_bf16 v[232:235], v[48:51], v[72:75], v[232:235]
    s_setprio 0
    buffer_load_dwordx4 v5, s[8:11], s64 offen offset:1024 sc1 lds
    v_mfma_f32_16x16x32_bf16 v[228:231], v[44:47], v[72:75], v[228:231]
    s_setprio 1
    v_mfma_f32_16x16x32_bf16 v[228:231], v[60:63], v[76:79], v[228:231]
    s_setprio 0
    v_mfma_f32_16x16x32_bf16 v[224:227], v[56:59], v[76:79], v[224:227]
    s_setprio 1
    v_mfma_f32_16x16x32_bf16 v[224:227], v[40:43], v[72:75], v[224:227]
    s_setprio 0
    ds_read_b64_tr_b16 v[72:73], v10 offset:14752
    s_waitcnt lgkmcnt(5)
    v_mfma_f32_16x16x32_bf16 v[240:243], v[40:43], v[80:83], v[240:243]
    s_setprio 1
    ds_read_b64_tr_b16 v[74:75], v10 offset:18336
    v_mfma_f32_16x16x32_bf16 v[240:243], v[56:59], v[84:87], v[240:243]
    s_setprio 0
    ds_read_b64_tr_b16 v[76:77], v10 offset:22048
    v_mfma_f32_16x16x32_bf16 v[244:247], v[60:63], v[84:87], v[244:247]
    s_setprio 1
    ds_read_b64_tr_b16 v[78:79], v10 offset:25632
    s_add_u32 m0, s28, 32768
    v_mfma_f32_16x16x32_bf16 v[244:247], v[44:47], v[80:83], v[244:247]
    s_setprio 0
    buffer_load_dwordx4 v4, s[8:11], s66 offen offset:2048 sc1 lds
    v_mfma_f32_16x16x32_bf16 v[248:251], v[48:51], v[80:83], v[248:251]
    s_setprio 1
    v_mfma_f32_16x16x32_bf16 v[248:251], v[64:67], v[84:87], v[248:251]
    s_setprio 0
    v_mfma_f32_16x16x32_bf16 v[252:255], v[68:71], v[84:87], v[252:255]
    s_setprio 1
    v_mfma_f32_16x16x32_bf16 v[252:255], v[52:55], v[80:83], v[252:255]
    s_setprio 0
    ds_read_b64_tr_b16 v[80:81], v10 offset:14784
    s_waitcnt lgkmcnt(5)
    v_mfma_f32_16x16x32_bf16 v[156:159], v[88:91], v[52:55], v[156:159]
    s_setprio 1
    ds_read_b64_tr_b16 v[82:83], v10 offset:18368
    v_mfma_f32_16x16x32_bf16 v[156:159], v[28:31], v[68:71], v[156:159]
    s_setprio 0
    ds_read_b64_tr_b16 v[84:85], v10 offset:22080
    v_mfma_f32_16x16x32_bf16 v[152:155], v[28:31], v[64:67], v[152:155]
    s_setprio 1
    ds_read_b64_tr_b16 v[86:87], v10 offset:25664
    s_add_u32 m0, s28, 32768
    v_mfma_f32_16x16x32_bf16 v[152:155], v[88:91], v[48:51], v[152:155]
    s_setprio 0
    buffer_load_dwordx4 v5, s[8:11], s66 offen offset:3072 sc1 lds
    v_mfma_f32_16x16x32_bf16 v[148:151], v[88:91], v[44:47], v[148:151]
    s_setprio 1
    s_add_u32 s64, s64, 128
    s_bitset0_b32 s64, 11
    v_mfma_f32_16x16x32_bf16 v[148:151], v[28:31], v[60:63], v[148:151]
    s_setprio 0
    s_add_u32 s66, s64, 30720
    s_waitcnt vmcnt(11) lgkmcnt(0)
    s_barrier
    v_mfma_f32_16x16x32_bf16 v[144:147], v[28:31], v[56:59], v[144:147]
    s_setprio 1
    ds_read_b128 v[12:15], v8 offset:6144
    s_add_u32 m0, s29, 14592
    v_mfma_f32_16x16x32_bf16 v[144:147], v[88:91], v[40:43], v[144:147]
    s_setprio 0
    ds_read_b64_tr_b16 v[88:89], v10 offset:29312
    buffer_load_dwordx4 v6, s[16:19], s65 offen lds
    v_mfma_f32_16x16x32_bf16 v[176:179], v[72:75], v[40:43], v[176:179]
    s_setprio 1
    ds_read_b64_tr_b16 v[90:91], v10 offset:32896
    s_add_u32 s65, s65, 229376
    v_mfma_f32_16x16x32_bf16 v[176:179], v[76:79], v[56:59], v[176:179]
    s_setprio 0
    ds_read_b64_tr_b16 v[28:29], v10 offset:36608
    v_mfma_f32_16x16x32_bf16 v[180:183], v[76:79], v[60:63], v[180:183]
    s_setprio 1
    ds_read_b64_tr_b16 v[30:31], v10 offset:40192
    v_mfma_f32_16x16x32_bf16 v[180:183], v[72:75], v[44:47], v[180:183]
    s_setprio 0
    ds_read_b128 v[36:39], v9 offset:6144
    v_mfma_f32_16x16x32_bf16 v[184:187], v[72:75], v[48:51], v[184:187]
    s_setprio 1
    ds_read_b64_tr_b16 v[16:17], v10 offset:29344
    v_mfma_f32_16x16x32_bf16 v[184:187], v[76:79], v[64:67], v[184:187]
    s_setprio 0
    ds_read_b64_tr_b16 v[18:19], v10 offset:32928
    v_mfma_f32_16x16x32_bf16 v[188:191], v[76:79], v[68:71], v[188:191]
    s_setprio 1
    s_add_u32 m0, s29, 21888
    v_mfma_f32_16x16x32_bf16 v[188:191], v[72:75], v[52:55], v[188:191]
    s_setprio 0
    buffer_load_dwordx4 v6, s[16:19], s65 offen lds
    v_mfma_f32_16x16x32_bf16 v[220:223], v[80:83], v[52:55], v[220:223]
    s_setprio 1
    ds_read_b128 v[52:55], v9 offset:4096
    ds_read_b64_tr_b16 v[72:73], v10 offset:36640
    s_add_u32 s65, s65, 229376
    v_mfma_f32_16x16x32_bf16 v[220:223], v[84:87], v[68:71], v[220:223]
    s_setprio 0
    ds_read_b128 v[68:71], v8 offset:4096
    ds_read_b64_tr_b16 v[74:75], v10 offset:40224
    v_mfma_f32_16x16x32_bf16 v[216:219], v[84:87], v[64:67], v[216:219]
    s_setprio 1
    ds_read_b128 v[64:67], v8 offset:2048
    v_mfma_f32_16x16x32_bf16 v[216:219], v[80:83], v[48:51], v[216:219]
    s_setprio 0
    ds_read_b128 v[48:51], v9 offset:2048
    v_mfma_f32_16x16x32_bf16 v[212:215], v[80:83], v[44:47], v[212:215]
    s_setprio 1
    ds_read_b128 v[44:47], v9 offset:0
    ds_read_b64_tr_b16 v[76:77], v10 offset:29376
    v_mfma_f32_16x16x32_bf16 v[212:215], v[84:87], v[60:63], v[212:215]
    s_setprio 0
    ds_read_b128 v[60:63], v8 offset:0
    ds_read_b64_tr_b16 v[78:79], v10 offset:32960
    v_mfma_f32_16x16x32_bf16 v[208:211], v[84:87], v[56:59], v[208:211]
    s_setprio 1
    s_mov_b32 m0, 136192
    v_mfma_f32_16x16x32_bf16 v[208:211], v[80:83], v[40:43], v[208:211]
    s_setprio 0
    buffer_load_dwordx4 v35, s[76:79], s37 offen  lds
    s_add_u32 s37, s37, 196608
    s_waitcnt lgkmcnt(12)
    v_mfma_f32_16x16x32_bf16 v[140:143], v[88:91], v[12:15], v[140:143]
    s_setprio 1
    ds_read_b64_tr_b16 v[80:81], v10 offset:36672
    v_mfma_f32_16x16x32_bf16 v[140:143], v[28:31], v[36:39], v[140:143]
    s_setprio 0
    ds_read_b64_tr_b16 v[82:83], v10 offset:40256
    s_waitcnt lgkmcnt(9)
    v_mfma_f32_16x16x32_bf16 v[136:139], v[28:31], v[52:55], v[136:139]
    s_setprio 1
    v_mfma_f32_16x16x32_bf16 v[136:139], v[88:91], v[68:71], v[136:139]
    s_setprio 0
    s_waitcnt lgkmcnt(6)
    v_mfma_f32_16x16x32_bf16 v[132:135], v[88:91], v[64:67], v[132:135]
    s_setprio 1
    v_mfma_f32_16x16x32_bf16 v[132:135], v[28:31], v[48:51], v[132:135]
    s_setprio 0
    s_waitcnt lgkmcnt(3)
    v_mfma_f32_16x16x32_bf16 v[128:131], v[28:31], v[44:47], v[128:131]
    s_setprio 1
    s_mov_b32 m0, 142336
    v_mfma_f32_16x16x32_bf16 v[128:131], v[88:91], v[60:63], v[128:131]
    s_setprio 0
    buffer_load_dwordx4 v35, s[76:79], s37 offen  lds
    v_mfma_f32_16x16x32_bf16 v[160:163], v[16:19], v[60:63], v[160:163]
    s_setprio 1
    s_add_u32 s37, s37, 196608
    v_mfma_f32_16x16x32_bf16 v[160:163], v[72:75], v[44:47], v[160:163]
    s_setprio 0
    v_mfma_f32_16x16x32_bf16 v[164:167], v[72:75], v[48:51], v[164:167]
    s_setprio 1
    v_mfma_f32_16x16x32_bf16 v[164:167], v[16:19], v[64:67], v[164:167]
    s_setprio 0
    v_mfma_f32_16x16x32_bf16 v[168:171], v[16:19], v[68:71], v[168:171]
    s_setprio 1
    v_mfma_f32_16x16x32_bf16 v[168:171], v[72:75], v[52:55], v[168:171]
    s_setprio 0
    s_waitcnt vmcnt(11) lgkmcnt(0)
    s_barrier
    v_mfma_f32_16x16x32_bf16 v[172:175], v[72:75], v[36:39], v[172:175]
    s_setprio 1
    ds_read_b64_tr_b16 v[84:85], v92 offset:47104
    s_add_u32 m0, s29, 29184
    v_mfma_f32_16x16x32_bf16 v[172:175], v[16:19], v[12:15], v[172:175]
    s_setprio 0
    ds_read_b64_tr_b16 v[86:87], v92 offset:48128
    buffer_load_dwordx4 v6, s[12:15], s65 offen lds
    v_mfma_f32_16x16x32_bf16 v[204:207], v[76:79], v[12:15], v[204:207]
    s_setprio 1
    ds_read_b64_tr_b16 v[88:89], v92 offset:53248
    s_add_u32 s65, s65, 229376
    v_mfma_f32_16x16x32_bf16 v[204:207], v[80:83], v[36:39], v[204:207]
    s_setprio 0
    ds_read_b64_tr_b16 v[90:91], v92 offset:54272
    v_mfma_f32_16x16x32_bf16 v[200:203], v[80:83], v[52:55], v[200:203]
    s_setprio 1
    ds_read_b64_tr_b16 v[28:29], v32 offset:47104
    v_mfma_f32_16x16x32_bf16 v[200:203], v[76:79], v[68:71], v[200:203]
    s_setprio 0
    ds_read_b64_tr_b16 v[30:31], v32 offset:48128
    v_mfma_f32_16x16x32_bf16 v[196:199], v[76:79], v[64:67], v[196:199]
    s_setprio 1
    ds_read_b64_tr_b16 v[16:17], v32 offset:53248
    v_mfma_f32_16x16x32_bf16 v[196:199], v[80:83], v[48:51], v[196:199]
    s_setprio 0
    ds_read_b64_tr_b16 v[18:19], v32 offset:54272
    v_mfma_f32_16x16x32_bf16 v[192:195], v[80:83], v[44:47], v[192:195]
    s_setprio 1
    ds_read_b64_tr_b16 v[72:73], v92 offset:49152
    s_add_u32 m0, s29, 36480
    v_mfma_f32_16x16x32_bf16 v[192:195], v[76:79], v[60:63], v[192:195]
    s_setprio 0
    ds_read_b64_tr_b16 v[74:75], v92 offset:50176
    buffer_load_dwordx4 v6, s[12:15], s65 offen lds
    s_waitcnt lgkmcnt(6)
    v_mfma_f32_16x16x32_bf16 v[96:99], v[84:87], v[60:63], v[96:99]
    s_setprio 1
    ds_read_b64_tr_b16 v[76:77], v92 offset:55296
    s_sub_u32 s65, s65, 229376
    v_mfma_f32_16x16x32_bf16 v[96:99], v[88:91], v[44:47], v[96:99]
    s_setprio 0
    ds_read_b64_tr_b16 v[78:79], v92 offset:56320
    v_mfma_f32_16x16x32_bf16 v[100:103], v[88:91], v[48:51], v[100:103]
    s_setprio 1
    v_mfma_f32_16x16x32_bf16 v[100:103], v[84:87], v[64:67], v[100:103]
    s_setprio 0
    v_mfma_f32_16x16x32_bf16 v[104:107], v[84:87], v[68:71], v[104:107]
    s_setprio 1
    ds_read_b64_tr_b16 v[80:81], v32 offset:49152
    v_mfma_f32_16x16x32_bf16 v[104:107], v[88:91], v[52:55], v[104:107]
    s_setprio 0
    ds_read_b64_tr_b16 v[82:83], v32 offset:50176
    v_mfma_f32_16x16x32_bf16 v[108:111], v[88:91], v[36:39], v[108:111]
    s_setprio 1
    s_mov_b32 m0, 28672
    v_mfma_f32_16x16x32_bf16 v[108:111], v[84:87], v[12:15], v[108:111]
    s_setprio 0
    s_add_u32 s5, s66, 131072
    buffer_load_dwordx4 v4, s[8:11], s5 offen offset:2048 sc1 lds
    s_waitcnt lgkmcnt(6)
    v_mfma_f32_16x16x32_bf16 v[124:127], v[28:31], v[12:15], v[124:127]
    s_setprio 1
    ds_read_b64_tr_b16 v[84:85], v32 offset:55296
    v_mfma_f32_16x16x32_bf16 v[124:127], v[16:19], v[36:39], v[124:127]
    s_setprio 0
    ds_read_b64_tr_b16 v[86:87], v32 offset:56320
    v_mfma_f32_16x16x32_bf16 v[120:123], v[16:19], v[52:55], v[120:123]
    s_setprio 1
    s_add_u32 m0, s28, 0
    v_mfma_f32_16x16x32_bf16 v[120:123], v[28:31], v[68:71], v[120:123]
    s_setprio 0
    buffer_load_dwordx4 v4, s[8:11], s64 offen offset:0 sc1 lds
    v_mfma_f32_16x16x32_bf16 v[116:119], v[28:31], v[64:67], v[116:119]
    s_setprio 1
    ds_read_b64_tr_b16 v[88:89], v10 offset:43904
    v_mfma_f32_16x16x32_bf16 v[116:119], v[16:19], v[48:51], v[116:119]
    s_setprio 0
    ds_read_b64_tr_b16 v[90:91], v10 offset:47488
    v_mfma_f32_16x16x32_bf16 v[112:115], v[16:19], v[44:47], v[112:115]
    s_setprio 1
    v_mfma_f32_16x16x32_bf16 v[112:115], v[28:31], v[60:63], v[112:115]
    s_setprio 0
    s_waitcnt lgkmcnt(6)
    v_mfma_f32_16x16x32_bf16 v[224:227], v[60:63], v[72:75], v[224:227]
    s_setprio 1
    ds_read_b64_tr_b16 v[28:29], v10 offset:51200
    v_mfma_f32_16x16x32_bf16 v[224:227], v[44:47], v[76:79], v[224:227]
    s_setprio 0
    ds_read_b64_tr_b16 v[30:31], v10 offset:54784
    v_mfma_f32_16x16x32_bf16 v[228:231], v[48:51], v[76:79], v[228:231]
    s_setprio 1
    s_add_u32 m0, s28, 0
    v_mfma_f32_16x16x32_bf16 v[228:231], v[64:67], v[72:75], v[228:231]
    s_setprio 0
    buffer_load_dwordx4 v5, s[8:11], s64 offen offset:1024 sc1 lds
    v_mfma_f32_16x16x32_bf16 v[232:235], v[68:71], v[72:75], v[232:235]
    s_setprio 1
    v_mfma_f32_16x16x32_bf16 v[232:235], v[52:55], v[76:79], v[232:235]
    s_setprio 0
    v_mfma_f32_16x16x32_bf16 v[236:239], v[36:39], v[76:79], v[236:239]
    s_setprio 1
    v_mfma_f32_16x16x32_bf16 v[236:239], v[12:15], v[72:75], v[236:239]
    s_setprio 0
    ds_read_b64_tr_b16 v[72:73], v10 offset:43936
    s_waitcnt lgkmcnt(5)
    v_mfma_f32_16x16x32_bf16 v[252:255], v[12:15], v[80:83], v[252:255]
    s_setprio 1
    ds_read_b64_tr_b16 v[74:75], v10 offset:47520
    v_mfma_f32_16x16x32_bf16 v[252:255], v[36:39], v[84:87], v[252:255]
    s_setprio 0
    ds_read_b64_tr_b16 v[76:77], v10 offset:51232
    v_mfma_f32_16x16x32_bf16 v[248:251], v[52:55], v[84:87], v[248:251]
    s_setprio 1
    ds_read_b64_tr_b16 v[78:79], v10 offset:54816
    s_add_u32 m0, s28, 0
    v_mfma_f32_16x16x32_bf16 v[248:251], v[68:71], v[80:83], v[248:251]
    s_setprio 0
    buffer_load_dwordx4 v4, s[8:11], s66 offen offset:2048 sc1 lds
    v_mfma_f32_16x16x32_bf16 v[244:247], v[64:67], v[80:83], v[244:247]
    s_setprio 1
    v_mfma_f32_16x16x32_bf16 v[244:247], v[48:51], v[84:87], v[244:247]
    s_setprio 0
    v_mfma_f32_16x16x32_bf16 v[240:243], v[44:47], v[84:87], v[240:243]
    s_setprio 1
    v_mfma_f32_16x16x32_bf16 v[240:243], v[60:63], v[80:83], v[240:243]
    s_setprio 0
    ds_read_b64_tr_b16 v[80:81], v10 offset:43968
    s_waitcnt lgkmcnt(5)
    v_mfma_f32_16x16x32_bf16 v[144:147], v[88:91], v[60:63], v[144:147]
    s_setprio 1
    ds_read_b64_tr_b16 v[82:83], v10 offset:47552
    v_mfma_f32_16x16x32_bf16 v[144:147], v[28:31], v[44:47], v[144:147]
    s_setprio 0
    ds_read_b64_tr_b16 v[84:85], v10 offset:51264
    v_mfma_f32_16x16x32_bf16 v[148:151], v[28:31], v[48:51], v[148:151]
    s_setprio 1
    ds_read_b64_tr_b16 v[86:87], v10 offset:54848
    s_add_u32 m0, s28, 0
    v_mfma_f32_16x16x32_bf16 v[148:151], v[88:91], v[64:67], v[148:151]
    s_setprio 0
    buffer_load_dwordx4 v5, s[8:11], s66 offen offset:3072 sc1 lds
    v_mfma_f32_16x16x32_bf16 v[152:155], v[88:91], v[68:71], v[152:155]
    s_setprio 1
    s_add_u32 s64, s64, 128
    s_bitset0_b32 s64, 11
    v_mfma_f32_16x16x32_bf16 v[152:155], v[28:31], v[52:55], v[152:155]
    s_setprio 0
    s_add_u32 s66, s64, 30720
    s_waitcnt vmcnt(11) lgkmcnt(0)
    s_barrier
    v_mfma_f32_16x16x32_bf16 v[156:159], v[28:31], v[36:39], v[156:159]
    s_setprio 1
    ds_read_b128 v[40:43], v8 offset:32768
    s_add_u32 m0, s29, 43776
    v_mfma_f32_16x16x32_bf16 v[156:159], v[88:91], v[12:15], v[156:159]
    s_setprio 0
    ds_read_b64_tr_b16 v[88:89], v10 offset:128
    buffer_load_dwordx4 v6, s[16:19], s65 offen lds
    v_mfma_f32_16x16x32_bf16 v[188:191], v[72:75], v[12:15], v[188:191]
    s_setprio 1
    ds_read_b64_tr_b16 v[90:91], v10 offset:3712
    s_add_u32 s65, s65, 229376
    v_mfma_f32_16x16x32_bf16 v[188:191], v[76:79], v[36:39], v[188:191]
    s_setprio 0
    ds_read_b64_tr_b16 v[28:29], v10 offset:7424
    v_mfma_f32_16x16x32_bf16 v[184:187], v[76:79], v[52:55], v[184:187]
    s_setprio 1
    ds_read_b64_tr_b16 v[30:31], v10 offset:11008
    v_mfma_f32_16x16x32_bf16 v[184:187], v[72:75], v[68:71], v[184:187]
    s_setprio 0
    ds_read_b128 v[56:59], v9 offset:32768
    v_mfma_f32_16x16x32_bf16 v[180:183], v[72:75], v[64:67], v[180:183]
    s_setprio 1
    ds_read_b64_tr_b16 v[16:17], v10 offset:160
    v_mfma_f32_16x16x32_bf16 v[180:183], v[76:79], v[48:51], v[180:183]
    s_setprio 0
    ds_read_b64_tr_b16 v[18:19], v10 offset:3744
    v_mfma_f32_16x16x32_bf16 v[176:179], v[76:79], v[44:47], v[176:179]
    s_setprio 1
    s_add_u32 m0, s29, 51072
    v_mfma_f32_16x16x32_bf16 v[176:179], v[72:75], v[60:63], v[176:179]
    s_setprio 0
    buffer_load_dwordx4 v6, s[16:19], s65 offen lds
    v_mfma_f32_16x16x32_bf16 v[208:211], v[80:83], v[60:63], v[208:211]
    s_setprio 1
    ds_read_b128 v[60:63], v9 offset:34816
    ds_read_b64_tr_b16 v[72:73], v10 offset:7456
    s_add_u32 s65, s65, 229376
    v_mfma_f32_16x16x32_bf16 v[208:211], v[84:87], v[44:47], v[208:211]
    s_setprio 0
    ds_read_b128 v[44:47], v8 offset:34816
    ds_read_b64_tr_b16 v[74:75], v10 offset:11040
    v_mfma_f32_16x16x32_bf16 v[212:215], v[84:87], v[48:51], v[212:215]
    s_setprio 1
    ds_read_b128 v[48:51], v8 offset:36864
    v_mfma_f32_16x16x32_bf16 v[212:215], v[80:83], v[64:67], v[212:215]
    s_setprio 0
    ds_read_b128 v[64:67], v9 offset:36864
    v_mfma_f32_16x16x32_bf16 v[216:219], v[80:83], v[68:71], v[216:219]
    s_setprio 1
    ds_read_b128 v[68:71], v9 offset:38912
    ds_read_b64_tr_b16 v[76:77], v10 offset:192
    v_mfma_f32_16x16x32_bf16 v[216:219], v[84:87], v[52:55], v[216:219]
    s_setprio 0
    ds_read_b128 v[52:55], v8 offset:38912
    ds_read_b64_tr_b16 v[78:79], v10 offset:3776
    v_mfma_f32_16x16x32_bf16 v[220:223], v[84:87], v[36:39], v[220:223]
    s_setprio 1
    s_mov_b32 m0, 148480
    v_mfma_f32_16x16x32_bf16 v[220:223], v[80:83], v[12:15], v[220:223]
    s_setprio 0
    buffer_load_dwordx4 v35, s[76:79], s37 offen  lds
    s_add_u32 s37, s37, 196608
    s_waitcnt lgkmcnt(12)
    v_mfma_f32_16x16x32_bf16 v[128:131], v[88:91], v[40:43], v[128:131]
    s_setprio 1
    ds_read_b64_tr_b16 v[80:81], v10 offset:7488
    v_mfma_f32_16x16x32_bf16 v[128:131], v[28:31], v[56:59], v[128:131]
    s_setprio 0
    ds_read_b64_tr_b16 v[82:83], v10 offset:11072
    s_waitcnt lgkmcnt(9)
    v_mfma_f32_16x16x32_bf16 v[132:135], v[28:31], v[60:63], v[132:135]
    s_setprio 1
    v_mfma_f32_16x16x32_bf16 v[132:135], v[88:91], v[44:47], v[132:135]
    s_setprio 0
    s_bitcmp1_b32 0x10, s36
    s_cbranch_scc1 L_h5p3_2
L_r5p3_2:
    s_waitcnt lgkmcnt(6)
    v_mfma_f32_16x16x32_bf16 v[136:139], v[88:91], v[48:51], v[136:139]
    s_setprio 1
    v_mfma_f32_16x16x32_bf16 v[136:139], v[28:31], v[64:67], v[136:139]
    s_setprio 0
    s_waitcnt lgkmcnt(3)
    v_mfma_f32_16x16x32_bf16 v[140:143], v[28:31], v[68:71], v[140:143]
    s_setprio 1
    s_mov_b32 m0, 154624
    v_mfma_f32_16x16x32_bf16 v[140:143], v[88:91], v[52:55], v[140:143]
    s_setprio 0
    buffer_load_dwordx4 v35, s[76:79], s37 offen  lds
    v_mfma_f32_16x16x32_bf16 v[172:175], v[16:19], v[52:55], v[172:175]
    s_setprio 1
    s_add_u32 s37, s37, 196608
    v_mfma_f32_16x16x32_bf16 v[172:175], v[72:75], v[68:71], v[172:175]
    s_setprio 0
    v_mfma_f32_16x16x32_bf16 v[168:171], v[72:75], v[64:67], v[168:171]
    s_setprio 1
    v_mfma_f32_16x16x32_bf16 v[168:171], v[16:19], v[48:51], v[168:171]
    s_setprio 0
    v_mfma_f32_16x16x32_bf16 v[164:167], v[16:19], v[44:47], v[164:167]
    s_setprio 1
    v_mfma_f32_16x16x32_bf16 v[164:167], v[72:75], v[60:63], v[164:167]
    s_setprio 0
    s_waitcnt vmcnt(11) lgkmcnt(0)
    s_barrier
    v_mfma_f32_16x16x32_bf16 v[160:163], v[72:75], v[56:59], v[160:163]
    s_setprio 1
    ds_read_b64_tr_b16 v[84:85], v92 offset:34816
    s_add_u32 m0, s29, 0
    v_mfma_f32_16x16x32_bf16 v[160:163], v[16:19], v[40:43], v[160:163]
    s_setprio 0
    ds_read_b64_tr_b16 v[86:87], v92 offset:35840
    buffer_load_dwordx4 v6, s[12:15], s65 offen lds
    v_mfma_f32_16x16x32_bf16 v[192:195], v[76:79], v[40:43], v[192:195]
    s_setprio 1
    ds_read_b64_tr_b16 v[88:89], v92 offset:40960
    s_add_u32 s65, s65, 229376
    v_mfma_f32_16x16x32_bf16 v[192:195], v[80:83], v[56:59], v[192:195]
    s_setprio 0
    ds_read_b64_tr_b16 v[90:91], v92 offset:41984
    v_mfma_f32_16x16x32_bf16 v[196:199], v[80:83], v[60:63], v[196:199]
    s_setprio 1
    ds_read_b64_tr_b16 v[28:29], v32 offset:34816
    v_mfma_f32_16x16x32_bf16 v[196:199], v[76:79], v[44:47], v[196:199]
    s_setprio 0
    ds_read_b64_tr_b16 v[30:31], v32 offset:35840
    v_mfma_f32_16x16x32_bf16 v[200:203], v[76:79], v[48:51], v[200:203]
    s_setprio 1
    ds_read_b64_tr_b16 v[16:17], v32 offset:40960
    v_mfma_f32_16x16x32_bf16 v[200:203], v[80:83], v[64:67], v[200:203]
    s_setprio 0
    ds_read_b64_tr_b16 v[18:19], v32 offset:41984
    v_mfma_f32_16x16x32_bf16 v[204:207], v[80:83], v[68:71], v[204:207]
    s_setprio 1
    ds_read_b64_tr_b16 v[72:73], v92 offset:36864
    s_add_u32 m0, s29, 7296
    v_mfma_f32_16x16x32_bf16 v[204:207], v[76:79], v[52:55], v[204:207]
    s_setprio 0
    ds_read_b64_tr_b16 v[74:75], v92 offset:37888
    buffer_load_dwordx4 v6, s[12:15], s65 offen lds
    s_waitcnt lgkmcnt(6)
    v_mfma_f32_16x16x32_bf16 v[108:111], v[84:87], v[52:55], v[108:111]
    s_setprio 1
    ds_read_b64_tr_b16 v[76:77], v92 offset:43008
    s_sub_u32 s65, s65, 229376
    v_mfma_f32_16x16x32_bf16 v[108:111], v[88:91], v[68:71], v[108:111]
    s_setprio 0
    ds_read_b64_tr_b16 v[78:79], v92 offset:44032
    v_mfma_f32_16x16x32_bf16 v[104:107], v[88:91], v[64:67], v[104:107]
    s_setprio 1
    v_mfma_f32_16x16x32_bf16 v[104:107], v[84:87], v[48:51], v[104:107]
    s_setprio 0
    v_mfma_f32_16x16x32_bf16 v[100:103], v[84:87], v[44:47], v[100:103]
    s_setprio 1
    ds_read_b64_tr_b16 v[80:81], v32 offset:36864
    v_mfma_f32_16x16x32_bf16 v[100:103], v[88:91], v[60:63], v[100:103]
    s_setprio 0
    ds_read_b64_tr_b16 v[82:83], v32 offset:37888
    v_mfma_f32_16x16x32_bf16 v[96:99], v[88:91], v[56:59], v[96:99]
    s_setprio 1
    s_mov_b32 m0, 61440
    v_mfma_f32_16x16x32_bf16 v[96:99], v[84:87], v[40:43], v[96:99]
    s_setprio 0
    s_add_u32 s5, s66, 131072
    buffer_load_dwordx4 v4, s[8:11], s5 offen offset:2048 sc1 lds
    s_waitcnt lgkmcnt(6)
    v_mfma_f32_16x16x32_bf16 v[112:115], v[28:31], v[40:43], v[112:115]
    s_setprio 1
    ds_read_b64_tr_b16 v[84:85], v32 offset:43008
    v_mfma_f32_16x16x32_bf16 v[112:115], v[16:19], v[56:59], v[112:115]
    s_setprio 0
    ds_read_b64_tr_b16 v[86:87], v32 offset:44032
    v_mfma_f32_16x16x32_bf16 v[116:119], v[16:19], v[60:63], v[116:119]
    s_setprio 1
    s_add_u32 m0, s28, 32768
    v_mfma_f32_16x16x32_bf16 v[116:119], v[28:31], v[44:47], v[116:119]
    s_setprio 0
    buffer_load_dwordx4 v4, s[8:11], s64 offen offset:0 sc1 lds
    v_mfma_f32_16x16x32_bf16 v[120:123], v[28:31], v[48:51], v[120:123]
    s_setprio 1
    ds_read_b64_tr_b16 v[88:89], v10 offset:14720
    v_mfma_f32_16x16x32_bf16 v[120:123], v[16:19], v[64:67], v[120:123]
    s_setprio 0
    ds_read_b64_tr_b16 v[90:91], v10 offset:18304
    v_mfma_f32_16x16x32_bf16 v[124:127], v[16:19], v[68:71], v[124:127]
    s_setprio 1
    v_mfma_f32_16x16x32_bf16 v[124:127], v[28:31], v[52:55], v[124:127]
    s_setprio 0
    s_add_u32 s36, s36, 1
    s_cmp_lt_u32 s36, 5
    s_cbranch_scc1 L_loop5
    s_mov_b32 s80, 1206272
    s_mov_b32 s81, 1183744
    s_mov_b32 s82, 1208320
    s_mov_b32 s29, 113664
    s_mov_b32 s37, 28672
    s_mov_b32 s83, 136192
    s_branch L_pb1
L_w6:
    s_barrier
    s_add_u32 m0, s28, 0
    s_nop 0
    buffer_load_dwordx4 v4, s[8:11], s64 offen offset:0 sc1 lds
    buffer_load_dwordx4 v5, s[8:11], s64 offen offset:1024 sc1 lds
    buffer_load_dwordx4 v4, s[8:11], s66 offen offset:2048 sc1 lds
    buffer_load_dwordx4 v5, s[8:11], s66 offen offset:3072 sc1 lds
    s_add_u32 s64, s64, 128
    s_bitset0_b32 s64, 11
    s_add_u32 s66, s64, 30720
    s_add_u32 m0, s29, 0
    s_nop 0
    buffer_load_dwordx4 v6, s[12:15], s65 offen lds
    s_add_u32 s65, s65, 229376
    s_add_u32 m0, s29, 7296
    s_nop 0
    buffer_load_dwordx4 v6, s[12:15], s65 offen lds
    s_sub_u32 s65, s65, 229376
    s_add_u32 m0, s29, 14592
    s_nop 0
    buffer_load_dwordx4 v6, s[16:19], s65 offen lds
    s_add_u32 s65, s65, 229376
    s_add_u32 m0, s29, 21888
    s_nop 0
    buffer_load_dwordx4 v6, s[16:19], s65 offen lds
    s_add_u32 s65, s65, 229376
    s_waitcnt vmcnt(9)
    v_lshlrev_b32 v112, 16, v104
    v_and_b32 v113, 0xffff0000, v104
    v_lshlrev_b32 v114, 16, v105
    v_and_b32 v115, 0xffff0000, v105
    v_lshlrev_b32 v116, 16, v106
    v_and_b32 v117, 0xffff0000, v106
    v_lshlrev_b32 v118, 16, v107
    v_and_b32 v119, 0xffff0000, v107
    v_lshlrev_b32 v120, 16, v108
    v_and_b32 v121, 0xffff0000, v108
    v_lshlrev_b32 v122, 16, v109
    v_and_b32 v123, 0xffff0000, v109
    v_lshlrev_b32 v124, 16, v110
    v_and_b32 v125, 0xffff0000, v110
    v_lshlrev_b32 v126, 16, v111
    v_and_b32 v127, 0xffff0000, v111
    v_add_f32 v36, v112, v116
    v_add_f32 v37, v113, v117
    v_add_f32 v38, v114, v118
    v_add_f32 v39, v115, v119
    v_add_f32 v36, v36, v120
    v_add_f32 v37, v37, v121
    v_add_f32 v38, v38, v122
    v_add_f32 v39, v39, v123
    v_add_f32 v36, v36, v124
    v_add_f32 v37, v37, v125
    v_add_f32 v38, v38, v126
    v_add_f32 v39, v39, v127
    v_add_f32 v36, v36, v37
    v_add_f32 v38, v38, v39
    v_add_f32 v34, v36, v38
    s_nop 1
    v_add_f32_dpp v34, v34, v34 row_ror:8 row_mask:0xf bank_mask:0xf
    s_nop 1
    v_add_f32_dpp v34, v34, v34 row_ror:4 row_mask:0xf bank_mask:0xf
    s_nop 1
    v_add_f32_dpp v34, v34, v34 row_ror:2 row_mask:0xf bank_mask:0xf
    s_nop 1
    v_add_f32_dpp v34, v34, v34 row_ror:1 row_mask:0xf bank_mask:0xf
    v_mov_b32 v36, v34
    s_nop 1
    v_permlane16_swap_b32 v34, v36
    v_add_f32 v34, v34, v36
    v_mov_b32 v36, v34
    s_nop 1
    v_permlane32_swap_b32 v34, v36
    v_add_f32 v34, v34, v36
    v_mul_f32 v34, 0x3a800000, v34
    v_cvt_pk_bf16_f32 v14, v34, v34
    v_and_b32 v14, 0xffff0000, v14
    v_sub_f32 v112, v112, v14
    v_sub_f32 v113, v113, v14
    v_sub_f32 v114, v114, v14
    v_sub_f32 v115, v115, v14
    v_sub_f32 v116, v116, v14
    v_sub_f32 v117, v117, v14
    v_sub_f32 v118, v118, v14
    v_sub_f32 v119, v119, v14
    v_sub_f32 v120, v120, v14
    v_sub_f32 v121, v121, v14
    v_sub_f32 v122, v122, v14
    v_sub_f32 v123, v123, v14
    v_sub_f32 v124, v124, v14
    v_sub_f32 v125, v125, v14
    v_sub_f32 v126, v126, v14
    v_sub_f32 v127, v127, v14
    v_mul_f32 v36, v112, v112
    v_mul_f32 v37, v113, v113
    v_mul_f32 v38, v114, v114
    v_mul_f32 v39, v115, v115
    v_fmac_f32 v36, v116, v116
    v_fmac_f32 v37, v117, v117
    v_fmac_f32 v38, v118, v118
    v_fmac_f32 v39, v119, v119
    v_fmac_f32 v36, v120, v120
    v_fmac_f32 v37, v121, v121
    v_fmac_f32 v38, v122, v122
    v_fmac_f32 v39, v123, v123
    v_fmac_f32 v36, v124, v124
    v_fmac_f32 v37, v125, v125
    v_fmac_f32 v38, v126, v126
    v_fmac_f32 v39, v127, v127
    v_add_f32 v36, v36, v37
    v_add_f32 v38, v38, v39
    v_sub_f32 v34, v34, v14
    v_add_f32 v12, v36, v38
    s_nop 1
    v_add_f32_dpp v12, v12, v12 row_ror:8 row_mask:0xf bank_mask:0xf
    v_cvt_pk_bf16_f32 v104, v112, v113
    s_nop 0
    v_add_f32_dpp v12, v12, v12 row_ror:4 row_mask:0xf bank_mask:0xf
    v_cvt_pk_bf16_f32 v105, v114, v115
    s_nop 0
    v_add_f32_dpp v12, v12, v12 row_ror:2 row_mask:0xf bank_mask:0xf
    v_cvt_pk_bf16_f32 v106, v116, v117
    s_nop 0
    v_add_f32_dpp v12, v12, v12 row_ror:1 row_mask:0xf bank_mask:0xf
    v_cvt_pk_bf16_f32 v107, v118, v119
    v_mov_b32 v36, v12
    v_cvt_pk_bf16_f32 v108, v120, v121
    s_nop 0
    v_permlane16_swap_b32 v12, v36
    v_cvt_pk_bf16_f32 v109, v122, v123
    v_add_f32 v12, v12, v36
    v_cvt_pk_bf16_f32 v110, v124, v125
    v_mov_b32 v36, v12
    v_cvt_pk_bf16_f32 v111, v126, v127
    s_nop 0
    v_permlane32_swap_b32 v12, v36
    v_lshlrev_b32 v112, 16, v104
    v_add_f32 v12, v12, v36
    v_and_b32 v113, 0xffff0000, v104
    v_mul_f32 v12, 0x3a800000, v12
    v_lshlrev_b32 v114, 16, v105
    v_fma_f32 v12, -v34, v34, v12
    v_and_b32 v115, 0xffff0000, v105
    v_max_f32 v12, 0, v12
    v_lshlrev_b32 v116, 16, v106
    v_cvt_pk_bf16_f32 v12, v12, v12
    v_and_b32 v117, 0xffff0000, v106
    v_and_b32 v12, 0xffff0000, v12
    v_lshlrev_b32 v118, 16, v107
    v_add_f32 v12, 0x3727c5ac, v12
    v_and_b32 v119, 0xffff0000, v107
    v_cvt_pk_bf16_f32 v12, v12, v12
    v_lshlrev_b32 v120, 16, v108
    v_and_b32 v12, 0xffff0000, v12
    v_and_b32 v121, 0xffff0000, v108
    v_sqrt_f32 v15, v12
    v_lshlrev_b32 v122, 16, v109
    v_cvt_pk_bf16_f32 v15, v15, v15
    v_and_b32 v123, 0xffff0000, v109
    v_and_b32 v15, 0xffff0000, v15
    v_lshlrev_b32 v124, 16, v110
    v_rcp_f32 v12, v15
    v_and_b32 v125, 0xffff0000, v110
    v_sub_f32 v14, 0, v14
    v_lshlrev_b32 v126, 16, v111
    v_and_b32 v127, 0xffff0000, v111
    v_mul_f32 v112, v112, v12
    v_mul_f32 v113, v113, v12
    v_mul_f32 v114, v114, v12
    v_mul_f32 v115, v115, v12
    v_mul_f32 v116, v116, v12
    v_mul_f32 v117, v117, v12
    v_mul_f32 v118, v118, v12
    v_mul_f32 v119, v119, v12
    v_mul_f32 v120, v120, v12
    v_mul_f32 v121, v121, v12
    v_mul_f32 v122, v122, v12
    v_mul_f32 v123, v123, v12
    v_mul_f32 v124, v124, v12
    v_mul_f32 v125, v125, v12
    v_mul_f32 v126, v126, v12
    v_mul_f32 v127, v127, v12
    v_cvt_pk_bf16_f32 v104, v112, v113
    v_cvt_pk_bf16_f32 v105, v114, v115
    v_cvt_pk_bf16_f32 v106, v116, v117
    v_cvt_pk_bf16_f32 v107, v118, v119
    v_cvt_pk_bf16_f32 v108, v120, v121
    v_cvt_pk_bf16_f32 v109, v122, v123
    v_cvt_pk_bf16_f32 v110, v124, v125
    v_cvt_pk_bf16_f32 v111, v126, v127
    buffer_store_dwordx4 v[104:107], v2, s[20:23], s3 offen offset:0 sc1
    buffer_store_dwordx4 v[108:111], v2, s[20:23], s3 offen offset:1024 sc1
    v_lshrrev_b32 v14, 16, v14
    v_or_b32 v14, v14, v15
    s_waitcnt vmcnt(10)
    s_mov_b32 s5, 0x9E3779B1
    v_mul_lo_u32 v33, v33, s5
    v_add_u32 v33, 0x7F4A7C15, v33
    s_nop 0
    v_readfirstlane_b32 s58, v33
    v_mov_b32 v15, v33
    s_waitcnt vmcnt(4)
    s_barrier
    ds_read_b128 v[40:43], v8 offset:0
    ds_read_b64_tr_b16 v[88:89], v10 offset:128
    ds_read_b64_tr_b16 v[90:91], v10 offset:3712
    ds_read_b128 v[56:59], v9 offset:0
    ds_read_b64_tr_b16 v[72:73], v10 offset:7424
    ds_read_b64_tr_b16 v[74:75], v10 offset:11008
    ds_read_b128 v[60:63], v9 offset:2048
    ds_read_b128 v[44:47], v8 offset:2048
    ds_read_b128 v[48:51], v8 offset:4096
    ds_read_b128 v[64:67], v9 offset:4096
    ds_read_b128 v[68:71], v9 offset:6144
    ds_read_b128 v[52:55], v8 offset:6144
    ds_read_b64_tr_b16 v[76:77], v10 offset:160
    ds_read_b64_tr_b16 v[78:79], v10 offset:3744
    ds_read_b64_tr_b16 v[80:81], v10 offset:7456
    ds_read_b64_tr_b16 v[82:83], v10 offset:11040
    s_waitcnt lgkmcnt(10)
    v_mfma_f32_16x16x32_bf16 v[128:131], v[88:91], v[40:43], 0
    s_setprio 1
    ds_read_b64_tr_b16 v[84:85], v10 offset:192
    s_add_u32 m0, s28, 32768
    v_mfma_f32_16x16x32_bf16 v[128:131], v[72:75], v[56:59], v[128:131]
    s_setprio 0
    ds_read_b64_tr_b16 v[86:87], v10 offset:3776
    buffer_load_dwordx4 v4, s[8:11], s64 offen offset:0 sc1 lds
    s_waitcnt lgkmcnt(10)
    v_mfma_f32_16x16x32_bf16 v[132:135], v[72:75], v[60:63], 0
    s_setprio 1
    s_add_u32 m0, s28, 32768
    v_mfma_f32_16x16x32_bf16 v[132:135], v[88:91], v[44:47], v[132:135]
    s_setprio 0
    buffer_load_dwordx4 v5, s[8:11], s64 offen offset:1024 sc1 lds
    s_waitcnt lgkmcnt(8)
    v_mfma_f32_16x16x32_bf16 v[136:139], v[88:91], v[48:51], 0
    s_setprio 1
    s_add_u32 m0, s28, 32768
    v_mfma_f32_16x16x32_bf16 v[136:139], v[72:75], v[64:67], v[136:139]
    s_setprio 0
    buffer_load_dwordx4 v4, s[8:11], s66 offen offset:2048 sc1 lds
    s_waitcnt lgkmcnt(6)
    v_mfma_f32_16x16x32_bf16 v[140:143], v[72:75], v[68:71], 0
    s_setprio 1
    s_add_u32 m0, s28, 32768
    v_mfma_f32_16x16x32_bf16 v[140:143], v[88:91], v[52:55], v[140:143]
    s_setprio 0
    ds_read_b64_tr_b16 v[88:89], v10 offset:7488
    buffer_load_dwordx4 v5, s[8:11], s66 offen offset:3072 sc1 lds
    s_waitcnt lgkmcnt(3)
    v_mfma_f32_16x16x32_bf16 v[172:175], v[76:79], v[52:55], 0
    s_setprio 1
    ds_read_b64_tr_b16 v[90:91], v10 offset:11072
    s_add_u32 s64, s64, 128
    s_bitset0_b32 s64, 11
    s_add_u32 m0, s29, 29184
    v_mfma_f32_16x16x32_bf16 v[172:175], v[80:83], v[68:71], v[172:175]
    s_setprio 0
    s_add_u32 s66, s64, 30720
    buffer_load_dwordx4 v6, s[12:15], s65 offen lds
    s_waitcnt vmcnt(7) lgkmcnt(0)
    s_barrier
    v_mfma_f32_16x16x32_bf16 v[168:171], v[80:83], v[64:67], 0
    s_setprio 1
    ds_read_b64_tr_b16 v[72:73], v10 offset:14720
    s_add_u32 s65, s65, 229376
    s_add_u32 m0, s29, 36480
    v_mfma_f32_16x16x32_bf16 v[168:171], v[76:79], v[48:51], v[168:171]
    s_setprio 0
    ds_read_b64_tr_b16 v[74:75], v10 offset:18304
    buffer_load_dwordx4 v6, s[12:15], s65 offen lds
    v_mfma_f32_16x16x32_bf16 v[164:167], v[76:79], v[44:47], 0
    s_setprio 1
    s_sub_u32 s65, s65, 229376
    s_add_u32 m0, s29, 43776
    v_mfma_f32_16x16x32_bf16 v[164:167], v[80:83], v[60:63], v[164:167]
    s_setprio 0
    buffer_load_dwordx4 v6, s[16:19], s65 offen lds
    v_mfma_f32_16x16x32_bf16 v[160:163], v[80:83], v[56:59], 0
    s_setprio 1
    s_add_u32 s65, s65, 229376
    s_add_u32 m0, s29, 51072
    v_mfma_f32_16x16x32_bf16 v[160:163], v[76:79], v[40:43], v[160:163]
    s_setprio 0
    ds_read_b64_tr_b16 v[76:77], v10 offset:22016
    buffer_load_dwordx4 v6, s[16:19], s65 offen lds
    v_mfma_f32_16x16x32_bf16 v[192:195], v[84:87], v[40:43], 0
    s_setprio 1
    ds_read_b64_tr_b16 v[78:79], v10 offset:25600
    s_add_u32 s65, s65, 229376
    s_add_u32 m0, s29, 0
    v_mfma_f32_16x16x32_bf16 v[192:195], v[88:91], v[56:59], v[192:195]
    s_setprio 0
    ds_read_b64_tr_b16 v[80:81], v10 offset:14752
    buffer_load_dwordx4 v6, s[12:15], s65 offen lds
    v_mfma_f32_16x16x32_bf16 v[196:199], v[88:91], v[60:63], 0
    s_setprio 1
    ds_read_b64_tr_b16 v[82:83], v10 offset:18336
    s_add_u32 s65, s65, 229376
    s_add_u32 m0, s29, 7296
    v_mfma_f32_16x16x32_bf16 v[196:199], v[84:87], v[44:47], v[196:199]
    s_setprio 0
    v_mfma_f32_16x16x32_bf16 v[16:19], v[28:31], v[84:87], 0
    v_mfma_f32_16x16x32_bf16 v[16:19], v[28:31], v[88:91], v[16:19]
    buffer_load_dwordx4 v6, s[12:15], s65 offen lds
    v_mfma_f32_16x16x32_bf16 v[200:203], v[84:87], v[48:51], 0
    s_setprio 1
    s_sub_u32 s65, s65, 229376
    s_add_u32 m0, s28, 123904
    v_mfma_f32_16x16x32_bf16 v[200:203], v[88:91], v[64:67], v[200:203]
    s_setprio 0
    buffer_load_dwordx4 v4, s[8:11], s64 offen offset:0 sc1 lds
    v_mfma_f32_16x16x32_bf16 v[204:207], v[88:91], v[68:71], 0
    s_setprio 1
    s_add_u32 m0, s28, 123904
    v_mfma_f32_16x16x32_bf16 v[204:207], v[84:87], v[52:55], v[204:207]
    s_setprio 0
    ds_read_b64_tr_b16 v[84:85], v10 offset:22048
    buffer_load_dwordx4 v5, s[8:11], s64 offen offset:1024 sc1 lds
    s_waitcnt lgkmcnt(3)
    v_mfma_f32_16x16x32_bf16 v[156:159], v[72:75], v[52:55], 0
    s_setprio 1
    ds_read_b64_tr_b16 v[86:87], v10 offset:25632
    s_add_u32 m0, s28, 123904
    v_mfma_f32_16x16x32_bf16 v[156:159], v[76:79], v[68:71], v[156:159]
    s_setprio 0
    ds_read_b64_tr_b16 v[88:89], v10 offset:14784
    buffer_load_dwordx4 v4, s[8:11], s66 offen offset:2048 sc1 lds
    v_mfma_f32_16x16x32_bf16 v[152:155], v[76:79], v[64:67], 0
    s_setprio 1
    ds_read_b64_tr_b16 v[90:91], v10 offset:18368
    s_add_u32 m0, s28, 123904
    v_mfma_f32_16x16x32_bf16 v[152:155], v[72:75], v[48:51], v[152:155]
    s_setprio 0
    buffer_load_dwordx4 v5, s[8:11], s66 offen offset:3072 sc1 lds
    v_mfma_f32_16x16x32_bf16 v[148:151], v[72:75], v[44:47], 0
    s_setprio 1
    s_add_u32 s64, s64, 128
    s_bitset0_b32 s64, 11
    v_mfma_f32_16x16x32_bf16 v[148:151], v[76:79], v[60:63], v[148:151]
    s_setprio 0
    s_add_u32 s66, s64, 30720
    v_mfma_f32_16x16x32_bf16 v[144:147], v[76:79], v[56:59], 0
    s_setprio 1
    v_mfma_f32_16x16x32_bf16 v[144:147], v[72:75], v[40:43], v[144:147]
    s_setprio 0
    s_waitcnt vmcnt(14)
    s_lshr_b32 s3, s3, 8
    s_add_u32 s3, s3, 3211264
    s_mov_b64 exec, 1
    buffer_store_dwordx2 v[14:15], off, s[24:27], s3 sc1
    s_mov_b64 exec, -1
    ds_read_b64_tr_b16 v[72:73], v10 offset:22080
    s_waitcnt lgkmcnt(3)
    v_mfma_f32_16x16x32_bf16 v[176:179], v[80:83], v[40:43], 0
    s_setprio 1
    ds_read_b64_tr_b16 v[74:75], v10 offset:25664
    v_mfma_f32_16x16x32_bf16 v[176:179], v[84:87], v[56:59], v[176:179]
    s_setprio 0
    s_waitcnt vmcnt(9) lgkmcnt(0)
    s_barrier
    s_add_u32 m0, s29, 14592
    v_mfma_f32_16x16x32_bf16 v[180:183], v[84:87], v[60:63], 0
    s_setprio 1
    ds_read_b64_tr_b16 v[76:77], v10 offset:29312
    v_mfma_f32_16x16x32_bf16 v[180:183], v[80:83], v[44:47], v[180:183]
    s_setprio 0
    buffer_load_dwordx4 v6, s[16:19], s65 offen lds
    s_add_u32 s65, s65, 229376
    ds_read_b64_tr_b16 v[78:79], v10 offset:32896
    s_add_u32 m0, s29, 21888
    v_mfma_f32_16x16x32_bf16 v[184:187], v[80:83], v[48:51], 0
    s_setprio 1
    v_mfma_f32_16x16x32_bf16 v[184:187], v[84:87], v[64:67], v[184:187]
    s_setprio 0
    buffer_load_dwordx4 v6, s[16:19], s65 offen lds
    s_add_u32 s65, s65, 229376
    s_mov_b32 m0, 28672
    v_mfma_f32_16x16x32_bf16 v[188:191], v[84:87], v[68:71], 0
    s_setprio 1
    v_mfma_f32_16x16x32_bf16 v[188:191], v[80:83], v[52:55], v[188:191]
    s_setprio 0
    s_add_u32 s5, s66, 65536
    buffer_load_dwordx4 v5, s[8:11], s5 offen offset:3072 sc1 lds
    ds_read_b64_tr_b16 v[80:81], v10 offset:36608
    s_add_u32 m0, s28, 0
    v_mfma_f32_16x16x32_bf16 v[220:223], v[88:91], v[52:55], 0
    s_setprio 1
    ds_read_b128 v[52:55], v8 offset:38912
    ds_read_b64_tr_b16 v[82:83], v10 offset:40192
    v_mfma_f32_16x16x32_bf16 v[220:223], v[72:75], v[68:71], v[220:223]
    s_setprio 0
    buffer_load_dwordx4 v4, s[8:11], s64 offen offset:0 sc1 lds
    ds_read_b128 v[68:71], v9 offset:38912
    ds_read_b64_tr_b16 v[84:85], v10 offset:29344
    s_add_u32 m0, s28, 0
    v_mfma_f32_16x16x32_bf16 v[216:219], v[72:75], v[64:67], 0
    s_setprio 1
    ds_read_b128 v[64:67], v9 offset:36864
    ds_read_b64_tr_b16 v[86:87], v10 offset:32928
    v_mfma_f32_16x16x32_bf16 v[216:219], v[88:91], v[48:51], v[216:219]
    s_setprio 0
    v_mfma_f32_16x16x32_bf16 v[20:23], v[28:31], v[88:91], 0
    v_mfma_f32_16x16x32_bf16 v[20:23], v[28:31], v[72:75], v[20:23]
    buffer_load_dwordx4 v5, s[8:11], s64 offen offset:1024 sc1 lds
    ds_read_b128 v[48:51], v8 offset:36864
    s_add_u32 m0, s28, 0
    v_mfma_f32_16x16x32_bf16 v[212:215], v[88:91], v[44:47], 0
    s_setprio 1
    ds_read_b128 v[44:47], v8 offset:34816
    v_mfma_f32_16x16x32_bf16 v[212:215], v[72:75], v[60:63], v[212:215]
    s_setprio 0
    buffer_load_dwordx4 v4, s[8:11], s66 offen offset:2048 sc1 lds
    ds_read_b128 v[60:63], v9 offset:34816
    s_add_u32 m0, s28, 0
    v_mfma_f32_16x16x32_bf16 v[208:211], v[72:75], v[56:59], 0
    s_setprio 1
    ds_read_b128 v[56:59], v9 offset:32768
    v_mfma_f32_16x16x32_bf16 v[208:211], v[88:91], v[40:43], v[208:211]
    s_setprio 0
    buffer_load_dwordx4 v5, s[8:11], s66 offen offset:3072 sc1 lds
    s_add_u32 s64, s64, 128
    s_bitset0_b32 s64, 11
    s_add_u32 s66, s64, 30720
    ds_read_b128 v[40:43], v8 offset:32768
    ds_read_b64_tr_b16 v[88:89], v10 offset:36640
    s_waitcnt lgkmcnt(9)
    v_mfma_f32_16x16x32_bf16 v[140:143], v[76:79], v[52:55], v[140:143]
    s_setprio 1
    ds_read_b64_tr_b16 v[90:91], v10 offset:40224
    v_mfma_f32_16x16x32_bf16 v[140:143], v[80:83], v[68:71], v[140:143]
    s_setprio 0
    ds_read_b64_tr_b16 v[72:73], v10 offset:29376
    s_waitcnt lgkmcnt(7)
    v_mfma_f32_16x16x32_bf16 v[136:139], v[80:83], v[64:67], v[136:139]
    s_setprio 1
    ds_read_b64_tr_b16 v[74:75], v10 offset:32960
    v_mfma_f32_16x16x32_bf16 v[136:139], v[76:79], v[48:51], v[136:139]
    s_setprio 0
    s_waitcnt lgkmcnt(6)
    v_mfma_f32_16x16x32_bf16 v[132:135], v[76:79], v[44:47], v[132:135]
    s_setprio 1
    v_mfma_f32_16x16x32_bf16 v[132:135], v[80:83], v[60:63], v[132:135]
    s_setprio 0
    s_waitcnt lgkmcnt(4)
    v_mfma_f32_16x16x32_bf16 v[128:131], v[80:83], v[56:59], v[128:131]
    s_setprio 1
    v_mfma_f32_16x16x32_bf16 v[128:131], v[76:79], v[40:43], v[128:131]
    s_setprio 0
    ds_read_b64_tr_b16 v[76:77], v10 offset:36672
    s_waitcnt lgkmcnt(3)
    v_mfma_f32_16x16x32_bf16 v[160:163], v[84:87], v[40:43], v[160:163]
    s_setprio 1
    ds_read_b64_tr_b16 v[78:79], v10 offset:40256
    v_mfma_f32_16x16x32_bf16 v[160:163], v[88:91], v[56:59], v[160:163]
    s_setprio 0
    s_waitcnt vmcnt(14) lgkmcnt(0)
    s_barrier
    v_mfma_f32_16x16x32_bf16 v[164:167], v[88:91], v[60:63], v[164:167]
    s_setprio 1
    ds_read_b64_tr_b16 v[80:81], v10 offset:43904
    s_add_u32 m0, s29, 29184
    v_mfma_f32_16x16x32_bf16 v[164:167], v[84:87], v[44:47], v[164:167]
    s_setprio 0
    ds_read_b64_tr_b16 v[82:83], v10 offset:47488
    buffer_load_dwordx4 v6, s[12:15], s65 offen lds
    v_mfma_f32_16x16x32_bf16 v[168:171], v[84:87], v[48:51], v[168:171]
    s_setprio 1
    s_add_u32 s65, s65, 229376
    v_mfma_f32_16x16x32_bf16 v[168:171], v[88:91], v[64:67], v[168:171]
    s_setprio 0
    v_mfma_f32_16x16x32_bf16 v[172:175], v[88:91], v[68:71], v[172:175]
    s_setprio 1
    s_add_u32 m0, s29, 36480
    v_mfma_f32_16x16x32_bf16 v[172:175], v[84:87], v[52:55], v[172:175]
    s_setprio 0
    ds_read_b64_tr_b16 v[84:85], v10 offset:51200
    buffer_load_dwordx4 v6, s[12:15], s65 offen lds
    v_mfma_f32_16x16x32_bf16 v[204:207], v[72:75], v[52:55], v[204:207]
    s_setprio 1
    ds_read_b64_tr_b16 v[86:87], v10 offset:54784
    s_sub_u32 s65, s65, 229376
    v_mfma_f32_16x16x32_bf16 v[204:207], v[76:79], v[68:71], v[204:207]
    s_setprio 0
    ds_read_b64_tr_b16 v[88:89], v10 offset:43936
    v_mfma_f32_16x16x32_bf16 v[200:203], v[76:79], v[64:67], v[200:203]
    s_setprio 1
    ds_read_b64_tr_b16 v[90:91], v10 offset:47520
    v_mfma_f32_16x16x32_bf16 v[200:203], v[72:75], v[48:51], v[200:203]
    s_setprio 0
    v_mfma_f32_16x16x32_bf16 v[16:19], v[28:31], v[72:75], v[16:19]
    v_mfma_f32_16x16x32_bf16 v[16:19], v[28:31], v[76:79], v[16:19]
    v_mfma_f32_16x16x32_bf16 v[196:199], v[72:75], v[44:47], v[196:199]
    s_setprio 1
    v_mfma_f32_16x16x32_bf16 v[196:199], v[76:79], v[60:63], v[196:199]
    s_setprio 0
    v_mfma_f32_16x16x32_bf16 v[192:195], v[76:79], v[56:59], v[192:195]
    s_setprio 1
    v_mfma_f32_16x16x32_bf16 v[192:195], v[72:75], v[40:43], v[192:195]
    s_setprio 0
    ds_read_b64_tr_b16 v[72:73], v10 offset:51232
    s_waitcnt lgkmcnt(3)
    v_mfma_f32_16x16x32_bf16 v[144:147], v[80:83], v[40:43], v[144:147]
    s_setprio 1
    ds_read_b64_tr_b16 v[74:75], v10 offset:54816
    v_mfma_f32_16x16x32_bf16 v[144:147], v[84:87], v[56:59], v[144:147]
    s_setprio 0
    ds_read_b64_tr_b16 v[76:77], v10 offset:43968
    v_mfma_f32_16x16x32_bf16 v[148:151], v[84:87], v[60:63], v[148:151]
    s_setprio 1
    ds_read_b64_tr_b16 v[78:79], v10 offset:47552
    v_mfma_f32_16x16x32_bf16 v[148:151], v[80:83], v[44:47], v[148:151]
    s_setprio 0
    v_mfma_f32_16x16x32_bf16 v[152:155], v[80:83], v[48:51], v[152:155]
    s_setprio 1
    v_mfma_f32_16x16x32_bf16 v[152:155], v[84:87], v[64:67], v[152:155]
    s_setprio 0
    v_mfma_f32_16x16x32_bf16 v[156:159], v[84:87], v[68:71], v[156:159]
    s_setprio 1
    v_mfma_f32_16x16x32_bf16 v[156:159], v[80:83], v[52:55], v[156:159]
    s_setprio 0
    ds_read_b64_tr_b16 v[80:81], v10 offset:51264
    s_waitcnt lgkmcnt(3)
    v_mfma_f32_16x16x32_bf16 v[188:191], v[88:91], v[52:55], v[188:191]
    s_setprio 1
    ds_read_b64_tr_b16 v[82:83], v10 offset:54848
    v_mfma_f32_16x16x32_bf16 v[188:191], v[72:75], v[68:71], v[188:191]
    s_setprio 0
    s_waitcnt vmcnt(10) lgkmcnt(0)
    s_barrier
    v_mfma_f32_16x16x32_bf16 v[184:187], v[72:75], v[64:67], v[184:187]
    s_setprio 1
    ds_read_b64_tr_b16 v[84:85], v10 offset:128
    s_add_u32 m0, s29, 43776
    v_mfma_f32_16x16x32_bf16 v[184:187], v[88:91], v[48:51], v[184:187]
    s_setprio 0
    ds_read_b64_tr_b16 v[86:87], v10 offset:3712
    buffer_load_dwordx4 v6, s[16:19], s65 offen lds
    v_mfma_f32_16x16x32_bf16 v[180:183], v[88:91], v[44:47], v[180:183]
    s_setprio 1
    s_add_u32 s65, s65, 229376
    v_mfma_f32_16x16x32_bf16 v[180:183], v[72:75], v[60:63], v[180:183]
    s_setprio 0
    v_mfma_f32_16x16x32_bf16 v[176:179], v[72:75], v[56:59], v[176:179]
    s_setprio 1
    s_add_u32 m0, s29, 51072
    v_mfma_f32_16x16x32_bf16 v[176:179], v[88:91], v[40:43], v[176:179]
    s_setprio 0
    ds_read_b64_tr_b16 v[88:89], v10 offset:7424
    buffer_load_dwordx4 v6, s[16:19], s65 offen lds
    v_mfma_f32_16x16x32_bf16 v[208:211], v[76:79], v[40:43], v[208:211]
    s_setprio 1
    ds_read_b128 v[40:43], v94 offset:0
    ds_read_b64_tr_b16 v[90:91], v10 offset:11008
    s_add_u32 s65, s65, 229376
    v_mfma_f32_16x16x32_bf16 v[208:211], v[80:83], v[56:59], v[208:211]
    s_setprio 0
    ds_read_b128 v[56:59], v95 offset:0
    ds_read_b64_tr_b16 v[72:73], v10 offset:160
    v_mfma_f32_16x16x32_bf16 v[212:215], v[80:83], v[60:63], v[212:215]
    s_setprio 1
    ds_read_b128 v[60:63], v95 offset:2048
    ds_read_b64_tr_b16 v[74:75], v10 offset:3744
    v_mfma_f32_16x16x32_bf16 v[212:215], v[76:79], v[44:47], v[212:215]
    s_setprio 0
    ds_read_b128 v[44:47], v94 offset:2048
    v_mfma_f32_16x16x32_bf16 v[20:23], v[28:31], v[76:79], v[20:23]
    v_mfma_f32_16x16x32_bf16 v[20:23], v[28:31], v[80:83], v[20:23]
    v_mfma_f32_16x16x32_bf16 v[216:219], v[76:79], v[48:51], v[216:219]
    s_setprio 1
    ds_read_b128 v[48:51], v94 offset:4096
    v_mfma_f32_16x16x32_bf16 v[216:219], v[80:83], v[64:67], v[216:219]
    s_setprio 0
    ds_read_b128 v[64:67], v95 offset:4096
    v_mfma_f32_16x16x32_bf16 v[220:223], v[80:83], v[68:71], v[220:223]
    s_setprio 1
    ds_read_b128 v[68:71], v95 offset:6144
    v_mfma_f32_16x16x32_bf16 v[220:223], v[76:79], v[52:55], v[220:223]
    s_setprio 0
    ds_read_b128 v[52:55], v94 offset:6144
    ds_read_b64_tr_b16 v[76:77], v10 offset:7456
    s_waitcnt lgkmcnt(9)
    v_mfma_f32_16x16x32_bf16 v[128:131], v[84:87], v[40:43], v[128:131]
    s_setprio 1
    ds_read_b64_tr_b16 v[78:79], v10 offset:11040
    v_mfma_f32_16x16x32_bf16 v[128:131], v[88:91], v[56:59], v[128:131]
    s_setprio 0
    ds_read_b64_tr_b16 v[80:81], v10 offset:192
    s_waitcnt lgkmcnt(7)
    v_mfma_f32_16x16x32_bf16 v[132:135], v[88:91], v[60:63], v[132:135]
    s_setprio 1
    ds_read_b64_tr_b16 v[82:83], v10 offset:3776
    v_mfma_f32_16x16x32_bf16 v[132:135], v[84:87], v[44:47], v[132:135]
    s_setprio 0
    s_waitcnt lgkmcnt(6)
    v_mfma_f32_16x16x32_bf16 v[136:139], v[84:87], v[48:51], v[136:139]
    s_setprio 1
    v_mfma_f32_16x16x32_bf16 v[136:139], v[88:91], v[64:67], v[136:139]
    s_setprio 0
    s_waitcnt lgkmcnt(4)
    v_mfma_f32_16x16x32_bf16 v[140:143], v[88:91], v[68:71], v[140:143]
    s_setprio 1
    v_mfma_f32_16x16x32_bf16 v[140:143], v[84:87], v[52:55], v[140:143]
    s_setprio 0
    ds_read_b64_tr_b16 v[84:85], v10 offset:7488
    s_waitcnt lgkmcnt(3)
    v_mfma_f32_16x16x32_bf16 v[172:175], v[72:75], v[52:55], v[172:175]
    s_setprio 1
    ds_read_b64_tr_b16 v[86:87], v10 offset:11072
    v_mfma_f32_16x16x32_bf16 v[172:175], v[76:79], v[68:71], v[172:175]
    s_setprio 0
    s_waitcnt vmcnt(9) lgkmcnt(0)
    s_barrier
    v_mfma_f32_16x16x32_bf16 v[168:171], v[76:79], v[64:67], v[168:171]
    s_setprio 1
    ds_read_b64_tr_b16 v[88:89], v10 offset:14720
    s_add_u32 m0, s29, 0
    v_mfma_f32_16x16x32_bf16 v[168:171], v[72:75], v[48:51], v[168:171]
    s_setprio 0
    s_mov_b64 s[8:9], s[56:57]
    v_mov_b32 v236, 0
    ds_read_b64_tr_b16 v[90:91], v10 offset:18304
    buffer_load_dwordx4 v6, s[12:15], s65 offen lds
    v_mov_b32 v237, 0
    v_mfma_f32_16x16x32_bf16 v[164:167], v[72:75], v[44:47], v[164:167]
    s_setprio 1
    s_add_u32 s65, s65, 229376
    v_mfma_f32_16x16x32_bf16 v[164:167], v[76:79], v[60:63], v[164:167]
    s_setprio 0
    v_mov_b32 v238, 0
    v_mfma_f32_16x16x32_bf16 v[160:163], v[76:79], v[56:59], v[160:163]
    s_setprio 1
    s_add_u32 m0, s29, 7296
    v_mfma_f32_16x16x32_bf16 v[160:163], v[72:75], v[40:43], v[160:163]
    s_setprio 0
    ds_read_b64_tr_b16 v[72:73], v10 offset:22016
    buffer_load_dwordx4 v6, s[12:15], s65 offen lds
    v_mov_b32 v239, 0
    v_mfma_f32_16x16x32_bf16 v[192:195], v[80:83], v[40:43], v[192:195]
    s_setprio 1
    ds_read_b64_tr_b16 v[74:75], v10 offset:25600
    s_sub_u32 s65, s65, 229376
    v_mfma_f32_16x16x32_bf16 v[192:195], v[84:87], v[56:59], v[192:195]
    s_setprio 0
    ds_read_b64_tr_b16 v[76:77], v10 offset:14752
    v_mov_b32 v232, 0
    v_mfma_f32_16x16x32_bf16 v[196:199], v[84:87], v[60:63], v[196:199]
    s_setprio 1
    ds_read_b64_tr_b16 v[78:79], v10 offset:18336
    s_mov_b32 m0, 61440
    v_mfma_f32_16x16x32_bf16 v[196:199], v[80:83], v[44:47], v[196:199]
    s_setprio 0
    v_mfma_f32_16x16x32_bf16 v[16:19], v[28:31], v[80:83], v[16:19]
    v_mfma_f32_16x16x32_bf16 v[16:19], v[28:31], v[84:87], v[16:19]
    s_add_u32 s5, s66, 65536
    buffer_load_dwordx4 v5, s[8:11], s5 offen offset:3072 sc1 lds
    v_mov_b32 v233, 0
    v_mfma_f32_16x16x32_bf16 v[200:203], v[80:83], v[48:51], v[200:203]
    s_setprio 1
    v_mfma_f32_16x16x32_bf16 v[200:203], v[84:87], v[64:67], v[200:203]
    s_setprio 0
    v_mov_b32 v234, 0
    v_mfma_f32_16x16x32_bf16 v[204:207], v[84:87], v[68:71], v[204:207]
    s_setprio 1
    s_add_u32 m0, s28, 32768
    v_mfma_f32_16x16x32_bf16 v[204:207], v[80:83], v[52:55], v[204:207]
    s_setprio 0
    ds_read_b64_tr_b16 v[80:81], v10 offset:22048
    buffer_load_dwordx4 v4, s[8:11], s64 offen offset:0 sc1 lds
    v_mov_b32 v235, 0
    s_waitcnt lgkmcnt(3)
    v_mfma_f32_16x16x32_bf16 v[156:159], v[88:91], v[52:55], v[156:159]
    s_setprio 1
    ds_read_b64_tr_b16 v[82:83], v10 offset:25632
    v_mfma_f32_16x16x32_bf16 v[156:159], v[72:75], v[68:71], v[156:159]
    s_setprio 0
    ds_read_b64_tr_b16 v[84:85], v10 offset:14784
    v_mov_b32 v228, 0
    v_mfma_f32_16x16x32_bf16 v[152:155], v[72:75], v[64:67], v[152:155]
    s_setprio 1
    ds_read_b64_tr_b16 v[86:87], v10 offset:18368
    s_add_u32 m0, s28, 32768
    v_mfma_f32_16x16x32_bf16 v[152:155], v[88:91], v[48:51], v[152:155]
    s_setprio 0
    buffer_load_dwordx4 v5, s[8:11], s64 offen offset:1024 sc1 lds
    v_mov_b32 v229, 0
    v_mfma_f32_16x16x32_bf16 v[148:151], v[88:91], v[44:47], v[148:151]
    s_setprio 1
    v_mfma_f32_16x16x32_bf16 v[148:151], v[72:75], v[60:63], v[148:151]
    s_setprio 0
    v_mov_b32 v230, 0
    v_mfma_f32_16x16x32_bf16 v[144:147], v[72:75], v[56:59], v[144:147]
    s_setprio 1
    s_add_u32 m0, s28, 32768
    v_mfma_f32_16x16x32_bf16 v[144:147], v[88:91], v[40:43], v[144:147]
    s_setprio 0
    ds_read_b64_tr_b16 v[88:89], v10 offset:22080
    buffer_load_dwordx4 v4, s[8:11], s66 offen offset:2048 sc1 lds
    v_mov_b32 v231, 0
    s_waitcnt lgkmcnt(3)
    v_mfma_f32_16x16x32_bf16 v[176:179], v[76:79], v[40:43], v[176:179]
    s_setprio 1
    ds_read_b64_tr_b16 v[90:91], v10 offset:25664
    s_add_u32 m0, s28, 32768
    v_mfma_f32_16x16x32_bf16 v[176:179], v[80:83], v[56:59], v[176:179]
    s_setprio 0
    buffer_load_dwordx4 v5, s[8:11], s66 offen offset:3072 sc1 lds
    v_mov_b32 v224, 0
    s_waitcnt vmcnt(9) lgkmcnt(0)
    s_barrier
    v_mfma_f32_16x16x32_bf16 v[180:183], v[80:83], v[60:63], v[180:183]
    s_setprio 1
    ds_read_b64_tr_b16 v[72:73], v10 offset:29312
    s_add_u32 s64, s64, 128
    s_bitset0_b32 s64, 11
    s_add_u32 m0, s29, 14592
    v_mfma_f32_16x16x32_bf16 v[180:183], v[76:79], v[44:47], v[180:183]
    s_setprio 0
    s_add_u32 s66, s64, 30720
    ds_read_b64_tr_b16 v[74:75], v10 offset:32896
    buffer_load_dwordx4 v6, s[16:19], s65 offen lds
    v_mov_b32 v225, 0
    v_mfma_f32_16x16x32_bf16 v[184:187], v[76:79], v[48:51], v[184:187]
    s_setprio 1
    s_add_u32 s65, s65, 229376
    v_mfma_f32_16x16x32_bf16 v[184:187], v[80:83], v[64:67], v[184:187]
    s_setprio 0
    v_mov_b32 v226, 0
    v_mfma_f32_16x16x32_bf16 v[188:191], v[80:83], v[68:71], v[188:191]
    s_setprio 1
    s_add_u32 m0, s29, 21888
    v_mfma_f32_16x16x32_bf16 v[188:191], v[76:79], v[52:55], v[188:191]
    s_setprio 0
    ds_read_b64_tr_b16 v[76:77], v10 offset:36608
    buffer_load_dwordx4 v6, s[16:19], s65 offen lds
    v_mov_b32 v227, 0
    v_mfma_f32_16x16x32_bf16 v[220:223], v[84:87], v[52:55], v[220:223]
    s_setprio 1
    ds_read_b128 v[52:55], v8 offset:6144
    ds_read_b64_tr_b16 v[78:79], v10 offset:40192
    s_add_u32 s65, s65, 229376
    v_mfma_f32_16x16x32_bf16 v[220:223], v[88:91], v[68:71], v[220:223]
    s_setprio 0
    ds_read_b128 v[68:71], v9 offset:6144
    ds_read_b64_tr_b16 v[80:81], v10 offset:29344
    v_mov_b32 v240, 0
    v_mfma_f32_16x16x32_bf16 v[216:219], v[88:91], v[64:67], v[216:219]
    s_setprio 1
    ds_read_b128 v[64:67], v9 offset:4096
    ds_read_b64_tr_b16 v[82:83], v10 offset:32928
    v_mfma_f32_16x16x32_bf16 v[216:219], v[84:87], v[48:51], v[216:219]
    s_setprio 0
    v_mfma_f32_16x16x32_bf16 v[20:23], v[28:31], v[84:87], v[20:23]
    v_mfma_f32_16x16x32_bf16 v[20:23], v[28:31], v[88:91], v[20:23]
    v_mov_b32 v241, 0
    ds_read_b128 v[48:51], v8 offset:4096
    v_mfma_f32_16x16x32_bf16 v[212:215], v[84:87], v[44:47], v[212:215]
    s_setprio 1
    ds_read_b128 v[44:47], v8 offset:2048
    v_mfma_f32_16x16x32_bf16 v[212:215], v[88:91], v[60:63], v[212:215]
    s_setprio 0
    v_mov_b32 v242, 0
    ds_read_b128 v[60:63], v9 offset:2048
    v_mfma_f32_16x16x32_bf16 v[208:211], v[88:91], v[56:59], v[208:211]
    s_setprio 1
    ds_read_b128 v[56:59], v9 offset:0
    v_mfma_f32_16x16x32_bf16 v[208:211], v[84:87], v[40:43], v[208:211]
    s_setprio 0
    v_mov_b32 v243, 0
    ds_read_b128 v[40:43], v8 offset:0
    ds_read_b64_tr_b16 v[84:85], v10 offset:36640
    s_waitcnt lgkmcnt(9)
    v_mfma_f32_16x16x32_bf16 v[140:143], v[72:75], v[52:55], v[140:143]
    s_setprio 1
    ds_read_b64_tr_b16 v[86:87], v10 offset:40224
    v_mfma_f32_16x16x32_bf16 v[140:143], v[76:79], v[68:71], v[140:143]
    s_setprio 0
    v_mov_b32 v244, 0
    ds_read_b64_tr_b16 v[88:89], v10 offset:29376
    s_waitcnt lgkmcnt(7)
    v_mfma_f32_16x16x32_bf16 v[136:139], v[76:79], v[64:67], v[136:139]
    s_setprio 1
    ds_read_b64_tr_b16 v[90:91], v10 offset:32960
    v_mfma_f32_16x16x32_bf16 v[136:139], v[72:75], v[48:51], v[136:139]
    s_setprio 0
    v_mov_b32 v245, 0
    s_waitcnt lgkmcnt(6)
    v_mfma_f32_16x16x32_bf16 v[132:135], v[72:75], v[44:47], v[132:135]
    s_setprio 1
    v_mfma_f32_16x16x32_bf16 v[132:135], v[76:79], v[60:63], v[132:135]
    s_setprio 0
    v_mov_b32 v246, 0
    s_waitcnt lgkmcnt(4)
    v_mfma_f32_16x16x32_bf16 v[128:131], v[76:79], v[56:59], v[128:131]
    s_setprio 1
    v_mfma_f32_16x16x32_bf16 v[128:131], v[72:75], v[40:43], v[128:131]
    s_setprio 0
    v_mov_b32 v247, 0
    ds_read_b64_tr_b16 v[72:73], v10 offset:36672
    s_waitcnt lgkmcnt(3)
    v_mfma_f32_16x16x32_bf16 v[160:163], v[80:83], v[40:43], v[160:163]
    s_setprio 1
    ds_read_b64_tr_b16 v[74:75], v10 offset:40256
    v_mfma_f32_16x16x32_bf16 v[160:163], v[84:87], v[56:59], v[160:163]
    s_setprio 0
    v_mov_b32 v248, 0
    s_waitcnt vmcnt(9) lgkmcnt(0)
    s_barrier
    v_mfma_f32_16x16x32_bf16 v[164:167], v[84:87], v[60:63], v[164:167]
    s_setprio 1
    ds_read_b64_tr_b16 v[76:77], v10 offset:43904
    s_add_u32 m0, s29, 29184
    v_mfma_f32_16x16x32_bf16 v[164:167], v[80:83], v[44:47], v[164:167]
    s_setprio 0
    v_mov_b32 v249, 0
    ds_read_b64_tr_b16 v[78:79], v10 offset:47488
    buffer_load_dwordx4 v6, s[12:15], s65 offen lds
    ds_read_b64 v[36:37], v26 offset:0
    v_mfma_f32_16x16x32_bf16 v[168:171], v[80:83], v[48:51], v[168:171]
    s_setprio 1
    ds_read_b64 v[38:39], v26 offset:128
    s_add_u32 s65, s65, 229376
    v_mfma_f32_16x16x32_bf16 v[168:171], v[84:87], v[64:67], v[168:171]
    s_setprio 0
    v_mov_b32 v250, 0
    ds_read_b64 v[12:13], v26 offset:256
    v_mfma_f32_16x16x32_bf16 v[172:175], v[84:87], v[68:71], v[172:175]
    s_setprio 1
    ds_read_b64 v[14:15], v26 offset:384
    s_add_u32 m0, s29, 36480
    v_mfma_f32_16x16x32_bf16 v[172:175], v[80:83], v[52:55], v[172:175]
    s_setprio 0
    v_mov_b32 v251, 0
    ds_read_b64_tr_b16 v[80:81], v10 offset:51200
    buffer_load_dwordx4 v6, s[12:15], s65 offen lds
    v_mfma_f32_16x16x32_bf16 v[204:207], v[88:91], v[52:55], v[204:207]
    s_setprio 1
    ds_read_b64_tr_b16 v[82:83], v10 offset:54784
    s_sub_u32 s65, s65, 229376
    v_mfma_f32_16x16x32_bf16 v[204:207], v[72:75], v[68:71], v[204:207]
    s_setprio 0
    v_mov_b32 v252, 0
    ds_read_b64_tr_b16 v[84:85], v10 offset:43936
    v_mfma_f32_16x16x32_bf16 v[200:203], v[72:75], v[64:67], v[200:203]
    s_setprio 1
    ds_read_b64_tr_b16 v[86:87], v10 offset:47520
    s_mov_b32 m0, 28672
    v_mfma_f32_16x16x32_bf16 v[200:203], v[88:91], v[48:51], v[200:203]
    s_setprio 0
    v_mfma_f32_16x16x32_bf16 v[16:19], v[28:31], v[88:91], v[16:19]
    v_mfma_f32_16x16x32_bf16 v[16:19], v[28:31], v[72:75], v[16:19]
    v_mov_b32 v253, 0
    s_add_u32 s5, s66, 65536
    buffer_load_dwordx4 v5, s[8:11], s5 offen offset:3072 sc1 lds
    v_mfma_f32_16x16x32_bf16 v[196:199], v[88:91], v[44:47], v[196:199]
    s_setprio 1
    v_mfma_f32_16x16x32_bf16 v[196:199], v[72:75], v[60:63], v[196:199]
    s_setprio 0
    v_mov_b32 v254, 0
    v_mfma_f32_16x16x32_bf16 v[192:195], v[72:75], v[56:59], v[192:195]
    s_setprio 1
    s_add_u32 m0, s28, 0
    v_mfma_f32_16x16x32_bf16 v[192:195], v[88:91], v[40:43], v[192:195]
    s_setprio 0
    v_mov_b32 v255, 0
    ds_read_b64_tr_b16 v[88:89], v10 offset:51232
    buffer_load_dwordx4 v4, s[8:11], s64 offen offset:0 sc1 lds
    s_waitcnt lgkmcnt(3)
    v_mfma_f32_16x16x32_bf16 v[144:147], v[76:79], v[40:43], v[144:147]
    s_setprio 1
    ds_read_b64_tr_b16 v[90:91], v10 offset:54816
    v_mfma_f32_16x16x32_bf16 v[144:147], v[80:83], v[56:59], v[144:147]
    s_setprio 0
    ds_read_b64_tr_b16 v[72:73], v10 offset:43968
    v_mfma_f32_16x16x32_bf16 v[148:151], v[80:83], v[60:63], v[148:151]
    s_setprio 1
    ds_read_b64_tr_b16 v[74:75], v10 offset:47552
    s_add_u32 m0, s28, 0
    v_mfma_f32_16x16x32_bf16 v[148:151], v[76:79], v[44:47], v[148:151]
    s_setprio 0
    buffer_load_dwordx4 v5, s[8:11], s64 offen offset:1024 sc1 lds
    v_mul_f32 v140, v140, v15
    v_mul_f32 v141, v141, v15
    v_mul_f32 v142, v142, v15
    v_mfma_f32_16x16x32_bf16 v[152:155], v[76:79], v[48:51], v[152:155]
    s_setprio 1
    v_mfma_f32_16x16x32_bf16 v[152:155], v[80:83], v[64:67], v[152:155]
    s_setprio 0
    v_mul_f32 v143, v143, v15
    v_mul_f32 v136, v136, v13
    v_mul_f32 v137, v137, v13
    v_mul_f32 v138, v138, v13
    v_mul_f32 v139, v139, v13
    v_mfma_f32_16x16x32_bf16 v[156:159], v[80:83], v[68:71], v[156:159]
    s_setprio 1
    s_add_u32 m0, s28, 0
    v_mfma_f32_16x16x32_bf16 v[156:159], v[76:79], v[52:55], v[156:159]
    s_setprio 0
    v_mul_f32 v132, v132, v39
    v_mul_f32 v133, v133, v39
    ds_read_b64_tr_b16 v[76:77], v10 offset:51264
    buffer_load_dwordx4 v4, s[8:11], s66 offen offset:2048 sc1 lds
    v_mul_f32 v134, v134, v39
    v_mul_f32 v135, v135, v39
    s_waitcnt lgkmcnt(3)
    v_mfma_f32_16x16x32_bf16 v[188:191], v[84:87], v[52:55], v[188:191]
    s_setprio 1
    ds_read_b64_tr_b16 v[78:79], v10 offset:54848
    s_add_u32 m0, s28, 0
    v_mfma_f32_16x16x32_bf16 v[188:191], v[88:91], v[68:71], v[188:191]
    s_setprio 0
    v_mul_f32 v128, v128, v37
    v_mul_f32 v129, v129, v37
    v_mul_f32 v130, v130, v37
    buffer_load_dwordx4 v5, s[8:11], s66 offen offset:3072 sc1 lds
    v_mul_f32 v131, v131, v37
    v_mul_f32 v160, v160, v37
    s_waitcnt vmcnt(9) lgkmcnt(0)
    s_barrier
    v_mfma_f32_16x16x32_bf16 v[184:187], v[88:91], v[64:67], v[184:187]
    s_setprio 1
    ds_read_b64_tr_b16 v[80:81], v10 offset:128
    s_add_u32 s64, s64, 128
    s_bitset0_b32 s64, 11
    s_add_u32 m0, s29, 43776
    v_mfma_f32_16x16x32_bf16 v[184:187], v[84:87], v[48:51], v[184:187]
    s_setprio 0
    s_add_u32 s66, s64, 30720
    v_mul_f32 v161, v161, v37
    v_mul_f32 v162, v162, v37
    v_mul_f32 v163, v163, v37
    ds_read_b64_tr_b16 v[82:83], v10 offset:3712
    buffer_load_dwordx4 v6, s[16:19], s65 offen lds
    v_mul_f32 v164, v164, v39
    v_mul_f32 v165, v165, v39
    v_mfma_f32_16x16x32_bf16 v[180:183], v[84:87], v[44:47], v[180:183]
    s_setprio 1
    s_add_u32 s65, s65, 229376
    v_mfma_f32_16x16x32_bf16 v[180:183], v[88:91], v[60:63], v[180:183]
    s_setprio 0
    v_mul_f32 v166, v166, v39
    v_mul_f32 v167, v167, v39
    v_mul_f32 v168, v168, v13
    v_mul_f32 v169, v169, v13
    v_mul_f32 v170, v170, v13
    v_mfma_f32_16x16x32_bf16 v[176:179], v[88:91], v[56:59], v[176:179]
    s_setprio 1
    s_add_u32 m0, s29, 51072
    v_mfma_f32_16x16x32_bf16 v[176:179], v[84:87], v[40:43], v[176:179]
    s_setprio 0
    v_mul_f32 v171, v171, v13
    v_mul_f32 v172, v172, v15
    ds_read_b64_tr_b16 v[84:85], v10 offset:7424
    buffer_load_dwordx4 v6, s[16:19], s65 offen lds
    v_mul_f32 v173, v173, v15
    v_mul_f32 v174, v174, v15
    v_mul_f32 v175, v175, v15
    v_mfma_f32_16x16x32_bf16 v[208:211], v[72:75], v[40:43], v[208:211]
    s_setprio 1
    ds_read_b128 v[40:43], v8 offset:32768
    ds_read_b64_tr_b16 v[86:87], v10 offset:11008
    s_add_u32 s65, s65, 229376
    v_mfma_f32_16x16x32_bf16 v[208:211], v[76:79], v[56:59], v[208:211]
    s_setprio 0
    v_mul_f32 v204, v204, v15
    v_mul_f32 v205, v205, v15
    ds_read_b128 v[56:59], v9 offset:32768
    ds_read_b64_tr_b16 v[88:89], v10 offset:160
    v_mul_f32 v206, v206, v15
    v_mul_f32 v207, v207, v15
    v_mfma_f32_16x16x32_bf16 v[212:215], v[76:79], v[60:63], v[212:215]
    s_setprio 1
    ds_read_b128 v[60:63], v9 offset:34816
    ds_read_b64_tr_b16 v[90:91], v10 offset:3744
    v_mfma_f32_16x16x32_bf16 v[212:215], v[72:75], v[44:47], v[212:215]
    s_setprio 0
    v_mfma_f32_16x16x32_bf16 v[20:23], v[28:31], v[72:75], v[20:23]
    v_mfma_f32_16x16x32_bf16 v[20:23], v[28:31], v[76:79], v[20:23]
    v_mul_f32 v200, v200, v13
    v_mul_f32 v201, v201, v13
    v_mul_f32 v202, v202, v13
    ds_read_b128 v[44:47], v8 offset:34816
    v_mul_f32 v203, v203, v13
    v_mul_f32 v196, v196, v39
    v_mfma_f32_16x16x32_bf16 v[216:219], v[72:75], v[48:51], v[216:219]
    s_setprio 1
    ds_read_b128 v[48:51], v8 offset:36864
    v_mfma_f32_16x16x32_bf16 v[216:219], v[76:79], v[64:67], v[216:219]
    s_setprio 0
    v_mul_f32 v197, v197, v39
    v_mul_f32 v198, v198, v39
    v_mul_f32 v199, v199, v39
    ds_read_b128 v[64:67], v9 offset:36864
    v_mul_f32 v192, v192, v37
    v_mul_f32 v193, v193, v37
    v_mfma_f32_16x16x32_bf16 v[220:223], v[76:79], v[68:71], v[220:223]
    s_setprio 1
    ds_read_b128 v[68:71], v9 offset:38912
    v_mfma_f32_16x16x32_bf16 v[220:223], v[72:75], v[52:55], v[220:223]
    s_setprio 0
    v_mul_f32 v194, v194, v37
    v_mul_f32 v195, v195, v37
    ds_read_b128 v[52:55], v8 offset:38912
    ds_read_b64_tr_b16 v[72:73], v10 offset:7456
    s_waitcnt lgkmcnt(9)
    v_mfma_f32_16x16x32_bf16 v[128:131], v[80:83], v[40:43], v[128:131]
    s_setprio 1
    ds_read_b64_tr_b16 v[74:75], v10 offset:11040
    v_mfma_f32_16x16x32_bf16 v[128:131], v[84:87], v[56:59], v[128:131]
    s_setprio 0
    v_mul_f32 v144, v144, v37
    v_mul_f32 v145, v145, v37
    ds_read_b64_tr_b16 v[76:77], v10 offset:192
    v_mul_f32 v146, v146, v37
    s_waitcnt lgkmcnt(7)
    v_mfma_f32_16x16x32_bf16 v[132:135], v[84:87], v[60:63], v[132:135]
    s_setprio 1
    ds_read_b64_tr_b16 v[78:79], v10 offset:3776
    v_mfma_f32_16x16x32_bf16 v[132:135], v[80:83], v[44:47], v[132:135]
    s_setprio 0
    v_mul_f32 v147, v147, v37
    ds_write2_b32 v27, v16, v20 offset1:64
    v_mul_f32 v148, v148, v39
    s_waitcnt lgkmcnt(7)
    v_mfma_f32_16x16x32_bf16 v[136:139], v[80:83], v[48:51], v[136:139]
    s_setprio 1
    v_mfma_f32_16x16x32_bf16 v[136:139], v[84:87], v[64:67], v[136:139]
    s_setprio 0
    v_mul_f32 v149, v149, v39
    v_mul_f32 v150, v150, v39
    v_mul_f32 v151, v151, v39
    s_waitcnt lgkmcnt(5)
    v_mfma_f32_16x16x32_bf16 v[140:143], v[84:87], v[68:71], v[140:143]
    s_setprio 1
    v_mfma_f32_16x16x32_bf16 v[140:143], v[80:83], v[52:55], v[140:143]
    s_setprio 0
    v_mul_f32 v152, v152, v13
    ds_read_b64_tr_b16 v[80:81], v10 offset:7488
    v_mul_f32 v153, v153, v13
    s_waitcnt lgkmcnt(4)
    v_mfma_f32_16x16x32_bf16 v[172:175], v[88:91], v[52:55], v[172:175]
    s_setprio 1
    ds_read_b64_tr_b16 v[82:83], v10 offset:11072
    v_mfma_f32_16x16x32_bf16 v[172:175], v[72:75], v[68:71], v[172:175]
    s_setprio 0
    v_mul_f32 v154, v154, v13
    v_mul_f32 v155, v155, v13
    v_mul_f32 v156, v156, v15
    s_waitcnt vmcnt(9) lgkmcnt(0)
    s_barrier
    v_mfma_f32_16x16x32_bf16 v[168:171], v[72:75], v[64:67], v[168:171]
    s_setprio 1
    ds_read_b64_tr_b16 v[84:85], v92 offset:34816
    s_add_u32 m0, s29, 0
    v_mfma_f32_16x16x32_bf16 v[168:171], v[88:91], v[48:51], v[168:171]
    s_setprio 0
    v_mul_f32 v157, v157, v15
    ds_read_b64_tr_b16 v[86:87], v92 offset:35840
    buffer_load_dwordx4 v6, s[12:15], s65 offen lds
    v_mul_f32 v158, v158, v15
    v_mfma_f32_16x16x32_bf16 v[164:167], v[88:91], v[44:47], v[164:167]
    s_setprio 1
    s_add_u32 s65, s65, 229376
    v_mfma_f32_16x16x32_bf16 v[164:167], v[72:75], v[60:63], v[164:167]
    s_setprio 0
    v_mul_f32 v159, v159, v15
    v_mul_f32 v188, v188, v15
    v_mul_f32 v189, v189, v15
    v_mfma_f32_16x16x32_bf16 v[160:163], v[72:75], v[56:59], v[160:163]
    s_setprio 1
    s_add_u32 m0, s29, 7296
    v_mfma_f32_16x16x32_bf16 v[160:163], v[88:91], v[40:43], v[160:163]
    s_setprio 0
    v_mul_f32 v190, v190, v15
    ds_read_b64_tr_b16 v[88:89], v92 offset:40960
    buffer_load_dwordx4 v6, s[12:15], s65 offen lds
    v_mul_f32 v191, v191, v15
    v_mfma_f32_16x16x32_bf16 v[192:195], v[76:79], v[40:43], v[192:195]
    s_setprio 1
    ds_read_b64_tr_b16 v[90:91], v92 offset:41984
    s_sub_u32 s65, s65, 229376
    v_mfma_f32_16x16x32_bf16 v[192:195], v[80:83], v[56:59], v[192:195]
    s_setprio 0
    v_mul_f32 v184, v184, v13
    ds_read_b64_tr_b16 v[28:29], v32 offset:34816
    v_mul_f32 v185, v185, v13
    v_mul_f32 v186, v186, v13
    v_mfma_f32_16x16x32_bf16 v[196:199], v[80:83], v[60:63], v[196:199]
    s_setprio 1
    ds_read_b64_tr_b16 v[30:31], v32 offset:35840
    v_mfma_f32_16x16x32_bf16 v[196:199], v[76:79], v[44:47], v[196:199]
    s_setprio 0
    v_mul_f32 v187, v187, v13
    ds_read_b64_tr_b16 v[16:17], v32 offset:40960
    v_mul_f32 v180, v180, v39
    v_mfma_f32_16x16x32_bf16 v[200:203], v[76:79], v[48:51], v[200:203]
    s_setprio 1
    ds_read_b64_tr_b16 v[18:19], v32 offset:41984
    v_mfma_f32_16x16x32_bf16 v[200:203], v[80:83], v[64:67], v[200:203]
    s_setprio 0
    v_mul_f32 v181, v181, v39
    ds_read_b64_tr_b16 v[72:73], v92 offset:36864
    v_mul_f32 v182, v182, v39
    v_mul_f32 v183, v183, v39
    v_mfma_f32_16x16x32_bf16 v[204:207], v[80:83], v[68:71], v[204:207]
    s_setprio 1
    ds_read_b64_tr_b16 v[74:75], v92 offset:37888
    v_mfma_f32_16x16x32_bf16 v[204:207], v[76:79], v[52:55], v[204:207]
    s_setprio 0
    v_mul_f32 v176, v176, v37
    v_mul_f32 v177, v177, v37
    s_waitcnt lgkmcnt(6)
    v_mfma_f32_16x16x32_bf16 v[108:111], v[84:87], v[52:55], 0
    s_setprio 1
    ds_read_b64_tr_b16 v[76:77], v92 offset:43008
    v_mfma_f32_16x16x32_bf16 v[108:111], v[88:91], v[68:71], v[108:111]
    s_setprio 0
    v_mul_f32 v178, v178, v37
    ds_read_b64_tr_b16 v[78:79], v92 offset:44032
    v_mul_f32 v179, v179, v37
    v_mfma_f32_16x16x32_bf16 v[104:107], v[88:91], v[64:67], 0
    s_setprio 1
    v_mfma_f32_16x16x32_bf16 v[104:107], v[84:87], v[48:51], v[104:107]
    s_setprio 0
    v_mul_f32 v208, v208, v37
    v_mul_f32 v209, v209, v37
    v_mul_f32 v210, v210, v37
    v_mfma_f32_16x16x32_bf16 v[100:103], v[84:87], v[44:47], 0
    s_setprio 1
    ds_read_b64_tr_b16 v[80:81], v32 offset:36864
    v_mfma_f32_16x16x32_bf16 v[100:103], v[88:91], v[60:63], v[100:103]
    s_setprio 0
    v_mul_f32 v211, v211, v37
    ds_read_b64_tr_b16 v[82:83], v32 offset:37888
    v_mul_f32 v212, v212, v39
    v_mfma_f32_16x16x32_bf16 v[96:99], v[88:91], v[56:59], 0
    s_setprio 1
    s_mov_b32 m0, 61440
    v_mfma_f32_16x16x32_bf16 v[96:99], v[84:87], v[40:43], v[96:99]
    s_setprio 0
    v_mul_f32 v213, v213, v39
    v_mul_f32 v214, v214, v39
    s_add_u32 s5, s66, 65536
    buffer_load_dwordx4 v5, s[8:11], s5 offen offset:3072 sc1 lds
    v_mul_f32 v215, v215, v39
    s_waitcnt lgkmcnt(6)
    v_mfma_f32_16x16x32_bf16 v[112:115], v[28:31], v[40:43], 0
    s_setprio 1
    ds_read_b64_tr_b16 v[84:85], v32 offset:43008
    v_mfma_f32_16x16x32_bf16 v[112:115], v[16:19], v[56:59], v[112:115]
    s_setprio 0
    v_mul_f32 v216, v216, v13
    ds_read_b64_tr_b16 v[86:87], v32 offset:44032
    v_mul_f32 v217, v217, v13
    v_mfma_f32_16x16x32_bf16 v[116:119], v[16:19], v[60:63], 0
    s_setprio 1
    s_add_u32 m0, s28, 32768
    v_mfma_f32_16x16x32_bf16 v[116:119], v[28:31], v[44:47], v[116:119]
    s_setprio 0
    v_mul_f32 v218, v218, v13
    v_mul_f32 v219, v219, v13
    buffer_load_dwordx4 v4, s[8:11], s64 offen offset:0 sc1 lds
    v_mul_f32 v220, v220, v15
    v_mfma_f32_16x16x32_bf16 v[120:123], v[28:31], v[48:51], 0
    s_setprio 1
    ds_read_b64_tr_b16 v[88:89], v10 offset:14720
    v_mfma_f32_16x16x32_bf16 v[120:123], v[16:19], v[64:67], v[120:123]
    s_setprio 0
    v_mul_f32 v221, v221, v15
    ds_read_b64_tr_b16 v[90:91], v10 offset:18304
    v_mul_f32 v222, v222, v15
    v_mfma_f32_16x16x32_bf16 v[124:127], v[16:19], v[68:71], 0
    s_setprio 1
    v_mfma_f32_16x16x32_bf16 v[124:127], v[28:31], v[52:55], v[124:127]
    s_setprio 0
    v_mul_f32 v223, v223, v15
    s_nop 1
L_loop6:
    s_waitcnt lgkmcnt(6)
    v_mfma_f32_16x16x32_bf16 v[236:239], v[52:55], v[72:75], v[236:239]
    s_setprio 1
    ds_read_b64_tr_b16 v[28:29], v10 offset:22016
    v_mfma_f32_16x16x32_bf16 v[236:239], v[68:71], v[76:79], v[236:239]
    s_setprio 0
    ds_read_b64_tr_b16 v[30:31], v10 offset:25600
    v_mfma_f32_16x16x32_bf16 v[232:235], v[64:67], v[76:79], v[232:235]
    s_setprio 1
    s_add_u32 m0, s28, 32768
    v_mfma_f32_16x16x32_bf16 v[232:235], v[48:51], v[72:75], v[232:235]
    s_setprio 0
    buffer_load_dwordx4 v5, s[8:11], s64 offen offset:1024 sc1 lds
    v_mfma_f32_16x16x32_bf16 v[228:231], v[44:47], v[72:75], v[228:231]
    s_setprio 1
    v_mfma_f32_16x16x32_bf16 v[228:231], v[60:63], v[76:79], v[228:231]
    s_setprio 0
    v_mfma_f32_16x16x32_bf16 v[224:227], v[56:59], v[76:79], v[224:227]
    s_setprio 1
    v_mfma_f32_16x16x32_bf16 v[224:227], v[40:43], v[72:75], v[224:227]
    s_setprio 0
    ds_read_b64_tr_b16 v[72:73], v10 offset:14752
    s_waitcnt lgkmcnt(5)
    v_mfma_f32_16x16x32_bf16 v[240:243], v[40:43], v[80:83], v[240:243]
    s_setprio 1
    ds_read_b64_tr_b16 v[74:75], v10 offset:18336
    v_mfma_f32_16x16x32_bf16 v[240:243], v[56:59], v[84:87], v[240:243]
    s_setprio 0
    ds_read_b64_tr_b16 v[76:77], v10 offset:22048
    v_mfma_f32_16x16x32_bf16 v[244:247], v[60:63], v[84:87], v[244:247]
    s_setprio 1
    ds_read_b64_tr_b16 v[78:79], v10 offset:25632
    s_add_u32 m0, s28, 32768
    v_mfma_f32_16x16x32_bf16 v[244:247], v[44:47], v[80:83], v[244:247]
    s_setprio 0
    buffer_load_dwordx4 v4, s[8:11], s66 offen offset:2048 sc1 lds
    v_mfma_f32_16x16x32_bf16 v[248:251], v[48:51], v[80:83], v[248:251]
    s_setprio 1
    v_mfma_f32_16x16x32_bf16 v[248:251], v[64:67], v[84:87], v[248:251]
    s_setprio 0
    v_mfma_f32_16x16x32_bf16 v[252:255], v[68:71], v[84:87], v[252:255]
    s_setprio 1
    v_mfma_f32_16x16x32_bf16 v[252:255], v[52:55], v[80:83], v[252:255]
    s_setprio 0
    ds_read_b64_tr_b16 v[80:81], v10 offset:14784
    s_waitcnt lgkmcnt(5)
    v_mfma_f32_16x16x32_bf16 v[156:159], v[88:91], v[52:55], v[156:159]
    s_setprio 1
    ds_read_b64_tr_b16 v[82:83], v10 offset:18368
    v_mfma_f32_16x16x32_bf16 v[156:159], v[28:31], v[68:71], v[156:159]
    s_setprio 0
    ds_read_b64_tr_b16 v[84:85], v10 offset:22080
    v_mfma_f32_16x16x32_bf16 v[152:155], v[28:31], v[64:67], v[152:155]
    s_setprio 1
    ds_read_b64_tr_b16 v[86:87], v10 offset:25664
    s_add_u32 m0, s28, 32768
    v_mfma_f32_16x16x32_bf16 v[152:155], v[88:91], v[48:51], v[152:155]
    s_setprio 0
    buffer_load_dwordx4 v5, s[8:11], s66 offen offset:3072 sc1 lds
    v_mfma_f32_16x16x32_bf16 v[148:151], v[88:91], v[44:47], v[148:151]
    s_setprio 1
    s_add_u32 s64, s64, 128
    s_bitset0_b32 s64, 11
    v_mfma_f32_16x16x32_bf16 v[148:151], v[28:31], v[60:63], v[148:151]
    s_setprio 0
    s_add_u32 s66, s64, 30720
    s_waitcnt vmcnt(9) lgkmcnt(0)
    s_barrier
    v_mfma_f32_16x16x32_bf16 v[144:147], v[28:31], v[56:59], v[144:147]
    s_setprio 1
    ds_read_b128 v[12:15], v8 offset:6144
    s_add_u32 m0, s29, 14592
    v_mfma_f32_16x16x32_bf16 v[144:147], v[88:91], v[40:43], v[144:147]
    s_setprio 0
    ds_read_b64_tr_b16 v[88:89], v10 offset:29312
    buffer_load_dwordx4 v6, s[16:19], s65 offen lds
    v_mfma_f32_16x16x32_bf16 v[176:179], v[72:75], v[40:43], v[176:179]
    s_setprio 1
    ds_read_b64_tr_b16 v[90:91], v10 offset:32896
    s_add_u32 s65, s65, 229376
    v_mfma_f32_16x16x32_bf16 v[176:179], v[76:79], v[56:59], v[176:179]
    s_setprio 0
    ds_read_b64_tr_b16 v[28:29], v10 offset:36608
    v_mfma_f32_16x16x32_bf16 v[180:183], v[76:79], v[60:63], v[180:183]
    s_setprio 1
    ds_read_b64_tr_b16 v[30:31], v10 offset:40192
    v_mfma_f32_16x16x32_bf16 v[180:183], v[72:75], v[44:47], v[180:183]
    s_setprio 0
    ds_read_b128 v[36:39], v9 offset:6144
    v_mfma_f32_16x16x32_bf16 v[184:187], v[72:75], v[48:51], v[184:187]
    s_setprio 1
    ds_read_b64_tr_b16 v[16:17], v10 offset:29344
    v_mfma_f32_16x16x32_bf16 v[184:187], v[76:79], v[64:67], v[184:187]
    s_setprio 0
    ds_read_b64_tr_b16 v[18:19], v10 offset:32928
    v_mfma_f32_16x16x32_bf16 v[188:191], v[76:79], v[68:71], v[188:191]
    s_setprio 1
    s_add_u32 m0, s29, 21888
    v_mfma_f32_16x16x32_bf16 v[188:191], v[72:75], v[52:55], v[188:191]
    s_setprio 0
    buffer_load_dwordx4 v6, s[16:19], s65 offen lds
    v_mfma_f32_16x16x32_bf16 v[220:223], v[80:83], v[52:55], v[220:223]
    s_setprio 1
    ds_read_b128 v[52:55], v9 offset:4096
    ds_read_b64_tr_b16 v[72:73], v10 offset:36640
    s_add_u32 s65, s65, 229376
    v_mfma_f32_16x16x32_bf16 v[220:223], v[84:87], v[68:71], v[220:223]
    s_setprio 0
    ds_read_b128 v[68:71], v8 offset:4096
    ds_read_b64_tr_b16 v[74:75], v10 offset:40224
    v_mfma_f32_16x16x32_bf16 v[216:219], v[84:87], v[64:67], v[216:219]
    s_setprio 1
    ds_read_b128 v[64:67], v8 offset:2048
    v_mfma_f32_16x16x32_bf16 v[216:219], v[80:83], v[48:51], v[216:219]
    s_setprio 0
    ds_read_b128 v[48:51], v9 offset:2048
    v_mfma_f32_16x16x32_bf16 v[212:215], v[80:83], v[44:47], v[212:215]
    s_setprio 1
    ds_read_b128 v[44:47], v9 offset:0
    ds_read_b64_tr_b16 v[76:77], v10 offset:29376
    v_mfma_f32_16x16x32_bf16 v[212:215], v[84:87], v[60:63], v[212:215]
    s_setprio 0
    ds_read_b128 v[60:63], v8 offset:0
    ds_read_b64_tr_b16 v[78:79], v10 offset:32960
    v_mfma_f32_16x16x32_bf16 v[208:211], v[84:87], v[56:59], v[208:211]
    s_setprio 1
    v_mfma_f32_16x16x32_bf16 v[208:211], v[80:83], v[40:43], v[208:211]
    s_setprio 0
    s_waitcnt lgkmcnt(12)
    v_mfma_f32_16x16x32_bf16 v[140:143], v[88:91], v[12:15], v[140:143]
    s_setprio 1
    ds_read_b64_tr_b16 v[80:81], v10 offset:36672
    v_mfma_f32_16x16x32_bf16 v[140:143], v[28:31], v[36:39], v[140:143]
    s_setprio 0
    ds_read_b64_tr_b16 v[82:83], v10 offset:40256
    s_waitcnt lgkmcnt(9)
    v_mfma_f32_16x16x32_bf16 v[136:139], v[28:31], v[52:55], v[136:139]
    s_setprio 1
    v_mfma_f32_16x16x32_bf16 v[136:139], v[88:91], v[68:71], v[136:139]
    s_setprio 0
    s_waitcnt lgkmcnt(6)
    v_mfma_f32_16x16x32_bf16 v[132:135], v[88:91], v[64:67], v[132:135]
    s_setprio 1
    v_mfma_f32_16x16x32_bf16 v[132:135], v[28:31], v[48:51], v[132:135]
    s_setprio 0
    s_waitcnt lgkmcnt(3)
    v_mfma_f32_16x16x32_bf16 v[128:131], v[28:31], v[44:47], v[128:131]
    s_setprio 1
    v_mfma_f32_16x16x32_bf16 v[128:131], v[88:91], v[60:63], v[128:131]
    s_setprio 0
    v_mfma_f32_16x16x32_bf16 v[160:163], v[16:19], v[60:63], v[160:163]
    s_setprio 1
    v_mfma_f32_16x16x32_bf16 v[160:163], v[72:75], v[44:47], v[160:163]
    s_setprio 0
    v_mfma_f32_16x16x32_bf16 v[164:167], v[72:75], v[48:51], v[164:167]
    s_setprio 1
    v_mfma_f32_16x16x32_bf16 v[164:167], v[16:19], v[64:67], v[164:167]
    s_setprio 0
    v_mfma_f32_16x16x32_bf16 v[168:171], v[16:19], v[68:71], v[168:171]
    s_setprio 1
    v_mfma_f32_16x16x32_bf16 v[168:171], v[72:75], v[52:55], v[168:171]
    s_setprio 0
    s_waitcnt vmcnt(9) lgkmcnt(0)
    s_barrier
    v_mfma_f32_16x16x32_bf16 v[172:175], v[72:75], v[36:39], v[172:175]
    s_setprio 1
    ds_read_b64_tr_b16 v[84:85], v92 offset:47104
    s_add_u32 m0, s29, 29184
    v_mfma_f32_16x16x32_bf16 v[172:175], v[16:19], v[12:15], v[172:175]
    s_setprio 0
    ds_read_b64_tr_b16 v[86:87], v92 offset:48128
    buffer_load_dwordx4 v6, s[12:15], s65 offen lds
    v_mfma_f32_16x16x32_bf16 v[204:207], v[76:79], v[12:15], v[204:207]
    s_setprio 1
    ds_read_b64_tr_b16 v[88:89], v92 offset:53248
    s_add_u32 s65, s65, 229376
    v_mfma_f32_16x16x32_bf16 v[204:207], v[80:83], v[36:39], v[204:207]
    s_setprio 0
    ds_read_b64_tr_b16 v[90:91], v92 offset:54272
    v_mfma_f32_16x16x32_bf16 v[200:203], v[80:83], v[52:55], v[200:203]
    s_setprio 1
    ds_read_b64_tr_b16 v[28:29], v32 offset:47104
    v_mfma_f32_16x16x32_bf16 v[200:203], v[76:79], v[68:71], v[200:203]
    s_setprio 0
    ds_read_b64_tr_b16 v[30:31], v32 offset:48128
    v_mfma_f32_16x16x32_bf16 v[196:199], v[76:79], v[64:67], v[196:199]
    s_setprio 1
    ds_read_b64_tr_b16 v[16:17], v32 offset:53248
    v_mfma_f32_16x16x32_bf16 v[196:199], v[80:83], v[48:51], v[196:199]
    s_setprio 0
    ds_read_b64_tr_b16 v[18:19], v32 offset:54272
    v_mfma_f32_16x16x32_bf16 v[192:195], v[80:83], v[44:47], v[192:195]
    s_setprio 1
    ds_read_b64_tr_b16 v[72:73], v92 offset:49152
    s_add_u32 m0, s29, 36480
    v_mfma_f32_16x16x32_bf16 v[192:195], v[76:79], v[60:63], v[192:195]
    s_setprio 0
    ds_read_b64_tr_b16 v[74:75], v92 offset:50176
    buffer_load_dwordx4 v6, s[12:15], s65 offen lds
    s_waitcnt lgkmcnt(6)
    v_mfma_f32_16x16x32_bf16 v[96:99], v[84:87], v[60:63], v[96:99]
    s_setprio 1
    ds_read_b64_tr_b16 v[76:77], v92 offset:55296
    s_sub_u32 s65, s65, 229376
    v_mfma_f32_16x16x32_bf16 v[96:99], v[88:91], v[44:47], v[96:99]
    s_setprio 0
    ds_read_b64_tr_b16 v[78:79], v92 offset:56320
    v_mfma_f32_16x16x32_bf16 v[100:103], v[88:91], v[48:51], v[100:103]
    s_setprio 1
    v_mfma_f32_16x16x32_bf16 v[100:103], v[84:87], v[64:67], v[100:103]
    s_setprio 0
    v_mfma_f32_16x16x32_bf16 v[104:107], v[84:87], v[68:71], v[104:107]
    s_setprio 1
    ds_read_b64_tr_b16 v[80:81], v32 offset:49152
    v_mfma_f32_16x16x32_bf16 v[104:107], v[88:91], v[52:55], v[104:107]
    s_setprio 0
    ds_read_b64_tr_b16 v[82:83], v32 offset:50176
    v_mfma_f32_16x16x32_bf16 v[108:111], v[88:91], v[36:39], v[108:111]
    s_setprio 1
    s_mov_b32 m0, 28672
    v_mfma_f32_16x16x32_bf16 v[108:111], v[84:87], v[12:15], v[108:111]
    s_setprio 0
    s_add_u32 s5, s66, 65536
    buffer_load_dwordx4 v5, s[8:11], s5 offen offset:3072 sc1 lds
    s_waitcnt lgkmcnt(6)
    v_mfma_f32_16x16x32_bf16 v[124:127], v[28:31], v[12:15], v[124:127]
    s_setprio 1
    ds_read_b64_tr_b16 v[84:85], v32 offset:55296
    v_mfma_f32_16x16x32_bf16 v[124:127], v[16:19], v[36:39], v[124:127]
    s_setprio 0
    ds_read_b64_tr_b16 v[86:87], v32 offset:56320
    v_mfma_f32_16x16x32_bf16 v[120:123], v[16:19], v[52:55], v[120:123]
    s_setprio 1
    s_add_u32 m0, s28, 0
    v_mfma_f32_16x16x32_bf16 v[120:123], v[28:31], v[68:71], v[120:123]
    s_setprio 0
    buffer_load_dwordx4 v4, s[8:11], s64 offen offset:0 sc1 lds
    v_mfma_f32_16x16x32_bf16 v[116:119], v[28:31], v[64:67], v[116:119]
    s_setprio 1
    ds_read_b64_tr_b16 v[88:89], v10 offset:43904
    v_mfma_f32_16x16x32_bf16 v[116:119], v[16:19], v[48:51], v[116:119]
    s_setprio 0
    ds_read_b64_tr_b16 v[90:91], v10 offset:47488
    v_mfma_f32_16x16x32_bf16 v[112:115], v[16:19], v[44:47], v[112:115]
    s_setprio 1
    v_mfma_f32_16x16x32_bf16 v[112:115], v[28:31], v[60:63], v[112:115]
    s_setprio 0
    s_waitcnt lgkmcnt(6)
    v_mfma_f32_16x16x32_bf16 v[224:227], v[60:63], v[72:75], v[224:227]
    s_setprio 1
    ds_read_b64_tr_b16 v[28:29], v10 offset:51200
    v_mfma_f32_16x16x32_bf16 v[224:227], v[44:47], v[76:79], v[224:227]
    s_setprio 0
    ds_read_b64_tr_b16 v[30:31], v10 offset:54784
    v_mfma_f32_16x16x32_bf16 v[228:231], v[48:51], v[76:79], v[228:231]
    s_setprio 1
    s_add_u32 m0, s28, 0
    v_mfma_f32_16x16x32_bf16 v[228:231], v[64:67], v[72:75], v[228:231]
    s_setprio 0
    buffer_load_dwordx4 v5, s[8:11], s64 offen offset:1024 sc1 lds
    v_mfma_f32_16x16x32_bf16 v[232:235], v[68:71], v[72:75], v[232:235]
    s_setprio 1
    v_mfma_f32_16x16x32_bf16 v[232:235], v[52:55], v[76:79], v[232:235]
    s_setprio 0
    v_mfma_f32_16x16x32_bf16 v[236:239], v[36:39], v[76:79], v[236:239]
    s_setprio 1
    v_mfma_f32_16x16x32_bf16 v[236:239], v[12:15], v[72:75], v[236:239]
    s_setprio 0
    ds_read_b64_tr_b16 v[72:73], v10 offset:43936
    s_waitcnt lgkmcnt(5)
    v_mfma_f32_16x16x32_bf16 v[252:255], v[12:15], v[80:83], v[252:255]
    s_setprio 1
    ds_read_b64_tr_b16 v[74:75], v10 offset:47520
    v_mfma_f32_16x16x32_bf16 v[252:255], v[36:39], v[84:87], v[252:255]
    s_setprio 0
    ds_read_b64_tr_b16 v[76:77], v10 offset:51232
    v_mfma_f32_16x16x32_bf16 v[248:251], v[52:55], v[84:87], v[248:251]
    s_setprio 1
    ds_read_b64_tr_b16 v[78:79], v10 offset:54816
    s_add_u32 m0, s28, 0
    v_mfma_f32_16x16x32_bf16 v[248:251], v[68:71], v[80:83], v[248:251]
    s_setprio 0
    buffer_load_dwordx4 v4, s[8:11], s66 offen offset:2048 sc1 lds
    v_mfma_f32_16x16x32_bf16 v[244:247], v[64:67], v[80:83], v[244:247]
    s_setprio 1
    v_mfma_f32_16x16x32_bf16 v[244:247], v[48:51], v[84:87], v[244:247]
    s_setprio 0
    v_mfma_f32_16x16x32_bf16 v[240:243], v[44:47], v[84:87], v[240:243]
    s_setprio 1
    v_mfma_f32_16x16x32_bf16 v[240:243], v[60:63], v[80:83], v[240:243]
    s_setprio 0
    ds_read_b64_tr_b16 v[80:81], v10 offset:43968
    s_waitcnt lgkmcnt(5)
    v_mfma_f32_16x16x32_bf16 v[144:147], v[88:91], v[60:63], v[144:147]
    s_setprio 1
    ds_read_b64_tr_b16 v[82:83], v10 offset:47552
    v_mfma_f32_16x16x32_bf16 v[144:147], v[28:31], v[44:47], v[144:147]
    s_setprio 0
    ds_read_b64_tr_b16 v[84:85], v10 offset:51264
    v_mfma_f32_16x16x32_bf16 v[148:151], v[28:31], v[48:51], v[148:151]
    s_setprio 1
    ds_read_b64_tr_b16 v[86:87], v10 offset:54848
    s_add_u32 m0, s28, 0
    v_mfma_f32_16x16x32_bf16 v[148:151], v[88:91], v[64:67], v[148:151]
    s_setprio 0
    buffer_load_dwordx4 v5, s[8:11], s66 offen offset:3072 sc1 lds
    v_mfma_f32_16x16x32_bf16 v[152:155], v[88:91], v[68:71], v[152:155]
    s_setprio 1
    s_add_u32 s64, s64, 128
    s_bitset0_b32 s64, 11
    v_mfma_f32_16x16x32_bf16 v[152:155], v[28:31], v[52:55], v[152:155]
    s_setprio 0
    s_add_u32 s66, s64, 30720
    s_waitcnt vmcnt(9) lgkmcnt(0)
    s_barrier
    v_mfma_f32_16x16x32_bf16 v[156:159], v[28:31], v[36:39], v[156:159]
    s_setprio 1
    ds_read_b128 v[40:43], v8 offset:32768
    s_add_u32 m0, s29, 43776
    v_mfma_f32_16x16x32_bf16 v[156:159], v[88:91], v[12:15], v[156:159]
    s_setprio 0
    ds_read_b64_tr_b16 v[88:89], v10 offset:128
    buffer_load_dwordx4 v6, s[16:19], s65 offen lds
    v_mfma_f32_16x16x32_bf16 v[188:191], v[72:75], v[12:15], v[188:191]
    s_setprio 1
    ds_read_b64_tr_b16 v[90:91], v10 offset:3712
    s_add_u32 s65, s65, 229376
    v_mfma_f32_16x16x32_bf16 v[188:191], v[76:79], v[36:39], v[188:191]
    s_setprio 0
    ds_read_b64_tr_b16 v[28:29], v10 offset:7424
    v_mfma_f32_16x16x32_bf16 v[184:187], v[76:79], v[52:55], v[184:187]
    s_setprio 1
    ds_read_b64_tr_b16 v[30:31], v10 offset:11008
    v_mfma_f32_16x16x32_bf16 v[184:187], v[72:75], v[68:71], v[184:187]
    s_setprio 0
    ds_read_b128 v[56:59], v9 offset:32768
    v_mfma_f32_16x16x32_bf16 v[180:183], v[72:75], v[64:67], v[180:183]
    s_setprio 1
    ds_read_b64_tr_b16 v[16:17], v10 offset:160
    v_mfma_f32_16x16x32_bf16 v[180:183], v[76:79], v[48:51], v[180:183]
    s_setprio 0
    ds_read_b64_tr_b16 v[18:19], v10 offset:3744
    v_mfma_f32_16x16x32_bf16 v[176:179], v[76:79], v[44:47], v[176:179]
    s_setprio 1
    s_add_u32 m0, s29, 51072
    v_mfma_f32_16x16x32_bf16 v[176:179], v[72:75], v[60:63], v[176:179]
    s_setprio 0
    buffer_load_dwordx4 v6, s[16:19], s65 offen lds
    v_mfma_f32_16x16x32_bf16 v[208:211], v[80:83], v[60:63], v[208:211]
    s_setprio 1
    ds_read_b128 v[60:63], v9 offset:34816
    ds_read_b64_tr_b16 v[72:73], v10 offset:7456
    s_add_u32 s65, s65, 229376
    v_mfma_f32_16x16x32_bf16 v[208:211], v[84:87], v[44:47], v[208:211]
    s_setprio 0
    ds_read_b128 v[44:47], v8 offset:34816
    ds_read_b64_tr_b16 v[74:75], v10 offset:11040
    v_mfma_f32_16x16x32_bf16 v[212:215], v[84:87], v[48:51], v[212:215]
    s_setprio 1
    ds_read_b128 v[48:51], v8 offset:36864
    v_mfma_f32_16x16x32_bf16 v[212:215], v[80:83], v[64:67], v[212:215]
    s_setprio 0
    ds_read_b128 v[64:67], v9 offset:36864
    v_mfma_f32_16x16x32_bf16 v[216:219], v[80:83], v[68:71], v[216:219]
    s_setprio 1
    ds_read_b128 v[68:71], v9 offset:38912
    ds_read_b64_tr_b16 v[76:77], v10 offset:192
    v_mfma_f32_16x16x32_bf16 v[216:219], v[84:87], v[52:55], v[216:219]
    s_setprio 0
    ds_read_b128 v[52:55], v8 offset:38912
    ds_read_b64_tr_b16 v[78:79], v10 offset:3776
    v_mfma_f32_16x16x32_bf16 v[220:223], v[84:87], v[36:39], v[220:223]
    s_setprio 1
    v_mfma_f32_16x16x32_bf16 v[220:223], v[80:83], v[12:15], v[220:223]
    s_setprio 0
    s_waitcnt lgkmcnt(12)
    v_mfma_f32_16x16x32_bf16 v[128:131], v[88:91], v[40:43], v[128:131]
    s_setprio 1
    ds_read_b64_tr_b16 v[80:81], v10 offset:7488
    v_mfma_f32_16x16x32_bf16 v[128:131], v[28:31], v[56:59], v[128:131]
    s_setprio 0
    ds_read_b64_tr_b16 v[82:83], v10 offset:11072
    s_waitcnt lgkmcnt(9)
    v_mfma_f32_16x16x32_bf16 v[132:135], v[28:31], v[60:63], v[132:135]
    s_setprio 1
    v_mfma_f32_16x16x32_bf16 v[132:135], v[88:91], v[44:47], v[132:135]
    s_setprio 0
    s_bitcmp1_b32 0x10, s36
    s_cbranch_scc1 L_h6p3_2
L_r6p3_2:
    s_waitcnt lgkmcnt(6)
    v_mfma_f32_16x16x32_bf16 v[136:139], v[88:91], v[48:51], v[136:139]
    s_setprio 1
    v_mfma_f32_16x16x32_bf16 v[136:139], v[28:31], v[64:67], v[136:139]
    s_setprio 0
    s_waitcnt lgkmcnt(3)
    v_mfma_f32_16x16x32_bf16 v[140:143], v[28:31], v[68:71], v[140:143]
    s_setprio 1
    v_mfma_f32_16x16x32_bf16 v[140:143], v[88:91], v[52:55], v[140:143]
    s_setprio 0
    v_mfma_f32_16x16x32_bf16 v[172:175], v[16:19], v[52:55], v[172:175]
    s_setprio 1
    v_mfma_f32_16x16x32_bf16 v[172:175], v[72:75], v[68:71], v[172:175]
    s_setprio 0
    v_mfma_f32_16x16x32_bf16 v[168:171], v[72:75], v[64:67], v[168:171]
    s_setprio 1
    v_mfma_f32_16x16x32_bf16 v[168:171], v[16:19], v[48:51], v[168:171]
    s_setprio 0
    v_mfma_f32_16x16x32_bf16 v[164:167], v[16:19], v[44:47], v[164:167]
    s_setprio 1
    v_mfma_f32_16x16x32_bf16 v[164:167], v[72:75], v[60:63], v[164:167]
    s_setprio 0
    s_waitcnt vmcnt(9) lgkmcnt(0)
    s_barrier
    v_mfma_f32_16x16x32_bf16 v[160:163], v[72:75], v[56:59], v[160:163]
    s_setprio 1
    ds_read_b64_tr_b16 v[84:85], v92 offset:34816
    s_add_u32 m0, s29, 0
    v_mfma_f32_16x16x32_bf16 v[160:163], v[16:19], v[40:43], v[160:163]
    s_setprio 0
    ds_read_b64_tr_b16 v[86:87], v92 offset:35840
    buffer_load_dwordx4 v6, s[12:15], s65 offen lds
    v_mfma_f32_16x16x32_bf16 v[192:195], v[76:79], v[40:43], v[192:195]
    s_setprio 1
    ds_read_b64_tr_b16 v[88:89], v92 offset:40960
    s_add_u32 s65, s65, 229376
    v_mfma_f32_16x16x32_bf16 v[192:195], v[80:83], v[56:59], v[192:195]
    s_setprio 0
    ds_read_b64_tr_b16 v[90:91], v92 offset:41984
    v_mfma_f32_16x16x32_bf16 v[196:199], v[80:83], v[60:63], v[196:199]
    s_setprio 1
    ds_read_b64_tr_b16 v[28:29], v32 offset:34816
    v_mfma_f32_16x16x32_bf16 v[196:199], v[76:79], v[44:47], v[196:199]
    s_setprio 0
    ds_read_b64_tr_b16 v[30:31], v32 offset:35840
    v_mfma_f32_16x16x32_bf16 v[200:203], v[76:79], v[48:51], v[200:203]
    s_setprio 1
    ds_read_b64_tr_b16 v[16:17], v32 offset:40960
    v_mfma_f32_16x16x32_bf16 v[200:203], v[80:83], v[64:67], v[200:203]
    s_setprio 0
    ds_read_b64_tr_b16 v[18:19], v32 offset:41984
    v_mfma_f32_16x16x32_bf16 v[204:207], v[80:83], v[68:71], v[204:207]
    s_setprio 1
    ds_read_b64_tr_b16 v[72:73], v92 offset:36864
    s_add_u32 m0, s29, 7296
    v_mfma_f32_16x16x32_bf16 v[204:207], v[76:79], v[52:55], v[204:207]
    s_setprio 0
    ds_read_b64_tr_b16 v[74:75], v92 offset:37888
    buffer_load_dwordx4 v6, s[12:15], s65 offen lds
    s_waitcnt lgkmcnt(6)
    v_mfma_f32_16x16x32_bf16 v[108:111], v[84:87], v[52:55], v[108:111]
    s_setprio 1
    ds_read_b64_tr_b16 v[76:77], v92 offset:43008
    s_sub_u32 s65, s65, 229376
    v_mfma_f32_16x16x32_bf16 v[108:111], v[88:91], v[68:71], v[108:111]
    s_setprio 0
    ds_read_b64_tr_b16 v[78:79], v92 offset:44032
    v_mfma_f32_16x16x32_bf16 v[104:107], v[88:91], v[64:67], v[104:107]
    s_setprio 1
    v_mfma_f32_16x16x32_bf16 v[104:107], v[84:87], v[48:51], v[104:107]
    s_setprio 0
    v_mfma_f32_16x16x32_bf16 v[100:103], v[84:87], v[44:47], v[100:103]
    s_setprio 1
    ds_read_b64_tr_b16 v[80:81], v32 offset:36864
    v_mfma_f32_16x16x32_bf16 v[100:103], v[88:91], v[60:63], v[100:103]
    s_setprio 0
    ds_read_b64_tr_b16 v[82:83], v32 offset:37888
    v_mfma_f32_16x16x32_bf16 v[96:99], v[88:91], v[56:59], v[96:99]
    s_setprio 1
    s_mov_b32 m0, 61440
    v_mfma_f32_16x16x32_bf16 v[96:99], v[84:87], v[40:43], v[96:99]
    s_setprio 0
    s_add_u32 s5, s66, 65536
    buffer_load_dwordx4 v5, s[8:11], s5 offen offset:3072 sc1 lds
    s_waitcnt lgkmcnt(6)
    v_mfma_f32_16x16x32_bf16 v[112:115], v[28:31], v[40:43], v[112:115]
    s_setprio 1
    ds_read_b64_tr_b16 v[84:85], v32 offset:43008
    v_mfma_f32_16x16x32_bf16 v[112:115], v[16:19], v[56:59], v[112:115]
    s_setprio 0
    ds_read_b64_tr_b16 v[86:87], v32 offset:44032
    v_mfma_f32_16x16x32_bf16 v[116:119], v[16:19], v[60:63], v[116:119]
    s_setprio 1
    s_add_u32 m0, s28, 32768
    v_mfma_f32_16x16x32_bf16 v[116:119], v[28:31], v[44:47], v[116:119]
    s_setprio 0
    buffer_load_dwordx4 v4, s[8:11], s64 offen offset:0 sc1 lds
    v_mfma_f32_16x16x32_bf16 v[120:123], v[28:31], v[48:51], v[120:123]
    s_setprio 1
    ds_read_b64_tr_b16 v[88:89], v10 offset:14720
    v_mfma_f32_16x16x32_bf16 v[120:123], v[16:19], v[64:67], v[120:123]
    s_setprio 0
    ds_read_b64_tr_b16 v[90:91], v10 offset:18304
    v_mfma_f32_16x16x32_bf16 v[124:127], v[16:19], v[68:71], v[124:127]
    s_setprio 1
    v_mfma_f32_16x16x32_bf16 v[124:127], v[28:31], v[52:55], v[124:127]
    s_setprio 0
    s_add_u32 s36, s36, 1
    s_cmp_lt_u32 s36, 5
    s_cbranch_scc1 L_loop6
    s_mov_b32 s80, 1376256
    s_mov_b32 s81, 1400832
    s_mov_b32 s82, 1378304
    s_mov_b32 s29, 116736
    s_mov_b32 s37, 0
    s_mov_b32 s83, 131072
    s_branch L_pb1
L_w7:
    s_mov_b32 s12, s52
    s_mov_b32 s13, s53
    s_and_b32 s13, s13, 0xffff
    s_mov_b32 s14, 0x700000
    s_mov_b32 s15, 0x20000
    s_mov_b32 s16, s46
    s_mov_b32 s17, s47
    s_and_b32 s17, s17, 0xffff
    s_mov_b32 s18, 0x200000
    s_mov_b32 s19, 0x20000
    v_lshlrev_b32 v7, 7, v1
    v_min_u32 v6, 7040, v7
    s_lshr_b32 s5, s2, 3
    s_lshl_b32 s5, s5, 1
    s_and_b32 s6, s2, 1
    s_add_u32 s5, s5, s6
    s_lshl_b32 s6, s70, 6
    s_add_u32 s5, s5, s6
    s_mul_i32 s65, s5, 28672
    s_lshl_b32 s67, s5, 13
    v_min_u32 v16, 47, v1
    v_mul_u32_u24 v17, 43, v16
    v_lshrrev_b32 v17, 8, v17
    v_mul_u32_u24 v18, 6, v17
    v_sub_u32 v16, v16, v18
    v_mul_u32_u24 v17, 6144, v17
    v_lshrrev_b32 v18, 1, v16
    v_lshl_add_u32 v17, v18, 11, v17
    v_and_b32 v16, 1, v16
    v_lshl_add_u32 v21, v16, 7, v17
    s_lshr_b32 s5, s2, 3
    s_mul_i32 s39, s5, 49152
    s_and_b32 s5, s2, 7
    s_lshl_b32 s5, s5, 8
    s_add_u32 s39, s39, s5
    s_add_u32 s39, s39, 1572864
    s_lshl_b32 s38, s62, 11
    s_add_u32 s38, s38, 3211264
    s_barrier
    s_add_u32 m0, s28, 0
    s_nop 0
    buffer_load_dwordx4 v4, s[8:11], s64 offen offset:0 sc1 lds
    buffer_load_dwordx4 v5, s[8:11], s64 offen offset:1024 sc1 lds
    buffer_load_dwordx4 v4, s[8:11], s66 offen offset:2048 sc1 lds
    buffer_load_dwordx4 v5, s[8:11], s66 offen offset:3072 sc1 lds
    s_add_u32 s64, s64, 128
    s_bitset0_b32 s64, 11
    s_add_u32 s66, s64, 30720
    s_waitcnt vmcnt(5)
    v_lshlrev_b32 v112, 16, v104
    v_and_b32 v113, 0xffff0000, v104
    v_lshlrev_b32 v114, 16, v105
    v_and_b32 v115, 0xffff0000, v105
    v_lshlrev_b32 v116, 16, v106
    v_and_b32 v117, 0xffff0000, v106
    v_lshlrev_b32 v118, 16, v107
    v_and_b32 v119, 0xffff0000, v107
    v_lshlrev_b32 v120, 16, v108
    v_and_b32 v121, 0xffff0000, v108
    v_lshlrev_b32 v122, 16, v109
    v_and_b32 v123, 0xffff0000, v109
    v_lshlrev_b32 v124, 16, v110
    v_and_b32 v125, 0xffff0000, v110
    v_lshlrev_b32 v126, 16, v111
    v_and_b32 v127, 0xffff0000, v111
    v_add_f32 v36, v112, v116
    v_add_f32 v37, v113, v117
    v_add_f32 v38, v114, v118
    v_add_f32 v39, v115, v119
    v_add_f32 v36, v36, v120
    v_add_f32 v37, v37, v121
    v_add_f32 v38, v38, v122
    v_add_f32 v39, v39, v123
    v_add_f32 v36, v36, v124
    v_add_f32 v37, v37, v125
    v_add_f32 v38, v38, v126
    v_add_f32 v39, v39, v127
    v_add_f32 v36, v36, v37
    v_add_f32 v38, v38, v39
    v_add_f32 v34, v36, v38
    s_nop 1
    v_add_f32_dpp v34, v34, v34 row_ror:8 row_mask:0xf bank_mask:0xf
    s_nop 1
    v_add_f32_dpp v34, v34, v34 row_ror:4 row_mask:0xf bank_mask:0xf
    s_nop 1
    v_add_f32_dpp v34, v34, v34 row_ror:2 row_mask:0xf bank_mask:0xf
    s_nop 1
    v_add_f32_dpp v34, v34, v34 row_ror:1 row_mask:0xf bank_mask:0xf
    v_mov_b32 v36, v34
    s_nop 1
    v_permlane16_swap_b32 v34, v36
    v_add_f32 v34, v34, v36
    v_mov_b32 v36, v34
    s_nop 1
    v_permlane32_swap_b32 v34, v36
    v_add_f32 v34, v34, v36
    v_mul_f32 v34, 0x3a800000, v34
    v_cvt_pk_bf16_f32 v14, v34, v34
    v_and_b32 v14, 0xffff0000, v14
    v_sub_f32 v112, v112, v14
    v_sub_f32 v113, v113, v14
    v_sub_f32 v114, v114, v14
    v_sub_f32 v115, v115, v14
    v_sub_f32 v116, v116, v14
    v_sub_f32 v117, v117, v14
    v_sub_f32 v118, v118, v14
    v_sub_f32 v119, v119, v14
    v_sub_f32 v120, v120, v14
    v_sub_f32 v121, v121, v14
    v_sub_f32 v122, v122, v14
    v_sub_f32 v123, v123, v14
    v_sub_f32 v124, v124, v14
    v_sub_f32 v125, v125, v14
    v_sub_f32 v126, v126, v14
    v_sub_f32 v127, v127, v14
    v_mul_f32 v36, v112, v112
    v_mul_f32 v37, v113, v113
    v_mul_f32 v38, v114, v114
    v_mul_f32 v39, v115, v115
    v_fmac_f32 v36, v116, v116
    v_fmac_f32 v37, v117, v117
    v_fmac_f32 v38, v118, v118
    v_fmac_f32 v39, v119, v119
    v_fmac_f32 v36, v120, v120
    v_fmac_f32 v37, v121, v121
    v_fmac_f32 v38, v122, v122
    v_fmac_f32 v39, v123, v123
    v_fmac_f32 v36, v124, v124
    v_fmac_f32 v37, v125, v125
    v_fmac_f32 v38, v126, v126
    v_fmac_f32 v39, v127, v127
    v_add_f32 v36, v36, v37
    v_add_f32 v38, v38, v39
    v_sub_f32 v34, v34, v14
    v_add_f32 v12, v36, v38
    s_nop 1
    v_add_f32_dpp v12, v12, v12 row_ror:8 row_mask:0xf bank_mask:0xf
    v_cvt_pk_bf16_f32 v104, v112, v113
    s_nop 0
    v_add_f32_dpp v12, v12, v12 row_ror:4 row_mask:0xf bank_mask:0xf
    v_cvt_pk_bf16_f32 v105, v114, v115
    s_nop 0
    v_add_f32_dpp v12, v12, v12 row_ror:2 row_mask:0xf bank_mask:0xf
    v_cvt_pk_bf16_f32 v106, v116, v117
    s_nop 0
    v_add_f32_dpp v12, v12, v12 row_ror:1 row_mask:0xf bank_mask:0xf
    v_cvt_pk_bf16_f32 v107, v118, v119
    v_mov_b32 v36, v12
    v_cvt_pk_bf16_f32 v108, v120, v121
    s_nop 0
    v_permlane16_swap_b32 v12, v36
    v_cvt_pk_bf16_f32 v109, v122, v123
    v_add_f32 v12, v12, v36
    v_cvt_pk_bf16_f32 v110, v124, v125
    v_mov_b32 v36, v12
    v_cvt_pk_bf16_f32 v111, v126, v127
    s_nop 0
    v_permlane32_swap_b32 v12, v36
    v_lshlrev_b32 v112, 16, v104
    v_add_f32 v12, v12, v36
    v_and_b32 v113, 0xffff0000, v104
    v_mul_f32 v12, 0x3a800000, v12
    v_lshlrev_b32 v114, 16, v105
    v_fma_f32 v12, -v34, v34, v12
    v_and_b32 v115, 0xffff0000, v105
    v_max_f32 v12, 0, v12
    v_lshlrev_b32 v116, 16, v106
    v_cvt_pk_bf16_f32 v12, v12, v12
    v_and_b32 v117, 0xffff0000, v106
    v_and_b32 v12, 0xffff0000, v12
    v_lshlrev_b32 v118, 16, v107
    v_add_f32 v12, 0x3727c5ac, v12
    v_and_b32 v119, 0xffff0000, v107
    v_cvt_pk_bf16_f32 v12, v12, v12
    v_lshlrev_b32 v120, 16, v108
    v_and_b32 v12, 0xffff0000, v12
    v_and_b32 v121, 0xffff0000, v108
    v_sqrt_f32 v15, v12
    v_lshlrev_b32 v122, 16, v109
    v_cvt_pk_bf16_f32 v15, v15, v15
    v_and_b32 v123, 0xffff0000, v109
    v_and_b32 v15, 0xffff0000, v15
    v_lshlrev_b32 v124, 16, v110
    v_rcp_f32 v12, v15
    v_and_b32 v125, 0xffff0000, v110
    v_sub_f32 v14, 0, v14
    v_lshlrev_b32 v126, 16, v111
    v_and_b32 v127, 0xffff0000, v111
    v_mul_f32 v112, v112, v12
    v_mul_f32 v113, v113, v12
    v_mul_f32 v114, v114, v12
    v_mul_f32 v115, v115, v12
    v_mul_f32 v116, v116, v12
    v_mul_f32 v117, v117, v12
    v_mul_f32 v118, v118, v12
    v_mul_f32 v119, v119, v12
    v_mul_f32 v120, v120, v12
    v_mul_f32 v121, v121, v12
    v_mul_f32 v122, v122, v12
    v_mul_f32 v123, v123, v12
    v_mul_f32 v124, v124, v12
    v_mul_f32 v125, v125, v12
    v_mul_f32 v126, v126, v12
    v_mul_f32 v127, v127, v12
    v_cvt_pk_bf16_f32 v104, v112, v113
    v_cvt_pk_bf16_f32 v105, v114, v115
    v_cvt_pk_bf16_f32 v106, v116, v117
    v_cvt_pk_bf16_f32 v107, v118, v119
    v_cvt_pk_bf16_f32 v108, v120, v121
    v_cvt_pk_bf16_f32 v109, v122, v123
    v_cvt_pk_bf16_f32 v110, v124, v125
    v_cvt_pk_bf16_f32 v111, v126, v127
    buffer_store_dwordx4 v[104:107], v2, s[20:23], s3 offen offset:0 sc1
    buffer_store_dwordx4 v[108:111], v2, s[20:23], s3 offen offset:1024 sc1
    v_lshrrev_b32 v14, 16, v14
    v_or_b32 v14, v14, v15
    s_waitcnt vmcnt(6)
    s_mov_b32 s5, 0x9E3779B1
    v_mul_lo_u32 v33, v33, s5
    v_add_u32 v33, 0x7F4A7C15, v33
    s_nop 0
    v_readfirstlane_b32 s58, v33
    v_mov_b32 v15, v33
    s_waitcnt vmcnt(2)
    s_barrier
    ds_read_b128 v[40:43], v8 offset:0
    ds_read_b64_tr_b16 v[88:89], v10 offset:128
    ds_read_b64_tr_b16 v[90:91], v10 offset:3712
    ds_read_b128 v[56:59], v9 offset:0
    ds_read_b64_tr_b16 v[72:73], v10 offset:7424
    ds_read_b64_tr_b16 v[74:75], v10 offset:11008
    ds_read_b128 v[60:63], v9 offset:2048
    ds_read_b128 v[44:47], v8 offset:2048
    ds_read_b128 v[48:51], v8 offset:4096
    ds_read_b128 v[64:67], v9 offset:4096
    ds_read_b128 v[68:71], v9 offset:6144
    ds_read_b128 v[52:55], v8 offset:6144
    ds_read_b64_tr_b16 v[76:77], v10 offset:160
    ds_read_b64_tr_b16 v[78:79], v10 offset:3744
    ds_read_b64_tr_b16 v[80:81], v10 offset:7456
    ds_read_b64_tr_b16 v[82:83], v10 offset:11040
    s_waitcnt lgkmcnt(10)
    v_mfma_f32_16x16x32_bf16 v[128:131], v[88:91], v[40:43], 0
    s_setprio 1
    ds_read_b64_tr_b16 v[84:85], v10 offset:192
    s_add_u32 m0, s28, 32768
    v_mfma_f32_16x16x32_bf16 v[128:131], v[72:75], v[56:59], v[128:131]
    s_setprio 0
    ds_read_b64_tr_b16 v[86:87], v10 offset:3776
    buffer_load_dwordx4 v4, s[8:11], s64 offen offset:0 sc1 lds
    s_waitcnt lgkmcnt(10)
    v_mfma_f32_16x16x32_bf16 v[132:135], v[72:75], v[60:63], 0
    s_setprio 1
    s_add_u32 m0, s28, 32768
    v_mfma_f32_16x16x32_bf16 v[132:135], v[88:91], v[44:47], v[132:135]
    s_setprio 0
    buffer_load_dwordx4 v5, s[8:11], s64 offen offset:1024 sc1 lds
    s_waitcnt lgkmcnt(8)
    v_mfma_f32_16x16x32_bf16 v[136:139], v[88:91], v[48:51], 0
    s_setprio 1
    s_add_u32 m0, s28, 32768
    v_mfma_f32_16x16x32_bf16 v[136:139], v[72:75], v[64:67], v[136:139]
    s_setprio 0
    buffer_load_dwordx4 v4, s[8:11], s66 offen offset:2048 sc1 lds
    s_waitcnt lgkmcnt(6)
    v_mfma_f32_16x16x32_bf16 v[140:143], v[72:75], v[68:71], 0
    s_setprio 1
    s_add_u32 m0, s28, 32768
    v_mfma_f32_16x16x32_bf16 v[140:143], v[88:91], v[52:55], v[140:143]
    s_setprio 0
    ds_read_b64_tr_b16 v[88:89], v10 offset:7488
    buffer_load_dwordx4 v5, s[8:11], s66 offen offset:3072 sc1 lds
    s_waitcnt lgkmcnt(3)
    v_mfma_f32_16x16x32_bf16 v[172:175], v[76:79], v[52:55], 0
    s_setprio 1
    ds_read_b64_tr_b16 v[90:91], v10 offset:11072
    s_add_u32 s64, s64, 128
    s_bitset0_b32 s64, 11
    s_add_u32 m0, s28, 123904
    v_mfma_f32_16x16x32_bf16 v[172:175], v[80:83], v[68:71], v[172:175]
    s_setprio 0
    s_add_u32 s66, s64, 30720
    buffer_load_dwordx4 v4, s[8:11], s64 offen offset:0 sc1 lds
    s_waitcnt lgkmcnt(0)
    s_barrier
    v_mfma_f32_16x16x32_bf16 v[168:171], v[80:83], v[64:67], 0
    s_setprio 1
    ds_read_b64_tr_b16 v[72:73], v10 offset:14720
    s_add_u32 m0, s28, 123904
    v_mfma_f32_16x16x32_bf16 v[168:171], v[76:79], v[48:51], v[168:171]
    s_setprio 0
    ds_read_b64_tr_b16 v[74:75], v10 offset:18304
    buffer_load_dwordx4 v5, s[8:11], s64 offen offset:1024 sc1 lds
    v_mfma_f32_16x16x32_bf16 v[164:167], v[76:79], v[44:47], 0
    s_setprio 1
    s_add_u32 m0, s28, 123904
    v_mfma_f32_16x16x32_bf16 v[164:167], v[80:83], v[60:63], v[164:167]
    s_setprio 0
    buffer_load_dwordx4 v4, s[8:11], s66 offen offset:2048 sc1 lds
    v_mfma_f32_16x16x32_bf16 v[160:163], v[80:83], v[56:59], 0
    s_setprio 1
    s_add_u32 m0, s28, 123904
    v_mfma_f32_16x16x32_bf16 v[160:163], v[76:79], v[40:43], v[160:163]
    s_setprio 0
    ds_read_b64_tr_b16 v[76:77], v10 offset:22016
    buffer_load_dwordx4 v5, s[8:11], s66 offen offset:3072 sc1 lds
    v_mfma_f32_16x16x32_bf16 v[192:195], v[84:87], v[40:43], 0
    s_setprio 1
    ds_read_b64_tr_b16 v[78:79], v10 offset:25600
    s_add_u32 s64, s64, 128
    s_bitset0_b32 s64, 11
    v_mfma_f32_16x16x32_bf16 v[192:195], v[88:91], v[56:59], v[192:195]
    s_setprio 0
    s_add_u32 s66, s64, 30720
    ds_read_b64_tr_b16 v[80:81], v10 offset:14752
    v_mfma_f32_16x16x32_bf16 v[196:199], v[88:91], v[60:63], 0
    s_setprio 1
    ds_read_b64_tr_b16 v[82:83], v10 offset:18336
    s_add_u32 s64, s64, 128
    s_bitset0_b32 s64, 11
    v_mfma_f32_16x16x32_bf16 v[196:199], v[84:87], v[44:47], v[196:199]
    s_setprio 0
    s_add_u32 s66, s64, 30720
    v_mfma_f32_16x16x32_bf16 v[200:203], v[84:87], v[48:51], 0
    s_setprio 1
    v_mfma_f32_16x16x32_bf16 v[200:203], v[88:91], v[64:67], v[200:203]
    s_setprio 0
    v_mfma_f32_16x16x32_bf16 v[204:207], v[88:91], v[68:71], 0
    s_setprio 1
    v_mfma_f32_16x16x32_bf16 v[204:207], v[84:87], v[52:55], v[204:207]
    s_setprio 0
    ds_read_b64_tr_b16 v[84:85], v10 offset:22048
    s_waitcnt lgkmcnt(3)
    v_mfma_f32_16x16x32_bf16 v[156:159], v[72:75], v[52:55], 0
    s_setprio 1
    ds_read_b64_tr_b16 v[86:87], v10 offset:25632
    v_mfma_f32_16x16x32_bf16 v[156:159], v[76:79], v[68:71], v[156:159]
    s_setprio 0
    ds_read_b64_tr_b16 v[88:89], v10 offset:14784
    v_mfma_f32_16x16x32_bf16 v[152:155], v[76:79], v[64:67], 0
    s_setprio 1
    ds_read_b64_tr_b16 v[90:91], v10 offset:18368
    v_mfma_f32_16x16x32_bf16 v[152:155], v[72:75], v[48:51], v[152:155]
    s_setprio 0
    v_mfma_f32_16x16x32_bf16 v[148:151], v[72:75], v[44:47], 0
    s_setprio 1
    v_mfma_f32_16x16x32_bf16 v[148:151], v[76:79], v[60:63], v[148:151]
    s_setprio 0
    v_mfma_f32_16x16x32_bf16 v[144:147], v[76:79], v[56:59], 0
    s_setprio 1
    v_mfma_f32_16x16x32_bf16 v[144:147], v[72:75], v[40:43], v[144:147]
    s_setprio 0
    s_waitcnt vmcnt(8)
    s_lshr_b32 s3, s3, 8
    s_add_u32 s3, s3, 3211264
    s_mov_b64 exec, 1
    buffer_store_dwordx2 v[14:15], off, s[24:27], s3 sc1
    s_mov_b64 exec, -1
    ds_read_b64_tr_b16 v[72:73], v10 offset:22080
    s_waitcnt lgkmcnt(3)
    v_mfma_f32_16x16x32_bf16 v[176:179], v[80:83], v[40:43], 0
    s_setprio 1
    ds_read_b64_tr_b16 v[74:75], v10 offset:25664
    v_mfma_f32_16x16x32_bf16 v[176:179], v[84:87], v[56:59], v[176:179]
    s_setprio 0
    s_waitcnt vmcnt(5) lgkmcnt(0)
    s_barrier
    v_mfma_f32_16x16x32_bf16 v[180:183], v[84:87], v[60:63], 0
    s_setprio 1
    ds_read_b64_tr_b16 v[76:77], v10 offset:29312
    v_mfma_f32_16x16x32_bf16 v[180:183], v[80:83], v[44:47], v[180:183]
    s_setprio 0
    ds_read_b64_tr_b16 v[78:79], v10 offset:32896
    v_mfma_f32_16x16x32_bf16 v[184:187], v[80:83], v[48:51], 0
    s_setprio 1
    v_mfma_f32_16x16x32_bf16 v[184:187], v[84:87], v[64:67], v[184:187]
    s_setprio 0
    v_mfma_f32_16x16x32_bf16 v[188:191], v[84:87], v[68:71], 0
    s_setprio 1
    v_mfma_f32_16x16x32_bf16 v[188:191], v[80:83], v[52:55], v[188:191]
    s_setprio 0
    ds_read_b64_tr_b16 v[80:81], v10 offset:36608
    global_load_dword v20, v[22:23], off
    v_add_co_u32 v22, vcc, 917504, v22
    s_nop 1
    v_addc_co_u32 v23, vcc, 0, v23, vcc
    v_mfma_f32_16x16x32_bf16 v[220:223], v[88:91], v[52:55], 0
    s_setprio 1
    ds_read_b128 v[52:55], v8 offset:38912
    ds_read_b64_tr_b16 v[82:83], v10 offset:40192
    v_mfma_f32_16x16x32_bf16 v[220:223], v[72:75], v[68:71], v[220:223]
    s_setprio 0
    ds_read_b128 v[68:71], v9 offset:38912
    ds_read_b64_tr_b16 v[84:85], v10 offset:29344
    v_mfma_f32_16x16x32_bf16 v[216:219], v[72:75], v[64:67], 0
    s_setprio 1
    ds_read_b128 v[64:67], v9 offset:36864
    ds_read_b64_tr_b16 v[86:87], v10 offset:32928
    v_mfma_f32_16x16x32_bf16 v[216:219], v[88:91], v[48:51], v[216:219]
    s_setprio 0
    ds_read_b128 v[48:51], v8 offset:36864
    v_mfma_f32_16x16x32_bf16 v[212:215], v[88:91], v[44:47], 0
    s_setprio 1
    ds_read_b128 v[44:47], v8 offset:34816
    v_mfma_f32_16x16x32_bf16 v[212:215], v[72:75], v[60:63], v[212:215]
    s_setprio 0
    ds_read_b128 v[60:63], v9 offset:34816
    v_mfma_f32_16x16x32_bf16 v[208:211], v[72:75], v[56:59], 0
    s_setprio 1
    ds_read_b128 v[56:59], v9 offset:32768
    v_mfma_f32_16x16x32_bf16 v[208:211], v[88:91], v[40:43], v[208:211]
    s_setprio 0
    ds_read_b128 v[40:43], v8 offset:32768
    ds_read_b64_tr_b16 v[88:89], v10 offset:36640
    s_waitcnt lgkmcnt(9)
    v_mfma_f32_16x16x32_bf16 v[140:143], v[76:79], v[52:55], v[140:143]
    s_setprio 1
    ds_read_b64_tr_b16 v[90:91], v10 offset:40224
    v_mfma_f32_16x16x32_bf16 v[140:143], v[80:83], v[68:71], v[140:143]
    s_setprio 0
    ds_read_b64_tr_b16 v[72:73], v10 offset:29376
    s_waitcnt lgkmcnt(7)
    v_mfma_f32_16x16x32_bf16 v[136:139], v[80:83], v[64:67], v[136:139]
    s_setprio 1
    ds_read_b64_tr_b16 v[74:75], v10 offset:32960
    v_mfma_f32_16x16x32_bf16 v[136:139], v[76:79], v[48:51], v[136:139]
    s_setprio 0
    s_waitcnt lgkmcnt(6)
    v_mfma_f32_16x16x32_bf16 v[132:135], v[76:79], v[44:47], v[132:135]
    s_setprio 1
    v_mfma_f32_16x16x32_bf16 v[132:135], v[80:83], v[60:63], v[132:135]
    s_setprio 0
    s_waitcnt lgkmcnt(4)
    v_mfma_f32_16x16x32_bf16 v[128:131], v[80:83], v[56:59], v[128:131]
    s_setprio 1
    v_mfma_f32_16x16x32_bf16 v[128:131], v[76:79], v[40:43], v[128:131]
    s_setprio 0
    ds_read_b64_tr_b16 v[76:77], v10 offset:36672
    s_waitcnt lgkmcnt(3)
    v_mfma_f32_16x16x32_bf16 v[160:163], v[84:87], v[40:43], v[160:163]
    s_setprio 1
    ds_read_b64_tr_b16 v[78:79], v10 offset:40256
    v_mfma_f32_16x16x32_bf16 v[160:163], v[88:91], v[56:59], v[160:163]
    s_setprio 0
    s_waitcnt lgkmcnt(0)
    s_barrier
    v_mfma_f32_16x16x32_bf16 v[164:167], v[88:91], v[60:63], v[164:167]
    s_setprio 1
    ds_read_b64_tr_b16 v[80:81], v10 offset:43904
    v_mfma_f32_16x16x32_bf16 v[164:167], v[84:87], v[44:47], v[164:167]
    s_setprio 0
    ds_read_b64_tr_b16 v[82:83], v10 offset:47488
    v_mfma_f32_16x16x32_bf16 v[168:171], v[84:87], v[48:51], v[168:171]
    s_setprio 1
    v_mfma_f32_16x16x32_bf16 v[168:171], v[88:91], v[64:67], v[168:171]
    s_setprio 0
    v_mfma_f32_16x16x32_bf16 v[172:175], v[88:91], v[68:71], v[172:175]
    s_setprio 1
    v_mfma_f32_16x16x32_bf16 v[172:175], v[84:87], v[52:55], v[172:175]
    s_setprio 0
    ds_read_b64_tr_b16 v[84:85], v10 offset:51200
    buffer_load_dword v20, v21, s[76:79], s39 offen
    s_add_u32 s39, s39, 0x180000
    v_mfma_f32_16x16x32_bf16 v[204:207], v[72:75], v[52:55], v[204:207]
    s_setprio 1
    ds_read_b64_tr_b16 v[86:87], v10 offset:54784
    v_mfma_f32_16x16x32_bf16 v[204:207], v[76:79], v[68:71], v[204:207]
    s_setprio 0
    ds_read_b64_tr_b16 v[88:89], v10 offset:43936
    v_mfma_f32_16x16x32_bf16 v[200:203], v[76:79], v[64:67], v[200:203]
    s_setprio 1
    ds_read_b64_tr_b16 v[90:91], v10 offset:47520
    v_mfma_f32_16x16x32_bf16 v[200:203], v[72:75], v[48:51], v[200:203]
    s_setprio 0
    v_mfma_f32_16x16x32_bf16 v[196:199], v[72:75], v[44:47], v[196:199]
    s_setprio 1
    v_mfma_f32_16x16x32_bf16 v[196:199], v[76:79], v[60:63], v[196:199]
    s_setprio 0
    v_mfma_f32_16x16x32_bf16 v[192:195], v[76:79], v[56:59], v[192:195]
    s_setprio 1
    v_mfma_f32_16x16x32_bf16 v[192:195], v[72:75], v[40:43], v[192:195]
    s_setprio 0
    ds_read_b64_tr_b16 v[72:73], v10 offset:51232
    s_waitcnt lgkmcnt(3)
    v_mfma_f32_16x16x32_bf16 v[144:147], v[80:83], v[40:43], v[144:147]
    s_setprio 1
    ds_read_b64_tr_b16 v[74:75], v10 offset:54816
    v_mfma_f32_16x16x32_bf16 v[144:147], v[84:87], v[56:59], v[144:147]
    s_setprio 0
    ds_read_b64_tr_b16 v[76:77], v10 offset:43968
    v_mfma_f32_16x16x32_bf16 v[148:151], v[84:87], v[60:63], v[148:151]
    s_setprio 1
    ds_read_b64_tr_b16 v[78:79], v10 offset:47552
    v_mfma_f32_16x16x32_bf16 v[148:151], v[80:83], v[44:47], v[148:151]
    s_setprio 0
    v_mfma_f32_16x16x32_bf16 v[152:155], v[80:83], v[48:51], v[152:155]
    s_setprio 1
    v_mfma_f32_16x16x32_bf16 v[152:155], v[84:87], v[64:67], v[152:155]
    s_setprio 0
    buffer_load_dwordx4 v[96:99], v2, s[24:27], s38 offen offset:0 sc1
    buffer_load_dwordx4 v[100:103], v2, s[24:27], s38 offen offset:1024 sc1
    v_mfma_f32_16x16x32_bf16 v[156:159], v[84:87], v[68:71], v[156:159]
    s_setprio 1
    v_mfma_f32_16x16x32_bf16 v[156:159], v[80:83], v[52:55], v[156:159]
    s_setprio 0
    ds_read_b64_tr_b16 v[80:81], v10 offset:51264
    s_waitcnt lgkmcnt(3)
    v_mfma_f32_16x16x32_bf16 v[188:191], v[88:91], v[52:55], v[188:191]
    s_setprio 1
    ds_read_b64_tr_b16 v[82:83], v10 offset:54848
    v_mfma_f32_16x16x32_bf16 v[188:191], v[72:75], v[68:71], v[188:191]
    s_setprio 0
    s_waitcnt vmcnt(5) lgkmcnt(0)
    s_barrier
    v_mfma_f32_16x16x32_bf16 v[184:187], v[72:75], v[64:67], v[184:187]
    s_setprio 1
    ds_read_b64_tr_b16 v[84:85], v10 offset:128
    v_mfma_f32_16x16x32_bf16 v[184:187], v[88:91], v[48:51], v[184:187]
    s_setprio 0
    ds_read_b64_tr_b16 v[86:87], v10 offset:3712
    v_mfma_f32_16x16x32_bf16 v[180:183], v[88:91], v[44:47], v[180:183]
    s_setprio 1
    v_mfma_f32_16x16x32_bf16 v[180:183], v[72:75], v[60:63], v[180:183]
    s_setprio 0
    v_mfma_f32_16x16x32_bf16 v[176:179], v[72:75], v[56:59], v[176:179]
    s_setprio 1
    v_mfma_f32_16x16x32_bf16 v[176:179], v[88:91], v[40:43], v[176:179]
    s_setprio 0
    ds_read_b64_tr_b16 v[88:89], v10 offset:7424
    global_load_dword v20, v[22:23], off
    v_add_co_u32 v22, vcc, 917504, v22
    s_nop 1
    v_addc_co_u32 v23, vcc, 0, v23, vcc
    v_mfma_f32_16x16x32_bf16 v[208:211], v[76:79], v[40:43], v[208:211]
    s_setprio 1
    ds_read_b128 v[40:43], v94 offset:0
    ds_read_b64_tr_b16 v[90:91], v10 offset:11008
    v_mfma_f32_16x16x32_bf16 v[208:211], v[80:83], v[56:59], v[208:211]
    s_setprio 0
    ds_read_b128 v[56:59], v95 offset:0
    ds_read_b64_tr_b16 v[72:73], v10 offset:160
    v_mfma_f32_16x16x32_bf16 v[212:215], v[80:83], v[60:63], v[212:215]
    s_setprio 1
    ds_read_b128 v[60:63], v95 offset:2048
    ds_read_b64_tr_b16 v[74:75], v10 offset:3744
    v_mfma_f32_16x16x32_bf16 v[212:215], v[76:79], v[44:47], v[212:215]
    s_setprio 0
    ds_read_b128 v[44:47], v94 offset:2048
    v_mfma_f32_16x16x32_bf16 v[216:219], v[76:79], v[48:51], v[216:219]
    s_setprio 1
    ds_read_b128 v[48:51], v94 offset:4096
    v_mfma_f32_16x16x32_bf16 v[216:219], v[80:83], v[64:67], v[216:219]
    s_setprio 0
    ds_read_b128 v[64:67], v95 offset:4096
    v_mfma_f32_16x16x32_bf16 v[220:223], v[80:83], v[68:71], v[220:223]
    s_setprio 1
    ds_read_b128 v[68:71], v95 offset:6144
    v_mfma_f32_16x16x32_bf16 v[220:223], v[76:79], v[52:55], v[220:223]
    s_setprio 0
    ds_read_b128 v[52:55], v94 offset:6144
    ds_read_b64_tr_b16 v[76:77], v10 offset:7456
    s_waitcnt lgkmcnt(9)
    v_mfma_f32_16x16x32_bf16 v[128:131], v[84:87], v[40:43], v[128:131]
    s_setprio 1
    ds_read_b64_tr_b16 v[78:79], v10 offset:11040
    v_mfma_f32_16x16x32_bf16 v[128:131], v[88:91], v[56:59], v[128:131]
    s_setprio 0
    ds_read_b64_tr_b16 v[80:81], v10 offset:192
    s_waitcnt lgkmcnt(7)
    v_mfma_f32_16x16x32_bf16 v[132:135], v[88:91], v[60:63], v[132:135]
    s_setprio 1
    ds_read_b64_tr_b16 v[82:83], v10 offset:3776
    v_mfma_f32_16x16x32_bf16 v[132:135], v[84:87], v[44:47], v[132:135]
    s_setprio 0
    s_waitcnt vmcnt(1)
    s_mov_b32 s7, 0
L_lnp:
    v_cmp_ne_u32 s[80:81], s58, v97
    v_cmp_ne_u32 s[82:83], s58, v99
    v_cmp_ne_u32 s[4:5], s58, v101
    v_cmp_ne_u32 vcc, s58, v103
    s_or_b64 s[80:81], s[80:81], s[82:83]
    s_or_b64 vcc, vcc, s[4:5]
    s_or_b64 vcc, vcc, s[80:81]
    s_cbranch_scc0 L_lnp_ok
    s_add_u32 s7, s7, 1
    s_cmp_ge_u32 s7, 0x20000
    s_cbranch_scc1 L_lnp_ok
    s_sleep 1
    buffer_load_dwordx4 v[96:99], v2, s[24:27], s38 offen offset:0 sc1
    buffer_load_dwordx4 v[100:103], v2, s[24:27], s38 offen offset:1024 sc1
    s_waitcnt vmcnt(0)
    s_branch L_lnp
L_lnp_ok:
    v_and_b32 v97, 0xffff0000, v96
    v_and_b32 v99, 0xffff0000, v98
    v_and_b32 v101, 0xffff0000, v100
    v_and_b32 v103, 0xffff0000, v102
    v_rcp_f32 v97, v97
    v_rcp_f32 v99, v99
    v_rcp_f32 v101, v101
    v_rcp_f32 v103, v103
    v_lshlrev_b32 v96, 16, v96
    v_lshlrev_b32 v98, 16, v98
    v_lshlrev_b32 v100, 16, v100
    v_lshlrev_b32 v102, 16, v102
    v_add_u32 v19, 156672, v2
    v_mul_f32 v96, v96, v97
    v_mul_f32 v98, v98, v99
    v_mul_f32 v100, v100, v101
    v_mul_f32 v102, v102, v103
    ds_write_b128 v19, v[96:99] offset:0
    ds_write_b128 v19, v[100:103] offset:1024
    s_waitcnt lgkmcnt(8)
    v_mfma_f32_16x16x32_bf16 v[136:139], v[84:87], v[48:51], v[136:139]
    s_setprio 1
    v_mfma_f32_16x16x32_bf16 v[136:139], v[88:91], v[64:67], v[136:139]
    s_setprio 0
    s_waitcnt lgkmcnt(6)
    v_mfma_f32_16x16x32_bf16 v[140:143], v[88:91], v[68:71], v[140:143]
    s_setprio 1
    v_mfma_f32_16x16x32_bf16 v[140:143], v[84:87], v[52:55], v[140:143]
    s_setprio 0
    ds_read_b64_tr_b16 v[84:85], v10 offset:7488
    s_waitcnt lgkmcnt(5)
    v_mfma_f32_16x16x32_bf16 v[172:175], v[72:75], v[52:55], v[172:175]
    s_setprio 1
    ds_read_b64_tr_b16 v[86:87], v10 offset:11072
    v_mfma_f32_16x16x32_bf16 v[172:175], v[76:79], v[68:71], v[172:175]
    s_setprio 0
    s_waitcnt lgkmcnt(0)
    s_barrier
    v_mfma_f32_16x16x32_bf16 v[168:171], v[76:79], v[64:67], v[168:171]
    s_setprio 1
    ds_read_b64_tr_b16 v[88:89], v10 offset:14720
    v_mfma_f32_16x16x32_bf16 v[168:171], v[72:75], v[48:51], v[168:171]
    s_setprio 0
    s_mov_b64 s[8:9], s[56:57]
    v_mov_b32 v236, 0
    ds_read_b64_tr_b16 v[90:91], v10 offset:18304
    v_mov_b32 v237, 0
    v_mfma_f32_16x16x32_bf16 v[164:167], v[72:75], v[44:47], v[164:167]
    s_setprio 1
    v_mfma_f32_16x16x32_bf16 v[164:167], v[76:79], v[60:63], v[164:167]
    s_setprio 0
    v_mov_b32 v238, 0
    v_mfma_f32_16x16x32_bf16 v[160:163], v[76:79], v[56:59], v[160:163]
    s_setprio 1
    v_mfma_f32_16x16x32_bf16 v[160:163], v[72:75], v[40:43], v[160:163]
    s_setprio 0
    ds_read_b64_tr_b16 v[72:73], v10 offset:22016
    v_mov_b32 v239, 0
    v_mfma_f32_16x16x32_bf16 v[192:195], v[80:83], v[40:43], v[192:195]
    s_setprio 1
    ds_read_b64_tr_b16 v[74:75], v10 offset:25600
    v_mfma_f32_16x16x32_bf16 v[192:195], v[84:87], v[56:59], v[192:195]
    s_setprio 0
    ds_read_b64_tr_b16 v[76:77], v10 offset:14752
    v_mov_b32 v232, 0
    v_mfma_f32_16x16x32_bf16 v[196:199], v[84:87], v[60:63], v[196:199]
    s_setprio 1
    ds_read_b64_tr_b16 v[78:79], v10 offset:18336
    v_mfma_f32_16x16x32_bf16 v[196:199], v[80:83], v[44:47], v[196:199]
    s_setprio 0
    v_mov_b32 v233, 0
    v_mfma_f32_16x16x32_bf16 v[200:203], v[80:83], v[48:51], v[200:203]
    s_setprio 1
    v_mfma_f32_16x16x32_bf16 v[200:203], v[84:87], v[64:67], v[200:203]
    s_setprio 0
    v_mov_b32 v234, 0
    v_mfma_f32_16x16x32_bf16 v[204:207], v[84:87], v[68:71], v[204:207]
    s_setprio 1
    v_mfma_f32_16x16x32_bf16 v[204:207], v[80:83], v[52:55], v[204:207]
    s_setprio 0
    ds_read_b64_tr_b16 v[80:81], v10 offset:22048
    v_mov_b32 v235, 0
    s_waitcnt lgkmcnt(3)
    v_mfma_f32_16x16x32_bf16 v[156:159], v[88:91], v[52:55], v[156:159]
    s_setprio 1
    ds_read_b64_tr_b16 v[82:83], v10 offset:25632
    v_mfma_f32_16x16x32_bf16 v[156:159], v[72:75], v[68:71], v[156:159]
    s_setprio 0
    ds_read_b64_tr_b16 v[84:85], v10 offset:14784
    v_mov_b32 v228, 0
    v_mfma_f32_16x16x32_bf16 v[152:155], v[72:75], v[64:67], v[152:155]
    s_setprio 1
    ds_read_b64_tr_b16 v[86:87], v10 offset:18368
    v_mfma_f32_16x16x32_bf16 v[152:155], v[88:91], v[48:51], v[152:155]
    s_setprio 0
    v_mov_b32 v229, 0
    v_mfma_f32_16x16x32_bf16 v[148:151], v[88:91], v[44:47], v[148:151]
    s_setprio 1
    v_mfma_f32_16x16x32_bf16 v[148:151], v[72:75], v[60:63], v[148:151]
    s_setprio 0
    v_mov_b32 v230, 0
    v_mfma_f32_16x16x32_bf16 v[144:147], v[72:75], v[56:59], v[144:147]
    s_setprio 1
    v_mfma_f32_16x16x32_bf16 v[144:147], v[88:91], v[40:43], v[144:147]
    s_setprio 0
    ds_read_b64_tr_b16 v[88:89], v10 offset:22080
    v_mov_b32 v231, 0
    s_waitcnt lgkmcnt(3)
    v_mfma_f32_16x16x32_bf16 v[176:179], v[76:79], v[40:43], v[176:179]
    s_setprio 1
    ds_read_b64_tr_b16 v[90:91], v10 offset:25664
    v_mfma_f32_16x16x32_bf16 v[176:179], v[80:83], v[56:59], v[176:179]
    s_setprio 0
    v_mov_b32 v224, 0
    s_waitcnt lgkmcnt(0)
    s_barrier
    v_mfma_f32_16x16x32_bf16 v[180:183], v[80:83], v[60:63], v[180:183]
    s_setprio 1
    ds_read_b64_tr_b16 v[72:73], v10 offset:29312
    s_add_u32 s64, s64, 128
    s_bitset0_b32 s64, 11
    v_mfma_f32_16x16x32_bf16 v[180:183], v[76:79], v[44:47], v[180:183]
    s_setprio 0
    s_add_u32 s66, s64, 30720
    ds_read_b64_tr_b16 v[74:75], v10 offset:32896
    v_mov_b32 v225, 0
    v_mfma_f32_16x16x32_bf16 v[184:187], v[76:79], v[48:51], v[184:187]
    s_setprio 1
    v_mfma_f32_16x16x32_bf16 v[184:187], v[80:83], v[64:67], v[184:187]
    s_setprio 0
    v_mov_b32 v226, 0
    v_mfma_f32_16x16x32_bf16 v[188:191], v[80:83], v[68:71], v[188:191]
    s_setprio 1
    v_mfma_f32_16x16x32_bf16 v[188:191], v[76:79], v[52:55], v[188:191]
    s_setprio 0
    ds_read_b64_tr_b16 v[76:77], v10 offset:36608
    global_load_dword v20, v[22:23], off
    v_add_co_u32 v22, vcc, 917504, v22
    s_nop 1
    v_addc_co_u32 v23, vcc, 0, v23, vcc
    v_mov_b32 v227, 0
    v_mfma_f32_16x16x32_bf16 v[220:223], v[84:87], v[52:55], v[220:223]
    s_setprio 1
    ds_read_b128 v[52:55], v8 offset:6144
    ds_read_b64_tr_b16 v[78:79], v10 offset:40192
    v_mfma_f32_16x16x32_bf16 v[220:223], v[88:91], v[68:71], v[220:223]
    s_setprio 0
    ds_read_b128 v[68:71], v9 offset:6144
    ds_read_b64_tr_b16 v[80:81], v10 offset:29344
    v_mov_b32 v240, 0
    v_mfma_f32_16x16x32_bf16 v[216:219], v[88:91], v[64:67], v[216:219]
    s_setprio 1
    ds_read_b128 v[64:67], v9 offset:4096
    ds_read_b64_tr_b16 v[82:83], v10 offset:32928
    v_mfma_f32_16x16x32_bf16 v[216:219], v[84:87], v[48:51], v[216:219]
    s_setprio 0
    v_mov_b32 v241, 0
    ds_read_b128 v[48:51], v8 offset:4096
    v_mfma_f32_16x16x32_bf16 v[212:215], v[84:87], v[44:47], v[212:215]
    s_setprio 1
    ds_read_b128 v[44:47], v8 offset:2048
    v_mfma_f32_16x16x32_bf16 v[212:215], v[88:91], v[60:63], v[212:215]
    s_setprio 0
    v_mov_b32 v242, 0
    ds_read_b128 v[60:63], v9 offset:2048
    v_mfma_f32_16x16x32_bf16 v[208:211], v[88:91], v[56:59], v[208:211]
    s_setprio 1
    ds_read_b128 v[56:59], v9 offset:0
    v_mfma_f32_16x16x32_bf16 v[208:211], v[84:87], v[40:43], v[208:211]
    s_setprio 0
    v_mov_b32 v243, 0
    ds_read_b128 v[40:43], v8 offset:0
    ds_read_b64_tr_b16 v[84:85], v10 offset:36640
    s_waitcnt lgkmcnt(9)
    v_mfma_f32_16x16x32_bf16 v[140:143], v[72:75], v[52:55], v[140:143]
    s_setprio 1
    ds_read_b64_tr_b16 v[86:87], v10 offset:40224
    v_mfma_f32_16x16x32_bf16 v[140:143], v[76:79], v[68:71], v[140:143]
    s_setprio 0
    v_mov_b32 v244, 0
    ds_read_b64_tr_b16 v[88:89], v10 offset:29376
    s_waitcnt lgkmcnt(7)
    v_mfma_f32_16x16x32_bf16 v[136:139], v[76:79], v[64:67], v[136:139]
    s_setprio 1
    ds_read_b64_tr_b16 v[90:91], v10 offset:32960
    v_mfma_f32_16x16x32_bf16 v[136:139], v[72:75], v[48:51], v[136:139]
    s_setprio 0
    v_mov_b32 v245, 0
    s_waitcnt lgkmcnt(6)
    v_mfma_f32_16x16x32_bf16 v[132:135], v[72:75], v[44:47], v[132:135]
    s_setprio 1
    v_mfma_f32_16x16x32_bf16 v[132:135], v[76:79], v[60:63], v[132:135]
    s_setprio 0
    v_mov_b32 v246, 0
    s_waitcnt lgkmcnt(4)
    v_mfma_f32_16x16x32_bf16 v[128:131], v[76:79], v[56:59], v[128:131]
    s_setprio 1
    v_mfma_f32_16x16x32_bf16 v[128:131], v[72:75], v[40:43], v[128:131]
    s_setprio 0
    v_mov_b32 v247, 0
    ds_read_b64_tr_b16 v[72:73], v10 offset:36672
    s_waitcnt lgkmcnt(3)
    v_mfma_f32_16x16x32_bf16 v[160:163], v[80:83], v[40:43], v[160:163]
    s_setprio 1
    ds_read_b64_tr_b16 v[74:75], v10 offset:40256
    v_mfma_f32_16x16x32_bf16 v[160:163], v[84:87], v[56:59], v[160:163]
    s_setprio 0
    v_mov_b32 v248, 0
    s_waitcnt lgkmcnt(0)
    s_barrier
    v_mfma_f32_16x16x32_bf16 v[164:167], v[84:87], v[60:63], v[164:167]
    s_setprio 1
    ds_read_b64_tr_b16 v[76:77], v10 offset:43904
    v_mfma_f32_16x16x32_bf16 v[164:167], v[80:83], v[44:47], v[164:167]
    s_setprio 0
    v_mov_b32 v249, 0
    ds_read_b64_tr_b16 v[78:79], v10 offset:47488
    ds_read_b64 v[36:37], v26 offset:0
    v_mfma_f32_16x16x32_bf16 v[168:171], v[80:83], v[48:51], v[168:171]
    s_setprio 1
    ds_read_b64 v[38:39], v26 offset:128
    v_mfma_f32_16x16x32_bf16 v[168:171], v[84:87], v[64:67], v[168:171]
    s_setprio 0
    v_mov_b32 v250, 0
    ds_read_b64 v[12:13], v26 offset:256
    v_mfma_f32_16x16x32_bf16 v[172:175], v[84:87], v[68:71], v[172:175]
    s_setprio 1
    ds_read_b64 v[14:15], v26 offset:384
    v_mfma_f32_16x16x32_bf16 v[172:175], v[80:83], v[52:55], v[172:175]
    s_setprio 0
    v_mov_b32 v251, 0
    ds_read_b64_tr_b16 v[80:81], v10 offset:51200
    v_mfma_f32_16x16x32_bf16 v[204:207], v[88:91], v[52:55], v[204:207]
    s_setprio 1
    ds_read_b64_tr_b16 v[82:83], v10 offset:54784
    v_mfma_f32_16x16x32_bf16 v[204:207], v[72:75], v[68:71], v[204:207]
    s_setprio 0
    v_mov_b32 v252, 0
    ds_read_b64_tr_b16 v[84:85], v10 offset:43936
    v_mfma_f32_16x16x32_bf16 v[200:203], v[72:75], v[64:67], v[200:203]
    s_setprio 1
    ds_read_b64_tr_b16 v[86:87], v10 offset:47520
    v_mfma_f32_16x16x32_bf16 v[200:203], v[88:91], v[48:51], v[200:203]
    s_setprio 0
    v_mov_b32 v253, 0
    v_mfma_f32_16x16x32_bf16 v[196:199], v[88:91], v[44:47], v[196:199]
    s_setprio 1
    v_mfma_f32_16x16x32_bf16 v[196:199], v[72:75], v[60:63], v[196:199]
    s_setprio 0
    v_mov_b32 v254, 0
    v_mfma_f32_16x16x32_bf16 v[192:195], v[72:75], v[56:59], v[192:195]
    s_setprio 1
    v_mfma_f32_16x16x32_bf16 v[192:195], v[88:91], v[40:43], v[192:195]
    s_setprio 0
    v_mov_b32 v255, 0
    ds_read_b64_tr_b16 v[88:89], v10 offset:51232
    s_waitcnt lgkmcnt(3)
    v_mfma_f32_16x16x32_bf16 v[144:147], v[76:79], v[40:43], v[144:147]
    s_setprio 1
    ds_read_b64_tr_b16 v[90:91], v10 offset:54816
    v_mfma_f32_16x16x32_bf16 v[144:147], v[80:83], v[56:59], v[144:147]
    s_setprio 0
    ds_read_b64_tr_b16 v[72:73], v10 offset:43968
    v_mfma_f32_16x16x32_bf16 v[148:151], v[80:83], v[60:63], v[148:151]
    s_setprio 1
    ds_read_b64_tr_b16 v[74:75], v10 offset:47552
    v_mfma_f32_16x16x32_bf16 v[148:151], v[76:79], v[44:47], v[148:151]
    s_setprio 0
    v_mul_f32 v140, v140, v15
    v_mul_f32 v141, v141, v15
    v_mul_f32 v142, v142, v15
    v_mfma_f32_16x16x32_bf16 v[152:155], v[76:79], v[48:51], v[152:155]
    s_setprio 1
    v_mfma_f32_16x16x32_bf16 v[152:155], v[80:83], v[64:67], v[152:155]
    s_setprio 0
    v_mul_f32 v143, v143, v15
    v_mul_f32 v136, v136, v13
    v_mul_f32 v137, v137, v13
    v_mul_f32 v138, v138, v13
    v_mul_f32 v139, v139, v13
    v_mfma_f32_16x16x32_bf16 v[156:159], v[80:83], v[68:71], v[156:159]
    s_setprio 1
    v_mfma_f32_16x16x32_bf16 v[156:159], v[76:79], v[52:55], v[156:159]
    s_setprio 0
    v_mul_f32 v132, v132, v39
    v_mul_f32 v133, v133, v39
    ds_read_b64_tr_b16 v[76:77], v10 offset:51264
    v_mul_f32 v134, v134, v39
    v_mul_f32 v135, v135, v39
    s_waitcnt lgkmcnt(3)
    v_mfma_f32_16x16x32_bf16 v[188:191], v[84:87], v[52:55], v[188:191]
    s_setprio 1
    ds_read_b64_tr_b16 v[78:79], v10 offset:54848
    v_mfma_f32_16x16x32_bf16 v[188:191], v[88:91], v[68:71], v[188:191]
    s_setprio 0
    v_mul_f32 v128, v128, v37
    v_mul_f32 v129, v129, v37
    v_mul_f32 v130, v130, v37
    v_mul_f32 v131, v131, v37
    v_mul_f32 v160, v160, v37
    s_waitcnt lgkmcnt(0)
    s_barrier
    v_mfma_f32_16x16x32_bf16 v[184:187], v[88:91], v[64:67], v[184:187]
    s_setprio 1
    ds_read_b64_tr_b16 v[80:81], v10 offset:128
    s_add_u32 s64, s64, 128
    s_bitset0_b32 s64, 11
    v_mfma_f32_16x16x32_bf16 v[184:187], v[84:87], v[48:51], v[184:187]
    s_setprio 0
    s_add_u32 s66, s64, 30720
    v_mul_f32 v161, v161, v37
    v_mul_f32 v162, v162, v37
    v_mul_f32 v163, v163, v37
    ds_read_b64_tr_b16 v[82:83], v10 offset:3712
    v_mul_f32 v164, v164, v39
    v_mul_f32 v165, v165, v39
    v_mfma_f32_16x16x32_bf16 v[180:183], v[84:87], v[44:47], v[180:183]
    s_setprio 1
    v_mfma_f32_16x16x32_bf16 v[180:183], v[88:91], v[60:63], v[180:183]
    s_setprio 0
    v_mul_f32 v166, v166, v39
    v_mul_f32 v167, v167, v39
    v_mul_f32 v168, v168, v13
    v_mul_f32 v169, v169, v13
    v_mul_f32 v170, v170, v13
    v_mfma_f32_16x16x32_bf16 v[176:179], v[88:91], v[56:59], v[176:179]
    s_setprio 1
    v_mfma_f32_16x16x32_bf16 v[176:179], v[84:87], v[40:43], v[176:179]
    s_setprio 0
    v_mul_f32 v171, v171, v13
    v_mul_f32 v172, v172, v15
    ds_read_b64_tr_b16 v[84:85], v10 offset:7424
    global_load_dword v20, v[22:23], off
    v_add_co_u32 v22, vcc, 917504, v22
    s_nop 1
    v_addc_co_u32 v23, vcc, 0, v23, vcc
    v_min_u32 v19, 4096, v7
    s_mul_i32 s5, s2, 4224
    s_add_u32 s5, s5, 2162688
    buffer_load_dword v20, v19, s[24:27], s5 offen sc1
    v_mul_f32 v173, v173, v15
    v_mul_f32 v174, v174, v15
    v_mul_f32 v175, v175, v15
    v_mfma_f32_16x16x32_bf16 v[208:211], v[72:75], v[40:43], v[208:211]
    s_setprio 1
    ds_read_b128 v[40:43], v8 offset:32768
    ds_read_b64_tr_b16 v[86:87], v10 offset:11008
    v_mfma_f32_16x16x32_bf16 v[208:211], v[76:79], v[56:59], v[208:211]
    s_setprio 0
    v_mul_f32 v204, v204, v15
    v_mul_f32 v205, v205, v15
    ds_read_b128 v[56:59], v9 offset:32768
    ds_read_b64_tr_b16 v[88:89], v10 offset:160
    v_mul_f32 v206, v206, v15
    v_mul_f32 v207, v207, v15
    v_mfma_f32_16x16x32_bf16 v[212:215], v[76:79], v[60:63], v[212:215]
    s_setprio 1
    ds_read_b128 v[60:63], v9 offset:34816
    ds_read_b64_tr_b16 v[90:91], v10 offset:3744
    v_mfma_f32_16x16x32_bf16 v[212:215], v[72:75], v[44:47], v[212:215]
    s_setprio 0
    v_mul_f32 v200, v200, v13
    v_mul_f32 v201, v201, v13
    v_mul_f32 v202, v202, v13
    ds_read_b128 v[44:47], v8 offset:34816
    v_mul_f32 v203, v203, v13
    v_mul_f32 v196, v196, v39
    v_mfma_f32_16x16x32_bf16 v[216:219], v[72:75], v[48:51], v[216:219]
    s_setprio 1
    ds_read_b128 v[48:51], v8 offset:36864
    v_mfma_f32_16x16x32_bf16 v[216:219], v[76:79], v[64:67], v[216:219]
    s_setprio 0
    v_mul_f32 v197, v197, v39
    v_mul_f32 v198, v198, v39
    v_mul_f32 v199, v199, v39
    ds_read_b128 v[64:67], v9 offset:36864
    v_mul_f32 v192, v192, v37
    v_mul_f32 v193, v193, v37
    v_mfma_f32_16x16x32_bf16 v[220:223], v[76:79], v[68:71], v[220:223]
    s_setprio 1
    ds_read_b128 v[68:71], v9 offset:38912
    v_mfma_f32_16x16x32_bf16 v[220:223], v[72:75], v[52:55], v[220:223]
    s_setprio 0
    v_mul_f32 v194, v194, v37
    v_mul_f32 v195, v195, v37
    ds_read_b128 v[52:55], v8 offset:38912
    ds_read_b64_tr_b16 v[72:73], v10 offset:7456
    s_waitcnt lgkmcnt(9)
    v_mfma_f32_16x16x32_bf16 v[128:131], v[80:83], v[40:43], v[128:131]
    s_setprio 1
    ds_read_b64_tr_b16 v[74:75], v10 offset:11040
    v_mfma_f32_16x16x32_bf16 v[128:131], v[84:87], v[56:59], v[128:131]
    s_setprio 0
    v_mul_f32 v144, v144, v37
    v_mul_f32 v145, v145, v37
    ds_read_b64_tr_b16 v[76:77], v10 offset:192
    v_mul_f32 v146, v146, v37
    s_waitcnt lgkmcnt(7)
    v_mfma_f32_16x16x32_bf16 v[132:135], v[84:87], v[60:63], v[132:135]
    s_setprio 1
    ds_read_b64_tr_b16 v[78:79], v10 offset:3776
    v_mfma_f32_16x16x32_bf16 v[132:135], v[80:83], v[44:47], v[132:135]
    s_setprio 0
    v_mul_f32 v147, v147, v37
    v_mul_f32 v148, v148, v39
    s_waitcnt lgkmcnt(6)
    v_mfma_f32_16x16x32_bf16 v[136:139], v[80:83], v[48:51], v[136:139]
    s_setprio 1
    v_mfma_f32_16x16x32_bf16 v[136:139], v[84:87], v[64:67], v[136:139]
    s_setprio 0
    v_mul_f32 v149, v149, v39
    v_mul_f32 v150, v150, v39
    v_mul_f32 v151, v151, v39
    s_waitcnt lgkmcnt(4)
    v_mfma_f32_16x16x32_bf16 v[140:143], v[84:87], v[68:71], v[140:143]
    s_setprio 1
    v_mfma_f32_16x16x32_bf16 v[140:143], v[80:83], v[52:55], v[140:143]
    s_setprio 0
    v_mul_f32 v152, v152, v13
    ds_read_b64_tr_b16 v[80:81], v10 offset:7488
    v_mul_f32 v153, v153, v13
    s_waitcnt lgkmcnt(3)
    v_mfma_f32_16x16x32_bf16 v[172:175], v[88:91], v[52:55], v[172:175]
    s_setprio 1
    ds_read_b64_tr_b16 v[82:83], v10 offset:11072
    v_mfma_f32_16x16x32_bf16 v[172:175], v[72:75], v[68:71], v[172:175]
    s_setprio 0
    v_mul_f32 v154, v154, v13
    v_mul_f32 v155, v155, v13
    v_mul_f32 v156, v156, v15
    s_waitcnt lgkmcnt(0)
    s_barrier
    v_mfma_f32_16x16x32_bf16 v[168:171], v[72:75], v[64:67], v[168:171]
    s_setprio 1
    ds_read_b64_tr_b16 v[84:85], v92 offset:34816
    v_mfma_f32_16x16x32_bf16 v[168:171], v[88:91], v[48:51], v[168:171]
    s_setprio 0
    v_mul_f32 v157, v157, v15
    ds_read_b64_tr_b16 v[86:87], v92 offset:35840
    v_mul_f32 v158, v158, v15
    v_mfma_f32_16x16x32_bf16 v[164:167], v[88:91], v[44:47], v[164:167]
    s_setprio 1
    v_mfma_f32_16x16x32_bf16 v[164:167], v[72:75], v[60:63], v[164:167]
    s_setprio 0
    v_mul_f32 v159, v159, v15
    v_mul_f32 v188, v188, v15
    v_mul_f32 v189, v189, v15
    v_mfma_f32_16x16x32_bf16 v[160:163], v[72:75], v[56:59], v[160:163]
    s_setprio 1
    v_mfma_f32_16x16x32_bf16 v[160:163], v[88:91], v[40:43], v[160:163]
    s_setprio 0
    v_mul_f32 v190, v190, v15
    ds_read_b64_tr_b16 v[88:89], v92 offset:40960
    v_mul_f32 v191, v191, v15
    v_mfma_f32_16x16x32_bf16 v[192:195], v[76:79], v[40:43], v[192:195]
    s_setprio 1
    ds_read_b64_tr_b16 v[90:91], v92 offset:41984
    v_mfma_f32_16x16x32_bf16 v[192:195], v[80:83], v[56:59], v[192:195]
    s_setprio 0
    v_mul_f32 v184, v184, v13
    ds_read_b64_tr_b16 v[28:29], v32 offset:34816
    v_mul_f32 v185, v185, v13
    v_mul_f32 v186, v186, v13
    v_mfma_f32_16x16x32_bf16 v[196:199], v[80:83], v[60:63], v[196:199]
    s_setprio 1
    ds_read_b64_tr_b16 v[30:31], v32 offset:35840
    v_mfma_f32_16x16x32_bf16 v[196:199], v[76:79], v[44:47], v[196:199]
    s_setprio 0
    v_mul_f32 v187, v187, v13
    ds_read_b64_tr_b16 v[16:17], v32 offset:40960
    v_mul_f32 v180, v180, v39
    v_mfma_f32_16x16x32_bf16 v[200:203], v[76:79], v[48:51], v[200:203]
    s_setprio 1
    ds_read_b64_tr_b16 v[18:19], v32 offset:41984
    v_mfma_f32_16x16x32_bf16 v[200:203], v[80:83], v[64:67], v[200:203]
    s_setprio 0
    v_mul_f32 v181, v181, v39
    ds_read_b64_tr_b16 v[72:73], v92 offset:36864
    v_mul_f32 v182, v182, v39
    v_mul_f32 v183, v183, v39
    v_mfma_f32_16x16x32_bf16 v[204:207], v[80:83], v[68:71], v[204:207]
    s_setprio 1
    ds_read_b64_tr_b16 v[74:75], v92 offset:37888
    v_mfma_f32_16x16x32_bf16 v[204:207], v[76:79], v[52:55], v[204:207]
    s_setprio 0
    v_mul_f32 v176, v176, v37
    v_mul_f32 v177, v177, v37
    s_waitcnt lgkmcnt(6)
    v_mfma_f32_16x16x32_bf16 v[108:111], v[84:87], v[52:55], 0
    s_setprio 1
    ds_read_b64_tr_b16 v[76:77], v92 offset:43008
    v_mfma_f32_16x16x32_bf16 v[108:111], v[88:91], v[68:71], v[108:111]
    s_setprio 0
    v_mul_f32 v178, v178, v37
    ds_read_b64_tr_b16 v[78:79], v92 offset:44032
    v_mul_f32 v179, v179, v37
    v_mfma_f32_16x16x32_bf16 v[104:107], v[88:91], v[64:67], 0
    s_setprio 1
    v_mfma_f32_16x16x32_bf16 v[104:107], v[84:87], v[48:51], v[104:107]
    s_setprio 0
    v_mul_f32 v208, v208, v37
    v_mul_f32 v209, v209, v37
    v_mul_f32 v210, v210, v37
    v_mfma_f32_16x16x32_bf16 v[100:103], v[84:87], v[44:47], 0
    s_setprio 1
    ds_read_b64_tr_b16 v[80:81], v32 offset:36864
    v_mfma_f32_16x16x32_bf16 v[100:103], v[88:91], v[60:63], v[100:103]
    s_setprio 0
    v_mul_f32 v211, v211, v37
    ds_read_b64_tr_b16 v[82:83], v32 offset:37888
    v_mul_f32 v212, v212, v39
    v_mfma_f32_16x16x32_bf16 v[96:99], v[88:91], v[56:59], 0
    s_setprio 1
    v_mfma_f32_16x16x32_bf16 v[96:99], v[84:87], v[40:43], v[96:99]
    s_setprio 0
    v_mul_f32 v213, v213, v39
    v_mul_f32 v214, v214, v39
    v_mul_f32 v215, v215, v39
    s_waitcnt lgkmcnt(6)
    v_mfma_f32_16x16x32_bf16 v[112:115], v[28:31], v[40:43], 0
    s_setprio 1
    ds_read_b64_tr_b16 v[84:85], v32 offset:43008
    v_mfma_f32_16x16x32_bf16 v[112:115], v[16:19], v[56:59], v[112:115]
    s_setprio 0
    v_mul_f32 v216, v216, v13
    ds_read_b64_tr_b16 v[86:87], v32 offset:44032
    v_mul_f32 v217, v217, v13
    v_mfma_f32_16x16x32_bf16 v[116:119], v[16:19], v[60:63], 0
    s_setprio 1
    v_mfma_f32_16x16x32_bf16 v[116:119], v[28:31], v[44:47], v[116:119]
    s_setprio 0
    v_mul_f32 v218, v218, v13
    v_mul_f32 v219, v219, v13
    v_mul_f32 v220, v220, v15
    v_mfma_f32_16x16x32_bf16 v[120:123], v[28:31], v[48:51], 0
    s_setprio 1
    ds_read_b64_tr_b16 v[88:89], v10 offset:14720
    v_mfma_f32_16x16x32_bf16 v[120:123], v[16:19], v[64:67], v[120:123]
    s_setprio 0
    v_mul_f32 v221, v221, v15
    ds_read_b64_tr_b16 v[90:91], v10 offset:18304
    v_mul_f32 v222, v222, v15
    v_mfma_f32_16x16x32_bf16 v[124:127], v[16:19], v[68:71], 0
    s_setprio 1
    v_mfma_f32_16x16x32_bf16 v[124:127], v[28:31], v[52:55], v[124:127]
    s_setprio 0
    v_mul_f32 v223, v223, v15
    s_nop 1
L_loop7:
    s_waitcnt lgkmcnt(6)
    v_mfma_f32_16x16x32_bf16 v[236:239], v[52:55], v[72:75], v[236:239]
    s_setprio 1
    ds_read_b64_tr_b16 v[28:29], v10 offset:22016
    v_mfma_f32_16x16x32_bf16 v[236:239], v[68:71], v[76:79], v[236:239]
    s_setprio 0
    ds_read_b64_tr_b16 v[30:31], v10 offset:25600
    v_mfma_f32_16x16x32_bf16 v[232:235], v[64:67], v[76:79], v[232:235]
    s_setprio 1
    v_mfma_f32_16x16x32_bf16 v[232:235], v[48:51], v[72:75], v[232:235]
    s_setprio 0
    v_mfma_f32_16x16x32_bf16 v[228:231], v[44:47], v[72:75], v[228:231]
    s_setprio 1
    v_mfma_f32_16x16x32_bf16 v[228:231], v[60:63], v[76:79], v[228:231]
    s_setprio 0
    v_mfma_f32_16x16x32_bf16 v[224:227], v[56:59], v[76:79], v[224:227]
    s_setprio 1
    v_mfma_f32_16x16x32_bf16 v[224:227], v[40:43], v[72:75], v[224:227]
    s_setprio 0
    ds_read_b64_tr_b16 v[72:73], v10 offset:14752
    s_waitcnt lgkmcnt(5)
    v_mfma_f32_16x16x32_bf16 v[240:243], v[40:43], v[80:83], v[240:243]
    s_setprio 1
    ds_read_b64_tr_b16 v[74:75], v10 offset:18336
    v_mfma_f32_16x16x32_bf16 v[240:243], v[56:59], v[84:87], v[240:243]
    s_setprio 0
    ds_read_b64_tr_b16 v[76:77], v10 offset:22048
    v_mfma_f32_16x16x32_bf16 v[244:247], v[60:63], v[84:87], v[244:247]
    s_setprio 1
    ds_read_b64_tr_b16 v[78:79], v10 offset:25632
    v_mfma_f32_16x16x32_bf16 v[244:247], v[44:47], v[80:83], v[244:247]
    s_setprio 0
    v_mfma_f32_16x16x32_bf16 v[248:251], v[48:51], v[80:83], v[248:251]
    s_setprio 1
    v_mfma_f32_16x16x32_bf16 v[248:251], v[64:67], v[84:87], v[248:251]
    s_setprio 0
    v_mfma_f32_16x16x32_bf16 v[252:255], v[68:71], v[84:87], v[252:255]
    s_setprio 1
    v_mfma_f32_16x16x32_bf16 v[252:255], v[52:55], v[80:83], v[252:255]
    s_setprio 0
    ds_read_b64_tr_b16 v[80:81], v10 offset:14784
    s_waitcnt lgkmcnt(5)
    v_mfma_f32_16x16x32_bf16 v[156:159], v[88:91], v[52:55], v[156:159]
    s_setprio 1
    ds_read_b64_tr_b16 v[82:83], v10 offset:18368
    v_mfma_f32_16x16x32_bf16 v[156:159], v[28:31], v[68:71], v[156:159]
    s_setprio 0
    ds_read_b64_tr_b16 v[84:85], v10 offset:22080
    v_mfma_f32_16x16x32_bf16 v[152:155], v[28:31], v[64:67], v[152:155]
    s_setprio 1
    ds_read_b64_tr_b16 v[86:87], v10 offset:25664
    v_mfma_f32_16x16x32_bf16 v[152:155], v[88:91], v[48:51], v[152:155]
    s_setprio 0
    v_mfma_f32_16x16x32_bf16 v[148:151], v[88:91], v[44:47], v[148:151]
    s_setprio 1
    s_add_u32 s64, s64, 128
    s_bitset0_b32 s64, 11
    v_mfma_f32_16x16x32_bf16 v[148:151], v[28:31], v[60:63], v[148:151]
    s_setprio 0
    s_add_u32 s66, s64, 30720
    s_waitcnt lgkmcnt(0)
    s_barrier
    v_mfma_f32_16x16x32_bf16 v[144:147], v[28:31], v[56:59], v[144:147]
    s_setprio 1
    ds_read_b128 v[12:15], v8 offset:6144
    v_mfma_f32_16x16x32_bf16 v[144:147], v[88:91], v[40:43], v[144:147]
    s_setprio 0
    ds_read_b64_tr_b16 v[88:89], v10 offset:29312
    v_mfma_f32_16x16x32_bf16 v[176:179], v[72:75], v[40:43], v[176:179]
    s_setprio 1
    ds_read_b64_tr_b16 v[90:91], v10 offset:32896
    v_mfma_f32_16x16x32_bf16 v[176:179], v[76:79], v[56:59], v[176:179]
    s_setprio 0
    ds_read_b64_tr_b16 v[28:29], v10 offset:36608
    v_mfma_f32_16x16x32_bf16 v[180:183], v[76:79], v[60:63], v[180:183]
    s_setprio 1
    ds_read_b64_tr_b16 v[30:31], v10 offset:40192
    v_mfma_f32_16x16x32_bf16 v[180:183], v[72:75], v[44:47], v[180:183]
    s_setprio 0
    ds_read_b128 v[36:39], v9 offset:6144
    s_bitcmp1_b32 0x1f, s36
    s_cbranch_scc1 L_h7p0_27
L_r7p0_27:
    v_mfma_f32_16x16x32_bf16 v[184:187], v[72:75], v[48:51], v[184:187]
    s_setprio 1
    ds_read_b64_tr_b16 v[16:17], v10 offset:29344
    v_mfma_f32_16x16x32_bf16 v[184:187], v[76:79], v[64:67], v[184:187]
    s_setprio 0
    ds_read_b64_tr_b16 v[18:19], v10 offset:32928
    v_mfma_f32_16x16x32_bf16 v[188:191], v[76:79], v[68:71], v[188:191]
    s_setprio 1
    v_mfma_f32_16x16x32_bf16 v[188:191], v[72:75], v[52:55], v[188:191]
    s_setprio 0
    v_mfma_f32_16x16x32_bf16 v[220:223], v[80:83], v[52:55], v[220:223]
    s_setprio 1
    ds_read_b128 v[52:55], v9 offset:4096
    ds_read_b64_tr_b16 v[72:73], v10 offset:36640
    v_mfma_f32_16x16x32_bf16 v[220:223], v[84:87], v[68:71], v[220:223]
    s_setprio 0
    ds_read_b128 v[68:71], v8 offset:4096
    ds_read_b64_tr_b16 v[74:75], v10 offset:40224
    v_mfma_f32_16x16x32_bf16 v[216:219], v[84:87], v[64:67], v[216:219]
    s_setprio 1
    ds_read_b128 v[64:67], v8 offset:2048
    v_mfma_f32_16x16x32_bf16 v[216:219], v[80:83], v[48:51], v[216:219]
    s_setprio 0
    ds_read_b128 v[48:51], v9 offset:2048
    v_mfma_f32_16x16x32_bf16 v[212:215], v[80:83], v[44:47], v[212:215]
    s_setprio 1
    ds_read_b128 v[44:47], v9 offset:0
    ds_read_b64_tr_b16 v[76:77], v10 offset:29376
    v_mfma_f32_16x16x32_bf16 v[212:215], v[84:87], v[60:63], v[212:215]
    s_setprio 0
    ds_read_b128 v[60:63], v8 offset:0
    ds_read_b64_tr_b16 v[78:79], v10 offset:32960
    v_mfma_f32_16x16x32_bf16 v[208:211], v[84:87], v[56:59], v[208:211]
    s_setprio 1
    v_mfma_f32_16x16x32_bf16 v[208:211], v[80:83], v[40:43], v[208:211]
    s_setprio 0
    s_waitcnt lgkmcnt(12)
    v_mfma_f32_16x16x32_bf16 v[140:143], v[88:91], v[12:15], v[140:143]
    s_setprio 1
    ds_read_b64_tr_b16 v[80:81], v10 offset:36672
    v_mfma_f32_16x16x32_bf16 v[140:143], v[28:31], v[36:39], v[140:143]
    s_setprio 0
    ds_read_b64_tr_b16 v[82:83], v10 offset:40256
    s_waitcnt lgkmcnt(9)
    v_mfma_f32_16x16x32_bf16 v[136:139], v[28:31], v[52:55], v[136:139]
    s_setprio 1
    v_mfma_f32_16x16x32_bf16 v[136:139], v[88:91], v[68:71], v[136:139]
    s_setprio 0
    s_waitcnt lgkmcnt(6)
    v_mfma_f32_16x16x32_bf16 v[132:135], v[88:91], v[64:67], v[132:135]
    s_setprio 1
    v_mfma_f32_16x16x32_bf16 v[132:135], v[28:31], v[48:51], v[132:135]
    s_setprio 0
    s_waitcnt lgkmcnt(3)
    v_mfma_f32_16x16x32_bf16 v[128:131], v[28:31], v[44:47], v[128:131]
    s_setprio 1
    v_mfma_f32_16x16x32_bf16 v[128:131], v[88:91], v[60:63], v[128:131]
    s_setprio 0
    v_mfma_f32_16x16x32_bf16 v[160:163], v[16:19], v[60:63], v[160:163]
    s_setprio 1
    v_mfma_f32_16x16x32_bf16 v[160:163], v[72:75], v[44:47], v[160:163]
    s_setprio 0
    v_mfma_f32_16x16x32_bf16 v[164:167], v[72:75], v[48:51], v[164:167]
    s_setprio 1
    v_mfma_f32_16x16x32_bf16 v[164:167], v[16:19], v[64:67], v[164:167]
    s_setprio 0
    v_mfma_f32_16x16x32_bf16 v[168:171], v[16:19], v[68:71], v[168:171]
    s_setprio 1
    v_mfma_f32_16x16x32_bf16 v[168:171], v[72:75], v[52:55], v[168:171]
    s_setprio 0
    s_waitcnt lgkmcnt(0)
    s_barrier
    v_mfma_f32_16x16x32_bf16 v[172:175], v[72:75], v[36:39], v[172:175]
    s_setprio 1
    ds_read_b64_tr_b16 v[84:85], v92 offset:47104
    v_mfma_f32_16x16x32_bf16 v[172:175], v[16:19], v[12:15], v[172:175]
    s_setprio 0
    ds_read_b64_tr_b16 v[86:87], v92 offset:48128
    v_mfma_f32_16x16x32_bf16 v[204:207], v[76:79], v[12:15], v[204:207]
    s_setprio 1
    ds_read_b64_tr_b16 v[88:89], v92 offset:53248
    v_mfma_f32_16x16x32_bf16 v[204:207], v[80:83], v[36:39], v[204:207]
    s_setprio 0
    ds_read_b64_tr_b16 v[90:91], v92 offset:54272
    v_mfma_f32_16x16x32_bf16 v[200:203], v[80:83], v[52:55], v[200:203]
    s_setprio 1
    ds_read_b64_tr_b16 v[28:29], v32 offset:47104
    v_mfma_f32_16x16x32_bf16 v[200:203], v[76:79], v[68:71], v[200:203]
    s_setprio 0
    ds_read_b64_tr_b16 v[30:31], v32 offset:48128
    v_mfma_f32_16x16x32_bf16 v[196:199], v[76:79], v[64:67], v[196:199]
    s_setprio 1
    ds_read_b64_tr_b16 v[16:17], v32 offset:53248
    v_mfma_f32_16x16x32_bf16 v[196:199], v[80:83], v[48:51], v[196:199]
    s_setprio 0
    ds_read_b64_tr_b16 v[18:19], v32 offset:54272
    v_mfma_f32_16x16x32_bf16 v[192:195], v[80:83], v[44:47], v[192:195]
    s_setprio 1
    ds_read_b64_tr_b16 v[72:73], v92 offset:49152
    v_mfma_f32_16x16x32_bf16 v[192:195], v[76:79], v[60:63], v[192:195]
    s_setprio 0
    ds_read_b64_tr_b16 v[74:75], v92 offset:50176
    s_waitcnt lgkmcnt(6)
    v_mfma_f32_16x16x32_bf16 v[96:99], v[84:87], v[60:63], v[96:99]
    s_setprio 1
    ds_read_b64_tr_b16 v[76:77], v92 offset:55296
    v_mfma_f32_16x16x32_bf16 v[96:99], v[88:91], v[44:47], v[96:99]
    s_setprio 0
    ds_read_b64_tr_b16 v[78:79], v92 offset:56320
    v_mfma_f32_16x16x32_bf16 v[100:103], v[88:91], v[48:51], v[100:103]
    s_setprio 1
    v_mfma_f32_16x16x32_bf16 v[100:103], v[84:87], v[64:67], v[100:103]
    s_setprio 0
    v_mfma_f32_16x16x32_bf16 v[104:107], v[84:87], v[68:71], v[104:107]
    s_setprio 1
    ds_read_b64_tr_b16 v[80:81], v32 offset:49152
    v_mfma_f32_16x16x32_bf16 v[104:107], v[88:91], v[52:55], v[104:107]
    s_setprio 0
    ds_read_b64_tr_b16 v[82:83], v32 offset:50176
    v_mfma_f32_16x16x32_bf16 v[108:111], v[88:91], v[36:39], v[108:111]
    s_setprio 1
    v_mfma_f32_16x16x32_bf16 v[108:111], v[84:87], v[12:15], v[108:111]
    s_setprio 0
    s_waitcnt lgkmcnt(6)
    v_mfma_f32_16x16x32_bf16 v[124:127], v[28:31], v[12:15], v[124:127]
    s_setprio 1
    ds_read_b64_tr_b16 v[84:85], v32 offset:55296
    v_mfma_f32_16x16x32_bf16 v[124:127], v[16:19], v[36:39], v[124:127]
    s_setprio 0
    ds_read_b64_tr_b16 v[86:87], v32 offset:56320
    v_mfma_f32_16x16x32_bf16 v[120:123], v[16:19], v[52:55], v[120:123]
    s_setprio 1
    v_mfma_f32_16x16x32_bf16 v[120:123], v[28:31], v[68:71], v[120:123]
    s_setprio 0
    v_mfma_f32_16x16x32_bf16 v[116:119], v[28:31], v[64:67], v[116:119]
    s_setprio 1
    ds_read_b64_tr_b16 v[88:89], v10 offset:43904
    v_mfma_f32_16x16x32_bf16 v[116:119], v[16:19], v[48:51], v[116:119]
    s_setprio 0
    ds_read_b64_tr_b16 v[90:91], v10 offset:47488
    v_mfma_f32_16x16x32_bf16 v[112:115], v[16:19], v[44:47], v[112:115]
    s_setprio 1
    v_mfma_f32_16x16x32_bf16 v[112:115], v[28:31], v[60:63], v[112:115]
    s_setprio 0
    s_waitcnt lgkmcnt(6)
    v_mfma_f32_16x16x32_bf16 v[224:227], v[60:63], v[72:75], v[224:227]
    s_setprio 1
    ds_read_b64_tr_b16 v[28:29], v10 offset:51200
    v_mfma_f32_16x16x32_bf16 v[224:227], v[44:47], v[76:79], v[224:227]
    s_setprio 0
    ds_read_b64_tr_b16 v[30:31], v10 offset:54784
    v_mfma_f32_16x16x32_bf16 v[228:231], v[48:51], v[76:79], v[228:231]
    s_setprio 1
    v_mfma_f32_16x16x32_bf16 v[228:231], v[64:67], v[72:75], v[228:231]
    s_setprio 0
    v_mfma_f32_16x16x32_bf16 v[232:235], v[68:71], v[72:75], v[232:235]
    s_setprio 1
    v_mfma_f32_16x16x32_bf16 v[232:235], v[52:55], v[76:79], v[232:235]
    s_setprio 0
    v_mfma_f32_16x16x32_bf16 v[236:239], v[36:39], v[76:79], v[236:239]
    s_setprio 1
    v_mfma_f32_16x16x32_bf16 v[236:239], v[12:15], v[72:75], v[236:239]
    s_setprio 0
    ds_read_b64_tr_b16 v[72:73], v10 offset:43936
    s_waitcnt lgkmcnt(5)
    v_mfma_f32_16x16x32_bf16 v[252:255], v[12:15], v[80:83], v[252:255]
    s_setprio 1
    ds_read_b64_tr_b16 v[74:75], v10 offset:47520
    v_mfma_f32_16x16x32_bf16 v[252:255], v[36:39], v[84:87], v[252:255]
    s_setprio 0
    ds_read_b64_tr_b16 v[76:77], v10 offset:51232
    v_mfma_f32_16x16x32_bf16 v[248:251], v[52:55], v[84:87], v[248:251]
    s_setprio 1
    ds_read_b64_tr_b16 v[78:79], v10 offset:54816
    v_mfma_f32_16x16x32_bf16 v[248:251], v[68:71], v[80:83], v[248:251]
    s_setprio 0
    v_mfma_f32_16x16x32_bf16 v[244:247], v[64:67], v[80:83], v[244:247]
    s_setprio 1
    v_mfma_f32_16x16x32_bf16 v[244:247], v[48:51], v[84:87], v[244:247]
    s_setprio 0
    v_mfma_f32_16x16x32_bf16 v[240:243], v[44:47], v[84:87], v[240:243]
    s_setprio 1
    v_mfma_f32_16x16x32_bf16 v[240:243], v[60:63], v[80:83], v[240:243]
    s_setprio 0
    ds_read_b64_tr_b16 v[80:81], v10 offset:43968
    s_waitcnt lgkmcnt(5)
    v_mfma_f32_16x16x32_bf16 v[144:147], v[88:91], v[60:63], v[144:147]
    s_setprio 1
    ds_read_b64_tr_b16 v[82:83], v10 offset:47552
    v_mfma_f32_16x16x32_bf16 v[144:147], v[28:31], v[44:47], v[144:147]
    s_setprio 0
    ds_read_b64_tr_b16 v[84:85], v10 offset:51264
    v_mfma_f32_16x16x32_bf16 v[148:151], v[28:31], v[48:51], v[148:151]
    s_setprio 1
    ds_read_b64_tr_b16 v[86:87], v10 offset:54848
    v_mfma_f32_16x16x32_bf16 v[148:151], v[88:91], v[64:67], v[148:151]
    s_setprio 0
    v_mfma_f32_16x16x32_bf16 v[152:155], v[88:91], v[68:71], v[152:155]
    s_setprio 1
    s_add_u32 s64, s64, 128
    s_bitset0_b32 s64, 11
    v_mfma_f32_16x16x32_bf16 v[152:155], v[28:31], v[52:55], v[152:155]
    s_setprio 0
    s_add_u32 s66, s64, 30720
    s_waitcnt lgkmcnt(0)
    s_barrier
    v_mfma_f32_16x16x32_bf16 v[156:159], v[28:31], v[36:39], v[156:159]
    s_setprio 1
    ds_read_b128 v[40:43], v8 offset:32768
    v_mfma_f32_16x16x32_bf16 v[156:159], v[88:91], v[12:15], v[156:159]
    s_setprio 0
    ds_read_b64_tr_b16 v[88:89], v10 offset:128
    v_mfma_f32_16x16x32_bf16 v[188:191], v[72:75], v[12:15], v[188:191]
    s_setprio 1
    ds_read_b64_tr_b16 v[90:91], v10 offset:3712
    v_mfma_f32_16x16x32_bf16 v[188:191], v[76:79], v[36:39], v[188:191]
    s_setprio 0
    ds_read_b64_tr_b16 v[28:29], v10 offset:7424
    v_mfma_f32_16x16x32_bf16 v[184:187], v[76:79], v[52:55], v[184:187]
    s_setprio 1
    ds_read_b64_tr_b16 v[30:31], v10 offset:11008
    v_mfma_f32_16x16x32_bf16 v[184:187], v[72:75], v[68:71], v[184:187]
    s_setprio 0
    ds_read_b128 v[56:59], v9 offset:32768
    v_mfma_f32_16x16x32_bf16 v[180:183], v[72:75], v[64:67], v[180:183]
    s_setprio 1
    ds_read_b64_tr_b16 v[16:17], v10 offset:160
    v_mfma_f32_16x16x32_bf16 v[180:183], v[76:79], v[48:51], v[180:183]
    s_setprio 0
    ds_read_b64_tr_b16 v[18:19], v10 offset:3744
    v_mfma_f32_16x16x32_bf16 v[176:179], v[76:79], v[44:47], v[176:179]
    s_setprio 1
    v_mfma_f32_16x16x32_bf16 v[176:179], v[72:75], v[60:63], v[176:179]
    s_setprio 0
    v_mfma_f32_16x16x32_bf16 v[208:211], v[80:83], v[60:63], v[208:211]
    s_setprio 1
    ds_read_b128 v[60:63], v9 offset:34816
    ds_read_b64_tr_b16 v[72:73], v10 offset:7456
    v_mfma_f32_16x16x32_bf16 v[208:211], v[84:87], v[44:47], v[208:211]
    s_setprio 0
    ds_read_b128 v[44:47], v8 offset:34816
    ds_read_b64_tr_b16 v[74:75], v10 offset:11040
    v_mfma_f32_16x16x32_bf16 v[212:215], v[84:87], v[48:51], v[212:215]
    s_setprio 1
    ds_read_b128 v[48:51], v8 offset:36864
    v_mfma_f32_16x16x32_bf16 v[212:215], v[80:83], v[64:67], v[212:215]
    s_setprio 0
    ds_read_b128 v[64:67], v9 offset:36864
    v_mfma_f32_16x16x32_bf16 v[216:219], v[80:83], v[68:71], v[216:219]
    s_setprio 1
    ds_read_b128 v[68:71], v9 offset:38912
    ds_read_b64_tr_b16 v[76:77], v10 offset:192
    v_mfma_f32_16x16x32_bf16 v[216:219], v[84:87], v[52:55], v[216:219]
    s_setprio 0
    ds_read_b128 v[52:55], v8 offset:38912
    ds_read_b64_tr_b16 v[78:79], v10 offset:3776
    v_mfma_f32_16x16x32_bf16 v[220:223], v[84:87], v[36:39], v[220:223]
    s_setprio 1
    v_mfma_f32_16x16x32_bf16 v[220:223], v[80:83], v[12:15], v[220:223]
    s_setprio 0
    s_waitcnt lgkmcnt(12)
    v_mfma_f32_16x16x32_bf16 v[128:131], v[88:91], v[40:43], v[128:131]
    s_setprio 1
    ds_read_b64_tr_b16 v[80:81], v10 offset:7488
    v_mfma_f32_16x16x32_bf16 v[128:131], v[28:31], v[56:59], v[128:131]
    s_setprio 0
    ds_read_b64_tr_b16 v[82:83], v10 offset:11072
    s_waitcnt lgkmcnt(9)
    v_mfma_f32_16x16x32_bf16 v[132:135], v[28:31], v[60:63], v[132:135]
    s_setprio 1
    v_mfma_f32_16x16x32_bf16 v[132:135], v[88:91], v[44:47], v[132:135]
    s_setprio 0
    s_waitcnt lgkmcnt(6)
    v_mfma_f32_16x16x32_bf16 v[136:139], v[88:91], v[48:51], v[136:139]
    s_setprio 1
    v_mfma_f32_16x16x32_bf16 v[136:139], v[28:31], v[64:67], v[136:139]
    s_setprio 0
    s_waitcnt lgkmcnt(3)
    v_mfma_f32_16x16x32_bf16 v[140:143], v[28:31], v[68:71], v[140:143]
    s_setprio 1
    v_mfma_f32_16x16x32_bf16 v[140:143], v[88:91], v[52:55], v[140:143]
    s_setprio 0
    v_mfma_f32_16x16x32_bf16 v[172:175], v[16:19], v[52:55], v[172:175]
    s_setprio 1
    v_mfma_f32_16x16x32_bf16 v[172:175], v[72:75], v[68:71], v[172:175]
    s_setprio 0
    v_mfma_f32_16x16x32_bf16 v[168:171], v[72:75], v[64:67], v[168:171]
    s_setprio 1
    v_mfma_f32_16x16x32_bf16 v[168:171], v[16:19], v[48:51], v[168:171]
    s_setprio 0
    v_mfma_f32_16x16x32_bf16 v[164:167], v[16:19], v[44:47], v[164:167]
    s_setprio 1
    v_mfma_f32_16x16x32_bf16 v[164:167], v[72:75], v[60:63], v[164:167]
    s_setprio 0
    s_waitcnt lgkmcnt(0)
    s_barrier
    v_mfma_f32_16x16x32_bf16 v[160:163], v[72:75], v[56:59], v[160:163]
    s_setprio 1
    ds_read_b64_tr_b16 v[84:85], v92 offset:34816
    v_mfma_f32_16x16x32_bf16 v[160:163], v[16:19], v[40:43], v[160:163]
    s_setprio 0
    ds_read_b64_tr_b16 v[86:87], v92 offset:35840
    v_mfma_f32_16x16x32_bf16 v[192:195], v[76:79], v[40:43], v[192:195]
    s_setprio 1
    ds_read_b64_tr_b16 v[88:89], v92 offset:40960
    v_mfma_f32_16x16x32_bf16 v[192:195], v[80:83], v[56:59], v[192:195]
    s_setprio 0
    ds_read_b64_tr_b16 v[90:91], v92 offset:41984
    v_mfma_f32_16x16x32_bf16 v[196:199], v[80:83], v[60:63], v[196:199]
    s_setprio 1
    ds_read_b64_tr_b16 v[28:29], v32 offset:34816
    v_mfma_f32_16x16x32_bf16 v[196:199], v[76:79], v[44:47], v[196:199]
    s_setprio 0
    ds_read_b64_tr_b16 v[30:31], v32 offset:35840
    v_mfma_f32_16x16x32_bf16 v[200:203], v[76:79], v[48:51], v[200:203]
    s_setprio 1
    ds_read_b64_tr_b16 v[16:17], v32 offset:40960
    v_mfma_f32_16x16x32_bf16 v[200:203], v[80:83], v[64:67], v[200:203]
    s_setprio 0
    ds_read_b64_tr_b16 v[18:19], v32 offset:41984
    v_mfma_f32_16x16x32_bf16 v[204:207], v[80:83], v[68:71], v[204:207]
    s_setprio 1
    ds_read_b64_tr_b16 v[72:73], v92 offset:36864
    v_mfma_f32_16x16x32_bf16 v[204:207], v[76:79], v[52:55], v[204:207]
    s_setprio 0
    ds_read_b64_tr_b16 v[74:75], v92 offset:37888
    s_waitcnt lgkmcnt(6)
    v_mfma_f32_16x16x32_bf16 v[108:111], v[84:87], v[52:55], v[108:111]
    s_setprio 1
    ds_read_b64_tr_b16 v[76:77], v92 offset:43008
    v_mfma_f32_16x16x32_bf16 v[108:111], v[88:91], v[68:71], v[108:111]
    s_setprio 0
    ds_read_b64_tr_b16 v[78:79], v92 offset:44032
    v_mfma_f32_16x16x32_bf16 v[104:107], v[88:91], v[64:67], v[104:107]
    s_setprio 1
    v_mfma_f32_16x16x32_bf16 v[104:107], v[84:87], v[48:51], v[104:107]
    s_setprio 0
    v_mfma_f32_16x16x32_bf16 v[100:103], v[84:87], v[44:47], v[100:103]
    s_setprio 1
    ds_read_b64_tr_b16 v[80:81], v32 offset:36864
    v_mfma_f32_16x16x32_bf16 v[100:103], v[88:91], v[60:63], v[100:103]
    s_setprio 0
    ds_read_b64_tr_b16 v[82:83], v32 offset:37888
    v_mfma_f32_16x16x32_bf16 v[96:99], v[88:91], v[56:59], v[96:99]
    s_setprio 1
    v_mfma_f32_16x16x32_bf16 v[96:99], v[84:87], v[40:43], v[96:99]
    s_setprio 0
    s_waitcnt lgkmcnt(6)
    v_mfma_f32_16x16x32_bf16 v[112:115], v[28:31], v[40:43], v[112:115]
    s_setprio 1
    ds_read_b64_tr_b16 v[84:85], v32 offset:43008
    v_mfma_f32_16x16x32_bf16 v[112:115], v[16:19], v[56:59], v[112:115]
    s_setprio 0
    ds_read_b64_tr_b16 v[86:87], v32 offset:44032
    v_mfma_f32_16x16x32_bf16 v[116:119], v[16:19], v[60:63], v[116:119]
    s_setprio 1
    v_mfma_f32_16x16x32_bf16 v[116:119], v[28:31], v[44:47], v[116:119]
    s_setprio 0
    v_mfma_f32_16x16x32_bf16 v[120:123], v[28:31], v[48:51], v[120:123]
    s_setprio 1
    ds_read_b64_tr_b16 v[88:89], v10 offset:14720
    v_mfma_f32_16x16x32_bf16 v[120:123], v[16:19], v[64:67], v[120:123]
    s_setprio 0
    ds_read_b64_tr_b16 v[90:91], v10 offset:18304
    v_mfma_f32_16x16x32_bf16 v[124:127], v[16:19], v[68:71], v[124:127]
    s_setprio 1
    v_mfma_f32_16x16x32_bf16 v[124:127], v[28:31], v[52:55], v[124:127]
    s_setprio 0
    s_add_u32 s36, s36, 1
    s_cmp_lt_u32 s36, 5
    s_cbranch_scc1 L_loop7
    s_mov_b32 s80, 1402880
    s_mov_b32 s81, 1380352
    s_mov_b32 s82, 1404928
    s_mov_b32 s29, 119808
    s_mov_b32 s37, 24576
    s_mov_b32 s83, 132096
    s_waitcnt vmcnt(0)
    s_branch L_pb1
L_w4:
    s_barrier
    s_add_u32 m0, s28, 0
    s_nop 0
    buffer_load_dwordx4 v4, s[8:11], s64 offen offset:0 sc1 lds
    buffer_load_dwordx4 v5, s[8:11], s64 offen offset:1024 sc1 lds
    buffer_load_dwordx4 v4, s[8:11], s66 offen offset:2048 sc1 lds
    buffer_load_dwordx4 v5, s[8:11], s66 offen offset:3072 sc1 lds
    s_add_u32 s64, s64, 128
    s_bitset0_b32 s64, 11
    s_add_u32 s66, s64, 30720
    s_add_u32 m0, s29, 0
    s_nop 0
    buffer_load_dwordx4 v6, s[12:15], s65 offen lds
    s_add_u32 s65, s65, 229376
    s_add_u32 m0, s29, 7296
    s_nop 0
    buffer_load_dwordx4 v6, s[12:15], s65 offen lds
    s_sub_u32 s65, s65, 229376
    s_add_u32 m0, s29, 14592
    s_nop 0
    buffer_load_dwordx4 v6, s[16:19], s65 offen lds
    s_add_u32 s65, s65, 229376
    s_add_u32 m0, s29, 21888
    s_nop 0
    buffer_load_dwordx4 v6, s[16:19], s65 offen lds
    s_add_u32 s65, s65, 229376
    s_waitcnt vmcnt(9)
    v_lshlrev_b32 v112, 16, v104
    v_and_b32 v113, 0xffff0000, v104
    v_lshlrev_b32 v114, 16, v105
    v_and_b32 v115, 0xffff0000, v105
    v_lshlrev_b32 v116, 16, v106
    v_and_b32 v117, 0xffff0000, v106
    v_lshlrev_b32 v118, 16, v107
    v_and_b32 v119, 0xffff0000, v107
    v_lshlrev_b32 v120, 16, v108
    v_and_b32 v121, 0xffff0000, v108
    v_lshlrev_b32 v122, 16, v109
    v_and_b32 v123, 0xffff0000, v109
    v_lshlrev_b32 v124, 16, v110
    v_and_b32 v125, 0xffff0000, v110
    v_lshlrev_b32 v126, 16, v111
    v_and_b32 v127, 0xffff0000, v111
    v_add_f32 v36, v112, v116
    v_add_f32 v37, v113, v117
    v_add_f32 v38, v114, v118
    v_add_f32 v39, v115, v119
    v_add_f32 v36, v36, v120
    v_add_f32 v37, v37, v121
    v_add_f32 v38, v38, v122
    v_add_f32 v39, v39, v123
    v_add_f32 v36, v36, v124
    v_add_f32 v37, v37, v125
    v_add_f32 v38, v38, v126
    v_add_f32 v39, v39, v127
    v_add_f32 v36, v36, v37
    v_add_f32 v38, v38, v39
    v_add_f32 v34, v36, v38
    s_nop 1
    v_add_f32_dpp v34, v34, v34 row_ror:8 row_mask:0xf bank_mask:0xf
    s_nop 1
    v_add_f32_dpp v34, v34, v34 row_ror:4 row_mask:0xf bank_mask:0xf
    s_nop 1
    v_add_f32_dpp v34, v34, v34 row_ror:2 row_mask:0xf bank_mask:0xf
    s_nop 1
    v_add_f32_dpp v34, v34, v34 row_ror:1 row_mask:0xf bank_mask:0xf
    v_mov_b32 v36, v34
    s_nop 1
    v_permlane16_swap_b32 v34, v36
    v_add_f32 v34, v34, v36
    v_mov_b32 v36, v34
    s_nop 1
    v_permlane32_swap_b32 v34, v36
    v_add_f32 v34, v34, v36
    v_mul_f32 v34, 0x3a800000, v34
    v_cvt_pk_bf16_f32 v14, v34, v34
    v_and_b32 v14, 0xffff0000, v14
    v_sub_f32 v112, v112, v14
    v_sub_f32 v113, v113, v14
    v_sub_f32 v114, v114, v14
    v_sub_f32 v115, v115, v14
    v_sub_f32 v116, v116, v14
    v_sub_f32 v117, v117, v14
    v_sub_f32 v118, v118, v14
    v_sub_f32 v119, v119, v14
    v_sub_f32 v120, v120, v14
    v_sub_f32 v121, v121, v14
    v_sub_f32 v122, v122, v14
    v_sub_f32 v123, v123, v14
    v_sub_f32 v124, v124, v14
    v_sub_f32 v125, v125, v14
    v_sub_f32 v126, v126, v14
    v_sub_f32 v127, v127, v14
    v_mul_f32 v36, v112, v112
    v_mul_f32 v37, v113, v113
    v_mul_f32 v38, v114, v114
    v_mul_f32 v39, v115, v115
    v_fmac_f32 v36, v116, v116
    v_fmac_f32 v37, v117, v117
    v_fmac_f32 v38, v118, v118
    v_fmac_f32 v39, v119, v119
    v_fmac_f32 v36, v120, v120
    v_fmac_f32 v37, v121, v121
    v_fmac_f32 v38, v122, v122
    v_fmac_f32 v39, v123, v123
    v_fmac_f32 v36, v124, v124
    v_fmac_f32 v37, v125, v125
    v_fmac_f32 v38, v126, v126
    v_fmac_f32 v39, v127, v127
    v_add_f32 v36, v36, v37
    v_add_f32 v38, v38, v39
    v_sub_f32 v34, v34, v14
    v_add_f32 v12, v36, v38
    s_nop 1
    v_add_f32_dpp v12, v12, v12 row_ror:8 row_mask:0xf bank_mask:0xf
    v_cvt_pk_bf16_f32 v104, v112, v113
    s_nop 0
    v_add_f32_dpp v12, v12, v12 row_ror:4 row_mask:0xf bank_mask:0xf
    v_cvt_pk_bf16_f32 v105, v114, v115
    s_nop 0
    v_add_f32_dpp v12, v12, v12 row_ror:2 row_mask:0xf bank_mask:0xf
    v_cvt_pk_bf16_f32 v106, v116, v117
    s_nop 0
    v_add_f32_dpp v12, v12, v12 row_ror:1 row_mask:0xf bank_mask:0xf
    v_cvt_pk_bf16_f32 v107, v118, v119
    v_mov_b32 v36, v12
    v_cvt_pk_bf16_f32 v108, v120, v121
    s_nop 0
    v_permlane16_swap_b32 v12, v36
    v_cvt_pk_bf16_f32 v109, v122, v123
    v_add_f32 v12, v12, v36
    v_cvt_pk_bf16_f32 v110, v124, v125
    v_mov_b32 v36, v12
    v_cvt_pk_bf16_f32 v111, v126, v127
    s_nop 0
    v_permlane32_swap_b32 v12, v36
    v_lshlrev_b32 v112, 16, v104
    v_add_f32 v12, v12, v36
    v_and_b32 v113, 0xffff0000, v104
    v_mul_f32 v12, 0x3a800000, v12
    v_lshlrev_b32 v114, 16, v105
    v_fma_f32 v12, -v34, v34, v12
    v_and_b32 v115, 0xffff0000, v105
    v_max_f32 v12, 0, v12
    v_lshlrev_b32 v116, 16, v106
    v_cvt_pk_bf16_f32 v12, v12, v12
    v_and_b32 v117, 0xffff0000, v106
    v_and_b32 v12, 0xffff0000, v12
    v_lshlrev_b32 v118, 16, v107
    v_add_f32 v12, 0x3727c5ac, v12
    v_and_b32 v119, 0xffff0000, v107
    v_cvt_pk_bf16_f32 v12, v12, v12
    v_lshlrev_b32 v120, 16, v108
    v_and_b32 v12, 0xffff0000, v12
    v_and_b32 v121, 0xffff0000, v108
    v_sqrt_f32 v15, v12
    v_lshlrev_b32 v122, 16, v109
    v_cvt_pk_bf16_f32 v15, v15, v15
    v_and_b32 v123, 0xffff0000, v109
    v_and_b32 v15, 0xffff0000, v15
    v_lshlrev_b32 v124, 16, v110
    v_rcp_f32 v12, v15
    v_and_b32 v125, 0xffff0000, v110
    v_sub_f32 v14, 0, v14
    v_lshlrev_b32 v126, 16, v111
    v_and_b32 v127, 0xffff0000, v111
    v_mul_f32 v112, v112, v12
    v_mul_f32 v113, v113, v12
    v_mul_f32 v114, v114, v12
    v_mul_f32 v115, v115, v12
    v_mul_f32 v116, v116, v12
    v_mul_f32 v117, v117, v12
    v_mul_f32 v118, v118, v12
    v_mul_f32 v119, v119, v12
    v_mul_f32 v120, v120, v12
    v_mul_f32 v121, v121, v12
    v_mul_f32 v122, v122, v12
    v_mul_f32 v123, v123, v12
    v_mul_f32 v124, v124, v12
    v_mul_f32 v125, v125, v12
    v_mul_f32 v126, v126, v12
    v_mul_f32 v127, v127, v12
    v_cvt_pk_bf16_f32 v104, v112, v113
    v_cvt_pk_bf16_f32 v105, v114, v115
    v_cvt_pk_bf16_f32 v106, v116, v117
    v_cvt_pk_bf16_f32 v107, v118, v119
    v_cvt_pk_bf16_f32 v108, v120, v121
    v_cvt_pk_bf16_f32 v109, v122, v123
    v_cvt_pk_bf16_f32 v110, v124, v125
    v_cvt_pk_bf16_f32 v111, v126, v127
    buffer_store_dwordx4 v[104:107], v2, s[20:23], s3 offen offset:0 sc1
    buffer_store_dwordx4 v[108:111], v2, s[20:23], s3 offen offset:1024 sc1
    v_lshrrev_b32 v14, 16, v14
    v_or_b32 v14, v14, v15
    s_waitcnt vmcnt(10)
    s_mov_b32 s5, 0x9E3779B1
    v_mul_lo_u32 v33, v33, s5
    v_add_u32 v33, 0x7F4A7C15, v33
    s_nop 0
    v_readfirstlane_b32 s58, v33
    v_mov_b32 v15, v33
    s_waitcnt vmcnt(4)
    s_barrier
    ds_read_b128 v[40:43], v8 offset:0
    ds_read_b64_tr_b16 v[88:89], v10 offset:128
    ds_read_b64_tr_b16 v[90:91], v10 offset:3712
    ds_read_b128 v[56:59], v9 offset:0
    ds_read_b64_tr_b16 v[72:73], v10 offset:7424
    ds_read_b64_tr_b16 v[74:75], v10 offset:11008
    ds_read_b128 v[60:63], v9 offset:2048
    ds_read_b128 v[44:47], v8 offset:2048
    ds_read_b128 v[48:51], v8 offset:4096
    ds_read_b128 v[64:67], v9 offset:4096
    ds_read_b128 v[68:71], v9 offset:6144
    ds_read_b128 v[52:55], v8 offset:6144
    ds_read_b64_tr_b16 v[76:77], v10 offset:160
    ds_read_b64_tr_b16 v[78:79], v10 offset:3744
    ds_read_b64_tr_b16 v[80:81], v10 offset:7456
    ds_read_b64_tr_b16 v[82:83], v10 offset:11040
    s_mov_b32 s37, 1576960
    s_add_u32 m0, s28, 32768
    s_waitcnt lgkmcnt(10)
    v_mfma_f32_16x16x32_bf16 v[128:131], v[88:91], v[40:43], 0
    s_setprio 1
    ds_read_b64_tr_b16 v[84:85], v10 offset:192
    v_mfma_f32_16x16x32_bf16 v[128:131], v[72:75], v[56:59], v[128:131]
    s_setprio 0
    buffer_load_dwordx4 v4, s[8:11], s64 offen offset:0 sc1 lds
    ds_read_b64_tr_b16 v[86:87], v10 offset:3776
    s_add_u32 m0, s28, 32768
    s_waitcnt lgkmcnt(10)
    v_mfma_f32_16x16x32_bf16 v[132:135], v[72:75], v[60:63], 0
    s_setprio 1
    v_mfma_f32_16x16x32_bf16 v[132:135], v[88:91], v[44:47], v[132:135]
    s_setprio 0
    v_mfma_f32_16x16x32_bf16 v[16:19], v[28:31], v[88:91], 0
    v_mfma_f32_16x16x32_bf16 v[16:19], v[28:31], v[72:75], v[16:19]
    buffer_load_dwordx4 v5, s[8:11], s64 offen offset:1024 sc1 lds
    s_add_u32 m0, s28, 32768
    s_waitcnt lgkmcnt(8)
    v_mfma_f32_16x16x32_bf16 v[136:139], v[88:91], v[48:51], 0
    s_setprio 1
    v_mfma_f32_16x16x32_bf16 v[136:139], v[72:75], v[64:67], v[136:139]
    s_setprio 0
    buffer_load_dwordx4 v4, s[8:11], s66 offen offset:2048 sc1 lds
    s_add_u32 m0, s28, 32768
    s_waitcnt lgkmcnt(6)
    v_mfma_f32_16x16x32_bf16 v[140:143], v[72:75], v[68:71], 0
    s_setprio 1
    v_mfma_f32_16x16x32_bf16 v[140:143], v[88:91], v[52:55], v[140:143]
    s_setprio 0
    buffer_load_dwordx4 v5, s[8:11], s66 offen offset:3072 sc1 lds
    s_add_u32 s64, s64, 128
    s_bitset0_b32 s64, 11
    s_add_u32 s66, s64, 30720
    ds_read_b64_tr_b16 v[88:89], v10 offset:7488
    s_add_u32 m0, s29, 29184
    s_waitcnt lgkmcnt(3)
    v_mfma_f32_16x16x32_bf16 v[172:175], v[76:79], v[52:55], 0
    s_setprio 1
    ds_read_b64_tr_b16 v[90:91], v10 offset:11072
    v_mfma_f32_16x16x32_bf16 v[172:175], v[80:83], v[68:71], v[172:175]
    s_setprio 0
    buffer_load_dwordx4 v6, s[12:15], s65 offen lds
    s_add_u32 s65, s65, 229376
    s_waitcnt vmcnt(7) lgkmcnt(0)
    s_barrier
    s_add_u32 m0, s29, 36480
    v_mfma_f32_16x16x32_bf16 v[168:171], v[80:83], v[64:67], 0
    s_setprio 1
    ds_read_b64_tr_b16 v[72:73], v10 offset:14720
    v_mfma_f32_16x16x32_bf16 v[168:171], v[76:79], v[48:51], v[168:171]
    s_setprio 0
    buffer_load_dwordx4 v6, s[12:15], s65 offen lds
    s_sub_u32 s65, s65, 229376
    ds_read_b64_tr_b16 v[74:75], v10 offset:18304
    s_add_u32 m0, s29, 43776
    v_mfma_f32_16x16x32_bf16 v[164:167], v[76:79], v[44:47], 0
    s_setprio 1
    v_mfma_f32_16x16x32_bf16 v[164:167], v[80:83], v[60:63], v[164:167]
    s_setprio 0
    buffer_load_dwordx4 v6, s[16:19], s65 offen lds
    s_add_u32 s65, s65, 229376
    s_add_u32 m0, s29, 51072
    v_mfma_f32_16x16x32_bf16 v[160:163], v[80:83], v[56:59], 0
    s_setprio 1
    v_mfma_f32_16x16x32_bf16 v[160:163], v[76:79], v[40:43], v[160:163]
    s_setprio 0
    buffer_load_dwordx4 v6, s[16:19], s65 offen lds
    s_add_u32 s65, s65, 229376
    ds_read_b64_tr_b16 v[76:77], v10 offset:22016
    s_add_u32 m0, s29, 0
    v_mfma_f32_16x16x32_bf16 v[192:195], v[84:87], v[40:43], 0
    s_setprio 1
    ds_read_b64_tr_b16 v[78:79], v10 offset:25600
    v_mfma_f32_16x16x32_bf16 v[192:195], v[88:91], v[56:59], v[192:195]
    s_setprio 0
    buffer_load_dwordx4 v6, s[12:15], s65 offen lds
    s_add_u32 s65, s65, 229376
    ds_read_b64_tr_b16 v[80:81], v10 offset:14752
    s_add_u32 m0, s29, 7296
    v_mfma_f32_16x16x32_bf16 v[196:199], v[88:91], v[60:63], 0
    s_setprio 1
    ds_read_b64_tr_b16 v[82:83], v10 offset:18336
    v_mfma_f32_16x16x32_bf16 v[196:199], v[84:87], v[44:47], v[196:199]
    s_setprio 0
    buffer_load_dwordx4 v6, s[12:15], s65 offen lds
    s_sub_u32 s65, s65, 229376
    s_add_u32 m0, s28, 123904
    v_mfma_f32_16x16x32_bf16 v[200:203], v[84:87], v[48:51], 0
    s_setprio 1
    v_mfma_f32_16x16x32_bf16 v[200:203], v[88:91], v[64:67], v[200:203]
    s_setprio 0
    buffer_load_dwordx4 v4, s[8:11], s64 offen offset:0 sc1 lds
    s_add_u32 m0, s28, 123904
    v_mfma_f32_16x16x32_bf16 v[204:207], v[88:91], v[68:71], 0
    s_setprio 1
    v_mfma_f32_16x16x32_bf16 v[204:207], v[84:87], v[52:55], v[204:207]
    s_setprio 0
    buffer_load_dwordx4 v5, s[8:11], s64 offen offset:1024 sc1 lds
    ds_read_b64_tr_b16 v[84:85], v10 offset:22048
    s_add_u32 m0, s28, 123904
    s_waitcnt lgkmcnt(3)
    v_mfma_f32_16x16x32_bf16 v[156:159], v[72:75], v[52:55], 0
    s_setprio 1
    ds_read_b64_tr_b16 v[86:87], v10 offset:25632
    v_mfma_f32_16x16x32_bf16 v[156:159], v[76:79], v[68:71], v[156:159]
    s_setprio 0
    buffer_load_dwordx4 v4, s[8:11], s66 offen offset:2048 sc1 lds
    ds_read_b64_tr_b16 v[88:89], v10 offset:14784
    s_add_u32 m0, s28, 123904
    v_mfma_f32_16x16x32_bf16 v[152:155], v[76:79], v[64:67], 0
    s_setprio 1
    ds_read_b64_tr_b16 v[90:91], v10 offset:18368
    v_mfma_f32_16x16x32_bf16 v[152:155], v[72:75], v[48:51], v[152:155]
    s_setprio 0
    v_mfma_f32_16x16x32_bf16 v[20:23], v[28:31], v[72:75], 0
    v_mfma_f32_16x16x32_bf16 v[20:23], v[28:31], v[76:79], v[20:23]
    buffer_load_dwordx4 v5, s[8:11], s66 offen offset:3072 sc1 lds
    s_add_u32 s64, s64, 128
    s_bitset0_b32 s64, 11
    s_add_u32 s66, s64, 30720
    v_mfma_f32_16x16x32_bf16 v[148:151], v[72:75], v[44:47], 0
    s_setprio 1
    v_mfma_f32_16x16x32_bf16 v[148:151], v[76:79], v[60:63], v[148:151]
    s_setprio 0
    v_mfma_f32_16x16x32_bf16 v[144:147], v[76:79], v[56:59], 0
    s_setprio 1
    v_mfma_f32_16x16x32_bf16 v[144:147], v[72:75], v[40:43], v[144:147]
    s_setprio 0
    s_waitcnt vmcnt(14)
    s_lshr_b32 s3, s3, 8
    s_add_u32 s3, s3, 3211264
    s_mov_b64 exec, 1
    buffer_store_dwordx2 v[14:15], off, s[24:27], s3 sc1
    s_mov_b64 exec, -1
    ds_read_b64_tr_b16 v[72:73], v10 offset:22080
    s_waitcnt lgkmcnt(3)
    v_mfma_f32_16x16x32_bf16 v[176:179], v[80:83], v[40:43], 0
    s_setprio 1
    ds_read_b64_tr_b16 v[74:75], v10 offset:25664
    v_mfma_f32_16x16x32_bf16 v[176:179], v[84:87], v[56:59], v[176:179]
    s_setprio 0
    s_waitcnt vmcnt(9) lgkmcnt(0)
    s_barrier
    s_add_u32 m0, s29, 14592
    v_mfma_f32_16x16x32_bf16 v[180:183], v[84:87], v[60:63], 0
    s_setprio 1
    ds_read_b64_tr_b16 v[76:77], v10 offset:29312
    v_mfma_f32_16x16x32_bf16 v[180:183], v[80:83], v[44:47], v[180:183]
    s_setprio 0
    buffer_load_dwordx4 v6, s[16:19], s65 offen lds
    s_add_u32 s65, s65, 229376
    ds_read_b64_tr_b16 v[78:79], v10 offset:32896
    s_add_u32 m0, s29, 21888
    v_mfma_f32_16x16x32_bf16 v[184:187], v[80:83], v[48:51], 0
    s_setprio 1
    v_mfma_f32_16x16x32_bf16 v[184:187], v[84:87], v[64:67], v[184:187]
    s_setprio 0
    buffer_load_dwordx4 v6, s[16:19], s65 offen lds
    s_add_u32 s65, s65, 229376
    s_mov_b32 m0, 28672
    v_mfma_f32_16x16x32_bf16 v[188:191], v[84:87], v[68:71], 0
    s_setprio 1
    v_mfma_f32_16x16x32_bf16 v[188:191], v[80:83], v[52:55], v[188:191]
    s_setprio 0
    s_add_u32 s5, s64, 196608
    buffer_load_dwordx4 v5, s[8:11], s5 offen offset:1024 sc1 lds
    ds_read_b64_tr_b16 v[80:81], v10 offset:36608
    s_add_u32 m0, s28, 0
    v_mfma_f32_16x16x32_bf16 v[220:223], v[88:91], v[52:55], 0
    s_setprio 1
    ds_read_b128 v[52:55], v8 offset:38912
    ds_read_b64_tr_b16 v[82:83], v10 offset:40192
    v_mfma_f32_16x16x32_bf16 v[220:223], v[72:75], v[68:71], v[220:223]
    s_setprio 0
    buffer_load_dwordx4 v4, s[8:11], s64 offen offset:0 sc1 lds
    ds_read_b128 v[68:71], v9 offset:38912
    ds_read_b64_tr_b16 v[84:85], v10 offset:29344
    s_add_u32 m0, s28, 0
    v_mfma_f32_16x16x32_bf16 v[216:219], v[72:75], v[64:67], 0
    s_setprio 1
    ds_read_b128 v[64:67], v9 offset:36864
    ds_read_b64_tr_b16 v[86:87], v10 offset:32928
    v_mfma_f32_16x16x32_bf16 v[216:219], v[88:91], v[48:51], v[216:219]
    s_setprio 0
    buffer_load_dwordx4 v5, s[8:11], s64 offen offset:1024 sc1 lds
    ds_read_b128 v[48:51], v8 offset:36864
    s_add_u32 m0, s28, 0
    v_mfma_f32_16x16x32_bf16 v[212:215], v[88:91], v[44:47], 0
    s_setprio 1
    ds_read_b128 v[44:47], v8 offset:34816
    v_mfma_f32_16x16x32_bf16 v[212:215], v[72:75], v[60:63], v[212:215]
    s_setprio 0
    buffer_load_dwordx4 v4, s[8:11], s66 offen offset:2048 sc1 lds
    ds_read_b128 v[60:63], v9 offset:34816
    s_add_u32 m0, s28, 0
    v_mfma_f32_16x16x32_bf16 v[208:211], v[72:75], v[56:59], 0
    s_setprio 1
    ds_read_b128 v[56:59], v9 offset:32768
    v_mfma_f32_16x16x32_bf16 v[208:211], v[88:91], v[40:43], v[208:211]
    s_setprio 0
    buffer_load_dwordx4 v5, s[8:11], s66 offen offset:3072 sc1 lds
    s_add_u32 s64, s64, 128
    s_bitset0_b32 s64, 11
    s_add_u32 s66, s64, 30720
    ds_read_b128 v[40:43], v8 offset:32768
    ds_read_b64_tr_b16 v[88:89], v10 offset:36640
    s_waitcnt lgkmcnt(9)
    v_mfma_f32_16x16x32_bf16 v[140:143], v[76:79], v[52:55], v[140:143]
    s_setprio 1
    ds_read_b64_tr_b16 v[90:91], v10 offset:40224
    v_mfma_f32_16x16x32_bf16 v[140:143], v[80:83], v[68:71], v[140:143]
    s_setprio 0
    ds_read_b64_tr_b16 v[72:73], v10 offset:29376
    s_waitcnt lgkmcnt(7)
    v_mfma_f32_16x16x32_bf16 v[136:139], v[80:83], v[64:67], v[136:139]
    s_setprio 1
    ds_read_b64_tr_b16 v[74:75], v10 offset:32960
    v_mfma_f32_16x16x32_bf16 v[136:139], v[76:79], v[48:51], v[136:139]
    s_setprio 0
    v_mfma_f32_16x16x32_bf16 v[16:19], v[28:31], v[76:79], v[16:19]
    v_mfma_f32_16x16x32_bf16 v[16:19], v[28:31], v[80:83], v[16:19]
    s_waitcnt lgkmcnt(6)
    v_mfma_f32_16x16x32_bf16 v[132:135], v[76:79], v[44:47], v[132:135]
    s_setprio 1
    v_mfma_f32_16x16x32_bf16 v[132:135], v[80:83], v[60:63], v[132:135]
    s_setprio 0
    s_waitcnt lgkmcnt(4)
    v_mfma_f32_16x16x32_bf16 v[128:131], v[80:83], v[56:59], v[128:131]
    s_setprio 1
    v_mfma_f32_16x16x32_bf16 v[128:131], v[76:79], v[40:43], v[128:131]
    s_setprio 0
    ds_read_b64_tr_b16 v[76:77], v10 offset:36672
    s_waitcnt lgkmcnt(3)
    v_mfma_f32_16x16x32_bf16 v[160:163], v[84:87], v[40:43], v[160:163]
    s_setprio 1
    ds_read_b64_tr_b16 v[78:79], v10 offset:40256
    v_mfma_f32_16x16x32_bf16 v[160:163], v[88:91], v[56:59], v[160:163]
    s_setprio 0
    s_waitcnt vmcnt(14) lgkmcnt(0)
    s_barrier
    v_mfma_f32_16x16x32_bf16 v[164:167], v[88:91], v[60:63], v[164:167]
    s_setprio 1
    ds_read_b64_tr_b16 v[80:81], v10 offset:43904
    s_add_u32 m0, s29, 29184
    v_mfma_f32_16x16x32_bf16 v[164:167], v[84:87], v[44:47], v[164:167]
    s_setprio 0
    ds_read_b64_tr_b16 v[82:83], v10 offset:47488
    buffer_load_dwordx4 v6, s[12:15], s65 offen lds
    v_mfma_f32_16x16x32_bf16 v[168:171], v[84:87], v[48:51], v[168:171]
    s_setprio 1
    s_add_u32 s65, s65, 229376
    v_mfma_f32_16x16x32_bf16 v[168:171], v[88:91], v[64:67], v[168:171]
    s_setprio 0
    v_mfma_f32_16x16x32_bf16 v[172:175], v[88:91], v[68:71], v[172:175]
    s_setprio 1
    s_add_u32 m0, s29, 36480
    v_mfma_f32_16x16x32_bf16 v[172:175], v[84:87], v[52:55], v[172:175]
    s_setprio 0
    ds_read_b64_tr_b16 v[84:85], v10 offset:51200
    buffer_load_dwordx4 v6, s[12:15], s65 offen lds
    v_mfma_f32_16x16x32_bf16 v[204:207], v[72:75], v[52:55], v[204:207]
    s_setprio 1
    ds_read_b64_tr_b16 v[86:87], v10 offset:54784
    s_sub_u32 s65, s65, 229376
    v_mfma_f32_16x16x32_bf16 v[204:207], v[76:79], v[68:71], v[204:207]
    s_setprio 0
    ds_read_b64_tr_b16 v[88:89], v10 offset:43936
    v_mfma_f32_16x16x32_bf16 v[200:203], v[76:79], v[64:67], v[200:203]
    s_setprio 1
    ds_read_b64_tr_b16 v[90:91], v10 offset:47520
    v_mfma_f32_16x16x32_bf16 v[200:203], v[72:75], v[48:51], v[200:203]
    s_setprio 0
    v_mfma_f32_16x16x32_bf16 v[196:199], v[72:75], v[44:47], v[196:199]
    s_setprio 1
    v_mfma_f32_16x16x32_bf16 v[196:199], v[76:79], v[60:63], v[196:199]
    s_setprio 0
    v_mfma_f32_16x16x32_bf16 v[192:195], v[76:79], v[56:59], v[192:195]
    s_setprio 1
    v_mfma_f32_16x16x32_bf16 v[192:195], v[72:75], v[40:43], v[192:195]
    s_setprio 0
    ds_read_b64_tr_b16 v[72:73], v10 offset:51232
    s_waitcnt lgkmcnt(3)
    v_mfma_f32_16x16x32_bf16 v[144:147], v[80:83], v[40:43], v[144:147]
    s_setprio 1
    ds_read_b64_tr_b16 v[74:75], v10 offset:54816
    v_mfma_f32_16x16x32_bf16 v[144:147], v[84:87], v[56:59], v[144:147]
    s_setprio 0
    ds_read_b64_tr_b16 v[76:77], v10 offset:43968
    v_mfma_f32_16x16x32_bf16 v[148:151], v[84:87], v[60:63], v[148:151]
    s_setprio 1
    ds_read_b64_tr_b16 v[78:79], v10 offset:47552
    v_mfma_f32_16x16x32_bf16 v[148:151], v[80:83], v[44:47], v[148:151]
    s_setprio 0
    v_mfma_f32_16x16x32_bf16 v[20:23], v[28:31], v[80:83], v[20:23]
    v_mfma_f32_16x16x32_bf16 v[20:23], v[28:31], v[84:87], v[20:23]
    v_mfma_f32_16x16x32_bf16 v[152:155], v[80:83], v[48:51], v[152:155]
    s_setprio 1
    v_mfma_f32_16x16x32_bf16 v[152:155], v[84:87], v[64:67], v[152:155]
    s_setprio 0
    v_mfma_f32_16x16x32_bf16 v[156:159], v[84:87], v[68:71], v[156:159]
    s_setprio 1
    v_mfma_f32_16x16x32_bf16 v[156:159], v[80:83], v[52:55], v[156:159]
    s_setprio 0
    ds_read_b64_tr_b16 v[80:81], v10 offset:51264
    s_waitcnt lgkmcnt(3)
    v_mfma_f32_16x16x32_bf16 v[188:191], v[88:91], v[52:55], v[188:191]
    s_setprio 1
    ds_read_b64_tr_b16 v[82:83], v10 offset:54848
    v_mfma_f32_16x16x32_bf16 v[188:191], v[72:75], v[68:71], v[188:191]
    s_setprio 0
    s_waitcnt vmcnt(10) lgkmcnt(0)
    s_barrier
    v_mfma_f32_16x16x32_bf16 v[184:187], v[72:75], v[64:67], v[184:187]
    s_setprio 1
    ds_read_b64_tr_b16 v[84:85], v10 offset:128
    s_add_u32 m0, s29, 43776
    v_mfma_f32_16x16x32_bf16 v[184:187], v[88:91], v[48:51], v[184:187]
    s_setprio 0
    ds_read_b64_tr_b16 v[86:87], v10 offset:3712
    buffer_load_dwordx4 v6, s[16:19], s65 offen lds
    v_mfma_f32_16x16x32_bf16 v[180:183], v[88:91], v[44:47], v[180:183]
    s_setprio 1
    s_add_u32 s65, s65, 229376
    v_mfma_f32_16x16x32_bf16 v[180:183], v[72:75], v[60:63], v[180:183]
    s_setprio 0
    v_mfma_f32_16x16x32_bf16 v[176:179], v[72:75], v[56:59], v[176:179]
    s_setprio 1
    s_add_u32 m0, s29, 51072
    v_mfma_f32_16x16x32_bf16 v[176:179], v[88:91], v[40:43], v[176:179]
    s_setprio 0
    ds_read_b64_tr_b16 v[88:89], v10 offset:7424
    buffer_load_dwordx4 v6, s[16:19], s65 offen lds
    v_mfma_f32_16x16x32_bf16 v[208:211], v[76:79], v[40:43], v[208:211]
    s_setprio 1
    ds_read_b128 v[40:43], v94 offset:0
    ds_read_b64_tr_b16 v[90:91], v10 offset:11008
    s_add_u32 s65, s65, 229376
    v_mfma_f32_16x16x32_bf16 v[208:211], v[80:83], v[56:59], v[208:211]
    s_setprio 0
    ds_read_b128 v[56:59], v95 offset:0
    ds_read_b64_tr_b16 v[72:73], v10 offset:160
    v_mfma_f32_16x16x32_bf16 v[212:215], v[80:83], v[60:63], v[212:215]
    s_setprio 1
    ds_read_b128 v[60:63], v95 offset:2048
    ds_read_b64_tr_b16 v[74:75], v10 offset:3744
    v_mfma_f32_16x16x32_bf16 v[212:215], v[76:79], v[44:47], v[212:215]
    s_setprio 0
    ds_read_b128 v[44:47], v94 offset:2048
    v_mfma_f32_16x16x32_bf16 v[216:219], v[76:79], v[48:51], v[216:219]
    s_setprio 1
    ds_read_b128 v[48:51], v94 offset:4096
    v_mfma_f32_16x16x32_bf16 v[216:219], v[80:83], v[64:67], v[216:219]
    s_setprio 0
    ds_read_b128 v[64:67], v95 offset:4096
    v_mfma_f32_16x16x32_bf16 v[220:223], v[80:83], v[68:71], v[220:223]
    s_setprio 1
    ds_read_b128 v[68:71], v95 offset:6144
    v_mfma_f32_16x16x32_bf16 v[220:223], v[76:79], v[52:55], v[220:223]
    s_setprio 0
    ds_read_b128 v[52:55], v94 offset:6144
    ds_read_b64_tr_b16 v[76:77], v10 offset:7456
    s_waitcnt lgkmcnt(9)
    v_mfma_f32_16x16x32_bf16 v[128:131], v[84:87], v[40:43], v[128:131]
    s_setprio 1
    ds_read_b64_tr_b16 v[78:79], v10 offset:11040
    v_mfma_f32_16x16x32_bf16 v[128:131], v[88:91], v[56:59], v[128:131]
    s_setprio 0
    ds_read_b64_tr_b16 v[80:81], v10 offset:192
    s_waitcnt lgkmcnt(7)
    v_mfma_f32_16x16x32_bf16 v[132:135], v[88:91], v[60:63], v[132:135]
    s_setprio 1
    ds_read_b64_tr_b16 v[82:83], v10 offset:3776
    v_mfma_f32_16x16x32_bf16 v[132:135], v[84:87], v[44:47], v[132:135]
    s_setprio 0
    v_mfma_f32_16x16x32_bf16 v[16:19], v[28:31], v[84:87], v[16:19]
    v_mfma_f32_16x16x32_bf16 v[16:19], v[28:31], v[88:91], v[16:19]
    s_waitcnt lgkmcnt(6)
    v_mfma_f32_16x16x32_bf16 v[136:139], v[84:87], v[48:51], v[136:139]
    s_setprio 1
    v_mfma_f32_16x16x32_bf16 v[136:139], v[88:91], v[64:67], v[136:139]
    s_setprio 0
    s_waitcnt lgkmcnt(4)
    v_mfma_f32_16x16x32_bf16 v[140:143], v[88:91], v[68:71], v[140:143]
    s_setprio 1
    v_mfma_f32_16x16x32_bf16 v[140:143], v[84:87], v[52:55], v[140:143]
    s_setprio 0
    ds_read_b64_tr_b16 v[84:85], v10 offset:7488
    s_waitcnt lgkmcnt(3)
    v_mfma_f32_16x16x32_bf16 v[172:175], v[72:75], v[52:55], v[172:175]
    s_setprio 1
    ds_read_b64_tr_b16 v[86:87], v10 offset:11072
    v_mfma_f32_16x16x32_bf16 v[172:175], v[76:79], v[68:71], v[172:175]
    s_setprio 0
    s_waitcnt vmcnt(9) lgkmcnt(0)
    s_barrier
    v_mfma_f32_16x16x32_bf16 v[168:171], v[76:79], v[64:67], v[168:171]
    s_setprio 1
    ds_read_b64_tr_b16 v[88:89], v10 offset:14720
    s_add_u32 m0, s29, 0
    v_mfma_f32_16x16x32_bf16 v[168:171], v[72:75], v[48:51], v[168:171]
    s_setprio 0
    s_mov_b64 s[8:9], s[56:57]
    v_mov_b32 v236, 0
    ds_read_b64_tr_b16 v[90:91], v10 offset:18304
    buffer_load_dwordx4 v6, s[12:15], s65 offen lds
    v_mov_b32 v237, 0
    v_mfma_f32_16x16x32_bf16 v[164:167], v[72:75], v[44:47], v[164:167]
    s_setprio 1
    s_add_u32 s65, s65, 229376
    v_mfma_f32_16x16x32_bf16 v[164:167], v[76:79], v[60:63], v[164:167]
    s_setprio 0
    v_mov_b32 v238, 0
    v_mfma_f32_16x16x32_bf16 v[160:163], v[76:79], v[56:59], v[160:163]
    s_setprio 1
    s_add_u32 m0, s29, 7296
    v_mfma_f32_16x16x32_bf16 v[160:163], v[72:75], v[40:43], v[160:163]
    s_setprio 0
    ds_read_b64_tr_b16 v[72:73], v10 offset:22016
    buffer_load_dwordx4 v6, s[12:15], s65 offen lds
    v_mov_b32 v239, 0
    v_mfma_f32_16x16x32_bf16 v[192:195], v[80:83], v[40:43], v[192:195]
    s_setprio 1
    ds_read_b64_tr_b16 v[74:75], v10 offset:25600
    s_sub_u32 s65, s65, 229376
    v_mfma_f32_16x16x32_bf16 v[192:195], v[84:87], v[56:59], v[192:195]
    s_setprio 0
    ds_read_b64_tr_b16 v[76:77], v10 offset:14752
    v_mov_b32 v232, 0
    v_mfma_f32_16x16x32_bf16 v[196:199], v[84:87], v[60:63], v[196:199]
    s_setprio 1
    ds_read_b64_tr_b16 v[78:79], v10 offset:18336
    s_mov_b32 m0, 61440
    v_mfma_f32_16x16x32_bf16 v[196:199], v[80:83], v[44:47], v[196:199]
    s_setprio 0
    s_add_u32 s5, s64, 196608
    buffer_load_dwordx4 v5, s[8:11], s5 offen offset:1024 sc1 lds
    v_mov_b32 v233, 0
    v_mfma_f32_16x16x32_bf16 v[200:203], v[80:83], v[48:51], v[200:203]
    s_setprio 1
    v_mfma_f32_16x16x32_bf16 v[200:203], v[84:87], v[64:67], v[200:203]
    s_setprio 0
    v_mov_b32 v234, 0
    v_mfma_f32_16x16x32_bf16 v[204:207], v[84:87], v[68:71], v[204:207]
    s_setprio 1
    s_add_u32 m0, s28, 32768
    v_mfma_f32_16x16x32_bf16 v[204:207], v[80:83], v[52:55], v[204:207]
    s_setprio 0
    ds_read_b64_tr_b16 v[80:81], v10 offset:22048
    buffer_load_dwordx4 v4, s[8:11], s64 offen offset:0 sc1 lds
    v_mov_b32 v235, 0
    s_waitcnt lgkmcnt(3)
    v_mfma_f32_16x16x32_bf16 v[156:159], v[88:91], v[52:55], v[156:159]
    s_setprio 1
    ds_read_b64_tr_b16 v[82:83], v10 offset:25632
    v_mfma_f32_16x16x32_bf16 v[156:159], v[72:75], v[68:71], v[156:159]
    s_setprio 0
    ds_read_b64_tr_b16 v[84:85], v10 offset:14784
    v_mov_b32 v228, 0
    v_mfma_f32_16x16x32_bf16 v[152:155], v[72:75], v[64:67], v[152:155]
    s_setprio 1
    ds_read_b64_tr_b16 v[86:87], v10 offset:18368
    s_add_u32 m0, s28, 32768
    v_mfma_f32_16x16x32_bf16 v[152:155], v[88:91], v[48:51], v[152:155]
    s_setprio 0
    v_mfma_f32_16x16x32_bf16 v[20:23], v[28:31], v[88:91], v[20:23]
    v_mfma_f32_16x16x32_bf16 v[20:23], v[28:31], v[72:75], v[20:23]
    buffer_load_dwordx4 v5, s[8:11], s64 offen offset:1024 sc1 lds
    v_mov_b32 v229, 0
    v_mfma_f32_16x16x32_bf16 v[148:151], v[88:91], v[44:47], v[148:151]
    s_setprio 1
    v_mfma_f32_16x16x32_bf16 v[148:151], v[72:75], v[60:63], v[148:151]
    s_setprio 0
    v_mov_b32 v230, 0
    v_mfma_f32_16x16x32_bf16 v[144:147], v[72:75], v[56:59], v[144:147]
    s_setprio 1
    s_add_u32 m0, s28, 32768
    v_mfma_f32_16x16x32_bf16 v[144:147], v[88:91], v[40:43], v[144:147]
    s_setprio 0
    ds_read_b64_tr_b16 v[88:89], v10 offset:22080
    buffer_load_dwordx4 v4, s[8:11], s66 offen offset:2048 sc1 lds
    v_mov_b32 v231, 0
    s_waitcnt lgkmcnt(3)
    v_mfma_f32_16x16x32_bf16 v[176:179], v[76:79], v[40:43], v[176:179]
    s_setprio 1
    ds_read_b64_tr_b16 v[90:91], v10 offset:25664
    s_add_u32 m0, s28, 32768
    v_mfma_f32_16x16x32_bf16 v[176:179], v[80:83], v[56:59], v[176:179]
    s_setprio 0
    buffer_load_dwordx4 v5, s[8:11], s66 offen offset:3072 sc1 lds
    v_mov_b32 v224, 0
    s_waitcnt vmcnt(9) lgkmcnt(0)
    s_barrier
    v_mfma_f32_16x16x32_bf16 v[180:183], v[80:83], v[60:63], v[180:183]
    s_setprio 1
    ds_read_b64_tr_b16 v[72:73], v10 offset:29312
    s_add_u32 s64, s64, 128
    s_bitset0_b32 s64, 11
    s_add_u32 m0, s29, 14592
    v_mfma_f32_16x16x32_bf16 v[180:183], v[76:79], v[44:47], v[180:183]
    s_setprio 0
    s_add_u32 s66, s64, 30720
    ds_read_b64_tr_b16 v[74:75], v10 offset:32896
    buffer_load_dwordx4 v6, s[16:19], s65 offen lds
    v_mov_b32 v225, 0
    v_mfma_f32_16x16x32_bf16 v[184:187], v[76:79], v[48:51], v[184:187]
    s_setprio 1
    s_add_u32 s65, s65, 229376
    v_mfma_f32_16x16x32_bf16 v[184:187], v[80:83], v[64:67], v[184:187]
    s_setprio 0
    v_mov_b32 v226, 0
    v_mfma_f32_16x16x32_bf16 v[188:191], v[80:83], v[68:71], v[188:191]
    s_setprio 1
    s_add_u32 m0, s29, 21888
    v_mfma_f32_16x16x32_bf16 v[188:191], v[76:79], v[52:55], v[188:191]
    s_setprio 0
    ds_read_b64_tr_b16 v[76:77], v10 offset:36608
    buffer_load_dwordx4 v6, s[16:19], s65 offen lds
    v_mov_b32 v227, 0
    v_mfma_f32_16x16x32_bf16 v[220:223], v[84:87], v[52:55], v[220:223]
    s_setprio 1
    ds_read_b128 v[52:55], v8 offset:6144
    ds_read_b64_tr_b16 v[78:79], v10 offset:40192
    s_add_u32 s65, s65, 229376
    v_mfma_f32_16x16x32_bf16 v[220:223], v[88:91], v[68:71], v[220:223]
    s_setprio 0
    ds_read_b128 v[68:71], v9 offset:6144
    ds_read_b64_tr_b16 v[80:81], v10 offset:29344
    v_mov_b32 v240, 0
    v_mfma_f32_16x16x32_bf16 v[216:219], v[88:91], v[64:67], v[216:219]
    s_setprio 1
    ds_read_b128 v[64:67], v9 offset:4096
    ds_read_b64_tr_b16 v[82:83], v10 offset:32928
    s_mov_b32 m0, 135168
    v_mfma_f32_16x16x32_bf16 v[216:219], v[84:87], v[48:51], v[216:219]
    s_setprio 0
    v_mov_b32 v241, 0
    ds_read_b128 v[48:51], v8 offset:4096
    buffer_load_dwordx4 v35, s[76:79], s37 offen  lds
    v_mfma_f32_16x16x32_bf16 v[212:215], v[84:87], v[44:47], v[212:215]
    s_setprio 1
    ds_read_b128 v[44:47], v8 offset:2048
    s_add_u32 s37, s37, 196608
    v_mfma_f32_16x16x32_bf16 v[212:215], v[88:91], v[60:63], v[212:215]
    s_setprio 0
    v_mov_b32 v242, 0
    ds_read_b128 v[60:63], v9 offset:2048
    v_mfma_f32_16x16x32_bf16 v[208:211], v[88:91], v[56:59], v[208:211]
    s_setprio 1
    ds_read_b128 v[56:59], v9 offset:0
    v_mfma_f32_16x16x32_bf16 v[208:211], v[84:87], v[40:43], v[208:211]
    s_setprio 0
    v_mov_b32 v243, 0
    ds_read_b128 v[40:43], v8 offset:0
    ds_read_b64_tr_b16 v[84:85], v10 offset:36640
    s_waitcnt lgkmcnt(9)
    v_mfma_f32_16x16x32_bf16 v[140:143], v[72:75], v[52:55], v[140:143]
    s_setprio 1
    ds_read_b64_tr_b16 v[86:87], v10 offset:40224
    v_mfma_f32_16x16x32_bf16 v[140:143], v[76:79], v[68:71], v[140:143]
    s_setprio 0
    v_mov_b32 v244, 0
    ds_read_b64_tr_b16 v[88:89], v10 offset:29376
    s_waitcnt lgkmcnt(7)
    v_mfma_f32_16x16x32_bf16 v[136:139], v[76:79], v[64:67], v[136:139]
    s_setprio 1
    ds_read_b64_tr_b16 v[90:91], v10 offset:32960
    s_mov_b32 m0, 141312
    v_mfma_f32_16x16x32_bf16 v[136:139], v[72:75], v[48:51], v[136:139]
    s_setprio 0
    v_mfma_f32_16x16x32_bf16 v[16:19], v[28:31], v[72:75], v[16:19]
    v_mfma_f32_16x16x32_bf16 v[16:19], v[28:31], v[76:79], v[16:19]
    v_mov_b32 v245, 0
    buffer_load_dwordx4 v35, s[76:79], s37 offen  lds
    s_waitcnt lgkmcnt(6)
    v_mfma_f32_16x16x32_bf16 v[132:135], v[72:75], v[44:47], v[132:135]
    s_setprio 1
    s_add_u32 s37, s37, 196608
    v_mfma_f32_16x16x32_bf16 v[132:135], v[76:79], v[60:63], v[132:135]
    s_setprio 0
    v_mov_b32 v246, 0
    s_waitcnt lgkmcnt(4)
    v_mfma_f32_16x16x32_bf16 v[128:131], v[76:79], v[56:59], v[128:131]
    s_setprio 1
    v_mfma_f32_16x16x32_bf16 v[128:131], v[72:75], v[40:43], v[128:131]
    s_setprio 0
    v_mov_b32 v247, 0
    ds_read_b64_tr_b16 v[72:73], v10 offset:36672
    s_waitcnt lgkmcnt(3)
    v_mfma_f32_16x16x32_bf16 v[160:163], v[80:83], v[40:43], v[160:163]
    s_setprio 1
    ds_read_b64_tr_b16 v[74:75], v10 offset:40256
    v_mfma_f32_16x16x32_bf16 v[160:163], v[84:87], v[56:59], v[160:163]
    s_setprio 0
    v_mov_b32 v248, 0
    s_waitcnt vmcnt(11) lgkmcnt(0)
    s_barrier
    v_mfma_f32_16x16x32_bf16 v[164:167], v[84:87], v[60:63], v[164:167]
    s_setprio 1
    ds_read_b64_tr_b16 v[76:77], v10 offset:43904
    s_add_u32 m0, s29, 29184
    v_mfma_f32_16x16x32_bf16 v[164:167], v[80:83], v[44:47], v[164:167]
    s_setprio 0
    v_mov_b32 v249, 0
    ds_read_b64_tr_b16 v[78:79], v10 offset:47488
    buffer_load_dwordx4 v6, s[12:15], s65 offen lds
    ds_read_b64 v[36:37], v26 offset:0
    v_mfma_f32_16x16x32_bf16 v[168:171], v[80:83], v[48:51], v[168:171]
    s_setprio 1
    ds_read_b64 v[38:39], v26 offset:128
    s_add_u32 s65, s65, 229376
    v_mfma_f32_16x16x32_bf16 v[168:171], v[84:87], v[64:67], v[168:171]
    s_setprio 0
    v_mov_b32 v250, 0
    ds_read_b64 v[12:13], v26 offset:256
    v_mfma_f32_16x16x32_bf16 v[172:175], v[84:87], v[68:71], v[172:175]
    s_setprio 1
    ds_read_b64 v[14:15], v26 offset:384
    s_add_u32 m0, s29, 36480
    v_mfma_f32_16x16x32_bf16 v[172:175], v[80:83], v[52:55], v[172:175]
    s_setprio 0
    v_mov_b32 v251, 0
    ds_read_b64_tr_b16 v[80:81], v10 offset:51200
    buffer_load_dwordx4 v6, s[12:15], s65 offen lds
    v_mfma_f32_16x16x32_bf16 v[204:207], v[88:91], v[52:55], v[204:207]
    s_setprio 1
    ds_read_b64_tr_b16 v[82:83], v10 offset:54784
    s_sub_u32 s65, s65, 229376
    v_mfma_f32_16x16x32_bf16 v[204:207], v[72:75], v[68:71], v[204:207]
    s_setprio 0
    v_mov_b32 v252, 0
    ds_read_b64_tr_b16 v[84:85], v10 offset:43936
    v_mfma_f32_16x16x32_bf16 v[200:203], v[72:75], v[64:67], v[200:203]
    s_setprio 1
    ds_read_b64_tr_b16 v[86:87], v10 offset:47520
    s_mov_b32 m0, 28672
    v_mfma_f32_16x16x32_bf16 v[200:203], v[88:91], v[48:51], v[200:203]
    s_setprio 0
    v_mov_b32 v253, 0
    s_add_u32 s5, s64, 196608
    buffer_load_dwordx4 v5, s[8:11], s5 offen offset:1024 sc1 lds
    v_mfma_f32_16x16x32_bf16 v[196:199], v[88:91], v[44:47], v[196:199]
    s_setprio 1
    v_mfma_f32_16x16x32_bf16 v[196:199], v[72:75], v[60:63], v[196:199]
    s_setprio 0
    v_mov_b32 v254, 0
    v_mfma_f32_16x16x32_bf16 v[192:195], v[72:75], v[56:59], v[192:195]
    s_setprio 1
    s_add_u32 m0, s28, 0
    v_mfma_f32_16x16x32_bf16 v[192:195], v[88:91], v[40:43], v[192:195]
    s_setprio 0
    v_mov_b32 v255, 0
    ds_read_b64_tr_b16 v[88:89], v10 offset:51232
    buffer_load_dwordx4 v4, s[8:11], s64 offen offset:0 sc1 lds
    s_waitcnt lgkmcnt(3)
    v_mfma_f32_16x16x32_bf16 v[144:147], v[76:79], v[40:43], v[144:147]
    s_setprio 1
    ds_read_b64_tr_b16 v[90:91], v10 offset:54816
    v_mfma_f32_16x16x32_bf16 v[144:147], v[80:83], v[56:59], v[144:147]
    s_setprio 0
    ds_read_b64_tr_b16 v[72:73], v10 offset:43968
    v_mfma_f32_16x16x32_bf16 v[148:151], v[80:83], v[60:63], v[148:151]
    s_setprio 1
    ds_read_b64_tr_b16 v[74:75], v10 offset:47552
    s_add_u32 m0, s28, 0
    v_mfma_f32_16x16x32_bf16 v[148:151], v[76:79], v[44:47], v[148:151]
    s_setprio 0
    v_mfma_f32_16x16x32_bf16 v[20:23], v[28:31], v[76:79], v[20:23]
    v_mfma_f32_16x16x32_bf16 v[20:23], v[28:31], v[80:83], v[20:23]
    buffer_load_dwordx4 v5, s[8:11], s64 offen offset:1024 sc1 lds
    v_mul_f32 v140, v140, v15
    v_mul_f32 v141, v141, v15
    v_mul_f32 v142, v142, v15
    v_mfma_f32_16x16x32_bf16 v[152:155], v[76:79], v[48:51], v[152:155]
    s_setprio 1
    v_mfma_f32_16x16x32_bf16 v[152:155], v[80:83], v[64:67], v[152:155]
    s_setprio 0
    v_mul_f32 v143, v143, v15
    v_mul_f32 v136, v136, v13
    v_mul_f32 v137, v137, v13
    v_mul_f32 v138, v138, v13
    v_mul_f32 v139, v139, v13
    v_mfma_f32_16x16x32_bf16 v[156:159], v[80:83], v[68:71], v[156:159]
    s_setprio 1
    s_add_u32 m0, s28, 0
    v_mfma_f32_16x16x32_bf16 v[156:159], v[76:79], v[52:55], v[156:159]
    s_setprio 0
    v_mul_f32 v132, v132, v39
    v_mul_f32 v133, v133, v39
    ds_read_b64_tr_b16 v[76:77], v10 offset:51264
    buffer_load_dwordx4 v4, s[8:11], s66 offen offset:2048 sc1 lds
    v_mul_f32 v134, v134, v39
    v_mul_f32 v135, v135, v39
    s_waitcnt lgkmcnt(3)
    v_mfma_f32_16x16x32_bf16 v[188:191], v[84:87], v[52:55], v[188:191]
    s_setprio 1
    ds_read_b64_tr_b16 v[78:79], v10 offset:54848
    s_add_u32 m0, s28, 0
    v_mfma_f32_16x16x32_bf16 v[188:191], v[88:91], v[68:71], v[188:191]
    s_setprio 0
    v_mul_f32 v128, v128, v37
    v_mul_f32 v129, v129, v37
    v_mul_f32 v130, v130, v37
    buffer_load_dwordx4 v5, s[8:11], s66 offen offset:3072 sc1 lds
    v_mul_f32 v131, v131, v37
    v_mul_f32 v160, v160, v37
    s_waitcnt vmcnt(11) lgkmcnt(0)
    s_barrier
    v_mfma_f32_16x16x32_bf16 v[184:187], v[88:91], v[64:67], v[184:187]
    s_setprio 1
    ds_read_b64_tr_b16 v[80:81], v10 offset:128
    s_add_u32 s64, s64, 128
    s_bitset0_b32 s64, 11
    s_add_u32 m0, s29, 43776
    v_mfma_f32_16x16x32_bf16 v[184:187], v[84:87], v[48:51], v[184:187]
    s_setprio 0
    s_add_u32 s66, s64, 30720
    v_mul_f32 v161, v161, v37
    v_mul_f32 v162, v162, v37
    v_mul_f32 v163, v163, v37
    ds_read_b64_tr_b16 v[82:83], v10 offset:3712
    buffer_load_dwordx4 v6, s[16:19], s65 offen lds
    v_mul_f32 v164, v164, v39
    v_mul_f32 v165, v165, v39
    v_mfma_f32_16x16x32_bf16 v[180:183], v[84:87], v[44:47], v[180:183]
    s_setprio 1
    s_add_u32 s65, s65, 229376
    v_mfma_f32_16x16x32_bf16 v[180:183], v[88:91], v[60:63], v[180:183]
    s_setprio 0
    v_mul_f32 v166, v166, v39
    v_mul_f32 v167, v167, v39
    v_mul_f32 v168, v168, v13
    v_mul_f32 v169, v169, v13
    v_mul_f32 v170, v170, v13
    v_mfma_f32_16x16x32_bf16 v[176:179], v[88:91], v[56:59], v[176:179]
    s_setprio 1
    s_add_u32 m0, s29, 51072
    v_mfma_f32_16x16x32_bf16 v[176:179], v[84:87], v[40:43], v[176:179]
    s_setprio 0
    v_mul_f32 v171, v171, v13
    v_mul_f32 v172, v172, v15
    ds_read_b64_tr_b16 v[84:85], v10 offset:7424
    buffer_load_dwordx4 v6, s[16:19], s65 offen lds
    v_mul_f32 v173, v173, v15
    v_mul_f32 v174, v174, v15
    v_mul_f32 v175, v175, v15
    v_mfma_f32_16x16x32_bf16 v[208:211], v[72:75], v[40:43], v[208:211]
    s_setprio 1
    ds_read_b128 v[40:43], v8 offset:32768
    ds_read_b64_tr_b16 v[86:87], v10 offset:11008
    s_add_u32 s65, s65, 229376
    v_mfma_f32_16x16x32_bf16 v[208:211], v[76:79], v[56:59], v[208:211]
    s_setprio 0
    v_mul_f32 v204, v204, v15
    v_mul_f32 v205, v205, v15
    ds_read_b128 v[56:59], v9 offset:32768
    ds_read_b64_tr_b16 v[88:89], v10 offset:160
    v_mul_f32 v206, v206, v15
    v_mul_f32 v207, v207, v15
    v_mfma_f32_16x16x32_bf16 v[212:215], v[76:79], v[60:63], v[212:215]
    s_setprio 1
    ds_read_b128 v[60:63], v9 offset:34816
    ds_read_b64_tr_b16 v[90:91], v10 offset:3744
    s_mov_b32 m0, 147456
    v_mfma_f32_16x16x32_bf16 v[212:215], v[72:75], v[44:47], v[212:215]
    s_setprio 0
    v_mul_f32 v200, v200, v13
    v_mul_f32 v201, v201, v13
    v_mul_f32 v202, v202, v13
    ds_read_b128 v[44:47], v8 offset:34816
    buffer_load_dwordx4 v35, s[76:79], s37 offen  lds
    v_mul_f32 v203, v203, v13
    v_mul_f32 v196, v196, v39
    v_mfma_f32_16x16x32_bf16 v[216:219], v[72:75], v[48:51], v[216:219]
    s_setprio 1
    ds_read_b128 v[48:51], v8 offset:36864
    s_add_u32 s37, s37, 196608
    v_mfma_f32_16x16x32_bf16 v[216:219], v[76:79], v[64:67], v[216:219]
    s_setprio 0
    v_mul_f32 v197, v197, v39
    v_mul_f32 v198, v198, v39
    v_mul_f32 v199, v199, v39
    ds_read_b128 v[64:67], v9 offset:36864
    v_mul_f32 v192, v192, v37
    v_mul_f32 v193, v193, v37
    v_mfma_f32_16x16x32_bf16 v[220:223], v[76:79], v[68:71], v[220:223]
    s_setprio 1
    ds_read_b128 v[68:71], v9 offset:38912
    v_mfma_f32_16x16x32_bf16 v[220:223], v[72:75], v[52:55], v[220:223]
    s_setprio 0
    v_mul_f32 v194, v194, v37
    v_mul_f32 v195, v195, v37
    ds_read_b128 v[52:55], v8 offset:38912
    ds_read_b64_tr_b16 v[72:73], v10 offset:7456
    s_waitcnt lgkmcnt(9)
    v_mfma_f32_16x16x32_bf16 v[128:131], v[80:83], v[40:43], v[128:131]
    s_setprio 1
    ds_read_b64_tr_b16 v[74:75], v10 offset:11040
    v_mfma_f32_16x16x32_bf16 v[128:131], v[84:87], v[56:59], v[128:131]
    s_setprio 0
    v_mul_f32 v144, v144, v37
    v_mul_f32 v145, v145, v37
    ds_read_b64_tr_b16 v[76:77], v10 offset:192
    v_mul_f32 v146, v146, v37
    s_waitcnt lgkmcnt(7)
    v_mfma_f32_16x16x32_bf16 v[132:135], v[84:87], v[60:63], v[132:135]
    s_setprio 1
    ds_read_b64_tr_b16 v[78:79], v10 offset:3776
    s_mov_b32 m0, 153600
    v_mfma_f32_16x16x32_bf16 v[132:135], v[80:83], v[44:47], v[132:135]
    s_setprio 0
    v_mul_f32 v147, v147, v37
    ds_write2_b32 v27, v16, v20 offset1:64
    buffer_load_dwordx4 v35, s[76:79], s37 offen  lds
    v_mul_f32 v148, v148, v39
    s_waitcnt lgkmcnt(7)
    v_mfma_f32_16x16x32_bf16 v[136:139], v[80:83], v[48:51], v[136:139]
    s_setprio 1
    s_add_u32 s37, s37, 196608
    v_mfma_f32_16x16x32_bf16 v[136:139], v[84:87], v[64:67], v[136:139]
    s_setprio 0
    v_mul_f32 v149, v149, v39
    v_mul_f32 v150, v150, v39
    v_mul_f32 v151, v151, v39
    s_waitcnt lgkmcnt(5)
    v_mfma_f32_16x16x32_bf16 v[140:143], v[84:87], v[68:71], v[140:143]
    s_setprio 1
    v_mfma_f32_16x16x32_bf16 v[140:143], v[80:83], v[52:55], v[140:143]
    s_setprio 0
    v_mul_f32 v152, v152, v13
    ds_read_b64_tr_b16 v[80:81], v10 offset:7488
    v_mul_f32 v153, v153, v13
    s_waitcnt lgkmcnt(4)
    v_mfma_f32_16x16x32_bf16 v[172:175], v[88:91], v[52:55], v[172:175]
    s_setprio 1
    ds_read_b64_tr_b16 v[82:83], v10 offset:11072
    v_mfma_f32_16x16x32_bf16 v[172:175], v[72:75], v[68:71], v[172:175]
    s_setprio 0
    v_mul_f32 v154, v154, v13
    v_mul_f32 v155, v155, v13
    v_mul_f32 v156, v156, v15
    s_waitcnt vmcnt(11) lgkmcnt(0)
    s_barrier
    v_mfma_f32_16x16x32_bf16 v[168:171], v[72:75], v[64:67], v[168:171]
    s_setprio 1
    ds_read_b64_tr_b16 v[84:85], v92 offset:34816
    s_add_u32 m0, s29, 0
    v_mfma_f32_16x16x32_bf16 v[168:171], v[88:91], v[48:51], v[168:171]
    s_setprio 0
    v_mul_f32 v157, v157, v15
    ds_read_b64_tr_b16 v[86:87], v92 offset:35840
    buffer_load_dwordx4 v6, s[12:15], s65 offen lds
    v_mul_f32 v158, v158, v15
    v_mfma_f32_16x16x32_bf16 v[164:167], v[88:91], v[44:47], v[164:167]
    s_setprio 1
    s_add_u32 s65, s65, 229376
    v_mfma_f32_16x16x32_bf16 v[164:167], v[72:75], v[60:63], v[164:167]
    s_setprio 0
    v_mul_f32 v159, v159, v15
    v_mul_f32 v188, v188, v15
    v_mul_f32 v189, v189, v15
    v_mfma_f32_16x16x32_bf16 v[160:163], v[72:75], v[56:59], v[160:163]
    s_setprio 1
    s_add_u32 m0, s29, 7296
    v_mfma_f32_16x16x32_bf16 v[160:163], v[88:91], v[40:43], v[160:163]
    s_setprio 0
    v_mul_f32 v190, v190, v15
    ds_read_b64_tr_b16 v[88:89], v92 offset:40960
    buffer_load_dwordx4 v6, s[12:15], s65 offen lds
    v_mul_f32 v191, v191, v15
    v_mfma_f32_16x16x32_bf16 v[192:195], v[76:79], v[40:43], v[192:195]
    s_setprio 1
    ds_read_b64_tr_b16 v[90:91], v92 offset:41984
    s_sub_u32 s65, s65, 229376
    v_mfma_f32_16x16x32_bf16 v[192:195], v[80:83], v[56:59], v[192:195]
    s_setprio 0
    v_mul_f32 v184, v184, v13
    ds_read_b64_tr_b16 v[28:29], v32 offset:34816
    v_mul_f32 v185, v185, v13
    v_mul_f32 v186, v186, v13
    v_mfma_f32_16x16x32_bf16 v[196:199], v[80:83], v[60:63], v[196:199]
    s_setprio 1
    ds_read_b64_tr_b16 v[30:31], v32 offset:35840
    v_mfma_f32_16x16x32_bf16 v[196:199], v[76:79], v[44:47], v[196:199]
    s_setprio 0
    v_mul_f32 v187, v187, v13
    ds_read_b64_tr_b16 v[16:17], v32 offset:40960
    v_mul_f32 v180, v180, v39
    v_mfma_f32_16x16x32_bf16 v[200:203], v[76:79], v[48:51], v[200:203]
    s_setprio 1
    ds_read_b64_tr_b16 v[18:19], v32 offset:41984
    v_mfma_f32_16x16x32_bf16 v[200:203], v[80:83], v[64:67], v[200:203]
    s_setprio 0
    v_mul_f32 v181, v181, v39
    ds_read_b64_tr_b16 v[72:73], v92 offset:36864
    v_mul_f32 v182, v182, v39
    v_mul_f32 v183, v183, v39
    v_mfma_f32_16x16x32_bf16 v[204:207], v[80:83], v[68:71], v[204:207]
    s_setprio 1
    ds_read_b64_tr_b16 v[74:75], v92 offset:37888
    v_mfma_f32_16x16x32_bf16 v[204:207], v[76:79], v[52:55], v[204:207]
    s_setprio 0
    v_mul_f32 v176, v176, v37
    v_mul_f32 v177, v177, v37
    s_waitcnt lgkmcnt(6)
    v_mfma_f32_16x16x32_bf16 v[108:111], v[84:87], v[52:55], 0
    s_setprio 1
    ds_read_b64_tr_b16 v[76:77], v92 offset:43008
    v_mfma_f32_16x16x32_bf16 v[108:111], v[88:91], v[68:71], v[108:111]
    s_setprio 0
    v_mul_f32 v178, v178, v37
    ds_read_b64_tr_b16 v[78:79], v92 offset:44032
    v_mul_f32 v179, v179, v37
    v_mfma_f32_16x16x32_bf16 v[104:107], v[88:91], v[64:67], 0
    s_setprio 1
    v_mfma_f32_16x16x32_bf16 v[104:107], v[84:87], v[48:51], v[104:107]
    s_setprio 0
    v_mul_f32 v208, v208, v37
    v_mul_f32 v209, v209, v37
    v_mul_f32 v210, v210, v37
    v_mfma_f32_16x16x32_bf16 v[100:103], v[84:87], v[44:47], 0
    s_setprio 1
    ds_read_b64_tr_b16 v[80:81], v32 offset:36864
    v_mfma_f32_16x16x32_bf16 v[100:103], v[88:91], v[60:63], v[100:103]
    s_setprio 0
    v_mul_f32 v211, v211, v37
    ds_read_b64_tr_b16 v[82:83], v32 offset:37888
    v_mul_f32 v212, v212, v39
    v_mfma_f32_16x16x32_bf16 v[96:99], v[88:91], v[56:59], 0
    s_setprio 1
    s_mov_b32 m0, 61440
    v_mfma_f32_16x16x32_bf16 v[96:99], v[84:87], v[40:43], v[96:99]
    s_setprio 0
    v_mul_f32 v213, v213, v39
    v_mul_f32 v214, v214, v39
    s_add_u32 s5, s64, 196608
    buffer_load_dwordx4 v5, s[8:11], s5 offen offset:1024 sc1 lds
    v_mul_f32 v215, v215, v39
    s_waitcnt lgkmcnt(6)
    v_mfma_f32_16x16x32_bf16 v[112:115], v[28:31], v[40:43], 0
    s_setprio 1
    ds_read_b64_tr_b16 v[84:85], v32 offset:43008
    v_mfma_f32_16x16x32_bf16 v[112:115], v[16:19], v[56:59], v[112:115]
    s_setprio 0
    v_mul_f32 v216, v216, v13
    ds_read_b64_tr_b16 v[86:87], v32 offset:44032
    v_mul_f32 v217, v217, v13
    v_mfma_f32_16x16x32_bf16 v[116:119], v[16:19], v[60:63], 0
    s_setprio 1
    s_add_u32 m0, s28, 32768
    v_mfma_f32_16x16x32_bf16 v[116:119], v[28:31], v[44:47], v[116:119]
    s_setprio 0
    v_mul_f32 v218, v218, v13
    v_mul_f32 v219, v219, v13
    buffer_load_dwordx4 v4, s[8:11], s64 offen offset:0 sc1 lds
    v_mul_f32 v220, v220, v15
    v_mfma_f32_16x16x32_bf16 v[120:123], v[28:31], v[48:51], 0
    s_setprio 1
    ds_read_b64_tr_b16 v[88:89], v10 offset:14720
    v_mfma_f32_16x16x32_bf16 v[120:123], v[16:19], v[64:67], v[120:123]
    s_setprio 0
    v_mul_f32 v221, v221, v15
    ds_read_b64_tr_b16 v[90:91], v10 offset:18304
    v_mul_f32 v222, v222, v15
    v_mfma_f32_16x16x32_bf16 v[124:127], v[16:19], v[68:71], 0
    s_setprio 1
    v_mfma_f32_16x16x32_bf16 v[124:127], v[28:31], v[52:55], v[124:127]
    s_setprio 0
    v_mul_f32 v223, v223, v15
    s_nop 1
L_loop4:
    s_waitcnt lgkmcnt(6)
    v_mfma_f32_16x16x32_bf16 v[236:239], v[52:55], v[72:75], v[236:239]
    s_setprio 1
    ds_read_b64_tr_b16 v[28:29], v10 offset:22016
    v_mfma_f32_16x16x32_bf16 v[236:239], v[68:71], v[76:79], v[236:239]
    s_setprio 0
    ds_read_b64_tr_b16 v[30:31], v10 offset:25600
    v_mfma_f32_16x16x32_bf16 v[232:235], v[64:67], v[76:79], v[232:235]
    s_setprio 1
    s_add_u32 m0, s28, 32768
    v_mfma_f32_16x16x32_bf16 v[232:235], v[48:51], v[72:75], v[232:235]
    s_setprio 0
    buffer_load_dwordx4 v5, s[8:11], s64 offen offset:1024 sc1 lds
    v_mfma_f32_16x16x32_bf16 v[228:231], v[44:47], v[72:75], v[228:231]
    s_setprio 1
    v_mfma_f32_16x16x32_bf16 v[228:231], v[60:63], v[76:79], v[228:231]
    s_setprio 0
    v_mfma_f32_16x16x32_bf16 v[224:227], v[56:59], v[76:79], v[224:227]
    s_setprio 1
    v_mfma_f32_16x16x32_bf16 v[224:227], v[40:43], v[72:75], v[224:227]
    s_setprio 0
    ds_read_b64_tr_b16 v[72:73], v10 offset:14752
    s_waitcnt lgkmcnt(5)
    v_mfma_f32_16x16x32_bf16 v[240:243], v[40:43], v[80:83], v[240:243]
    s_setprio 1
    ds_read_b64_tr_b16 v[74:75], v10 offset:18336
    v_mfma_f32_16x16x32_bf16 v[240:243], v[56:59], v[84:87], v[240:243]
    s_setprio 0
    ds_read_b64_tr_b16 v[76:77], v10 offset:22048
    v_mfma_f32_16x16x32_bf16 v[244:247], v[60:63], v[84:87], v[244:247]
    s_setprio 1
    ds_read_b64_tr_b16 v[78:79], v10 offset:25632
    s_add_u32 m0, s28, 32768
    v_mfma_f32_16x16x32_bf16 v[244:247], v[44:47], v[80:83], v[244:247]
    s_setprio 0
    buffer_load_dwordx4 v4, s[8:11], s66 offen offset:2048 sc1 lds
    v_mfma_f32_16x16x32_bf16 v[248:251], v[48:51], v[80:83], v[248:251]
    s_setprio 1
    v_mfma_f32_16x16x32_bf16 v[248:251], v[64:67], v[84:87], v[248:251]
    s_setprio 0
    v_mfma_f32_16x16x32_bf16 v[252:255], v[68:71], v[84:87], v[252:255]
    s_setprio 1
    v_mfma_f32_16x16x32_bf16 v[252:255], v[52:55], v[80:83], v[252:255]
    s_setprio 0
    ds_read_b64_tr_b16 v[80:81], v10 offset:14784
    s_waitcnt lgkmcnt(5)
    v_mfma_f32_16x16x32_bf16 v[156:159], v[88:91], v[52:55], v[156:159]
    s_setprio 1
    ds_read_b64_tr_b16 v[82:83], v10 offset:18368
    v_mfma_f32_16x16x32_bf16 v[156:159], v[28:31], v[68:71], v[156:159]
    s_setprio 0
    ds_read_b64_tr_b16 v[84:85], v10 offset:22080
    v_mfma_f32_16x16x32_bf16 v[152:155], v[28:31], v[64:67], v[152:155]
    s_setprio 1
    ds_read_b64_tr_b16 v[86:87], v10 offset:25664
    s_add_u32 m0, s28, 32768
    v_mfma_f32_16x16x32_bf16 v[152:155], v[88:91], v[48:51], v[152:155]
    s_setprio 0
    buffer_load_dwordx4 v5, s[8:11], s66 offen offset:3072 sc1 lds
    v_mfma_f32_16x16x32_bf16 v[148:151], v[88:91], v[44:47], v[148:151]
    s_setprio 1
    s_add_u32 s64, s64, 128
    s_bitset0_b32 s64, 11
    v_mfma_f32_16x16x32_bf16 v[148:151], v[28:31], v[60:63], v[148:151]
    s_setprio 0
    s_add_u32 s66, s64, 30720
    s_waitcnt vmcnt(11) lgkmcnt(0)
    s_barrier
    v_mfma_f32_16x16x32_bf16 v[144:147], v[28:31], v[56:59], v[144:147]
    s_setprio 1
    ds_read_b128 v[12:15], v8 offset:6144
    s_add_u32 m0, s29, 14592
    v_mfma_f32_16x16x32_bf16 v[144:147], v[88:91], v[40:43], v[144:147]
    s_setprio 0
    ds_read_b64_tr_b16 v[88:89], v10 offset:29312
    buffer_load_dwordx4 v6, s[16:19], s65 offen lds
    v_mfma_f32_16x16x32_bf16 v[176:179], v[72:75], v[40:43], v[176:179]
    s_setprio 1
    ds_read_b64_tr_b16 v[90:91], v10 offset:32896
    s_add_u32 s65, s65, 229376
    v_mfma_f32_16x16x32_bf16 v[176:179], v[76:79], v[56:59], v[176:179]
    s_setprio 0
    ds_read_b64_tr_b16 v[28:29], v10 offset:36608
    v_mfma_f32_16x16x32_bf16 v[180:183], v[76:79], v[60:63], v[180:183]
    s_setprio 1
    ds_read_b64_tr_b16 v[30:31], v10 offset:40192
    v_mfma_f32_16x16x32_bf16 v[180:183], v[72:75], v[44:47], v[180:183]
    s_setprio 0
    ds_read_b128 v[36:39], v9 offset:6144
    v_mfma_f32_16x16x32_bf16 v[184:187], v[72:75], v[48:51], v[184:187]
    s_setprio 1
    ds_read_b64_tr_b16 v[16:17], v10 offset:29344
    v_mfma_f32_16x16x32_bf16 v[184:187], v[76:79], v[64:67], v[184:187]
    s_setprio 0
    ds_read_b64_tr_b16 v[18:19], v10 offset:32928
    v_mfma_f32_16x16x32_bf16 v[188:191], v[76:79], v[68:71], v[188:191]
    s_setprio 1
    s_add_u32 m0, s29, 21888
    v_mfma_f32_16x16x32_bf16 v[188:191], v[72:75], v[52:55], v[188:191]
    s_setprio 0
    buffer_load_dwordx4 v6, s[16:19], s65 offen lds
    v_mfma_f32_16x16x32_bf16 v[220:223], v[80:83], v[52:55], v[220:223]
    s_setprio 1
    ds_read_b128 v[52:55], v9 offset:4096
    ds_read_b64_tr_b16 v[72:73], v10 offset:36640
    s_add_u32 s65, s65, 229376
    v_mfma_f32_16x16x32_bf16 v[220:223], v[84:87], v[68:71], v[220:223]
    s_setprio 0
    ds_read_b128 v[68:71], v8 offset:4096
    ds_read_b64_tr_b16 v[74:75], v10 offset:40224
    v_mfma_f32_16x16x32_bf16 v[216:219], v[84:87], v[64:67], v[216:219]
    s_setprio 1
    ds_read_b128 v[64:67], v8 offset:2048
    v_mfma_f32_16x16x32_bf16 v[216:219], v[80:83], v[48:51], v[216:219]
    s_setprio 0
    ds_read_b128 v[48:51], v9 offset:2048
    v_mfma_f32_16x16x32_bf16 v[212:215], v[80:83], v[44:47], v[212:215]
    s_setprio 1
    ds_read_b128 v[44:47], v9 offset:0
    ds_read_b64_tr_b16 v[76:77], v10 offset:29376
    v_mfma_f32_16x16x32_bf16 v[212:215], v[84:87], v[60:63], v[212:215]
    s_setprio 0
    ds_read_b128 v[60:63], v8 offset:0
    ds_read_b64_tr_b16 v[78:79], v10 offset:32960
    v_mfma_f32_16x16x32_bf16 v[208:211], v[84:87], v[56:59], v[208:211]
    s_setprio 1
    s_mov_b32 m0, 135168
    v_mfma_f32_16x16x32_bf16 v[208:211], v[80:83], v[40:43], v[208:211]
    s_setprio 0
    buffer_load_dwordx4 v35, s[76:79], s37 offen  lds
    s_add_u32 s37, s37, 196608
    s_waitcnt lgkmcnt(12)
    v_mfma_f32_16x16x32_bf16 v[140:143], v[88:91], v[12:15], v[140:143]
    s_setprio 1
    ds_read_b64_tr_b16 v[80:81], v10 offset:36672
    v_mfma_f32_16x16x32_bf16 v[140:143], v[28:31], v[36:39], v[140:143]
    s_setprio 0
    ds_read_b64_tr_b16 v[82:83], v10 offset:40256
    s_waitcnt lgkmcnt(9)
    v_mfma_f32_16x16x32_bf16 v[136:139], v[28:31], v[52:55], v[136:139]
    s_setprio 1
    v_mfma_f32_16x16x32_bf16 v[136:139], v[88:91], v[68:71], v[136:139]
    s_setprio 0
    s_waitcnt lgkmcnt(6)
    v_mfma_f32_16x16x32_bf16 v[132:135], v[88:91], v[64:67], v[132:135]
    s_setprio 1
    v_mfma_f32_16x16x32_bf16 v[132:135], v[28:31], v[48:51], v[132:135]
    s_setprio 0
    s_waitcnt lgkmcnt(3)
    v_mfma_f32_16x16x32_bf16 v[128:131], v[28:31], v[44:47], v[128:131]
    s_setprio 1
    s_mov_b32 m0, 141312
    v_mfma_f32_16x16x32_bf16 v[128:131], v[88:91], v[60:63], v[128:131]
    s_setprio 0
    buffer_load_dwordx4 v35, s[76:79], s37 offen  lds
    v_mfma_f32_16x16x32_bf16 v[160:163], v[16:19], v[60:63], v[160:163]
    s_setprio 1
    s_add_u32 s37, s37, 196608
    v_mfma_f32_16x16x32_bf16 v[160:163], v[72:75], v[44:47], v[160:163]
    s_setprio 0
    v_mfma_f32_16x16x32_bf16 v[164:167], v[72:75], v[48:51], v[164:167]
    s_setprio 1
    v_mfma_f32_16x16x32_bf16 v[164:167], v[16:19], v[64:67], v[164:167]
    s_setprio 0
    v_mfma_f32_16x16x32_bf16 v[168:171], v[16:19], v[68:71], v[168:171]
    s_setprio 1
    v_mfma_f32_16x16x32_bf16 v[168:171], v[72:75], v[52:55], v[168:171]
    s_setprio 0
    s_waitcnt vmcnt(11) lgkmcnt(0)
    s_barrier
    v_mfma_f32_16x16x32_bf16 v[172:175], v[72:75], v[36:39], v[172:175]
    s_setprio 1
    ds_read_b64_tr_b16 v[84:85], v92 offset:47104
    s_add_u32 m0, s29, 29184
    v_mfma_f32_16x16x32_bf16 v[172:175], v[16:19], v[12:15], v[172:175]
    s_setprio 0
    ds_read_b64_tr_b16 v[86:87], v92 offset:48128
    buffer_load_dwordx4 v6, s[12:15], s65 offen lds
    v_mfma_f32_16x16x32_bf16 v[204:207], v[76:79], v[12:15], v[204:207]
    s_setprio 1
    ds_read_b64_tr_b16 v[88:89], v92 offset:53248
    s_add_u32 s65, s65, 229376
    v_mfma_f32_16x16x32_bf16 v[204:207], v[80:83], v[36:39], v[204:207]
    s_setprio 0
    ds_read_b64_tr_b16 v[90:91], v92 offset:54272
    v_mfma_f32_16x16x32_bf16 v[200:203], v[80:83], v[52:55], v[200:203]
    s_setprio 1
    ds_read_b64_tr_b16 v[28:29], v32 offset:47104
    v_mfma_f32_16x16x32_bf16 v[200:203], v[76:79], v[68:71], v[200:203]
    s_setprio 0
    ds_read_b64_tr_b16 v[30:31], v32 offset:48128
    v_mfma_f32_16x16x32_bf16 v[196:199], v[76:79], v[64:67], v[196:199]
    s_setprio 1
    ds_read_b64_tr_b16 v[16:17], v32 offset:53248
    v_mfma_f32_16x16x32_bf16 v[196:199], v[80:83], v[48:51], v[196:199]
    s_setprio 0
    ds_read_b64_tr_b16 v[18:19], v32 offset:54272
    v_mfma_f32_16x16x32_bf16 v[192:195], v[80:83], v[44:47], v[192:195]
    s_setprio 1
    ds_read_b64_tr_b16 v[72:73], v92 offset:49152
    s_add_u32 m0, s29, 36480
    v_mfma_f32_16x16x32_bf16 v[192:195], v[76:79], v[60:63], v[192:195]
    s_setprio 0
    ds_read_b64_tr_b16 v[74:75], v92 offset:50176
    buffer_load_dwordx4 v6, s[12:15], s65 offen lds
    s_waitcnt lgkmcnt(6)
    v_mfma_f32_16x16x32_bf16 v[96:99], v[84:87], v[60:63], v[96:99]
    s_setprio 1
    ds_read_b64_tr_b16 v[76:77], v92 offset:55296
    s_sub_u32 s65, s65, 229376
    v_mfma_f32_16x16x32_bf16 v[96:99], v[88:91], v[44:47], v[96:99]
    s_setprio 0
    ds_read_b64_tr_b16 v[78:79], v92 offset:56320
    v_mfma_f32_16x16x32_bf16 v[100:103], v[88:91], v[48:51], v[100:103]
    s_setprio 1
    v_mfma_f32_16x16x32_bf16 v[100:103], v[84:87], v[64:67], v[100:103]
    s_setprio 0
    v_mfma_f32_16x16x32_bf16 v[104:107], v[84:87], v[68:71], v[104:107]
    s_setprio 1
    ds_read_b64_tr_b16 v[80:81], v32 offset:49152
    v_mfma_f32_16x16x32_bf16 v[104:107], v[88:91], v[52:55], v[104:107]
    s_setprio 0
    ds_read_b64_tr_b16 v[82:83], v32 offset:50176
    v_mfma_f32_16x16x32_bf16 v[108:111], v[88:91], v[36:39], v[108:111]
    s_setprio 1
    s_mov_b32 m0, 28672
    v_mfma_f32_16x16x32_bf16 v[108:111], v[84:87], v[12:15], v[108:111]
    s_setprio 0
    s_add_u32 s5, s64, 196608
    buffer_load_dwordx4 v5, s[8:11], s5 offen offset:1024 sc1 lds
    s_waitcnt lgkmcnt(6)
    v_mfma_f32_16x16x32_bf16 v[124:127], v[28:31], v[12:15], v[124:127]
    s_setprio 1
    ds_read_b64_tr_b16 v[84:85], v32 offset:55296
    v_mfma_f32_16x16x32_bf16 v[124:127], v[16:19], v[36:39], v[124:127]
    s_setprio 0
    ds_read_b64_tr_b16 v[86:87], v32 offset:56320
    v_mfma_f32_16x16x32_bf16 v[120:123], v[16:19], v[52:55], v[120:123]
    s_setprio 1
    s_add_u32 m0, s28, 0
    v_mfma_f32_16x16x32_bf16 v[120:123], v[28:31], v[68:71], v[120:123]
    s_setprio 0
    buffer_load_dwordx4 v4, s[8:11], s64 offen offset:0 sc1 lds
    v_mfma_f32_16x16x32_bf16 v[116:119], v[28:31], v[64:67], v[116:119]
    s_setprio 1
    ds_read_b64_tr_b16 v[88:89], v10 offset:43904
    v_mfma_f32_16x16x32_bf16 v[116:119], v[16:19], v[48:51], v[116:119]
    s_setprio 0
    ds_read_b64_tr_b16 v[90:91], v10 offset:47488
    v_mfma_f32_16x16x32_bf16 v[112:115], v[16:19], v[44:47], v[112:115]
    s_setprio 1
    v_mfma_f32_16x16x32_bf16 v[112:115], v[28:31], v[60:63], v[112:115]
    s_setprio 0
    s_waitcnt lgkmcnt(6)
    v_mfma_f32_16x16x32_bf16 v[224:227], v[60:63], v[72:75], v[224:227]
    s_setprio 1
    ds_read_b64_tr_b16 v[28:29], v10 offset:51200
    v_mfma_f32_16x16x32_bf16 v[224:227], v[44:47], v[76:79], v[224:227]
    s_setprio 0
    ds_read_b64_tr_b16 v[30:31], v10 offset:54784
    v_mfma_f32_16x16x32_bf16 v[228:231], v[48:51], v[76:79], v[228:231]
    s_setprio 1
    s_add_u32 m0, s28, 0
    v_mfma_f32_16x16x32_bf16 v[228:231], v[64:67], v[72:75], v[228:231]
    s_setprio 0
    buffer_load_dwordx4 v5, s[8:11], s64 offen offset:1024 sc1 lds
    v_mfma_f32_16x16x32_bf16 v[232:235], v[68:71], v[72:75], v[232:235]
    s_setprio 1
    v_mfma_f32_16x16x32_bf16 v[232:235], v[52:55], v[76:79], v[232:235]
    s_setprio 0
    v_mfma_f32_16x16x32_bf16 v[236:239], v[36:39], v[76:79], v[236:239]
    s_setprio 1
    v_mfma_f32_16x16x32_bf16 v[236:239], v[12:15], v[72:75], v[236:239]
    s_setprio 0
    ds_read_b64_tr_b16 v[72:73], v10 offset:43936
    s_waitcnt lgkmcnt(5)
    v_mfma_f32_16x16x32_bf16 v[252:255], v[12:15], v[80:83], v[252:255]
    s_setprio 1
    ds_read_b64_tr_b16 v[74:75], v10 offset:47520
    v_mfma_f32_16x16x32_bf16 v[252:255], v[36:39], v[84:87], v[252:255]
    s_setprio 0
    ds_read_b64_tr_b16 v[76:77], v10 offset:51232
    v_mfma_f32_16x16x32_bf16 v[248:251], v[52:55], v[84:87], v[248:251]
    s_setprio 1
    ds_read_b64_tr_b16 v[78:79], v10 offset:54816
    s_add_u32 m0, s28, 0
    v_mfma_f32_16x16x32_bf16 v[248:251], v[68:71], v[80:83], v[248:251]
    s_setprio 0
    buffer_load_dwordx4 v4, s[8:11], s66 offen offset:2048 sc1 lds
    v_mfma_f32_16x16x32_bf16 v[244:247], v[64:67], v[80:83], v[244:247]
    s_setprio 1
    v_mfma_f32_16x16x32_bf16 v[244:247], v[48:51], v[84:87], v[244:247]
    s_setprio 0
    v_mfma_f32_16x16x32_bf16 v[240:243], v[44:47], v[84:87], v[240:243]
    s_setprio 1
    v_mfma_f32_16x16x32_bf16 v[240:243], v[60:63], v[80:83], v[240:243]
    s_setprio 0
    ds_read_b64_tr_b16 v[80:81], v10 offset:43968
    s_waitcnt lgkmcnt(5)
    v_mfma_f32_16x16x32_bf16 v[144:147], v[88:91], v[60:63], v[144:147]
    s_setprio 1
    ds_read_b64_tr_b16 v[82:83], v10 offset:47552
    v_mfma_f32_16x16x32_bf16 v[144:147], v[28:31], v[44:47], v[144:147]
    s_setprio 0
    ds_read_b64_tr_b16 v[84:85], v10 offset:51264
    v_mfma_f32_16x16x32_bf16 v[148:151], v[28:31], v[48:51], v[148:151]
    s_setprio 1
    ds_read_b64_tr_b16 v[86:87], v10 offset:54848
    s_add_u32 m0, s28, 0
    v_mfma_f32_16x16x32_bf16 v[148:151], v[88:91], v[64:67], v[148:151]
    s_setprio 0
    buffer_load_dwordx4 v5, s[8:11], s66 offen offset:3072 sc1 lds
    v_mfma_f32_16x16x32_bf16 v[152:155], v[88:91], v[68:71], v[152:155]
    s_setprio 1
    s_add_u32 s64, s64, 128
    s_bitset0_b32 s64, 11
    v_mfma_f32_16x16x32_bf16 v[152:155], v[28:31], v[52:55], v[152:155]
    s_setprio 0
    s_add_u32 s66, s64, 30720
    s_waitcnt vmcnt(11) lgkmcnt(0)
    s_barrier
    v_mfma_f32_16x16x32_bf16 v[156:159], v[28:31], v[36:39], v[156:159]
    s_setprio 1
    ds_read_b128 v[40:43], v8 offset:32768
    s_add_u32 m0, s29, 43776
    v_mfma_f32_16x16x32_bf16 v[156:159], v[88:91], v[12:15], v[156:159]
    s_setprio 0
    ds_read_b64_tr_b16 v[88:89], v10 offset:128
    buffer_load_dwordx4 v6, s[16:19], s65 offen lds
    v_mfma_f32_16x16x32_bf16 v[188:191], v[72:75], v[12:15], v[188:191]
    s_setprio 1
    ds_read_b64_tr_b16 v[90:91], v10 offset:3712
    s_add_u32 s65, s65, 229376
    v_mfma_f32_16x16x32_bf16 v[188:191], v[76:79], v[36:39], v[188:191]
    s_setprio 0
    ds_read_b64_tr_b16 v[28:29], v10 offset:7424
    v_mfma_f32_16x16x32_bf16 v[184:187], v[76:79], v[52:55], v[184:187]
    s_setprio 1
    ds_read_b64_tr_b16 v[30:31], v10 offset:11008
    v_mfma_f32_16x16x32_bf16 v[184:187], v[72:75], v[68:71], v[184:187]
    s_setprio 0
    ds_read_b128 v[56:59], v9 offset:32768
    v_mfma_f32_16x16x32_bf16 v[180:183], v[72:75], v[64:67], v[180:183]
    s_setprio 1
    ds_read_b64_tr_b16 v[16:17], v10 offset:160
    v_mfma_f32_16x16x32_bf16 v[180:183], v[76:79], v[48:51], v[180:183]
    s_setprio 0
    ds_read_b64_tr_b16 v[18:19], v10 offset:3744
    v_mfma_f32_16x16x32_bf16 v[176:179], v[76:79], v[44:47], v[176:179]
    s_setprio 1
    s_add_u32 m0, s29, 51072
    v_mfma_f32_16x16x32_bf16 v[176:179], v[72:75], v[60:63], v[176:179]
    s_setprio 0
    buffer_load_dwordx4 v6, s[16:19], s65 offen lds
    v_mfma_f32_16x16x32_bf16 v[208:211], v[80:83], v[60:63], v[208:211]
    s_setprio 1
    ds_read_b128 v[60:63], v9 offset:34816
    ds_read_b64_tr_b16 v[72:73], v10 offset:7456
    s_add_u32 s65, s65, 229376
    v_mfma_f32_16x16x32_bf16 v[208:211], v[84:87], v[44:47], v[208:211]
    s_setprio 0
    ds_read_b128 v[44:47], v8 offset:34816
    ds_read_b64_tr_b16 v[74:75], v10 offset:11040
    v_mfma_f32_16x16x32_bf16 v[212:215], v[84:87], v[48:51], v[212:215]
    s_setprio 1
    ds_read_b128 v[48:51], v8 offset:36864
    v_mfma_f32_16x16x32_bf16 v[212:215], v[80:83], v[64:67], v[212:215]
    s_setprio 0
    ds_read_b128 v[64:67], v9 offset:36864
    v_mfma_f32_16x16x32_bf16 v[216:219], v[80:83], v[68:71], v[216:219]
    s_setprio 1
    ds_read_b128 v[68:71], v9 offset:38912
    ds_read_b64_tr_b16 v[76:77], v10 offset:192
    v_mfma_f32_16x16x32_bf16 v[216:219], v[84:87], v[52:55], v[216:219]
    s_setprio 0
    ds_read_b128 v[52:55], v8 offset:38912
    ds_read_b64_tr_b16 v[78:79], v10 offset:3776
    v_mfma_f32_16x16x32_bf16 v[220:223], v[84:87], v[36:39], v[220:223]
    s_setprio 1
    s_mov_b32 m0, 147456
    v_mfma_f32_16x16x32_bf16 v[220:223], v[80:83], v[12:15], v[220:223]
    s_setprio 0
    buffer_load_dwordx4 v35, s[76:79], s37 offen  lds
    s_add_u32 s37, s37, 196608
    s_waitcnt lgkmcnt(12)
    v_mfma_f32_16x16x32_bf16 v[128:131], v[88:91], v[40:43], v[128:131]
    s_setprio 1
    ds_read_b64_tr_b16 v[80:81], v10 offset:7488
    v_mfma_f32_16x16x32_bf16 v[128:131], v[28:31], v[56:59], v[128:131]
    s_setprio 0
    ds_read_b64_tr_b16 v[82:83], v10 offset:11072
    s_waitcnt lgkmcnt(9)
    v_mfma_f32_16x16x32_bf16 v[132:135], v[28:31], v[60:63], v[132:135]
    s_setprio 1
    v_mfma_f32_16x16x32_bf16 v[132:135], v[88:91], v[44:47], v[132:135]
    s_setprio 0
    s_bitcmp1_b32 0x10, s36
    s_cbranch_scc1 L_h4p3_2
L_r4p3_2:
    s_waitcnt lgkmcnt(6)
    v_mfma_f32_16x16x32_bf16 v[136:139], v[88:91], v[48:51], v[136:139]
    s_setprio 1
    v_mfma_f32_16x16x32_bf16 v[136:139], v[28:31], v[64:67], v[136:139]
    s_setprio 0
    s_waitcnt lgkmcnt(3)
    v_mfma_f32_16x16x32_bf16 v[140:143], v[28:31], v[68:71], v[140:143]
    s_setprio 1
    s_mov_b32 m0, 153600
    v_mfma_f32_16x16x32_bf16 v[140:143], v[88:91], v[52:55], v[140:143]
    s_setprio 0
    buffer_load_dwordx4 v35, s[76:79], s37 offen  lds
    v_mfma_f32_16x16x32_bf16 v[172:175], v[16:19], v[52:55], v[172:175]
    s_setprio 1
    s_add_u32 s37, s37, 196608
    v_mfma_f32_16x16x32_bf16 v[172:175], v[72:75], v[68:71], v[172:175]
    s_setprio 0
    v_mfma_f32_16x16x32_bf16 v[168:171], v[72:75], v[64:67], v[168:171]
    s_setprio 1
    v_mfma_f32_16x16x32_bf16 v[168:171], v[16:19], v[48:51], v[168:171]
    s_setprio 0
    v_mfma_f32_16x16x32_bf16 v[164:167], v[16:19], v[44:47], v[164:167]
    s_setprio 1
    v_mfma_f32_16x16x32_bf16 v[164:167], v[72:75], v[60:63], v[164:167]
    s_setprio 0
    s_waitcnt vmcnt(11) lgkmcnt(0)
    s_barrier
    v_mfma_f32_16x16x32_bf16 v[160:163], v[72:75], v[56:59], v[160:163]
    s_setprio 1
    ds_read_b64_tr_b16 v[84:85], v92 offset:34816
    s_add_u32 m0, s29, 0
    v_mfma_f32_16x16x32_bf16 v[160:163], v[16:19], v[40:43], v[160:163]
    s_setprio 0
    ds_read_b64_tr_b16 v[86:87], v92 offset:35840
    buffer_load_dwordx4 v6, s[12:15], s65 offen lds
    v_mfma_f32_16x16x32_bf16 v[192:195], v[76:79], v[40:43], v[192:195]
    s_setprio 1
    ds_read_b64_tr_b16 v[88:89], v92 offset:40960
    s_add_u32 s65, s65, 229376
    v_mfma_f32_16x16x32_bf16 v[192:195], v[80:83], v[56:59], v[192:195]
    s_setprio 0
    ds_read_b64_tr_b16 v[90:91], v92 offset:41984
    v_mfma_f32_16x16x32_bf16 v[196:199], v[80:83], v[60:63], v[196:199]
    s_setprio 1
    ds_read_b64_tr_b16 v[28:29], v32 offset:34816
    v_mfma_f32_16x16x32_bf16 v[196:199], v[76:79], v[44:47], v[196:199]
    s_setprio 0
    ds_read_b64_tr_b16 v[30:31], v32 offset:35840
    v_mfma_f32_16x16x32_bf16 v[200:203], v[76:79], v[48:51], v[200:203]
    s_setprio 1
    ds_read_b64_tr_b16 v[16:17], v32 offset:40960
    v_mfma_f32_16x16x32_bf16 v[200:203], v[80:83], v[64:67], v[200:203]
    s_setprio 0
    ds_read_b64_tr_b16 v[18:19], v32 offset:41984
    v_mfma_f32_16x16x32_bf16 v[204:207], v[80:83], v[68:71], v[204:207]
    s_setprio 1
    ds_read_b64_tr_b16 v[72:73], v92 offset:36864
    s_add_u32 m0, s29, 7296
    v_mfma_f32_16x16x32_bf16 v[204:207], v[76:79], v[52:55], v[204:207]
    s_setprio 0
    ds_read_b64_tr_b16 v[74:75], v92 offset:37888
    buffer_load_dwordx4 v6, s[12:15], s65 offen lds
    s_waitcnt lgkmcnt(6)
    v_mfma_f32_16x16x32_bf16 v[108:111], v[84:87], v[52:55], v[108:111]
    s_setprio 1
    ds_read_b64_tr_b16 v[76:77], v92 offset:43008
    s_sub_u32 s65, s65, 229376
    v_mfma_f32_16x16x32_bf16 v[108:111], v[88:91], v[68:71], v[108:111]
    s_setprio 0
    ds_read_b64_tr_b16 v[78:79], v92 offset:44032
    v_mfma_f32_16x16x32_bf16 v[104:107], v[88:91], v[64:67], v[104:107]
    s_setprio 1
    v_mfma_f32_16x16x32_bf16 v[104:107], v[84:87], v[48:51], v[104:107]
    s_setprio 0
    v_mfma_f32_16x16x32_bf16 v[100:103], v[84:87], v[44:47], v[100:103]
    s_setprio 1
    ds_read_b64_tr_b16 v[80:81], v32 offset:36864
    v_mfma_f32_16x16x32_bf16 v[100:103], v[88:91], v[60:63], v[100:103]
    s_setprio 0
    ds_read_b64_tr_b16 v[82:83], v32 offset:37888
    v_mfma_f32_16x16x32_bf16 v[96:99], v[88:91], v[56:59], v[96:99]
    s_setprio 1
    s_mov_b32 m0, 61440
    v_mfma_f32_16x16x32_bf16 v[96:99], v[84:87], v[40:43], v[96:99]
    s_setprio 0
    s_add_u32 s5, s64, 196608
    buffer_load_dwordx4 v5, s[8:11], s5 offen offset:1024 sc1 lds
    s_waitcnt lgkmcnt(6)
    v_mfma_f32_16x16x32_bf16 v[112:115], v[28:31], v[40:43], v[112:115]
    s_setprio 1
    ds_read_b64_tr_b16 v[84:85], v32 offset:43008
    v_mfma_f32_16x16x32_bf16 v[112:115], v[16:19], v[56:59], v[112:115]
    s_setprio 0
    ds_read_b64_tr_b16 v[86:87], v32 offset:44032
    v_mfma_f32_16x16x32_bf16 v[116:119], v[16:19], v[60:63], v[116:119]
    s_setprio 1
    s_add_u32 m0, s28, 32768
    v_mfma_f32_16x16x32_bf16 v[116:119], v[28:31], v[44:47], v[116:119]
    s_setprio 0
    buffer_load_dwordx4 v4, s[8:11], s64 offen offset:0 sc1 lds
    v_mfma_f32_16x16x32_bf16 v[120:123], v[28:31], v[48:51], v[120:123]
    s_setprio 1
    ds_read_b64_tr_b16 v[88:89], v10 offset:14720
    v_mfma_f32_16x16x32_bf16 v[120:123], v[16:19], v[64:67], v[120:123]
    s_setprio 0
    ds_read_b64_tr_b16 v[90:91], v10 offset:18304
    v_mfma_f32_16x16x32_bf16 v[124:127], v[16:19], v[68:71], v[124:127]
    s_setprio 1
    v_mfma_f32_16x16x32_bf16 v[124:127], v[28:31], v[52:55], v[124:127]
    s_setprio 0
    s_add_u32 s36, s36, 1
    s_cmp_lt_u32 s36, 5
    s_cbranch_scc1 L_loop4
    s_mov_b32 s80, 1179648
    s_mov_b32 s81, 1204224
    s_mov_b32 s82, 1181696
    s_mov_b32 s29, 110592
    s_mov_b32 s37, 4096
    s_mov_b32 s83, 135168
L_pb1:
    s_waitcnt lgkmcnt(6)
    v_mfma_f32_16x16x32_bf16 v[236:239], v[52:55], v[72:75], v[236:239]
    s_setprio 1
    v_mfma_f32_16x16x32_bf16 v[236:239], v[68:71], v[76:79], v[236:239]
    s_setprio 0
    v_and_b32 v34, 48, v1
    v_add_u32 v34, 161280, v34
    ds_read2_b32 v[12:13], v26 offset0:0 offset1:32
    v_mfma_f32_16x16x32_bf16 v[232:235], v[64:67], v[76:79], v[232:235]
    s_setprio 1
    s_add_u32 m0, s28, 32768
    v_mfma_f32_16x16x32_bf16 v[232:235], v[48:51], v[72:75], v[232:235]
    s_setprio 0
    buffer_load_dwordx4 v5, s[8:11], s64 offen offset:1024 sc1 lds
    ds_read2_b32 v[14:15], v26 offset0:64 offset1:96
    ds_read_b128 v[16:19], v34 offset:0
    v_mov_b32 v94, s69
    v_mfma_f32_16x16x32_bf16 v[228:231], v[44:47], v[72:75], v[228:231]
    s_setprio 1
    v_mfma_f32_16x16x32_bf16 v[228:231], v[60:63], v[76:79], v[228:231]
    s_setprio 0
    v_mov_b32 v95, s69
    v_lshrrev_b32 v30, 4, v1
    v_and_b32 v29, 15, v1
    v_mfma_f32_16x16x32_bf16 v[224:227], v[56:59], v[76:79], v[224:227]
    s_setprio 1
    v_mfma_f32_16x16x32_bf16 v[224:227], v[40:43], v[72:75], v[224:227]
    s_setprio 0
    ds_read_b64_tr_b16 v[72:73], v10 offset:22016
    v_lshlrev_b32 v28, 1, v30
    v_xor_b32 v29, v29, v28
    s_waitcnt lgkmcnt(6)
    v_mfma_f32_16x16x32_bf16 v[240:243], v[40:43], v[80:83], v[240:243]
    s_setprio 1
    ds_read_b64_tr_b16 v[74:75], v10 offset:25600
    v_mfma_f32_16x16x32_bf16 v[240:243], v[56:59], v[84:87], v[240:243]
    s_setprio 0
    ds_read_b64_tr_b16 v[76:77], v10 offset:14752
    v_lshlrev_b32 v29, 4, v29
    ds_read_b128 v[20:23], v34 offset:256
    s_waitcnt lgkmcnt(4)
    v_fmac_f32 v128, v12, v16
    v_mfma_f32_16x16x32_bf16 v[244:247], v[60:63], v[84:87], v[244:247]
    s_setprio 1
    ds_read_b64_tr_b16 v[78:79], v10 offset:18336
    s_add_u32 m0, s28, 32768
    v_mfma_f32_16x16x32_bf16 v[244:247], v[44:47], v[80:83], v[244:247]
    s_setprio 0
    buffer_load_dwordx4 v4, s[8:11], s66 offen offset:2048 sc1 lds
    v_fmac_f32 v129, v12, v17
    v_fmac_f32 v130, v12, v18
    v_fmac_f32 v131, v12, v19
    v_mfma_f32_16x16x32_bf16 v[248:251], v[48:51], v[80:83], v[248:251]
    s_setprio 1
    v_mfma_f32_16x16x32_bf16 v[248:251], v[64:67], v[84:87], v[248:251]
    s_setprio 0
    v_fmac_f32 v132, v13, v16
    v_fmac_f32 v133, v13, v17
    v_mfma_f32_16x16x32_bf16 v[252:255], v[68:71], v[84:87], v[252:255]
    s_setprio 1
    v_mfma_f32_16x16x32_bf16 v[252:255], v[52:55], v[80:83], v[252:255]
    s_setprio 0
    ds_read_b64_tr_b16 v[80:81], v10 offset:22048
    v_fmac_f32 v134, v13, v18
    v_fmac_f32 v135, v13, v19
    v_fmac_f32 v136, v14, v16
    s_waitcnt lgkmcnt(4)
    v_mfma_f32_16x16x32_bf16 v[156:159], v[88:91], v[52:55], v[156:159]
    s_setprio 1
    ds_read_b64_tr_b16 v[82:83], v10 offset:25632
    v_mfma_f32_16x16x32_bf16 v[156:159], v[72:75], v[68:71], v[156:159]
    s_setprio 0
    ds_read_b64_tr_b16 v[84:85], v10 offset:14784
    v_fmac_f32 v137, v14, v17
    v_fmac_f32 v138, v14, v18
    v_fmac_f32 v139, v14, v19
    v_mfma_f32_16x16x32_bf16 v[152:155], v[72:75], v[64:67], v[152:155]
    s_setprio 1
    ds_read_b64_tr_b16 v[86:87], v10 offset:18368
    s_add_u32 m0, s28, 32768
    v_mfma_f32_16x16x32_bf16 v[152:155], v[88:91], v[48:51], v[152:155]
    s_setprio 0
    buffer_load_dwordx4 v5, s[8:11], s66 offen offset:3072 sc1 lds
    v_fmac_f32 v140, v15, v16
    v_fmac_f32 v141, v15, v17
    v_mfma_f32_16x16x32_bf16 v[148:151], v[88:91], v[44:47], v[148:151]
    s_setprio 1
    s_add_u32 s64, s64, 128
    s_bitset0_b32 s64, 11
    v_mfma_f32_16x16x32_bf16 v[148:151], v[72:75], v[60:63], v[148:151]
    s_setprio 0
    s_add_u32 s66, s64, 30720
    v_fmac_f32 v142, v15, v18
    v_fmac_f32 v143, v15, v19
    v_lshl_add_u32 v29, v30, 11, v29
    v_mfma_f32_16x16x32_bf16 v[144:147], v[72:75], v[56:59], v[144:147]
    s_setprio 1
    v_mfma_f32_16x16x32_bf16 v[144:147], v[88:91], v[40:43], v[144:147]
    s_setprio 0
    ds_read_b64_tr_b16 v[88:89], v10 offset:22080
    s_lshl_b32 s5, s59, 14
    s_lshl_b32 s6, s72, 8
    s_add_u32 s5, s5, s6
    v_add_u32 v6, s5, v29
    v_xor_b32 v7, 0x80, v6
    v_add_u32 v7, 7168, v7
    s_waitcnt lgkmcnt(3)
    v_mfma_f32_16x16x32_bf16 v[176:179], v[76:79], v[40:43], v[176:179]
    s_setprio 1
    ds_read_b64_tr_b16 v[90:91], v10 offset:25664
    v_mfma_f32_16x16x32_bf16 v[176:179], v[80:83], v[56:59], v[176:179]
    s_setprio 0
    v_lshrrev_b32 v31, 4, v1
    v_lshrrev_b32 v28, 2, v1
    s_waitcnt vmcnt(9) lgkmcnt(0)
    s_barrier
    v_mfma_f32_16x16x32_bf16 v[180:183], v[80:83], v[60:63], v[180:183]
    s_setprio 1
    ds_read_b64_tr_b16 v[72:73], v10 offset:29312
    s_add_u32 m0, s83, 0x0
    v_mfma_f32_16x16x32_bf16 v[180:183], v[76:79], v[44:47], v[180:183]
    s_setprio 0
    ds_read_b64_tr_b16 v[74:75], v10 offset:32896
    buffer_load_dwordx4 v35, s[76:79], s37 offen  lds
    v_and_b32 v29, 3, v1
    ds_read_b128 v[16:19], v34 offset:320
    v_fmac_f32 v144, v12, v20
    v_mfma_f32_16x16x32_bf16 v[184:187], v[76:79], v[48:51], v[184:187]
    s_setprio 1
    s_add_u32 s37, s37, 196608
    v_mfma_f32_16x16x32_bf16 v[184:187], v[80:83], v[64:67], v[184:187]
    s_setprio 0
    v_fmac_f32 v145, v12, v21
    v_fmac_f32 v146, v12, v22
    v_fmac_f32 v147, v12, v23
    v_mfma_f32_16x16x32_bf16 v[188:191], v[80:83], v[68:71], v[188:191]
    s_setprio 1
    s_add_u32 m0, s83, 0x1800
    v_mfma_f32_16x16x32_bf16 v[188:191], v[76:79], v[52:55], v[188:191]
    s_setprio 0
    ds_read_b64_tr_b16 v[76:77], v10 offset:36608
    buffer_load_dwordx4 v35, s[76:79], s37 offen  lds
    v_fmac_f32 v148, v13, v20
    v_fmac_f32 v149, v13, v21
    v_mfma_f32_16x16x32_bf16 v[220:223], v[84:87], v[52:55], v[220:223]
    s_setprio 1
    ds_read_b128 v[52:55], v8 offset:6144
    ds_read_b64_tr_b16 v[78:79], v10 offset:40192
    s_add_u32 s37, s37, 196608
    v_mfma_f32_16x16x32_bf16 v[220:223], v[88:91], v[68:71], v[220:223]
    s_setprio 0
    ds_read_b128 v[68:71], v9 offset:6144
    ds_read_b64_tr_b16 v[80:81], v10 offset:29344
    v_fmac_f32 v150, v13, v22
    v_fmac_f32 v151, v13, v23
    v_fmac_f32 v152, v14, v20
    v_mfma_f32_16x16x32_bf16 v[216:219], v[88:91], v[64:67], v[216:219]
    s_setprio 1
    ds_read_b128 v[64:67], v9 offset:4096
    ds_read_b64_tr_b16 v[82:83], v10 offset:32928
    v_mfma_f32_16x16x32_bf16 v[216:219], v[84:87], v[48:51], v[216:219]
    s_setprio 0
    ds_read_b128 v[48:51], v8 offset:4096
    v_fmac_f32 v153, v14, v21
    v_fmac_f32 v154, v14, v22
    v_fmac_f32 v155, v14, v23
    v_mfma_f32_16x16x32_bf16 v[212:215], v[84:87], v[44:47], v[212:215]
    s_setprio 1
    ds_read_b128 v[44:47], v8 offset:2048
    v_mfma_f32_16x16x32_bf16 v[212:215], v[88:91], v[60:63], v[212:215]
    s_setprio 0
    ds_read_b128 v[60:63], v9 offset:2048
    v_fmac_f32 v156, v15, v20
    v_fmac_f32 v157, v15, v21
    v_mfma_f32_16x16x32_bf16 v[208:211], v[88:91], v[56:59], v[208:211]
    s_setprio 1
    ds_read_b128 v[56:59], v9 offset:0
    v_mfma_f32_16x16x32_bf16 v[208:211], v[84:87], v[40:43], v[208:211]
    s_setprio 0
    ds_read_b128 v[40:43], v8 offset:0
    ds_read_b64_tr_b16 v[84:85], v10 offset:36640
    v_fmac_f32 v158, v15, v22
    v_fmac_f32 v159, v15, v23
    v_lshlrev_b32 v29, 3, v29
    s_waitcnt lgkmcnt(9)
    v_mfma_f32_16x16x32_bf16 v[140:143], v[72:75], v[52:55], v[140:143]
    s_setprio 1
    ds_read_b64_tr_b16 v[86:87], v10 offset:40224
    v_mfma_f32_16x16x32_bf16 v[140:143], v[76:79], v[68:71], v[140:143]
    s_setprio 0
    ds_read_b64_tr_b16 v[88:89], v10 offset:29376
    v_lshl_add_u32 v30, v28, 6, v29
    v_add_u32 v38, 161792, v30
    v_mul_u32_u24 v37, 144, v28
    s_waitcnt lgkmcnt(7)
    v_mfma_f32_16x16x32_bf16 v[136:139], v[76:79], v[64:67], v[136:139]
    s_setprio 1
    ds_read_b64_tr_b16 v[90:91], v10 offset:32960
    v_mfma_f32_16x16x32_bf16 v[136:139], v[72:75], v[48:51], v[136:139]
    s_setprio 0
    s_lshl_b32 s5, s60, 5
    s_add_u32 s5, s5, 98304
    v_add3_u32 v37, v37, v29, s5
    v_and_b32 v30, 15, v1
    s_waitcnt lgkmcnt(6)
    v_mfma_f32_16x16x32_bf16 v[132:135], v[72:75], v[44:47], v[132:135]
    s_setprio 1
    v_mfma_f32_16x16x32_bf16 v[132:135], v[76:79], v[60:63], v[132:135]
    s_setprio 0
    v_mul_u32_u24 v30, 144, v30
    ds_read_b128 v[20:23], v34 offset:64
    v_fmac_f32 v176, v12, v16
    s_waitcnt lgkmcnt(5)
    v_mfma_f32_16x16x32_bf16 v[128:131], v[76:79], v[56:59], v[128:131]
    s_setprio 1
    v_mfma_f32_16x16x32_bf16 v[128:131], v[72:75], v[40:43], v[128:131]
    s_setprio 0
    ds_read_b64_tr_b16 v[72:73], v10 offset:36672
    v_fmac_f32 v177, v12, v17
    v_fmac_f32 v178, v12, v18
    v_fmac_f32 v179, v12, v19
    s_waitcnt lgkmcnt(4)
    v_mfma_f32_16x16x32_bf16 v[160:163], v[80:83], v[40:43], v[160:163]
    s_setprio 1
    ds_read_b64_tr_b16 v[74:75], v10 offset:40256
    v_mfma_f32_16x16x32_bf16 v[160:163], v[84:87], v[56:59], v[160:163]
    s_setprio 0
    v_fmac_f32 v180, v13, v16
    v_fmac_f32 v181, v13, v17
    s_waitcnt vmcnt(7) lgkmcnt(0)
    s_barrier
    v_mfma_f32_16x16x32_bf16 v[164:167], v[84:87], v[60:63], v[164:167]
    s_setprio 1
    ds_read_b64_tr_b16 v[76:77], v92 offset:47104
    s_add_u32 m0, s83, 0xffffe800
    v_mfma_f32_16x16x32_bf16 v[164:167], v[80:83], v[44:47], v[164:167]
    s_setprio 0
    ds_read_b64_tr_b16 v[78:79], v92 offset:48128
    buffer_load_dwordx4 v35, s[76:79], s37 offen  lds
    v_fmac_f32 v182, v13, v18
    v_fmac_f32 v183, v13, v19
    v_fmac_f32 v184, v14, v16
    v_mfma_f32_16x16x32_bf16 v[168:171], v[80:83], v[48:51], v[168:171]
    s_setprio 1
    s_add_u32 s37, s37, 196608
    v_mfma_f32_16x16x32_bf16 v[168:171], v[84:87], v[64:67], v[168:171]
    s_setprio 0
    v_fmac_f32 v185, v14, v17
    v_fmac_f32 v186, v14, v18
    v_fmac_f32 v187, v14, v19
    v_mfma_f32_16x16x32_bf16 v[172:175], v[84:87], v[68:71], v[172:175]
    s_setprio 1
    s_add_u32 m0, s28, 0
    v_mfma_f32_16x16x32_bf16 v[172:175], v[80:83], v[52:55], v[172:175]
    s_setprio 0
    ds_read_b64_tr_b16 v[80:81], v92 offset:53248
    buffer_load_dwordx4 v4, s[8:11], s64 offen offset:0 sc1 lds
    v_fmac_f32 v188, v15, v16
    v_fmac_f32 v189, v15, v17
    v_mfma_f32_16x16x32_bf16 v[204:207], v[88:91], v[52:55], v[204:207]
    s_setprio 1
    ds_read_b64_tr_b16 v[82:83], v92 offset:54272
    v_mfma_f32_16x16x32_bf16 v[204:207], v[72:75], v[68:71], v[204:207]
    s_setprio 0
    ds_read_b64_tr_b16 v[84:85], v32 offset:47104
    v_fmac_f32 v190, v15, v18
    v_fmac_f32 v191, v15, v19
    v_lshl_add_u32 v30, v31, 3, v30
    v_mfma_f32_16x16x32_bf16 v[200:203], v[72:75], v[64:67], v[200:203]
    s_setprio 1
    ds_read_b64_tr_b16 v[86:87], v32 offset:48128
    s_add_u32 m0, s28, 0
    v_mfma_f32_16x16x32_bf16 v[200:203], v[88:91], v[48:51], v[200:203]
    s_setprio 0
    buffer_load_dwordx4 v5, s[8:11], s64 offen offset:1024 sc1 lds
    s_mul_i32 s5, s59, 4608
    s_add_u32 s5, s5, 98304
    v_add_u32 v36, s5, v30
    v_and_b32 v30, 7, v28
    s_and_b32 s5, s59, 3
    s_xor_b32 s5, s5, s70
    s_lshl_b32 s5, s5, 1
    v_xor_b32 v30, s5, v30
    v_mfma_f32_16x16x32_bf16 v[196:199], v[88:91], v[44:47], v[196:199]
    s_setprio 1
    v_mfma_f32_16x16x32_bf16 v[196:199], v[72:75], v[60:63], v[196:199]
    s_setprio 0
    v_lshl_add_u32 v30, v30, 5, v29
    v_lshl_add_u32 v24, v28, 8, v30
    v_mfma_f32_16x16x32_bf16 v[192:195], v[72:75], v[56:59], v[192:195]
    s_setprio 1
    s_add_u32 m0, s28, 0
    v_mfma_f32_16x16x32_bf16 v[192:195], v[88:91], v[40:43], v[192:195]
    s_setprio 0
    ds_read_b64_tr_b16 v[88:89], v32 offset:53248
    buffer_load_dwordx4 v4, s[8:11], s66 offen offset:2048 sc1 lds
    v_xor_b32 v0, v2, v1
    ds_read_b128 v[16:19], v34 offset:128
    v_fmac_f32 v160, v12, v20
    s_waitcnt lgkmcnt(4)
    v_mfma_f32_16x16x32_bf16 v[96:99], v[76:79], v[40:43], v[96:99]
    s_setprio 1
    ds_read_b64_tr_b16 v[90:91], v32 offset:54272
    v_mfma_f32_16x16x32_bf16 v[96:99], v[80:83], v[56:59], v[96:99]
    s_setprio 0
    ds_read_b64_tr_b16 v[72:73], v92 offset:49152
    v_fmac_f32 v161, v12, v21
    v_fmac_f32 v162, v12, v22
    v_fmac_f32 v163, v12, v23
    v_mfma_f32_16x16x32_bf16 v[100:103], v[80:83], v[60:63], v[100:103]
    s_setprio 1
    ds_read_b64_tr_b16 v[74:75], v92 offset:50176
    s_add_u32 m0, s28, 0
    v_mfma_f32_16x16x32_bf16 v[100:103], v[76:79], v[44:47], v[100:103]
    s_setprio 0
    buffer_load_dwordx4 v5, s[8:11], s66 offen offset:3072 sc1 lds
    v_fmac_f32 v164, v13, v20
    v_fmac_f32 v165, v13, v21
    v_mfma_f32_16x16x32_bf16 v[104:107], v[76:79], v[48:51], v[104:107]
    s_setprio 1
    s_add_u32 s64, s64, 128
    s_bitset0_b32 s64, 11
    v_mfma_f32_16x16x32_bf16 v[104:107], v[80:83], v[64:67], v[104:107]
    s_setprio 0
    s_add_u32 s66, s64, 30720
    v_fmac_f32 v166, v13, v22
    v_fmac_f32 v167, v13, v23
    v_fmac_f32 v168, v14, v20
    v_mfma_f32_16x16x32_bf16 v[108:111], v[80:83], v[68:71], v[108:111]
    s_setprio 1
    s_add_u32 m0, s28, 65536
    v_mfma_f32_16x16x32_bf16 v[108:111], v[76:79], v[52:55], v[108:111]
    s_setprio 0
    ds_read_b64_tr_b16 v[76:77], v92 offset:55296
    buffer_load_dwordx4 v4, s[8:11], s64 offen offset:0 sc1 lds
    v_fmac_f32 v169, v14, v21
    v_fmac_f32 v170, v14, v22
    v_fmac_f32 v171, v14, v23
    s_waitcnt lgkmcnt(3)
    v_mfma_f32_16x16x32_bf16 v[124:127], v[84:87], v[52:55], v[124:127]
    s_setprio 1
    ds_read_b64_tr_b16 v[78:79], v92 offset:56320
    v_mfma_f32_16x16x32_bf16 v[124:127], v[88:91], v[68:71], v[124:127]
    s_setprio 0
    ds_read_b64_tr_b16 v[80:81], v32 offset:49152
    v_fmac_f32 v172, v15, v20
    v_fmac_f32 v173, v15, v21
    v_mfma_f32_16x16x32_bf16 v[120:123], v[88:91], v[64:67], v[120:123]
    s_setprio 1
    ds_read_b64_tr_b16 v[82:83], v32 offset:50176
    s_add_u32 m0, s28, 65536
    v_mfma_f32_16x16x32_bf16 v[120:123], v[84:87], v[48:51], v[120:123]
    s_setprio 0
    buffer_load_dwordx4 v5, s[8:11], s64 offen offset:1024 sc1 lds
    v_fmac_f32 v174, v15, v22
    v_fmac_f32 v175, v15, v23
    v_and_b32 v0, 48, v0
    v_mfma_f32_16x16x32_bf16 v[116:119], v[84:87], v[44:47], v[116:119]
    s_setprio 1
    v_mfma_f32_16x16x32_bf16 v[116:119], v[88:91], v[60:63], v[116:119]
    s_setprio 0
    v_lshl_add_u32 v0, v28, 11, v0
    v_and_b32 v28, 7, v1
    v_and_b32 v29, 8, v1
    v_mfma_f32_16x16x32_bf16 v[112:115], v[88:91], v[56:59], v[112:115]
    s_setprio 1
    s_add_u32 m0, s28, 65536
    v_mfma_f32_16x16x32_bf16 v[112:115], v[84:87], v[40:43], v[112:115]
    s_setprio 0
    ds_read_b64_tr_b16 v[84:85], v32 offset:55296
    buffer_load_dwordx4 v4, s[8:11], s66 offen offset:2048 sc1 lds
    v_lshlrev_b32 v29, 1, v29
    v_lshl_add_u32 v28, v28, 7, v29
    s_waitcnt lgkmcnt(3)
    v_mfma_f32_16x16x32_bf16 v[224:227], v[40:43], v[72:75], v[224:227]
    s_setprio 1
    ds_read_b64_tr_b16 v[86:87], v32 offset:56320
    v_mfma_f32_16x16x32_bf16 v[224:227], v[56:59], v[76:79], v[224:227]
    s_setprio 0
    ds_read_b64_tr_b16 v[88:89], v10 offset:43904
    s_lshr_b32 s5, s59, 1
    s_lshl_b32 s5, s5, 2
    v_add_u32 v39, s5, v28
    ds_read_b128 v[20:23], v34 offset:384
    v_fmac_f32 v192, v12, v16
    v_mfma_f32_16x16x32_bf16 v[228:231], v[60:63], v[76:79], v[228:231]
    s_setprio 1
    ds_read_b64_tr_b16 v[90:91], v10 offset:47488
    s_add_u32 m0, s28, 65536
    v_mfma_f32_16x16x32_bf16 v[228:231], v[44:47], v[72:75], v[228:231]
    s_setprio 0
    buffer_load_dwordx4 v5, s[8:11], s66 offen offset:3072 sc1 lds
    v_fmac_f32 v193, v12, v17
    v_fmac_f32 v194, v12, v18
    v_fmac_f32 v195, v12, v19
    v_mfma_f32_16x16x32_bf16 v[232:235], v[48:51], v[72:75], v[232:235]
    s_setprio 1
    s_add_u32 s64, s64, 128
    s_bitset0_b32 s64, 11
    v_mfma_f32_16x16x32_bf16 v[232:235], v[64:67], v[76:79], v[232:235]
    s_setprio 0
    s_add_u32 s66, s64, 30720
    v_fmac_f32 v196, v13, v16
    v_fmac_f32 v197, v13, v17
    v_mfma_f32_16x16x32_bf16 v[236:239], v[68:71], v[76:79], v[236:239]
    s_setprio 1
    v_mfma_f32_16x16x32_bf16 v[236:239], v[52:55], v[72:75], v[236:239]
    s_setprio 0
    ds_read_b64_tr_b16 v[72:73], v10 offset:51200
    v_fmac_f32 v198, v13, v18
    v_fmac_f32 v199, v13, v19
    v_fmac_f32 v200, v14, v16
    s_waitcnt lgkmcnt(4)
    v_mfma_f32_16x16x32_bf16 v[252:255], v[52:55], v[80:83], v[252:255]
    s_setprio 1
    ds_read_b64_tr_b16 v[74:75], v10 offset:54784
    v_mfma_f32_16x16x32_bf16 v[252:255], v[68:71], v[84:87], v[252:255]
    s_setprio 0
    ds_read_b64_tr_b16 v[76:77], v10 offset:43936
    v_fmac_f32 v201, v14, v17
    v_fmac_f32 v202, v14, v18
    v_fmac_f32 v203, v14, v19
    v_mfma_f32_16x16x32_bf16 v[248:251], v[64:67], v[84:87], v[248:251]
    s_setprio 1
    ds_read_b64_tr_b16 v[78:79], v10 offset:47520
    v_mfma_f32_16x16x32_bf16 v[248:251], v[48:51], v[80:83], v[248:251]
    s_setprio 0
    s_add_u32 s20, s56, 0x400000
    s_addc_u32 s21, s57, 0
    s_and_b32 s21, s21, 0xffff
    s_mov_b32 s22, 0x1200000
    s_mov_b32 s23, 0x20000
    v_fmac_f32 v204, v15, v16
    v_fmac_f32 v205, v15, v17
    v_mfma_f32_16x16x32_bf16 v[244:247], v[44:47], v[80:83], v[244:247]
    s_setprio 1
    v_mfma_f32_16x16x32_bf16 v[244:247], v[60:63], v[84:87], v[244:247]
    s_setprio 0
    s_mov_b32 s12, s52
    s_mov_b32 s13, s53
    s_and_b32 s13, s13, 0xffff
    s_mov_b32 s14, 0x700000
    s_mov_b32 s15, 0x20000
    v_fmac_f32 v206, v15, v18
    v_fmac_f32 v207, v15, v19
    s_lshl_b32 s5, s61, 10
    s_add_u32 s5, s5, 135168
    v_add_u32 v11, s5, v2
    v_mfma_f32_16x16x32_bf16 v[240:243], v[56:59], v[84:87], v[240:243]
    s_setprio 1
    v_mfma_f32_16x16x32_bf16 v[240:243], v[40:43], v[80:83], v[240:243]
    s_setprio 0
    s_add_u32 s3, s88, 8192
    s_sub_u32 s6, s88, 23552
    s_bitcmp1_b32 s63, 0
    s_cselect_b32 s3, s6, s3
    ds_read_b64_tr_b16 v[80:81], v10 offset:51232
    v_xor_b32 v25, 32, v24
    v_xor_b32 v26, 64, v24
    v_xor_b32 v27, 96, v24
    s_waitcnt lgkmcnt(3)
    v_mfma_f32_16x16x32_bf16 v[144:147], v[88:91], v[40:43], v[144:147]
    s_setprio 1
    ds_read_b64_tr_b16 v[82:83], v10 offset:54816
    v_mfma_f32_16x16x32_bf16 v[144:147], v[72:75], v[56:59], v[144:147]
    s_setprio 0
    ds_read_b64_tr_b16 v[84:85], v10 offset:43968
    v_xor_b32 v28, 128, v24
    v_xor_b32 v29, 160, v24
    v_mfma_f32_16x16x32_bf16 v[148:151], v[72:75], v[60:63], v[148:151]
    s_setprio 1
    ds_read_b64_tr_b16 v[86:87], v10 offset:47552
    v_mfma_f32_16x16x32_bf16 v[148:151], v[88:91], v[44:47], v[148:151]
    s_setprio 0
    v_xor_b32 v30, 192, v24
    v_xor_b32 v31, 224, v24
    v_fmac_f32 v208, v12, v20
    v_mfma_f32_16x16x32_bf16 v[152:155], v[88:91], v[48:51], v[152:155]
    s_setprio 1
    v_mfma_f32_16x16x32_bf16 v[152:155], v[72:75], v[64:67], v[152:155]
    s_setprio 0
    v_fmac_f32 v209, v12, v21
    v_fmac_f32 v210, v12, v22
    v_fmac_f32 v211, v12, v23
    v_mfma_f32_16x16x32_bf16 v[156:159], v[72:75], v[68:71], v[156:159]
    s_setprio 1
    v_mfma_f32_16x16x32_bf16 v[156:159], v[88:91], v[52:55], v[156:159]
    s_setprio 0
    ds_read_b64_tr_b16 v[88:89], v10 offset:51264
    v_fmac_f32 v212, v13, v20
    v_fmac_f32 v213, v13, v21
    s_waitcnt lgkmcnt(3)
    v_mfma_f32_16x16x32_bf16 v[188:191], v[76:79], v[52:55], v[188:191]
    s_setprio 1
    ds_read_b64_tr_b16 v[90:91], v10 offset:54848
    v_mfma_f32_16x16x32_bf16 v[188:191], v[80:83], v[68:71], v[188:191]
    s_setprio 0
    v_fmac_f32 v214, v13, v22
    v_fmac_f32 v215, v13, v23
    v_fmac_f32 v216, v14, v20
    s_waitcnt vmcnt(9) lgkmcnt(0)
    s_barrier
    v_mfma_f32_16x16x32_bf16 v[184:187], v[80:83], v[64:67], v[184:187]
    s_setprio 1
    ds_read_b64_tr_b16 v[72:73], v92 offset:34816
    s_add_u32 m0, s83, 0x4800
    v_mfma_f32_16x16x32_bf16 v[184:187], v[76:79], v[48:51], v[184:187]
    s_setprio 0
    ds_read_b64_tr_b16 v[74:75], v92 offset:35840
    buffer_load_dwordx4 v35, s[76:79], s37 offen  lds
    v_fmac_f32 v217, v14, v21
    v_fmac_f32 v218, v14, v22
    v_fmac_f32 v219, v14, v23
    v_mfma_f32_16x16x32_bf16 v[180:183], v[76:79], v[44:47], v[180:183]
    s_setprio 1
    s_add_u32 s37, s37, 196608
    v_mfma_f32_16x16x32_bf16 v[180:183], v[80:83], v[60:63], v[180:183]
    s_setprio 0
    v_fmac_f32 v220, v15, v20
    v_fmac_f32 v221, v15, v21
    v_mfma_f32_16x16x32_bf16 v[176:179], v[80:83], v[56:59], v[176:179]
    s_setprio 1
    s_add_u32 m0, s29, 0
    v_mfma_f32_16x16x32_bf16 v[176:179], v[76:79], v[40:43], v[176:179]
    s_setprio 0
    ds_read_b64_tr_b16 v[76:77], v32 offset:34816
    buffer_load_dwordx4 v35, s[76:79], s80 offen  lds
    v_fmac_f32 v222, v15, v22
    v_fmac_f32 v223, v15, v23
    v_and_b32 v14, 0xf0, v2
    v_mfma_f32_16x16x32_bf16 v[208:211], v[84:87], v[40:43], v[208:211]
    s_setprio 1
    ds_read_b128 v[40:43], v8 offset:32768
    ds_read_b64_tr_b16 v[78:79], v32 offset:35840
    v_mfma_f32_16x16x32_bf16 v[208:211], v[88:91], v[56:59], v[208:211]
    s_setprio 0
    ds_read_b64_tr_b16 v[80:81], v92 offset:36864
    v_bfe_u32 v15, v1, 4, 1
    v_lshl_add_u32 v14, v15, 3, v14
    v_lshrrev_b32 v15, 5, v1
    v_mfma_f32_16x16x32_bf16 v[212:215], v[88:91], v[60:63], v[212:215]
    s_setprio 1
    ds_read_b64_tr_b16 v[82:83], v92 offset:37888
    s_add_u32 m0, s29, 1024
    v_mfma_f32_16x16x32_bf16 v[212:215], v[84:87], v[44:47], v[212:215]
    s_setprio 0
    ds_read_b128 v[44:47], v8 offset:34816
    buffer_load_dwordx4 v35, s[76:79], s81 offen  lds
    v_lshl_add_u32 v14, v15, 8, v14
    s_lshl_b32 s5, s60, 11
    s_add_u32 s5, s5, 81920
    v_add_u32 v13, s5, v2
    v_mfma_f32_16x16x32_bf16 v[216:219], v[84:87], v[48:51], v[216:219]
    s_setprio 1
    ds_read_b128 v[48:51], v8 offset:36864
    v_mfma_f32_16x16x32_bf16 v[216:219], v[88:91], v[64:67], v[216:219]
    s_setprio 0
    v_mov_b32 v20, s87
    v_mov_b32 v21, s87
    v_mov_b32 v22, s87
    v_mfma_f32_16x16x32_bf16 v[220:223], v[88:91], v[68:71], v[220:223]
    s_setprio 1
    s_add_u32 m0, s29, 2048
    v_mfma_f32_16x16x32_bf16 v[220:223], v[84:87], v[52:55], v[220:223]
    s_setprio 0
    ds_read_b128 v[52:55], v8 offset:38912
    ds_read_b64_tr_b16 v[84:85], v32 offset:36864
    buffer_load_dwordx4 v35, s[76:79], s82 offen  lds
    v_mov_b32 v23, s87
    s_waitcnt lgkmcnt(7)
    v_mfma_f32_16x16x32_bf16 v[96:99], v[72:75], v[40:43], v[96:99]
    ds_read_b64_tr_b16 v[86:87], v32 offset:37888
    ds_read_b128 v[56:59], v9 offset:32768
    ds_read_b128 v[60:63], v9 offset:34816
    v_pk_mul_f32 v[16:17], v[128:129], v[128:129]
    v_pk_mul_f32 v[18:19], v[130:131], v[130:131]
    v_pk_mul_f32 v[144:145], v[128:129], v[144:145]
    v_pk_mul_f32 v[146:147], v[130:131], v[146:147]
    v_pk_fma_f32 v[16:17], v[16:17], s[86:87], v[94:95] op_sel_hi:[1,0,1]
    v_pk_fma_f32 v[18:19], v[18:19], s[86:87], v[94:95] op_sel_hi:[1,0,1]
    v_pk_mul_f32 v[16:17], v[16:17], v[128:129]
    v_pk_mul_f32 v[18:19], v[18:19], v[130:131]
    s_waitcnt lgkmcnt(6)
    v_mfma_f32_16x16x32_bf16 v[100:103], v[72:75], v[44:47], v[100:103]
    ds_read_b64_tr_b16 v[88:89], v92 offset:40960
    ds_read_b64_tr_b16 v[90:91], v92 offset:41984
    ds_read_b128 v[64:67], v9 offset:36864
    ds_read_b128 v[68:71], v9 offset:38912
    v_exp_f32 v16, v16
    s_waitcnt lgkmcnt(9)
    v_mfma_f32_16x16x32_bf16 v[104:107], v[72:75], v[48:51], v[104:107]
    v_exp_f32 v17, v17
    s_waitcnt lgkmcnt(8)
    v_mfma_f32_16x16x32_bf16 v[108:111], v[72:75], v[52:55], v[108:111]
    ds_read_b64_tr_b16 v[72:73], v32 offset:40960
    ds_read_b64_tr_b16 v[74:75], v32 offset:41984
    v_exp_f32 v18, v18
    s_waitcnt vmcnt(8) lgkmcnt(0)
    s_barrier
    s_add_u32 m0, s28, 32768
    v_mfma_f32_16x16x32_bf16 v[124:127], v[76:79], v[52:55], v[124:127]
    buffer_load_dwordx4 v4, s[8:11], s64 offen offset:0 sc1 lds
    v_exp_f32 v19, v19
    v_mfma_f32_16x16x32_bf16 v[120:123], v[76:79], v[48:51], v[120:123]
    v_add_f32 v16, 1.0, v16
    v_add_f32 v17, 1.0, v17
    v_add_f32 v18, 1.0, v18
    v_add_f32 v19, 1.0, v19
    s_add_u32 m0, s28, 32768
    v_mfma_f32_16x16x32_bf16 v[116:119], v[76:79], v[44:47], v[116:119]
    buffer_load_dwordx4 v5, s[8:11], s64 offen offset:1024 sc1 lds
    v_rcp_f32 v16, v16
    v_mfma_f32_16x16x32_bf16 v[112:115], v[76:79], v[40:43], v[112:115]
    ds_read_b64_tr_b16 v[76:77], v92 offset:43008
    ds_read_b64_tr_b16 v[78:79], v92 offset:44032
    v_rcp_f32 v17, v17
    s_add_u32 m0, s28, 32768
    v_mfma_f32_16x16x32_bf16 v[224:227], v[40:43], v[80:83], v[224:227]
    buffer_load_dwordx4 v4, s[8:11], s66 offen offset:2048 sc1 lds
    v_rcp_f32 v18, v18
    v_mfma_f32_16x16x32_bf16 v[228:231], v[44:47], v[80:83], v[228:231]
    v_rcp_f32 v19, v19
    s_add_u32 m0, s28, 32768
    v_mfma_f32_16x16x32_bf16 v[232:235], v[48:51], v[80:83], v[232:235]
    buffer_load_dwordx4 v5, s[8:11], s66 offen offset:3072 sc1 lds
    s_add_u32 s64, s64, 128
    s_bitset0_b32 s64, 11
    s_add_u32 s66, s64, 30720
    v_mul_f32 v144, v144, v16
    v_mul_f32 v145, v145, v17
    v_mul_f32 v146, v146, v18
    v_mul_f32 v147, v147, v19
    v_cvt_pk_bf16_f32 v128, v144, v145
    v_cvt_pk_bf16_f32 v129, v146, v147
    v_pk_mul_f32 v[16:17], v[160:161], v[160:161]
    v_pk_mul_f32 v[18:19], v[162:163], v[162:163]
    v_pk_mul_f32 v[176:177], v[160:161], v[176:177]
    v_pk_mul_f32 v[178:179], v[162:163], v[178:179]
    v_pk_fma_f32 v[16:17], v[16:17], s[86:87], v[94:95] op_sel_hi:[1,0,1]
    v_pk_fma_f32 v[18:19], v[18:19], s[86:87], v[94:95] op_sel_hi:[1,0,1]
    v_pk_mul_f32 v[16:17], v[16:17], v[160:161]
    v_pk_mul_f32 v[18:19], v[18:19], v[162:163]
    v_mfma_f32_16x16x32_bf16 v[236:239], v[52:55], v[80:83], v[236:239]
    ds_read_b64_tr_b16 v[80:81], v32 offset:43008
    ds_read_b64_tr_b16 v[82:83], v32 offset:44032
    v_exp_f32 v16, v16
    v_mfma_f32_16x16x32_bf16 v[252:255], v[52:55], v[84:87], v[252:255]
    v_exp_f32 v17, v17
    v_mfma_f32_16x16x32_bf16 v[248:251], v[48:51], v[84:87], v[248:251]
    v_exp_f32 v18, v18
    v_mfma_f32_16x16x32_bf16 v[244:247], v[44:47], v[84:87], v[244:247]
    v_exp_f32 v19, v19
    v_mfma_f32_16x16x32_bf16 v[240:243], v[40:43], v[84:87], v[240:243]
    ds_read_b64_tr_b16 v[84:85], v92 offset:28672
    ds_read_b64_tr_b16 v[86:87], v92 offset:29696
    v_add_f32 v16, 1.0, v16
    v_add_f32 v17, 1.0, v17
    v_add_f32 v18, 1.0, v18
    v_add_f32 v19, 1.0, v19
    v_mfma_f32_16x16x32_bf16 v[96:99], v[88:91], v[56:59], v[96:99]
    ds_read_b128 v[40:43], v8 offset:0
    v_rcp_f32 v16, v16
    v_mfma_f32_16x16x32_bf16 v[100:103], v[88:91], v[60:63], v[100:103]
    ds_read_b128 v[44:47], v8 offset:2048
    v_rcp_f32 v17, v17
    v_mfma_f32_16x16x32_bf16 v[104:107], v[88:91], v[64:67], v[104:107]
    ds_read_b128 v[48:51], v8 offset:4096
    v_rcp_f32 v18, v18
    v_mfma_f32_16x16x32_bf16 v[108:111], v[88:91], v[68:71], v[108:111]
    ds_read_b64_tr_b16 v[88:89], v32 offset:28672
    ds_read_b64_tr_b16 v[90:91], v32 offset:29696
    ds_read_b128 v[52:55], v8 offset:6144
    v_rcp_f32 v19, v19
    v_mfma_f32_16x16x32_bf16 v[124:127], v[72:75], v[68:71], v[124:127]
    v_mul_f32 v176, v176, v16
    v_mul_f32 v177, v177, v17
    v_mfma_f32_16x16x32_bf16 v[120:123], v[72:75], v[64:67], v[120:123]
    v_mul_f32 v178, v178, v18
    v_mul_f32 v179, v179, v19
    v_cvt_pk_bf16_f32 v130, v176, v177
    v_cvt_pk_bf16_f32 v131, v178, v179
    buffer_store_dwordx4 v[128:131], v2, s[20:23], s88 offen offset:0 sc1
    v_pk_mul_f32 v[16:17], v[192:193], v[192:193]
    v_pk_mul_f32 v[18:19], v[194:195], v[194:195]
    v_pk_mul_f32 v[208:209], v[192:193], v[208:209]
    v_pk_mul_f32 v[210:211], v[194:195], v[210:211]
    v_pk_fma_f32 v[16:17], v[16:17], s[86:87], v[94:95] op_sel_hi:[1,0,1]
    v_pk_fma_f32 v[18:19], v[18:19], s[86:87], v[94:95] op_sel_hi:[1,0,1]
    v_pk_mul_f32 v[16:17], v[16:17], v[192:193]
    v_pk_mul_f32 v[18:19], v[18:19], v[194:195]
    v_mfma_f32_16x16x32_bf16 v[116:119], v[72:75], v[60:63], v[116:119]
    v_exp_f32 v16, v16
    v_mfma_f32_16x16x32_bf16 v[112:115], v[72:75], v[56:59], v[112:115]
    ds_read_b64_tr_b16 v[72:73], v92 offset:30720
    ds_read_b64_tr_b16 v[74:75], v92 offset:31744
    v_exp_f32 v17, v17
    s_waitcnt lgkmcnt(12)
    v_mfma_f32_16x16x32_bf16 v[224:227], v[56:59], v[76:79], v[224:227]
    v_exp_f32 v18, v18
    v_mfma_f32_16x16x32_bf16 v[228:231], v[60:63], v[76:79], v[228:231]
    v_exp_f32 v19, v19
    v_mfma_f32_16x16x32_bf16 v[232:235], v[64:67], v[76:79], v[232:235]
    v_add_f32 v16, 1.0, v16
    v_add_f32 v17, 1.0, v17
    v_add_f32 v18, 1.0, v18
    v_add_f32 v19, 1.0, v19
    v_mfma_f32_16x16x32_bf16 v[236:239], v[68:71], v[76:79], v[236:239]
    ds_read_b64_tr_b16 v[76:77], v32 offset:30720
    ds_read_b64_tr_b16 v[78:79], v32 offset:31744
    v_rcp_f32 v16, v16
    s_waitcnt lgkmcnt(12)
    v_mfma_f32_16x16x32_bf16 v[252:255], v[68:71], v[80:83], v[252:255]
    v_rcp_f32 v17, v17
    v_mfma_f32_16x16x32_bf16 v[248:251], v[64:67], v[80:83], v[248:251]
    v_rcp_f32 v18, v18
    v_mfma_f32_16x16x32_bf16 v[244:247], v[60:63], v[80:83], v[244:247]
    v_rcp_f32 v19, v19
    v_mfma_f32_16x16x32_bf16 v[240:243], v[56:59], v[80:83], v[240:243]
    v_mul_f32 v208, v208, v16
    v_mul_f32 v209, v209, v17
    s_waitcnt lgkmcnt(9)
    v_mfma_f32_16x16x32_bf16 v[96:99], v[84:87], v[40:43], v[96:99]
    ds_read_b128 v[56:59], v9 offset:0
    ds_read_b128 v[60:63], v9 offset:2048
    v_mul_f32 v210, v210, v18
    v_mul_f32 v211, v211, v19
    v_cvt_pk_bf16_f32 v192, v208, v209
    v_cvt_pk_bf16_f32 v193, v210, v211
    v_pk_mul_f32 v[16:17], v[196:197], v[196:197]
    v_pk_mul_f32 v[18:19], v[198:199], v[198:199]
    v_pk_mul_f32 v[212:213], v[196:197], v[212:213]
    v_pk_mul_f32 v[214:215], v[198:199], v[214:215]
    v_pk_fma_f32 v[16:17], v[16:17], s[86:87], v[94:95] op_sel_hi:[1,0,1]
    v_pk_fma_f32 v[18:19], v[18:19], s[86:87], v[94:95] op_sel_hi:[1,0,1]
    v_pk_mul_f32 v[16:17], v[16:17], v[196:197]
    v_pk_mul_f32 v[18:19], v[18:19], v[198:199]
    s_waitcnt lgkmcnt(10)
    v_mfma_f32_16x16x32_bf16 v[100:103], v[84:87], v[44:47], v[100:103]
    ds_read_b128 v[64:67], v9 offset:4096
    ds_read_b128 v[68:71], v9 offset:6144
    v_exp_f32 v16, v16
    s_waitcnt lgkmcnt(11)
    v_mfma_f32_16x16x32_bf16 v[104:107], v[84:87], v[48:51], v[104:107]
    v_exp_f32 v17, v17
    s_waitcnt lgkmcnt(8)
    v_mfma_f32_16x16x32_bf16 v[108:111], v[84:87], v[52:55], v[108:111]
    v_exp_f32 v18, v18
    s_waitcnt vmcnt(5) lgkmcnt(0)
    s_barrier
    s_add_u32 m0, s95, 0
    v_mfma_f32_16x16x32_bf16 v[124:127], v[88:91], v[52:55], v[124:127]
    ds_read_b64_tr_b16 v[80:81], v92 offset:53248
    ds_read_b64_tr_b16 v[82:83], v92 offset:54272
    buffer_load_dwordx4 v6, s[12:15], s74 offen  lds
    v_exp_f32 v19, v19
    v_mfma_f32_16x16x32_bf16 v[120:123], v[88:91], v[48:51], v[120:123]
    ds_read_b64_tr_b16 v[84:85], v32 offset:53248
    ds_read_b64_tr_b16 v[86:87], v32 offset:54272
    v_add_f32 v16, 1.0, v16
    v_add_f32 v17, 1.0, v17
    v_add_f32 v18, 1.0, v18
    v_add_f32 v19, 1.0, v19
    s_add_u32 m0, s95, 0
    v_mfma_f32_16x16x32_bf16 v[116:119], v[88:91], v[44:47], v[116:119]
    buffer_load_dwordx4 v7, s[12:15], s74 offen offset:1024  lds
    s_add_u32 s74, s74, 0x20000
    v_rcp_f32 v16, v16
    v_mfma_f32_16x16x32_bf16 v[112:115], v[88:91], v[40:43], v[112:115]
    ds_read_b64_tr_b16 v[88:89], v92 offset:55296
    ds_read_b64_tr_b16 v[90:91], v92 offset:56320
    v_rcp_f32 v17, v17
    v_mfma_f32_16x16x32_bf16 v[224:227], v[40:43], v[72:75], v[224:227]
    v_rcp_f32 v18, v18
    v_mfma_f32_16x16x32_bf16 v[228:231], v[44:47], v[72:75], v[228:231]
    v_rcp_f32 v19, v19
    v_mfma_f32_16x16x32_bf16 v[232:235], v[48:51], v[72:75], v[232:235]
    v_mul_f32 v212, v212, v16
    v_mul_f32 v213, v213, v17
    v_mul_f32 v214, v214, v18
    v_mul_f32 v215, v215, v19
    v_cvt_pk_bf16_f32 v194, v212, v213
    v_cvt_pk_bf16_f32 v195, v214, v215
    buffer_store_dwordx4 v[192:195], v2, s[20:23], s3 offen offset:0 sc1
    v_pk_mul_f32 v[16:17], v[132:133], v[132:133]
    v_pk_mul_f32 v[18:19], v[134:135], v[134:135]
    v_pk_mul_f32 v[148:149], v[132:133], v[148:149]
    v_pk_mul_f32 v[150:151], v[134:135], v[150:151]
    v_pk_fma_f32 v[16:17], v[16:17], s[86:87], v[94:95] op_sel_hi:[1,0,1]
    v_pk_fma_f32 v[18:19], v[18:19], s[86:87], v[94:95] op_sel_hi:[1,0,1]
    v_pk_mul_f32 v[16:17], v[16:17], v[132:133]
    v_pk_mul_f32 v[18:19], v[18:19], v[134:135]
    v_mfma_f32_16x16x32_bf16 v[236:239], v[52:55], v[72:75], v[236:239]
    ds_read_b64_tr_b16 v[72:73], v32 offset:55296
    ds_read_b64_tr_b16 v[74:75], v32 offset:56320
    v_exp_f32 v16, v16
    v_mfma_f32_16x16x32_bf16 v[252:255], v[52:55], v[76:79], v[252:255]
    v_exp_f32 v17, v17
    v_mfma_f32_16x16x32_bf16 v[248:251], v[48:51], v[76:79], v[248:251]
    v_exp_f32 v18, v18
    v_mfma_f32_16x16x32_bf16 v[244:247], v[44:47], v[76:79], v[244:247]
    v_exp_f32 v19, v19
    v_mfma_f32_16x16x32_bf16 v[240:243], v[40:43], v[76:79], v[240:243]
    ds_read_b64_tr_b16 v[76:77], v92 offset:2048
    ds_read_b64_tr_b16 v[78:79], v92 offset:3072
    v_add_u32 v8, 32768, v8
    v_add_u32 v9, 32768, v9
    v_add_f32 v16, 1.0, v16
    v_add_f32 v17, 1.0, v17
    v_add_f32 v18, 1.0, v18
    v_add_f32 v19, 1.0, v19
    s_add_u32 m0, s95, 16384
    s_waitcnt lgkmcnt(8)
    v_mfma_f32_16x16x32_bf16 v[96:99], v[80:83], v[56:59], v[96:99]
    ds_read_b128 v[40:43], v8 offset:32768
    buffer_load_dwordx4 v6, s[12:15], s74 offen  lds
    v_rcp_f32 v16, v16
    v_mfma_f32_16x16x32_bf16 v[100:103], v[80:83], v[60:63], v[100:103]
    ds_read_b128 v[44:47], v8 offset:34816
    v_rcp_f32 v17, v17
    s_add_u32 m0, s95, 16384
    v_mfma_f32_16x16x32_bf16 v[104:107], v[80:83], v[64:67], v[104:107]
    ds_read_b128 v[48:51], v8 offset:36864
    buffer_load_dwordx4 v7, s[12:15], s74 offen offset:1024  lds
    s_add_u32 s74, s74, 0x20000
    v_rcp_f32 v18, v18
    v_mfma_f32_16x16x32_bf16 v[108:111], v[80:83], v[68:71], v[108:111]
    ds_read_b64_tr_b16 v[80:81], v32 offset:2048
    ds_read_b64_tr_b16 v[82:83], v32 offset:3072
    ds_read_b128 v[52:55], v8 offset:38912
    v_rcp_f32 v19, v19
    s_waitcnt lgkmcnt(12)
    v_mfma_f32_16x16x32_bf16 v[124:127], v[84:87], v[68:71], v[124:127]
    v_mul_f32 v148, v148, v16
    v_mul_f32 v149, v149, v17
    v_mfma_f32_16x16x32_bf16 v[120:123], v[84:87], v[64:67], v[120:123]
    v_mul_f32 v150, v150, v18
    v_mul_f32 v151, v151, v19
    v_cvt_pk_bf16_f32 v132, v148, v149
    v_cvt_pk_bf16_f32 v133, v150, v151
    v_pk_mul_f32 v[16:17], v[164:165], v[164:165]
    v_pk_mul_f32 v[18:19], v[166:167], v[166:167]
    v_pk_mul_f32 v[180:181], v[164:165], v[180:181]
    v_pk_mul_f32 v[182:183], v[166:167], v[182:183]
    v_pk_fma_f32 v[16:17], v[16:17], s[86:87], v[94:95] op_sel_hi:[1,0,1]
    v_pk_fma_f32 v[18:19], v[18:19], s[86:87], v[94:95] op_sel_hi:[1,0,1]
    v_pk_mul_f32 v[16:17], v[16:17], v[164:165]
    v_pk_mul_f32 v[18:19], v[18:19], v[166:167]
    v_mfma_f32_16x16x32_bf16 v[116:119], v[84:87], v[60:63], v[116:119]
    v_exp_f32 v16, v16
    v_mfma_f32_16x16x32_bf16 v[112:115], v[84:87], v[56:59], v[112:115]
    ds_read_b64_tr_b16 v[84:85], v92 offset:4096
    ds_read_b64_tr_b16 v[86:87], v92 offset:5120
    v_exp_f32 v17, v17
    s_waitcnt lgkmcnt(12)
    v_mfma_f32_16x16x32_bf16 v[224:227], v[56:59], v[88:91], v[224:227]
    v_exp_f32 v18, v18
    v_mfma_f32_16x16x32_bf16 v[228:231], v[60:63], v[88:91], v[228:231]
    v_exp_f32 v19, v19
    v_mfma_f32_16x16x32_bf16 v[232:235], v[64:67], v[88:91], v[232:235]
    v_add_f32 v16, 1.0, v16
    v_add_f32 v17, 1.0, v17
    v_add_f32 v18, 1.0, v18
    v_add_f32 v19, 1.0, v19
    v_mfma_f32_16x16x32_bf16 v[236:239], v[68:71], v[88:91], v[236:239]
    ds_read_b64_tr_b16 v[88:89], v32 offset:4096
    ds_read_b64_tr_b16 v[90:91], v32 offset:5120
    v_rcp_f32 v16, v16
    s_waitcnt lgkmcnt(12)
    v_mfma_f32_16x16x32_bf16 v[252:255], v[68:71], v[72:75], v[252:255]
    v_rcp_f32 v17, v17
    v_mfma_f32_16x16x32_bf16 v[248:251], v[64:67], v[72:75], v[248:251]
    v_rcp_f32 v18, v18
    v_mfma_f32_16x16x32_bf16 v[244:247], v[60:63], v[72:75], v[244:247]
    v_rcp_f32 v19, v19
    v_mfma_f32_16x16x32_bf16 v[240:243], v[56:59], v[72:75], v[240:243]
    ds_read_b64_tr_b16 v[72:73], v92 offset:8192
    ds_read_b64_tr_b16 v[74:75], v92 offset:9216
    v_mul_f32 v180, v180, v16
    v_mul_f32 v181, v181, v17
    s_waitcnt lgkmcnt(11)
    v_mfma_f32_16x16x32_bf16 v[96:99], v[76:79], v[40:43], v[96:99]
    ds_read_b128 v[56:59], v9 offset:32768
    ds_read_b128 v[60:63], v9 offset:34816
    v_mul_f32 v182, v182, v18
    v_mul_f32 v183, v183, v19
    v_cvt_pk_bf16_f32 v134, v180, v181
    v_cvt_pk_bf16_f32 v135, v182, v183
    buffer_store_dwordx4 v[132:135], v2, s[20:23], s88 offen offset:1024 sc1
    v_pk_mul_f32 v[16:17], v[136:137], v[136:137]
    v_pk_mul_f32 v[18:19], v[138:139], v[138:139]
    v_pk_mul_f32 v[152:153], v[136:137], v[152:153]
    v_pk_mul_f32 v[154:155], v[138:139], v[154:155]
    v_pk_fma_f32 v[16:17], v[16:17], s[86:87], v[94:95] op_sel_hi:[1,0,1]
    v_pk_fma_f32 v[18:19], v[18:19], s[86:87], v[94:95] op_sel_hi:[1,0,1]
    v_pk_mul_f32 v[16:17], v[16:17], v[136:137]
    v_pk_mul_f32 v[18:19], v[18:19], v[138:139]
    s_waitcnt lgkmcnt(12)
    v_mfma_f32_16x16x32_bf16 v[100:103], v[76:79], v[44:47], v[100:103]
    ds_read_b128 v[64:67], v9 offset:36864
    ds_read_b128 v[68:71], v9 offset:38912
    v_exp_f32 v16, v16
    s_waitcnt lgkmcnt(13)
    v_mfma_f32_16x16x32_bf16 v[104:107], v[76:79], v[48:51], v[104:107]
    v_exp_f32 v17, v17
    s_waitcnt lgkmcnt(10)
    v_mfma_f32_16x16x32_bf16 v[108:111], v[76:79], v[52:55], v[108:111]
    ds_read_b64_tr_b16 v[76:77], v32 offset:8192
    ds_read_b64_tr_b16 v[78:79], v32 offset:9216
    v_exp_f32 v18, v18
    s_waitcnt vmcnt(7) lgkmcnt(0)
    s_barrier
    v_mfma_f32_16x16x32_bf16 v[124:127], v[80:83], v[52:55], v[124:127]
    v_exp_f32 v19, v19
    v_mfma_f32_16x16x32_bf16 v[120:123], v[80:83], v[48:51], v[120:123]
    v_add_f32 v16, 1.0, v16
    v_add_f32 v17, 1.0, v17
    v_add_f32 v18, 1.0, v18
    v_add_f32 v19, 1.0, v19
    v_mfma_f32_16x16x32_bf16 v[116:119], v[80:83], v[44:47], v[116:119]
    v_rcp_f32 v16, v16
    v_mfma_f32_16x16x32_bf16 v[112:115], v[80:83], v[40:43], v[112:115]
    ds_read_b64_tr_b16 v[80:81], v92 offset:10240
    ds_read_b64_tr_b16 v[82:83], v92 offset:11264
    v_rcp_f32 v17, v17
    v_mfma_f32_16x16x32_bf16 v[224:227], v[40:43], v[84:87], v[224:227]
    v_rcp_f32 v18, v18
    v_mfma_f32_16x16x32_bf16 v[228:231], v[44:47], v[84:87], v[228:231]
    v_rcp_f32 v19, v19
    v_mfma_f32_16x16x32_bf16 v[232:235], v[48:51], v[84:87], v[232:235]
    v_mul_f32 v152, v152, v16
    v_mul_f32 v153, v153, v17
    v_mul_f32 v154, v154, v18
    v_mul_f32 v155, v155, v19
    v_cvt_pk_bf16_f32 v136, v152, v153
    v_cvt_pk_bf16_f32 v137, v154, v155
    v_pk_mul_f32 v[16:17], v[168:169], v[168:169]
    v_pk_mul_f32 v[18:19], v[170:171], v[170:171]
    v_pk_mul_f32 v[184:185], v[168:169], v[184:185]
    v_pk_mul_f32 v[186:187], v[170:171], v[186:187]
    v_pk_fma_f32 v[16:17], v[16:17], s[86:87], v[94:95] op_sel_hi:[1,0,1]
    v_pk_fma_f32 v[18:19], v[18:19], s[86:87], v[94:95] op_sel_hi:[1,0,1]
    v_pk_mul_f32 v[16:17], v[16:17], v[168:169]
    v_pk_mul_f32 v[18:19], v[18:19], v[170:171]
    v_mfma_f32_16x16x32_bf16 v[236:239], v[52:55], v[84:87], v[236:239]
    ds_read_b64_tr_b16 v[84:85], v32 offset:10240
    ds_read_b64_tr_b16 v[86:87], v32 offset:11264
    v_exp_f32 v16, v16
    v_mfma_f32_16x16x32_bf16 v[252:255], v[52:55], v[88:91], v[252:255]
    v_exp_f32 v17, v17
    v_mfma_f32_16x16x32_bf16 v[248:251], v[48:51], v[88:91], v[248:251]
    v_exp_f32 v18, v18
    v_mfma_f32_16x16x32_bf16 v[244:247], v[44:47], v[88:91], v[244:247]
    v_exp_f32 v19, v19
    v_mfma_f32_16x16x32_bf16 v[240:243], v[40:43], v[88:91], v[240:243]
    ds_read_b64_tr_b16 v[88:89], v92 offset:14336
    ds_read_b64_tr_b16 v[90:91], v92 offset:15360
    v_add_f32 v16, 1.0, v16
    v_add_f32 v17, 1.0, v17
    v_add_f32 v18, 1.0, v18
    v_add_f32 v19, 1.0, v19
    v_mfma_f32_16x16x32_bf16 v[96:99], v[72:75], v[56:59], v[96:99]
    ds_read_b128 v[40:43], v8 offset:0
    v_rcp_f32 v16, v16
    v_mfma_f32_16x16x32_bf16 v[100:103], v[72:75], v[60:63], v[100:103]
    ds_read_b128 v[44:47], v8 offset:2048
    v_rcp_f32 v17, v17
    v_mfma_f32_16x16x32_bf16 v[104:107], v[72:75], v[64:67], v[104:107]
    ds_read_b128 v[48:51], v8 offset:4096
    v_rcp_f32 v18, v18
    v_mfma_f32_16x16x32_bf16 v[108:111], v[72:75], v[68:71], v[108:111]
    ds_read_b64_tr_b16 v[72:73], v32 offset:14336
    ds_read_b64_tr_b16 v[74:75], v32 offset:15360
    ds_read_b128 v[52:55], v8 offset:6144
    v_rcp_f32 v19, v19
    v_mfma_f32_16x16x32_bf16 v[124:127], v[76:79], v[68:71], v[124:127]
    v_mul_f32 v184, v184, v16
    v_mul_f32 v185, v185, v17
    v_mfma_f32_16x16x32_bf16 v[120:123], v[76:79], v[64:67], v[120:123]
    v_mul_f32 v186, v186, v18
    v_mul_f32 v187, v187, v19
    v_cvt_pk_bf16_f32 v138, v184, v185
    v_cvt_pk_bf16_f32 v139, v186, v187
    buffer_store_dwordx4 v[136:139], v2, s[20:23], s88 offen offset:2048 sc1
    v_pk_mul_f32 v[16:17], v[200:201], v[200:201]
    v_pk_mul_f32 v[18:19], v[202:203], v[202:203]
    v_pk_mul_f32 v[216:217], v[200:201], v[216:217]
    v_pk_mul_f32 v[218:219], v[202:203], v[218:219]
    v_pk_fma_f32 v[16:17], v[16:17], s[86:87], v[94:95] op_sel_hi:[1,0,1]
    v_pk_fma_f32 v[18:19], v[18:19], s[86:87], v[94:95] op_sel_hi:[1,0,1]
    v_pk_mul_f32 v[16:17], v[16:17], v[200:201]
    v_pk_mul_f32 v[18:19], v[18:19], v[202:203]
    v_mfma_f32_16x16x32_bf16 v[116:119], v[76:79], v[60:63], v[116:119]
    v_exp_f32 v16, v16
    v_mfma_f32_16x16x32_bf16 v[112:115], v[76:79], v[56:59], v[112:115]
    ds_read_b64_tr_b16 v[76:77], v92 offset:16384
    ds_read_b64_tr_b16 v[78:79], v92 offset:17408
    v_exp_f32 v17, v17
    s_waitcnt lgkmcnt(12)
    v_mfma_f32_16x16x32_bf16 v[224:227], v[56:59], v[80:83], v[224:227]
    v_exp_f32 v18, v18
    v_mfma_f32_16x16x32_bf16 v[228:231], v[60:63], v[80:83], v[228:231]
    v_exp_f32 v19, v19
    v_mfma_f32_16x16x32_bf16 v[232:235], v[64:67], v[80:83], v[232:235]
    v_add_f32 v16, 1.0, v16
    v_add_f32 v17, 1.0, v17
    v_add_f32 v18, 1.0, v18
    v_add_f32 v19, 1.0, v19
    v_mfma_f32_16x16x32_bf16 v[236:239], v[68:71], v[80:83], v[236:239]
    ds_read_b64_tr_b16 v[80:81], v32 offset:16384
    ds_read_b64_tr_b16 v[82:83], v32 offset:17408
    v_rcp_f32 v16, v16
    s_waitcnt lgkmcnt(12)
    v_mfma_f32_16x16x32_bf16 v[252:255], v[68:71], v[84:87], v[252:255]
    v_rcp_f32 v17, v17
    v_mfma_f32_16x16x32_bf16 v[248:251], v[64:67], v[84:87], v[248:251]
    v_rcp_f32 v18, v18
    v_mfma_f32_16x16x32_bf16 v[244:247], v[60:63], v[84:87], v[244:247]
    v_rcp_f32 v19, v19
    v_mfma_f32_16x16x32_bf16 v[240:243], v[56:59], v[84:87], v[240:243]
    ds_read_b64_tr_b16 v[84:85], v92 offset:20480
    ds_read_b64_tr_b16 v[86:87], v92 offset:21504
    v_mul_f32 v216, v216, v16
    v_mul_f32 v217, v217, v17
    s_waitcnt lgkmcnt(11)
    v_mfma_f32_16x16x32_bf16 v[96:99], v[88:91], v[40:43], v[96:99]
    ds_read_b128 v[56:59], v9 offset:0
    ds_read_b128 v[60:63], v9 offset:2048
    v_mul_f32 v218, v218, v18
    v_mul_f32 v219, v219, v19
    v_cvt_pk_bf16_f32 v200, v216, v217
    v_cvt_pk_bf16_f32 v201, v218, v219
    v_pk_mul_f32 v[16:17], v[204:205], v[204:205]
    v_pk_mul_f32 v[18:19], v[206:207], v[206:207]
    v_pk_mul_f32 v[220:221], v[204:205], v[220:221]
    v_pk_mul_f32 v[222:223], v[206:207], v[222:223]
    v_pk_fma_f32 v[16:17], v[16:17], s[86:87], v[94:95] op_sel_hi:[1,0,1]
    v_pk_fma_f32 v[18:19], v[18:19], s[86:87], v[94:95] op_sel_hi:[1,0,1]
    v_pk_mul_f32 v[16:17], v[16:17], v[204:205]
    v_pk_mul_f32 v[18:19], v[18:19], v[206:207]
    s_waitcnt lgkmcnt(12)
    v_mfma_f32_16x16x32_bf16 v[100:103], v[88:91], v[44:47], v[100:103]
    ds_read_b128 v[64:67], v9 offset:4096
    ds_read_b128 v[68:71], v9 offset:6144
    v_exp_f32 v16, v16
    s_waitcnt lgkmcnt(13)
    v_mfma_f32_16x16x32_bf16 v[104:107], v[88:91], v[48:51], v[104:107]
    v_exp_f32 v17, v17
    s_waitcnt lgkmcnt(10)
    v_mfma_f32_16x16x32_bf16 v[108:111], v[88:91], v[52:55], v[108:111]
    ds_read_b64_tr_b16 v[88:89], v32 offset:20480
    ds_read_b64_tr_b16 v[90:91], v32 offset:21504
    v_exp_f32 v18, v18
    v_mfma_f32_16x16x32_bf16 v[124:127], v[72:75], v[52:55], v[124:127]
    v_exp_f32 v19, v19
    v_mfma_f32_16x16x32_bf16 v[120:123], v[72:75], v[48:51], v[120:123]
    v_add_f32 v16, 1.0, v16
    v_add_f32 v17, 1.0, v17
    v_add_f32 v18, 1.0, v18
    v_add_f32 v19, 1.0, v19
    v_mfma_f32_16x16x32_bf16 v[116:119], v[72:75], v[44:47], v[116:119]
    v_rcp_f32 v16, v16
    v_mfma_f32_16x16x32_bf16 v[112:115], v[72:75], v[40:43], v[112:115]
    ds_read_b64_tr_b16 v[72:73], v92 offset:22528
    ds_read_b64_tr_b16 v[74:75], v92 offset:23552
    v_rcp_f32 v17, v17
    s_waitcnt lgkmcnt(12)
    v_mfma_f32_16x16x32_bf16 v[224:227], v[40:43], v[76:79], v[224:227]
    v_rcp_f32 v18, v18
    v_mfma_f32_16x16x32_bf16 v[228:231], v[44:47], v[76:79], v[228:231]
    v_rcp_f32 v19, v19
    v_mfma_f32_16x16x32_bf16 v[232:235], v[48:51], v[76:79], v[232:235]
    v_mul_f32 v220, v220, v16
    v_mul_f32 v221, v221, v17
    v_mul_f32 v222, v222, v18
    v_mul_f32 v223, v223, v19
    v_cvt_pk_bf16_f32 v202, v220, v221
    v_cvt_pk_bf16_f32 v203, v222, v223
    buffer_store_dwordx4 v[200:203], v2, s[20:23], s3 offen offset:2048 sc1
    v_pk_mul_f32 v[16:17], v[140:141], v[140:141]
    v_pk_mul_f32 v[18:19], v[142:143], v[142:143]
    v_pk_mul_f32 v[156:157], v[140:141], v[156:157]
    v_pk_mul_f32 v[158:159], v[142:143], v[158:159]
    v_pk_fma_f32 v[16:17], v[16:17], s[86:87], v[94:95] op_sel_hi:[1,0,1]
    v_pk_fma_f32 v[18:19], v[18:19], s[86:87], v[94:95] op_sel_hi:[1,0,1]
    v_pk_mul_f32 v[16:17], v[16:17], v[140:141]
    v_pk_mul_f32 v[18:19], v[18:19], v[142:143]
    v_mfma_f32_16x16x32_bf16 v[236:239], v[52:55], v[76:79], v[236:239]
    ds_read_b64_tr_b16 v[76:77], v32 offset:22528
    ds_read_b64_tr_b16 v[78:79], v32 offset:23552
    v_exp_f32 v16, v16
    s_waitcnt lgkmcnt(12)
    v_mfma_f32_16x16x32_bf16 v[252:255], v[52:55], v[80:83], v[252:255]
    v_exp_f32 v17, v17
    v_mfma_f32_16x16x32_bf16 v[248:251], v[48:51], v[80:83], v[248:251]
    v_exp_f32 v18, v18
    v_mfma_f32_16x16x32_bf16 v[244:247], v[44:47], v[80:83], v[244:247]
    v_exp_f32 v19, v19
    v_mfma_f32_16x16x32_bf16 v[240:243], v[40:43], v[80:83], v[240:243]
    v_add_f32 v16, 1.0, v16
    v_add_f32 v17, 1.0, v17
    v_add_f32 v18, 1.0, v18
    v_add_f32 v19, 1.0, v19
    s_waitcnt lgkmcnt(9)
    v_mfma_f32_16x16x32_bf16 v[96:99], v[84:87], v[56:59], v[96:99]
    v_rcp_f32 v16, v16
    s_waitcnt lgkmcnt(8)
    v_mfma_f32_16x16x32_bf16 v[100:103], v[84:87], v[60:63], v[100:103]
    v_rcp_f32 v17, v17
    s_waitcnt lgkmcnt(7)
    v_mfma_f32_16x16x32_bf16 v[104:107], v[84:87], v[64:67], v[104:107]
    v_rcp_f32 v18, v18
    s_waitcnt lgkmcnt(6)
    v_mfma_f32_16x16x32_bf16 v[108:111], v[84:87], v[68:71], v[108:111]
    v_rcp_f32 v19, v19
    s_waitcnt lgkmcnt(4)
    v_mfma_f32_16x16x32_bf16 v[124:127], v[88:91], v[68:71], v[124:127]
    v_mul_f32 v156, v156, v16
    v_mul_f32 v157, v157, v17
    v_mfma_f32_16x16x32_bf16 v[120:123], v[88:91], v[64:67], v[120:123]
    v_mul_f32 v158, v158, v18
    v_mul_f32 v159, v159, v19
    v_cvt_pk_bf16_f32 v140, v156, v157
    v_cvt_pk_bf16_f32 v141, v158, v159
    v_pk_mul_f32 v[16:17], v[172:173], v[172:173]
    v_pk_mul_f32 v[18:19], v[174:175], v[174:175]
    v_pk_mul_f32 v[188:189], v[172:173], v[188:189]
    v_pk_mul_f32 v[190:191], v[174:175], v[190:191]
    v_pk_fma_f32 v[16:17], v[16:17], s[86:87], v[94:95] op_sel_hi:[1,0,1]
    v_pk_fma_f32 v[18:19], v[18:19], s[86:87], v[94:95] op_sel_hi:[1,0,1]
    v_pk_mul_f32 v[16:17], v[16:17], v[172:173]
    v_pk_mul_f32 v[18:19], v[18:19], v[174:175]
    v_mfma_f32_16x16x32_bf16 v[116:119], v[88:91], v[60:63], v[116:119]
    v_exp_f32 v16, v16
    v_mfma_f32_16x16x32_bf16 v[112:115], v[88:91], v[56:59], v[112:115]
    v_exp_f32 v17, v17
    s_waitcnt lgkmcnt(2)
    v_mfma_f32_16x16x32_bf16 v[224:227], v[56:59], v[72:75], v[224:227]
    v_exp_f32 v18, v18
    v_mfma_f32_16x16x32_bf16 v[228:231], v[60:63], v[72:75], v[228:231]
    v_exp_f32 v19, v19
    v_mfma_f32_16x16x32_bf16 v[232:235], v[64:67], v[72:75], v[232:235]
    v_add_f32 v16, 1.0, v16
    v_add_f32 v17, 1.0, v17
    v_add_f32 v18, 1.0, v18
    v_add_f32 v19, 1.0, v19
    v_mfma_f32_16x16x32_bf16 v[236:239], v[68:71], v[72:75], v[236:239]
    v_rcp_f32 v16, v16
    s_waitcnt lgkmcnt(0)
    v_mfma_f32_16x16x32_bf16 v[252:255], v[68:71], v[76:79], v[252:255]
    v_rcp_f32 v17, v17
    v_mfma_f32_16x16x32_bf16 v[248:251], v[64:67], v[76:79], v[248:251]
    v_rcp_f32 v18, v18
    v_mfma_f32_16x16x32_bf16 v[244:247], v[60:63], v[76:79], v[244:247]
    v_rcp_f32 v19, v19
    v_mfma_f32_16x16x32_bf16 v[240:243], v[56:59], v[76:79], v[240:243]
    v_mul_f32 v188, v188, v16
    v_mul_f32 v189, v189, v17
    v_mul_f32 v190, v190, v18
    v_mul_f32 v191, v191, v19
    v_cvt_pk_bf16_f32 v142, v188, v189
    v_cvt_pk_bf16_f32 v143, v190, v191
    buffer_store_dwordx4 v[140:143], v2, s[20:23], s88 offen offset:3072 sc1
    v_cvt_pk_bf16_f32 v40, v96, v97
    v_cvt_pk_bf16_f32 v41, v98, v99
    v_cvt_pk_bf16_f32 v42, v112, v113
    v_cvt_pk_bf16_f32 v43, v114, v115
    ds_write_b128 v13, v[40:43] offset:0
    v_cvt_pk_bf16_f32 v44, v100, v101
    v_cvt_pk_bf16_f32 v45, v102, v103
    v_cvt_pk_bf16_f32 v46, v116, v117
    v_cvt_pk_bf16_f32 v47, v118, v119
    ds_write_b128 v13, v[44:47] offset:1024
    v_cvt_pk_bf16_f32 v72, v104, v105
    v_cvt_pk_bf16_f32 v73, v106, v107
    v_cvt_pk_bf16_f32 v74, v120, v121
    v_cvt_pk_bf16_f32 v75, v122, v123
    v_cvt_pk_bf16_f32 v76, v108, v109
    v_cvt_pk_bf16_f32 v77, v110, v111
    v_cvt_pk_bf16_f32 v78, v124, v125
    v_cvt_pk_bf16_f32 v79, v126, v127
    ds_read_b64_tr_b16 v[88:89], v38 offset:0
    ds_read_b64_tr_b16 v[90:91], v38 offset:1024
    ds_read_b64_tr_b16 v[92:93], v38 offset:32
    ds_read_b64_tr_b16 v[94:95], v38 offset:1056
    s_waitcnt lgkmcnt(4)
    s_barrier
    ds_read_b128 v[80:83], v13 offset:8192
    ds_read_b128 v[84:87], v13 offset:9216
    v_cvt_pk_bf16_f32 v96, v224, v225
    v_cvt_pk_bf16_f32 v97, v226, v227
    v_cvt_pk_bf16_f32 v98, v228, v229
    v_cvt_pk_bf16_f32 v99, v230, v231
    ds_write_b128 v13, v[96:99] offset:53248
    v_cvt_pk_bf16_f32 v100, v240, v241
    v_cvt_pk_bf16_f32 v101, v242, v243
    v_cvt_pk_bf16_f32 v102, v244, v245
    v_cvt_pk_bf16_f32 v103, v246, v247
    ds_write_b128 v13, v[100:103] offset:54272
    v_cvt_pk_bf16_f32 v104, v232, v233
    v_cvt_pk_bf16_f32 v105, v234, v235
    v_cvt_pk_bf16_f32 v106, v236, v237
    v_cvt_pk_bf16_f32 v107, v238, v239
    ds_write_b128 v13, v[104:107] offset:61440
    v_cvt_pk_bf16_f32 v108, v248, v249
    v_cvt_pk_bf16_f32 v109, v250, v251
    v_cvt_pk_bf16_f32 v110, v252, v253
    v_cvt_pk_bf16_f32 v111, v254, v255
    ds_write_b128 v13, v[108:111] offset:62464
    s_waitcnt lgkmcnt(0)
    s_nop 0
L_k3:
    s_nop 7
    v_mfma_f32_16x16x32_bf16 v[192:195], v[88:91], v[72:75], 0
    v_mfma_f32_16x16x32_bf16 v[196:199], v[92:95], v[72:75], 0
    v_mfma_f32_16x16x32_bf16 v[200:203], v[88:91], v[76:79], 0
    v_mfma_f32_16x16x32_bf16 v[204:207], v[92:95], v[76:79], 0
    v_mfma_f32_16x16x32_bf16 v[40:43], v[88:91], v[80:83], 0
    v_mfma_f32_16x16x32_bf16 v[44:47], v[92:95], v[80:83], 0
    v_mfma_f32_16x16x32_bf16 v[48:51], v[88:91], v[84:87], 0
    v_mfma_f32_16x16x32_bf16 v[52:55], v[92:95], v[84:87], 0
    s_mov_b64 s[8:9], s[40:41]
    s_and_b32 s9, s9, 0xffff
    s_mul_i32 s29, s59, 2560
    s_add_u32 s29, s29, 139264
    s_mul_i32 s4, s62, 8448
    s_add_u32 s4, s4, s91
    s_lshl_b32 s5, s59, 9
    s_add_u32 s3, s4, s5
    s_lshl_b32 s5, s60, 6
    s_add_u32 s4, s4, s5
    s_add_u32 s4, s4, 8192
    s_lshl_b32 s5, s63, 10
    s_lshl_b32 s6, s62, 7
    s_add_u32 s5, s5, s6
    s_lshl_b32 s6, s59, 2
    s_add_u32 s5, s5, s6
    s_add_u32 s36, s5, 2490368
    v_cvt_pk_bf16_f32 v224, v192, v193
    s_add_u32 m0, s95, 32768
    s_nop 0
    buffer_load_dwordx4 v6, s[12:15], s74 offen  lds
    v_cvt_pk_bf16_f32 v225, v194, v195
    v_cvt_pk_bf16_f32 v226, v196, v197
    v_cvt_pk_bf16_f32 v227, v198, v199
    v_cvt_pk_bf16_f32 v228, v200, v201
    v_cvt_pk_bf16_f32 v229, v202, v203
    v_cvt_pk_bf16_f32 v230, v204, v205
    v_cvt_pk_bf16_f32 v231, v206, v207
    v_lshlrev_b32 v192, 16, v224
    s_add_u32 m0, s95, 32768
    s_nop 0
    buffer_load_dwordx4 v7, s[12:15], s74 offen offset:1024  lds
    s_add_u32 s74, s74, 0x20000
    v_and_b32 v193, 0xffff0000, v224
    v_lshlrev_b32 v194, 16, v225
    v_and_b32 v195, 0xffff0000, v225
    v_lshlrev_b32 v196, 16, v226
    v_and_b32 v197, 0xffff0000, v226
    v_lshlrev_b32 v198, 16, v227
    v_and_b32 v199, 0xffff0000, v227
    v_lshlrev_b32 v200, 16, v228
    s_add_u32 m0, s95, 49152
    s_nop 0
    buffer_load_dwordx4 v6, s[12:15], s74 offen  lds
    v_and_b32 v201, 0xffff0000, v228
    v_lshlrev_b32 v202, 16, v229
    v_and_b32 v203, 0xffff0000, v229
    v_lshlrev_b32 v204, 16, v230
    v_and_b32 v205, 0xffff0000, v230
    v_lshlrev_b32 v206, 16, v231
    v_and_b32 v207, 0xffff0000, v231
    v_max3_f32 v224, v192, v193, v194
    s_add_u32 m0, s95, 49152
    s_nop 0
    buffer_load_dwordx4 v7, s[12:15], s74 offen offset:1024  lds
    s_add_u32 s74, s74, 0x20000
    v_max3_f32 v226, v200, v201, v202
    v_max3_f32 v228, -v192, -v193, -v194
    v_max3_f32 v230, -v200, -v201, -v202
    v_max3_f32 v224, v224, v195, v196
    v_max3_f32 v226, v226, v203, v204
    v_max3_f32 v228, v228, -v195, -v196
    v_max3_f32 v230, v230, -v203, -v204
    v_max3_f32 v224, v224, v197, v198
    v_max3_f32 v226, v226, v205, v206
    v_max3_f32 v228, v228, -v197, -v198
    v_max3_f32 v230, v230, -v205, -v206
    v_max3_f32 v224, v224, v199, v199
    v_max3_f32 v226, v226, v207, v207
    v_max3_f32 v228, v228, -v199, -v199
    v_max3_f32 v230, v230, -v207, -v207
    s_waitcnt vmcnt(4)
    s_mov_b64 exec, 1
    buffer_store_dword v33, off, s[24:27], s89 sc1
    s_mov_b64 exec, -1
    v_permlane32_swap_b32 v224, v228
    v_permlane32_swap_b32 v226, v230
    v_max_f32 v224, v224, v228
    v_max_f32 v226, v226, v230
    s_nop 1
    v_permlane16_swap_b32 v224, v226
    v_max_f32 v224, v224, v226
    v_mul_f32 v224, s84, v224
    v_mov_b32 v226, v224
    s_nop 1
    v_permlane16_swap_b32 v224, v226
    v_mov_b32 v228, v224
    v_mov_b32 v230, v226
    s_nop 0
    v_permlane32_swap_b32 v224, v228
    v_permlane32_swap_b32 v226, v230
    v_pk_fma_f32 v[208:209], v[192:193], s[84:85], v[224:225] op_sel_hi:[1,1,0] neg_lo:[0,0,1] neg_hi:[0,0,1]
    v_pk_fma_f32 v[192:193], v[192:193], s[84:85], v[228:229] op_sel_hi:[1,1,0] neg_lo:[1,0,1] neg_hi:[1,0,1]
    v_pk_fma_f32 v[210:211], v[194:195], s[84:85], v[224:225] op_sel_hi:[1,1,0] neg_lo:[0,0,1] neg_hi:[0,0,1]
    v_pk_fma_f32 v[194:195], v[194:195], s[84:85], v[228:229] op_sel_hi:[1,1,0] neg_lo:[1,0,1] neg_hi:[1,0,1]
    v_pk_fma_f32 v[212:213], v[196:197], s[84:85], v[224:225] op_sel_hi:[1,1,0] neg_lo:[0,0,1] neg_hi:[0,0,1]
    v_pk_fma_f32 v[196:197], v[196:197], s[84:85], v[228:229] op_sel_hi:[1,1,0] neg_lo:[1,0,1] neg_hi:[1,0,1]
    v_pk_fma_f32 v[214:215], v[198:199], s[84:85], v[224:225] op_sel_hi:[1,1,0] neg_lo:[0,0,1] neg_hi:[0,0,1]
    v_pk_fma_f32 v[198:199], v[198:199], s[84:85], v[228:229] op_sel_hi:[1,1,0] neg_lo:[1,0,1] neg_hi:[1,0,1]
    v_pk_fma_f32 v[216:217], v[200:201], s[84:85], v[226:227] op_sel_hi:[1,1,0] neg_lo:[0,0,1] neg_hi:[0,0,1]
    v_pk_fma_f32 v[200:201], v[200:201], s[84:85], v[230:231] op_sel_hi:[1,1,0] neg_lo:[1,0,1] neg_hi:[1,0,1]
    v_pk_fma_f32 v[218:219], v[202:203], s[84:85], v[226:227] op_sel_hi:[1,1,0] neg_lo:[0,0,1] neg_hi:[0,0,1]
    v_pk_fma_f32 v[202:203], v[202:203], s[84:85], v[230:231] op_sel_hi:[1,1,0] neg_lo:[1,0,1] neg_hi:[1,0,1]
    v_pk_fma_f32 v[220:221], v[204:205], s[84:85], v[226:227] op_sel_hi:[1,1,0] neg_lo:[0,0,1] neg_hi:[0,0,1]
    v_pk_fma_f32 v[204:205], v[204:205], s[84:85], v[230:231] op_sel_hi:[1,1,0] neg_lo:[1,0,1] neg_hi:[1,0,1]
    v_pk_fma_f32 v[222:223], v[206:207], s[84:85], v[226:227] op_sel_hi:[1,1,0] neg_lo:[0,0,1] neg_hi:[0,0,1]
    v_pk_fma_f32 v[206:207], v[206:207], s[84:85], v[230:231] op_sel_hi:[1,1,0] neg_lo:[1,0,1] neg_hi:[1,0,1]
    v_exp_f32 v208, v208
    v_exp_f32 v192, v192
    v_exp_f32 v209, v209
    v_exp_f32 v193, v193
    v_exp_f32 v210, v210
    v_exp_f32 v194, v194
    v_exp_f32 v211, v211
    v_exp_f32 v195, v195
    v_exp_f32 v212, v212
    v_exp_f32 v196, v196
    v_exp_f32 v213, v213
    v_exp_f32 v197, v197
    v_exp_f32 v214, v214
    v_exp_f32 v198, v198
    v_exp_f32 v215, v215
    v_exp_f32 v199, v199
    v_exp_f32 v216, v216
    v_exp_f32 v200, v200
    v_exp_f32 v217, v217
    v_exp_f32 v201, v201
    v_exp_f32 v218, v218
    v_exp_f32 v202, v202
    v_exp_f32 v219, v219
    v_exp_f32 v203, v203
    v_exp_f32 v220, v220
    v_exp_f32 v204, v204
    v_exp_f32 v221, v221
    v_exp_f32 v205, v205
    v_exp_f32 v222, v222
    v_exp_f32 v206, v206
    v_exp_f32 v223, v223
    v_exp_f32 v207, v207
    v_pk_add_f32 v[224:225], v[208:209], v[210:211]
    v_pk_add_f32 v[226:227], v[216:217], v[218:219]
    v_pk_add_f32 v[228:229], v[192:193], v[194:195]
    v_pk_add_f32 v[230:231], v[200:201], v[202:203]
    v_pk_add_f32 v[224:225], v[224:225], v[212:213]
    v_pk_add_f32 v[226:227], v[226:227], v[220:221]
    v_pk_add_f32 v[228:229], v[228:229], v[196:197]
    v_pk_add_f32 v[230:231], v[230:231], v[204:205]
    v_pk_add_f32 v[224:225], v[224:225], v[214:215]
    v_pk_add_f32 v[226:227], v[226:227], v[222:223]
    v_pk_add_f32 v[228:229], v[228:229], v[198:199]
    v_pk_add_f32 v[230:231], v[230:231], v[206:207]
    v_add_f32 v224, v224, v225
    v_add_f32 v226, v226, v227
    v_add_f32 v228, v228, v229
    v_add_f32 v230, v230, v231
    s_nop 0
    v_permlane32_swap_b32 v224, v228
    v_permlane32_swap_b32 v226, v230
    v_add_f32 v224, v224, v228
    v_add_f32 v226, v226, v230
    s_nop 1
    v_permlane16_swap_b32 v224, v226
    v_add_f32 v224, v224, v226
    v_rcp_f32 v224, v224
    s_nop 0
    v_mov_b32 v226, v224
    s_nop 1
    v_permlane16_swap_b32 v224, v226
    v_mov_b32 v228, v224
    v_mov_b32 v230, v226
    s_nop 0
    v_permlane32_swap_b32 v224, v228
    v_permlane32_swap_b32 v226, v230
    v_pk_mul_f32 v[208:209], v[208:209], v[224:225] op_sel_hi:[1,0]
    v_pk_mul_f32 v[210:211], v[210:211], v[224:225] op_sel_hi:[1,0]
    v_pk_mul_f32 v[212:213], v[212:213], v[224:225] op_sel_hi:[1,0]
    v_pk_mul_f32 v[214:215], v[214:215], v[224:225] op_sel_hi:[1,0]
    v_pk_mul_f32 v[216:217], v[216:217], v[226:227] op_sel_hi:[1,0]
    v_pk_mul_f32 v[218:219], v[218:219], v[226:227] op_sel_hi:[1,0]
    v_pk_mul_f32 v[220:221], v[220:221], v[226:227] op_sel_hi:[1,0]
    v_pk_mul_f32 v[222:223], v[222:223], v[226:227] op_sel_hi:[1,0]
    v_pk_mul_f32 v[192:193], v[192:193], v[228:229] op_sel_hi:[1,0]
    v_pk_mul_f32 v[194:195], v[194:195], v[228:229] op_sel_hi:[1,0]
    v_pk_mul_f32 v[196:197], v[196:197], v[228:229] op_sel_hi:[1,0]
    v_pk_mul_f32 v[198:199], v[198:199], v[228:229] op_sel_hi:[1,0]
    v_pk_mul_f32 v[200:201], v[200:201], v[230:231] op_sel_hi:[1,0]
    v_pk_mul_f32 v[202:203], v[202:203], v[230:231] op_sel_hi:[1,0]
    v_pk_mul_f32 v[204:205], v[204:205], v[230:231] op_sel_hi:[1,0]
    v_pk_mul_f32 v[206:207], v[206:207], v[230:231] op_sel_hi:[1,0]
    v_cvt_pk_bf16_f32 v56, v208, v209
    v_cvt_pk_bf16_f32 v57, v210, v211
    v_cvt_pk_bf16_f32 v58, v212, v213
    v_cvt_pk_bf16_f32 v59, v214, v215
    v_cvt_pk_bf16_f32 v64, v216, v217
    v_cvt_pk_bf16_f32 v65, v218, v219
    v_cvt_pk_bf16_f32 v66, v220, v221
    v_cvt_pk_bf16_f32 v67, v222, v223
    v_cvt_pk_bf16_f32 v60, v192, v193
    v_cvt_pk_bf16_f32 v61, v194, v195
    v_cvt_pk_bf16_f32 v62, v196, v197
    v_cvt_pk_bf16_f32 v63, v198, v199
    v_cvt_pk_bf16_f32 v68, v200, v201
    v_cvt_pk_bf16_f32 v69, v202, v203
    v_cvt_pk_bf16_f32 v70, v204, v205
    v_cvt_pk_bf16_f32 v71, v206, v207
    ds_write_b64 v36, v[56:57] offset:0
    ds_write_b64 v36, v[58:59] offset:32
    ds_write_b64 v36, v[60:61] offset:64
    ds_write_b64 v36, v[62:63] offset:96
    ds_write_b64 v36, v[64:65] offset:2304
    ds_write_b64 v36, v[66:67] offset:2336
    ds_write_b64 v36, v[68:69] offset:2368
    ds_write_b64 v36, v[70:71] offset:2400
    v_cvt_pk_bf16_f32 v224, v40, v41
    v_cvt_pk_bf16_f32 v225, v42, v43
    v_cvt_pk_bf16_f32 v226, v44, v45
    v_cvt_pk_bf16_f32 v227, v46, v47
    v_cvt_pk_bf16_f32 v228, v48, v49
    v_cvt_pk_bf16_f32 v229, v50, v51
    s_waitcnt lgkmcnt(0)
    s_barrier
    ds_read_b64_tr_b16 v[56:57], v37 offset:0
    ds_read_b64_tr_b16 v[58:59], v37 offset:2304
    ds_read_b128 v[60:63], v11 offset:0
    ds_read_b64_tr_b16 v[64:65], v37 offset:4608
    ds_read_b64_tr_b16 v[66:67], v37 offset:6912
    ds_read_b128 v[68:71], v11 offset:2048
    ds_read_b64_tr_b16 v[72:73], v37 offset:9216
    ds_read_b64_tr_b16 v[74:75], v37 offset:11520
    ds_read_b128 v[76:79], v11 offset:4096
    ds_read_b64_tr_b16 v[80:81], v37 offset:13824
    ds_read_b64_tr_b16 v[82:83], v37 offset:16128
    ds_read_b128 v[84:87], v11 offset:6144
    v_cvt_pk_bf16_f32 v230, v52, v53
    v_cvt_pk_bf16_f32 v231, v54, v55
    v_lshlrev_b32 v40, 16, v224
    v_and_b32 v41, 0xffff0000, v224
    v_lshlrev_b32 v42, 16, v225
    v_and_b32 v43, 0xffff0000, v225
    v_lshlrev_b32 v44, 16, v226
    v_and_b32 v45, 0xffff0000, v226
    v_lshlrev_b32 v46, 16, v227
    v_and_b32 v47, 0xffff0000, v227
    s_waitcnt lgkmcnt(9)
    v_mfma_f32_16x16x32_bf16 v[88:91], v[56:59], v[60:63], 0
    v_mfma_f32_16x16x32_bf16 v[92:95], v[56:59], v[20:23], 0
    ds_read_b64_tr_b16 v[56:57], v37 offset:18432
    ds_read_b64_tr_b16 v[58:59], v37 offset:20736
    ds_read_b128 v[60:63], v11 offset:8192
    v_lshlrev_b32 v48, 16, v228
    v_and_b32 v49, 0xffff0000, v228
    v_lshlrev_b32 v50, 16, v229
    v_and_b32 v51, 0xffff0000, v229
    s_waitcnt lgkmcnt(9)
    v_mfma_f32_16x16x32_bf16 v[88:91], v[64:67], v[68:71], v[88:91]
    v_mfma_f32_16x16x32_bf16 v[92:95], v[64:67], v[20:23], v[92:95]
    ds_read_b64_tr_b16 v[64:65], v37 offset:23040
    ds_read_b64_tr_b16 v[66:67], v37 offset:25344
    ds_read_b128 v[68:71], v11 offset:10240
    v_lshlrev_b32 v52, 16, v230
    v_and_b32 v53, 0xffff0000, v230
    v_lshlrev_b32 v54, 16, v231
    v_and_b32 v55, 0xffff0000, v231
    s_waitcnt lgkmcnt(9)
    v_mfma_f32_16x16x32_bf16 v[88:91], v[72:75], v[76:79], v[88:91]
    v_mfma_f32_16x16x32_bf16 v[92:95], v[72:75], v[20:23], v[92:95]
    ds_read_b64_tr_b16 v[72:73], v37 offset:27648
    ds_read_b64_tr_b16 v[74:75], v37 offset:29952
    ds_read_b128 v[76:79], v11 offset:12288
    v_max3_f32 v224, v40, v41, v42
    v_max3_f32 v226, v48, v49, v50
    v_max3_f32 v228, -v40, -v41, -v42
    v_max3_f32 v230, -v48, -v49, -v50
    s_waitcnt lgkmcnt(9)
    v_mfma_f32_16x16x32_bf16 v[88:91], v[80:83], v[84:87], v[88:91]
    v_mfma_f32_16x16x32_bf16 v[92:95], v[80:83], v[20:23], v[92:95]
    ds_read_b64_tr_b16 v[80:81], v37 offset:32256
    ds_read_b64_tr_b16 v[82:83], v37 offset:34560
    ds_read_b128 v[84:87], v11 offset:14336
    v_max3_f32 v224, v224, v43, v44
    v_max3_f32 v226, v226, v51, v52
    v_max3_f32 v228, v228, -v43, -v44
    v_max3_f32 v230, v230, -v51, -v52
    s_waitcnt lgkmcnt(9)
    v_mfma_f32_16x16x32_bf16 v[88:91], v[56:59], v[60:63], v[88:91]
    v_mfma_f32_16x16x32_bf16 v[92:95], v[56:59], v[20:23], v[92:95]
    v_max3_f32 v224, v224, v45, v46
    v_max3_f32 v226, v226, v53, v54
    v_max3_f32 v228, v228, -v45, -v46
    v_max3_f32 v230, v230, -v53, -v54
    s_waitcnt lgkmcnt(6)
    v_mfma_f32_16x16x32_bf16 v[88:91], v[64:67], v[68:71], v[88:91]
    v_mfma_f32_16x16x32_bf16 v[92:95], v[64:67], v[20:23], v[92:95]
    v_max3_f32 v224, v224, v47, v47
    v_max3_f32 v226, v226, v55, v55
    v_max3_f32 v228, v228, -v47, -v47
    v_max3_f32 v230, v230, -v55, -v55
    s_waitcnt lgkmcnt(3)
    v_mfma_f32_16x16x32_bf16 v[88:91], v[72:75], v[76:79], v[88:91]
    v_mfma_f32_16x16x32_bf16 v[92:95], v[72:75], v[20:23], v[92:95]
    v_permlane32_swap_b32 v224, v228
    v_permlane32_swap_b32 v226, v230
    v_max_f32 v224, v224, v228
    v_max_f32 v226, v226, v230
    s_waitcnt lgkmcnt(0)
    v_mfma_f32_16x16x32_bf16 v[88:91], v[80:83], v[84:87], v[88:91]
    v_mfma_f32_16x16x32_bf16 v[92:95], v[80:83], v[20:23], v[92:95]
    v_permlane16_swap_b32 v224, v226
    v_max_f32 v224, v224, v226
    v_mul_f32 v224, s84, v224
    v_mov_b32 v226, v224
    s_nop 1
    v_permlane16_swap_b32 v224, v226
    v_mov_b32 v228, v224
    v_mov_b32 v230, v226
    s_nop 0
    v_permlane32_swap_b32 v224, v228
    v_cvt_pk_bf16_f32 v88, v88, v89
    v_cvt_pk_bf16_f32 v89, v90, v91
    s_mov_b32 exec_lo, 0x10001
    s_mov_b32 exec_hi, 0x10001
    buffer_store_dwordx4 v[92:95], v1, s[24:27], s4 offen sc1
    s_mov_b64 exec, -1
    buffer_store_dwordx2 v[88:89], v14, s[24:27], s3 offen sc1
    v_permlane32_swap_b32 v226, v230
    v_pk_fma_f32 v[208:209], v[40:41], s[84:85], v[224:225] op_sel_hi:[1,1,0] neg_lo:[0,0,1] neg_hi:[0,0,1]
    v_pk_fma_f32 v[40:41], v[40:41], s[84:85], v[228:229] op_sel_hi:[1,1,0] neg_lo:[1,0,1] neg_hi:[1,0,1]
    v_pk_fma_f32 v[210:211], v[42:43], s[84:85], v[224:225] op_sel_hi:[1,1,0] neg_lo:[0,0,1] neg_hi:[0,0,1]
    v_pk_fma_f32 v[42:43], v[42:43], s[84:85], v[228:229] op_sel_hi:[1,1,0] neg_lo:[1,0,1] neg_hi:[1,0,1]
    v_pk_fma_f32 v[212:213], v[44:45], s[84:85], v[224:225] op_sel_hi:[1,1,0] neg_lo:[0,0,1] neg_hi:[0,0,1]
    v_pk_fma_f32 v[44:45], v[44:45], s[84:85], v[228:229] op_sel_hi:[1,1,0] neg_lo:[1,0,1] neg_hi:[1,0,1]
    v_pk_fma_f32 v[214:215], v[46:47], s[84:85], v[224:225] op_sel_hi:[1,1,0] neg_lo:[0,0,1] neg_hi:[0,0,1]
    v_pk_fma_f32 v[46:47], v[46:47], s[84:85], v[228:229] op_sel_hi:[1,1,0] neg_lo:[1,0,1] neg_hi:[1,0,1]
    v_pk_fma_f32 v[216:217], v[48:49], s[84:85], v[226:227] op_sel_hi:[1,1,0] neg_lo:[0,0,1] neg_hi:[0,0,1]
    v_pk_fma_f32 v[48:49], v[48:49], s[84:85], v[230:231] op_sel_hi:[1,1,0] neg_lo:[1,0,1] neg_hi:[1,0,1]
    v_pk_fma_f32 v[218:219], v[50:51], s[84:85], v[226:227] op_sel_hi:[1,1,0] neg_lo:[0,0,1] neg_hi:[0,0,1]
    v_pk_fma_f32 v[50:51], v[50:51], s[84:85], v[230:231] op_sel_hi:[1,1,0] neg_lo:[1,0,1] neg_hi:[1,0,1]
    v_pk_fma_f32 v[220:221], v[52:53], s[84:85], v[226:227] op_sel_hi:[1,1,0] neg_lo:[0,0,1] neg_hi:[0,0,1]
    v_pk_fma_f32 v[52:53], v[52:53], s[84:85], v[230:231] op_sel_hi:[1,1,0] neg_lo:[1,0,1] neg_hi:[1,0,1]
    v_pk_fma_f32 v[222:223], v[54:55], s[84:85], v[226:227] op_sel_hi:[1,1,0] neg_lo:[0,0,1] neg_hi:[0,0,1]
    v_pk_fma_f32 v[54:55], v[54:55], s[84:85], v[230:231] op_sel_hi:[1,1,0] neg_lo:[1,0,1] neg_hi:[1,0,1]
    v_exp_f32 v208, v208
    v_exp_f32 v40, v40
    v_exp_f32 v209, v209
    v_exp_f32 v41, v41
    v_exp_f32 v210, v210
    v_exp_f32 v42, v42
    v_exp_f32 v211, v211
    v_exp_f32 v43, v43
    v_exp_f32 v212, v212
    v_exp_f32 v44, v44
    v_exp_f32 v213, v213
    s_add_u32 s34, s90, 0
    buffer_load_dword v34, v39, s[24:27], s34 offen offset:0 sc1
    v_exp_f32 v45, v45
    v_exp_f32 v214, v214
    v_exp_f32 v46, v46
    v_exp_f32 v215, v215
    v_exp_f32 v47, v47
    v_exp_f32 v216, v216
    v_exp_f32 v48, v48
    v_exp_f32 v217, v217
    v_exp_f32 v49, v49
    v_exp_f32 v218, v218
    v_exp_f32 v50, v50
    v_exp_f32 v219, v219
    v_exp_f32 v51, v51
    v_exp_f32 v220, v220
    v_exp_f32 v52, v52
    v_exp_f32 v221, v221
    v_exp_f32 v53, v53
    v_exp_f32 v222, v222
    v_exp_f32 v54, v54
    v_exp_f32 v223, v223
    s_waitcnt vmcnt(1)
    s_mov_b64 exec, 1
    buffer_store_dword v33, off, s[24:27], s36 sc1
    s_mov_b64 exec, -1
    v_exp_f32 v55, v55
    v_pk_add_f32 v[224:225], v[208:209], v[210:211]
    v_pk_add_f32 v[226:227], v[216:217], v[218:219]
    v_pk_add_f32 v[228:229], v[40:41], v[42:43]
    v_pk_add_f32 v[230:231], v[48:49], v[50:51]
    v_pk_add_f32 v[224:225], v[224:225], v[212:213]
    v_pk_add_f32 v[226:227], v[226:227], v[220:221]
    v_pk_add_f32 v[228:229], v[228:229], v[44:45]
    v_pk_add_f32 v[230:231], v[230:231], v[52:53]
    v_pk_add_f32 v[224:225], v[224:225], v[214:215]
    v_pk_add_f32 v[226:227], v[226:227], v[222:223]
    v_pk_add_f32 v[228:229], v[228:229], v[46:47]
    v_pk_add_f32 v[230:231], v[230:231], v[54:55]
    v_add_f32 v224, v224, v225
    v_add_f32 v226, v226, v227
    v_add_f32 v228, v228, v229
    v_add_f32 v230, v230, v231
    s_nop 0
    v_permlane32_swap_b32 v224, v228
    v_permlane32_swap_b32 v226, v230
    v_add_f32 v224, v224, v228
    v_add_f32 v226, v226, v230
    s_nop 1
    v_permlane16_swap_b32 v224, v226
    v_add_f32 v224, v224, v226
    v_rcp_f32 v224, v224
    s_nop 0
    v_mov_b32 v226, v224
    s_nop 1
    v_permlane16_swap_b32 v224, v226
    v_mov_b32 v228, v224
    v_mov_b32 v230, v226
    s_nop 0
    v_permlane32_swap_b32 v224, v228
    v_permlane32_swap_b32 v226, v230
    v_pk_mul_f32 v[208:209], v[208:209], v[224:225] op_sel_hi:[1,0]
    v_pk_mul_f32 v[210:211], v[210:211], v[224:225] op_sel_hi:[1,0]
    v_pk_mul_f32 v[212:213], v[212:213], v[224:225] op_sel_hi:[1,0]
    v_pk_mul_f32 v[214:215], v[214:215], v[224:225] op_sel_hi:[1,0]
    v_pk_mul_f32 v[216:217], v[216:217], v[226:227] op_sel_hi:[1,0]
    v_pk_mul_f32 v[218:219], v[218:219], v[226:227] op_sel_hi:[1,0]
    v_pk_mul_f32 v[220:221], v[220:221], v[226:227] op_sel_hi:[1,0]
    v_pk_mul_f32 v[222:223], v[222:223], v[226:227] op_sel_hi:[1,0]
    v_pk_mul_f32 v[40:41], v[40:41], v[228:229] op_sel_hi:[1,0]
    v_pk_mul_f32 v[42:43], v[42:43], v[228:229] op_sel_hi:[1,0]
    s_waitcnt vmcnt(1)
    s_mov_b32 s7, 0
L_hp:
    v_cmp_ne_u32 vcc, s58, v34
    s_nop 0
    s_cmp_eq_u64 vcc, 0
    s_cbranch_scc1 L_hp_ok
    s_add_u32 s7, s7, 1
    s_cmp_ge_u32 s7, 0x20000
    s_cbranch_scc1 L_hp_ok
    s_sleep 1
    buffer_load_dword v34, v39, s[24:27], s34 offen offset:0 sc1
    s_waitcnt vmcnt(0)
    s_branch L_hp
L_hp_ok:
    buffer_load_dwordx4 v[128:131], v2, s[20:23], s75 offen sc1
    v_pk_mul_f32 v[44:45], v[44:45], v[228:229] op_sel_hi:[1,0]
    v_pk_mul_f32 v[46:47], v[46:47], v[228:229] op_sel_hi:[1,0]
    v_pk_mul_f32 v[48:49], v[48:49], v[230:231] op_sel_hi:[1,0]
    buffer_load_dwordx4 v[132:135], v2, s[20:23], s75 offen offset:1024 sc1
    s_add_u32 s75, s75, 0x2000
    v_pk_mul_f32 v[50:51], v[50:51], v[230:231] op_sel_hi:[1,0]
    v_pk_mul_f32 v[52:53], v[52:53], v[230:231] op_sel_hi:[1,0]
    v_pk_mul_f32 v[54:55], v[54:55], v[230:231] op_sel_hi:[1,0]
    buffer_load_dwordx4 v[136:139], v2, s[20:23], s75 offen sc1
    v_cvt_pk_bf16_f32 v56, v208, v209
    v_cvt_pk_bf16_f32 v57, v210, v211
    v_cvt_pk_bf16_f32 v58, v212, v213
    buffer_load_dwordx4 v[140:143], v2, s[20:23], s75 offen offset:1024 sc1
    s_add_u32 s75, s75, 0x2000
    v_cvt_pk_bf16_f32 v59, v214, v215
    v_cvt_pk_bf16_f32 v64, v216, v217
    v_cvt_pk_bf16_f32 v65, v218, v219
    buffer_load_dwordx4 v[144:147], v2, s[20:23], s75 offen sc1
    v_cvt_pk_bf16_f32 v66, v220, v221
    v_cvt_pk_bf16_f32 v67, v222, v223
    v_cvt_pk_bf16_f32 v60, v40, v41
    buffer_load_dwordx4 v[148:151], v2, s[20:23], s75 offen offset:1024 sc1
    s_add_u32 s75, s75, 0x2000
    v_cvt_pk_bf16_f32 v61, v42, v43
    v_cvt_pk_bf16_f32 v62, v44, v45
    v_cvt_pk_bf16_f32 v63, v46, v47
    buffer_load_dwordx4 v[152:155], v2, s[20:23], s75 offen sc1
    v_cvt_pk_bf16_f32 v68, v48, v49
    v_cvt_pk_bf16_f32 v69, v50, v51
    v_cvt_pk_bf16_f32 v70, v52, v53
    buffer_load_dwordx4 v[156:159], v2, s[20:23], s75 offen offset:1024 sc1
    s_add_u32 s75, s75, 0x2000
    v_cvt_pk_bf16_f32 v71, v54, v55
    s_lshl_b32 s3, s63, 10
    s_add_u32 s3, s3, 2490368
    v_lshrrev_b32 v12, 3, v1
    buffer_load_dwordx4 v[160:163], v2, s[20:23], s75 offen sc1
    v_and_b32 v13, 7, v1
    v_lshlrev_b32 v13, 2, v13
    v_lshl_add_u32 v32, v12, 7, v13
    buffer_load_dwordx4 v[164:167], v2, s[20:23], s75 offen offset:1024 sc1
    s_add_u32 s75, s75, 0x2000
    s_lshl_b32 s5, s59, 9
    s_add_u32 s4, s5, s91
    s_lshl_b32 s5, s59, 5
    s_add_u32 s6, s5, s91
    s_add_u32 s6, s6, 8192
    v_mul_u32_u24 v12, 8448, v12
    v_add_u32 v12, v13, v12
    buffer_load_dwordx4 v[168:171], v2, s[20:23], s75 offen sc1
    s_lshr_b32 s5, s59, 1
    s_lshl_b32 s5, s5, 10
    s_and_b32 s30, s59, 1
    s_lshl_b32 s30, s30, 3
    s_add_u32 s5, s5, s30
    s_add_u32 s5, s5, 131072
    v_add_u32 v13, s5, v2
    v_add_u32 v5, 131072, v2
    v_and_b32 v36, 3, v1
    buffer_load_dwordx4 v[172:175], v2, s[20:23], s75 offen offset:1024 sc1
    s_add_u32 s75, s75, 0x2000
    v_and_b32 v37, 4, v1
    v_lshlrev_b32 v36, 1, v36
    v_lshl_add_u32 v36, v37, 2, v36
    s_lshl_b32 s5, s61, 6
    s_lshl_b32 s30, s30, 2
    s_add_u32 s5, s5, s30
    s_and_b32 s30, s59, 2
    s_lshl_b32 s30, s30, 2
    s_add_u32 s5, s5, s30
    s_add_u32 s5, s5, 135168
    v_add_u32 v36, s5, v36
    v_lshrrev_b32 v37, 4, v1
    v_mul_u32_u24 v35, 8192, v37
    v_add_u32 v35, v35, v2
    v_lshlrev_b32 v37, 4, v37
    v_add_u32 v37, 135168, v37
    v_and_b32 v14, 16, v2
    s_mov_b32 s5, 0x3f80
    v_lshlrev_b32 v14, v14, s5
    s_mov_b32 vcc_lo, 0x30003
    s_mov_b32 vcc_hi, vcc_lo
    v_cndmask_b32 v16, 0, v14, vcc
    s_mov_b32 vcc_lo, 0xc000c
    s_mov_b32 vcc_hi, vcc_lo
    v_cndmask_b32 v17, 0, v14, vcc
    s_mov_b32 vcc_lo, 0x300030
    s_mov_b32 vcc_hi, vcc_lo
    v_cndmask_b32 v18, 0, v14, vcc
    s_mov_b32 vcc_lo, 0xc000c0
    s_mov_b32 vcc_hi, vcc_lo
    v_cndmask_b32 v19, 0, v14, vcc
    s_mov_b32 vcc_lo, 0x3000300
    s_mov_b32 vcc_hi, vcc_lo
    v_cndmask_b32 v20, 0, v14, vcc
    s_mov_b32 vcc_lo, 0xc000c00
    s_mov_b32 vcc_hi, vcc_lo
    v_cndmask_b32 v21, 0, v14, vcc
    s_mov_b32 vcc_lo, 0x30003000
    s_mov_b32 vcc_hi, vcc_lo
    v_cndmask_b32 v22, 0, v14, vcc
    s_mov_b32 vcc_lo, 0xc000c000
    s_mov_b32 vcc_hi, vcc_lo
    v_cndmask_b32 v23, 0, v14, vcc
    ds_read_b64_tr_b16 v[96:97], v24 offset:0
    ds_read_b64_tr_b16 v[98:99], v24 offset:4096
    ds_read_b64_tr_b16 v[100:101], v24 offset:8192
    ds_read_b64_tr_b16 v[102:103], v24 offset:12288
    ds_read_b64_tr_b16 v[104:105], v25 offset:0
    ds_read_b64_tr_b16 v[106:107], v25 offset:4096
    ds_read_b64_tr_b16 v[108:109], v25 offset:8192
    ds_read_b64_tr_b16 v[110:111], v25 offset:12288
    s_waitcnt vmcnt(8) lgkmcnt(4)
    v_mfma_f32_16x16x32_bf16 v[192:195], v[96:99], v[128:131], 0
    s_setprio 2
    ds_read_b64_tr_b16 v[112:113], v26 offset:0
    v_mfma_f32_16x16x32_bf16 v[192:195], v[100:103], v[136:139], v[192:195]
    s_setprio 0
    ds_read_b64_tr_b16 v[114:115], v26 offset:4096
    v_mfma_f32_16x16x32_bf16 v[196:199], v[100:103], v[140:143], 0
    s_setprio 2
    ds_read_b64_tr_b16 v[116:117], v26 offset:8192
    v_mfma_f32_16x16x32_bf16 v[196:199], v[96:99], v[132:135], v[196:199]
    s_setprio 0
    ds_read_b64_tr_b16 v[118:119], v26 offset:12288
    buffer_load_dwordx4 v[176:179], v2, s[20:23], s75 offen sc1
    s_waitcnt lgkmcnt(4)
    v_mfma_f32_16x16x32_bf16 v[204:207], v[104:107], v[132:135], 0
    s_setprio 2
    ds_read_b64_tr_b16 v[120:121], v27 offset:0
    v_mfma_f32_16x16x32_bf16 v[204:207], v[108:111], v[140:143], v[204:207]
    s_setprio 0
    ds_read_b64_tr_b16 v[122:123], v27 offset:4096
    s_add_u32 m0, s95, 65536
    v_mfma_f32_16x16x32_bf16 v[200:203], v[108:111], v[136:139], 0
    s_setprio 2
    ds_read_b64_tr_b16 v[124:125], v27 offset:8192
    v_mfma_f32_16x16x32_bf16 v[200:203], v[104:107], v[128:131], v[200:203]
    s_setprio 0
    ds_read_b64_tr_b16 v[126:127], v27 offset:12288
    buffer_load_dwordx4 v6, s[12:15], s74 offen  lds
    s_waitcnt lgkmcnt(4)
    v_mfma_f32_16x16x32_bf16 v[208:211], v[112:115], v[128:131], 0
    s_setprio 2
    ds_read_b64_tr_b16 v[96:97], v28 offset:0
    v_mfma_f32_16x16x32_bf16 v[208:211], v[116:119], v[136:139], v[208:211]
    s_setprio 0
    ds_read_b64_tr_b16 v[98:99], v28 offset:4096
    v_mfma_f32_16x16x32_bf16 v[212:215], v[116:119], v[140:143], 0
    s_setprio 2
    ds_read_b64_tr_b16 v[100:101], v28 offset:8192
    v_mfma_f32_16x16x32_bf16 v[212:215], v[112:115], v[132:135], v[212:215]
    s_setprio 0
    ds_read_b64_tr_b16 v[102:103], v28 offset:12288
    buffer_load_dwordx4 v[180:183], v2, s[20:23], s75 offen offset:1024 sc1
    s_add_u32 s75, s75, 0x2000
    s_waitcnt lgkmcnt(4)
    v_mfma_f32_16x16x32_bf16 v[220:223], v[120:123], v[132:135], 0
    s_setprio 2
    ds_read_b64_tr_b16 v[104:105], v29 offset:0
    v_mfma_f32_16x16x32_bf16 v[220:223], v[124:127], v[140:143], v[220:223]
    s_setprio 0
    ds_read_b64_tr_b16 v[106:107], v29 offset:4096
    v_mfma_f32_16x16x32_bf16 v[216:219], v[124:127], v[136:139], 0
    s_setprio 2
    ds_read_b64_tr_b16 v[108:109], v29 offset:8192
    v_mfma_f32_16x16x32_bf16 v[216:219], v[120:123], v[128:131], v[216:219]
    s_setprio 0
    ds_read_b64_tr_b16 v[110:111], v29 offset:12288
    s_waitcnt lgkmcnt(4)
    v_mfma_f32_16x16x32_bf16 v[224:227], v[96:99], v[128:131], 0
    s_setprio 2
    ds_read_b64_tr_b16 v[112:113], v30 offset:0
    v_mfma_f32_16x16x32_bf16 v[224:227], v[100:103], v[136:139], v[224:227]
    s_setprio 0
    ds_read_b64_tr_b16 v[114:115], v30 offset:4096
    v_mfma_f32_16x16x32_bf16 v[228:231], v[100:103], v[140:143], 0
    s_setprio 2
    ds_read_b64_tr_b16 v[116:117], v30 offset:8192
    v_mfma_f32_16x16x32_bf16 v[228:231], v[96:99], v[132:135], v[228:231]
    s_setprio 0
    ds_read_b64_tr_b16 v[118:119], v30 offset:12288
    buffer_load_dwordx4 v[184:187], v2, s[20:23], s75 offen sc1
    s_waitcnt lgkmcnt(4)
    v_mfma_f32_16x16x32_bf16 v[236:239], v[104:107], v[132:135], 0
    s_setprio 2
    ds_read_b64_tr_b16 v[120:121], v31 offset:0
    v_mfma_f32_16x16x32_bf16 v[236:239], v[108:111], v[140:143], v[236:239]
    s_setprio 0
    ds_read_b64_tr_b16 v[122:123], v31 offset:4096
    s_add_u32 m0, s95, 65536
    v_mfma_f32_16x16x32_bf16 v[232:235], v[108:111], v[136:139], 0
    s_setprio 2
    ds_read_b64_tr_b16 v[124:125], v31 offset:8192
    v_mfma_f32_16x16x32_bf16 v[232:235], v[104:107], v[128:131], v[232:235]
    s_setprio 0
    ds_read_b64_tr_b16 v[126:127], v31 offset:12288
    buffer_load_dwordx4 v7, s[12:15], s74 offen offset:1024  lds
    s_add_u32 s74, s74, 0x20000
    s_barrier
    s_waitcnt lgkmcnt(4)
    v_mfma_f32_16x16x32_bf16 v[240:243], v[112:115], v[128:131], 0
    s_setprio 2
    ds_read_b64_tr_b16 v[96:97], v24 offset:16384
    v_mfma_f32_16x16x32_bf16 v[240:243], v[116:119], v[136:139], v[240:243]
    s_setprio 0
    ds_read_b64_tr_b16 v[98:99], v24 offset:20480
    v_mfma_f32_16x16x32_bf16 v[244:247], v[116:119], v[140:143], 0
    s_setprio 2
    ds_read_b64_tr_b16 v[100:101], v24 offset:24576
    v_mfma_f32_16x16x32_bf16 v[244:247], v[112:115], v[132:135], v[244:247]
    s_setprio 0
    ds_read_b64_tr_b16 v[102:103], v24 offset:28672
    buffer_load_dwordx4 v[188:191], v2, s[20:23], s75 offen offset:1024 sc1
    s_add_u32 s75, s75, 0x2000
    s_waitcnt vmcnt(10)
    v_swap_b32 v154, v156
    v_swap_b32 v155, v157
    s_waitcnt lgkmcnt(4)
    v_mfma_f32_16x16x32_bf16 v[252:255], v[120:123], v[132:135], 0
    s_setprio 2
    ds_read_b64_tr_b16 v[104:105], v25 offset:16384
    v_mfma_f32_16x16x32_bf16 v[252:255], v[124:127], v[140:143], v[252:255]
    s_setprio 0
    ds_read_b64_tr_b16 v[106:107], v25 offset:20480
    v_mfma_f32_16x16x32_bf16 v[248:251], v[124:127], v[136:139], 0
    s_setprio 2
    ds_read_b64_tr_b16 v[108:109], v25 offset:24576
    v_mfma_f32_16x16x32_bf16 v[248:251], v[120:123], v[128:131], v[248:251]
    s_setprio 0
    ds_read_b64_tr_b16 v[110:111], v25 offset:28672
    s_waitcnt lgkmcnt(4)
    v_mfma_f32_16x16x32_bf16 v[192:195], v[96:99], v[144:147], v[192:195]
    s_setprio 2
    ds_read_b64_tr_b16 v[112:113], v26 offset:16384
    v_mfma_f32_16x16x32_bf16 v[192:195], v[100:103], v[152:155], v[192:195]
    s_setprio 0
    ds_read_b64_tr_b16 v[114:115], v26 offset:20480
    v_mfma_f32_16x16x32_bf16 v[196:199], v[100:103], v[156:159], v[196:199]
    s_setprio 2
    ds_read_b64_tr_b16 v[116:117], v26 offset:24576
    v_mfma_f32_16x16x32_bf16 v[196:199], v[96:99], v[148:151], v[196:199]
    s_setprio 0
    ds_read_b64_tr_b16 v[118:119], v26 offset:28672
    buffer_load_dwordx4 v[128:131], v2, s[20:23], s75 offen sc1
    s_waitcnt lgkmcnt(4)
    v_mfma_f32_16x16x32_bf16 v[204:207], v[104:107], v[148:151], v[204:207]
    s_setprio 2
    ds_read_b64_tr_b16 v[120:121], v27 offset:16384
    v_mfma_f32_16x16x32_bf16 v[204:207], v[108:111], v[156:159], v[204:207]
    s_setprio 0
    ds_read_b64_tr_b16 v[122:123], v27 offset:20480
    s_add_u32 m0, s95, 81920
    v_mfma_f32_16x16x32_bf16 v[200:203], v[108:111], v[152:155], v[200:203]
    s_setprio 2
    ds_read_b64_tr_b16 v[124:125], v27 offset:24576
    v_mfma_f32_16x16x32_bf16 v[200:203], v[104:107], v[144:147], v[200:203]
    s_setprio 0
    ds_read_b64_tr_b16 v[126:127], v27 offset:28672
    buffer_load_dwordx4 v6, s[12:15], s74 offen  lds
    s_waitcnt lgkmcnt(4)
    v_mfma_f32_16x16x32_bf16 v[208:211], v[112:115], v[144:147], v[208:211]
    s_setprio 2
    ds_read_b64_tr_b16 v[96:97], v28 offset:16384
    v_mfma_f32_16x16x32_bf16 v[208:211], v[116:119], v[152:155], v[208:211]
    s_setprio 0
    ds_read_b64_tr_b16 v[98:99], v28 offset:20480
    v_mfma_f32_16x16x32_bf16 v[212:215], v[116:119], v[156:159], v[212:215]
    s_setprio 2
    ds_read_b64_tr_b16 v[100:101], v28 offset:24576
    v_mfma_f32_16x16x32_bf16 v[212:215], v[112:115], v[148:151], v[212:215]
    s_setprio 0
    ds_read_b64_tr_b16 v[102:103], v28 offset:28672
    buffer_load_dwordx4 v[132:135], v2, s[20:23], s75 offen offset:1024 sc1
    s_add_u32 s75, s75, 0x2000
    s_add_u32 m0, s29, 0
    s_waitcnt lgkmcnt(4)
    v_mfma_f32_16x16x32_bf16 v[220:223], v[120:123], v[148:151], v[220:223]
    s_setprio 2
    ds_read_b64_tr_b16 v[104:105], v29 offset:16384
    v_mfma_f32_16x16x32_bf16 v[220:223], v[124:127], v[156:159], v[220:223]
    s_setprio 0
    ds_read_b64_tr_b16 v[106:107], v29 offset:20480
    buffer_load_dwordx4 v0, s[8:11], s93 offen lds
    s_xor_b32 s93, s93, 0x8000
    s_add_u32 m0, s95, 81920
    v_mfma_f32_16x16x32_bf16 v[216:219], v[124:127], v[152:155], v[216:219]
    s_setprio 2
    ds_read_b64_tr_b16 v[108:109], v29 offset:24576
    v_mfma_f32_16x16x32_bf16 v[216:219], v[120:123], v[144:147], v[216:219]
    s_setprio 0
    ds_read_b64_tr_b16 v[110:111], v29 offset:28672
    buffer_load_dwordx4 v7, s[12:15], s74 offen offset:1024  lds
    s_add_u32 s74, s74, 0x20000
    buffer_load_dword v34, v32, s[24:27], s3 offen offset:0 sc1
    s_waitcnt lgkmcnt(4)
    v_mfma_f32_16x16x32_bf16 v[224:227], v[96:99], v[144:147], v[224:227]
    s_setprio 2
    ds_read_b64_tr_b16 v[112:113], v30 offset:16384
    v_mfma_f32_16x16x32_bf16 v[224:227], v[100:103], v[152:155], v[224:227]
    s_setprio 0
    ds_read_b64_tr_b16 v[114:115], v30 offset:20480
    v_mfma_f32_16x16x32_bf16 v[228:231], v[100:103], v[156:159], v[228:231]
    s_setprio 2
    ds_read_b64_tr_b16 v[116:117], v30 offset:24576
    v_mfma_f32_16x16x32_bf16 v[228:231], v[96:99], v[148:151], v[228:231]
    s_setprio 0
    ds_read_b64_tr_b16 v[118:119], v30 offset:28672
    buffer_load_dwordx4 v[136:139], v2, s[20:23], s75 offen sc1
    s_waitcnt lgkmcnt(4)
    v_mfma_f32_16x16x32_bf16 v[236:239], v[104:107], v[148:151], v[236:239]
    s_setprio 2
    ds_read_b64_tr_b16 v[120:121], v31 offset:16384
    v_mfma_f32_16x16x32_bf16 v[236:239], v[108:111], v[156:159], v[236:239]
    s_setprio 0
    ds_read_b64_tr_b16 v[122:123], v31 offset:20480
    s_add_u32 m0, s95, 98304
    v_mfma_f32_16x16x32_bf16 v[232:235], v[108:111], v[152:155], v[232:235]
    s_setprio 2
    ds_read_b64_tr_b16 v[124:125], v31 offset:24576
    v_mfma_f32_16x16x32_bf16 v[232:235], v[104:107], v[144:147], v[232:235]
    s_setprio 0
    ds_read_b64_tr_b16 v[126:127], v31 offset:28672
    buffer_load_dwordx4 v6, s[12:15], s74 offen  lds
    s_barrier
    s_waitcnt lgkmcnt(4)
    v_mfma_f32_16x16x32_bf16 v[240:243], v[112:115], v[144:147], v[240:243]
    s_setprio 2
    ds_read_b64_tr_b16 v[96:97], v24 offset:32768
    v_mfma_f32_16x16x32_bf16 v[240:243], v[116:119], v[152:155], v[240:243]
    s_setprio 0
    ds_read_b64_tr_b16 v[98:99], v24 offset:36864
    v_mfma_f32_16x16x32_bf16 v[244:247], v[116:119], v[156:159], v[244:247]
    s_setprio 2
    ds_read_b64_tr_b16 v[100:101], v24 offset:40960
    v_mfma_f32_16x16x32_bf16 v[244:247], v[112:115], v[148:151], v[244:247]
    s_setprio 0
    ds_read_b64_tr_b16 v[102:103], v24 offset:45056
    buffer_load_dwordx4 v[140:143], v2, s[20:23], s75 offen offset:1024 sc1
    s_add_u32 s75, s75, 0x2000
    s_waitcnt lgkmcnt(4)
    v_mfma_f32_16x16x32_bf16 v[252:255], v[120:123], v[148:151], v[252:255]
    s_setprio 2
    ds_read_b64_tr_b16 v[104:105], v25 offset:32768
    v_mfma_f32_16x16x32_bf16 v[252:255], v[124:127], v[156:159], v[252:255]
    s_setprio 0
    ds_read_b64_tr_b16 v[106:107], v25 offset:36864
    s_add_u32 m0, s95, 98304
    v_mfma_f32_16x16x32_bf16 v[248:251], v[124:127], v[152:155], v[248:251]
    s_setprio 2
    ds_read_b64_tr_b16 v[108:109], v25 offset:40960
    v_mfma_f32_16x16x32_bf16 v[248:251], v[120:123], v[144:147], v[248:251]
    s_setprio 0
    ds_read_b64_tr_b16 v[110:111], v25 offset:45056
    buffer_load_dwordx4 v7, s[12:15], s74 offen offset:1024  lds
    s_add_u32 s74, s74, 0x20000
    s_waitcnt vmcnt(16) lgkmcnt(4)
    v_mfma_f32_16x16x32_bf16 v[192:195], v[96:99], v[160:163], v[192:195]
    s_setprio 2
    ds_read_b64_tr_b16 v[112:113], v26 offset:32768
    v_mfma_f32_16x16x32_bf16 v[192:195], v[100:103], v[168:171], v[192:195]
    s_setprio 0
    ds_read_b64_tr_b16 v[114:115], v26 offset:36864
    s_waitcnt vmcnt(4)
    s_mov_b32 s7, 0
L_kp:
    v_cmp_ne_u32 vcc, s58, v34
    s_nop 0
    s_cmp_eq_u64 vcc, 0
    s_cbranch_scc1 L_kp_ok
    s_add_u32 s7, s7, 1
    s_cmp_ge_u32 s7, 0x20000
    s_cbranch_scc1 L_kp_ok
    s_sleep 1
    buffer_load_dword v34, v32, s[24:27], s3 offen offset:0 sc1
    s_waitcnt vmcnt(0)
    s_branch L_kp
L_kp_ok:
    buffer_load_dwordx4 v[80:83], v35, s[24:27], s4 offen offset:0 sc1
    v_mfma_f32_16x16x32_bf16 v[196:199], v[100:103], v[172:175], v[196:199]
    s_setprio 2
    ds_read_b64_tr_b16 v[116:117], v26 offset:40960
    v_mfma_f32_16x16x32_bf16 v[196:199], v[96:99], v[164:167], v[196:199]
    s_setprio 0
    ds_read_b64_tr_b16 v[118:119], v26 offset:45056
    buffer_load_dwordx4 v[144:147], v2, s[20:23], s75 offen sc1
    s_waitcnt lgkmcnt(4)
    v_mfma_f32_16x16x32_bf16 v[204:207], v[104:107], v[164:167], v[204:207]
    s_setprio 2
    ds_read_b64_tr_b16 v[120:121], v27 offset:32768
    v_mfma_f32_16x16x32_bf16 v[204:207], v[108:111], v[172:175], v[204:207]
    s_setprio 0
    ds_read_b64_tr_b16 v[122:123], v27 offset:36864
    buffer_load_dwordx4 v[84:87], v35, s[24:27], s4 offen offset:256 sc1
    s_add_u32 s4, s4, 33792
    s_add_u32 m0, s95, 114688
    v_mfma_f32_16x16x32_bf16 v[200:203], v[108:111], v[168:171], v[200:203]
    s_setprio 2
    ds_read_b64_tr_b16 v[124:125], v27 offset:40960
    v_mfma_f32_16x16x32_bf16 v[200:203], v[104:107], v[160:163], v[200:203]
    s_setprio 0
    ds_read_b64_tr_b16 v[126:127], v27 offset:45056
    buffer_load_dwordx4 v6, s[12:15], s74 offen  lds
    s_waitcnt lgkmcnt(4)
    v_mfma_f32_16x16x32_bf16 v[208:211], v[112:115], v[160:163], v[208:211]
    s_setprio 2
    ds_read_b64_tr_b16 v[96:97], v28 offset:32768
    v_mfma_f32_16x16x32_bf16 v[208:211], v[116:119], v[168:171], v[208:211]
    s_setprio 0
    ds_read_b64_tr_b16 v[98:99], v28 offset:36864
    v_mfma_f32_16x16x32_bf16 v[212:215], v[116:119], v[172:175], v[212:215]
    s_setprio 2
    ds_read_b64_tr_b16 v[100:101], v28 offset:40960
    v_mfma_f32_16x16x32_bf16 v[212:215], v[112:115], v[164:167], v[212:215]
    s_setprio 0
    ds_read_b64_tr_b16 v[102:103], v28 offset:45056
    buffer_load_dwordx4 v[148:151], v2, s[20:23], s75 offen offset:1024 sc1
    s_add_u32 s75, s75, 0x2000
    buffer_load_dwordx4 v[88:91], v35, s[24:27], s4 offen offset:0 sc1
    s_waitcnt lgkmcnt(4)
    v_mfma_f32_16x16x32_bf16 v[220:223], v[120:123], v[164:167], v[220:223]
    s_setprio 2
    ds_read_b64_tr_b16 v[104:105], v29 offset:32768
    v_mfma_f32_16x16x32_bf16 v[220:223], v[124:127], v[172:175], v[220:223]
    s_setprio 0
    ds_read_b64_tr_b16 v[106:107], v29 offset:36864
    s_add_u32 m0, s95, 114688
    v_mfma_f32_16x16x32_bf16 v[216:219], v[124:127], v[168:171], v[216:219]
    s_setprio 2
    ds_read_b64_tr_b16 v[108:109], v29 offset:40960
    v_mfma_f32_16x16x32_bf16 v[216:219], v[120:123], v[160:163], v[216:219]
    s_setprio 0
    ds_read_b64_tr_b16 v[110:111], v29 offset:45056
    buffer_load_dwordx4 v7, s[12:15], s74 offen offset:1024  lds
    s_add_u32 s74, s74, 0x20000
    buffer_load_dwordx4 v[92:95], v35, s[24:27], s4 offen offset:256 sc1
    buffer_load_dword v14, v12, s[24:27], s6 offen sc1
    s_waitcnt lgkmcnt(4)
    v_mfma_f32_16x16x32_bf16 v[224:227], v[96:99], v[160:163], v[224:227]
    s_setprio 2
    ds_read_b64_tr_b16 v[112:113], v30 offset:32768
    v_mfma_f32_16x16x32_bf16 v[224:227], v[100:103], v[168:171], v[224:227]
    s_setprio 0
    ds_read_b64_tr_b16 v[114:115], v30 offset:36864
    v_mfma_f32_16x16x32_bf16 v[228:231], v[100:103], v[172:175], v[228:231]
    s_setprio 2
    ds_read_b64_tr_b16 v[116:117], v30 offset:40960
    v_mfma_f32_16x16x32_bf16 v[228:231], v[96:99], v[164:167], v[228:231]
    s_setprio 0
    ds_read_b64_tr_b16 v[118:119], v30 offset:45056
    buffer_load_dwordx4 v[152:155], v2, s[20:23], s75 offen sc1
    s_waitcnt lgkmcnt(4)
    v_mfma_f32_16x16x32_bf16 v[236:239], v[104:107], v[164:167], v[236:239]
    s_setprio 2
    ds_read_b64_tr_b16 v[120:121], v31 offset:32768
    v_mfma_f32_16x16x32_bf16 v[236:239], v[108:111], v[172:175], v[236:239]
    s_setprio 0
    ds_read_b64_tr_b16 v[122:123], v31 offset:36864
    s_add_u32 m0, s95, 0
    v_mfma_f32_16x16x32_bf16 v[232:235], v[108:111], v[168:171], v[232:235]
    s_setprio 2
    ds_read_b64_tr_b16 v[124:125], v31 offset:40960
    v_mfma_f32_16x16x32_bf16 v[232:235], v[104:107], v[160:163], v[232:235]
    s_setprio 0
    ds_read_b64_tr_b16 v[126:127], v31 offset:45056
    buffer_load_dwordx4 v6, s[12:15], s74 offen  lds
    s_barrier
    s_waitcnt lgkmcnt(4)
    v_mfma_f32_16x16x32_bf16 v[240:243], v[112:115], v[160:163], v[240:243]
    s_setprio 2
    ds_read_b64_tr_b16 v[96:97], v24 offset:49152
    v_mfma_f32_16x16x32_bf16 v[240:243], v[116:119], v[168:171], v[240:243]
    s_setprio 0
    ds_read_b64_tr_b16 v[98:99], v24 offset:53248
    v_mfma_f32_16x16x32_bf16 v[244:247], v[116:119], v[172:175], v[244:247]
    s_setprio 2
    ds_read_b64_tr_b16 v[100:101], v24 offset:57344
    v_mfma_f32_16x16x32_bf16 v[244:247], v[112:115], v[164:167], v[244:247]
    s_setprio 0
    ds_read_b64_tr_b16 v[102:103], v24 offset:61440
    buffer_load_dwordx4 v[156:159], v2, s[20:23], s75 offen offset:1024 sc1
    s_add_u32 s75, s75, 0x2000
    s_waitcnt lgkmcnt(4)
    v_mfma_f32_16x16x32_bf16 v[252:255], v[120:123], v[164:167], v[252:255]
    s_setprio 2
    ds_read_b64_tr_b16 v[104:105], v25 offset:49152
    v_mfma_f32_16x16x32_bf16 v[252:255], v[124:127], v[172:175], v[252:255]
    s_setprio 0
    ds_read_b64_tr_b16 v[106:107], v25 offset:53248
    s_add_u32 m0, s95, 0
    v_mfma_f32_16x16x32_bf16 v[248:251], v[124:127], v[168:171], v[248:251]
    s_setprio 2
    ds_read_b64_tr_b16 v[108:109], v25 offset:57344
    v_mfma_f32_16x16x32_bf16 v[248:251], v[120:123], v[160:163], v[248:251]
    s_setprio 0
    ds_read_b64_tr_b16 v[110:111], v25 offset:61440
    buffer_load_dwordx4 v7, s[12:15], s74 offen offset:1024  lds
    s_add_u32 s74, s74, 0x20000
    s_waitcnt lgkmcnt(4)
    v_mfma_f32_16x16x32_bf16 v[192:195], v[96:99], v[176:179], v[192:195]
    s_setprio 2
    ds_read_b64_tr_b16 v[112:113], v26 offset:49152
    v_mfma_f32_16x16x32_bf16 v[192:195], v[100:103], v[184:187], v[192:195]
    s_setprio 0
    ds_read_b64_tr_b16 v[114:115], v26 offset:53248
    v_mfma_f32_16x16x32_bf16 v[196:199], v[100:103], v[188:191], v[196:199]
    s_setprio 2
    ds_read_b64_tr_b16 v[116:117], v26 offset:57344
    v_mfma_f32_16x16x32_bf16 v[196:199], v[96:99], v[180:183], v[196:199]
    s_setprio 0
    ds_read_b64_tr_b16 v[118:119], v26 offset:61440
    buffer_load_dwordx4 v[160:163], v2, s[20:23], s75 offen sc1
    s_waitcnt lgkmcnt(4)
    v_mfma_f32_16x16x32_bf16 v[204:207], v[104:107], v[180:183], v[204:207]
    s_setprio 2
    ds_read_b64_tr_b16 v[120:121], v27 offset:49152
    v_mfma_f32_16x16x32_bf16 v[204:207], v[108:111], v[188:191], v[204:207]
    s_setprio 0
    ds_read_b64_tr_b16 v[122:123], v27 offset:53248
    s_add_u32 m0, s95, 16384
    v_mfma_f32_16x16x32_bf16 v[200:203], v[108:111], v[184:187], v[200:203]
    s_setprio 2
    ds_read_b64_tr_b16 v[124:125], v27 offset:57344
    v_mfma_f32_16x16x32_bf16 v[200:203], v[104:107], v[176:179], v[200:203]
    s_setprio 0
    ds_read_b64_tr_b16 v[126:127], v27 offset:61440
    buffer_load_dwordx4 v6, s[12:15], s74 offen  lds
    s_waitcnt lgkmcnt(4)
    v_mfma_f32_16x16x32_bf16 v[208:211], v[112:115], v[176:179], v[208:211]
    s_setprio 2
    ds_read_b64_tr_b16 v[96:97], v28 offset:49152
    v_mfma_f32_16x16x32_bf16 v[208:211], v[116:119], v[184:187], v[208:211]
    s_setprio 0
    ds_read_b64_tr_b16 v[98:99], v28 offset:53248
    v_mfma_f32_16x16x32_bf16 v[212:215], v[116:119], v[188:191], v[212:215]
    s_setprio 2
    ds_read_b64_tr_b16 v[100:101], v28 offset:57344
    v_mfma_f32_16x16x32_bf16 v[212:215], v[112:115], v[180:183], v[212:215]
    s_setprio 0
    ds_read_b64_tr_b16 v[102:103], v28 offset:61440
    buffer_load_dwordx4 v[164:167], v2, s[20:23], s75 offen offset:1024 sc1
    s_add_u32 s75, s75, 0x2000
    s_waitcnt lgkmcnt(4)
    v_mfma_f32_16x16x32_bf16 v[220:223], v[120:123], v[180:183], v[220:223]
    s_setprio 2
    ds_read_b64_tr_b16 v[104:105], v29 offset:49152
    v_mfma_f32_16x16x32_bf16 v[220:223], v[124:127], v[188:191], v[220:223]
    s_setprio 0
    ds_read_b64_tr_b16 v[106:107], v29 offset:53248
    s_waitcnt vmcnt(7)
    v_mfma_f32_16x16x32_bf16 v[8:11], v[16:19], v[80:83], 0
    v_mfma_f32_16x16x32_bf16 v[8:11], v[20:23], v[84:87], v[8:11]
    v_add_f32_dpp v14, v14, v14 row_ror:8 row_mask:0xf bank_mask:0xf
    v_mov_b32 v15, v14
    v_mfma_f32_16x16x32_bf16 v[216:219], v[124:127], v[184:187], v[216:219]
    s_setprio 2
    ds_read_b64_tr_b16 v[108:109], v29 offset:57344
    v_mfma_f32_16x16x32_bf16 v[216:219], v[120:123], v[176:179], v[216:219]
    s_setprio 0
    ds_read_b64_tr_b16 v[110:111], v29 offset:61440
    v_mfma_f32_16x16x32_bf16 v[8:11], v[16:19], v[88:91], v[8:11]
    v_mfma_f32_16x16x32_bf16 v[8:11], v[20:23], v[92:95], v[8:11]
    v_permlane16_swap_b32 v14, v15
    v_add_f32 v14, v14, v15
    v_mov_b32 v15, v14
    s_waitcnt lgkmcnt(4)
    v_mfma_f32_16x16x32_bf16 v[224:227], v[96:99], v[176:179], v[224:227]
    s_setprio 2
    ds_read_b64_tr_b16 v[112:113], v30 offset:49152
    v_mfma_f32_16x16x32_bf16 v[224:227], v[100:103], v[184:187], v[224:227]
    s_setprio 0
    ds_read_b64_tr_b16 v[114:115], v30 offset:53248
    v_permlane32_swap_b32 v14, v15
    v_add_f32 v14, v14, v15
    v_cvt_pk_bf16_f32 v14, v14, v14
    ds_write_b16 v36, v14
    v_mfma_f32_16x16x32_bf16 v[228:231], v[100:103], v[188:191], v[228:231]
    s_setprio 2
    ds_read_b64_tr_b16 v[116:117], v30 offset:57344
    v_mfma_f32_16x16x32_bf16 v[228:231], v[96:99], v[180:183], v[228:231]
    s_setprio 0
    ds_read_b64_tr_b16 v[118:119], v30 offset:61440
    buffer_load_dwordx4 v[168:171], v2, s[20:23], s75 offen sc1
    v_cvt_pk_bf16_f32 v8, v8, v9
    v_cvt_pk_bf16_f32 v9, v10, v11
    ds_write_b64 v13, v[8:9]
    s_waitcnt lgkmcnt(6)
    v_mfma_f32_16x16x32_bf16 v[236:239], v[104:107], v[180:183], v[236:239]
    s_setprio 2
    ds_read_b64_tr_b16 v[120:121], v31 offset:49152
    v_mfma_f32_16x16x32_bf16 v[236:239], v[108:111], v[188:191], v[236:239]
    s_setprio 0
    ds_read_b64_tr_b16 v[122:123], v31 offset:53248
    s_add_u32 m0, s95, 16384
    v_mfma_f32_16x16x32_bf16 v[232:235], v[108:111], v[184:187], v[232:235]
    s_setprio 2
    ds_read_b64_tr_b16 v[124:125], v31 offset:57344
    v_mfma_f32_16x16x32_bf16 v[232:235], v[104:107], v[176:179], v[232:235]
    s_setprio 0
    ds_read_b64_tr_b16 v[126:127], v31 offset:61440
    buffer_load_dwordx4 v7, s[12:15], s74 offen offset:1024  lds
    s_add_u32 s74, s74, 0x20000
    s_waitcnt lgkmcnt(4)
    s_barrier
    v_mfma_f32_16x16x32_bf16 v[240:243], v[112:115], v[176:179], v[240:243]
    s_setprio 2
    v_xor_b32 v24, 0x10000, v24
    ds_read_b64_tr_b16 v[96:97], v24 offset:0
    v_mfma_f32_16x16x32_bf16 v[240:243], v[116:119], v[184:187], v[240:243]
    s_setprio 0
    ds_read_b64_tr_b16 v[98:99], v24 offset:4096
    v_mfma_f32_16x16x32_bf16 v[244:247], v[116:119], v[188:191], v[244:247]
    s_setprio 2
    ds_read_b64_tr_b16 v[100:101], v24 offset:8192
    v_mfma_f32_16x16x32_bf16 v[244:247], v[112:115], v[180:183], v[244:247]
    s_setprio 0
    ds_read_b64_tr_b16 v[102:103], v24 offset:12288
    buffer_load_dwordx4 v[172:175], v2, s[20:23], s75 offen offset:1024 sc1
    s_add_u32 s75, s75, 0x2000
    s_waitcnt lgkmcnt(4)
    v_mfma_f32_16x16x32_bf16 v[252:255], v[120:123], v[180:183], v[252:255]
    s_setprio 2
    v_xor_b32 v25, 0x10000, v25
    ds_read_b64_tr_b16 v[104:105], v25 offset:0
    v_mfma_f32_16x16x32_bf16 v[252:255], v[124:127], v[188:191], v[252:255]
    s_setprio 0
    ds_read_b64_tr_b16 v[106:107], v25 offset:4096
    v_mfma_f32_16x16x32_bf16 v[248:251], v[124:127], v[184:187], v[248:251]
    s_setprio 2
    ds_read_b64_tr_b16 v[108:109], v25 offset:8192
    v_mfma_f32_16x16x32_bf16 v[248:251], v[120:123], v[176:179], v[248:251]
    s_setprio 0
    ds_read_b64_tr_b16 v[110:111], v25 offset:12288
    s_waitcnt lgkmcnt(4)
    v_mfma_f32_16x16x32_bf16 v[192:195], v[96:99], v[128:131], v[192:195]
    s_setprio 2
    v_xor_b32 v26, 0x10000, v26
    ds_read_b64_tr_b16 v[112:113], v26 offset:0
    v_mfma_f32_16x16x32_bf16 v[192:195], v[100:103], v[136:139], v[192:195]
    s_setprio 0
    ds_read_b64_tr_b16 v[114:115], v26 offset:4096
    ds_read_b128 v[72:75], v37 offset:0
    ds_read_b128 v[40:43], v5 offset:0
    v_mfma_f32_16x16x32_bf16 v[196:199], v[100:103], v[140:143], v[196:199]
    s_setprio 2
    ds_read_b64_tr_b16 v[116:117], v26 offset:8192
    v_mfma_f32_16x16x32_bf16 v[196:199], v[96:99], v[132:135], v[196:199]
    s_setprio 0
    ds_read_b64_tr_b16 v[118:119], v26 offset:12288
    buffer_load_dwordx4 v[176:179], v2, s[20:23], s75 offen sc1
    ds_read_b128 v[76:79], v37 offset:64
    ds_read_b128 v[44:47], v5 offset:1024
    s_waitcnt lgkmcnt(8)
    v_mfma_f32_16x16x32_bf16 v[204:207], v[104:107], v[132:135], v[204:207]
    s_setprio 2
    v_xor_b32 v27, 0x10000, v27
    ds_read_b64_tr_b16 v[120:121], v27 offset:0
    v_mfma_f32_16x16x32_bf16 v[204:207], v[108:111], v[140:143], v[204:207]
    s_setprio 0
    ds_read_b64_tr_b16 v[122:123], v27 offset:4096
    ds_read_b128 v[48:51], v5 offset:2048
    s_add_u32 m0, s95, 32768
    v_mfma_f32_16x16x32_bf16 v[200:203], v[108:111], v[136:139], v[200:203]
    s_setprio 2
    ds_read_b64_tr_b16 v[124:125], v27 offset:8192
    v_mfma_f32_16x16x32_bf16 v[200:203], v[104:107], v[128:131], v[200:203]
    s_setprio 0
    ds_read_b64_tr_b16 v[126:127], v27 offset:12288
    buffer_load_dwordx4 v6, s[12:15], s74 offen  lds
    ds_read_b128 v[52:55], v5 offset:3072
    s_waitcnt lgkmcnt(7)
    v_mfma_f32_16x16x32_bf16 v[16:19], v[72:75], v[56:59], 0
    v_mfma_f32_16x16x32_bf16 v[20:23], v[72:75], v[64:67], 0
    v_mfma_f32_16x16x32_bf16 v[208:211], v[112:115], v[128:131], v[208:211]
    s_setprio 2
    v_xor_b32 v28, 0x10000, v28
    ds_read_b64_tr_b16 v[96:97], v28 offset:0
    v_mfma_f32_16x16x32_bf16 v[208:211], v[116:119], v[136:139], v[208:211]
    s_setprio 0
    ds_read_b64_tr_b16 v[98:99], v28 offset:4096
    v_mfma_f32_16x16x32_bf16 v[16:19], v[76:79], v[60:63], v[16:19]
    v_mfma_f32_16x16x32_bf16 v[20:23], v[76:79], v[68:71], v[20:23]
    v_mfma_f32_16x16x32_bf16 v[212:215], v[116:119], v[140:143], v[212:215]
    s_setprio 2
    ds_read_b64_tr_b16 v[100:101], v28 offset:8192
    v_mfma_f32_16x16x32_bf16 v[212:215], v[112:115], v[132:135], v[212:215]
    s_setprio 0
    ds_read_b64_tr_b16 v[102:103], v28 offset:12288
    buffer_load_dwordx4 v[180:183], v2, s[20:23], s75 offen offset:1024 sc1
    s_add_u32 s75, s75, 0x2000
    v_mfma_f32_16x16x32_bf16 v[80:83], v[40:43], v[56:59], 0
    v_mfma_f32_16x16x32_bf16 v[88:91], v[40:43], v[64:67], 0
    s_add_u32 m0, s29, 1024
    s_waitcnt lgkmcnt(5)
    v_mfma_f32_16x16x32_bf16 v[220:223], v[120:123], v[132:135], v[220:223]
    s_setprio 2
    v_xor_b32 v29, 0x10000, v29
    ds_read_b64_tr_b16 v[104:105], v29 offset:0
    v_mfma_f32_16x16x32_bf16 v[220:223], v[124:127], v[140:143], v[220:223]
    s_setprio 0
    ds_read_b64_tr_b16 v[106:107], v29 offset:4096
    v_mfma_f32_16x16x32_bf16 v[80:83], v[44:47], v[60:63], v[80:83]
    v_mfma_f32_16x16x32_bf16 v[88:91], v[44:47], v[68:71], v[88:91]
    buffer_load_dwordx4 v0, s[8:11], s93 offen lds
    s_xor_b32 s93, s93, 0x8000
    v_mfma_f32_16x16x32_bf16 v[216:219], v[124:127], v[136:139], v[216:219]
    s_setprio 2
    ds_read_b64_tr_b16 v[108:109], v29 offset:8192
    v_mfma_f32_16x16x32_bf16 v[216:219], v[120:123], v[128:131], v[216:219]
    s_setprio 0
    ds_read_b64_tr_b16 v[110:111], v29 offset:12288
    v_mfma_f32_16x16x32_bf16 v[84:87], v[48:51], v[56:59], 0
    v_mfma_f32_16x16x32_bf16 v[92:95], v[48:51], v[64:67], 0
    v_add_f32 v16, 0x358637bd, v16
    v_add_f32 v20, 0x358637bd, v20
    s_waitcnt lgkmcnt(4)
    v_mfma_f32_16x16x32_bf16 v[224:227], v[96:99], v[128:131], v[224:227]
    s_setprio 2
    v_xor_b32 v30, 0x10000, v30
    ds_read_b64_tr_b16 v[112:113], v30 offset:0
    v_mfma_f32_16x16x32_bf16 v[224:227], v[100:103], v[136:139], v[224:227]
    s_setprio 0
    ds_read_b64_tr_b16 v[114:115], v30 offset:4096
    v_mfma_f32_16x16x32_bf16 v[84:87], v[52:55], v[60:63], v[84:87]
    v_mfma_f32_16x16x32_bf16 v[92:95], v[52:55], v[68:71], v[92:95]
    v_rcp_f32 v16, v16
    v_rcp_f32 v20, v20
    v_mfma_f32_16x16x32_bf16 v[228:231], v[100:103], v[140:143], v[228:231]
    s_setprio 2
    ds_read_b64_tr_b16 v[116:117], v30 offset:8192
    v_mfma_f32_16x16x32_bf16 v[228:231], v[96:99], v[132:135], v[228:231]
    s_setprio 0
    ds_read_b64_tr_b16 v[118:119], v30 offset:12288
    buffer_load_dwordx4 v[184:187], v2, s[20:23], s75 offen sc1
    s_lshl_b32 s30, s62, 1
    s_lshr_b32 s5, s60, 1
    s_add_u32 s30, s30, s5
    s_mul_i32 s3, s30, 1179648
    s_add_u32 s5, s63, 112
    s_lshl_b32 s5, s5, 13
    s_add_u32 s3, s3, s5
    s_lshl_b32 s30, s60, 1
    s_add_u32 s30, s30, s61
    s_and_b32 s5, s30, 3
    s_lshl_b32 s5, s5, 11
    s_add_u32 s3, s3, s5
    s_andn2_b32 s4, s89, 28
    s_lshl_b32 s30, s30, 2
    s_add_u32 s4, s4, s30
    s_add_u32 s4, s4, 393216
    s_waitcnt lgkmcnt(4)
    v_mfma_f32_16x16x32_bf16 v[236:239], v[104:107], v[132:135], v[236:239]
    s_setprio 2
    v_xor_b32 v31, 0x10000, v31
    ds_read_b64_tr_b16 v[120:121], v31 offset:0
    v_mfma_f32_16x16x32_bf16 v[236:239], v[108:111], v[140:143], v[236:239]
    s_setprio 0
    ds_read_b64_tr_b16 v[122:123], v31 offset:4096
    v_mul_f32 v80, v80, v16
    v_mul_f32 v81, v81, v16
    v_mul_f32 v82, v82, v16
    v_mul_f32 v83, v83, v16
    s_add_u32 m0, s95, 32768
    v_mfma_f32_16x16x32_bf16 v[232:235], v[108:111], v[136:139], v[232:235]
    s_setprio 2
    ds_read_b64_tr_b16 v[124:125], v31 offset:8192
    v_mfma_f32_16x16x32_bf16 v[232:235], v[104:107], v[128:131], v[232:235]
    s_setprio 0
    ds_read_b64_tr_b16 v[126:127], v31 offset:12288
    buffer_load_dwordx4 v7, s[12:15], s74 offen offset:1024  lds
    s_add_u32 s74, s74, 0x20000
    v_mul_f32 v84, v84, v16
    v_mul_f32 v85, v85, v16
    v_mul_f32 v86, v86, v16
    s_barrier
    s_waitcnt lgkmcnt(4)
    v_mfma_f32_16x16x32_bf16 v[240:243], v[112:115], v[128:131], v[240:243]
    s_setprio 2
    ds_read_b64_tr_b16 v[96:97], v24 offset:16384
    v_mfma_f32_16x16x32_bf16 v[240:243], v[116:119], v[136:139], v[240:243]
    s_setprio 0
    ds_read_b64_tr_b16 v[98:99], v24 offset:20480
    v_mul_f32 v87, v87, v16
    v_cvt_pk_bf16_f32 v40, v80, v81
    v_cvt_pk_bf16_f32 v41, v82, v83
    v_cvt_pk_bf16_f32 v42, v84, v85
    v_mfma_f32_16x16x32_bf16 v[244:247], v[116:119], v[140:143], v[244:247]
    s_setprio 2
    ds_read_b64_tr_b16 v[100:101], v24 offset:24576
    v_mfma_f32_16x16x32_bf16 v[244:247], v[112:115], v[132:135], v[244:247]
    s_setprio 0
    ds_read_b64_tr_b16 v[102:103], v24 offset:28672
    buffer_load_dwordx4 v[188:191], v2, s[20:23], s75 offen offset:1024 sc1
    s_add_u32 s75, s75, 0x2000
    v_swap_b32 v146, v148
    v_swap_b32 v147, v149
    v_cvt_pk_bf16_f32 v43, v86, v87
    buffer_store_dwordx4 v[40:43], v2, s[20:23], s3 offen offset:0 sc1
    s_waitcnt lgkmcnt(4)
    v_mfma_f32_16x16x32_bf16 v[252:255], v[120:123], v[132:135], v[252:255]
    s_setprio 2
    ds_read_b64_tr_b16 v[104:105], v25 offset:16384
    v_mfma_f32_16x16x32_bf16 v[252:255], v[124:127], v[140:143], v[252:255]
    s_setprio 0
    ds_read_b64_tr_b16 v[106:107], v25 offset:20480
    v_mul_f32 v88, v88, v20
    v_mul_f32 v89, v89, v20
    v_mul_f32 v90, v90, v20
    v_mul_f32 v91, v91, v20
    v_mfma_f32_16x16x32_bf16 v[248:251], v[124:127], v[136:139], v[248:251]
    s_setprio 2
    ds_read_b64_tr_b16 v[108:109], v25 offset:24576
    v_mfma_f32_16x16x32_bf16 v[248:251], v[120:123], v[128:131], v[248:251]
    s_setprio 0
    ds_read_b64_tr_b16 v[110:111], v25 offset:28672
    v_mul_f32 v92, v92, v20
    v_mul_f32 v93, v93, v20
    v_mul_f32 v94, v94, v20
    s_waitcnt vmcnt(15) lgkmcnt(4)
    v_mfma_f32_16x16x32_bf16 v[192:195], v[96:99], v[144:147], v[192:195]
    s_setprio 2
    ds_read_b64_tr_b16 v[112:113], v26 offset:16384
    v_mfma_f32_16x16x32_bf16 v[192:195], v[100:103], v[152:155], v[192:195]
    s_setprio 0
    ds_read_b64_tr_b16 v[114:115], v26 offset:20480
    v_mul_f32 v95, v95, v20
    v_cvt_pk_bf16_f32 v44, v88, v89
    v_cvt_pk_bf16_f32 v45, v90, v91
    v_cvt_pk_bf16_f32 v46, v92, v93
    v_mfma_f32_16x16x32_bf16 v[196:199], v[100:103], v[156:159], v[196:199]
    s_setprio 2
    ds_read_b64_tr_b16 v[116:117], v26 offset:24576
    v_mfma_f32_16x16x32_bf16 v[196:199], v[96:99], v[148:151], v[196:199]
    s_setprio 0
    ds_read_b64_tr_b16 v[118:119], v26 offset:28672
    buffer_load_dwordx4 v[128:131], v2, s[20:23], s75 offen sc1
    v_cvt_pk_bf16_f32 v47, v94, v95
    buffer_store_dwordx4 v[44:47], v2, s[20:23], s3 offen offset:1024 sc1
    s_waitcnt lgkmcnt(4)
    v_mfma_f32_16x16x32_bf16 v[204:207], v[104:107], v[148:151], v[204:207]
    s_setprio 2
    ds_read_b64_tr_b16 v[120:121], v27 offset:16384
    v_mfma_f32_16x16x32_bf16 v[204:207], v[108:111], v[156:159], v[204:207]
    s_setprio 0
    ds_read_b64_tr_b16 v[122:123], v27 offset:20480
    s_add_u32 m0, s95, 49152
    v_mfma_f32_16x16x32_bf16 v[200:203], v[108:111], v[152:155], v[200:203]
    s_setprio 2
    ds_read_b64_tr_b16 v[124:125], v27 offset:24576
    v_mfma_f32_16x16x32_bf16 v[200:203], v[104:107], v[144:147], v[200:203]
    s_setprio 0
    ds_read_b64_tr_b16 v[126:127], v27 offset:28672
    buffer_load_dwordx4 v6, s[12:15], s74 offen  lds
    s_waitcnt lgkmcnt(4)
    v_mfma_f32_16x16x32_bf16 v[208:211], v[112:115], v[144:147], v[208:211]
    s_setprio 2
    ds_read_b64_tr_b16 v[96:97], v28 offset:16384
    v_mfma_f32_16x16x32_bf16 v[208:211], v[116:119], v[152:155], v[208:211]
    s_setprio 0
    ds_read_b64_tr_b16 v[98:99], v28 offset:20480
    v_mfma_f32_16x16x32_bf16 v[212:215], v[116:119], v[156:159], v[212:215]
    s_setprio 2
    ds_read_b64_tr_b16 v[100:101], v28 offset:24576
    v_mfma_f32_16x16x32_bf16 v[212:215], v[112:115], v[148:151], v[212:215]
    s_setprio 0
    ds_read_b64_tr_b16 v[102:103], v28 offset:28672
    buffer_load_dwordx4 v[132:135], v2, s[20:23], s75 offen offset:1024 sc1
    s_add_u32 s75, s75, 0x2000
    s_waitcnt lgkmcnt(4)
    v_mfma_f32_16x16x32_bf16 v[220:223], v[120:123], v[148:151], v[220:223]
    s_setprio 2
    ds_read_b64_tr_b16 v[104:105], v29 offset:16384
    v_mfma_f32_16x16x32_bf16 v[220:223], v[124:127], v[156:159], v[220:223]
    s_setprio 0
    ds_read_b64_tr_b16 v[106:107], v29 offset:20480
    v_mfma_f32_16x16x32_bf16 v[216:219], v[124:127], v[152:155], v[216:219]
    s_setprio 2
    ds_read_b64_tr_b16 v[108:109], v29 offset:24576
    v_mfma_f32_16x16x32_bf16 v[216:219], v[120:123], v[144:147], v[216:219]
    s_setprio 0
    ds_read_b64_tr_b16 v[110:111], v29 offset:28672
    s_waitcnt lgkmcnt(4)
    v_mfma_f32_16x16x32_bf16 v[224:227], v[96:99], v[144:147], v[224:227]
    s_setprio 2
    ds_read_b64_tr_b16 v[112:113], v30 offset:16384
    v_mfma_f32_16x16x32_bf16 v[224:227], v[100:103], v[152:155], v[224:227]
    s_setprio 0
    ds_read_b64_tr_b16 v[114:115], v30 offset:20480
    v_mfma_f32_16x16x32_bf16 v[228:231], v[100:103], v[156:159], v[228:231]
    s_setprio 2
    ds_read_b64_tr_b16 v[116:117], v30 offset:24576
    v_mfma_f32_16x16x32_bf16 v[228:231], v[96:99], v[148:151], v[228:231]
    s_setprio 0
    ds_read_b64_tr_b16 v[118:119], v30 offset:28672
    buffer_load_dwordx4 v[136:139], v2, s[20:23], s75 offen sc1
    s_waitcnt lgkmcnt(4)
    v_mfma_f32_16x16x32_bf16 v[236:239], v[104:107], v[148:151], v[236:239]
    s_setprio 2
    ds_read_b64_tr_b16 v[120:121], v31 offset:16384
    v_mfma_f32_16x16x32_bf16 v[236:239], v[108:111], v[156:159], v[236:239]
    s_setprio 0
    ds_read_b64_tr_b16 v[122:123], v31 offset:20480
    s_add_u32 m0, s95, 49152
    v_mfma_f32_16x16x32_bf16 v[232:235], v[108:111], v[152:155], v[232:235]
    s_setprio 2
    ds_read_b64_tr_b16 v[124:125], v31 offset:24576
    v_mfma_f32_16x16x32_bf16 v[232:235], v[104:107], v[144:147], v[232:235]
    s_setprio 0
    ds_read_b64_tr_b16 v[126:127], v31 offset:28672
    buffer_load_dwordx4 v7, s[12:15], s74 offen offset:1024  lds
    s_add_u32 s74, s74, 0x20000
    s_barrier
    s_waitcnt lgkmcnt(4)
    v_mfma_f32_16x16x32_bf16 v[240:243], v[112:115], v[144:147], v[240:243]
    s_setprio 2
    ds_read_b64_tr_b16 v[96:97], v24 offset:32768
    v_mfma_f32_16x16x32_bf16 v[240:243], v[116:119], v[152:155], v[240:243]
    s_setprio 0
    ds_read_b64_tr_b16 v[98:99], v24 offset:36864
    v_mfma_f32_16x16x32_bf16 v[244:247], v[116:119], v[156:159], v[244:247]
    s_setprio 2
    ds_read_b64_tr_b16 v[100:101], v24 offset:40960
    v_mfma_f32_16x16x32_bf16 v[244:247], v[112:115], v[148:151], v[244:247]
    s_setprio 0
    ds_read_b64_tr_b16 v[102:103], v24 offset:45056
    buffer_load_dwordx4 v[140:143], v2, s[20:23], s75 offen offset:1024 sc1
    s_add_u32 s75, s75, 0x2000
    s_waitcnt lgkmcnt(4)
    v_mfma_f32_16x16x32_bf16 v[252:255], v[120:123], v[148:151], v[252:255]
    s_setprio 2
    ds_read_b64_tr_b16 v[104:105], v25 offset:32768
    v_mfma_f32_16x16x32_bf16 v[252:255], v[124:127], v[156:159], v[252:255]
    s_setprio 0
    ds_read_b64_tr_b16 v[106:107], v25 offset:36864
    v_mfma_f32_16x16x32_bf16 v[248:251], v[124:127], v[152:155], v[248:251]
    s_setprio 2
    ds_read_b64_tr_b16 v[108:109], v25 offset:40960
    v_mfma_f32_16x16x32_bf16 v[248:251], v[120:123], v[144:147], v[248:251]
    s_setprio 0
    ds_read_b64_tr_b16 v[110:111], v25 offset:45056
    s_waitcnt vmcnt(15) lgkmcnt(4)
    v_mfma_f32_16x16x32_bf16 v[192:195], v[96:99], v[160:163], v[192:195]
    s_setprio 2
    ds_read_b64_tr_b16 v[112:113], v26 offset:32768
    v_mfma_f32_16x16x32_bf16 v[192:195], v[100:103], v[168:171], v[192:195]
    s_setprio 0
    ds_read_b64_tr_b16 v[114:115], v26 offset:36864
    v_mfma_f32_16x16x32_bf16 v[196:199], v[100:103], v[172:175], v[196:199]
    s_setprio 2
    ds_read_b64_tr_b16 v[116:117], v26 offset:40960
    v_mfma_f32_16x16x32_bf16 v[196:199], v[96:99], v[164:167], v[196:199]
    s_setprio 0
    ds_read_b64_tr_b16 v[118:119], v26 offset:45056
    buffer_load_dwordx4 v[144:147], v2, s[20:23], s75 offen sc1
    s_waitcnt lgkmcnt(4)
    v_mfma_f32_16x16x32_bf16 v[204:207], v[104:107], v[164:167], v[204:207]
    s_setprio 2
    ds_read_b64_tr_b16 v[120:121], v27 offset:32768
    v_mfma_f32_16x16x32_bf16 v[204:207], v[108:111], v[172:175], v[204:207]
    s_setprio 0
    ds_read_b64_tr_b16 v[122:123], v27 offset:36864
    s_add_u32 m0, s95, 65536
    v_mfma_f32_16x16x32_bf16 v[200:203], v[108:111], v[168:171], v[200:203]
    s_setprio 2
    ds_read_b64_tr_b16 v[124:125], v27 offset:40960
    v_mfma_f32_16x16x32_bf16 v[200:203], v[104:107], v[160:163], v[200:203]
    s_setprio 0
    ds_read_b64_tr_b16 v[126:127], v27 offset:45056
    buffer_load_dwordx4 v6, s[12:15], s74 offen  lds
    s_waitcnt lgkmcnt(4)
    v_mfma_f32_16x16x32_bf16 v[208:211], v[112:115], v[160:163], v[208:211]
    s_setprio 2
    ds_read_b64_tr_b16 v[96:97], v28 offset:32768
    v_mfma_f32_16x16x32_bf16 v[208:211], v[116:119], v[168:171], v[208:211]
    s_setprio 0
    ds_read_b64_tr_b16 v[98:99], v28 offset:36864
    v_mfma_f32_16x16x32_bf16 v[212:215], v[116:119], v[172:175], v[212:215]
    s_setprio 2
    ds_read_b64_tr_b16 v[100:101], v28 offset:40960
    v_mfma_f32_16x16x32_bf16 v[212:215], v[112:115], v[164:167], v[212:215]
    s_setprio 0
    ds_read_b64_tr_b16 v[102:103], v28 offset:45056
    buffer_load_dwordx4 v[148:151], v2, s[20:23], s75 offen offset:1024 sc1
    s_add_u32 s75, s75, 0x2000
    s_waitcnt lgkmcnt(4)
    v_mfma_f32_16x16x32_bf16 v[220:223], v[120:123], v[164:167], v[220:223]
    s_setprio 2
    ds_read_b64_tr_b16 v[104:105], v29 offset:32768
    v_mfma_f32_16x16x32_bf16 v[220:223], v[124:127], v[172:175], v[220:223]
    s_setprio 0
    ds_read_b64_tr_b16 v[106:107], v29 offset:36864
    v_mfma_f32_16x16x32_bf16 v[216:219], v[124:127], v[168:171], v[216:219]
    s_setprio 2
    ds_read_b64_tr_b16 v[108:109], v29 offset:40960
    v_mfma_f32_16x16x32_bf16 v[216:219], v[120:123], v[160:163], v[216:219]
    s_setprio 0
    ds_read_b64_tr_b16 v[110:111], v29 offset:45056
    s_waitcnt vmcnt(8)
    s_mov_b64 exec, 1
    buffer_store_dword v33, off, s[24:27], s4 sc1
    s_mov_b64 exec, -1
    s_waitcnt lgkmcnt(4)
    v_mfma_f32_16x16x32_bf16 v[224:227], v[96:99], v[160:163], v[224:227]
    s_setprio 2
    ds_read_b64_tr_b16 v[112:113], v30 offset:32768
    v_mfma_f32_16x16x32_bf16 v[224:227], v[100:103], v[168:171], v[224:227]
    s_setprio 0
    ds_read_b64_tr_b16 v[114:115], v30 offset:36864
    s_mov_b32 s16, s54
    s_mov_b32 s17, s55
    s_and_b32 s17, s17, 0xffff
    s_mov_b32 s18, 0x400000
    s_mov_b32 s19, 0x20000
    v_mfma_f32_16x16x32_bf16 v[228:231], v[100:103], v[172:175], v[228:231]
    s_setprio 2
    ds_read_b64_tr_b16 v[116:117], v30 offset:40960
    v_mfma_f32_16x16x32_bf16 v[228:231], v[96:99], v[164:167], v[228:231]
    s_setprio 0
    ds_read_b64_tr_b16 v[118:119], v30 offset:45056
    buffer_load_dwordx4 v[152:155], v2, s[20:23], s75 offen sc1
    s_waitcnt lgkmcnt(4)
    v_mfma_f32_16x16x32_bf16 v[236:239], v[104:107], v[164:167], v[236:239]
    s_setprio 2
    ds_read_b64_tr_b16 v[120:121], v31 offset:32768
    v_mfma_f32_16x16x32_bf16 v[236:239], v[108:111], v[172:175], v[236:239]
    s_setprio 0
    ds_read_b64_tr_b16 v[122:123], v31 offset:36864
    v_and_b32 v39, 0x380, v39
    s_add_u32 m0, s95, 65536
    v_mfma_f32_16x16x32_bf16 v[232:235], v[108:111], v[168:171], v[232:235]
    s_setprio 2
    ds_read_b64_tr_b16 v[124:125], v31 offset:40960
    v_mfma_f32_16x16x32_bf16 v[232:235], v[104:107], v[160:163], v[232:235]
    s_setprio 0
    ds_read_b64_tr_b16 v[126:127], v31 offset:45056
    buffer_load_dwordx4 v7, s[12:15], s74 offen offset:1024  lds
    s_add_u32 s74, s74, 0x20000
    s_barrier
    s_waitcnt lgkmcnt(4)
    v_mfma_f32_16x16x32_bf16 v[240:243], v[112:115], v[160:163], v[240:243]
    s_setprio 2
    ds_read_b64_tr_b16 v[96:97], v24 offset:49152
    v_mfma_f32_16x16x32_bf16 v[240:243], v[116:119], v[168:171], v[240:243]
    s_setprio 0
    ds_read_b64_tr_b16 v[98:99], v24 offset:53248
    v_and_b32 v32, 4, v1
    v_mfma_f32_16x16x32_bf16 v[244:247], v[116:119], v[172:175], v[244:247]
    s_setprio 2
    ds_read_b64_tr_b16 v[100:101], v24 offset:57344
    v_mfma_f32_16x16x32_bf16 v[244:247], v[112:115], v[164:167], v[244:247]
    s_setprio 0
    ds_read_b64_tr_b16 v[102:103], v24 offset:61440
    buffer_load_dwordx4 v[156:159], v2, s[20:23], s75 offen offset:1024 sc1
    s_add_u32 s75, s75, 0x2000
    s_waitcnt lgkmcnt(4)
    v_mfma_f32_16x16x32_bf16 v[252:255], v[120:123], v[164:167], v[252:255]
    s_setprio 2
    ds_read_b64_tr_b16 v[104:105], v25 offset:49152
    v_mfma_f32_16x16x32_bf16 v[252:255], v[124:127], v[172:175], v[252:255]
    s_setprio 0
    ds_read_b64_tr_b16 v[106:107], v25 offset:53248
    s_add_u32 s4, s93, 0x8000
    s_lshl_b32 s5, s59, 2
    s_add_u32 s3, s5, s90
    s_add_u32 s3, s3, 393216
    v_mfma_f32_16x16x32_bf16 v[248:251], v[124:127], v[168:171], v[248:251]
    s_setprio 2
    ds_read_b64_tr_b16 v[108:109], v25 offset:57344
    v_mfma_f32_16x16x32_bf16 v[248:251], v[120:123], v[160:163], v[248:251]
    s_setprio 0
    ds_read_b64_tr_b16 v[110:111], v25 offset:61440
    s_waitcnt lgkmcnt(4)
    v_mfma_f32_16x16x32_bf16 v[192:195], v[96:99], v[176:179], v[192:195]
    s_setprio 2
    ds_read_b64_tr_b16 v[112:113], v26 offset:49152
    v_mfma_f32_16x16x32_bf16 v[192:195], v[100:103], v[184:187], v[192:195]
    s_setprio 0
    ds_read_b64_tr_b16 v[114:115], v26 offset:53248
    buffer_load_dwordx4 v[160:163], v2, s[20:23], s75 offen sc1
    v_and_b32 v12, 15, v1
    v_mfma_f32_16x16x32_bf16 v[196:199], v[100:103], v[188:191], v[196:199]
    s_setprio 2
    ds_read_b64_tr_b16 v[116:117], v26 offset:57344
    v_mfma_f32_16x16x32_bf16 v[196:199], v[96:99], v[180:183], v[196:199]
    s_setprio 0
    ds_read_b64_tr_b16 v[118:119], v26 offset:61440
    s_waitcnt lgkmcnt(4)
    v_mfma_f32_16x16x32_bf16 v[204:207], v[104:107], v[180:183], v[204:207]
    s_setprio 2
    ds_read_b64_tr_b16 v[120:121], v27 offset:49152
    v_mfma_f32_16x16x32_bf16 v[204:207], v[108:111], v[188:191], v[204:207]
    s_setprio 0
    ds_read_b64_tr_b16 v[122:123], v27 offset:53248
    v_lshrrev_b32 v14, 4, v1
    s_add_u32 m0, s95, 81920
    v_mfma_f32_16x16x32_bf16 v[200:203], v[108:111], v[184:187], v[200:203]
    s_setprio 2
    ds_read_b64_tr_b16 v[124:125], v27 offset:57344
    v_mfma_f32_16x16x32_bf16 v[200:203], v[104:107], v[176:179], v[200:203]
    s_setprio 0
    ds_read_b64_tr_b16 v[126:127], v27 offset:61440
    buffer_load_dwordx4 v6, s[12:15], s74 offen  lds
    s_waitcnt lgkmcnt(4)
    v_mfma_f32_16x16x32_bf16 v[208:211], v[112:115], v[176:179], v[208:211]
    s_setprio 2
    ds_read_b64_tr_b16 v[96:97], v28 offset:49152
    v_mfma_f32_16x16x32_bf16 v[208:211], v[116:119], v[184:187], v[208:211]
    s_setprio 0
    ds_read_b64_tr_b16 v[98:99], v28 offset:53248
    buffer_load_dwordx4 v[164:167], v2, s[20:23], s75 offen offset:1024 sc1
    s_add_u32 s75, s75, 0x2000
    v_lshlrev_b32 v14, 3, v14
    v_mfma_f32_16x16x32_bf16 v[212:215], v[116:119], v[188:191], v[212:215]
    s_setprio 2
    ds_read_b64_tr_b16 v[100:101], v28 offset:57344
    v_mfma_f32_16x16x32_bf16 v[212:215], v[112:115], v[180:183], v[212:215]
    s_setprio 0
    ds_read_b64_tr_b16 v[102:103], v28 offset:61440
    s_waitcnt lgkmcnt(4)
    v_mfma_f32_16x16x32_bf16 v[220:223], v[120:123], v[180:183], v[220:223]
    s_setprio 2
    ds_read_b64_tr_b16 v[104:105], v29 offset:49152
    v_mfma_f32_16x16x32_bf16 v[220:223], v[124:127], v[188:191], v[220:223]
    s_setprio 0
    ds_read_b64_tr_b16 v[106:107], v29 offset:53248
    v_lshlrev_b32 v13, 2, v12
    v_mfma_f32_16x16x32_bf16 v[216:219], v[124:127], v[184:187], v[216:219]
    s_setprio 2
    ds_read_b64_tr_b16 v[108:109], v29 offset:57344
    v_mfma_f32_16x16x32_bf16 v[216:219], v[120:123], v[176:179], v[216:219]
    s_setprio 0
    ds_read_b64_tr_b16 v[110:111], v29 offset:61440
    buffer_load_dwordx4 v[168:171], v2, s[20:23], s75 offen sc1
    s_waitcnt lgkmcnt(4)
    v_mfma_f32_16x16x32_bf16 v[224:227], v[96:99], v[176:179], v[224:227]
    s_setprio 2
    ds_read_b64_tr_b16 v[112:113], v30 offset:49152
    v_mfma_f32_16x16x32_bf16 v[224:227], v[100:103], v[184:187], v[224:227]
    s_setprio 0
    ds_read_b64_tr_b16 v[114:115], v30 offset:53248
    v_and_b32 v13, 48, v13
    v_mfma_f32_16x16x32_bf16 v[228:231], v[100:103], v[188:191], v[228:231]
    s_setprio 2
    ds_read_b64_tr_b16 v[116:117], v30 offset:57344
    v_mfma_f32_16x16x32_bf16 v[228:231], v[96:99], v[180:183], v[228:231]
    s_setprio 0
    ds_read_b64_tr_b16 v[118:119], v30 offset:61440
    s_waitcnt lgkmcnt(4)
    v_mfma_f32_16x16x32_bf16 v[236:239], v[104:107], v[180:183], v[236:239]
    s_setprio 2
    ds_read_b64_tr_b16 v[120:121], v31 offset:49152
    v_mfma_f32_16x16x32_bf16 v[236:239], v[108:111], v[188:191], v[236:239]
    s_setprio 0
    ds_read_b64_tr_b16 v[122:123], v31 offset:53248
    buffer_load_dwordx4 v[172:175], v2, s[20:23], s75 offen offset:1024 sc1
    s_add_u32 s75, s75, 0x2000
    v_xor_b32 v13, v13, v14
    s_add_u32 m0, s95, 81920
    v_mfma_f32_16x16x32_bf16 v[232:235], v[108:111], v[184:187], v[232:235]
    s_setprio 2
    ds_read_b64_tr_b16 v[124:125], v31 offset:57344
    v_mfma_f32_16x16x32_bf16 v[232:235], v[104:107], v[176:179], v[232:235]
    s_setprio 0
    ds_read_b64_tr_b16 v[126:127], v31 offset:61440
    buffer_load_dwordx4 v7, s[12:15], s74 offen offset:1024  lds
    s_add_u32 s74, s74, 0x20000
    s_barrier
    s_waitcnt lgkmcnt(4)
    v_mfma_f32_16x16x32_bf16 v[240:243], v[112:115], v[176:179], v[240:243]
    s_setprio 2
    v_xor_b32 v24, 0x10000, v24
    ds_read_b64_tr_b16 v[96:97], v24 offset:0
    v_mfma_f32_16x16x32_bf16 v[240:243], v[116:119], v[184:187], v[240:243]
    s_setprio 0
    ds_read_b64_tr_b16 v[98:99], v24 offset:4096
    v_lshl_add_u32 v13, v12, 6, v13
    v_mfma_f32_16x16x32_bf16 v[244:247], v[116:119], v[188:191], v[244:247]
    s_setprio 2
    ds_read_b64_tr_b16 v[100:101], v24 offset:8192
    v_mfma_f32_16x16x32_bf16 v[244:247], v[112:115], v[180:183], v[244:247]
    s_setprio 0
    ds_read_b64_tr_b16 v[102:103], v24 offset:12288
    buffer_load_dwordx4 v[40:43], v2, s[20:23], s75 offen sc1
    s_waitcnt vmcnt(14)
    v_swap_b32 v138, v140
    v_swap_b32 v139, v141
    s_waitcnt lgkmcnt(4)
    v_mfma_f32_16x16x32_bf16 v[252:255], v[120:123], v[180:183], v[252:255]
    s_setprio 2
    v_xor_b32 v25, 0x10000, v25
    ds_read_b64_tr_b16 v[104:105], v25 offset:0
    v_mfma_f32_16x16x32_bf16 v[252:255], v[124:127], v[188:191], v[252:255]
    s_setprio 0
    ds_read_b64_tr_b16 v[106:107], v25 offset:4096
    v_add_u32 v13, s29, v13
    v_mfma_f32_16x16x32_bf16 v[248:251], v[124:127], v[184:187], v[248:251]
    s_setprio 2
    ds_read_b64_tr_b16 v[108:109], v25 offset:8192
    v_mfma_f32_16x16x32_bf16 v[248:251], v[120:123], v[176:179], v[248:251]
    s_setprio 0
    ds_read_b64_tr_b16 v[110:111], v25 offset:12288
    s_waitcnt lgkmcnt(4)
    v_mfma_f32_16x16x32_bf16 v[192:195], v[96:99], v[128:131], v[192:195]
    s_setprio 2
    v_xor_b32 v26, 0x10000, v26
    ds_read_b64_tr_b16 v[112:113], v26 offset:0
    v_mfma_f32_16x16x32_bf16 v[192:195], v[100:103], v[136:139], v[192:195]
    s_setprio 0
    ds_read_b64_tr_b16 v[114:115], v26 offset:4096
    buffer_load_dwordx4 v[44:47], v2, s[20:23], s75 offen offset:1024 sc1
    s_add_u32 s75, s75, 0x2000
    v_mfma_f32_16x16x32_bf16 v[196:199], v[100:103], v[140:143], v[196:199]
    s_setprio 2
    ds_read_b64_tr_b16 v[116:117], v26 offset:8192
    v_mfma_f32_16x16x32_bf16 v[196:199], v[96:99], v[132:135], v[196:199]
    s_setprio 0
    ds_read_b64_tr_b16 v[118:119], v26 offset:12288
    v_xor_b32 v15, 32, v13
    s_waitcnt lgkmcnt(4)
    v_mfma_f32_16x16x32_bf16 v[204:207], v[104:107], v[132:135], v[204:207]
    s_setprio 2
    v_xor_b32 v27, 0x10000, v27
    ds_read_b64_tr_b16 v[120:121], v27 offset:0
    v_mfma_f32_16x16x32_bf16 v[204:207], v[108:111], v[140:143], v[204:207]
    s_setprio 0
    ds_read_b64_tr_b16 v[122:123], v27 offset:4096
    s_mov_b32 s12, s46
    s_mov_b32 s13, s47
    s_and_b32 s13, s13, 0xffff
    s_mov_b32 s14, 0x200000
    s_mov_b32 s15, 0x20000
    s_lshl_b32 s74, s70, 19
    s_add_u32 m0, s95, 98304
    v_mfma_f32_16x16x32_bf16 v[200:203], v[108:111], v[136:139], v[200:203]
    s_setprio 2
    ds_read_b64_tr_b16 v[124:125], v27 offset:8192
    v_mfma_f32_16x16x32_bf16 v[200:203], v[104:107], v[128:131], v[200:203]
    s_setprio 0
    ds_read_b64_tr_b16 v[126:127], v27 offset:12288
    buffer_load_dwordx4 v6, s[12:15], s74 offen  lds
    v_mul_u32_u24 v12, 80, v12
    s_waitcnt lgkmcnt(4)
    v_mfma_f32_16x16x32_bf16 v[208:211], v[112:115], v[128:131], v[208:211]
    s_setprio 2
    v_xor_b32 v28, 0x10000, v28
    ds_read_b64_tr_b16 v[96:97], v28 offset:0
    v_mfma_f32_16x16x32_bf16 v[208:211], v[116:119], v[136:139], v[208:211]
    s_setprio 0
    ds_read_b64_tr_b16 v[98:99], v28 offset:4096
    buffer_load_dwordx4 v[48:51], v2, s[20:23], s75 offen sc1
    v_mfma_f32_16x16x32_bf16 v[212:215], v[116:119], v[140:143], v[212:215]
    s_setprio 2
    ds_read_b64_tr_b16 v[100:101], v28 offset:8192
    v_mfma_f32_16x16x32_bf16 v[212:215], v[112:115], v[132:135], v[212:215]
    s_setprio 0
    ds_read_b64_tr_b16 v[102:103], v28 offset:12288
    v_add3_u32 v12, v12, v14, s29
    s_waitcnt lgkmcnt(4)
    v_mfma_f32_16x16x32_bf16 v[220:223], v[120:123], v[132:135], v[220:223]
    s_setprio 2
    v_xor_b32 v29, 0x10000, v29
    ds_read_b64_tr_b16 v[104:105], v29 offset:0
    v_mfma_f32_16x16x32_bf16 v[220:223], v[124:127], v[140:143], v[220:223]
    s_setprio 0
    ds_read_b64_tr_b16 v[106:107], v29 offset:4096
    v_mfma_f32_16x16x32_bf16 v[216:219], v[124:127], v[136:139], v[216:219]
    s_setprio 2
    ds_read_b64_tr_b16 v[108:109], v29 offset:8192
    v_mfma_f32_16x16x32_bf16 v[216:219], v[120:123], v[128:131], v[216:219]
    s_setprio 0
    ds_read_b64_tr_b16 v[110:111], v29 offset:12288
    buffer_load_dwordx4 v[52:55], v2, s[20:23], s75 offen offset:1024 sc1
    s_add_u32 s75, s75, 0x2000
    v_lshrrev_b32 v14, 2, v1
    s_waitcnt lgkmcnt(4)
    v_mfma_f32_16x16x32_bf16 v[224:227], v[96:99], v[128:131], v[224:227]
    s_setprio 2
    v_xor_b32 v30, 0x10000, v30
    ds_read_b64_tr_b16 v[112:113], v30 offset:0
    v_mfma_f32_16x16x32_bf16 v[224:227], v[100:103], v[136:139], v[224:227]
    s_setprio 0
    ds_read_b64_tr_b16 v[114:115], v30 offset:4096
    buffer_load_dword v34, v39, s[24:27], s3 offen offset:0 sc1
    v_mfma_f32_16x16x32_bf16 v[228:231], v[100:103], v[140:143], v[228:231]
    s_setprio 2
    ds_read_b64_tr_b16 v[116:117], v30 offset:8192
    v_mfma_f32_16x16x32_bf16 v[228:231], v[96:99], v[132:135], v[228:231]
    s_setprio 0
    ds_read_b64_tr_b16 v[118:119], v30 offset:12288
    v_mul_u32_u24 v14, 80, v14
    s_waitcnt lgkmcnt(4)
    v_mfma_f32_16x16x32_bf16 v[236:239], v[104:107], v[132:135], v[236:239]
    s_setprio 2
    v_xor_b32 v31, 0x10000, v31
    ds_read_b64_tr_b16 v[120:121], v31 offset:0
    v_mfma_f32_16x16x32_bf16 v[236:239], v[108:111], v[140:143], v[236:239]
    s_setprio 0
    ds_read_b64_tr_b16 v[122:123], v31 offset:4096
    buffer_load_dwordx4 v[56:59], v2, s[20:23], s75 offen sc1
    s_add_u32 m0, s95, 98304
    v_mfma_f32_16x16x32_bf16 v[232:235], v[108:111], v[136:139], v[232:235]
    s_setprio 2
    ds_read_b64_tr_b16 v[124:125], v31 offset:8192
    v_mfma_f32_16x16x32_bf16 v[232:235], v[104:107], v[128:131], v[232:235]
    s_setprio 0
    ds_read_b64_tr_b16 v[126:127], v31 offset:12288
    buffer_load_dwordx4 v7, s[12:15], s74 offen offset:1024  lds
    s_add_u32 s74, s74, 0x20000
    v_and_b32 v16, 48, v0
    s_barrier
    s_waitcnt lgkmcnt(4)
    v_mfma_f32_16x16x32_bf16 v[240:243], v[112:115], v[128:131], v[240:243]
    s_setprio 2
    ds_read_b64_tr_b16 v[96:97], v24 offset:16384
    v_mfma_f32_16x16x32_bf16 v[240:243], v[116:119], v[136:139], v[240:243]
    s_setprio 0
    ds_read_b64_tr_b16 v[98:99], v24 offset:20480
    v_mfma_f32_16x16x32_bf16 v[244:247], v[116:119], v[140:143], v[244:247]
    s_setprio 2
    ds_read_b64_tr_b16 v[100:101], v24 offset:24576
    v_mfma_f32_16x16x32_bf16 v[244:247], v[112:115], v[132:135], v[244:247]
    s_setprio 0
    ds_read_b64_tr_b16 v[102:103], v24 offset:28672
    buffer_load_dwordx4 v[60:63], v2, s[20:23], s75 offen offset:1024 sc1
    s_add_u32 s75, s75, 0x2000
    v_add3_u32 v14, v14, v16, s29
    s_waitcnt lgkmcnt(4)
    v_mfma_f32_16x16x32_bf16 v[252:255], v[120:123], v[132:135], v[252:255]
    s_setprio 2
    ds_read_b64_tr_b16 v[104:105], v25 offset:16384
    v_mfma_f32_16x16x32_bf16 v[252:255], v[124:127], v[140:143], v[252:255]
    s_setprio 0
    ds_read_b64_tr_b16 v[106:107], v25 offset:20480
    v_mfma_f32_16x16x32_bf16 v[248:251], v[124:127], v[136:139], v[248:251]
    s_setprio 2
    ds_read_b64_tr_b16 v[108:109], v25 offset:24576
    v_mfma_f32_16x16x32_bf16 v[248:251], v[120:123], v[128:131], v[248:251]
    s_setprio 0
    ds_read_b64_tr_b16 v[110:111], v25 offset:28672
    s_waitcnt vmcnt(15) lgkmcnt(4)
    v_mfma_f32_16x16x32_bf16 v[192:195], v[96:99], v[144:147], v[192:195]
    s_setprio 2
    ds_read_b64_tr_b16 v[112:113], v26 offset:16384
    v_mfma_f32_16x16x32_bf16 v[192:195], v[100:103], v[152:155], v[192:195]
    s_setprio 0
    ds_read_b64_tr_b16 v[114:115], v26 offset:20480
    buffer_load_dwordx4 v[64:67], v2, s[20:23], s75 offen sc1
    v_mfma_f32_16x16x32_bf16 v[196:199], v[100:103], v[156:159], v[196:199]
    s_setprio 2
    ds_read_b64_tr_b16 v[116:117], v26 offset:24576
    v_mfma_f32_16x16x32_bf16 v[196:199], v[96:99], v[148:151], v[196:199]
    s_setprio 0
    ds_read_b64_tr_b16 v[118:119], v26 offset:28672
    s_waitcnt lgkmcnt(4)
    v_mfma_f32_16x16x32_bf16 v[204:207], v[104:107], v[148:151], v[204:207]
    s_setprio 2
    ds_read_b64_tr_b16 v[120:121], v27 offset:16384
    v_mfma_f32_16x16x32_bf16 v[204:207], v[108:111], v[156:159], v[204:207]
    s_setprio 0
    ds_read_b64_tr_b16 v[122:123], v27 offset:20480
    s_add_u32 m0, s95, 114688
    v_mfma_f32_16x16x32_bf16 v[200:203], v[108:111], v[152:155], v[200:203]
    s_setprio 2
    ds_read_b64_tr_b16 v[124:125], v27 offset:24576
    v_mfma_f32_16x16x32_bf16 v[200:203], v[104:107], v[144:147], v[200:203]
    s_setprio 0
    ds_read_b64_tr_b16 v[126:127], v27 offset:28672
    buffer_load_dwordx4 v6, s[12:15], s74 offen  lds
    s_waitcnt lgkmcnt(4)
    v_mfma_f32_16x16x32_bf16 v[208:211], v[112:115], v[144:147], v[208:211]
    s_setprio 2
    ds_read_b64_tr_b16 v[96:97], v28 offset:16384
    v_mfma_f32_16x16x32_bf16 v[208:211], v[116:119], v[152:155], v[208:211]
    s_setprio 0
    ds_read_b64_tr_b16 v[98:99], v28 offset:20480
    buffer_load_dwordx4 v[68:71], v2, s[20:23], s75 offen offset:1024 sc1
    s_add_u32 s75, s75, 0x2000
    v_mfma_f32_16x16x32_bf16 v[212:215], v[116:119], v[156:159], v[212:215]
    s_setprio 2
    ds_read_b64_tr_b16 v[100:101], v28 offset:24576
    v_mfma_f32_16x16x32_bf16 v[212:215], v[112:115], v[148:151], v[212:215]
    s_setprio 0
    ds_read_b64_tr_b16 v[102:103], v28 offset:28672
    s_waitcnt lgkmcnt(4)
    v_mfma_f32_16x16x32_bf16 v[220:223], v[120:123], v[148:151], v[220:223]
    s_setprio 2
    ds_read_b64_tr_b16 v[104:105], v29 offset:16384
    v_mfma_f32_16x16x32_bf16 v[220:223], v[124:127], v[156:159], v[220:223]
    s_setprio 0
    ds_read_b64_tr_b16 v[106:107], v29 offset:20480
    v_mfma_f32_16x16x32_bf16 v[216:219], v[124:127], v[152:155], v[216:219]
    s_setprio 2
    ds_read_b64_tr_b16 v[108:109], v29 offset:24576
    v_mfma_f32_16x16x32_bf16 v[216:219], v[120:123], v[144:147], v[216:219]
    s_setprio 0
    ds_read_b64_tr_b16 v[110:111], v29 offset:28672
    buffer_load_dwordx4 v[72:75], v2, s[20:23], s75 offen sc1
    s_waitcnt lgkmcnt(4)
    v_mfma_f32_16x16x32_bf16 v[224:227], v[96:99], v[144:147], v[224:227]
    s_setprio 2
    ds_read_b64_tr_b16 v[112:113], v30 offset:16384
    v_mfma_f32_16x16x32_bf16 v[224:227], v[100:103], v[152:155], v[224:227]
    s_setprio 0
    ds_read_b64_tr_b16 v[114:115], v30 offset:20480
    v_mfma_f32_16x16x32_bf16 v[228:231], v[100:103], v[156:159], v[228:231]
    s_setprio 2
    ds_read_b64_tr_b16 v[116:117], v30 offset:24576
    v_mfma_f32_16x16x32_bf16 v[228:231], v[96:99], v[148:151], v[228:231]
    s_setprio 0
    ds_read_b64_tr_b16 v[118:119], v30 offset:28672
    s_waitcnt lgkmcnt(4)
    v_mfma_f32_16x16x32_bf16 v[236:239], v[104:107], v[148:151], v[236:239]
    s_setprio 2
    ds_read_b64_tr_b16 v[120:121], v31 offset:16384
    v_mfma_f32_16x16x32_bf16 v[236:239], v[108:111], v[156:159], v[236:239]
    s_setprio 0
    ds_read_b64_tr_b16 v[122:123], v31 offset:20480
    buffer_load_dwordx4 v[76:79], v2, s[20:23], s75 offen offset:1024 sc1
    s_add_u32 s75, s75, 0x2000
    s_add_u32 m0, s95, 114688
    v_mfma_f32_16x16x32_bf16 v[232:235], v[108:111], v[152:155], v[232:235]
    s_setprio 2
    ds_read_b64_tr_b16 v[124:125], v31 offset:24576
    v_mfma_f32_16x16x32_bf16 v[232:235], v[104:107], v[144:147], v[232:235]
    s_setprio 0
    ds_read_b64_tr_b16 v[126:127], v31 offset:28672
    buffer_load_dwordx4 v7, s[12:15], s74 offen offset:1024  lds
    s_add_u32 s74, s74, 0x20000
    s_barrier
    s_waitcnt lgkmcnt(4)
    v_mfma_f32_16x16x32_bf16 v[240:243], v[112:115], v[144:147], v[240:243]
    s_setprio 2
    ds_read_b64_tr_b16 v[96:97], v24 offset:32768
    v_mfma_f32_16x16x32_bf16 v[240:243], v[116:119], v[152:155], v[240:243]
    s_setprio 0
    ds_read_b64_tr_b16 v[98:99], v24 offset:36864
    v_mfma_f32_16x16x32_bf16 v[244:247], v[116:119], v[156:159], v[244:247]
    s_setprio 2
    ds_read_b64_tr_b16 v[100:101], v24 offset:40960
    v_mfma_f32_16x16x32_bf16 v[244:247], v[112:115], v[148:151], v[244:247]
    s_setprio 0
    ds_read_b64_tr_b16 v[102:103], v24 offset:45056
    buffer_load_dwordx4 v[80:83], v2, s[20:23], s75 offen sc1
    s_waitcnt lgkmcnt(4)
    v_mfma_f32_16x16x32_bf16 v[252:255], v[120:123], v[148:151], v[252:255]
    s_setprio 2
    ds_read_b64_tr_b16 v[104:105], v25 offset:32768
    v_mfma_f32_16x16x32_bf16 v[252:255], v[124:127], v[156:159], v[252:255]
    s_setprio 0
    ds_read_b64_tr_b16 v[106:107], v25 offset:36864
    v_mfma_f32_16x16x32_bf16 v[248:251], v[124:127], v[152:155], v[248:251]
    s_setprio 2
    ds_read_b64_tr_b16 v[108:109], v25 offset:40960
    v_mfma_f32_16x16x32_bf16 v[248:251], v[120:123], v[144:147], v[248:251]
    s_setprio 0
    ds_read_b64_tr_b16 v[110:111], v25 offset:45056
    s_waitcnt vmcnt(17) lgkmcnt(4)
    v_mfma_f32_16x16x32_bf16 v[192:195], v[96:99], v[160:163], v[192:195]
    s_setprio 2
    ds_read_b64_tr_b16 v[112:113], v26 offset:32768
    v_mfma_f32_16x16x32_bf16 v[192:195], v[100:103], v[168:171], v[192:195]
    s_setprio 0
    ds_read_b64_tr_b16 v[114:115], v26 offset:36864
    buffer_load_dwordx4 v[84:87], v2, s[20:23], s75 offen offset:1024 sc1
    s_add_u32 s75, s75, 0x2000
    s_waitcnt vmcnt(11)
    s_mov_b32 s7, 0
L_op:
    v_cmp_ne_u32 vcc, s58, v34
    s_nop 0
    s_cmp_eq_u64 vcc, 0
    s_cbranch_scc1 L_op_ok
    s_add_u32 s7, s7, 1
    s_cmp_ge_u32 s7, 0x20000
    s_cbranch_scc1 L_op_ok
    s_sleep 1
    buffer_load_dword v34, v39, s[24:27], s3 offen offset:0 sc1
    s_waitcnt vmcnt(0)
    s_branch L_op
L_op_ok:
    buffer_load_dwordx4 v[176:179], v2, s[20:23], s73 offen sc1
    v_mfma_f32_16x16x32_bf16 v[196:199], v[100:103], v[172:175], v[196:199]
    s_setprio 2
    ds_read_b64_tr_b16 v[116:117], v26 offset:40960
    v_mfma_f32_16x16x32_bf16 v[196:199], v[96:99], v[164:167], v[196:199]
    s_setprio 0
    ds_read_b64_tr_b16 v[118:119], v26 offset:45056
    s_waitcnt lgkmcnt(4)
    v_mfma_f32_16x16x32_bf16 v[204:207], v[104:107], v[164:167], v[204:207]
    s_setprio 2
    ds_read_b64_tr_b16 v[120:121], v27 offset:32768
    v_mfma_f32_16x16x32_bf16 v[204:207], v[108:111], v[172:175], v[204:207]
    s_setprio 0
    ds_read_b64_tr_b16 v[122:123], v27 offset:36864
    buffer_load_dwordx4 v[180:183], v2, s[20:23], s73 offen offset:1024 sc1
    s_add_u32 s73, s73, 0x2000
    s_add_u32 m0, s95, 0
    v_mfma_f32_16x16x32_bf16 v[200:203], v[108:111], v[168:171], v[200:203]
    s_setprio 2
    ds_read_b64_tr_b16 v[124:125], v27 offset:40960
    v_mfma_f32_16x16x32_bf16 v[200:203], v[104:107], v[160:163], v[200:203]
    s_setprio 0
    ds_read_b64_tr_b16 v[126:127], v27 offset:45056
    buffer_load_dwordx4 v6, s[12:15], s74 offen  lds
    s_waitcnt lgkmcnt(4)
    v_mfma_f32_16x16x32_bf16 v[208:211], v[112:115], v[160:163], v[208:211]
    s_setprio 2
    ds_read_b64_tr_b16 v[96:97], v28 offset:32768
    v_mfma_f32_16x16x32_bf16 v[208:211], v[116:119], v[168:171], v[208:211]
    s_setprio 0
    ds_read_b64_tr_b16 v[98:99], v28 offset:36864
    buffer_load_dwordx4 v[184:187], v2, s[20:23], s73 offen sc1
    v_mfma_f32_16x16x32_bf16 v[212:215], v[116:119], v[172:175], v[212:215]
    s_setprio 2
    ds_read_b64_tr_b16 v[100:101], v28 offset:40960
    v_mfma_f32_16x16x32_bf16 v[212:215], v[112:115], v[164:167], v[212:215]
    s_setprio 0
    ds_read_b64_tr_b16 v[102:103], v28 offset:45056
    s_waitcnt lgkmcnt(4)
    v_mfma_f32_16x16x32_bf16 v[220:223], v[120:123], v[164:167], v[220:223]
    s_setprio 2
    ds_read_b64_tr_b16 v[104:105], v29 offset:32768
    v_mfma_f32_16x16x32_bf16 v[220:223], v[124:127], v[172:175], v[220:223]
    s_setprio 0
    ds_read_b64_tr_b16 v[106:107], v29 offset:36864
    buffer_load_dwordx4 v[188:191], v2, s[20:23], s73 offen offset:1024 sc1
    s_add_u32 s73, s73, 0x2000
    v_mfma_f32_16x16x32_bf16 v[216:219], v[124:127], v[168:171], v[216:219]
    s_setprio 2
    ds_read_b64_tr_b16 v[108:109], v29 offset:40960
    v_mfma_f32_16x16x32_bf16 v[216:219], v[120:123], v[160:163], v[216:219]
    s_setprio 0
    ds_read_b64_tr_b16 v[110:111], v29 offset:45056
    s_waitcnt lgkmcnt(4)
    v_mfma_f32_16x16x32_bf16 v[224:227], v[96:99], v[160:163], v[224:227]
    s_setprio 2
    ds_read_b64_tr_b16 v[112:113], v30 offset:32768
    v_mfma_f32_16x16x32_bf16 v[224:227], v[100:103], v[168:171], v[224:227]
    s_setprio 0
    ds_read_b64_tr_b16 v[114:115], v30 offset:36864
    buffer_load_dwordx4 v[128:131], v2, s[20:23], s73 offen sc1
    v_mfma_f32_16x16x32_bf16 v[228:231], v[100:103], v[172:175], v[228:231]
    s_setprio 2
    ds_read_b64_tr_b16 v[116:117], v30 offset:40960
    v_mfma_f32_16x16x32_bf16 v[228:231], v[96:99], v[164:167], v[228:231]
    s_setprio 0
    ds_read_b64_tr_b16 v[118:119], v30 offset:45056
    s_waitcnt lgkmcnt(4)
    v_mfma_f32_16x16x32_bf16 v[236:239], v[104:107], v[164:167], v[236:239]
    s_setprio 2
    ds_read_b64_tr_b16 v[120:121], v31 offset:32768
    v_mfma_f32_16x16x32_bf16 v[236:239], v[108:111], v[172:175], v[236:239]
    s_setprio 0
    ds_read_b64_tr_b16 v[122:123], v31 offset:36864
    buffer_load_dwordx4 v[132:135], v2, s[20:23], s73 offen offset:1024 sc1
    s_add_u32 s73, s73, 0x2000
    s_add_u32 m0, s95, 0
    v_mfma_f32_16x16x32_bf16 v[232:235], v[108:111], v[168:171], v[232:235]
    s_setprio 2
    ds_read_b64_tr_b16 v[124:125], v31 offset:40960
    v_mfma_f32_16x16x32_bf16 v[232:235], v[104:107], v[160:163], v[232:235]
    s_setprio 0
    ds_read_b64_tr_b16 v[126:127], v31 offset:45056
    buffer_load_dwordx4 v7, s[12:15], s74 offen offset:1024  lds
    s_add_u32 s74, s74, 0x20000
    s_barrier
    s_waitcnt lgkmcnt(4)
    v_mfma_f32_16x16x32_bf16 v[240:243], v[112:115], v[160:163], v[240:243]
    s_setprio 2
    ds_read_b64_tr_b16 v[96:97], v26 offset:49152
    v_mfma_f32_16x16x32_bf16 v[240:243], v[116:119], v[168:171], v[240:243]
    s_setprio 0
    ds_read_b64_tr_b16 v[98:99], v26 offset:53248
    buffer_load_dwordx4 v[136:139], v2, s[20:23], s73 offen sc1
    v_mfma_f32_16x16x32_bf16 v[244:247], v[116:119], v[172:175], v[244:247]
    s_setprio 2
    ds_read_b64_tr_b16 v[100:101], v26 offset:57344
    v_mfma_f32_16x16x32_bf16 v[244:247], v[112:115], v[164:167], v[244:247]
    s_setprio 0
    ds_read_b64_tr_b16 v[102:103], v26 offset:61440
    s_waitcnt lgkmcnt(4)
    v_mfma_f32_16x16x32_bf16 v[252:255], v[120:123], v[164:167], v[252:255]
    s_setprio 2
    ds_read_b64_tr_b16 v[104:105], v27 offset:49152
    v_mfma_f32_16x16x32_bf16 v[252:255], v[124:127], v[172:175], v[252:255]
    s_setprio 0
    ds_read_b64_tr_b16 v[106:107], v27 offset:53248
    buffer_load_dwordx4 v[140:143], v2, s[20:23], s73 offen offset:1024 sc1
    s_add_u32 s73, s73, 0x2000
    v_mfma_f32_16x16x32_bf16 v[248:251], v[124:127], v[168:171], v[248:251]
    s_setprio 2
    ds_read_b64_tr_b16 v[108:109], v27 offset:57344
    v_mfma_f32_16x16x32_bf16 v[248:251], v[120:123], v[160:163], v[248:251]
    s_setprio 0
    ds_read_b64_tr_b16 v[110:111], v27 offset:61440
    s_waitcnt lgkmcnt(4)
    v_mfma_f32_16x16x32_bf16 v[208:211], v[96:99], v[40:43], v[208:211]
    s_setprio 2
    ds_read_b64_tr_b16 v[112:113], v28 offset:49152
    v_mfma_f32_16x16x32_bf16 v[208:211], v[100:103], v[48:51], v[208:211]
    s_setprio 0
    ds_read_b64_tr_b16 v[114:115], v28 offset:53248
    buffer_load_dwordx4 v[144:147], v2, s[20:23], s73 offen sc1
    v_mfma_f32_16x16x32_bf16 v[212:215], v[100:103], v[52:55], v[212:215]
    s_setprio 2
    ds_read_b64_tr_b16 v[116:117], v28 offset:57344
    v_mfma_f32_16x16x32_bf16 v[212:215], v[96:99], v[44:47], v[212:215]
    s_setprio 0
    ds_read_b64_tr_b16 v[118:119], v28 offset:61440
    s_waitcnt lgkmcnt(4)
    v_mfma_f32_16x16x32_bf16 v[220:223], v[104:107], v[44:47], v[220:223]
    s_setprio 2
    ds_read_b64_tr_b16 v[120:121], v29 offset:49152
    v_mfma_f32_16x16x32_bf16 v[220:223], v[108:111], v[52:55], v[220:223]
    s_setprio 0
    ds_read_b64_tr_b16 v[122:123], v29 offset:53248
    buffer_load_dwordx4 v[148:151], v2, s[20:23], s73 offen offset:1024 sc1
    s_add_u32 s73, s73, 0x2000
    s_add_u32 m0, s95, 16384
    v_mfma_f32_16x16x32_bf16 v[216:219], v[108:111], v[48:51], v[216:219]
    s_setprio 2
    ds_read_b64_tr_b16 v[124:125], v29 offset:57344
    v_mfma_f32_16x16x32_bf16 v[216:219], v[104:107], v[40:43], v[216:219]
    s_setprio 0
    ds_read_b64_tr_b16 v[126:127], v29 offset:61440
    buffer_load_dwordx4 v6, s[12:15], s74 offen  lds
    s_waitcnt lgkmcnt(4)
    v_mfma_f32_16x16x32_bf16 v[224:227], v[112:115], v[40:43], v[224:227]
    s_setprio 2
    ds_read_b64_tr_b16 v[96:97], v30 offset:49152
    v_mfma_f32_16x16x32_bf16 v[224:227], v[116:119], v[48:51], v[224:227]
    s_setprio 0
    ds_read_b64_tr_b16 v[98:99], v30 offset:53248
    buffer_load_dwordx4 v[152:155], v2, s[20:23], s73 offen sc1
    v_mfma_f32_16x16x32_bf16 v[228:231], v[116:119], v[52:55], v[228:231]
    s_setprio 2
    ds_read_b64_tr_b16 v[100:101], v30 offset:57344
    v_mfma_f32_16x16x32_bf16 v[228:231], v[112:115], v[44:47], v[228:231]
    s_setprio 0
    ds_read_b64_tr_b16 v[102:103], v30 offset:61440
    s_waitcnt lgkmcnt(4)
    v_mfma_f32_16x16x32_bf16 v[236:239], v[120:123], v[44:47], v[236:239]
    s_setprio 2
    ds_read_b64_tr_b16 v[104:105], v31 offset:49152
    v_mfma_f32_16x16x32_bf16 v[236:239], v[124:127], v[52:55], v[236:239]
    s_setprio 0
    ds_read_b64_tr_b16 v[106:107], v31 offset:53248
    buffer_load_dwordx4 v[156:159], v2, s[20:23], s73 offen offset:1024 sc1
    s_add_u32 s73, s73, 0x2000
    v_mfma_f32_16x16x32_bf16 v[232:235], v[124:127], v[48:51], v[232:235]
    s_setprio 2
    ds_read_b64_tr_b16 v[108:109], v31 offset:57344
    v_mfma_f32_16x16x32_bf16 v[232:235], v[120:123], v[40:43], v[232:235]
    s_setprio 0
    ds_read_b64_tr_b16 v[110:111], v31 offset:61440
    s_waitcnt vmcnt(7)
    s_barrier
    s_setprio 1
    s_waitcnt lgkmcnt(4)
    v_mfma_f32_16x16x32_bf16 v[240:243], v[96:99], v[40:43], v[240:243]
    v_xor_b32 v26, 0x10000, v26
    ds_read_b64_tr_b16 v[112:113], v26 offset:0
    v_mfma_f32_16x16x32_bf16 v[240:243], v[100:103], v[48:51], v[240:243]
    ds_read_b64_tr_b16 v[114:115], v26 offset:4096
    buffer_load_dwordx4 v[160:163], v2, s[20:23], s73 offen sc1
    s_add_u32 m0, s95, 16384
    v_mfma_f32_16x16x32_bf16 v[244:247], v[100:103], v[52:55], v[244:247]
    ds_read_b64_tr_b16 v[116:117], v26 offset:8192
    v_mfma_f32_16x16x32_bf16 v[244:247], v[96:99], v[44:47], v[244:247]
    ds_read_b64_tr_b16 v[118:119], v26 offset:12288
    buffer_load_dwordx4 v7, s[12:15], s74 offen offset:1024  lds
    s_add_u32 s74, s74, 0x20000
    v_swap_b32 v58, v60
    v_swap_b32 v59, v61
    s_waitcnt lgkmcnt(4)
    v_mfma_f32_16x16x32_bf16 v[252:255], v[104:107], v[44:47], v[252:255]
    v_xor_b32 v27, 0x10000, v27
    ds_read_b64_tr_b16 v[120:121], v27 offset:0
    v_mfma_f32_16x16x32_bf16 v[252:255], v[108:111], v[52:55], v[252:255]
    ds_read_b64_tr_b16 v[122:123], v27 offset:4096
    buffer_load_dwordx4 v[164:167], v2, s[20:23], s73 offen offset:1024 sc1
    s_add_u32 s73, s73, 0x2000
    v_mfma_f32_16x16x32_bf16 v[248:251], v[108:111], v[48:51], v[248:251]
    ds_read_b64_tr_b16 v[124:125], v27 offset:8192
    v_mfma_f32_16x16x32_bf16 v[248:251], v[104:107], v[40:43], v[248:251]
    ds_read_b64_tr_b16 v[126:127], v27 offset:12288
    s_waitcnt lgkmcnt(4)
    v_mfma_f32_16x16x32_bf16 v[208:211], v[112:115], v[56:59], v[208:211]
    ds_read_b64_tr_b16 v[96:97], v26 offset:16384
    v_mfma_f32_16x16x32_bf16 v[208:211], v[116:119], v[64:67], v[208:211]
    ds_read_b64_tr_b16 v[98:99], v26 offset:20480
    buffer_load_dwordx4 v[168:171], v2, s[20:23], s73 offen sc1
    v_mfma_f32_16x16x32_bf16 v[212:215], v[116:119], v[68:71], v[212:215]
    ds_read_b64_tr_b16 v[100:101], v26 offset:24576
    v_mfma_f32_16x16x32_bf16 v[212:215], v[112:115], v[60:63], v[212:215]
    ds_read_b64_tr_b16 v[102:103], v26 offset:28672
    s_waitcnt lgkmcnt(4)
    v_mfma_f32_16x16x32_bf16 v[220:223], v[120:123], v[60:63], v[220:223]
    ds_read_b64_tr_b16 v[104:105], v27 offset:16384
    v_mfma_f32_16x16x32_bf16 v[220:223], v[124:127], v[68:71], v[220:223]
    ds_read_b64_tr_b16 v[106:107], v27 offset:20480
    buffer_load_dwordx4 v[172:175], v2, s[20:23], s73 offen offset:1024 sc1
    s_add_u32 s73, s73, 0x2000
    v_mfma_f32_16x16x32_bf16 v[216:219], v[124:127], v[64:67], v[216:219]
    ds_read_b64_tr_b16 v[108:109], v27 offset:24576
    v_mfma_f32_16x16x32_bf16 v[216:219], v[120:123], v[56:59], v[216:219]
    ds_read_b64_tr_b16 v[110:111], v27 offset:28672
    s_add_u32 s9, s94, 0x4000
    s_add_u32 s10, s94, 0x8000
    s_add_u32 s11, s94, 0xc000
    s_waitcnt lgkmcnt(4)
    v_mfma_f32_16x16x32_bf16 v[208:211], v[96:99], v[72:75], v[208:211]
    ds_read_b64_tr_b16 v[112:113], v26 offset:32768
    v_mfma_f32_16x16x32_bf16 v[208:211], v[100:103], v[80:83], v[208:211]
    ds_read_b64_tr_b16 v[114:115], v26 offset:36864
    v_mfma_f32_16x16x32_bf16 v[212:215], v[100:103], v[84:87], v[212:215]
    ds_read_b64_tr_b16 v[116:117], v26 offset:40960
    v_mfma_f32_16x16x32_bf16 v[212:215], v[96:99], v[76:79], v[212:215]
    ds_read_b64_tr_b16 v[118:119], v26 offset:45056
    s_waitcnt lgkmcnt(4)
    v_mfma_f32_16x16x32_bf16 v[220:223], v[104:107], v[76:79], v[220:223]
    ds_read_b64_tr_b16 v[120:121], v27 offset:32768
    v_mfma_f32_16x16x32_bf16 v[220:223], v[108:111], v[84:87], v[220:223]
    ds_read_b64_tr_b16 v[122:123], v27 offset:36864
    v_mfma_f32_16x16x32_bf16 v[216:219], v[108:111], v[80:83], v[216:219]
    ds_read_b64_tr_b16 v[124:125], v27 offset:40960
    v_mfma_f32_16x16x32_bf16 v[216:219], v[104:107], v[72:75], v[216:219]
    ds_read_b64_tr_b16 v[126:127], v27 offset:45056
    s_waitcnt lgkmcnt(4)
    v_mfma_f32_16x16x32_bf16 v[208:211], v[112:115], v[176:179], v[208:211]
    ds_read_b64_tr_b16 v[96:97], v26 offset:49152
    v_mfma_f32_16x16x32_bf16 v[208:211], v[116:119], v[184:187], v[208:211]
    ds_read_b64_tr_b16 v[98:99], v26 offset:53248
    v_mfma_f32_16x16x32_bf16 v[212:215], v[116:119], v[188:191], v[212:215]
    ds_read_b64_tr_b16 v[100:101], v26 offset:57344
    v_mfma_f32_16x16x32_bf16 v[212:215], v[112:115], v[180:183], v[212:215]
    ds_read_b64_tr_b16 v[102:103], v26 offset:61440
    s_waitcnt lgkmcnt(4)
    v_mfma_f32_16x16x32_bf16 v[220:223], v[120:123], v[180:183], v[220:223]
    ds_read_b64_tr_b16 v[104:105], v27 offset:49152
    v_mfma_f32_16x16x32_bf16 v[220:223], v[124:127], v[188:191], v[220:223]
    ds_read_b64_tr_b16 v[106:107], v27 offset:53248
    v_mfma_f32_16x16x32_bf16 v[216:219], v[124:127], v[184:187], v[216:219]
    ds_read_b64_tr_b16 v[108:109], v27 offset:57344
    v_mfma_f32_16x16x32_bf16 v[216:219], v[120:123], v[176:179], v[216:219]
    ds_read_b64_tr_b16 v[110:111], v27 offset:61440
    s_waitcnt vmcnt(10) lgkmcnt(4)
    v_mfma_f32_16x16x32_bf16 v[208:211], v[96:99], v[128:131], v[208:211]
    v_xor_b32 v26, 0x10000, v26
    ds_read_b64_tr_b16 v[112:113], v26 offset:0
    v_mfma_f32_16x16x32_bf16 v[208:211], v[100:103], v[136:139], v[208:211]
    ds_read_b64_tr_b16 v[114:115], v26 offset:4096
    v_mfma_f32_16x16x32_bf16 v[212:215], v[100:103], v[140:143], v[212:215]
    ds_read_b64_tr_b16 v[116:117], v26 offset:8192
    v_mfma_f32_16x16x32_bf16 v[212:215], v[96:99], v[132:135], v[212:215]
    ds_read_b64_tr_b16 v[118:119], v26 offset:12288
    s_waitcnt lgkmcnt(4)
    v_mfma_f32_16x16x32_bf16 v[220:223], v[104:107], v[132:135], v[220:223]
    v_xor_b32 v27, 0x10000, v27
    ds_read_b64_tr_b16 v[120:121], v27 offset:0
    v_mfma_f32_16x16x32_bf16 v[220:223], v[108:111], v[140:143], v[220:223]
    ds_read_b64_tr_b16 v[122:123], v27 offset:4096
    v_mfma_f32_16x16x32_bf16 v[216:219], v[108:111], v[136:139], v[216:219]
    ds_read_b64_tr_b16 v[124:125], v27 offset:8192
    v_mfma_f32_16x16x32_bf16 v[216:219], v[104:107], v[128:131], v[216:219]
    ds_read_b64_tr_b16 v[126:127], v27 offset:12288
    s_waitcnt vmcnt(3)
    s_barrier
    s_waitcnt lgkmcnt(4)
    v_mfma_f32_16x16x32_bf16 v[208:211], v[112:115], v[144:147], v[208:211]
    ds_read_b64_tr_b16 v[96:97], v26 offset:16384
    v_mfma_f32_16x16x32_bf16 v[208:211], v[116:119], v[152:155], v[208:211]
    ds_read_b64_tr_b16 v[98:99], v26 offset:20480
    v_mfma_f32_16x16x32_bf16 v[212:215], v[116:119], v[156:159], v[212:215]
    ds_read_b64_tr_b16 v[100:101], v26 offset:24576
    v_mfma_f32_16x16x32_bf16 v[212:215], v[112:115], v[148:151], v[212:215]
    ds_read_b64_tr_b16 v[102:103], v26 offset:28672
    s_waitcnt lgkmcnt(4)
    v_mfma_f32_16x16x32_bf16 v[220:223], v[120:123], v[148:151], v[220:223]
    ds_read_b64_tr_b16 v[104:105], v27 offset:16384
    v_mfma_f32_16x16x32_bf16 v[220:223], v[124:127], v[156:159], v[220:223]
    ds_read_b64_tr_b16 v[106:107], v27 offset:20480
    v_mfma_f32_16x16x32_bf16 v[216:219], v[124:127], v[152:155], v[216:219]
    ds_read_b64_tr_b16 v[108:109], v27 offset:24576
    v_mfma_f32_16x16x32_bf16 v[216:219], v[120:123], v[144:147], v[216:219]
    ds_read_b64_tr_b16 v[110:111], v27 offset:28672
    s_waitcnt vmcnt(0) lgkmcnt(4)
    v_mfma_f32_16x16x32_bf16 v[208:211], v[96:99], v[160:163], v[208:211]
    v_xor_b32 v28, 0x10000, v28
    ds_read_b64_tr_b16 v[112:113], v28 offset:0
    v_mfma_f32_16x16x32_bf16 v[208:211], v[100:103], v[168:171], v[208:211]
    ds_read_b64_tr_b16 v[114:115], v28 offset:4096
    v_mfma_f32_16x16x32_bf16 v[212:215], v[100:103], v[172:175], v[212:215]
    ds_read_b64_tr_b16 v[116:117], v28 offset:8192
    v_mfma_f32_16x16x32_bf16 v[212:215], v[96:99], v[164:167], v[212:215]
    ds_read_b64_tr_b16 v[118:119], v28 offset:12288
    s_waitcnt lgkmcnt(4)
    v_mfma_f32_16x16x32_bf16 v[220:223], v[104:107], v[164:167], v[220:223]
    ds_read_b64_tr_b16 v[120:121], v28 offset:16384
    v_mfma_f32_16x16x32_bf16 v[220:223], v[108:111], v[172:175], v[220:223]
    ds_read_b64_tr_b16 v[122:123], v28 offset:20480
    v_mfma_f32_16x16x32_bf16 v[216:219], v[108:111], v[168:171], v[216:219]
    ds_read_b64_tr_b16 v[124:125], v28 offset:24576
    v_mfma_f32_16x16x32_bf16 v[216:219], v[104:107], v[160:163], v[216:219]
    ds_read_b64_tr_b16 v[126:127], v28 offset:28672
    s_waitcnt lgkmcnt(4)
    v_mfma_f32_16x16x32_bf16 v[224:227], v[112:115], v[56:59], v[224:227]
    ds_read_b64_tr_b16 v[96:97], v28 offset:32768
    v_mfma_f32_16x16x32_bf16 v[224:227], v[116:119], v[64:67], v[224:227]
    ds_read_b64_tr_b16 v[98:99], v28 offset:36864
    s_xor_b32 s3, s9, 0x10000
    s_xor_b32 s81, s92, 1028
    v_cvt_pk_bf16_f32 v208, v208, v209
    v_cvt_pk_bf16_f32 v209, v210, v211
    v_cvt_pk_bf16_f32 v210, v212, v213
    v_cvt_pk_bf16_f32 v211, v214, v215
    v_mfma_f32_16x16x32_bf16 v[228:231], v[116:119], v[68:71], v[228:231]
    ds_read_b64_tr_b16 v[100:101], v28 offset:40960
    v_mfma_f32_16x16x32_bf16 v[228:231], v[112:115], v[60:63], v[228:231]
    ds_read_b64_tr_b16 v[102:103], v28 offset:45056
    ds_read_b64 v[88:89], v13 offset:0
    ds_read_b64 v[90:91], v15 offset:0
    buffer_store_dwordx4 v[208:211], v2, s[24:27], s3 offen offset:0 sc1
    v_cvt_pk_bf16_f32 v212, v216, v217
    v_cvt_pk_bf16_f32 v213, v218, v219
    v_cvt_pk_bf16_f32 v214, v220, v221
    v_cvt_pk_bf16_f32 v215, v222, v223
    s_waitcnt lgkmcnt(6)
    v_mfma_f32_16x16x32_bf16 v[228:231], v[120:123], v[76:79], v[228:231]
    ds_read_b64_tr_b16 v[104:105], v28 offset:49152
    v_mfma_f32_16x16x32_bf16 v[228:231], v[124:127], v[84:87], v[228:231]
    ds_read_b64_tr_b16 v[106:107], v28 offset:53248
    ds_read_b64 v[92:93], v13 offset:1024
    ds_read_b64 v[94:95], v15 offset:1024
    buffer_store_dwordx4 v[212:215], v2, s[24:27], s3 offen offset:1024 sc1
    v_mfma_f32_16x16x32_bf16 v[224:227], v[124:127], v[80:83], v[224:227]
    ds_read_b64_tr_b16 v[108:109], v28 offset:57344
    v_mfma_f32_16x16x32_bf16 v[224:227], v[120:123], v[72:75], v[224:227]
    ds_read_b64_tr_b16 v[110:111], v28 offset:61440
    s_waitcnt lgkmcnt(8)
    v_mfma_f32_16x16x32_bf16 v[224:227], v[96:99], v[176:179], v[224:227]
    v_xor_b32 v28, 0x10000, v28
    ds_read_b64_tr_b16 v[112:113], v28 offset:0
    v_mfma_f32_16x16x32_bf16 v[224:227], v[100:103], v[184:187], v[224:227]
    ds_read_b64_tr_b16 v[114:115], v28 offset:4096
    s_waitcnt lgkmcnt(4)
    v_lshlrev_b32 v208, 16, v88
    v_mfma_f32_16x16x32_bf16 v[228:231], v[100:103], v[188:191], v[228:231]
    ds_read_b64_tr_b16 v[116:117], v28 offset:8192
    v_mfma_f32_16x16x32_bf16 v[228:231], v[96:99], v[180:183], v[228:231]
    ds_read_b64_tr_b16 v[118:119], v28 offset:12288
    v_and_b32 v209, 0xffff0000, v88
    s_waitcnt lgkmcnt(4)
    v_mfma_f32_16x16x32_bf16 v[228:231], v[104:107], v[132:135], v[228:231]
    ds_read_b64_tr_b16 v[120:121], v28 offset:16384
    v_mfma_f32_16x16x32_bf16 v[228:231], v[108:111], v[140:143], v[228:231]
    ds_read_b64_tr_b16 v[122:123], v28 offset:20480
    v_lshlrev_b32 v210, 16, v89
    v_mfma_f32_16x16x32_bf16 v[224:227], v[108:111], v[136:139], v[224:227]
    ds_read_b64_tr_b16 v[124:125], v28 offset:24576
    v_mfma_f32_16x16x32_bf16 v[224:227], v[104:107], v[128:131], v[224:227]
    ds_read_b64_tr_b16 v[126:127], v28 offset:28672
    s_waitcnt lgkmcnt(4)
    v_mfma_f32_16x16x32_bf16 v[224:227], v[112:115], v[144:147], v[224:227]
    v_xor_b32 v29, 0x10000, v29
    ds_read_b64_tr_b16 v[96:97], v29 offset:0
    v_mfma_f32_16x16x32_bf16 v[224:227], v[116:119], v[152:155], v[224:227]
    ds_read_b64_tr_b16 v[98:99], v29 offset:4096
    v_and_b32 v211, 0xffff0000, v89
    v_mfma_f32_16x16x32_bf16 v[228:231], v[116:119], v[156:159], v[228:231]
    ds_read_b64_tr_b16 v[100:101], v29 offset:8192
    v_mfma_f32_16x16x32_bf16 v[228:231], v[112:115], v[148:151], v[228:231]
    ds_read_b64_tr_b16 v[102:103], v29 offset:12288
    v_lshlrev_b32 v212, 16, v92
    s_waitcnt lgkmcnt(4)
    v_mfma_f32_16x16x32_bf16 v[228:231], v[120:123], v[164:167], v[228:231]
    ds_read_b64_tr_b16 v[104:105], v29 offset:16384
    v_mfma_f32_16x16x32_bf16 v[228:231], v[124:127], v[172:175], v[228:231]
    ds_read_b64_tr_b16 v[106:107], v29 offset:20480
    v_and_b32 v213, 0xffff0000, v92
    v_mfma_f32_16x16x32_bf16 v[224:227], v[124:127], v[168:171], v[224:227]
    ds_read_b64_tr_b16 v[108:109], v29 offset:24576
    v_mfma_f32_16x16x32_bf16 v[224:227], v[120:123], v[160:163], v[224:227]
    ds_read_b64_tr_b16 v[110:111], v29 offset:28672
    v_lshlrev_b32 v214, 16, v93
    s_waitcnt lgkmcnt(4)
    v_mfma_f32_16x16x32_bf16 v[232:235], v[96:99], v[56:59], v[232:235]
    ds_read_b64_tr_b16 v[112:113], v29 offset:32768
    v_mfma_f32_16x16x32_bf16 v[232:235], v[100:103], v[64:67], v[232:235]
    ds_read_b64_tr_b16 v[114:115], v29 offset:36864
    v_and_b32 v215, 0xffff0000, v93
    v_mfma_f32_16x16x32_bf16 v[236:239], v[100:103], v[68:71], v[236:239]
    ds_read_b64_tr_b16 v[116:117], v29 offset:40960
    v_mfma_f32_16x16x32_bf16 v[236:239], v[96:99], v[60:63], v[236:239]
    ds_read_b64_tr_b16 v[118:119], v29 offset:45056
    s_waitcnt lgkmcnt(4)
    v_mfma_f32_16x16x32_bf16 v[236:239], v[104:107], v[76:79], v[236:239]
    ds_read_b64_tr_b16 v[120:121], v29 offset:49152
    v_mfma_f32_16x16x32_bf16 v[236:239], v[108:111], v[84:87], v[236:239]
    ds_read_b64_tr_b16 v[122:123], v29 offset:53248
    v_lshlrev_b32 v216, 16, v90
    v_mfma_f32_16x16x32_bf16 v[232:235], v[108:111], v[80:83], v[232:235]
    ds_read_b64_tr_b16 v[124:125], v29 offset:57344
    v_mfma_f32_16x16x32_bf16 v[232:235], v[104:107], v[72:75], v[232:235]
    ds_read_b64_tr_b16 v[126:127], v29 offset:61440
    v_and_b32 v217, 0xffff0000, v90
    s_waitcnt lgkmcnt(4)
    v_mfma_f32_16x16x32_bf16 v[232:235], v[112:115], v[176:179], v[232:235]
    v_xor_b32 v29, 0x10000, v29
    ds_read_b64_tr_b16 v[96:97], v29 offset:0
    v_mfma_f32_16x16x32_bf16 v[232:235], v[116:119], v[184:187], v[232:235]
    ds_read_b64_tr_b16 v[98:99], v29 offset:4096
    v_lshlrev_b32 v218, 16, v91
    v_mfma_f32_16x16x32_bf16 v[236:239], v[116:119], v[188:191], v[236:239]
    ds_read_b64_tr_b16 v[100:101], v29 offset:8192
    v_mfma_f32_16x16x32_bf16 v[236:239], v[112:115], v[180:183], v[236:239]
    ds_read_b64_tr_b16 v[102:103], v29 offset:12288
    v_and_b32 v219, 0xffff0000, v91
    s_waitcnt lgkmcnt(4)
    v_mfma_f32_16x16x32_bf16 v[236:239], v[120:123], v[132:135], v[236:239]
    ds_read_b64_tr_b16 v[104:105], v29 offset:16384
    v_mfma_f32_16x16x32_bf16 v[236:239], v[124:127], v[140:143], v[236:239]
    ds_read_b64_tr_b16 v[106:107], v29 offset:20480
    v_mfma_f32_16x16x32_bf16 v[232:235], v[124:127], v[136:139], v[232:235]
    ds_read_b64_tr_b16 v[108:109], v29 offset:24576
    v_mfma_f32_16x16x32_bf16 v[232:235], v[120:123], v[128:131], v[232:235]
    ds_read_b64_tr_b16 v[110:111], v29 offset:28672
    v_lshlrev_b32 v220, 16, v94
    s_waitcnt lgkmcnt(4)
    v_mfma_f32_16x16x32_bf16 v[232:235], v[96:99], v[144:147], v[232:235]
    v_xor_b32 v30, 0x10000, v30
    ds_read_b64_tr_b16 v[112:113], v30 offset:0
    v_mfma_f32_16x16x32_bf16 v[232:235], v[100:103], v[152:155], v[232:235]
    ds_read_b64_tr_b16 v[114:115], v30 offset:4096
    v_and_b32 v221, 0xffff0000, v94
    v_mfma_f32_16x16x32_bf16 v[236:239], v[100:103], v[156:159], v[236:239]
    ds_read_b64_tr_b16 v[116:117], v30 offset:8192
    v_mfma_f32_16x16x32_bf16 v[236:239], v[96:99], v[148:151], v[236:239]
    ds_read_b64_tr_b16 v[118:119], v30 offset:12288
    v_lshlrev_b32 v222, 16, v95
    s_waitcnt lgkmcnt(4)
    v_mfma_f32_16x16x32_bf16 v[236:239], v[104:107], v[164:167], v[236:239]
    ds_read_b64_tr_b16 v[120:121], v30 offset:16384
    v_mfma_f32_16x16x32_bf16 v[236:239], v[108:111], v[172:175], v[236:239]
    ds_read_b64_tr_b16 v[122:123], v30 offset:20480
    v_and_b32 v223, 0xffff0000, v95
    v_mfma_f32_16x16x32_bf16 v[232:235], v[108:111], v[168:171], v[232:235]
    ds_read_b64_tr_b16 v[124:125], v30 offset:24576
    v_mfma_f32_16x16x32_bf16 v[232:235], v[104:107], v[160:163], v[232:235]
    ds_read_b64_tr_b16 v[126:127], v30 offset:28672
    s_waitcnt vmcnt(0)
    s_mov_b64 exec, 1
    buffer_store_dword v33, off, s[24:27], s81 sc1
    s_mov_b64 exec, -1
    s_waitcnt lgkmcnt(4)
    v_mfma_f32_16x16x32_bf16 v[240:243], v[112:115], v[56:59], v[240:243]
    ds_read_b64_tr_b16 v[96:97], v30 offset:32768
    v_mfma_f32_16x16x32_bf16 v[240:243], v[116:119], v[64:67], v[240:243]
    ds_read_b64_tr_b16 v[98:99], v30 offset:36864
    s_xor_b32 s3, s10, 0x20000
    s_xor_b32 s82, s92, 2056
    v_cvt_pk_bf16_f32 v224, v224, v225
    v_cvt_pk_bf16_f32 v225, v226, v227
    v_cvt_pk_bf16_f32 v226, v228, v229
    v_cvt_pk_bf16_f32 v227, v230, v231
    v_mfma_f32_16x16x32_bf16 v[244:247], v[116:119], v[68:71], v[244:247]
    ds_read_b64_tr_b16 v[100:101], v30 offset:40960
    v_mfma_f32_16x16x32_bf16 v[244:247], v[112:115], v[60:63], v[244:247]
    ds_read_b64_tr_b16 v[102:103], v30 offset:45056
    buffer_store_dwordx4 v[224:227], v2, s[24:27], s3 offen offset:0 sc1
    v_cvt_pk_bf16_f32 v228, v232, v233
    v_cvt_pk_bf16_f32 v229, v234, v235
    v_cvt_pk_bf16_f32 v230, v236, v237
    v_cvt_pk_bf16_f32 v231, v238, v239
    s_waitcnt lgkmcnt(4)
    v_mfma_f32_16x16x32_bf16 v[244:247], v[120:123], v[76:79], v[244:247]
    ds_read_b64_tr_b16 v[104:105], v30 offset:49152
    v_mfma_f32_16x16x32_bf16 v[244:247], v[124:127], v[84:87], v[244:247]
    ds_read_b64_tr_b16 v[106:107], v30 offset:53248
    buffer_store_dwordx4 v[228:231], v2, s[24:27], s3 offen offset:1024 sc1
    v_mfma_f32_16x16x32_bf16 v[240:243], v[124:127], v[80:83], v[240:243]
    ds_read_b64_tr_b16 v[108:109], v30 offset:57344
    v_mfma_f32_16x16x32_bf16 v[240:243], v[120:123], v[72:75], v[240:243]
    ds_read_b64_tr_b16 v[110:111], v30 offset:61440
    s_waitcnt lgkmcnt(4)
    v_mfma_f32_16x16x32_bf16 v[240:243], v[96:99], v[176:179], v[240:243]
    v_xor_b32 v30, 0x10000, v30
    ds_read_b64_tr_b16 v[112:113], v30 offset:0
    v_mfma_f32_16x16x32_bf16 v[240:243], v[100:103], v[184:187], v[240:243]
    ds_read_b64_tr_b16 v[114:115], v30 offset:4096
    v_mfma_f32_16x16x32_bf16 v[244:247], v[100:103], v[188:191], v[244:247]
    ds_read_b64_tr_b16 v[116:117], v30 offset:8192
    v_mfma_f32_16x16x32_bf16 v[244:247], v[96:99], v[180:183], v[244:247]
    ds_read_b64_tr_b16 v[118:119], v30 offset:12288
    s_waitcnt lgkmcnt(4)
    v_mfma_f32_16x16x32_bf16 v[244:247], v[104:107], v[132:135], v[244:247]
    ds_read_b64_tr_b16 v[120:121], v30 offset:16384
    v_mfma_f32_16x16x32_bf16 v[244:247], v[108:111], v[140:143], v[244:247]
    ds_read_b64_tr_b16 v[122:123], v30 offset:20480
    v_mfma_f32_16x16x32_bf16 v[240:243], v[108:111], v[136:139], v[240:243]
    ds_read_b64_tr_b16 v[124:125], v30 offset:24576
    v_mfma_f32_16x16x32_bf16 v[240:243], v[104:107], v[128:131], v[240:243]
    ds_read_b64_tr_b16 v[126:127], v30 offset:28672
    s_waitcnt lgkmcnt(4)
    v_mfma_f32_16x16x32_bf16 v[240:243], v[112:115], v[144:147], v[240:243]
    v_xor_b32 v31, 0x10000, v31
    ds_read_b64_tr_b16 v[96:97], v31 offset:0
    v_mfma_f32_16x16x32_bf16 v[240:243], v[116:119], v[152:155], v[240:243]
    ds_read_b64_tr_b16 v[98:99], v31 offset:4096
    v_mfma_f32_16x16x32_bf16 v[244:247], v[116:119], v[156:159], v[244:247]
    ds_read_b64_tr_b16 v[100:101], v31 offset:8192
    v_mfma_f32_16x16x32_bf16 v[244:247], v[112:115], v[148:151], v[244:247]
    ds_read_b64_tr_b16 v[102:103], v31 offset:12288
    s_waitcnt lgkmcnt(4)
    v_mfma_f32_16x16x32_bf16 v[244:247], v[120:123], v[164:167], v[244:247]
    ds_read_b64_tr_b16 v[104:105], v31 offset:16384
    v_mfma_f32_16x16x32_bf16 v[244:247], v[124:127], v[172:175], v[244:247]
    ds_read_b64_tr_b16 v[106:107], v31 offset:20480
    v_mfma_f32_16x16x32_bf16 v[240:243], v[124:127], v[168:171], v[240:243]
    ds_read_b64_tr_b16 v[108:109], v31 offset:24576
    v_mfma_f32_16x16x32_bf16 v[240:243], v[120:123], v[160:163], v[240:243]
    ds_read_b64_tr_b16 v[110:111], v31 offset:28672
    s_waitcnt lgkmcnt(4)
    v_mfma_f32_16x16x32_bf16 v[248:251], v[96:99], v[56:59], v[248:251]
    ds_read_b64_tr_b16 v[112:113], v31 offset:32768
    v_mfma_f32_16x16x32_bf16 v[248:251], v[100:103], v[64:67], v[248:251]
    ds_read_b64_tr_b16 v[114:115], v31 offset:36864
    v_mfma_f32_16x16x32_bf16 v[252:255], v[100:103], v[68:71], v[252:255]
    ds_read_b64_tr_b16 v[116:117], v31 offset:40960
    v_mfma_f32_16x16x32_bf16 v[252:255], v[96:99], v[60:63], v[252:255]
    ds_read_b64_tr_b16 v[118:119], v31 offset:45056
    s_waitcnt lgkmcnt(4)
    v_mfma_f32_16x16x32_bf16 v[252:255], v[104:107], v[76:79], v[252:255]
    ds_read_b64_tr_b16 v[120:121], v31 offset:49152
    v_mfma_f32_16x16x32_bf16 v[252:255], v[108:111], v[84:87], v[252:255]
    ds_read_b64_tr_b16 v[122:123], v31 offset:53248
    v_mfma_f32_16x16x32_bf16 v[248:251], v[108:111], v[80:83], v[248:251]
    ds_read_b64_tr_b16 v[124:125], v31 offset:57344
    v_mfma_f32_16x16x32_bf16 v[248:251], v[104:107], v[72:75], v[248:251]
    ds_read_b64_tr_b16 v[126:127], v31 offset:61440
    s_waitcnt lgkmcnt(4)
    v_mfma_f32_16x16x32_bf16 v[248:251], v[112:115], v[176:179], v[248:251]
    v_xor_b32 v31, 0x10000, v31
    ds_read_b64_tr_b16 v[96:97], v31 offset:0
    v_mfma_f32_16x16x32_bf16 v[248:251], v[116:119], v[184:187], v[248:251]
    ds_read_b64_tr_b16 v[98:99], v31 offset:4096
    v_mfma_f32_16x16x32_bf16 v[252:255], v[116:119], v[188:191], v[252:255]
    ds_read_b64_tr_b16 v[100:101], v31 offset:8192
    v_mfma_f32_16x16x32_bf16 v[252:255], v[112:115], v[180:183], v[252:255]
    ds_read_b64_tr_b16 v[102:103], v31 offset:12288
    s_waitcnt lgkmcnt(4)
    v_mfma_f32_16x16x32_bf16 v[252:255], v[120:123], v[132:135], v[252:255]
    ds_read_b64_tr_b16 v[104:105], v31 offset:16384
    v_mfma_f32_16x16x32_bf16 v[252:255], v[124:127], v[140:143], v[252:255]
    ds_read_b64_tr_b16 v[106:107], v31 offset:20480
    v_mfma_f32_16x16x32_bf16 v[248:251], v[124:127], v[136:139], v[248:251]
    ds_read_b64_tr_b16 v[108:109], v31 offset:24576
    v_mfma_f32_16x16x32_bf16 v[248:251], v[120:123], v[128:131], v[248:251]
    ds_read_b64_tr_b16 v[110:111], v31 offset:28672
    s_waitcnt lgkmcnt(4)
    v_mfma_f32_16x16x32_bf16 v[248:251], v[96:99], v[144:147], v[248:251]
    ds_read_b64_tr_b16 v[112:113], v24 offset:49152
    v_mfma_f32_16x16x32_bf16 v[248:251], v[100:103], v[152:155], v[248:251]
    ds_read_b64_tr_b16 v[114:115], v24 offset:53248
    v_mfma_f32_16x16x32_bf16 v[252:255], v[100:103], v[156:159], v[252:255]
    ds_read_b64_tr_b16 v[116:117], v24 offset:57344
    v_mfma_f32_16x16x32_bf16 v[252:255], v[96:99], v[148:151], v[252:255]
    ds_read_b64_tr_b16 v[118:119], v24 offset:61440
    s_waitcnt lgkmcnt(4)
    v_mfma_f32_16x16x32_bf16 v[252:255], v[104:107], v[164:167], v[252:255]
    v_xor_b32 v24, 0x10000, v24
    ds_read_b64_tr_b16 v[120:121], v24 offset:0
    v_mfma_f32_16x16x32_bf16 v[252:255], v[108:111], v[172:175], v[252:255]
    ds_read_b64_tr_b16 v[122:123], v24 offset:4096
    v_mfma_f32_16x16x32_bf16 v[248:251], v[108:111], v[168:171], v[248:251]
    ds_read_b64_tr_b16 v[124:125], v24 offset:8192
    v_mfma_f32_16x16x32_bf16 v[248:251], v[104:107], v[160:163], v[248:251]
    ds_read_b64_tr_b16 v[126:127], v24 offset:12288
    s_waitcnt vmcnt(0)
    s_mov_b64 exec, 1
    buffer_store_dword v33, off, s[24:27], s82 sc1
    s_mov_b64 exec, -1
    s_waitcnt lgkmcnt(4)
    v_mfma_f32_16x16x32_bf16 v[192:195], v[112:115], v[40:43], v[192:195]
    ds_read_b64_tr_b16 v[96:97], v24 offset:16384
    v_mfma_f32_16x16x32_bf16 v[192:195], v[116:119], v[48:51], v[192:195]
    ds_read_b64_tr_b16 v[98:99], v24 offset:20480
    s_xor_b32 s3, s11, 0x30000
    s_xor_b32 s83, s92, 3084
    v_cvt_pk_bf16_f32 v240, v240, v241
    v_cvt_pk_bf16_f32 v241, v242, v243
    v_cvt_pk_bf16_f32 v242, v244, v245
    v_cvt_pk_bf16_f32 v243, v246, v247
    v_mfma_f32_16x16x32_bf16 v[196:199], v[116:119], v[52:55], v[196:199]
    ds_read_b64_tr_b16 v[100:101], v24 offset:24576
    v_mfma_f32_16x16x32_bf16 v[196:199], v[112:115], v[44:47], v[196:199]
    ds_read_b64_tr_b16 v[102:103], v24 offset:28672
    buffer_store_dwordx4 v[240:243], v2, s[24:27], s3 offen offset:0 sc1
    v_cvt_pk_bf16_f32 v244, v248, v249
    v_cvt_pk_bf16_f32 v245, v250, v251
    v_cvt_pk_bf16_f32 v246, v252, v253
    v_cvt_pk_bf16_f32 v247, v254, v255
    s_waitcnt lgkmcnt(4)
    v_mfma_f32_16x16x32_bf16 v[196:199], v[120:123], v[60:63], v[196:199]
    ds_read_b64_tr_b16 v[104:105], v24 offset:32768
    v_mfma_f32_16x16x32_bf16 v[196:199], v[124:127], v[68:71], v[196:199]
    ds_read_b64_tr_b16 v[106:107], v24 offset:36864
    buffer_store_dwordx4 v[244:247], v2, s[24:27], s3 offen offset:1024 sc1
    s_setprio 0
    v_mfma_f32_16x16x32_bf16 v[192:195], v[124:127], v[64:67], v[192:195]
    ds_read_b64_tr_b16 v[108:109], v24 offset:40960
    v_mfma_f32_16x16x32_bf16 v[192:195], v[120:123], v[56:59], v[192:195]
    ds_read_b64_tr_b16 v[110:111], v24 offset:45056
    s_waitcnt lgkmcnt(4)
    v_mfma_f32_16x16x32_bf16 v[192:195], v[96:99], v[72:75], v[192:195]
    ds_read_b64_tr_b16 v[112:113], v24 offset:49152
    v_mfma_f32_16x16x32_bf16 v[192:195], v[100:103], v[80:83], v[192:195]
    ds_read_b64_tr_b16 v[114:115], v24 offset:53248
    v_mfma_f32_16x16x32_bf16 v[196:199], v[100:103], v[84:87], v[196:199]
    ds_read_b64_tr_b16 v[116:117], v24 offset:57344
    v_mfma_f32_16x16x32_bf16 v[196:199], v[96:99], v[76:79], v[196:199]
    ds_read_b64_tr_b16 v[118:119], v24 offset:61440
    s_waitcnt lgkmcnt(4)
    v_mfma_f32_16x16x32_bf16 v[196:199], v[104:107], v[180:183], v[196:199]
    v_xor_b32 v24, 0x10000, v24
    ds_read_b64_tr_b16 v[120:121], v24 offset:0
    v_mfma_f32_16x16x32_bf16 v[196:199], v[108:111], v[188:191], v[196:199]
    ds_read_b64_tr_b16 v[122:123], v24 offset:4096
    v_mfma_f32_16x16x32_bf16 v[192:195], v[108:111], v[184:187], v[192:195]
    ds_read_b64_tr_b16 v[124:125], v24 offset:8192
    v_mfma_f32_16x16x32_bf16 v[192:195], v[104:107], v[176:179], v[192:195]
    ds_read_b64_tr_b16 v[126:127], v24 offset:12288
    s_waitcnt lgkmcnt(4)
    v_mfma_f32_16x16x32_bf16 v[192:195], v[112:115], v[128:131], v[192:195]
    ds_read_b64_tr_b16 v[96:97], v24 offset:16384
    v_mfma_f32_16x16x32_bf16 v[192:195], v[116:119], v[136:139], v[192:195]
    ds_read_b64_tr_b16 v[98:99], v24 offset:20480
    buffer_load_dword v34, v32, s[24:27], s92 offen offset:4 sc1
    v_mfma_f32_16x16x32_bf16 v[196:199], v[116:119], v[140:143], v[196:199]
    ds_read_b64_tr_b16 v[100:101], v24 offset:24576
    v_mfma_f32_16x16x32_bf16 v[196:199], v[112:115], v[132:135], v[196:199]
    ds_read_b64_tr_b16 v[102:103], v24 offset:28672
    s_waitcnt lgkmcnt(4)
    v_mfma_f32_16x16x32_bf16 v[196:199], v[120:123], v[148:151], v[196:199]
    ds_read_b64_tr_b16 v[104:105], v25 offset:49152
    v_mfma_f32_16x16x32_bf16 v[196:199], v[124:127], v[156:159], v[196:199]
    ds_read_b64_tr_b16 v[106:107], v25 offset:53248
    v_mfma_f32_16x16x32_bf16 v[192:195], v[124:127], v[152:155], v[192:195]
    ds_read_b64_tr_b16 v[108:109], v25 offset:57344
    v_mfma_f32_16x16x32_bf16 v[192:195], v[120:123], v[144:147], v[192:195]
    ds_read_b64_tr_b16 v[110:111], v25 offset:61440
    s_waitcnt lgkmcnt(4)
    v_mfma_f32_16x16x32_bf16 v[192:195], v[96:99], v[160:163], v[192:195]
    v_xor_b32 v25, 0x10000, v25
    ds_read_b64_tr_b16 v[112:113], v25 offset:0
    v_mfma_f32_16x16x32_bf16 v[192:195], v[100:103], v[168:171], v[192:195]
    ds_read_b64_tr_b16 v[114:115], v25 offset:4096
    s_waitcnt vmcnt(1)
    s_mov_b64 exec, 1
    buffer_store_dword v33, off, s[24:27], s83 sc1
    s_mov_b64 exec, -1
    v_mfma_f32_16x16x32_bf16 v[196:199], v[100:103], v[172:175], v[196:199]
    ds_read_b64_tr_b16 v[116:117], v25 offset:8192
    v_mfma_f32_16x16x32_bf16 v[196:199], v[96:99], v[164:167], v[196:199]
    ds_read_b64_tr_b16 v[118:119], v25 offset:12288
    s_waitcnt lgkmcnt(4)
    v_mfma_f32_16x16x32_bf16 v[204:207], v[104:107], v[44:47], v[204:207]
    ds_read_b64_tr_b16 v[120:121], v25 offset:16384
    v_mfma_f32_16x16x32_bf16 v[204:207], v[108:111], v[52:55], v[204:207]
    ds_read_b64_tr_b16 v[122:123], v25 offset:20480
    v_mfma_f32_16x16x32_bf16 v[200:203], v[108:111], v[48:51], v[200:203]
    ds_read_b64_tr_b16 v[124:125], v25 offset:24576
    v_mfma_f32_16x16x32_bf16 v[200:203], v[104:107], v[40:43], v[200:203]
    ds_read_b64_tr_b16 v[126:127], v25 offset:28672
    s_waitcnt lgkmcnt(4)
    v_mfma_f32_16x16x32_bf16 v[200:203], v[112:115], v[56:59], v[200:203]
    ds_read_b64_tr_b16 v[96:97], v25 offset:32768
    v_mfma_f32_16x16x32_bf16 v[200:203], v[116:119], v[64:67], v[200:203]
    ds_read_b64_tr_b16 v[98:99], v25 offset:36864
    s_waitcnt vmcnt(1)
    s_mov_b32 s7, 0
L_pa:
    v_cmp_ne_u32 vcc, s58, v34
    s_nop 0
    s_cmp_eq_u64 vcc, 0
    s_cbranch_scc1 L_pa_ok
    s_add_u32 s7, s7, 1
    s_cmp_ge_u32 s7, 0x20000
    s_cbranch_scc1 L_pa_ok
    s_sleep 1
    buffer_load_dword v34, v32, s[24:27], s92 offen offset:4 sc1
    s_waitcnt vmcnt(0)
    s_branch L_pa
L_pa_ok:
    buffer_load_dwordx4 v[224:227], v2, s[24:27], s9 offen offset:0 sc1
    buffer_load_dwordx4 v[228:231], v2, s[24:27], s9 offen offset:1024 sc1
    v_mfma_f32_16x16x32_bf16 v[204:207], v[116:119], v[68:71], v[204:207]
    ds_read_b64_tr_b16 v[100:101], v25 offset:40960
    v_mfma_f32_16x16x32_bf16 v[204:207], v[112:115], v[60:63], v[204:207]
    ds_read_b64_tr_b16 v[102:103], v25 offset:45056
    buffer_load_dwordx4 v[232:235], v2, s[24:27], s10 offen offset:0 sc1
    buffer_load_dwordx4 v[236:239], v2, s[24:27], s10 offen offset:1024 sc1
    s_waitcnt lgkmcnt(4)
    v_mfma_f32_16x16x32_bf16 v[204:207], v[120:123], v[76:79], v[204:207]
    ds_read_b64_tr_b16 v[104:105], v25 offset:49152
    v_mfma_f32_16x16x32_bf16 v[204:207], v[124:127], v[84:87], v[204:207]
    ds_read_b64_tr_b16 v[106:107], v25 offset:53248
    v_mfma_f32_16x16x32_bf16 v[200:203], v[124:127], v[80:83], v[200:203]
    ds_read_b64_tr_b16 v[108:109], v25 offset:57344
    v_mfma_f32_16x16x32_bf16 v[200:203], v[120:123], v[72:75], v[200:203]
    ds_read_b64_tr_b16 v[110:111], v25 offset:61440
    s_waitcnt lgkmcnt(4)
    v_mfma_f32_16x16x32_bf16 v[200:203], v[96:99], v[176:179], v[200:203]
    v_xor_b32 v25, 0x10000, v25
    ds_read_b64_tr_b16 v[112:113], v25 offset:0
    v_mfma_f32_16x16x32_bf16 v[200:203], v[100:103], v[184:187], v[200:203]
    ds_read_b64_tr_b16 v[114:115], v25 offset:4096
    v_mfma_f32_16x16x32_bf16 v[204:207], v[100:103], v[188:191], v[204:207]
    ds_read_b64_tr_b16 v[116:117], v25 offset:8192
    v_mfma_f32_16x16x32_bf16 v[204:207], v[96:99], v[180:183], v[204:207]
    ds_read_b64_tr_b16 v[118:119], v25 offset:12288
    s_waitcnt lgkmcnt(4)
    v_mfma_f32_16x16x32_bf16 v[204:207], v[104:107], v[132:135], v[204:207]
    ds_read_b64_tr_b16 v[120:121], v25 offset:16384
    v_mfma_f32_16x16x32_bf16 v[204:207], v[108:111], v[140:143], v[204:207]
    ds_read_b64_tr_b16 v[122:123], v25 offset:20480
    v_mfma_f32_16x16x32_bf16 v[200:203], v[108:111], v[136:139], v[200:203]
    ds_read_b64_tr_b16 v[124:125], v25 offset:24576
    v_mfma_f32_16x16x32_bf16 v[200:203], v[104:107], v[128:131], v[200:203]
    ds_read_b64_tr_b16 v[126:127], v25 offset:28672
    s_waitcnt lgkmcnt(4)
    v_mfma_f32_16x16x32_bf16 v[200:203], v[112:115], v[144:147], v[200:203]
    v_mfma_f32_16x16x32_bf16 v[200:203], v[116:119], v[152:155], v[200:203]
    buffer_load_dword v34, off, s[24:27], s92 offset:12 sc1
    v_mfma_f32_16x16x32_bf16 v[204:207], v[116:119], v[156:159], v[204:207]
    v_mfma_f32_16x16x32_bf16 v[204:207], v[112:115], v[148:151], v[204:207]
    s_waitcnt lgkmcnt(0)
    v_mfma_f32_16x16x32_bf16 v[204:207], v[120:123], v[164:167], v[204:207]
    v_mfma_f32_16x16x32_bf16 v[204:207], v[124:127], v[172:175], v[204:207]
    v_mfma_f32_16x16x32_bf16 v[200:203], v[124:127], v[168:171], v[200:203]
    v_mfma_f32_16x16x32_bf16 v[200:203], v[120:123], v[160:163], v[200:203]
    s_waitcnt vmcnt(0)
    s_mov_b32 s7, 0
L_pp:
    v_cmp_ne_u32 vcc, s58, v34
    s_nop 0
    s_cmp_eq_u64 vcc, 0
    s_cbranch_scc1 L_pp_ok
    s_add_u32 s7, s7, 1
    s_cmp_ge_u32 s7, 0x20000
    s_cbranch_scc1 L_pp_ok
    buffer_load_dword v34, off, s[24:27], s92 offset:12 sc1
    s_waitcnt vmcnt(0)
    s_branch L_pp
L_pp_ok:
    buffer_load_dwordx4 v[240:243], v2, s[24:27], s11 offen offset:0 sc1
    buffer_load_dwordx4 v[244:247], v2, s[24:27], s11 offen offset:1024 sc1
    v_lshlrev_b32 v96, 16, v224
    v_and_b32 v97, 0xffff0000, v224
    v_lshlrev_b32 v98, 16, v225
    v_and_b32 v99, 0xffff0000, v225
    v_lshlrev_b32 v100, 16, v226
    v_and_b32 v101, 0xffff0000, v226
    v_lshlrev_b32 v102, 16, v227
    v_and_b32 v103, 0xffff0000, v227
    v_lshlrev_b32 v104, 16, v228
    v_and_b32 v105, 0xffff0000, v228
    v_lshlrev_b32 v106, 16, v229
    v_and_b32 v107, 0xffff0000, v229
    v_lshlrev_b32 v108, 16, v230
    v_and_b32 v109, 0xffff0000, v230
    v_lshlrev_b32 v110, 16, v231
    v_and_b32 v111, 0xffff0000, v231
    v_pk_add_f32 v[208:209], v[208:209], v[96:97]
    v_pk_add_f32 v[210:211], v[210:211], v[98:99]
    v_pk_add_f32 v[212:213], v[212:213], v[100:101]
    v_pk_add_f32 v[214:215], v[214:215], v[102:103]
    v_pk_add_f32 v[216:217], v[216:217], v[104:105]
    v_pk_add_f32 v[218:219], v[218:219], v[106:107]
    v_pk_add_f32 v[220:221], v[220:221], v[108:109]
    v_pk_add_f32 v[222:223], v[222:223], v[110:111]
    v_lshlrev_b32 v96, 16, v232
    v_and_b32 v97, 0xffff0000, v232
    v_lshlrev_b32 v98, 16, v233
    v_and_b32 v99, 0xffff0000, v233
    v_lshlrev_b32 v100, 16, v234
    v_and_b32 v101, 0xffff0000, v234
    v_lshlrev_b32 v102, 16, v235
    v_and_b32 v103, 0xffff0000, v235
    v_lshlrev_b32 v104, 16, v236
    v_and_b32 v105, 0xffff0000, v236
    v_lshlrev_b32 v106, 16, v237
    v_and_b32 v107, 0xffff0000, v237
    v_lshlrev_b32 v108, 16, v238
    v_and_b32 v109, 0xffff0000, v238
    v_lshlrev_b32 v110, 16, v239
    v_and_b32 v111, 0xffff0000, v239
    v_pk_add_f32 v[208:209], v[208:209], v[96:97]
    v_pk_add_f32 v[210:211], v[210:211], v[98:99]
    v_pk_add_f32 v[212:213], v[212:213], v[100:101]
    v_pk_add_f32 v[214:215], v[214:215], v[102:103]
    v_pk_add_f32 v[216:217], v[216:217], v[104:105]
    v_pk_add_f32 v[218:219], v[218:219], v[106:107]
    v_pk_add_f32 v[220:221], v[220:221], v[108:109]
    v_pk_add_f32 v[222:223], v[222:223], v[110:111]
    v_pk_add_f32 v[208:209], v[208:209], v[192:193]
    v_pk_add_f32 v[210:211], v[210:211], v[194:195]
    v_pk_add_f32 v[212:213], v[212:213], v[196:197]
    v_pk_add_f32 v[214:215], v[214:215], v[198:199]
    v_pk_add_f32 v[216:217], v[216:217], v[200:201]
    v_pk_add_f32 v[218:219], v[218:219], v[202:203]
    v_pk_add_f32 v[220:221], v[220:221], v[204:205]
    v_pk_add_f32 v[222:223], v[222:223], v[206:207]
    s_waitcnt vmcnt(0)
    v_lshlrev_b32 v96, 16, v240
    v_and_b32 v97, 0xffff0000, v240
    v_lshlrev_b32 v98, 16, v241
    v_and_b32 v99, 0xffff0000, v241
    v_lshlrev_b32 v100, 16, v242
    v_and_b32 v101, 0xffff0000, v242
    v_lshlrev_b32 v102, 16, v243
    v_and_b32 v103, 0xffff0000, v243
    v_lshlrev_b32 v104, 16, v244
    v_and_b32 v105, 0xffff0000, v244
    v_lshlrev_b32 v106, 16, v245
    v_and_b32 v107, 0xffff0000, v245
    v_lshlrev_b32 v108, 16, v246
    v_and_b32 v109, 0xffff0000, v246
    v_lshlrev_b32 v110, 16, v247
    v_and_b32 v111, 0xffff0000, v247
    v_pk_add_f32 v[208:209], v[208:209], v[96:97]
    v_pk_add_f32 v[210:211], v[210:211], v[98:99]
    v_pk_add_f32 v[212:213], v[212:213], v[100:101]
    v_pk_add_f32 v[214:215], v[214:215], v[102:103]
    v_pk_add_f32 v[216:217], v[216:217], v[104:105]
    v_pk_add_f32 v[218:219], v[218:219], v[106:107]
    v_pk_add_f32 v[220:221], v[220:221], v[108:109]
    v_pk_add_f32 v[222:223], v[222:223], v[110:111]
    v_cvt_pk_bf16_f32 v88, v208, v209
    v_cvt_pk_bf16_f32 v89, v210, v211
    v_cvt_pk_bf16_f32 v90, v216, v217
    v_cvt_pk_bf16_f32 v91, v218, v219
    ds_write2_b64 v12, v[88:89], v[90:91] offset0:0 offset1:4
    ds_read_b128 v[96:99], v14 offset:0
    v_cvt_pk_bf16_f32 v92, v212, v213
    v_cvt_pk_bf16_f32 v93, v214, v215
    v_cvt_pk_bf16_f32 v94, v220, v221
    v_cvt_pk_bf16_f32 v95, v222, v223
    ds_write2_b64 v12, v[92:93], v[94:95] offset0:160 offset1:164
    ds_read_b128 v[100:103], v14 offset:1280
    s_waitcnt lgkmcnt(2)
    buffer_store_dwordx4 v[96:99], v0, s[16:19], s93 offen sc1
    s_waitcnt lgkmcnt(0)
    buffer_store_dwordx4 v[100:103], v0, s[16:19], s4 offen sc1
    s_or_b32 s5, s2, s59
    s_cbranch_scc1 L_fin
    s_mov_b32 s5, 2162688
    s_mov_b64 exec, 1
    buffer_store_dword v33, off, s[24:27], s5 sc1
    s_mov_b64 exec, -1
L_fin:
L_done:
    s_endpgm
L_h0p3_2:
L_h0p3_2_4:
    s_mov_b32 s14, 0
    s_mov_b32 s18, 0
    s_branch L_r0p3_2
L_h1p3_2:
L_h1p3_2_4:
    s_mov_b32 s14, 0
    s_mov_b32 s18, 0
    s_branch L_r1p3_2
L_h2p3_2:
L_h2p3_2_4:
    s_mov_b32 s14, 0
    s_mov_b32 s18, 0
    s_branch L_r2p3_2
L_h3p3_2:
L_h3p3_2_4:
    s_mov_b32 s14, 0
    s_mov_b32 s18, 0
    s_branch L_r3p3_2
L_h5p3_2:
L_h5p3_2_4:
    s_mov_b32 s14, 0
    s_mov_b32 s18, 0
    s_branch L_r5p3_2
L_h6p3_2:
L_h6p3_2_4:
    s_mov_b32 s14, 0
    s_mov_b32 s18, 0
    s_branch L_r6p3_2
L_h7p0_27:
    s_cmp_eq_u32 s36, 1
    s_cbranch_scc1 L_h7p0_27_1
    s_cmp_eq_u32 s36, 2
    s_cbranch_scc1 L_h7p0_27_2
    s_cmp_eq_u32 s36, 3
    s_cbranch_scc1 L_h7p0_27_3
    s_cmp_eq_u32 s36, 4
    s_cbranch_scc1 L_h7p0_27_4
L_h7p0_27_0:
    buffer_load_dword v20, v21, s[76:79], s39 offen
    s_add_u32 s39, s39, 0x180000
    global_load_dword v20, v[22:23], off
    v_add_co_u32 v22, vcc, 917504, v22
    s_nop 1
    v_addc_co_u32 v23, vcc, 0, v23, vcc
    s_branch L_r7p0_27
L_h7p0_27_1:
    buffer_load_dword v20, v21, s[76:79], s39 offen
    s_add_u32 s39, s39, 0xffb80000
    global_load_dword v20, v[22:23], off
    v_add_co_u32 v22, vcc, 917504, v22
    s_nop 1
    v_addc_co_u32 v23, vcc, 0, v23, vcc
    s_branch L_r7p0_27
L_h7p0_27_2:
    buffer_load_dword v20, v21, s[76:79], s39 offen
    s_add_u32 s39, s39, 0x180000
    global_load_dword v20, v[22:23], off
    v_add_co_u32 v22, vcc, 917504, v22
    s_nop 1
    v_addc_co_u32 v23, vcc, 0, v23, vcc
    s_branch L_r7p0_27
L_h7p0_27_3:
    buffer_load_dword v20, v6, s[12:15], s65 offen
    s_add_u32 s65, s65, 0x1c00
    buffer_load_dword v20, v6, s[12:15], s65 offen
    s_add_u32 s65, s65, 0x1c00
    s_branch L_r7p0_27
L_h7p0_27_4:
    buffer_load_dword v20, v6, s[12:15], s65 offen
    s_add_u32 s65, s65, 0x1c00
    buffer_load_dword v20, v6, s[12:15], s65 offen
    s_add_u32 s65, s65, 0x1c00
    buffer_load_dword v20, v7, s[16:19], s67 offen
    s_lshl_b32 s5, s63, 11
    s_mov_b32 m0, 161792
    s_nop 0
    buffer_load_dwordx4 v2, s[32:35], s5 offen offset:0 lds
    buffer_load_dwordx4 v2, s[32:35], s5 offen offset:1024 lds
    s_branch L_r7p0_27
L_h4p3_2:
L_h4p3_2_4:
    s_mov_b32 s14, 0
    s_mov_b32 s18, 0
    s_branch L_r4p3_2
L_end:
.section .rodata,"a"
.p2align 6
.amdhsa_kernel parallel_sum__linear_kernel_hedgehog__geglu_ffn__prompt_kernel
  .amdhsa_next_free_vgpr 256
  .amdhsa_next_free_sgpr 102
  .amdhsa_accum_offset 256
  .amdhsa_group_segment_fixed_size 0
  .amdhsa_kernarg_size 88
  .amdhsa_user_sgpr_count 2
  .amdhsa_user_sgpr_kernarg_segment_ptr 1
  .amdhsa_system_sgpr_workgroup_id_x 1
.end_amdhsa_kernel
```
